```python
import torch

def _softmax(x, axis=-1):
    return torch.softmax(x, dim=axis)
def _gelu(x):
    return torch.nn.functional.gelu(x, approximate="tanh")
def _silu(x):
    return torch.nn.functional.silu(x)
def _sigmoid(x):
    return torch.sigmoid(x)
def _layernorm(x, axis=-1, eps=1e-5):
    m = x.mean(dim=axis, keepdim=True)
    v = x.var(dim=axis, keepdim=True, unbiased=False)
    return (x - m) / torch.sqrt(v + eps)
def _scatter_add(tgt, idx, src, axis=0):
    return tgt.clone().index_add_(axis, idx, src)
def _segment_sum(src, seg, n):
    out = torch.zeros((n,) + src.shape[1:], dtype=src.dtype)
    return out.index_add_(0, seg, src)
def _pad(x, pw):
    flat = tuple(v for pair in reversed(pw) for v in pair)
    return torch.nn.functional.pad(x, flat)

kernel_name = 'concat_heads__sliding_local_dilated__compressed_kv_cla__prompt'

def setup_inputs():

    _w = (lambda a: (lambda t: t.to(torch.bfloat16) if t.is_floating_point() else t)(torch.as_tensor(a)))
    def _A_setup():
        B, S, D = 1, 2048, 448
        return {
            "x": _w((lambda *s: torch.randn(*s, dtype=torch.bfloat16) * 0.4)(B, S, D)),
            "wqkv": _w((lambda *s: torch.randn(*s, dtype=torch.bfloat16) * 0.4)(D, 3 * D)),
            "wo": _w((lambda *s: torch.randn(*s, dtype=torch.bfloat16) * 0.05)(D, D)),
        }
    _A_in = _A_setup()

    def _B_setup():
        B, H, Sq, Sk, D, M = 1, 16, 2048, 2048, 256, 448
        Dc = 4 * D
        return {
            "x": _w((lambda *s: torch.randn(*s, dtype=torch.bfloat16) * 0.2)(B, Sq, M)),
            "c_kv": _w((lambda *s: torch.randn(*s, dtype=torch.bfloat16) * 1.6)(B, Sk, Dc)),
            "w_q": _w((lambda *s: torch.randn(*s, dtype=torch.bfloat16) * 3.2)(M, H, D) * (M ** -0.5)),
            "w_uk": _w((lambda *s: torch.randn(*s, dtype=torch.bfloat16) * 3.2)(Dc, H, D) * (Dc ** -0.5)),
            "w_uv": _w((lambda *s: torch.randn(*s, dtype=torch.bfloat16) * 1.6)(Dc, H, D) * (Dc ** -0.5)),
            "w_o": _w((lambda *s: torch.randn(*s, dtype=torch.bfloat16) * 1.6)(H, D, M) * ((H * D) ** -0.5)),
        }
    _B_in = _B_setup()

    return {
        "A_x": _A_in["x"],
        "A_wqkv": _A_in["wqkv"],
        "A_wo": _A_in["wo"],
        "B_x": _B_in["x"],
        "B_c_kv": _B_in["c_kv"],
        "B_w_q": _B_in["w_q"],
        "B_w_uk": _B_in["w_uk"],
        "B_w_uv": _B_in["w_uv"],
        "B_w_o": _B_in["w_o"],
    }

def reference(A_x, A_wqkv, A_wo, B_x, B_c_kv, B_w_q, B_w_uk, B_w_uv, B_w_o):
    def _A_ref(x, wqkv, wo):
        B, S, D = x.shape
        H = 16; Dh = D // H
        W, dil = 8, 2
        qkv = (lambda x, *d: x.permute(*d))((x @ wqkv).reshape(B, S, 3, H, Dh), 2, 0, 3, 1, 4)
        q, k, v = qkv[0], qkv[1], qkv[2]
        scale = Dh ** -0.5
        pos = torch.arange(S)
        off = torch.arange(W) * dil
        idx = pos[:, None] - off[None, :]
        mask = idx >= 0
        idx_c = torch.where(mask, idx, 0).reshape(-1)
        kg = k[:, :, idx_c, :].reshape(B, H, S, W, Dh)
        vg = v[:, :, idx_c, :].reshape(B, H, S, W, Dh)
        logits = torch.einsum("bhsd,bhswd->bhsw", q, kg) * scale
        logits = torch.where(mask[None, None, :, :], logits, -1e9)
        attn = _softmax(logits, axis=-1)
        o = torch.einsum("bhsw,bhswd->bhsd", attn, vg)
        return (lambda x, *d: x.permute(*d))(o, 0, 2, 1, 3).reshape(B, S, D) @ wo

    def _B_ref(x, c_kv, w_q, w_uk, w_uv, w_o):
        B, Sq, M = x.shape[0], x.shape[1], x.shape[2]
        Sk = c_kv.shape[1]
        H, D = w_q.shape[1], w_q.shape[2]
        q = torch.einsum("bqm,mhd->bhqd", x, w_q)
        k = torch.einsum("bkc,chd->bhkd", c_kv, w_uk)
        v = torch.einsum("bkc,chd->bhkd", c_kv, w_uv)
        scores = torch.einsum("bhqd,bhkd->bhqk", q, k) * (D ** -0.5)
        off = Sk - Sq
        qi = torch.arange(Sq)[:, None]
        kj = torch.arange(Sk)[None, :]
        cmask = kj <= (qi + off)
        scores = torch.where(cmask[None, None], scores, -1e9)
        p = _softmax(scores, axis=-1)
        ctx = torch.einsum("bhqk,bhkd->bhqd", p, v)
        return torch.einsum("bhqd,hdm->bqm", ctx, w_o)

    a = _A_ref(A_x, A_wqkv, A_wo)
    b = _B_ref(B_x, B_c_kv, B_w_q, B_w_uk, B_w_uv, B_w_o)
    return torch.concatenate([a, b], axis=-1)
```

```asm
; @launch grid=(256,1,1) block=(256,1,1) lds=163840
.amdgcn_target "amdgcn-amd-amdhsa--gfx950"
.text
.globl concat_heads__sliding_local_dilated__compressed_kv_cla__prompt_kernel
.p2align 8
.type concat_heads__sliding_local_dilated__compressed_kv_cla__prompt_kernel,@function
concat_heads__sliding_local_dilated__compressed_kv_cla__prompt_kernel:
 s_cmp_lt_u32 s2,256
 s_cbranch_scc1 F_GO
 s_endpgm
F_GO:
 s_getpc_b64 s[40:41]
F_PC0:
 s_and_b32 s42,s2,0xf8
 v_lshrrev_b32 v25,6,v0
 v_lshlrev_b32 v26,7,v0
 s_lshr_b32 s42,s42,1
 v_and_b32 v26,0x1f80,v26
 v_add3_u32 v25,v25,s42,v26
 v_lshlrev_b32 v25,7,v25
 v_min_u32 v25,F_ALL-F_PC0-4,v25
 global_load_dword v24,v25,s[40:41]
 s_load_dwordx16 s[60:75],s[0:1],0
 s_load_dwordx2 s[28:29],s[0:1],88
 s_load_dwordx2 s[98:99],s[0:1],64
 s_load_dwordx2 s[78:79],s[0:1],72
 v_lshrrev_b32 v25,6,v0
 v_and_b32 v26,63,v0
 v_readfirstlane_b32 s45,v25
 v_lshlrev_b32 v1,4,v26
 s_bfe_u32 s47,s2,0x30003
 s_bfe_u32 s48,s2,0x20006
 s_and_b32 s46,s2,7
 s_lshl_b32 s46,s46,1
 s_and_b32 s49,s48,1
 s_add_u32 s46,s46,s49
 s_lshl_b32 s51,s45,13
 s_lshr_b32 s44,s47,1
 s_and_b32 s49,s48,2
 s_lshl_b32 s49,s49,1
 s_add_u32 s44,s44,s49
 s_mov_b32 s32,0
 s_mov_b32 s33,15360
 s_mov_b32 s34,30720
 s_mov_b32 s35,46080
 s_mov_b32 s36,65536
 s_mov_b32 s37,80896
 s_mov_b32 s38,96256
 s_mov_b32 s39,111616
 v_bfe_u32 v27,v0,3,3
 v_bfe_u32 v28,v0,4,2
 v_and_b32 v29,7,v0
 v_xor_b32 v29,v29,v28
 v_lshlrev_b32 v29,4,v29
 v_lshl_add_u32 v30,v25,6,v27
 v_lshl_add_u32 v14,v30,11,v29
 v_xor_b32 v15,64,v14
 v_mul_u32_u24 v30,896,v30
 v_add_u32 v20,v30,v29
 v_xor_b32 v21,64,v20
 v_bfe_u32 v27,v0,5,1
 v_lshl_add_u32 v28,v25,4,v27
 v_lshlrev_b32 v28,13,v28
 v_and_b32 v29,31,v0
 v_lshlrev_b32 v27,1,v27
 v_xor_b32 v29,v29,v27
 v_lshl_add_u32 v16,v29,4,v28
 v_xor_b32 v17,64,v16
 v_xor_b32 v18,0x80,v16
 v_xor_b32 v19,0xc0,v16
 s_waitcnt lgkmcnt(0)
 s_cmp_lt_u32 s48,2
 s_cbranch_scc0 K1_V
 s_bitcmp0_b32 s47,0
 s_cselect_b64 s[72:73],s[72:73],s[74:75]
 s_lshl_b32 s49,s46,9
 s_add_u32 s8,s72,s49
 s_addc_u32 s9,s73,0
 s_and_b32 s9,s9,0xffff
 s_sub_u32 s10,8388608,s49
 s_mov_b32 s11,0x20000
 s_lshl_b32 s49,s44,19
 s_add_u32 s4,s68,s49
 s_addc_u32 s5,s69,0
 s_and_b32 s5,s5,0xffff
 s_sub_u32 s6,4194304,s49
 s_mov_b32 s7,0x20000
 s_add_u32 s50,s51,32768
 s_add_u32 m0,s51,98304
 s_nop 0
 buffer_load_dwordx4 v16,s[8:11],s32 offen offset:0 lds
 buffer_load_dwordx4 v17,s[8:11],s33 offen offset:1024 lds
 buffer_load_dwordx4 v16,s[8:11],s34 offen offset:2048 lds
 buffer_load_dwordx4 v17,s[8:11],s35 offen offset:3072 lds
 s_add_u32 m0,s51,102400
 s_nop 0
 buffer_load_dwordx4 v18,s[8:11],s36 offen offset:0 lds
 buffer_load_dwordx4 v19,s[8:11],s37 offen offset:1024 lds
 buffer_load_dwordx4 v18,s[8:11],s38 offen offset:2048 lds
 buffer_load_dwordx4 v19,s[8:11],s39 offen offset:3072 lds
 s_add_u32 s8,s8,524288
 s_addc_u32 s9,s9,0
 s_sub_u32 s10,s10,524288
 s_add_u32 m0,s50,0
 s_nop 0
 buffer_load_dwordx4 v14,s[4:7],s32 offen offset:0 lds
 buffer_load_dwordx4 v15,s[4:7],s33 offen offset:1024 lds
 buffer_load_dwordx4 v14,s[4:7],s34 offen offset:2048 lds
 buffer_load_dwordx4 v15,s[4:7],s35 offen offset:3072 lds
 s_add_u32 m0,s50,4096
 s_nop 0
 buffer_load_dwordx4 v14,s[4:7],s36 offen offset:0 lds
 buffer_load_dwordx4 v15,s[4:7],s37 offen offset:1024 lds
 buffer_load_dwordx4 v14,s[4:7],s38 offen offset:2048 lds
 buffer_load_dwordx4 v15,s[4:7],s39 offen offset:3072 lds
 s_add_u32 s4,s4,128
 s_addc_u32 s5,s5,0
 s_sub_u32 s6,s6,128
 s_add_u32 s50,s50,32768
 s_cmp_ge_u32 s50,98304
 s_cselect_b32 s50,s51,s50
 s_bfe_u32 s76,s2,0x10000
 s_lshl_b32 s76,s76,2
 s_and_b32 s49,s47,3
 s_add_u32 s76,s76,s49
 s_andn2_b32 s77,s46,2
 s_lshr_b32 s49,s47,1
 s_and_b32 s49,s49,2
 s_add_u32 s77,s77,s49
 s_mov_b32 s49,0
 s_add_u32 s24,s60,s49
 s_addc_u32 s25,s61,0
 s_and_b32 s25,s25,0xffff
 s_sub_u32 s26,1835008,s49
 s_mov_b32 s27,0x20000
 s_mul_i32 s49,s77,56
 s_and_b32 s49,s49,-16
 s_add_u32 s72,s62,s49
 s_addc_u32 s73,s63,0
 s_and_b32 s73,s73,0xffff
 s_sub_u32 s74,1204224,s49
 s_mov_b32 s75,0x20000
 s_mul_i32 s52,s45,9216
 s_mul_i32 s53,s45,3072
 s_lshl_b32 s49,s76,8
 s_mul_i32 s100,s45,72
 s_add_u32 s49,s49,s100
 s_cmp_eq_u32 s49,0
 s_cselect_b32 s100,14336,0
 s_cselect_b32 s101,16,s49
 s_sub_u32 s49,s101,16
 s_sub_u32 s12,0,s100
 s_sub_u32 s13,7168,s100
 s_sub_u32 s14,14336,s100
 s_sub_u32 s15,21504,s100
 s_sub_u32 s16,28672,s100
 s_sub_u32 s17,35840,s100
 s_sub_u32 s18,43008,s100
 s_sub_u32 s19,50176,s100
 s_sub_u32 s20,57344,s100
 s_cmp_eq_u32 s45,3
 s_cselect_b32 s19,0x80000000,s19
 s_cselect_b32 s20,0x80000000,s20
 v_bfe_u32 v26,v0,3,3
 v_add_u32 v26,s49,v26
 v_mul_u32_u24 v26,896,v26
 v_bfe_u32 v27,v0,4,3
 v_and_b32 v28,7,v0
 v_xor_b32 v28,v28,v27
 v_lshl_add_u32 v20,v28,4,v26
 v_xor_b32 v21,64,v20
 v_lshrrev_b32 v25,6,v0
 v_and_b32 v26,63,v0
 v_mul_u32_u24 v27,192,v25
 v_add_u32 v26,v26,v27
 v_add_u32 v27,0,v26
 v_mul_u32_u24 v28,43691,v27
 v_lshrrev_b32 v28,19,v28
 v_mul_u32_u24 v29,12,v28
 v_sub_u32 v29,v27,v29
 v_lshrrev_b32 v29,2,v29
 v_mul_u32_u24 v28,2688,v28
 v_mul_u32_u24 v29,896,v29
 v_and_b32 v27,3,v27
 v_lshl_add_u32 v28,v27,4,v28
 v_add_u32 v28,v28,v29
 v_subrev_u32 v38,0,v28
 v_add_u32 v27,64,v26
 v_mul_u32_u24 v28,43691,v27
 v_lshrrev_b32 v28,19,v28
 v_mul_u32_u24 v29,12,v28
 v_sub_u32 v29,v27,v29
 v_lshrrev_b32 v29,2,v29
 v_mul_u32_u24 v28,2688,v28
 v_mul_u32_u24 v29,896,v29
 v_and_b32 v27,3,v27
 v_lshl_add_u32 v28,v27,4,v28
 v_add_u32 v28,v28,v29
 v_subrev_u32 v39,1024,v28
 v_add_u32 v27,128,v26
 v_mul_u32_u24 v28,43691,v27
 v_lshrrev_b32 v28,19,v28
 v_mul_u32_u24 v29,12,v28
 v_sub_u32 v29,v27,v29
 v_lshrrev_b32 v29,2,v29
 v_mul_u32_u24 v28,2688,v28
 v_mul_u32_u24 v29,896,v29
 v_and_b32 v27,3,v27
 v_lshl_add_u32 v28,v27,4,v28
 v_add_u32 v28,v28,v29
 v_subrev_u32 v40,2048,v28
 v_bfe_u32 v26,v0,4,2
 v_bfe_u32 v27,v0,2,2
 v_lshl_add_u32 v26,v26,3,v27
 v_mul_u32_u24 v26,192,v26
 s_and_b32 s49,s77,1
 s_lshl_b32 s49,s49,3
 v_add_u32 v26,s49,v26
 v_and_b32 v27,3,v0
 v_lshlrev_b32 v27,3,v27
 v_add_u32 v41,v26,v27
 v_add_u32 v27,32,v27
 v_min_u32 v27,48,v27
 v_add_u32 v42,v26,v27
 s_lshl_b32 s21,s47,2
 s_add_u32 s21,s21,s45
 s_and_b32 s22,s21,7
 s_lshl_b32 s49,s46,3
 s_add_u32 s49,s49,s22
 s_mul_i32 s60,s49,28672
 s_lshr_b32 s49,s21,3
 s_lshl_b32 s61,s49,7
 s_add_u32 s60,s60,s61
 s_mul_i32 s100,s46,229376
 s_lshl_b32 s49,s49,15
 s_add_u32 s100,s100,s49
 s_lshl_b32 s49,s22,10
 s_add_u32 s100,s100,s49
 s_add_u32 s100,s100,104857600
 s_add_u32 s40,s98,s60
 s_addc_u32 s41,s99,0
 s_and_b32 s41,s41,0xffff
 s_sub_u32 s42,3670016,s60
 s_mov_b32 s43,0x20000
 s_add_u32 s60,s60,512
 s_add_u32 s101,s100,131072
 s_mul_i32 s61,s46,25088
 s_lshl_b32 s49,s22,7
 s_add_u32 s61,s61,s49
 s_lshl_b32 s62,s22,16
 s_lshl_b32 s49,s46,10
 s_add_u32 s62,s62,s49
 s_and_b32 s49,s49,8192
 s_add_u32 s62,s62,s49
 s_add_u32 s62,s62,109051904
 s_cmp_lt_u32 s21,24
 s_cselect_b32 s60,s60,s61
 s_cselect_b32 s101,s101,s62
 s_mov_b32 s57,24576
 s_cselect_b32 s57,8192,s57
 s_cselect_b32 s98,s98,s64
 s_cselect_b32 s99,s99,s65
 s_mov_b32 s22,401408
 s_cselect_b32 s22,3670016,s22
 s_add_u32 s64,s98,s60
 s_addc_u32 s65,s99,0
 s_and_b32 s65,s65,0xffff
 s_sub_u32 s66,s22,s60
 s_mov_b32 s67,0x20000
 s_cmp_eq_u32 s21,31
 s_cselect_b32 s66,0,s66
 v_bfe_u32 v25,v0,3,3
 v_mul_u32_u24 v25,896,v25
 v_and_b32 v26,7,v0
 v_lshl_add_u32 v43,v26,4,v25
 v_and_b32 v27,15,v0
 v_bfe_u32 v28,v0,1,3
 v_bfe_u32 v29,v0,4,2
 v_xor_b32 v28,v28,v29
 v_lshlrev_b32 v28,4,v28
 v_lshl_add_u32 v2,v27,7,v28
 v_xor_b32 v3,64,v2
 v_bfe_u32 v27,v0,2,2
 v_lshl_add_u32 v28,v29,3,v27
 v_lshlrev_b32 v28,9,v28
 v_add_u32 v28,0x18000,v28
 v_bfe_u32 v30,v0,6,1
 v_lshl_add_u32 v28,v30,8,v28
 v_and_b32 v30,3,v0
 v_lshl_add_u32 v28,v30,3,v28
 v_bfe_u32 v27,v0,2,3
 v_xor_b32 v30,0,v27
 v_lshl_add_u32 v6,v30,5,v28
 v_xor_b32 v30,1,v27
 v_lshl_add_u32 v7,v30,5,v28
 v_xor_b32 v30,2,v27
 v_lshl_add_u32 v8,v30,5,v28
 v_xor_b32 v30,3,v27
 v_lshl_add_u32 v9,v30,5,v28
 v_xor_b32 v30,4,v27
 v_lshl_add_u32 v10,v30,5,v28
 v_xor_b32 v30,5,v27
 v_lshl_add_u32 v11,v30,5,v28
 v_xor_b32 v30,6,v27
 v_lshl_add_u32 v12,v30,5,v28
 v_xor_b32 v30,7,v27
 v_lshl_add_u32 v13,v30,5,v28
 s_and_b32 s29,s29,0xffff
 s_mov_b32 s30,134217728
 s_mov_b32 s31,0x20000
 s_add_u32 s59,s47,0
 s_lshr_b32 s54,s45,1
 s_lshl_b32 s54,s54,14
 s_lshl_b32 s56,s46,20
 s_lshl_b32 s49,s54,2
 s_add_u32 s56,s56,s49
 s_and_b32 s49,s45,1
 s_lshl_b32 s49,s49,12
 s_lshl_b32 s58,s49,2
 s_add_u32 s58,s58,16777216
 s_bitcmp0_b32 s47,0
 s_cselect_b32 s49,s49,s58
 s_add_u32 s56,s56,s49
 s_lshl_b32 s49,s44,17
 s_add_u32 s56,s56,s49
 s_mov_b32 s58,0x3db8aa3b
 s_load_dwordx2 s[70:71],s[0:1],80
 s_and_b32 s49,s44,3
 s_lshl_b32 s49,s49,2
 s_add_u32 s49,s49,s45
 s_lshl_b32 s49,s49,16
 v_bfe_u32 v25,v0,2,3
 v_lshlrev_b32 v25,13,v25
 v_and_b32 v26,3,v0
 v_lshl_add_u32 v25,v26,7,v25
 v_add_u32 v32,s49,v25
 v_and_b32 v25,63,v0
 v_bfrev_b32 v30,1
 s_lshl_b32 s49,s76,4
 s_add_u32 s49,s49,s77
 s_lshl_b32 s49,s49,2
 s_add_u32 s49,s49,s45
 s_lshl_b32 s49,s49,2
 v_add_u32 v26,s49,v25
 v_mul_u32_u24 v26,896,v26
 v_cmp_gt_u32 vcc,4,v25
 s_nop 1
 v_cndmask_b32 v35,v30,v26,vcc
 s_lshl_b32 s49,s76,2
 s_add_u32 s49,s49,s45
 s_lshl_b32 s49,s49,1
 v_lshrrev_b32 v26,3,v25
 v_add_u32 v26,s49,v26
 v_mul_u32_u24 v26,2688,v26
 v_bfe_u32 v27,v25,1,2
 v_min_u32 v27,2,v27
 v_mul_u32_u24 v27,896,v27
 v_and_b32 v28,1,v25
 v_mul_u32_u24 v28,60,v28
 v_add3_u32 v26,v26,v27,v28
 v_cmp_gt_u32 vcc,16,v25
 s_nop 1
 v_cndmask_b32 v36,v30,v26,vcc
 v_mul_u32_u24 v26,896,v25
 v_cmp_gt_u32 vcc,5,v25
 s_nop 1
 v_cndmask_b32 v37,v30,v26,vcc
 s_add_u32 m0,s51,131072
 s_nop 0
 buffer_load_dwordx4 v16,s[8:11],s32 offen offset:0 lds
 buffer_load_dwordx4 v17,s[8:11],s33 offen offset:1024 lds
 buffer_load_dwordx4 v16,s[8:11],s34 offen offset:2048 lds
 buffer_load_dwordx4 v17,s[8:11],s35 offen offset:3072 lds
 s_add_u32 m0,s51,135168
 s_nop 0
 buffer_load_dwordx4 v18,s[8:11],s36 offen offset:0 lds
 buffer_load_dwordx4 v19,s[8:11],s37 offen offset:1024 lds
 buffer_load_dwordx4 v18,s[8:11],s38 offen offset:2048 lds
 buffer_load_dwordx4 v19,s[8:11],s39 offen offset:3072 lds
 s_add_u32 s8,s8,524288
 s_addc_u32 s9,s9,0
 s_sub_u32 s10,s10,524288
 v_bfe_u32 v26,v0,5,1
 v_min_u32 v26,0,v26
 v_lshl_add_u32 v25,v26,20,v32
 v_add_u32 v32,0x80000,v32
 buffer_load_dword v24,v25,s[8:11],0 offen
 s_lshl_b32 s61,s46,1
 s_and_b32 s62,s47,1
 s_add_u32 s61,s61,s62
 s_lshl_b32 s61,s61,2
 s_add_u32 s61,s61,s45
 s_lshl_b32 s61,s61,12
 v_and_b32 v25,1,v0
 v_lshlrev_b32 v25,11,v25
 v_bfe_u32 v26,v0,1,5
 v_lshl_add_u32 v25,v26,7,v25
 v_add_u32 v25,s61,v25
 v_bfrev_b32 v27,1
 v_cmp_gt_u32 vcc,3,v26
 v_add_u32 v28,128,v25
 s_nop 0
 v_cndmask_b32 v25,v27,v25,vcc
 v_cmp_gt_u32 vcc,2,v26
 buffer_load_dword v24,v25,s[4:7],0 offen
 s_nop 0
 v_cndmask_b32 v33,v27,v28,vcc
 s_cmp_eq_u32 s2,0
 s_cbranch_scc0 F_NOZ
 s_mov_b32 s60,125829120
 v_mov_b32 v25,0
 v_lshlrev_b32 v26,7,v0
 buffer_store_dword v25,v26,s[28:31],s60 offen sc1
F_NOZ:
 s_add_u32 s55,s54,32768
 v_add_u32 v4,s55,v2
 v_add_u32 v5,s55,v3
 s_waitcnt vmcnt(10)
 s_barrier
 ds_read_b64_tr_b16 a[64:65],v6 offset:0
 ds_read_b64_tr_b16 a[66:67],v6 offset:2048
 ds_read_b64_tr_b16 a[68:69],v6 offset:16384
 ds_read_b64_tr_b16 a[70:71],v6 offset:18432
 ds_read_b64_tr_b16 a[72:73],v7 offset:0
 ds_read_b64_tr_b16 a[74:75],v7 offset:2048
 ds_read_b64_tr_b16 a[76:77],v7 offset:16384
 ds_read_b64_tr_b16 a[78:79],v7 offset:18432
 ds_read_b64_tr_b16 a[80:81],v8 offset:0
 ds_read_b64_tr_b16 a[82:83],v8 offset:2048
 ds_read_b64_tr_b16 a[84:85],v8 offset:16384
 ds_read_b64_tr_b16 a[86:87],v8 offset:18432
 ds_read_b64_tr_b16 a[88:89],v9 offset:0
 ds_read_b64_tr_b16 a[90:91],v9 offset:2048
 ds_read_b64_tr_b16 a[92:93],v9 offset:16384
 ds_read_b64_tr_b16 a[94:95],v9 offset:18432
 ds_read_b64_tr_b16 a[96:97],v10 offset:0
 ds_read_b64_tr_b16 a[98:99],v10 offset:2048
 ds_read_b64_tr_b16 a[100:101],v10 offset:16384
 ds_read_b64_tr_b16 a[102:103],v10 offset:18432
 ds_read_b64_tr_b16 a[104:105],v11 offset:0
 ds_read_b64_tr_b16 a[106:107],v11 offset:2048
 ds_read_b64_tr_b16 a[108:109],v11 offset:16384
 ds_read_b64_tr_b16 a[110:111],v11 offset:18432
 ds_read_b64_tr_b16 a[112:113],v12 offset:0
 ds_read_b64_tr_b16 a[114:115],v12 offset:2048
 ds_read_b64_tr_b16 a[116:117],v12 offset:16384
 ds_read_b64_tr_b16 a[118:119],v12 offset:18432
 ds_read_b64_tr_b16 a[120:121],v13 offset:0
 ds_read_b64_tr_b16 a[122:123],v13 offset:2048
 ds_read_b64_tr_b16 a[124:125],v13 offset:16384
 ds_read_b64_tr_b16 a[126:127],v13 offset:18432
 ds_read_b128 a[192:195],v4 offset:0
 ds_read_b128 a[196:199],v5 offset:0
 s_waitcnt lgkmcnt(0)
 s_barrier
 s_bitcmp1_b32 s47,0
 s_cbranch_scc1 G1_V
 v_mfma_f32_16x16x32_bf16 v[48:51],a[64:67],a[192:195],0
 s_add_u32 m0,s50,0
 v_mfma_f32_16x16x32_bf16 v[48:51],a[68:71],a[196:199],v[48:51]
 ds_read_b128 a[200:203],v4 offset:2048
 v_mfma_f32_16x16x32_bf16 v[52:55],a[72:75],a[192:195],0
 buffer_load_dwordx4 v14,s[4:7],s32 offen offset:0 lds
 v_mfma_f32_16x16x32_bf16 v[52:55],a[76:79],a[196:199],v[52:55]
 ds_read_b128 a[204:207],v5 offset:2048
 v_mfma_f32_16x16x32_bf16 v[56:59],a[80:83],a[192:195],0
 v_mfma_f32_16x16x32_bf16 v[56:59],a[84:87],a[196:199],v[56:59]
 buffer_load_dwordx4 v15,s[4:7],s33 offen offset:1024 lds
 v_mfma_f32_16x16x32_bf16 v[60:63],a[88:91],a[192:195],0
 v_mfma_f32_16x16x32_bf16 v[60:63],a[92:95],a[196:199],v[60:63]
 buffer_load_dwordx4 v14,s[4:7],s34 offen offset:2048 lds
 v_mfma_f32_16x16x32_bf16 v[64:67],a[96:99],a[192:195],0
 v_mfma_f32_16x16x32_bf16 v[64:67],a[100:103],a[196:199],v[64:67]
 v_mfma_f32_16x16x32_bf16 v[68:71],a[104:107],a[192:195],0
 buffer_load_dwordx4 v15,s[4:7],s35 offen offset:3072 lds
 v_mfma_f32_16x16x32_bf16 v[68:71],a[108:111],a[196:199],v[68:71]
 v_mfma_f32_16x16x32_bf16 v[72:75],a[112:115],a[192:195],0
 s_add_u32 m0,s50,4096
 v_mfma_f32_16x16x32_bf16 v[72:75],a[116:119],a[196:199],v[72:75]
 v_mfma_f32_16x16x32_bf16 v[76:79],a[120:123],a[192:195],0
 v_mfma_f32_16x16x32_bf16 v[76:79],a[124:127],a[196:199],v[76:79]
 s_waitcnt lgkmcnt(0)
 v_mfma_f32_16x16x32_bf16 v[80:83],a[64:67],a[200:203],0
 buffer_load_dwordx4 v14,s[4:7],s36 offen offset:0 lds
 v_mfma_f32_16x16x32_bf16 v[80:83],a[68:71],a[204:207],v[80:83]
 ds_read_b128 a[192:195],v4 offset:4096
 v_mfma_f32_16x16x32_bf16 v[84:87],a[72:75],a[200:203],0
 buffer_load_dwordx4 v15,s[4:7],s37 offen offset:1024 lds
 v_mfma_f32_16x16x32_bf16 v[84:87],a[76:79],a[204:207],v[84:87]
 ds_read_b128 a[196:199],v5 offset:4096
 v_mfma_f32_16x16x32_bf16 v[88:91],a[80:83],a[200:203],0
 buffer_load_dwordx4 v14,s[4:7],s38 offen offset:2048 lds
 v_mfma_f32_16x16x32_bf16 v[88:91],a[84:87],a[204:207],v[88:91]
 v_mfma_f32_16x16x32_bf16 v[92:95],a[88:91],a[200:203],0
 buffer_load_dwordx4 v15,s[4:7],s39 offen offset:3072 lds
 v_mfma_f32_16x16x32_bf16 v[92:95],a[92:95],a[204:207],v[92:95]
 v_mfma_f32_16x16x32_bf16 v[96:99],a[96:99],a[200:203],0
 v_mfma_f32_16x16x32_bf16 v[96:99],a[100:103],a[204:207],v[96:99]
 s_add_u32 s4,s4,128
 s_addc_u32 s5,s5,0
 v_mfma_f32_16x16x32_bf16 v[100:103],a[104:107],a[200:203],0
 v_mfma_f32_16x16x32_bf16 v[100:103],a[108:111],a[204:207],v[100:103]
 s_sub_u32 s6,s6,128
 v_mfma_f32_16x16x32_bf16 v[104:107],a[112:115],a[200:203],0
 v_mfma_f32_16x16x32_bf16 v[104:107],a[116:119],a[204:207],v[104:107]
 v_mfma_f32_16x16x32_bf16 v[108:111],a[120:123],a[200:203],0
 s_add_u32 s50,s50,32768
 v_mfma_f32_16x16x32_bf16 v[108:111],a[124:127],a[204:207],v[108:111]
 s_waitcnt lgkmcnt(0)
 v_mfma_f32_16x16x32_bf16 v[112:115],a[64:67],a[192:195],0
 s_cmp_ge_u32 s50,98304
 s_cselect_b32 s50,s51,s50
 v_mfma_f32_16x16x32_bf16 v[112:115],a[68:71],a[196:199],v[112:115]
 ds_read_b128 a[200:203],v4 offset:6144
 v_mfma_f32_16x16x32_bf16 v[116:119],a[72:75],a[192:195],0
 v_mfma_f32_16x16x32_bf16 v[116:119],a[76:79],a[196:199],v[116:119]
 ds_read_b128 a[204:207],v5 offset:6144
 s_add_u32 m0,s51,98304
 v_mfma_f32_16x16x32_bf16 v[120:123],a[80:83],a[192:195],0
 v_mfma_f32_16x16x32_bf16 v[120:123],a[84:87],a[196:199],v[120:123]
 buffer_load_dwordx4 v16,s[8:11],s32 offen offset:0 lds
 v_mfma_f32_16x16x32_bf16 v[124:127],a[88:91],a[192:195],0
 v_mfma_f32_16x16x32_bf16 v[124:127],a[92:95],a[196:199],v[124:127]
 v_mfma_f32_16x16x32_bf16 v[128:131],a[96:99],a[192:195],0
 buffer_load_dwordx4 v17,s[8:11],s33 offen offset:1024 lds
 v_mfma_f32_16x16x32_bf16 v[128:131],a[100:103],a[196:199],v[128:131]
 v_mfma_f32_16x16x32_bf16 v[132:135],a[104:107],a[192:195],0
 buffer_load_dwordx4 v16,s[8:11],s34 offen offset:2048 lds
 v_mfma_f32_16x16x32_bf16 v[132:135],a[108:111],a[196:199],v[132:135]
 v_mfma_f32_16x16x32_bf16 v[136:139],a[112:115],a[192:195],0
 v_mfma_f32_16x16x32_bf16 v[136:139],a[116:119],a[196:199],v[136:139]
 buffer_load_dwordx4 v17,s[8:11],s35 offen offset:3072 lds
 v_mfma_f32_16x16x32_bf16 v[140:143],a[120:123],a[192:195],0
 v_mfma_f32_16x16x32_bf16 v[140:143],a[124:127],a[196:199],v[140:143]
 s_waitcnt lgkmcnt(0)
 s_add_u32 m0,s51,102400
 v_mfma_f32_16x16x32_bf16 v[144:147],a[64:67],a[200:203],0
 v_mfma_f32_16x16x32_bf16 v[144:147],a[68:71],a[204:207],v[144:147]
 ds_read_b128 a[192:195],v4 offset:8192
 v_mfma_f32_16x16x32_bf16 v[148:151],a[72:75],a[200:203],0
 buffer_load_dwordx4 v18,s[8:11],s36 offen offset:0 lds
 v_mfma_f32_16x16x32_bf16 v[148:151],a[76:79],a[204:207],v[148:151]
 ds_read_b128 a[196:199],v5 offset:8192
 v_mfma_f32_16x16x32_bf16 v[152:155],a[80:83],a[200:203],0
 buffer_load_dwordx4 v19,s[8:11],s37 offen offset:1024 lds
 v_mfma_f32_16x16x32_bf16 v[152:155],a[84:87],a[204:207],v[152:155]
 v_mfma_f32_16x16x32_bf16 v[156:159],a[88:91],a[200:203],0
 v_mfma_f32_16x16x32_bf16 v[156:159],a[92:95],a[204:207],v[156:159]
 buffer_load_dwordx4 v18,s[8:11],s38 offen offset:2048 lds
 v_mfma_f32_16x16x32_bf16 v[160:163],a[96:99],a[200:203],0
 s_waitcnt vmcnt(17)
 s_barrier
 v_mfma_f32_16x16x32_bf16 v[160:163],a[100:103],a[204:207],v[160:163]
 ds_read_b64_tr_b16 a[128:129],v6 offset:32768
 v_mfma_f32_16x16x32_bf16 v[164:167],a[104:107],a[200:203],0
 buffer_load_dwordx4 v19,s[8:11],s39 offen offset:3072 lds
 v_mfma_f32_16x16x32_bf16 v[164:167],a[108:111],a[204:207],v[164:167]
 ds_read_b64_tr_b16 a[130:131],v6 offset:34816
 ds_read_b64_tr_b16 a[132:133],v6 offset:49152
 v_mfma_f32_16x16x32_bf16 v[168:171],a[112:115],a[200:203],0
 s_add_u32 s8,s8,524288
 s_addc_u32 s9,s9,0
 v_mfma_f32_16x16x32_bf16 v[168:171],a[116:119],a[204:207],v[168:171]
 ds_read_b64_tr_b16 a[134:135],v6 offset:51200
 v_mfma_f32_16x16x32_bf16 v[172:175],a[120:123],a[200:203],0
 s_sub_u32 s10,s10,524288
 ds_read_b64_tr_b16 a[136:137],v7 offset:32768
 v_mfma_f32_16x16x32_bf16 v[172:175],a[124:127],a[204:207],v[172:175]
 s_waitcnt lgkmcnt(5)
 v_mfma_f32_16x16x32_bf16 v[176:179],a[64:67],a[192:195],0
 ds_read_b64_tr_b16 a[138:139],v7 offset:34816
 v_mfma_f32_16x16x32_bf16 v[176:179],a[68:71],a[196:199],v[176:179]
 ds_read_b128 a[200:203],v4 offset:10240
 s_add_u32 m0,s50,0
 v_mfma_f32_16x16x32_bf16 v[180:183],a[72:75],a[192:195],0
 ds_read_b64_tr_b16 a[140:141],v7 offset:49152
 v_mfma_f32_16x16x32_bf16 v[180:183],a[76:79],a[196:199],v[180:183]
 ds_read_b128 a[204:207],v5 offset:10240
 ds_read_b64_tr_b16 a[142:143],v7 offset:51200
 v_mfma_f32_16x16x32_bf16 v[184:187],a[80:83],a[192:195],0
 buffer_load_dwordx4 v14,s[4:7],s32 offen offset:0 lds
 v_mfma_f32_16x16x32_bf16 v[184:187],a[84:87],a[196:199],v[184:187]
 ds_read_b64_tr_b16 a[144:145],v8 offset:32768
 v_mfma_f32_16x16x32_bf16 v[188:191],a[88:91],a[192:195],0
 buffer_load_dwordx4 v15,s[4:7],s33 offen offset:1024 lds
 v_mfma_f32_16x16x32_bf16 v[188:191],a[92:95],a[196:199],v[188:191]
 ds_read_b64_tr_b16 a[146:147],v8 offset:34816
 ds_read_b64_tr_b16 a[148:149],v8 offset:49152
 v_mfma_f32_16x16x32_bf16 v[192:195],a[96:99],a[192:195],0
 buffer_load_dwordx4 v14,s[4:7],s34 offen offset:2048 lds
 v_mfma_f32_16x16x32_bf16 v[192:195],a[100:103],a[196:199],v[192:195]
 ds_read_b64_tr_b16 a[150:151],v8 offset:51200
 v_mfma_f32_16x16x32_bf16 v[196:199],a[104:107],a[192:195],0
 ds_read_b64_tr_b16 a[152:153],v9 offset:32768
 v_mfma_f32_16x16x32_bf16 v[196:199],a[108:111],a[196:199],v[196:199]
 buffer_load_dwordx4 v15,s[4:7],s35 offen offset:3072 lds
 v_mfma_f32_16x16x32_bf16 v[200:203],a[112:115],a[192:195],0
 ds_read_b64_tr_b16 a[154:155],v9 offset:34816
 v_mfma_f32_16x16x32_bf16 v[200:203],a[116:119],a[196:199],v[200:203]
 s_add_u32 m0,s50,4096
 ds_read_b64_tr_b16 a[156:157],v9 offset:49152
 v_mfma_f32_16x16x32_bf16 v[204:207],a[120:123],a[192:195],0
 v_mfma_f32_16x16x32_bf16 v[204:207],a[124:127],a[196:199],v[204:207]
 s_waitcnt lgkmcnt(8)
 ds_read_b64_tr_b16 a[158:159],v9 offset:51200
 v_mfma_f32_16x16x32_bf16 v[208:211],a[64:67],a[200:203],0
 buffer_load_dwordx4 v14,s[4:7],s36 offen offset:0 lds
 v_mfma_f32_16x16x32_bf16 v[208:211],a[68:71],a[204:207],v[208:211]
 ds_read_b64_tr_b16 a[160:161],v10 offset:32768
 ds_read_b128 a[192:195],v4 offset:12288
 v_mfma_f32_16x16x32_bf16 v[212:215],a[72:75],a[200:203],0
 ds_read_b64_tr_b16 a[162:163],v10 offset:34816
 v_mfma_f32_16x16x32_bf16 v[212:215],a[76:79],a[204:207],v[212:215]
 buffer_load_dword v24,v32,s[8:11],0 offen
 v_mfma_f32_16x16x32_bf16 v[216:219],a[80:83],a[200:203],0
 buffer_load_dwordx4 v15,s[4:7],s37 offen offset:1024 lds
 v_mfma_f32_16x16x32_bf16 v[216:219],a[84:87],a[204:207],v[216:219]
 ds_read_b128 a[196:199],v5 offset:12288
 ds_read_b64_tr_b16 a[164:165],v10 offset:49152
 v_mfma_f32_16x16x32_bf16 v[220:223],a[88:91],a[200:203],0
 ds_read_b64_tr_b16 a[166:167],v10 offset:51200
 ds_read_b64_tr_b16 a[168:169],v11 offset:32768
 v_mfma_f32_16x16x32_bf16 v[220:223],a[92:95],a[204:207],v[220:223]
 buffer_load_dwordx4 v14,s[4:7],s38 offen offset:2048 lds
 v_mfma_f32_16x16x32_bf16 v[224:227],a[96:99],a[200:203],0
 buffer_load_dword v24,v33,s[4:7],0 offen
 v_mfma_f32_16x16x32_bf16 v[224:227],a[100:103],a[204:207],v[224:227]
 buffer_load_dwordx4 v15,s[4:7],s39 offen offset:3072 lds
 v_mfma_f32_16x16x32_bf16 v[228:231],a[104:107],a[200:203],0
 ds_read_b64_tr_b16 a[170:171],v11 offset:34816
 ds_read_b64_tr_b16 a[172:173],v11 offset:49152
 v_mfma_f32_16x16x32_bf16 v[228:231],a[108:111],a[204:207],v[228:231]
 s_add_u32 s4,s4,128
 s_addc_u32 s5,s5,0
 v_mfma_f32_16x16x32_bf16 v[232:235],a[112:115],a[200:203],0
 ds_read_b64_tr_b16 a[174:175],v11 offset:51200
 ds_read_b64_tr_b16 a[176:177],v12 offset:32768
 v_mfma_f32_16x16x32_bf16 v[232:235],a[116:119],a[204:207],v[232:235]
 s_sub_u32 s6,s6,128
 ds_read_b64_tr_b16 a[178:179],v12 offset:34816
 v_mfma_f32_16x16x32_bf16 v[236:239],a[120:123],a[200:203],0
 v_mfma_f32_16x16x32_bf16 v[236:239],a[124:127],a[204:207],v[236:239]
 s_waitcnt lgkmcnt(8)
 s_add_u32 s50,s50,32768
 v_mfma_f32_16x16x32_bf16 v[240:243],a[64:67],a[192:195],0
 ds_read_b64_tr_b16 a[180:181],v12 offset:49152
 ds_read_b64_tr_b16 a[182:183],v12 offset:51200
 v_mfma_f32_16x16x32_bf16 v[240:243],a[68:71],a[196:199],v[240:243]
 ds_read_b128 a[200:203],v4 offset:14336
 v_mfma_f32_16x16x32_bf16 v[244:247],a[72:75],a[192:195],0
 s_cmp_ge_u32 s50,98304
 s_cselect_b32 s50,s51,s50
 v_mfma_f32_16x16x32_bf16 v[244:247],a[76:79],a[196:199],v[244:247]
 ds_read_b64_tr_b16 a[184:185],v13 offset:32768
 ds_read_b128 a[204:207],v5 offset:14336
 v_mfma_f32_16x16x32_bf16 v[248:251],a[80:83],a[192:195],0
 ds_read_b64_tr_b16 a[186:187],v13 offset:34816
 v_mfma_f32_16x16x32_bf16 v[248:251],a[84:87],a[196:199],v[248:251]
 ds_read_b64_tr_b16 a[188:189],v13 offset:49152
 v_mfma_f32_16x16x32_bf16 v[252:255],a[88:91],a[192:195],0
 ds_read_b64_tr_b16 a[190:191],v13 offset:51200
 v_mfma_f32_16x16x32_bf16 v[252:255],a[92:95],a[196:199],v[252:255]
 v_mfma_f32_16x16x32_bf16 a[208:211],a[96:99],a[192:195],0
 v_mfma_f32_16x16x32_bf16 a[208:211],a[100:103],a[196:199],a[208:211]
 s_add_u32 s55,s55,32768
 v_mfma_f32_16x16x32_bf16 a[212:215],a[104:107],a[192:195],0
 s_cmp_ge_u32 s55,98304
 s_cselect_b32 s55,s54,s55
 v_mfma_f32_16x16x32_bf16 a[212:215],a[108:111],a[196:199],a[212:215]
 v_add_u32 v4,s55,v2
 v_mfma_f32_16x16x32_bf16 a[216:219],a[112:115],a[192:195],0
 v_add_u32 v5,s55,v3
 v_mfma_f32_16x16x32_bf16 a[216:219],a[116:119],a[196:199],a[216:219]
 v_mfma_f32_16x16x32_bf16 a[220:223],a[120:123],a[192:195],0
 v_mfma_f32_16x16x32_bf16 a[220:223],a[124:127],a[196:199],a[220:223]
 s_waitcnt vmcnt(18) lgkmcnt(0)
 s_barrier
 v_mfma_f32_16x16x32_bf16 a[224:227],a[64:67],a[200:203],0
 ds_read_b128 a[192:195],v4 offset:0
 v_mfma_f32_16x16x32_bf16 a[224:227],a[68:71],a[204:207],a[224:227]
 ds_read_b128 a[196:199],v5 offset:0
 v_mfma_f32_16x16x32_bf16 a[228:231],a[72:75],a[200:203],0
 v_mfma_f32_16x16x32_bf16 a[228:231],a[76:79],a[204:207],a[228:231]
 v_mfma_f32_16x16x32_bf16 a[232:235],a[80:83],a[200:203],0
 v_mfma_f32_16x16x32_bf16 a[232:235],a[84:87],a[204:207],a[232:235]
 v_mfma_f32_16x16x32_bf16 a[236:239],a[88:91],a[200:203],0
 v_mfma_f32_16x16x32_bf16 a[236:239],a[92:95],a[204:207],a[236:239]
 v_mfma_f32_16x16x32_bf16 a[240:243],a[96:99],a[200:203],0
 v_mfma_f32_16x16x32_bf16 a[240:243],a[100:103],a[204:207],a[240:243]
 v_mfma_f32_16x16x32_bf16 a[244:247],a[104:107],a[200:203],0
 v_mfma_f32_16x16x32_bf16 a[244:247],a[108:111],a[204:207],a[244:247]
 v_mfma_f32_16x16x32_bf16 a[248:251],a[112:115],a[200:203],0
 v_mfma_f32_16x16x32_bf16 a[248:251],a[116:119],a[204:207],a[248:251]
 v_mfma_f32_16x16x32_bf16 a[252:255],a[120:123],a[200:203],0
 v_mfma_f32_16x16x32_bf16 a[252:255],a[124:127],a[204:207],a[252:255]
 s_waitcnt lgkmcnt(0)
 v_mfma_f32_16x16x32_bf16 v[48:51],a[128:131],a[192:195],v[48:51]
 s_add_u32 m0,s51,131072
 v_mfma_f32_16x16x32_bf16 v[48:51],a[132:135],a[196:199],v[48:51]
 ds_read_b128 a[200:203],v4 offset:2048
 v_mfma_f32_16x16x32_bf16 v[52:55],a[136:139],a[192:195],v[52:55]
 v_mfma_f32_16x16x32_bf16 v[52:55],a[140:143],a[196:199],v[52:55]
 ds_read_b128 a[204:207],v5 offset:2048
 v_mfma_f32_16x16x32_bf16 v[56:59],a[144:147],a[192:195],v[56:59]
 buffer_load_dwordx4 v16,s[8:11],s32 offen offset:0 lds
 v_mfma_f32_16x16x32_bf16 v[56:59],a[148:151],a[196:199],v[56:59]
 v_mfma_f32_16x16x32_bf16 v[60:63],a[152:155],a[192:195],v[60:63]
 v_mfma_f32_16x16x32_bf16 v[60:63],a[156:159],a[196:199],v[60:63]
 buffer_load_dwordx4 v17,s[8:11],s33 offen offset:1024 lds
 v_mfma_f32_16x16x32_bf16 v[64:67],a[160:163],a[192:195],v[64:67]
 v_mfma_f32_16x16x32_bf16 v[64:67],a[164:167],a[196:199],v[64:67]
 v_mfma_f32_16x16x32_bf16 v[68:71],a[168:171],a[192:195],v[68:71]
 v_mfma_f32_16x16x32_bf16 v[68:71],a[172:175],a[196:199],v[68:71]
 buffer_load_dwordx4 v16,s[8:11],s34 offen offset:2048 lds
 v_mfma_f32_16x16x32_bf16 v[72:75],a[176:179],a[192:195],v[72:75]
 v_mfma_f32_16x16x32_bf16 v[72:75],a[180:183],a[196:199],v[72:75]
 v_mfma_f32_16x16x32_bf16 v[76:79],a[184:187],a[192:195],v[76:79]
 v_mfma_f32_16x16x32_bf16 v[76:79],a[188:191],a[196:199],v[76:79]
 s_waitcnt lgkmcnt(0)
 v_mfma_f32_16x16x32_bf16 v[80:83],a[128:131],a[200:203],v[80:83]
 buffer_load_dwordx4 v17,s[8:11],s35 offen offset:3072 lds
 v_mfma_f32_16x16x32_bf16 v[80:83],a[132:135],a[204:207],v[80:83]
 ds_read_b128 a[192:195],v4 offset:4096
 v_mfma_f32_16x16x32_bf16 v[84:87],a[136:139],a[200:203],v[84:87]
 v_mfma_f32_16x16x32_bf16 v[84:87],a[140:143],a[204:207],v[84:87]
 ds_read_b128 a[196:199],v5 offset:4096
 s_add_u32 m0,s51,135168
 v_mfma_f32_16x16x32_bf16 v[88:91],a[144:147],a[200:203],v[88:91]
 v_mfma_f32_16x16x32_bf16 v[88:91],a[148:151],a[204:207],v[88:91]
 v_mfma_f32_16x16x32_bf16 v[92:95],a[152:155],a[200:203],v[92:95]
 v_mfma_f32_16x16x32_bf16 v[92:95],a[156:159],a[204:207],v[92:95]
 buffer_load_dwordx4 v18,s[8:11],s36 offen offset:0 lds
 v_mfma_f32_16x16x32_bf16 v[96:99],a[160:163],a[200:203],v[96:99]
 v_mfma_f32_16x16x32_bf16 v[96:99],a[164:167],a[204:207],v[96:99]
 v_mfma_f32_16x16x32_bf16 v[100:103],a[168:171],a[200:203],v[100:103]
 buffer_load_dwordx4 v19,s[8:11],s37 offen offset:1024 lds
 v_mfma_f32_16x16x32_bf16 v[100:103],a[172:175],a[204:207],v[100:103]
 v_mfma_f32_16x16x32_bf16 v[104:107],a[176:179],a[200:203],v[104:107]
 v_mfma_f32_16x16x32_bf16 v[104:107],a[180:183],a[204:207],v[104:107]
 v_mfma_f32_16x16x32_bf16 v[108:111],a[184:187],a[200:203],v[108:111]
 buffer_load_dwordx4 v18,s[8:11],s38 offen offset:2048 lds
 v_mfma_f32_16x16x32_bf16 v[108:111],a[188:191],a[204:207],v[108:111]
 s_waitcnt lgkmcnt(0)
 v_mfma_f32_16x16x32_bf16 v[112:115],a[128:131],a[192:195],v[112:115]
 v_mfma_f32_16x16x32_bf16 v[112:115],a[132:135],a[196:199],v[112:115]
 ds_read_b128 a[200:203],v4 offset:6144
 v_mfma_f32_16x16x32_bf16 v[116:119],a[136:139],a[192:195],v[116:119]
 buffer_load_dwordx4 v19,s[8:11],s39 offen offset:3072 lds
 v_mfma_f32_16x16x32_bf16 v[116:119],a[140:143],a[196:199],v[116:119]
 ds_read_b128 a[204:207],v5 offset:6144
 v_mfma_f32_16x16x32_bf16 v[120:123],a[144:147],a[192:195],v[120:123]
 v_mfma_f32_16x16x32_bf16 v[120:123],a[148:151],a[196:199],v[120:123]
 v_mfma_f32_16x16x32_bf16 v[124:127],a[152:155],a[192:195],v[124:127]
 s_add_u32 s8,s8,524288
 s_addc_u32 s9,s9,0
 v_mfma_f32_16x16x32_bf16 v[124:127],a[156:159],a[196:199],v[124:127]
 v_mfma_f32_16x16x32_bf16 v[128:131],a[160:163],a[192:195],v[128:131]
 v_mfma_f32_16x16x32_bf16 v[128:131],a[164:167],a[196:199],v[128:131]
 v_mfma_f32_16x16x32_bf16 v[132:135],a[168:171],a[192:195],v[132:135]
 s_sub_u32 s10,s10,524288
 v_mfma_f32_16x16x32_bf16 v[132:135],a[172:175],a[196:199],v[132:135]
 v_mfma_f32_16x16x32_bf16 v[136:139],a[176:179],a[192:195],v[136:139]
 v_mfma_f32_16x16x32_bf16 v[136:139],a[180:183],a[196:199],v[136:139]
 v_mfma_f32_16x16x32_bf16 v[140:143],a[184:187],a[192:195],v[140:143]
 s_add_u32 m0,s50,0
 v_mfma_f32_16x16x32_bf16 v[140:143],a[188:191],a[196:199],v[140:143]
 s_waitcnt lgkmcnt(0)
 v_mfma_f32_16x16x32_bf16 v[144:147],a[128:131],a[200:203],v[144:147]
 v_mfma_f32_16x16x32_bf16 v[144:147],a[132:135],a[204:207],v[144:147]
 ds_read_b128 a[192:195],v4 offset:8192
 v_mfma_f32_16x16x32_bf16 v[148:151],a[136:139],a[200:203],v[148:151]
 buffer_load_dwordx4 v14,s[4:7],s32 offen offset:0 lds
 v_mfma_f32_16x16x32_bf16 v[148:151],a[140:143],a[204:207],v[148:151]
 ds_read_b128 a[196:199],v5 offset:8192
 v_mfma_f32_16x16x32_bf16 v[152:155],a[144:147],a[200:203],v[152:155]
 v_mfma_f32_16x16x32_bf16 v[152:155],a[148:151],a[204:207],v[152:155]
 buffer_load_dwordx4 v15,s[4:7],s33 offen offset:1024 lds
 v_mfma_f32_16x16x32_bf16 v[156:159],a[152:155],a[200:203],v[156:159]
 v_mfma_f32_16x16x32_bf16 v[156:159],a[156:159],a[204:207],v[156:159]
 v_mfma_f32_16x16x32_bf16 v[160:163],a[160:163],a[200:203],v[160:163]
 s_waitcnt vmcnt(20)
 s_barrier
 v_mfma_f32_16x16x32_bf16 v[160:163],a[164:167],a[204:207],v[160:163]
 ds_read_b64_tr_b16 a[64:65],v6 offset:0
 v_mfma_f32_16x16x32_bf16 v[164:167],a[168:171],a[200:203],v[164:167]
 buffer_load_dwordx4 v14,s[4:7],s34 offen offset:2048 lds
 v_mfma_f32_16x16x32_bf16 v[164:167],a[172:175],a[204:207],v[164:167]
 ds_read_b64_tr_b16 a[66:67],v6 offset:2048
 ds_read_b64_tr_b16 a[68:69],v6 offset:16384
 v_mfma_f32_16x16x32_bf16 v[168:171],a[176:179],a[200:203],v[168:171]
 v_mfma_f32_16x16x32_bf16 v[168:171],a[180:183],a[204:207],v[168:171]
 ds_read_b64_tr_b16 a[70:71],v6 offset:18432
 v_mfma_f32_16x16x32_bf16 v[172:175],a[184:187],a[200:203],v[172:175]
 buffer_load_dwordx4 v15,s[4:7],s35 offen offset:3072 lds
 v_mfma_f32_16x16x32_bf16 v[172:175],a[188:191],a[204:207],v[172:175]
 s_waitcnt lgkmcnt(4)
 ds_read_b64_tr_b16 a[72:73],v7 offset:0
 v_mfma_f32_16x16x32_bf16 v[176:179],a[128:131],a[192:195],v[176:179]
 ds_read_b64_tr_b16 a[74:75],v7 offset:2048
 v_mfma_f32_16x16x32_bf16 v[176:179],a[132:135],a[196:199],v[176:179]
 ds_read_b128 a[200:203],v4 offset:10240
 s_add_u32 m0,s50,4096
 v_mfma_f32_16x16x32_bf16 v[180:183],a[136:139],a[192:195],v[180:183]
 ds_read_b64_tr_b16 a[76:77],v7 offset:16384
 v_mfma_f32_16x16x32_bf16 v[180:183],a[140:143],a[196:199],v[180:183]
 ds_read_b128 a[204:207],v5 offset:10240
 ds_read_b64_tr_b16 a[78:79],v7 offset:18432
 v_mfma_f32_16x16x32_bf16 v[184:187],a[144:147],a[192:195],v[184:187]
 ds_read_b64_tr_b16 a[80:81],v8 offset:0
 v_mfma_f32_16x16x32_bf16 v[184:187],a[148:151],a[196:199],v[184:187]
 buffer_load_dwordx4 v14,s[4:7],s36 offen offset:0 lds
 v_mfma_f32_16x16x32_bf16 v[188:191],a[152:155],a[192:195],v[188:191]
 ds_read_b64_tr_b16 a[82:83],v8 offset:2048
 v_mfma_f32_16x16x32_bf16 v[188:191],a[156:159],a[196:199],v[188:191]
 ds_read_b64_tr_b16 a[84:85],v8 offset:16384
 v_mfma_f32_16x16x32_bf16 v[192:195],a[160:163],a[192:195],v[192:195]
 v_mfma_f32_16x16x32_bf16 v[192:195],a[164:167],a[196:199],v[192:195]
 buffer_load_dwordx4 v15,s[4:7],s37 offen offset:1024 lds
 v_mfma_f32_16x16x32_bf16 v[196:199],a[168:171],a[192:195],v[196:199]
 ds_read_b64_tr_b16 a[86:87],v8 offset:18432
 ds_read_b64_tr_b16 a[88:89],v9 offset:0
 v_mfma_f32_16x16x32_bf16 v[196:199],a[172:175],a[196:199],v[196:199]
 v_mfma_f32_16x16x32_bf16 v[200:203],a[176:179],a[192:195],v[200:203]
 ds_read_b64_tr_b16 a[90:91],v9 offset:2048
 v_mfma_f32_16x16x32_bf16 v[200:203],a[180:183],a[196:199],v[200:203]
 buffer_load_dwordx4 v14,s[4:7],s38 offen offset:2048 lds
 v_mfma_f32_16x16x32_bf16 v[204:207],a[184:187],a[192:195],v[204:207]
 ds_read_b64_tr_b16 a[92:93],v9 offset:16384
 v_mfma_f32_16x16x32_bf16 v[204:207],a[188:191],a[196:199],v[204:207]
 s_waitcnt lgkmcnt(8)
 ds_read_b64_tr_b16 a[94:95],v9 offset:18432
 v_mfma_f32_16x16x32_bf16 v[208:211],a[128:131],a[200:203],v[208:211]
 ds_read_b64_tr_b16 a[96:97],v10 offset:0
 v_mfma_f32_16x16x32_bf16 v[208:211],a[132:135],a[204:207],v[208:211]
 buffer_load_dwordx4 v15,s[4:7],s39 offen offset:3072 lds
 v_mfma_f32_16x16x32_bf16 v[212:215],a[136:139],a[200:203],v[212:215]
 ds_read_b128 a[192:195],v4 offset:12288
 ds_read_b64_tr_b16 a[98:99],v10 offset:2048
 v_mfma_f32_16x16x32_bf16 v[212:215],a[140:143],a[204:207],v[212:215]
 buffer_load_dword v24,v35,s[24:27],0 offen
 v_mfma_f32_16x16x32_bf16 v[216:219],a[144:147],a[200:203],v[216:219]
 ds_read_b128 a[196:199],v5 offset:12288
 v_add_u32 v35,0x80,v35
 v_mfma_f32_16x16x32_bf16 v[216:219],a[148:151],a[204:207],v[216:219]
 ds_read_b64_tr_b16 a[100:101],v10 offset:16384
 ds_read_b64_tr_b16 a[102:103],v10 offset:18432
 v_mfma_f32_16x16x32_bf16 v[220:223],a[152:155],a[200:203],v[220:223]
 s_add_u32 s4,s4,128
 s_addc_u32 s5,s5,0
 v_mfma_f32_16x16x32_bf16 v[220:223],a[156:159],a[204:207],v[220:223]
 buffer_load_dword v24,v36,s[72:75],0 offen
 v_mfma_f32_16x16x32_bf16 v[224:227],a[160:163],a[200:203],v[224:227]
 ds_read_b64_tr_b16 a[104:105],v11 offset:0
 v_add_u32 v36,0x2a000,v36
 v_mfma_f32_16x16x32_bf16 v[224:227],a[164:167],a[204:207],v[224:227]
 buffer_load_dword v24,v37,s[40:43],0 offen
 v_mfma_f32_16x16x32_bf16 v[228:231],a[168:171],a[200:203],v[228:231]
 ds_read_b64_tr_b16 a[106:107],v11 offset:2048
 s_sub_u32 s6,s6,128
 v_mfma_f32_16x16x32_bf16 v[228:231],a[172:175],a[204:207],v[228:231]
 buffer_load_dword v24,v37,s[64:67],0 offen
 v_mfma_f32_16x16x32_bf16 v[232:235],a[176:179],a[200:203],v[232:235]
 ds_read_b64_tr_b16 a[108:109],v11 offset:16384
 v_add_u32 v37,0x1180,v37
 v_mfma_f32_16x16x32_bf16 v[232:235],a[180:183],a[204:207],v[232:235]
 ds_read_b64_tr_b16 a[110:111],v11 offset:18432
 ds_read_b64_tr_b16 a[112:113],v12 offset:0
 v_mfma_f32_16x16x32_bf16 v[236:239],a[184:187],a[200:203],v[236:239]
 s_add_u32 s50,s50,32768
 ds_read_b64_tr_b16 a[114:115],v12 offset:2048
 v_mfma_f32_16x16x32_bf16 v[236:239],a[188:191],a[204:207],v[236:239]
 s_waitcnt lgkmcnt(8)
 ds_read_b64_tr_b16 a[116:117],v12 offset:16384
 v_mfma_f32_16x16x32_bf16 v[240:243],a[128:131],a[192:195],v[240:243]
 s_cmp_ge_u32 s50,98304
 s_cselect_b32 s50,s51,s50
 v_mfma_f32_16x16x32_bf16 v[240:243],a[132:135],a[196:199],v[240:243]
 ds_read_b64_tr_b16 a[118:119],v12 offset:18432
 ds_read_b128 a[200:203],v4 offset:14336
 v_mfma_f32_16x16x32_bf16 v[244:247],a[136:139],a[192:195],v[244:247]
 ds_read_b64_tr_b16 a[120:121],v13 offset:0
 v_mfma_f32_16x16x32_bf16 v[244:247],a[140:143],a[196:199],v[244:247]
 ds_read_b128 a[204:207],v5 offset:14336
 ds_read_b64_tr_b16 a[122:123],v13 offset:2048
 v_mfma_f32_16x16x32_bf16 v[248:251],a[144:147],a[192:195],v[248:251]
 v_mfma_f32_16x16x32_bf16 v[248:251],a[148:151],a[196:199],v[248:251]
 ds_read_b64_tr_b16 a[124:125],v13 offset:16384
 v_mfma_f32_16x16x32_bf16 v[252:255],a[152:155],a[192:195],v[252:255]
 ds_read_b64_tr_b16 a[126:127],v13 offset:18432
 v_mfma_f32_16x16x32_bf16 v[252:255],a[156:159],a[196:199],v[252:255]
 v_mfma_f32_16x16x32_bf16 a[208:211],a[160:163],a[192:195],a[208:211]
 v_mfma_f32_16x16x32_bf16 a[208:211],a[164:167],a[196:199],a[208:211]
 s_add_u32 s55,s55,32768
 v_mfma_f32_16x16x32_bf16 a[212:215],a[168:171],a[192:195],a[212:215]
 s_cmp_ge_u32 s55,98304
 s_cselect_b32 s55,s54,s55
 v_mfma_f32_16x16x32_bf16 a[212:215],a[172:175],a[196:199],a[212:215]
 v_add_u32 v4,s55,v2
 v_mfma_f32_16x16x32_bf16 a[216:219],a[176:179],a[192:195],a[216:219]
 v_add_u32 v5,s55,v3
 v_mfma_f32_16x16x32_bf16 a[216:219],a[180:183],a[196:199],a[216:219]
 v_mfma_f32_16x16x32_bf16 a[220:223],a[184:187],a[192:195],a[220:223]
 v_mfma_f32_16x16x32_bf16 a[220:223],a[188:191],a[196:199],a[220:223]
 s_waitcnt vmcnt(20) lgkmcnt(0)
 s_barrier
 v_mfma_f32_16x16x32_bf16 a[224:227],a[128:131],a[200:203],a[224:227]
 ds_read_b128 a[192:195],v4 offset:0
 v_mfma_f32_16x16x32_bf16 a[224:227],a[132:135],a[204:207],a[224:227]
 ds_read_b128 a[196:199],v5 offset:0
 v_mfma_f32_16x16x32_bf16 a[228:231],a[136:139],a[200:203],a[228:231]
 v_mfma_f32_16x16x32_bf16 a[228:231],a[140:143],a[204:207],a[228:231]
 v_mfma_f32_16x16x32_bf16 a[232:235],a[144:147],a[200:203],a[232:235]
 v_mfma_f32_16x16x32_bf16 a[232:235],a[148:151],a[204:207],a[232:235]
 v_mfma_f32_16x16x32_bf16 a[236:239],a[152:155],a[200:203],a[236:239]
 v_mfma_f32_16x16x32_bf16 a[236:239],a[156:159],a[204:207],a[236:239]
 v_mfma_f32_16x16x32_bf16 a[240:243],a[160:163],a[200:203],a[240:243]
 v_mfma_f32_16x16x32_bf16 a[240:243],a[164:167],a[204:207],a[240:243]
 v_mfma_f32_16x16x32_bf16 a[244:247],a[168:171],a[200:203],a[244:247]
 v_mfma_f32_16x16x32_bf16 a[244:247],a[172:175],a[204:207],a[244:247]
 v_mfma_f32_16x16x32_bf16 a[248:251],a[176:179],a[200:203],a[248:251]
 v_mfma_f32_16x16x32_bf16 a[248:251],a[180:183],a[204:207],a[248:251]
 v_mfma_f32_16x16x32_bf16 a[252:255],a[184:187],a[200:203],a[252:255]
 v_mfma_f32_16x16x32_bf16 a[252:255],a[188:191],a[204:207],a[252:255]
 s_waitcnt lgkmcnt(0)
 s_or_b32 s60,s2,s45
 s_cbranch_scc1 ZD_1
 v_mov_b32 v25,1
 v_mov_b32 v26,0
 global_store_dword v26,v25,s[70:71] sc1
ZD_1:
 s_mov_b32 s49,6
.p2align 6
KVL_2:
 v_mfma_f32_16x16x32_bf16 v[48:51],a[64:67],a[192:195],v[48:51]
 s_add_u32 m0,s51,98304
 v_mfma_f32_16x16x32_bf16 v[48:51],a[68:71],a[196:199],v[48:51]
 ds_read_b128 a[200:203],v4 offset:2048
 v_mfma_f32_16x16x32_bf16 v[52:55],a[72:75],a[192:195],v[52:55]
 v_mfma_f32_16x16x32_bf16 v[52:55],a[76:79],a[196:199],v[52:55]
 ds_read_b128 a[204:207],v5 offset:2048
 v_mfma_f32_16x16x32_bf16 v[56:59],a[80:83],a[192:195],v[56:59]
 buffer_load_dwordx4 v16,s[8:11],s32 offen offset:0 lds
 v_mfma_f32_16x16x32_bf16 v[56:59],a[84:87],a[196:199],v[56:59]
 v_mfma_f32_16x16x32_bf16 v[60:63],a[88:91],a[192:195],v[60:63]
 v_mfma_f32_16x16x32_bf16 v[60:63],a[92:95],a[196:199],v[60:63]
 buffer_load_dwordx4 v17,s[8:11],s33 offen offset:1024 lds
 v_mfma_f32_16x16x32_bf16 v[64:67],a[96:99],a[192:195],v[64:67]
 v_mfma_f32_16x16x32_bf16 v[64:67],a[100:103],a[196:199],v[64:67]
 v_mfma_f32_16x16x32_bf16 v[68:71],a[104:107],a[192:195],v[68:71]
 v_mfma_f32_16x16x32_bf16 v[68:71],a[108:111],a[196:199],v[68:71]
 buffer_load_dwordx4 v16,s[8:11],s34 offen offset:2048 lds
 v_mfma_f32_16x16x32_bf16 v[72:75],a[112:115],a[192:195],v[72:75]
 v_mfma_f32_16x16x32_bf16 v[72:75],a[116:119],a[196:199],v[72:75]
 v_mfma_f32_16x16x32_bf16 v[76:79],a[120:123],a[192:195],v[76:79]
 v_mfma_f32_16x16x32_bf16 v[76:79],a[124:127],a[196:199],v[76:79]
 s_waitcnt lgkmcnt(0)
 v_mfma_f32_16x16x32_bf16 v[80:83],a[64:67],a[200:203],v[80:83]
 buffer_load_dwordx4 v17,s[8:11],s35 offen offset:3072 lds
 v_mfma_f32_16x16x32_bf16 v[80:83],a[68:71],a[204:207],v[80:83]
 ds_read_b128 a[192:195],v4 offset:4096
 v_mfma_f32_16x16x32_bf16 v[84:87],a[72:75],a[200:203],v[84:87]
 v_mfma_f32_16x16x32_bf16 v[84:87],a[76:79],a[204:207],v[84:87]
 ds_read_b128 a[196:199],v5 offset:4096
 s_add_u32 m0,s51,102400
 v_mfma_f32_16x16x32_bf16 v[88:91],a[80:83],a[200:203],v[88:91]
 v_mfma_f32_16x16x32_bf16 v[88:91],a[84:87],a[204:207],v[88:91]
 v_mfma_f32_16x16x32_bf16 v[92:95],a[88:91],a[200:203],v[92:95]
 v_mfma_f32_16x16x32_bf16 v[92:95],a[92:95],a[204:207],v[92:95]
 buffer_load_dwordx4 v18,s[8:11],s36 offen offset:0 lds
 v_mfma_f32_16x16x32_bf16 v[96:99],a[96:99],a[200:203],v[96:99]
 v_mfma_f32_16x16x32_bf16 v[96:99],a[100:103],a[204:207],v[96:99]
 v_mfma_f32_16x16x32_bf16 v[100:103],a[104:107],a[200:203],v[100:103]
 buffer_load_dwordx4 v19,s[8:11],s37 offen offset:1024 lds
 v_mfma_f32_16x16x32_bf16 v[100:103],a[108:111],a[204:207],v[100:103]
 v_mfma_f32_16x16x32_bf16 v[104:107],a[112:115],a[200:203],v[104:107]
 v_mfma_f32_16x16x32_bf16 v[104:107],a[116:119],a[204:207],v[104:107]
 v_mfma_f32_16x16x32_bf16 v[108:111],a[120:123],a[200:203],v[108:111]
 buffer_load_dwordx4 v18,s[8:11],s38 offen offset:2048 lds
 v_mfma_f32_16x16x32_bf16 v[108:111],a[124:127],a[204:207],v[108:111]
 s_waitcnt lgkmcnt(0)
 v_mfma_f32_16x16x32_bf16 v[112:115],a[64:67],a[192:195],v[112:115]
 v_mfma_f32_16x16x32_bf16 v[112:115],a[68:71],a[196:199],v[112:115]
 ds_read_b128 a[200:203],v4 offset:6144
 v_mfma_f32_16x16x32_bf16 v[116:119],a[72:75],a[192:195],v[116:119]
 buffer_load_dwordx4 v19,s[8:11],s39 offen offset:3072 lds
 v_mfma_f32_16x16x32_bf16 v[116:119],a[76:79],a[196:199],v[116:119]
 ds_read_b128 a[204:207],v5 offset:6144
 v_mfma_f32_16x16x32_bf16 v[120:123],a[80:83],a[192:195],v[120:123]
 v_mfma_f32_16x16x32_bf16 v[120:123],a[84:87],a[196:199],v[120:123]
 v_mfma_f32_16x16x32_bf16 v[124:127],a[88:91],a[192:195],v[124:127]
 s_add_u32 s8,s8,524288
 s_addc_u32 s9,s9,0
 v_mfma_f32_16x16x32_bf16 v[124:127],a[92:95],a[196:199],v[124:127]
 v_mfma_f32_16x16x32_bf16 v[128:131],a[96:99],a[192:195],v[128:131]
 v_mfma_f32_16x16x32_bf16 v[128:131],a[100:103],a[196:199],v[128:131]
 v_mfma_f32_16x16x32_bf16 v[132:135],a[104:107],a[192:195],v[132:135]
 s_sub_u32 s10,s10,524288
 v_mfma_f32_16x16x32_bf16 v[132:135],a[108:111],a[196:199],v[132:135]
 v_mfma_f32_16x16x32_bf16 v[136:139],a[112:115],a[192:195],v[136:139]
 v_mfma_f32_16x16x32_bf16 v[136:139],a[116:119],a[196:199],v[136:139]
 v_mfma_f32_16x16x32_bf16 v[140:143],a[120:123],a[192:195],v[140:143]
 s_add_u32 m0,s50,0
 v_mfma_f32_16x16x32_bf16 v[140:143],a[124:127],a[196:199],v[140:143]
 s_waitcnt lgkmcnt(0)
 v_mfma_f32_16x16x32_bf16 v[144:147],a[64:67],a[200:203],v[144:147]
 v_mfma_f32_16x16x32_bf16 v[144:147],a[68:71],a[204:207],v[144:147]
 ds_read_b128 a[192:195],v4 offset:8192
 v_mfma_f32_16x16x32_bf16 v[148:151],a[72:75],a[200:203],v[148:151]
 buffer_load_dwordx4 v14,s[4:7],s32 offen offset:0 lds
 v_mfma_f32_16x16x32_bf16 v[148:151],a[76:79],a[204:207],v[148:151]
 ds_read_b128 a[196:199],v5 offset:8192
 v_mfma_f32_16x16x32_bf16 v[152:155],a[80:83],a[200:203],v[152:155]
 v_mfma_f32_16x16x32_bf16 v[152:155],a[84:87],a[204:207],v[152:155]
 buffer_load_dwordx4 v15,s[4:7],s33 offen offset:1024 lds
 v_mfma_f32_16x16x32_bf16 v[156:159],a[88:91],a[200:203],v[156:159]
 v_mfma_f32_16x16x32_bf16 v[156:159],a[92:95],a[204:207],v[156:159]
 v_mfma_f32_16x16x32_bf16 v[160:163],a[96:99],a[200:203],v[160:163]
 s_waitcnt vmcnt(22)
 s_barrier
 v_mfma_f32_16x16x32_bf16 v[160:163],a[100:103],a[204:207],v[160:163]
 ds_read_b64_tr_b16 a[128:129],v6 offset:32768
 v_mfma_f32_16x16x32_bf16 v[164:167],a[104:107],a[200:203],v[164:167]
 buffer_load_dwordx4 v14,s[4:7],s34 offen offset:2048 lds
 v_mfma_f32_16x16x32_bf16 v[164:167],a[108:111],a[204:207],v[164:167]
 ds_read_b64_tr_b16 a[130:131],v6 offset:34816
 ds_read_b64_tr_b16 a[132:133],v6 offset:49152
 v_mfma_f32_16x16x32_bf16 v[168:171],a[112:115],a[200:203],v[168:171]
 v_mfma_f32_16x16x32_bf16 v[168:171],a[116:119],a[204:207],v[168:171]
 ds_read_b64_tr_b16 a[134:135],v6 offset:51200
 v_mfma_f32_16x16x32_bf16 v[172:175],a[120:123],a[200:203],v[172:175]
 buffer_load_dwordx4 v15,s[4:7],s35 offen offset:3072 lds
 v_mfma_f32_16x16x32_bf16 v[172:175],a[124:127],a[204:207],v[172:175]
 s_waitcnt lgkmcnt(4)
 ds_read_b64_tr_b16 a[136:137],v7 offset:32768
 v_mfma_f32_16x16x32_bf16 v[176:179],a[64:67],a[192:195],v[176:179]
 ds_read_b64_tr_b16 a[138:139],v7 offset:34816
 v_mfma_f32_16x16x32_bf16 v[176:179],a[68:71],a[196:199],v[176:179]
 ds_read_b128 a[200:203],v4 offset:10240
 s_add_u32 m0,s50,4096
 v_mfma_f32_16x16x32_bf16 v[180:183],a[72:75],a[192:195],v[180:183]
 ds_read_b64_tr_b16 a[140:141],v7 offset:49152
 v_mfma_f32_16x16x32_bf16 v[180:183],a[76:79],a[196:199],v[180:183]
 ds_read_b128 a[204:207],v5 offset:10240
 ds_read_b64_tr_b16 a[142:143],v7 offset:51200
 v_mfma_f32_16x16x32_bf16 v[184:187],a[80:83],a[192:195],v[184:187]
 ds_read_b64_tr_b16 a[144:145],v8 offset:32768
 v_mfma_f32_16x16x32_bf16 v[184:187],a[84:87],a[196:199],v[184:187]
 buffer_load_dwordx4 v14,s[4:7],s36 offen offset:0 lds
 v_mfma_f32_16x16x32_bf16 v[188:191],a[88:91],a[192:195],v[188:191]
 ds_read_b64_tr_b16 a[146:147],v8 offset:34816
 v_mfma_f32_16x16x32_bf16 v[188:191],a[92:95],a[196:199],v[188:191]
 ds_read_b64_tr_b16 a[148:149],v8 offset:49152
 v_mfma_f32_16x16x32_bf16 v[192:195],a[96:99],a[192:195],v[192:195]
 v_mfma_f32_16x16x32_bf16 v[192:195],a[100:103],a[196:199],v[192:195]
 buffer_load_dwordx4 v15,s[4:7],s37 offen offset:1024 lds
 v_mfma_f32_16x16x32_bf16 v[196:199],a[104:107],a[192:195],v[196:199]
 ds_read_b64_tr_b16 a[150:151],v8 offset:51200
 ds_read_b64_tr_b16 a[152:153],v9 offset:32768
 v_mfma_f32_16x16x32_bf16 v[196:199],a[108:111],a[196:199],v[196:199]
 v_mfma_f32_16x16x32_bf16 v[200:203],a[112:115],a[192:195],v[200:203]
 ds_read_b64_tr_b16 a[154:155],v9 offset:34816
 v_mfma_f32_16x16x32_bf16 v[200:203],a[116:119],a[196:199],v[200:203]
 buffer_load_dwordx4 v14,s[4:7],s38 offen offset:2048 lds
 v_mfma_f32_16x16x32_bf16 v[204:207],a[120:123],a[192:195],v[204:207]
 ds_read_b64_tr_b16 a[156:157],v9 offset:49152
 v_mfma_f32_16x16x32_bf16 v[204:207],a[124:127],a[196:199],v[204:207]
 s_waitcnt lgkmcnt(8)
 ds_read_b64_tr_b16 a[158:159],v9 offset:51200
 v_mfma_f32_16x16x32_bf16 v[208:211],a[64:67],a[200:203],v[208:211]
 ds_read_b64_tr_b16 a[160:161],v10 offset:32768
 v_mfma_f32_16x16x32_bf16 v[208:211],a[68:71],a[204:207],v[208:211]
 buffer_load_dwordx4 v15,s[4:7],s39 offen offset:3072 lds
 v_mfma_f32_16x16x32_bf16 v[212:215],a[72:75],a[200:203],v[212:215]
 ds_read_b128 a[192:195],v4 offset:12288
 ds_read_b64_tr_b16 a[162:163],v10 offset:34816
 v_mfma_f32_16x16x32_bf16 v[212:215],a[76:79],a[204:207],v[212:215]
 buffer_load_dword v24,v32,s[8:11],0 offen
 v_mfma_f32_16x16x32_bf16 v[216:219],a[80:83],a[200:203],v[216:219]
 ds_read_b128 a[196:199],v5 offset:12288
 ds_read_b64_tr_b16 a[164:165],v10 offset:49152
 v_mfma_f32_16x16x32_bf16 v[216:219],a[84:87],a[204:207],v[216:219]
 s_add_u32 s4,s4,128
 s_addc_u32 s5,s5,0
 v_mfma_f32_16x16x32_bf16 v[220:223],a[88:91],a[200:203],v[220:223]
 ds_read_b64_tr_b16 a[166:167],v10 offset:51200
 ds_read_b64_tr_b16 a[168:169],v11 offset:32768
 v_mfma_f32_16x16x32_bf16 v[220:223],a[92:95],a[204:207],v[220:223]
 buffer_load_dword v24,v33,s[4:7],0 offen
 v_mfma_f32_16x16x32_bf16 v[224:227],a[96:99],a[200:203],v[224:227]
 ds_read_b64_tr_b16 a[170:171],v11 offset:34816
 s_sub_u32 s6,s6,128
 v_mfma_f32_16x16x32_bf16 v[224:227],a[100:103],a[204:207],v[224:227]
 ds_read_b64_tr_b16 a[172:173],v11 offset:49152
 v_mfma_f32_16x16x32_bf16 v[228:231],a[104:107],a[200:203],v[228:231]
 ds_read_b64_tr_b16 a[174:175],v11 offset:51200
 v_mfma_f32_16x16x32_bf16 v[228:231],a[108:111],a[204:207],v[228:231]
 v_mfma_f32_16x16x32_bf16 v[232:235],a[112:115],a[200:203],v[232:235]
 ds_read_b64_tr_b16 a[176:177],v12 offset:32768
 s_add_u32 s50,s50,32768
 v_mfma_f32_16x16x32_bf16 v[232:235],a[116:119],a[204:207],v[232:235]
 ds_read_b64_tr_b16 a[178:179],v12 offset:34816
 v_mfma_f32_16x16x32_bf16 v[236:239],a[120:123],a[200:203],v[236:239]
 v_mfma_f32_16x16x32_bf16 v[236:239],a[124:127],a[204:207],v[236:239]
 s_waitcnt lgkmcnt(8)
 ds_read_b64_tr_b16 a[180:181],v12 offset:49152
 v_mfma_f32_16x16x32_bf16 v[240:243],a[64:67],a[192:195],v[240:243]
 s_cmp_ge_u32 s50,98304
 s_cselect_b32 s50,s51,s50
 v_mfma_f32_16x16x32_bf16 v[240:243],a[68:71],a[196:199],v[240:243]
 ds_read_b64_tr_b16 a[182:183],v12 offset:51200
 ds_read_b128 a[200:203],v4 offset:14336
 v_mfma_f32_16x16x32_bf16 v[244:247],a[72:75],a[192:195],v[244:247]
 ds_read_b64_tr_b16 a[184:185],v13 offset:32768
 v_mfma_f32_16x16x32_bf16 v[244:247],a[76:79],a[196:199],v[244:247]
 ds_read_b128 a[204:207],v5 offset:14336
 ds_read_b64_tr_b16 a[186:187],v13 offset:34816
 v_mfma_f32_16x16x32_bf16 v[248:251],a[80:83],a[192:195],v[248:251]
 v_mfma_f32_16x16x32_bf16 v[248:251],a[84:87],a[196:199],v[248:251]
 ds_read_b64_tr_b16 a[188:189],v13 offset:49152
 v_mfma_f32_16x16x32_bf16 v[252:255],a[88:91],a[192:195],v[252:255]
 ds_read_b64_tr_b16 a[190:191],v13 offset:51200
 v_mfma_f32_16x16x32_bf16 v[252:255],a[92:95],a[196:199],v[252:255]
 v_mfma_f32_16x16x32_bf16 a[208:211],a[96:99],a[192:195],a[208:211]
 v_mfma_f32_16x16x32_bf16 a[208:211],a[100:103],a[196:199],a[208:211]
 s_add_u32 s55,s55,32768
 v_mfma_f32_16x16x32_bf16 a[212:215],a[104:107],a[192:195],a[212:215]
 s_cmp_ge_u32 s55,98304
 s_cselect_b32 s55,s54,s55
 v_mfma_f32_16x16x32_bf16 a[212:215],a[108:111],a[196:199],a[212:215]
 v_add_u32 v4,s55,v2
 v_mfma_f32_16x16x32_bf16 a[216:219],a[112:115],a[192:195],a[216:219]
 v_add_u32 v5,s55,v3
 v_mfma_f32_16x16x32_bf16 a[216:219],a[116:119],a[196:199],a[216:219]
 v_mfma_f32_16x16x32_bf16 a[220:223],a[120:123],a[192:195],a[220:223]
 v_mfma_f32_16x16x32_bf16 a[220:223],a[124:127],a[196:199],a[220:223]
 s_waitcnt vmcnt(22) lgkmcnt(0)
 s_barrier
 v_mfma_f32_16x16x32_bf16 a[224:227],a[64:67],a[200:203],a[224:227]
 ds_read_b128 a[192:195],v4 offset:0
 v_mfma_f32_16x16x32_bf16 a[224:227],a[68:71],a[204:207],a[224:227]
 ds_read_b128 a[196:199],v5 offset:0
 v_mfma_f32_16x16x32_bf16 a[228:231],a[72:75],a[200:203],a[228:231]
 v_mfma_f32_16x16x32_bf16 a[228:231],a[76:79],a[204:207],a[228:231]
 v_mfma_f32_16x16x32_bf16 a[232:235],a[80:83],a[200:203],a[232:235]
 v_mfma_f32_16x16x32_bf16 a[232:235],a[84:87],a[204:207],a[232:235]
 v_mfma_f32_16x16x32_bf16 a[236:239],a[88:91],a[200:203],a[236:239]
 v_mfma_f32_16x16x32_bf16 a[236:239],a[92:95],a[204:207],a[236:239]
 v_mfma_f32_16x16x32_bf16 a[240:243],a[96:99],a[200:203],a[240:243]
 v_mfma_f32_16x16x32_bf16 a[240:243],a[100:103],a[204:207],a[240:243]
 v_mfma_f32_16x16x32_bf16 a[244:247],a[104:107],a[200:203],a[244:247]
 v_mfma_f32_16x16x32_bf16 a[244:247],a[108:111],a[204:207],a[244:247]
 v_mfma_f32_16x16x32_bf16 a[248:251],a[112:115],a[200:203],a[248:251]
 v_mfma_f32_16x16x32_bf16 a[248:251],a[116:119],a[204:207],a[248:251]
 v_mfma_f32_16x16x32_bf16 a[252:255],a[120:123],a[200:203],a[252:255]
 v_mfma_f32_16x16x32_bf16 a[252:255],a[124:127],a[204:207],a[252:255]
 s_waitcnt lgkmcnt(0)
 v_mfma_f32_16x16x32_bf16 v[48:51],a[128:131],a[192:195],v[48:51]
 s_add_u32 m0,s51,131072
 v_mfma_f32_16x16x32_bf16 v[48:51],a[132:135],a[196:199],v[48:51]
 ds_read_b128 a[200:203],v4 offset:2048
 v_mfma_f32_16x16x32_bf16 v[52:55],a[136:139],a[192:195],v[52:55]
 v_mfma_f32_16x16x32_bf16 v[52:55],a[140:143],a[196:199],v[52:55]
 ds_read_b128 a[204:207],v5 offset:2048
 v_mfma_f32_16x16x32_bf16 v[56:59],a[144:147],a[192:195],v[56:59]
 buffer_load_dwordx4 v16,s[8:11],s32 offen offset:0 lds
 v_mfma_f32_16x16x32_bf16 v[56:59],a[148:151],a[196:199],v[56:59]
 v_mfma_f32_16x16x32_bf16 v[60:63],a[152:155],a[192:195],v[60:63]
 v_mfma_f32_16x16x32_bf16 v[60:63],a[156:159],a[196:199],v[60:63]
 buffer_load_dwordx4 v17,s[8:11],s33 offen offset:1024 lds
 v_mfma_f32_16x16x32_bf16 v[64:67],a[160:163],a[192:195],v[64:67]
 v_mfma_f32_16x16x32_bf16 v[64:67],a[164:167],a[196:199],v[64:67]
 v_mfma_f32_16x16x32_bf16 v[68:71],a[168:171],a[192:195],v[68:71]
 v_mfma_f32_16x16x32_bf16 v[68:71],a[172:175],a[196:199],v[68:71]
 buffer_load_dwordx4 v16,s[8:11],s34 offen offset:2048 lds
 v_mfma_f32_16x16x32_bf16 v[72:75],a[176:179],a[192:195],v[72:75]
 v_mfma_f32_16x16x32_bf16 v[72:75],a[180:183],a[196:199],v[72:75]
 v_mfma_f32_16x16x32_bf16 v[76:79],a[184:187],a[192:195],v[76:79]
 v_mfma_f32_16x16x32_bf16 v[76:79],a[188:191],a[196:199],v[76:79]
 s_waitcnt lgkmcnt(0)
 v_mfma_f32_16x16x32_bf16 v[80:83],a[128:131],a[200:203],v[80:83]
 buffer_load_dwordx4 v17,s[8:11],s35 offen offset:3072 lds
 v_mfma_f32_16x16x32_bf16 v[80:83],a[132:135],a[204:207],v[80:83]
 ds_read_b128 a[192:195],v4 offset:4096
 v_mfma_f32_16x16x32_bf16 v[84:87],a[136:139],a[200:203],v[84:87]
 v_mfma_f32_16x16x32_bf16 v[84:87],a[140:143],a[204:207],v[84:87]
 ds_read_b128 a[196:199],v5 offset:4096
 s_add_u32 m0,s51,135168
 v_mfma_f32_16x16x32_bf16 v[88:91],a[144:147],a[200:203],v[88:91]
 v_mfma_f32_16x16x32_bf16 v[88:91],a[148:151],a[204:207],v[88:91]
 v_mfma_f32_16x16x32_bf16 v[92:95],a[152:155],a[200:203],v[92:95]
 v_mfma_f32_16x16x32_bf16 v[92:95],a[156:159],a[204:207],v[92:95]
 buffer_load_dwordx4 v18,s[8:11],s36 offen offset:0 lds
 v_mfma_f32_16x16x32_bf16 v[96:99],a[160:163],a[200:203],v[96:99]
 v_mfma_f32_16x16x32_bf16 v[96:99],a[164:167],a[204:207],v[96:99]
 v_mfma_f32_16x16x32_bf16 v[100:103],a[168:171],a[200:203],v[100:103]
 buffer_load_dwordx4 v19,s[8:11],s37 offen offset:1024 lds
 v_mfma_f32_16x16x32_bf16 v[100:103],a[172:175],a[204:207],v[100:103]
 v_mfma_f32_16x16x32_bf16 v[104:107],a[176:179],a[200:203],v[104:107]
 v_mfma_f32_16x16x32_bf16 v[104:107],a[180:183],a[204:207],v[104:107]
 v_mfma_f32_16x16x32_bf16 v[108:111],a[184:187],a[200:203],v[108:111]
 buffer_load_dwordx4 v18,s[8:11],s38 offen offset:2048 lds
 v_mfma_f32_16x16x32_bf16 v[108:111],a[188:191],a[204:207],v[108:111]
 s_waitcnt lgkmcnt(0)
 v_mfma_f32_16x16x32_bf16 v[112:115],a[128:131],a[192:195],v[112:115]
 v_mfma_f32_16x16x32_bf16 v[112:115],a[132:135],a[196:199],v[112:115]
 ds_read_b128 a[200:203],v4 offset:6144
 v_mfma_f32_16x16x32_bf16 v[116:119],a[136:139],a[192:195],v[116:119]
 buffer_load_dwordx4 v19,s[8:11],s39 offen offset:3072 lds
 v_mfma_f32_16x16x32_bf16 v[116:119],a[140:143],a[196:199],v[116:119]
 ds_read_b128 a[204:207],v5 offset:6144
 v_mfma_f32_16x16x32_bf16 v[120:123],a[144:147],a[192:195],v[120:123]
 v_mfma_f32_16x16x32_bf16 v[120:123],a[148:151],a[196:199],v[120:123]
 v_mfma_f32_16x16x32_bf16 v[124:127],a[152:155],a[192:195],v[124:127]
 s_add_u32 s8,s8,524288
 s_addc_u32 s9,s9,0
 v_mfma_f32_16x16x32_bf16 v[124:127],a[156:159],a[196:199],v[124:127]
 v_mfma_f32_16x16x32_bf16 v[128:131],a[160:163],a[192:195],v[128:131]
 v_mfma_f32_16x16x32_bf16 v[128:131],a[164:167],a[196:199],v[128:131]
 v_mfma_f32_16x16x32_bf16 v[132:135],a[168:171],a[192:195],v[132:135]
 s_sub_u32 s10,s10,524288
 v_mfma_f32_16x16x32_bf16 v[132:135],a[172:175],a[196:199],v[132:135]
 v_mfma_f32_16x16x32_bf16 v[136:139],a[176:179],a[192:195],v[136:139]
 v_mfma_f32_16x16x32_bf16 v[136:139],a[180:183],a[196:199],v[136:139]
 v_mfma_f32_16x16x32_bf16 v[140:143],a[184:187],a[192:195],v[140:143]
 s_add_u32 m0,s50,0
 v_mfma_f32_16x16x32_bf16 v[140:143],a[188:191],a[196:199],v[140:143]
 s_waitcnt lgkmcnt(0)
 v_mfma_f32_16x16x32_bf16 v[144:147],a[128:131],a[200:203],v[144:147]
 v_mfma_f32_16x16x32_bf16 v[144:147],a[132:135],a[204:207],v[144:147]
 ds_read_b128 a[192:195],v4 offset:8192
 v_mfma_f32_16x16x32_bf16 v[148:151],a[136:139],a[200:203],v[148:151]
 buffer_load_dwordx4 v14,s[4:7],s32 offen offset:0 lds
 v_mfma_f32_16x16x32_bf16 v[148:151],a[140:143],a[204:207],v[148:151]
 ds_read_b128 a[196:199],v5 offset:8192
 v_mfma_f32_16x16x32_bf16 v[152:155],a[144:147],a[200:203],v[152:155]
 v_mfma_f32_16x16x32_bf16 v[152:155],a[148:151],a[204:207],v[152:155]
 buffer_load_dwordx4 v15,s[4:7],s33 offen offset:1024 lds
 v_mfma_f32_16x16x32_bf16 v[156:159],a[152:155],a[200:203],v[156:159]
 v_mfma_f32_16x16x32_bf16 v[156:159],a[156:159],a[204:207],v[156:159]
 v_mfma_f32_16x16x32_bf16 v[160:163],a[160:163],a[200:203],v[160:163]
 s_waitcnt vmcnt(20)
 s_barrier
 v_mfma_f32_16x16x32_bf16 v[160:163],a[164:167],a[204:207],v[160:163]
 ds_read_b64_tr_b16 a[64:65],v6 offset:0
 v_mfma_f32_16x16x32_bf16 v[164:167],a[168:171],a[200:203],v[164:167]
 buffer_load_dwordx4 v14,s[4:7],s34 offen offset:2048 lds
 v_mfma_f32_16x16x32_bf16 v[164:167],a[172:175],a[204:207],v[164:167]
 ds_read_b64_tr_b16 a[66:67],v6 offset:2048
 ds_read_b64_tr_b16 a[68:69],v6 offset:16384
 v_mfma_f32_16x16x32_bf16 v[168:171],a[176:179],a[200:203],v[168:171]
 v_mfma_f32_16x16x32_bf16 v[168:171],a[180:183],a[204:207],v[168:171]
 ds_read_b64_tr_b16 a[70:71],v6 offset:18432
 v_mfma_f32_16x16x32_bf16 v[172:175],a[184:187],a[200:203],v[172:175]
 buffer_load_dwordx4 v15,s[4:7],s35 offen offset:3072 lds
 v_mfma_f32_16x16x32_bf16 v[172:175],a[188:191],a[204:207],v[172:175]
 s_waitcnt lgkmcnt(4)
 ds_read_b64_tr_b16 a[72:73],v7 offset:0
 v_mfma_f32_16x16x32_bf16 v[176:179],a[128:131],a[192:195],v[176:179]
 ds_read_b64_tr_b16 a[74:75],v7 offset:2048
 v_mfma_f32_16x16x32_bf16 v[176:179],a[132:135],a[196:199],v[176:179]
 ds_read_b128 a[200:203],v4 offset:10240
 s_add_u32 m0,s50,4096
 v_mfma_f32_16x16x32_bf16 v[180:183],a[136:139],a[192:195],v[180:183]
 ds_read_b64_tr_b16 a[76:77],v7 offset:16384
 v_mfma_f32_16x16x32_bf16 v[180:183],a[140:143],a[196:199],v[180:183]
 ds_read_b128 a[204:207],v5 offset:10240
 ds_read_b64_tr_b16 a[78:79],v7 offset:18432
 v_mfma_f32_16x16x32_bf16 v[184:187],a[144:147],a[192:195],v[184:187]
 ds_read_b64_tr_b16 a[80:81],v8 offset:0
 v_mfma_f32_16x16x32_bf16 v[184:187],a[148:151],a[196:199],v[184:187]
 buffer_load_dwordx4 v14,s[4:7],s36 offen offset:0 lds
 v_mfma_f32_16x16x32_bf16 v[188:191],a[152:155],a[192:195],v[188:191]
 ds_read_b64_tr_b16 a[82:83],v8 offset:2048
 v_mfma_f32_16x16x32_bf16 v[188:191],a[156:159],a[196:199],v[188:191]
 ds_read_b64_tr_b16 a[84:85],v8 offset:16384
 v_mfma_f32_16x16x32_bf16 v[192:195],a[160:163],a[192:195],v[192:195]
 v_mfma_f32_16x16x32_bf16 v[192:195],a[164:167],a[196:199],v[192:195]
 buffer_load_dwordx4 v15,s[4:7],s37 offen offset:1024 lds
 v_mfma_f32_16x16x32_bf16 v[196:199],a[168:171],a[192:195],v[196:199]
 ds_read_b64_tr_b16 a[86:87],v8 offset:18432
 ds_read_b64_tr_b16 a[88:89],v9 offset:0
 v_mfma_f32_16x16x32_bf16 v[196:199],a[172:175],a[196:199],v[196:199]
 v_mfma_f32_16x16x32_bf16 v[200:203],a[176:179],a[192:195],v[200:203]
 ds_read_b64_tr_b16 a[90:91],v9 offset:2048
 v_mfma_f32_16x16x32_bf16 v[200:203],a[180:183],a[196:199],v[200:203]
 buffer_load_dwordx4 v14,s[4:7],s38 offen offset:2048 lds
 v_mfma_f32_16x16x32_bf16 v[204:207],a[184:187],a[192:195],v[204:207]
 ds_read_b64_tr_b16 a[92:93],v9 offset:16384
 v_mfma_f32_16x16x32_bf16 v[204:207],a[188:191],a[196:199],v[204:207]
 s_waitcnt lgkmcnt(8)
 ds_read_b64_tr_b16 a[94:95],v9 offset:18432
 v_mfma_f32_16x16x32_bf16 v[208:211],a[128:131],a[200:203],v[208:211]
 ds_read_b64_tr_b16 a[96:97],v10 offset:0
 v_mfma_f32_16x16x32_bf16 v[208:211],a[132:135],a[204:207],v[208:211]
 buffer_load_dwordx4 v15,s[4:7],s39 offen offset:3072 lds
 v_mfma_f32_16x16x32_bf16 v[212:215],a[136:139],a[200:203],v[212:215]
 ds_read_b128 a[192:195],v4 offset:12288
 ds_read_b64_tr_b16 a[98:99],v10 offset:2048
 v_mfma_f32_16x16x32_bf16 v[212:215],a[140:143],a[204:207],v[212:215]
 buffer_load_dword v24,v35,s[24:27],0 offen
 v_mfma_f32_16x16x32_bf16 v[216:219],a[144:147],a[200:203],v[216:219]
 ds_read_b128 a[196:199],v5 offset:12288
 v_add_u32 v35,0x80,v35
 v_mfma_f32_16x16x32_bf16 v[216:219],a[148:151],a[204:207],v[216:219]
 ds_read_b64_tr_b16 a[100:101],v10 offset:16384
 ds_read_b64_tr_b16 a[102:103],v10 offset:18432
 v_mfma_f32_16x16x32_bf16 v[220:223],a[152:155],a[200:203],v[220:223]
 s_add_u32 s4,s4,128
 s_addc_u32 s5,s5,0
 v_mfma_f32_16x16x32_bf16 v[220:223],a[156:159],a[204:207],v[220:223]
 buffer_load_dword v24,v36,s[72:75],0 offen
 v_mfma_f32_16x16x32_bf16 v[224:227],a[160:163],a[200:203],v[224:227]
 ds_read_b64_tr_b16 a[104:105],v11 offset:0
 v_add_u32 v36,0x2a000,v36
 v_mfma_f32_16x16x32_bf16 v[224:227],a[164:167],a[204:207],v[224:227]
 buffer_load_dword v24,v37,s[40:43],0 offen
 v_mfma_f32_16x16x32_bf16 v[228:231],a[168:171],a[200:203],v[228:231]
 ds_read_b64_tr_b16 a[106:107],v11 offset:2048
 s_sub_u32 s6,s6,128
 v_mfma_f32_16x16x32_bf16 v[228:231],a[172:175],a[204:207],v[228:231]
 buffer_load_dword v24,v37,s[64:67],0 offen
 v_mfma_f32_16x16x32_bf16 v[232:235],a[176:179],a[200:203],v[232:235]
 ds_read_b64_tr_b16 a[108:109],v11 offset:16384
 v_add_u32 v37,0x1180,v37
 v_mfma_f32_16x16x32_bf16 v[232:235],a[180:183],a[204:207],v[232:235]
 ds_read_b64_tr_b16 a[110:111],v11 offset:18432
 ds_read_b64_tr_b16 a[112:113],v12 offset:0
 v_mfma_f32_16x16x32_bf16 v[236:239],a[184:187],a[200:203],v[236:239]
 s_add_u32 s50,s50,32768
 ds_read_b64_tr_b16 a[114:115],v12 offset:2048
 v_mfma_f32_16x16x32_bf16 v[236:239],a[188:191],a[204:207],v[236:239]
 s_waitcnt lgkmcnt(8)
 ds_read_b64_tr_b16 a[116:117],v12 offset:16384
 v_mfma_f32_16x16x32_bf16 v[240:243],a[128:131],a[192:195],v[240:243]
 s_cmp_ge_u32 s50,98304
 s_cselect_b32 s50,s51,s50
 v_mfma_f32_16x16x32_bf16 v[240:243],a[132:135],a[196:199],v[240:243]
 ds_read_b64_tr_b16 a[118:119],v12 offset:18432
 ds_read_b128 a[200:203],v4 offset:14336
 v_mfma_f32_16x16x32_bf16 v[244:247],a[136:139],a[192:195],v[244:247]
 ds_read_b64_tr_b16 a[120:121],v13 offset:0
 v_mfma_f32_16x16x32_bf16 v[244:247],a[140:143],a[196:199],v[244:247]
 ds_read_b128 a[204:207],v5 offset:14336
 ds_read_b64_tr_b16 a[122:123],v13 offset:2048
 v_mfma_f32_16x16x32_bf16 v[248:251],a[144:147],a[192:195],v[248:251]
 v_mfma_f32_16x16x32_bf16 v[248:251],a[148:151],a[196:199],v[248:251]
 ds_read_b64_tr_b16 a[124:125],v13 offset:16384
 v_mfma_f32_16x16x32_bf16 v[252:255],a[152:155],a[192:195],v[252:255]
 ds_read_b64_tr_b16 a[126:127],v13 offset:18432
 v_mfma_f32_16x16x32_bf16 v[252:255],a[156:159],a[196:199],v[252:255]
 v_mfma_f32_16x16x32_bf16 a[208:211],a[160:163],a[192:195],a[208:211]
 v_mfma_f32_16x16x32_bf16 a[208:211],a[164:167],a[196:199],a[208:211]
 s_add_u32 s55,s55,32768
 v_mfma_f32_16x16x32_bf16 a[212:215],a[168:171],a[192:195],a[212:215]
 s_cmp_ge_u32 s55,98304
 s_cselect_b32 s55,s54,s55
 v_mfma_f32_16x16x32_bf16 a[212:215],a[172:175],a[196:199],a[212:215]
 v_add_u32 v4,s55,v2
 v_mfma_f32_16x16x32_bf16 a[216:219],a[176:179],a[192:195],a[216:219]
 v_add_u32 v5,s55,v3
 v_mfma_f32_16x16x32_bf16 a[216:219],a[180:183],a[196:199],a[216:219]
 v_mfma_f32_16x16x32_bf16 a[220:223],a[184:187],a[192:195],a[220:223]
 v_mfma_f32_16x16x32_bf16 a[220:223],a[188:191],a[196:199],a[220:223]
 s_waitcnt vmcnt(22) lgkmcnt(0)
 s_barrier
 v_mfma_f32_16x16x32_bf16 a[224:227],a[128:131],a[200:203],a[224:227]
 ds_read_b128 a[192:195],v4 offset:0
 v_mfma_f32_16x16x32_bf16 a[224:227],a[132:135],a[204:207],a[224:227]
 ds_read_b128 a[196:199],v5 offset:0
 v_mfma_f32_16x16x32_bf16 a[228:231],a[136:139],a[200:203],a[228:231]
 v_mfma_f32_16x16x32_bf16 a[228:231],a[140:143],a[204:207],a[228:231]
 v_mfma_f32_16x16x32_bf16 a[232:235],a[144:147],a[200:203],a[232:235]
 v_mfma_f32_16x16x32_bf16 a[232:235],a[148:151],a[204:207],a[232:235]
 v_mfma_f32_16x16x32_bf16 a[236:239],a[152:155],a[200:203],a[236:239]
 v_mfma_f32_16x16x32_bf16 a[236:239],a[156:159],a[204:207],a[236:239]
 v_mfma_f32_16x16x32_bf16 a[240:243],a[160:163],a[200:203],a[240:243]
 v_mfma_f32_16x16x32_bf16 a[240:243],a[164:167],a[204:207],a[240:243]
 v_mfma_f32_16x16x32_bf16 a[244:247],a[168:171],a[200:203],a[244:247]
 v_mfma_f32_16x16x32_bf16 a[244:247],a[172:175],a[204:207],a[244:247]
 v_mfma_f32_16x16x32_bf16 a[248:251],a[176:179],a[200:203],a[248:251]
 v_mfma_f32_16x16x32_bf16 a[248:251],a[180:183],a[204:207],a[248:251]
 v_mfma_f32_16x16x32_bf16 a[252:255],a[184:187],a[200:203],a[252:255]
 v_mfma_f32_16x16x32_bf16 a[252:255],a[188:191],a[204:207],a[252:255]
 s_waitcnt lgkmcnt(0)
 s_sub_u32 s49,s49,1
 s_cmp_lg_u32 s49,0
 s_cbranch_scc1 KVL_2
 v_mov_b32 v26,0
 global_load_dword v34,v26,s[70:71] sc1
 s_getpc_b64 s[60:61]
PC_4:
 s_add_u32 s60,s60,G1T_3-PC_4
 s_addc_u32 s61,s61,(G1T_3-PC_4)>>32
 s_bfe_u32 s62,s2,0x30004
 s_lshl_b32 s62,s62,2
 s_add_u32 s62,s62,s45
 v_and_b32 v25,63,v0
 v_mul_u32_u24 v25,32,v25
 v_add_lshl_u32 v25,v25,s62,7
 v_min_u32 v25,G1T_3E-G1T_3-4,v25
 global_load_dword v24,v25,s[60:61]
G1T_3:
 v_mfma_f32_16x16x32_bf16 v[48:51],a[64:67],a[192:195],v[48:51]
 s_add_u32 m0,s53,102400
 v_mfma_f32_16x16x32_bf16 v[48:51],a[68:71],a[196:199],v[48:51]
 ds_read_b128 a[200:203],v4 offset:2048
 v_mfma_f32_16x16x32_bf16 v[52:55],a[72:75],a[192:195],v[52:55]
 v_mfma_f32_16x16x32_bf16 v[52:55],a[76:79],a[196:199],v[52:55]
 ds_read_b128 a[204:207],v5 offset:2048
 v_mfma_f32_16x16x32_bf16 v[56:59],a[80:83],a[192:195],v[56:59]
 buffer_load_dwordx4 v38,s[72:75],0 offen offset:0 lds
 v_mfma_f32_16x16x32_bf16 v[56:59],a[84:87],a[196:199],v[56:59]
 v_mfma_f32_16x16x32_bf16 v[60:63],a[88:91],a[192:195],v[60:63]
 v_mfma_f32_16x16x32_bf16 v[60:63],a[92:95],a[196:199],v[60:63]
 buffer_load_dwordx4 v39,s[72:75],0 offen offset:1024 lds
 v_mfma_f32_16x16x32_bf16 v[64:67],a[96:99],a[192:195],v[64:67]
 v_mfma_f32_16x16x32_bf16 v[64:67],a[100:103],a[196:199],v[64:67]
 v_mfma_f32_16x16x32_bf16 v[68:71],a[104:107],a[192:195],v[68:71]
 v_mfma_f32_16x16x32_bf16 v[68:71],a[108:111],a[196:199],v[68:71]
 buffer_load_dwordx4 v40,s[72:75],0 offen offset:2048 lds
 v_mfma_f32_16x16x32_bf16 v[72:75],a[112:115],a[192:195],v[72:75]
 v_mfma_f32_16x16x32_bf16 v[72:75],a[116:119],a[196:199],v[72:75]
 v_mfma_f32_16x16x32_bf16 v[76:79],a[120:123],a[192:195],v[76:79]
 v_mfma_f32_16x16x32_bf16 v[76:79],a[124:127],a[196:199],v[76:79]
 s_waitcnt lgkmcnt(0)
 s_add_u32 m0,s52,65536
 v_mfma_f32_16x16x32_bf16 v[80:83],a[64:67],a[200:203],v[80:83]
 v_mfma_f32_16x16x32_bf16 v[80:83],a[68:71],a[204:207],v[80:83]
 ds_read_b128 a[192:195],v4 offset:4096
 v_mfma_f32_16x16x32_bf16 v[84:87],a[72:75],a[200:203],v[84:87]
 v_mfma_f32_16x16x32_bf16 v[84:87],a[76:79],a[204:207],v[84:87]
 ds_read_b128 a[196:199],v5 offset:4096
 v_mfma_f32_16x16x32_bf16 v[88:91],a[80:83],a[200:203],v[88:91]
 buffer_load_dwordx4 v20,s[24:27],s12 offen offset:0 lds
 v_mfma_f32_16x16x32_bf16 v[88:91],a[84:87],a[204:207],v[88:91]
 v_mfma_f32_16x16x32_bf16 v[92:95],a[88:91],a[200:203],v[92:95]
 v_mfma_f32_16x16x32_bf16 v[92:95],a[92:95],a[204:207],v[92:95]
 s_add_u32 m0,s52,66560
 v_mfma_f32_16x16x32_bf16 v[96:99],a[96:99],a[200:203],v[96:99]
 v_mfma_f32_16x16x32_bf16 v[96:99],a[100:103],a[204:207],v[96:99]
 v_mfma_f32_16x16x32_bf16 v[100:103],a[104:107],a[200:203],v[100:103]
 buffer_load_dwordx4 v21,s[24:27],s13 offen offset:0 lds
 v_mfma_f32_16x16x32_bf16 v[100:103],a[108:111],a[204:207],v[100:103]
 v_mfma_f32_16x16x32_bf16 v[104:107],a[112:115],a[200:203],v[104:107]
 v_mfma_f32_16x16x32_bf16 v[104:107],a[116:119],a[204:207],v[104:107]
 v_mfma_f32_16x16x32_bf16 v[108:111],a[120:123],a[200:203],v[108:111]
 s_add_u32 m0,s52,67584
 v_mfma_f32_16x16x32_bf16 v[108:111],a[124:127],a[204:207],v[108:111]
 s_waitcnt lgkmcnt(0)
 v_mfma_f32_16x16x32_bf16 v[112:115],a[64:67],a[192:195],v[112:115]
 v_mfma_f32_16x16x32_bf16 v[112:115],a[68:71],a[196:199],v[112:115]
 ds_read_b128 a[200:203],v4 offset:6144
 v_mfma_f32_16x16x32_bf16 v[116:119],a[72:75],a[192:195],v[116:119]
 buffer_load_dwordx4 v20,s[24:27],s14 offen offset:0 lds
 v_mfma_f32_16x16x32_bf16 v[116:119],a[76:79],a[196:199],v[116:119]
 ds_read_b128 a[204:207],v5 offset:6144
 v_mfma_f32_16x16x32_bf16 v[120:123],a[80:83],a[192:195],v[120:123]
 v_mfma_f32_16x16x32_bf16 v[120:123],a[84:87],a[196:199],v[120:123]
 v_mfma_f32_16x16x32_bf16 v[124:127],a[88:91],a[192:195],v[124:127]
 s_add_u32 m0,s52,68608
 v_mfma_f32_16x16x32_bf16 v[124:127],a[92:95],a[196:199],v[124:127]
 v_mfma_f32_16x16x32_bf16 v[128:131],a[96:99],a[192:195],v[128:131]
 v_mfma_f32_16x16x32_bf16 v[128:131],a[100:103],a[196:199],v[128:131]
 v_mfma_f32_16x16x32_bf16 v[132:135],a[104:107],a[192:195],v[132:135]
 buffer_load_dwordx4 v21,s[24:27],s15 offen offset:0 lds
 v_mfma_f32_16x16x32_bf16 v[132:135],a[108:111],a[196:199],v[132:135]
 v_mfma_f32_16x16x32_bf16 v[136:139],a[112:115],a[192:195],v[136:139]
 v_mfma_f32_16x16x32_bf16 v[136:139],a[116:119],a[196:199],v[136:139]
 v_mfma_f32_16x16x32_bf16 v[140:143],a[120:123],a[192:195],v[140:143]
 s_add_u32 m0,s52,69632
 v_mfma_f32_16x16x32_bf16 v[140:143],a[124:127],a[196:199],v[140:143]
 s_waitcnt lgkmcnt(0)
 v_mfma_f32_16x16x32_bf16 v[144:147],a[64:67],a[200:203],v[144:147]
 v_mfma_f32_16x16x32_bf16 v[144:147],a[68:71],a[204:207],v[144:147]
 ds_read_b128 a[192:195],v4 offset:8192
 v_mfma_f32_16x16x32_bf16 v[148:151],a[72:75],a[200:203],v[148:151]
 buffer_load_dwordx4 v20,s[24:27],s16 offen offset:0 lds
 v_mfma_f32_16x16x32_bf16 v[148:151],a[76:79],a[204:207],v[148:151]
 ds_read_b128 a[196:199],v5 offset:8192
 v_mfma_f32_16x16x32_bf16 v[152:155],a[80:83],a[200:203],v[152:155]
 v_mfma_f32_16x16x32_bf16 v[152:155],a[84:87],a[204:207],v[152:155]
 s_add_u32 m0,s52,70656
 v_mfma_f32_16x16x32_bf16 v[156:159],a[88:91],a[200:203],v[156:159]
 v_mfma_f32_16x16x32_bf16 v[156:159],a[92:95],a[204:207],v[156:159]
 v_mfma_f32_16x16x32_bf16 v[160:163],a[96:99],a[200:203],v[160:163]
 s_waitcnt vmcnt(22)
 s_barrier
 v_mfma_f32_16x16x32_bf16 v[160:163],a[100:103],a[204:207],v[160:163]
 ds_read_b64_tr_b16 a[128:129],v6 offset:32768
 v_mfma_f32_16x16x32_bf16 v[164:167],a[104:107],a[200:203],v[164:167]
 buffer_load_dwordx4 v21,s[24:27],s17 offen offset:0 lds
 v_mfma_f32_16x16x32_bf16 v[164:167],a[108:111],a[204:207],v[164:167]
 ds_read_b64_tr_b16 a[130:131],v6 offset:34816
 ds_read_b64_tr_b16 a[132:133],v6 offset:49152
 v_mfma_f32_16x16x32_bf16 v[168:171],a[112:115],a[200:203],v[168:171]
 v_mfma_f32_16x16x32_bf16 v[168:171],a[116:119],a[204:207],v[168:171]
 ds_read_b64_tr_b16 a[134:135],v6 offset:51200
 s_add_u32 m0,s52,71680
 v_mfma_f32_16x16x32_bf16 v[172:175],a[120:123],a[200:203],v[172:175]
 ds_read_b64_tr_b16 a[136:137],v7 offset:32768
 v_mfma_f32_16x16x32_bf16 v[172:175],a[124:127],a[204:207],v[172:175]
 s_waitcnt lgkmcnt(5)
 v_mfma_f32_16x16x32_bf16 v[176:179],a[64:67],a[192:195],v[176:179]
 ds_read_b64_tr_b16 a[138:139],v7 offset:34816
 v_mfma_f32_16x16x32_bf16 v[176:179],a[68:71],a[196:199],v[176:179]
 ds_read_b128 a[200:203],v4 offset:10240
 ds_read_b64_tr_b16 a[140:141],v7 offset:49152
 v_mfma_f32_16x16x32_bf16 v[180:183],a[72:75],a[192:195],v[180:183]
 buffer_load_dwordx4 v20,s[24:27],s18 offen offset:0 lds
 v_mfma_f32_16x16x32_bf16 v[180:183],a[76:79],a[196:199],v[180:183]
 ds_read_b128 a[204:207],v5 offset:10240
 ds_read_b64_tr_b16 a[142:143],v7 offset:51200
 v_mfma_f32_16x16x32_bf16 v[184:187],a[80:83],a[192:195],v[184:187]
 ds_read_b64_tr_b16 a[144:145],v8 offset:32768
 v_mfma_f32_16x16x32_bf16 v[184:187],a[84:87],a[196:199],v[184:187]
 s_add_u32 m0,s52,72704
 v_mfma_f32_16x16x32_bf16 v[188:191],a[88:91],a[192:195],v[188:191]
 ds_read_b64_tr_b16 a[146:147],v8 offset:34816
 v_mfma_f32_16x16x32_bf16 v[188:191],a[92:95],a[196:199],v[188:191]
 ds_read_b64_tr_b16 a[148:149],v8 offset:49152
 v_mfma_f32_16x16x32_bf16 v[192:195],a[96:99],a[192:195],v[192:195]
 v_mfma_f32_16x16x32_bf16 v[192:195],a[100:103],a[196:199],v[192:195]
 buffer_load_dwordx4 v21,s[24:27],s19 offen offset:0 lds
 v_mfma_f32_16x16x32_bf16 v[196:199],a[104:107],a[192:195],v[196:199]
 ds_read_b64_tr_b16 a[150:151],v8 offset:51200
 ds_read_b64_tr_b16 a[152:153],v9 offset:32768
 v_mfma_f32_16x16x32_bf16 v[196:199],a[108:111],a[196:199],v[196:199]
 v_mfma_f32_16x16x32_bf16 v[200:203],a[112:115],a[192:195],v[200:203]
 ds_read_b64_tr_b16 a[154:155],v9 offset:34816
 s_add_u32 m0,s52,73728
 v_mfma_f32_16x16x32_bf16 v[200:203],a[116:119],a[196:199],v[200:203]
 ds_read_b64_tr_b16 a[156:157],v9 offset:49152
 v_mfma_f32_16x16x32_bf16 v[204:207],a[120:123],a[192:195],v[204:207]
 v_mfma_f32_16x16x32_bf16 v[204:207],a[124:127],a[196:199],v[204:207]
 s_waitcnt lgkmcnt(8)
 ds_read_b64_tr_b16 a[158:159],v9 offset:51200
 v_mfma_f32_16x16x32_bf16 v[208:211],a[64:67],a[200:203],v[208:211]
 ds_read_b64_tr_b16 a[160:161],v10 offset:32768
 v_mfma_f32_16x16x32_bf16 v[208:211],a[68:71],a[204:207],v[208:211]
 buffer_load_dwordx4 v20,s[24:27],s20 offen offset:0 lds
 v_mfma_f32_16x16x32_bf16 v[212:215],a[72:75],a[200:203],v[212:215]
 ds_read_b128 a[192:195],v4 offset:12288
 ds_read_b64_tr_b16 a[162:163],v10 offset:34816
 v_mfma_f32_16x16x32_bf16 v[212:215],a[76:79],a[204:207],v[212:215]
 ds_read_b128 a[196:199],v5 offset:12288
 ds_read_b64_tr_b16 a[164:165],v10 offset:49152
 v_mfma_f32_16x16x32_bf16 v[216:219],a[80:83],a[200:203],v[216:219]
 s_add_u32 s24,s24,128
 s_addc_u32 s25,s25,0
 v_mfma_f32_16x16x32_bf16 v[216:219],a[84:87],a[204:207],v[216:219]
 ds_read_b64_tr_b16 a[166:167],v10 offset:51200
 v_mfma_f32_16x16x32_bf16 v[220:223],a[88:91],a[200:203],v[220:223]
 ds_read_b64_tr_b16 a[168:169],v11 offset:32768
 v_mfma_f32_16x16x32_bf16 v[220:223],a[92:95],a[204:207],v[220:223]
 ds_read_b64_tr_b16 a[170:171],v11 offset:34816
 v_mfma_f32_16x16x32_bf16 v[224:227],a[96:99],a[200:203],v[224:227]
 s_sub_u32 s26,s26,128
 v_mfma_f32_16x16x32_bf16 v[224:227],a[100:103],a[204:207],v[224:227]
 ds_read_b64_tr_b16 a[172:173],v11 offset:49152
 v_mfma_f32_16x16x32_bf16 v[228:231],a[104:107],a[200:203],v[228:231]
 ds_read_b64_tr_b16 a[174:175],v11 offset:51200
 v_mfma_f32_16x16x32_bf16 v[228:231],a[108:111],a[204:207],v[228:231]
 v_mfma_f32_16x16x32_bf16 v[232:235],a[112:115],a[200:203],v[232:235]
 ds_read_b64_tr_b16 a[176:177],v12 offset:32768
 v_mfma_f32_16x16x32_bf16 v[232:235],a[116:119],a[204:207],v[232:235]
 s_add_u32 s72,s72,172032
 s_addc_u32 s73,s73,0
 v_mfma_f32_16x16x32_bf16 v[236:239],a[120:123],a[200:203],v[236:239]
 ds_read_b64_tr_b16 a[178:179],v12 offset:34816
 v_mfma_f32_16x16x32_bf16 v[236:239],a[124:127],a[204:207],v[236:239]
 s_waitcnt lgkmcnt(8)
 ds_read_b64_tr_b16 a[180:181],v12 offset:49152
 v_mfma_f32_16x16x32_bf16 v[240:243],a[64:67],a[192:195],v[240:243]
 s_sub_u32 s74,s74,172032
 ds_read_b64_tr_b16 a[182:183],v12 offset:51200
 v_mfma_f32_16x16x32_bf16 v[240:243],a[68:71],a[196:199],v[240:243]
 ds_read_b128 a[200:203],v4 offset:14336
 v_mfma_f32_16x16x32_bf16 v[244:247],a[72:75],a[192:195],v[244:247]
 ds_read_b64_tr_b16 a[184:185],v13 offset:32768
 v_mfma_f32_16x16x32_bf16 v[244:247],a[76:79],a[196:199],v[244:247]
 ds_read_b128 a[204:207],v5 offset:14336
 ds_read_b64_tr_b16 a[186:187],v13 offset:34816
 v_mfma_f32_16x16x32_bf16 v[248:251],a[80:83],a[192:195],v[248:251]
 v_mfma_f32_16x16x32_bf16 v[248:251],a[84:87],a[196:199],v[248:251]
 ds_read_b64_tr_b16 a[188:189],v13 offset:49152
 v_mfma_f32_16x16x32_bf16 v[252:255],a[88:91],a[192:195],v[252:255]
 ds_read_b64_tr_b16 a[190:191],v13 offset:51200
 v_mfma_f32_16x16x32_bf16 v[252:255],a[92:95],a[196:199],v[252:255]
 v_mfma_f32_16x16x32_bf16 a[208:211],a[96:99],a[192:195],a[208:211]
 v_mfma_f32_16x16x32_bf16 a[208:211],a[100:103],a[196:199],a[208:211]
 s_add_u32 s55,s55,32768
 v_mfma_f32_16x16x32_bf16 a[212:215],a[104:107],a[192:195],a[212:215]
 s_cmp_ge_u32 s55,98304
 s_cselect_b32 s55,s54,s55
 v_mfma_f32_16x16x32_bf16 a[212:215],a[108:111],a[196:199],a[212:215]
 v_add_u32 v4,s55,v2
 v_mfma_f32_16x16x32_bf16 a[216:219],a[112:115],a[192:195],a[216:219]
 v_add_u32 v5,s55,v3
 v_mfma_f32_16x16x32_bf16 a[216:219],a[116:119],a[196:199],a[216:219]
 v_mfma_f32_16x16x32_bf16 a[220:223],a[120:123],a[192:195],a[220:223]
 v_mfma_f32_16x16x32_bf16 a[220:223],a[124:127],a[196:199],a[220:223]
 s_waitcnt vmcnt(13) lgkmcnt(0)
 s_barrier
 v_mfma_f32_16x16x32_bf16 a[224:227],a[64:67],a[200:203],a[224:227]
 ds_read_b128 a[192:195],v4 offset:0
 v_mfma_f32_16x16x32_bf16 a[224:227],a[68:71],a[204:207],a[224:227]
 ds_read_b128 a[196:199],v5 offset:0
 v_mfma_f32_16x16x32_bf16 a[228:231],a[72:75],a[200:203],a[228:231]
 v_mfma_f32_16x16x32_bf16 a[228:231],a[76:79],a[204:207],a[228:231]
 v_mfma_f32_16x16x32_bf16 a[232:235],a[80:83],a[200:203],a[232:235]
 v_mfma_f32_16x16x32_bf16 a[232:235],a[84:87],a[204:207],a[232:235]
 v_mfma_f32_16x16x32_bf16 a[236:239],a[88:91],a[200:203],a[236:239]
 v_mfma_f32_16x16x32_bf16 a[236:239],a[92:95],a[204:207],a[236:239]
 v_mfma_f32_16x16x32_bf16 a[240:243],a[96:99],a[200:203],a[240:243]
 v_mfma_f32_16x16x32_bf16 a[240:243],a[100:103],a[204:207],a[240:243]
 v_mfma_f32_16x16x32_bf16 a[244:247],a[104:107],a[200:203],a[244:247]
 v_mfma_f32_16x16x32_bf16 a[244:247],a[108:111],a[204:207],a[244:247]
 v_mfma_f32_16x16x32_bf16 a[248:251],a[112:115],a[200:203],a[248:251]
 v_mfma_f32_16x16x32_bf16 a[248:251],a[116:119],a[204:207],a[248:251]
 v_mfma_f32_16x16x32_bf16 a[252:255],a[120:123],a[200:203],a[252:255]
 v_mfma_f32_16x16x32_bf16 a[252:255],a[124:127],a[204:207],a[252:255]
 s_waitcnt lgkmcnt(0)
ZP_7:
 v_readfirstlane_b32 s61,v34
 s_nop 3
 s_cmp_lg_u32 s61,0
 s_cbranch_scc1 ZC_6
 v_mov_b32 v26,0
 global_load_dword v34,v26,s[70:71] sc1
 s_waitcnt vmcnt(0)
 s_branch ZP_7
ZC_6:
 s_add_u32 s61,s46,224
 s_lshl_b32 s61,s61,7
 s_add_u32 s61,s61,125829120
 v_mov_b32 v29,s61
 v_mov_b32 v30,8
 buffer_load_dword v31,v29,s[28:31],0 offen sc1
 v_mfma_f32_16x16x32_bf16 v[48:51],a[128:131],a[192:195],v[48:51]
 s_add_u32 m0,s53,151552
 v_mfma_f32_16x16x32_bf16 v[48:51],a[132:135],a[196:199],v[48:51]
 ds_read_b128 a[200:203],v4 offset:2048
 v_mfma_f32_16x16x32_bf16 v[52:55],a[136:139],a[192:195],v[52:55]
 v_mfma_f32_16x16x32_bf16 v[52:55],a[140:143],a[196:199],v[52:55]
 ds_read_b128 a[204:207],v5 offset:2048
 v_mfma_f32_16x16x32_bf16 v[56:59],a[144:147],a[192:195],v[56:59]
 buffer_load_dwordx4 v38,s[72:75],0 offen offset:0 lds
 v_mfma_f32_16x16x32_bf16 v[56:59],a[148:151],a[196:199],v[56:59]
 v_mfma_f32_16x16x32_bf16 v[60:63],a[152:155],a[192:195],v[60:63]
 v_mfma_f32_16x16x32_bf16 v[60:63],a[156:159],a[196:199],v[60:63]
 buffer_load_dwordx4 v39,s[72:75],0 offen offset:1024 lds
 v_mfma_f32_16x16x32_bf16 v[64:67],a[160:163],a[192:195],v[64:67]
 v_mfma_f32_16x16x32_bf16 v[64:67],a[164:167],a[196:199],v[64:67]
 v_mfma_f32_16x16x32_bf16 v[68:71],a[168:171],a[192:195],v[68:71]
 v_mfma_f32_16x16x32_bf16 v[68:71],a[172:175],a[196:199],v[68:71]
 buffer_load_dwordx4 v40,s[72:75],0 offen offset:2048 lds
 v_mul_f32 v48,s58,v48
 v_mfma_f32_16x16x32_bf16 v[72:75],a[176:179],a[192:195],v[72:75]
 v_mul_f32 v49,s58,v49
 v_mul_f32 v50,s58,v50
 v_mul_f32 v51,s58,v51
 v_mfma_f32_16x16x32_bf16 v[72:75],a[180:183],a[196:199],v[72:75]
 v_mul_f32 v52,s58,v52
 v_mul_f32 v53,s58,v53
 v_mul_f32 v54,s58,v54
 v_mfma_f32_16x16x32_bf16 v[76:79],a[184:187],a[192:195],v[76:79]
 v_mul_f32 v55,s58,v55
 v_cvt_pk_bf16_f32 v48,v48,v49
 v_cvt_pk_bf16_f32 v49,v50,v51
 v_mfma_f32_16x16x32_bf16 v[76:79],a[188:191],a[196:199],v[76:79]
 s_waitcnt lgkmcnt(0)
 s_add_u32 m0,s52,114688
 s_add_u32 s60,s56,0
 v_mfma_f32_16x16x32_bf16 v[80:83],a[128:131],a[200:203],v[80:83]
 v_cvt_pk_bf16_f32 v50,v52,v53
 v_cvt_pk_bf16_f32 v51,v54,v55
 v_mfma_f32_16x16x32_bf16 v[80:83],a[132:135],a[204:207],v[80:83]
 buffer_store_dwordx4 v[48:51],v1,s[28:31],s60 offen sc1
 ds_read_b128 a[192:195],v4 offset:4096
 v_mfma_f32_16x16x32_bf16 v[84:87],a[136:139],a[200:203],v[84:87]
 v_mul_f32 v56,s58,v56
 v_mul_f32 v57,s58,v57
 v_mul_f32 v58,s58,v58
 v_mfma_f32_16x16x32_bf16 v[84:87],a[140:143],a[204:207],v[84:87]
 ds_read_b128 a[196:199],v5 offset:4096
 v_mul_f32 v59,s58,v59
 v_mul_f32 v60,s58,v60
 v_mfma_f32_16x16x32_bf16 v[88:91],a[144:147],a[200:203],v[88:91]
 buffer_load_dwordx4 v20,s[24:27],s12 offen offset:0 lds
 v_mul_f32 v61,s58,v61
 v_mfma_f32_16x16x32_bf16 v[88:91],a[148:151],a[204:207],v[88:91]
 v_mul_f32 v62,s58,v62
 v_mul_f32 v63,s58,v63
 v_cvt_pk_bf16_f32 v56,v56,v57
 v_mfma_f32_16x16x32_bf16 v[92:95],a[152:155],a[200:203],v[92:95]
 v_cvt_pk_bf16_f32 v57,v58,v59
 s_add_u32 s60,s56,1024
 v_cvt_pk_bf16_f32 v58,v60,v61
 v_mfma_f32_16x16x32_bf16 v[92:95],a[156:159],a[204:207],v[92:95]
 s_add_u32 m0,s52,115712
 v_cvt_pk_bf16_f32 v59,v62,v63
 v_mfma_f32_16x16x32_bf16 v[96:99],a[160:163],a[200:203],v[96:99]
 buffer_store_dwordx4 v[56:59],v1,s[28:31],s60 offen sc1
 v_mul_f32 v64,s58,v64
 v_mfma_f32_16x16x32_bf16 v[96:99],a[164:167],a[204:207],v[96:99]
 v_mul_f32 v65,s58,v65
 v_mul_f32 v66,s58,v66
 v_mul_f32 v67,s58,v67
 v_mfma_f32_16x16x32_bf16 v[100:103],a[168:171],a[200:203],v[100:103]
 v_mul_f32 v68,s58,v68
 v_mul_f32 v69,s58,v69
 v_mul_f32 v70,s58,v70
 v_mfma_f32_16x16x32_bf16 v[100:103],a[172:175],a[204:207],v[100:103]
 buffer_load_dwordx4 v21,s[24:27],s13 offen offset:0 lds
 v_mul_f32 v71,s58,v71
 v_mfma_f32_16x16x32_bf16 v[104:107],a[176:179],a[200:203],v[104:107]
 v_cvt_pk_bf16_f32 v64,v64,v65
 v_cvt_pk_bf16_f32 v65,v66,v67
 s_add_u32 s60,s56,2048
 v_mfma_f32_16x16x32_bf16 v[104:107],a[180:183],a[204:207],v[104:107]
 v_cvt_pk_bf16_f32 v66,v68,v69
 v_cvt_pk_bf16_f32 v67,v70,v71
 v_mfma_f32_16x16x32_bf16 v[108:111],a[184:187],a[200:203],v[108:111]
 buffer_store_dwordx4 v[64:67],v1,s[28:31],s60 offen sc1
 s_add_u32 m0,s52,116736
 v_mfma_f32_16x16x32_bf16 v[108:111],a[188:191],a[204:207],v[108:111]
 s_waitcnt lgkmcnt(0)
 v_mul_f32 v72,s58,v72
 v_mul_f32 v73,s58,v73
 v_mfma_f32_16x16x32_bf16 v[112:115],a[128:131],a[192:195],v[112:115]
 v_mul_f32 v74,s58,v74
 v_mul_f32 v75,s58,v75
 v_mul_f32 v76,s58,v76
 v_mfma_f32_16x16x32_bf16 v[112:115],a[132:135],a[196:199],v[112:115]
 ds_read_b128 a[200:203],v4 offset:6144
 v_mul_f32 v77,s58,v77
 v_mul_f32 v78,s58,v78
 v_mfma_f32_16x16x32_bf16 v[116:119],a[136:139],a[192:195],v[116:119]
 buffer_load_dwordx4 v20,s[24:27],s14 offen offset:0 lds
 v_mul_f32 v79,s58,v79
 v_mfma_f32_16x16x32_bf16 v[116:119],a[140:143],a[196:199],v[116:119]
 ds_read_b128 a[204:207],v5 offset:6144
 v_cvt_pk_bf16_f32 v72,v72,v73
 v_cvt_pk_bf16_f32 v73,v74,v75
 v_mfma_f32_16x16x32_bf16 v[120:123],a[144:147],a[192:195],v[120:123]
 s_add_u32 s60,s56,3072
 v_cvt_pk_bf16_f32 v74,v76,v77
 v_cvt_pk_bf16_f32 v75,v78,v79
 v_mfma_f32_16x16x32_bf16 v[120:123],a[148:151],a[196:199],v[120:123]
 buffer_store_dwordx4 v[72:75],v1,s[28:31],s60 offen sc1
 v_mul_f32 v80,s58,v80
 v_mfma_f32_16x16x32_bf16 v[124:127],a[152:155],a[192:195],v[124:127]
 s_add_u32 m0,s52,117760
 v_mul_f32 v81,s58,v81
 v_mul_f32 v82,s58,v82
 v_mfma_f32_16x16x32_bf16 v[124:127],a[156:159],a[196:199],v[124:127]
 v_mul_f32 v83,s58,v83
 v_mul_f32 v84,s58,v84
 v_mul_f32 v85,s58,v85
 v_mfma_f32_16x16x32_bf16 v[128:131],a[160:163],a[192:195],v[128:131]
 v_mul_f32 v86,s58,v86
 v_mul_f32 v87,s58,v87
 v_cvt_pk_bf16_f32 v80,v80,v81
 v_mfma_f32_16x16x32_bf16 v[128:131],a[164:167],a[196:199],v[128:131]
 v_cvt_pk_bf16_f32 v81,v82,v83
 s_add_u32 s60,s56,8192
 v_cvt_pk_bf16_f32 v82,v84,v85
 v_mfma_f32_16x16x32_bf16 v[132:135],a[168:171],a[192:195],v[132:135]
 buffer_load_dwordx4 v21,s[24:27],s15 offen offset:0 lds
 v_cvt_pk_bf16_f32 v83,v86,v87
 v_mfma_f32_16x16x32_bf16 v[132:135],a[172:175],a[196:199],v[132:135]
 buffer_store_dwordx4 v[80:83],v1,s[28:31],s60 offen sc1
 v_mul_f32 v88,s58,v88
 v_mfma_f32_16x16x32_bf16 v[136:139],a[176:179],a[192:195],v[136:139]
 v_mul_f32 v89,s58,v89
 v_mul_f32 v90,s58,v90
 v_mul_f32 v91,s58,v91
 v_mfma_f32_16x16x32_bf16 v[136:139],a[180:183],a[196:199],v[136:139]
 v_mul_f32 v92,s58,v92
 v_mul_f32 v93,s58,v93
 v_mul_f32 v94,s58,v94
 v_mfma_f32_16x16x32_bf16 v[140:143],a[184:187],a[192:195],v[140:143]
 s_add_u32 m0,s52,118784
 v_mul_f32 v95,s58,v95
 v_cvt_pk_bf16_f32 v88,v88,v89
 v_mfma_f32_16x16x32_bf16 v[140:143],a[188:191],a[196:199],v[140:143]
 s_waitcnt lgkmcnt(0)
 v_cvt_pk_bf16_f32 v89,v90,v91
 s_add_u32 s60,s56,9216
 v_mfma_f32_16x16x32_bf16 v[144:147],a[128:131],a[200:203],v[144:147]
 v_cvt_pk_bf16_f32 v90,v92,v93
 v_cvt_pk_bf16_f32 v91,v94,v95
 v_mfma_f32_16x16x32_bf16 v[144:147],a[132:135],a[204:207],v[144:147]
 buffer_store_dwordx4 v[88:91],v1,s[28:31],s60 offen sc1
 ds_read_b128 a[192:195],v4 offset:8192
 v_mfma_f32_16x16x32_bf16 v[148:151],a[136:139],a[200:203],v[148:151]
 v_mul_f32 v96,s58,v96
 v_mul_f32 v97,s58,v97
 v_mul_f32 v98,s58,v98
 v_mfma_f32_16x16x32_bf16 v[148:151],a[140:143],a[204:207],v[148:151]
 ds_read_b128 a[196:199],v5 offset:8192
 s_add_u32 s61,s51,65536
 v_mul_f32 v99,s58,v99
 v_mfma_f32_16x16x32_bf16 v[152:155],a[144:147],a[200:203],v[152:155]
 buffer_load_dwordx4 v20,s[24:27],s16 offen offset:0 lds
 v_mul_f32 v100,s58,v100
 v_mfma_f32_16x16x32_bf16 v[152:155],a[148:151],a[204:207],v[152:155]
 v_add_u32 v35,s61,v2
 v_add_u32 v36,s61,v3
 v_mul_f32 v101,s58,v101
 v_mfma_f32_16x16x32_bf16 v[156:159],a[152:155],a[200:203],v[156:159]
 s_add_u32 m0,s52,119808
 v_add_u32 v22,0x19000,v41
 v_mul_f32 v102,s58,v102
 v_mfma_f32_16x16x32_bf16 v[156:159],a[156:159],a[204:207],v[156:159]
 v_add_u32 v23,0x19000,v42
 v_mul_f32 v103,s58,v103
 v_cvt_pk_bf16_f32 v96,v96,v97
 v_mfma_f32_16x16x32_bf16 v[160:163],a[160:163],a[200:203],v[160:163]
 s_waitcnt vmcnt(15)
 s_barrier
 v_cvt_pk_bf16_f32 v97,v98,v99
 v_mfma_f32_16x16x32_bf16 v[160:163],a[164:167],a[204:207],v[160:163]
 ds_read_b128 a[48:51],v35 offset:0
 s_add_u32 s60,s56,10240
 v_cvt_pk_bf16_f32 v98,v100,v101
 v_mfma_f32_16x16x32_bf16 v[164:167],a[168:171],a[200:203],v[164:167]
 buffer_load_dwordx4 v21,s[24:27],s17 offen offset:0 lds
 v_cvt_pk_bf16_f32 v99,v102,v103
 v_mfma_f32_16x16x32_bf16 v[164:167],a[172:175],a[204:207],v[164:167]
 ds_read_b128 a[52:55],v36 offset:0
 ds_read_b128 a[56:59],v35 offset:2048
 v_mfma_f32_16x16x32_bf16 v[168:171],a[176:179],a[200:203],v[168:171]
 buffer_store_dwordx4 v[96:99],v1,s[28:31],s60 offen sc1
 v_mul_f32 v104,s58,v104
 v_mfma_f32_16x16x32_bf16 v[168:171],a[180:183],a[204:207],v[168:171]
 ds_read_b128 a[60:63],v36 offset:2048
 s_add_u32 m0,s52,120832
 v_mul_f32 v105,s58,v105
 v_mfma_f32_16x16x32_bf16 v[172:175],a[184:187],a[200:203],v[172:175]
 ds_read_b128 a[64:67],v35 offset:4096
 v_mul_f32 v106,s58,v106
 v_mul_f32 v107,s58,v107
 v_mfma_f32_16x16x32_bf16 v[172:175],a[188:191],a[204:207],v[172:175]
 s_waitcnt lgkmcnt(5)
 ds_read_b128 a[68:71],v36 offset:4096
 v_mul_f32 v108,s58,v108
 v_mfma_f32_16x16x32_bf16 v[176:179],a[128:131],a[192:195],v[176:179]
 v_mul_f32 v109,s58,v109
 v_mul_f32 v110,s58,v110
 v_mul_f32 v111,s58,v111
 v_mfma_f32_16x16x32_bf16 v[176:179],a[132:135],a[196:199],v[176:179]
 ds_read_b128 a[200:203],v4 offset:10240
 ds_read_b128 a[72:75],v35 offset:6144
 v_cvt_pk_bf16_f32 v104,v104,v105
 v_mfma_f32_16x16x32_bf16 v[180:183],a[136:139],a[192:195],v[180:183]
 buffer_load_dwordx4 v20,s[24:27],s18 offen offset:0 lds
 v_cvt_pk_bf16_f32 v105,v106,v107
 v_mfma_f32_16x16x32_bf16 v[180:183],a[140:143],a[196:199],v[180:183]
 ds_read_b128 a[76:79],v36 offset:6144
 ds_read_b128 a[204:207],v5 offset:10240
 s_add_u32 s60,s56,11264
 v_mfma_f32_16x16x32_bf16 v[184:187],a[144:147],a[192:195],v[184:187]
 ds_read_b128 a[80:83],v35 offset:8192
 v_cvt_pk_bf16_f32 v106,v108,v109
 v_cvt_pk_bf16_f32 v107,v110,v111
 v_mfma_f32_16x16x32_bf16 v[184:187],a[148:151],a[196:199],v[184:187]
 s_add_u32 m0,s52,121856
 ds_read_b128 a[84:87],v36 offset:8192
 v_mfma_f32_16x16x32_bf16 v[188:191],a[152:155],a[192:195],v[188:191]
 buffer_store_dwordx4 v[104:107],v1,s[28:31],s60 offen sc1
 ds_read_b64_tr_b16 a[0:1],v22 offset:0
 v_mfma_f32_16x16x32_bf16 v[188:191],a[156:159],a[196:199],v[188:191]
 v_mul_f32 v112,s58,v112
 v_mul_f32 v113,s58,v113
 v_mul_f32 v114,s58,v114
 v_mfma_f32_16x16x32_bf16 v[192:195],a[160:163],a[192:195],v[192:195]
 ds_read_b64_tr_b16 a[2:3],v22 offset:768
 v_mul_f32 v115,s58,v115
 v_mul_f32 v116,s58,v116
 v_mfma_f32_16x16x32_bf16 v[192:195],a[164:167],a[196:199],v[192:195]
 buffer_load_dwordx4 v21,s[24:27],s19 offen offset:0 lds
 v_mul_f32 v117,s58,v117
 v_mfma_f32_16x16x32_bf16 v[196:199],a[168:171],a[192:195],v[196:199]
 ds_read_b64_tr_b16 a[4:5],v22 offset:6144
 ds_read_b64_tr_b16 a[6:7],v22 offset:6912
 v_mul_f32 v118,s58,v118
 v_mfma_f32_16x16x32_bf16 v[196:199],a[172:175],a[196:199],v[196:199]
 v_mul_f32 v119,s58,v119
 v_cvt_pk_bf16_f32 v112,v112,v113
 v_cvt_pk_bf16_f32 v113,v114,v115
 v_mfma_f32_16x16x32_bf16 v[200:203],a[176:179],a[192:195],v[200:203]
 ds_read_b64_tr_b16 a[8:9],v23 offset:0
 s_add_u32 m0,s52,122880
 s_add_u32 s60,s56,16384
 v_mfma_f32_16x16x32_bf16 v[200:203],a[180:183],a[196:199],v[200:203]
 ds_read_b64_tr_b16 a[10:11],v23 offset:768
 v_cvt_pk_bf16_f32 v114,v116,v117
 v_cvt_pk_bf16_f32 v115,v118,v119
 v_mfma_f32_16x16x32_bf16 v[204:207],a[184:187],a[192:195],v[204:207]
 buffer_store_dwordx4 v[112:115],v1,s[28:31],s60 offen sc1
 v_mul_f32 v120,s58,v120
 v_mfma_f32_16x16x32_bf16 v[204:207],a[188:191],a[196:199],v[204:207]
 s_waitcnt lgkmcnt(8)
 ds_read_b64_tr_b16 a[12:13],v23 offset:6144
 v_mul_f32 v121,s58,v121
 v_mfma_f32_16x16x32_bf16 v[208:211],a[128:131],a[200:203],v[208:211]
 ds_read_b64_tr_b16 a[14:15],v23 offset:6912
 v_mul_f32 v122,s58,v122
 v_mul_f32 v123,s58,v123
 v_mfma_f32_16x16x32_bf16 v[208:211],a[132:135],a[204:207],v[208:211]
 buffer_load_dwordx4 v20,s[24:27],s20 offen offset:0 lds
 v_mul_f32 v124,s58,v124
 v_mfma_f32_16x16x32_bf16 v[212:215],a[136:139],a[200:203],v[212:215]
 ds_read_b128 a[192:195],v4 offset:12288
 ds_read_b64_tr_b16 a[16:17],v22 offset:64
 v_mul_f32 v125,s58,v125
 v_mfma_f32_16x16x32_bf16 v[212:215],a[140:143],a[204:207],v[212:215]
 ds_read_b128 a[196:199],v5 offset:12288
 ds_read_b64_tr_b16 a[18:19],v22 offset:832
 v_mul_f32 v126,s58,v126
 v_mfma_f32_16x16x32_bf16 v[216:219],a[144:147],a[200:203],v[216:219]
 s_add_u32 s24,s24,128
 s_addc_u32 s25,s25,0
 v_mul_f32 v127,s58,v127
 v_mfma_f32_16x16x32_bf16 v[216:219],a[148:151],a[204:207],v[216:219]
 ds_read_b64_tr_b16 a[20:21],v22 offset:6208
 v_cvt_pk_bf16_f32 v120,v120,v121
 v_cvt_pk_bf16_f32 v121,v122,v123
 v_mfma_f32_16x16x32_bf16 v[220:223],a[152:155],a[200:203],v[220:223]
 ds_read_b64_tr_b16 a[22:23],v22 offset:6976
 s_add_u32 s60,s56,17408
 v_cvt_pk_bf16_f32 v122,v124,v125
 v_mfma_f32_16x16x32_bf16 v[220:223],a[156:159],a[204:207],v[220:223]
 ds_read_b64_tr_b16 a[24:25],v23 offset:64
 v_cvt_pk_bf16_f32 v123,v126,v127
 v_mfma_f32_16x16x32_bf16 v[224:227],a[160:163],a[200:203],v[224:227]
 s_sub_u32 s26,s26,128
 ds_read_b64_tr_b16 a[26:27],v23 offset:832
 v_mfma_f32_16x16x32_bf16 v[224:227],a[164:167],a[204:207],v[224:227]
 buffer_store_dwordx4 v[120:123],v1,s[28:31],s60 offen sc1
 v_mul_f32 v128,s58,v128
 v_mfma_f32_16x16x32_bf16 v[228:231],a[168:171],a[200:203],v[228:231]
 ds_read_b64_tr_b16 a[28:29],v23 offset:6208
 v_mul_f32 v129,s58,v129
 v_mul_f32 v130,s58,v130
 v_mfma_f32_16x16x32_bf16 v[228:231],a[172:175],a[204:207],v[228:231]
 ds_read_b64_tr_b16 a[30:31],v23 offset:6976
 v_mul_f32 v131,s58,v131
 v_mul_f32 v132,s58,v132
 v_mfma_f32_16x16x32_bf16 v[232:235],a[176:179],a[200:203],v[232:235]
 s_add_u32 s72,s72,172032
 s_addc_u32 s73,s73,0
 v_mul_f32 v133,s58,v133
 v_mfma_f32_16x16x32_bf16 v[232:235],a[180:183],a[204:207],v[232:235]
 ds_read_b64_tr_b16 a[32:33],v22 offset:128
 v_mul_f32 v134,s58,v134
 v_mul_f32 v135,s58,v135
 v_mfma_f32_16x16x32_bf16 v[236:239],a[184:187],a[200:203],v[236:239]
 ds_read_b64_tr_b16 a[34:35],v22 offset:896
 v_cvt_pk_bf16_f32 v128,v128,v129
 v_cvt_pk_bf16_f32 v129,v130,v131
 v_mfma_f32_16x16x32_bf16 v[236:239],a[188:191],a[204:207],v[236:239]
 s_waitcnt lgkmcnt(9)
 ds_read_b64_tr_b16 a[36:37],v22 offset:6272
 s_add_u32 s60,s56,18432
 v_mfma_f32_16x16x32_bf16 v[240:243],a[128:131],a[192:195],v[240:243]
 s_sub_u32 s74,s74,172032
 v_cvt_pk_bf16_f32 v130,v132,v133
 v_cvt_pk_bf16_f32 v131,v134,v135
 v_mfma_f32_16x16x32_bf16 v[240:243],a[132:135],a[196:199],v[240:243]
 ds_read_b128 a[200:203],v4 offset:14336
 ds_read_b64_tr_b16 a[38:39],v22 offset:7040
 v_mfma_f32_16x16x32_bf16 v[244:247],a[136:139],a[192:195],v[244:247]
 buffer_store_dwordx4 v[128:131],v1,s[28:31],s60 offen sc1
 ds_read_b64_tr_b16 a[40:41],v23 offset:128
 v_mfma_f32_16x16x32_bf16 v[244:247],a[140:143],a[196:199],v[244:247]
 ds_read_b128 a[204:207],v5 offset:14336
 ds_read_b64_tr_b16 a[42:43],v23 offset:896
 v_mul_f32 v136,s58,v136
 v_mfma_f32_16x16x32_bf16 v[248:251],a[144:147],a[192:195],v[248:251]
 v_mul_f32 v137,s58,v137
 v_mul_f32 v138,s58,v138
 v_mul_f32 v139,s58,v139
 v_mfma_f32_16x16x32_bf16 v[248:251],a[148:151],a[196:199],v[248:251]
 ds_read_b64_tr_b16 a[44:45],v23 offset:6272
 v_mul_f32 v140,s58,v140
 v_mul_f32 v141,s58,v141
 v_mfma_f32_16x16x32_bf16 v[252:255],a[152:155],a[192:195],v[252:255]
 ds_read_b64_tr_b16 a[46:47],v23 offset:7040
 v_mul_f32 v142,s58,v142
 v_mul_f32 v143,s58,v143
 v_mfma_f32_16x16x32_bf16 v[252:255],a[156:159],a[196:199],v[252:255]
 v_cvt_pk_bf16_f32 v136,v136,v137
 v_cvt_pk_bf16_f32 v137,v138,v139
 s_add_u32 s60,s56,19456
 v_mfma_f32_16x16x32_bf16 a[208:211],a[160:163],a[192:195],a[208:211]
 v_cvt_pk_bf16_f32 v138,v140,v141
 v_cvt_pk_bf16_f32 v139,v142,v143
 v_mfma_f32_16x16x32_bf16 a[208:211],a[164:167],a[196:199],a[208:211]
 buffer_store_dwordx4 v[136:139],v1,s[28:31],s60 offen sc1
 v_mul_f32 v144,s58,v144
 v_mfma_f32_16x16x32_bf16 a[212:215],a[168:171],a[192:195],a[212:215]
 v_mul_f32 v145,s58,v145
 v_mul_f32 v146,s58,v146
 v_mul_f32 v147,s58,v147
 v_mfma_f32_16x16x32_bf16 a[212:215],a[172:175],a[196:199],a[212:215]
 v_mul_f32 v148,s58,v148
 v_mul_f32 v149,s58,v149
 v_mul_f32 v150,s58,v150
 v_mfma_f32_16x16x32_bf16 a[216:219],a[176:179],a[192:195],a[216:219]
 v_mul_f32 v151,s58,v151
 v_cvt_pk_bf16_f32 v144,v144,v145
 v_cvt_pk_bf16_f32 v145,v146,v147
 v_mfma_f32_16x16x32_bf16 a[216:219],a[180:183],a[196:199],a[216:219]
 s_add_u32 s60,s56,24576
 v_cvt_pk_bf16_f32 v146,v148,v149
 v_cvt_pk_bf16_f32 v147,v150,v151
 v_mfma_f32_16x16x32_bf16 a[220:223],a[184:187],a[192:195],a[220:223]
 buffer_store_dwordx4 v[144:147],v1,s[28:31],s60 offen sc1
 v_mul_f32 v152,s58,v152
 v_mfma_f32_16x16x32_bf16 a[220:223],a[188:191],a[196:199],a[220:223]
 s_waitcnt lgkmcnt(0)
 s_barrier
 v_mul_f32 v153,s58,v153
 v_mfma_f32_16x16x32_bf16 a[224:227],a[128:131],a[200:203],a[224:227]
 s_add_u32 m0,s53,53248
 v_mul_f32 v154,s58,v154
 v_mul_f32 v155,s58,v155
 v_mfma_f32_16x16x32_bf16 a[224:227],a[132:135],a[204:207],a[224:227]
 buffer_load_dwordx4 v38,s[72:75],0 offen offset:0 lds
 v_mul_f32 v156,s58,v156
 v_mfma_f32_16x16x32_bf16 a[228:231],a[136:139],a[200:203],a[228:231]
 buffer_load_dwordx4 v39,s[72:75],0 offen offset:1024 lds
 v_mul_f32 v157,s58,v157
 v_mfma_f32_16x16x32_bf16 a[228:231],a[140:143],a[204:207],a[228:231]
 buffer_load_dwordx4 v40,s[72:75],0 offen offset:2048 lds
 v_mul_f32 v158,s58,v158
 v_mfma_f32_16x16x32_bf16 a[232:235],a[144:147],a[200:203],a[232:235]
 s_add_u32 m0,s52,16384
 v_mul_f32 v159,s58,v159
 v_cvt_pk_bf16_f32 v152,v152,v153
 v_mfma_f32_16x16x32_bf16 a[232:235],a[148:151],a[204:207],a[232:235]
 buffer_load_dwordx4 v20,s[24:27],s12 offen offset:0 lds
 v_cvt_pk_bf16_f32 v153,v154,v155
 v_mfma_f32_16x16x32_bf16 a[236:239],a[152:155],a[200:203],a[236:239]
 s_add_u32 s60,s56,25600
 v_cvt_pk_bf16_f32 v154,v156,v157
 v_cvt_pk_bf16_f32 v155,v158,v159
 v_mfma_f32_16x16x32_bf16 a[236:239],a[156:159],a[204:207],a[236:239]
 buffer_store_dwordx4 v[152:155],v1,s[28:31],s60 offen sc1
 s_add_u32 m0,s52,17408
 v_mfma_f32_16x16x32_bf16 a[240:243],a[160:163],a[200:203],a[240:243]
 v_mul_f32 v160,s58,v160
 v_mul_f32 v161,s58,v161
 v_mul_f32 v162,s58,v162
 v_mfma_f32_16x16x32_bf16 a[240:243],a[164:167],a[204:207],a[240:243]
 v_mul_f32 v163,s58,v163
 v_mul_f32 v164,s58,v164
 v_mul_f32 v165,s58,v165
 v_mfma_f32_16x16x32_bf16 a[244:247],a[168:171],a[200:203],a[244:247]
 buffer_load_dwordx4 v21,s[24:27],s13 offen offset:0 lds
 v_mul_f32 v166,s58,v166
 v_mfma_f32_16x16x32_bf16 a[244:247],a[172:175],a[204:207],a[244:247]
 s_add_u32 m0,s52,18432
 v_mul_f32 v167,s58,v167
 v_cvt_pk_bf16_f32 v160,v160,v161
 v_mfma_f32_16x16x32_bf16 a[248:251],a[176:179],a[200:203],a[248:251]
 buffer_load_dwordx4 v20,s[24:27],s14 offen offset:0 lds
 v_cvt_pk_bf16_f32 v161,v162,v163
 v_mfma_f32_16x16x32_bf16 a[248:251],a[180:183],a[204:207],a[248:251]
 s_add_u32 m0,s52,19456
 s_add_u32 s60,s56,26624
 v_cvt_pk_bf16_f32 v162,v164,v165
 v_mfma_f32_16x16x32_bf16 a[252:255],a[184:187],a[200:203],a[252:255]
 buffer_load_dwordx4 v21,s[24:27],s15 offen offset:0 lds
 v_cvt_pk_bf16_f32 v163,v166,v167
 v_mfma_f32_16x16x32_bf16 a[252:255],a[188:191],a[204:207],a[252:255]
 buffer_store_dwordx4 v[160:163],v1,s[28:31],s60 offen sc1
 v_mul_f32 v168,s58,v168
 v_mfma_f32_16x16x32_bf16 v[48:51],a[16:19],a[48:51],0
 s_waitcnt vmcnt(13)
 s_barrier
 v_mul_f32 v169,s58,v169
 v_mul_f32 v170,s58,v170
 v_mul_f32 v171,s58,v171
 v_mfma_f32_16x16x32_bf16 v[48:51],a[20:23],a[52:55],v[48:51]
 s_add_u32 s61,s51,114688
 s_add_u32 m0,s52,20480
 v_mul_f32 v172,s58,v172
 v_mul_f32 v173,s58,v173
 v_mul_f32 v174,s58,v174
 v_mfma_f32_16x16x32_bf16 v[52:55],a[24:27],a[48:51],0
 v_add_u32 v35,s61,v2
 v_mul_f32 v175,s58,v175
 v_cvt_pk_bf16_f32 v168,v168,v169
 v_cvt_pk_bf16_f32 v169,v170,v171
 s_add_u32 s60,s56,27648
 v_mfma_f32_16x16x32_bf16 v[52:55],a[28:31],a[52:55],v[52:55]
 buffer_load_dwordx4 v20,s[24:27],s16 offen offset:0 lds
 v_cvt_pk_bf16_f32 v170,v172,v173
 v_cvt_pk_bf16_f32 v171,v174,v175
 v_mfma_f32_16x16x32_bf16 v[56:59],a[48:51],a[32:35],0
 buffer_store_dwordx4 v[168:171],v1,s[28:31],s60 offen sc1
 v_add_u32 v36,s61,v3
 s_add_u32 m0,s52,21504
 v_mul_f32 v176,s58,v176
 v_mfma_f32_16x16x32_bf16 v[56:59],a[52:55],a[36:39],v[56:59]
 v_add_u32 v22,0x25000,v41
 v_add_u32 v23,0x25000,v42
 v_mul_f32 v177,s58,v177
 v_mul_f32 v178,s58,v178
 v_mul_f32 v179,s58,v179
 v_mfma_f32_16x16x32_bf16 v[60:63],a[48:51],a[40:43],0
 ds_read_b128 a[136:139],v35 offset:0
 v_mul_f32 v180,s58,v180
 v_mul_f32 v181,s58,v181
 v_mul_f32 v182,s58,v182
 v_mul_f32 v183,s58,v183
 v_mfma_f32_16x16x32_bf16 v[60:63],a[52:55],a[44:47],v[60:63]
 buffer_load_dwordx4 v21,s[24:27],s17 offen offset:0 lds
 v_cvt_pk_bf16_f32 v176,v176,v177
 v_cvt_pk_bf16_f32 v177,v178,v179
 s_add_u32 s60,s56,32768
 v_mfma_f32_16x16x32_bf16 v[64:67],a[16:19],a[56:59],0
 s_add_u32 m0,s52,22528
 ds_read_b128 a[140:143],v36 offset:0
 v_cvt_pk_bf16_f32 v178,v180,v181
 v_cvt_pk_bf16_f32 v179,v182,v183
 v_mfma_f32_16x16x32_bf16 v[64:67],a[20:23],a[60:63],v[64:67]
 buffer_store_dwordx4 v[176:179],v1,s[28:31],s60 offen sc1
 buffer_load_dwordx4 v20,s[24:27],s18 offen offset:0 lds
 v_mul_f32 v184,s58,v184
 v_mfma_f32_16x16x32_bf16 v[68:71],a[24:27],a[56:59],0
 ds_read_b128 a[144:147],v35 offset:2048
 s_add_u32 m0,s52,23552
 v_mul_f32 v185,s58,v185
 v_mul_f32 v186,s58,v186
 v_mul_f32 v187,s58,v187
 v_mfma_f32_16x16x32_bf16 v[68:71],a[28:31],a[60:63],v[68:71]
 ds_read_b128 a[148:151],v36 offset:2048
 ds_read_b128 a[152:155],v35 offset:4096
 v_mul_f32 v188,s58,v188
 v_mul_f32 v189,s58,v189
 v_mul_f32 v190,s58,v190
 v_mfma_f32_16x16x32_bf16 v[72:75],a[56:59],a[32:35],0
 buffer_load_dwordx4 v21,s[24:27],s19 offen offset:0 lds
 v_mul_f32 v191,s58,v191
 v_cvt_pk_bf16_f32 v184,v184,v185
 v_cvt_pk_bf16_f32 v185,v186,v187
 v_mfma_f32_16x16x32_bf16 v[72:75],a[60:63],a[36:39],v[72:75]
 s_add_u32 m0,s52,24576
 ds_read_b128 a[156:159],v36 offset:4096
 s_add_u32 s60,s56,33792
 v_cvt_pk_bf16_f32 v186,v188,v189
 v_cvt_pk_bf16_f32 v187,v190,v191
 v_mfma_f32_16x16x32_bf16 v[76:79],a[56:59],a[40:43],0
 buffer_store_dwordx4 v[184:187],v1,s[28:31],s60 offen sc1
 buffer_load_dwordx4 v20,s[24:27],s20 offen offset:0 lds
 v_mul_f32 v192,s58,v192
 v_mfma_f32_16x16x32_bf16 v[76:79],a[60:63],a[44:47],v[76:79]
 ds_read_b128 a[160:163],v35 offset:6144
 ds_read_b128 a[164:167],v36 offset:6144
 v_mul_f32 v193,s58,v193
 v_mul_f32 v194,s58,v194
 v_mul_f32 v195,s58,v195
 v_mfma_f32_16x16x32_bf16 v[80:83],a[0:3],a[56:59],0
 s_add_u32 s24,s24,128
 s_addc_u32 s25,s25,0
 v_mul_f32 v196,s58,v196
 v_mul_f32 v197,s58,v197
 v_mul_f32 v198,s58,v198
 v_mfma_f32_16x16x32_bf16 v[80:83],a[4:7],a[60:63],v[80:83]
 s_sub_u32 s26,s26,128
 ds_read_b128 a[168:171],v35 offset:8192
 v_mul_f32 v199,s58,v199
 v_cvt_pk_bf16_f32 v192,v192,v193
 v_cvt_pk_bf16_f32 v193,v194,v195
 v_mfma_f32_16x16x32_bf16 v[84:87],a[8:11],a[56:59],0
 ds_read_b128 a[172:175],v36 offset:8192
 ds_read_b64_tr_b16 a[88:89],v22 offset:0
 s_add_u32 s60,s56,34816
 v_cvt_pk_bf16_f32 v194,v196,v197
 v_cvt_pk_bf16_f32 v195,v198,v199
 v_mfma_f32_16x16x32_bf16 v[84:87],a[12:15],a[60:63],v[84:87]
 buffer_store_dwordx4 v[192:195],v1,s[28:31],s60 offen sc1
 s_add_u32 s72,s72,172032
 s_addc_u32 s73,s73,0
 v_mul_f32 v200,s58,v200
 v_mfma_f32_16x16x32_bf16 v[88:91],a[16:19],a[64:67],0
 s_sub_u32 s74,s74,172032
 ds_read_b64_tr_b16 a[90:91],v22 offset:768
 v_mul_f32 v201,s58,v201
 v_mul_f32 v202,s58,v202
 v_mul_f32 v203,s58,v203
 v_mfma_f32_16x16x32_bf16 v[88:91],a[20:23],a[68:71],v[88:91]
 s_add_u32 m0,s53,102400
 ds_read_b64_tr_b16 a[92:93],v22 offset:6144
 v_mul_f32 v204,s58,v204
 v_mul_f32 v205,s58,v205
 v_mul_f32 v206,s58,v206
 v_mfma_f32_16x16x32_bf16 v[92:95],a[24:27],a[64:67],0
 buffer_load_dwordx4 v38,s[72:75],0 offen offset:0 lds
 v_mul_f32 v207,s58,v207
 v_cvt_pk_bf16_f32 v200,v200,v201
 v_cvt_pk_bf16_f32 v201,v202,v203
 v_mfma_f32_16x16x32_bf16 v[92:95],a[28:31],a[68:71],v[92:95]
 ds_read_b64_tr_b16 a[94:95],v22 offset:6912
 ds_read_b64_tr_b16 a[96:97],v23 offset:0
 s_add_u32 s60,s56,35840
 v_cvt_pk_bf16_f32 v202,v204,v205
 v_cvt_pk_bf16_f32 v203,v206,v207
 v_mfma_f32_16x16x32_bf16 v[96:99],a[64:67],a[32:35],0
 buffer_store_dwordx4 v[200:203],v1,s[28:31],s60 offen sc1
 buffer_load_dwordx4 v39,s[72:75],0 offen offset:1024 lds
 v_mul_f32 v208,s58,v208
 v_mfma_f32_16x16x32_bf16 v[96:99],a[68:71],a[36:39],v[96:99]
 ds_read_b64_tr_b16 a[98:99],v23 offset:768
 ds_read_b64_tr_b16 a[100:101],v23 offset:6144
 v_mul_f32 v209,s58,v209
 v_mul_f32 v210,s58,v210
 v_mul_f32 v211,s58,v211
 v_mfma_f32_16x16x32_bf16 v[100:103],a[64:67],a[40:43],0
 ds_read_b64_tr_b16 a[102:103],v23 offset:6912
 ds_read_b64_tr_b16 a[104:105],v22 offset:64
 v_mul_f32 v212,s58,v212
 v_mul_f32 v213,s58,v213
 v_mul_f32 v214,s58,v214
 v_mfma_f32_16x16x32_bf16 v[100:103],a[68:71],a[44:47],v[100:103]
 buffer_load_dwordx4 v40,s[72:75],0 offen offset:2048 lds
 v_mul_f32 v215,s58,v215
 v_cvt_pk_bf16_f32 v208,v208,v209
 v_cvt_pk_bf16_f32 v209,v210,v211
 v_mfma_f32_16x16x32_bf16 v[104:107],a[0:3],a[64:67],0
 s_add_u32 m0,s52,65536
 ds_read_b64_tr_b16 a[106:107],v22 offset:832
 s_add_u32 s60,s56,40960
 v_cvt_pk_bf16_f32 v210,v212,v213
 v_cvt_pk_bf16_f32 v211,v214,v215
 v_mfma_f32_16x16x32_bf16 v[104:107],a[4:7],a[68:71],v[104:107]
 buffer_store_dwordx4 v[208:211],v1,s[28:31],s60 offen sc1
 buffer_load_dwordx4 v20,s[24:27],s12 offen offset:0 lds
 v_mul_f32 v216,s58,v216
 v_mfma_f32_16x16x32_bf16 v[108:111],a[8:11],a[64:67],0
 s_add_u32 m0,s52,66560
 ds_read_b64_tr_b16 a[108:109],v22 offset:6208
 v_mul_f32 v217,s58,v217
 v_mul_f32 v218,s58,v218
 v_mul_f32 v219,s58,v219
 v_mfma_f32_16x16x32_bf16 v[108:111],a[12:15],a[68:71],v[108:111]
 ds_read_b64_tr_b16 a[110:111],v22 offset:6976
 ds_read_b64_tr_b16 a[112:113],v23 offset:64
 v_mul_f32 v220,s58,v220
 v_mul_f32 v221,s58,v221
 v_mul_f32 v222,s58,v222
 v_mfma_f32_16x16x32_bf16 v[112:115],a[16:19],a[72:75],0
 buffer_load_dwordx4 v21,s[24:27],s13 offen offset:0 lds
 v_mul_f32 v223,s58,v223
 v_cvt_pk_bf16_f32 v216,v216,v217
 v_cvt_pk_bf16_f32 v217,v218,v219
 v_mfma_f32_16x16x32_bf16 v[112:115],a[20:23],a[76:79],v[112:115]
 s_add_u32 m0,s52,67584
 ds_read_b64_tr_b16 a[114:115],v23 offset:832
 s_add_u32 s60,s56,41984
 v_cvt_pk_bf16_f32 v218,v220,v221
 v_cvt_pk_bf16_f32 v219,v222,v223
 v_mfma_f32_16x16x32_bf16 v[116:119],a[24:27],a[72:75],0
 buffer_store_dwordx4 v[216:219],v1,s[28:31],s60 offen sc1
 buffer_load_dwordx4 v20,s[24:27],s14 offen offset:0 lds
 v_mul_f32 v224,s58,v224
 v_mfma_f32_16x16x32_bf16 v[116:119],a[28:31],a[76:79],v[116:119]
 s_add_u32 m0,s52,68608
 ds_read_b64_tr_b16 a[116:117],v23 offset:6208
 v_mul_f32 v225,s58,v225
 v_mul_f32 v226,s58,v226
 v_mul_f32 v227,s58,v227
 v_mfma_f32_16x16x32_bf16 v[120:123],a[72:75],a[32:35],0
 ds_read_b64_tr_b16 a[118:119],v23 offset:6976
 ds_read_b64_tr_b16 a[120:121],v22 offset:128
 v_mul_f32 v228,s58,v228
 v_mul_f32 v229,s58,v229
 v_mul_f32 v230,s58,v230
 v_mfma_f32_16x16x32_bf16 v[120:123],a[76:79],a[36:39],v[120:123]
 buffer_load_dwordx4 v21,s[24:27],s15 offen offset:0 lds
 v_mul_f32 v231,s58,v231
 v_cvt_pk_bf16_f32 v224,v224,v225
 v_cvt_pk_bf16_f32 v225,v226,v227
 v_mfma_f32_16x16x32_bf16 v[124:127],a[72:75],a[40:43],0
 s_add_u32 m0,s52,69632
 ds_read_b64_tr_b16 a[122:123],v22 offset:896
 s_add_u32 s60,s56,43008
 v_cvt_pk_bf16_f32 v226,v228,v229
 v_cvt_pk_bf16_f32 v227,v230,v231
 v_mfma_f32_16x16x32_bf16 v[124:127],a[76:79],a[44:47],v[124:127]
 buffer_store_dwordx4 v[224:227],v1,s[28:31],s60 offen sc1
 buffer_load_dwordx4 v20,s[24:27],s16 offen offset:0 lds
 v_mul_f32 v232,s58,v232
 v_mfma_f32_16x16x32_bf16 v[128:131],a[0:3],a[72:75],0
 ds_read_b64_tr_b16 a[124:125],v22 offset:6272
 s_add_u32 m0,s52,70656
 v_mul_f32 v233,s58,v233
 v_mul_f32 v234,s58,v234
 v_mul_f32 v235,s58,v235
 v_mfma_f32_16x16x32_bf16 v[128:131],a[4:7],a[76:79],v[128:131]
 ds_read_b64_tr_b16 a[126:127],v22 offset:7040
 ds_read_b64_tr_b16 a[128:129],v23 offset:128
 v_mul_f32 v236,s58,v236
 v_mul_f32 v237,s58,v237
 v_mul_f32 v238,s58,v238
 v_mfma_f32_16x16x32_bf16 v[132:135],a[8:11],a[72:75],0
 buffer_load_dwordx4 v21,s[24:27],s17 offen offset:0 lds
 v_mul_f32 v239,s58,v239
 v_cvt_pk_bf16_f32 v232,v232,v233
 v_cvt_pk_bf16_f32 v233,v234,v235
 v_mfma_f32_16x16x32_bf16 v[132:135],a[12:15],a[76:79],v[132:135]
 s_add_u32 m0,s52,71680
 ds_read_b64_tr_b16 a[130:131],v23 offset:896
 s_add_u32 s60,s56,44032
 v_cvt_pk_bf16_f32 v234,v236,v237
 v_cvt_pk_bf16_f32 v235,v238,v239
 v_mfma_f32_16x16x32_bf16 v[136:139],a[16:19],a[80:83],0
 buffer_store_dwordx4 v[232:235],v1,s[28:31],s60 offen sc1
 buffer_load_dwordx4 v20,s[24:27],s18 offen offset:0 lds
 v_mul_f32 v240,s58,v240
 v_mfma_f32_16x16x32_bf16 v[136:139],a[20:23],a[84:87],v[136:139]
 ds_read_b64_tr_b16 a[132:133],v23 offset:6272
 s_add_u32 m0,s52,72704
 v_mul_f32 v241,s58,v241
 v_mul_f32 v242,s58,v242
 v_mul_f32 v243,s58,v243
 v_mfma_f32_16x16x32_bf16 v[140:143],a[24:27],a[80:83],0
 ds_read_b64_tr_b16 a[134:135],v23 offset:7040
 v_mul_f32 v244,s58,v244
 v_mul_f32 v245,s58,v245
 v_mul_f32 v246,s58,v246
 v_mul_f32 v247,s58,v247
 v_mfma_f32_16x16x32_bf16 v[140:143],a[28:31],a[84:87],v[140:143]
 buffer_load_dwordx4 v21,s[24:27],s19 offen offset:0 lds
 v_cvt_pk_bf16_f32 v240,v240,v241
 v_cvt_pk_bf16_f32 v241,v242,v243
 s_add_u32 s60,s56,49152
 v_mfma_f32_16x16x32_bf16 v[144:147],a[80:83],a[32:35],0
 s_add_u32 m0,s52,73728
 v_cvt_pk_bf16_f32 v242,v244,v245
 v_cvt_pk_bf16_f32 v243,v246,v247
 v_mfma_f32_16x16x32_bf16 v[144:147],a[84:87],a[36:39],v[144:147]
 buffer_store_dwordx4 v[240:243],v1,s[28:31],s60 offen sc1
 buffer_load_dwordx4 v20,s[24:27],s20 offen offset:0 lds
 v_mul_f32 v248,s58,v248
 v_mfma_f32_16x16x32_bf16 v[148:151],a[80:83],a[40:43],0
 s_add_u32 s24,s24,128
 s_addc_u32 s25,s25,0
 v_mul_f32 v249,s58,v249
 v_mul_f32 v250,s58,v250
 v_mul_f32 v251,s58,v251
 v_mfma_f32_16x16x32_bf16 v[148:151],a[84:87],a[44:47],v[148:151]
 s_sub_u32 s26,s26,128
 v_mul_f32 v252,s58,v252
 v_mul_f32 v253,s58,v253
 v_mul_f32 v254,s58,v254
 v_mul_f32 v255,s58,v255
 v_mfma_f32_16x16x32_bf16 v[152:155],a[0:3],a[80:83],0
 s_add_u32 s72,s72,172032
 s_addc_u32 s73,s73,0
 v_cvt_pk_bf16_f32 v248,v248,v249
 v_cvt_pk_bf16_f32 v249,v250,v251
 s_add_u32 s60,s56,50176
 v_mfma_f32_16x16x32_bf16 v[152:155],a[4:7],a[84:87],v[152:155]
 s_sub_u32 s74,s74,172032
 v_cvt_pk_bf16_f32 v250,v252,v253
 v_cvt_pk_bf16_f32 v251,v254,v255
 v_mfma_f32_16x16x32_bf16 v[156:159],a[8:11],a[80:83],0
 buffer_store_dwordx4 v[248:251],v1,s[28:31],s60 offen sc1
 v_accvgpr_read_b32 v176,a208
 v_accvgpr_read_b32 v177,a209
 v_accvgpr_read_b32 v178,a210
 v_mfma_f32_16x16x32_bf16 v[156:159],a[12:15],a[84:87],v[156:159]
 s_waitcnt lgkmcnt(0)
 v_accvgpr_read_b32 v179,a211
 v_accvgpr_read_b32 v180,a212
 v_accvgpr_read_b32 v181,a213
 v_accvgpr_read_b32 v182,a214
 v_mfma_f32_16x16x32_bf16 v[48:51],a[104:107],a[136:139],v[48:51]
 s_waitcnt vmcnt(20)
 s_barrier
 v_accvgpr_read_b32 v183,a215
 v_mul_f32 v176,s58,v176
 v_mul_f32 v177,s58,v177
 v_mfma_f32_16x16x32_bf16 v[48:51],a[108:111],a[140:143],v[48:51]
 s_add_u32 s61,s51,16384
 s_add_u32 m0,s53,151552
 v_mul_f32 v178,s58,v178
 v_mul_f32 v179,s58,v179
 v_mul_f32 v180,s58,v180
 v_mfma_f32_16x16x32_bf16 v[52:55],a[112:115],a[136:139],v[52:55]
 v_add_u32 v35,s61,v2
 v_mul_f32 v181,s58,v181
 v_mul_f32 v182,s58,v182
 v_mul_f32 v183,s58,v183
 v_cvt_pk_bf16_f32 v176,v176,v177
 v_mfma_f32_16x16x32_bf16 v[52:55],a[116:119],a[140:143],v[52:55]
 buffer_load_dwordx4 v38,s[72:75],0 offen offset:0 lds
 v_cvt_pk_bf16_f32 v177,v178,v179
 s_add_u32 s60,s56,51200
 v_cvt_pk_bf16_f32 v178,v180,v181
 v_mfma_f32_16x16x32_bf16 v[56:59],a[136:139],a[120:123],v[56:59]
 v_add_u32 v36,s61,v3
 v_add_u32 v22,0xd000,v41
 v_cvt_pk_bf16_f32 v179,v182,v183
 v_mfma_f32_16x16x32_bf16 v[56:59],a[140:143],a[124:127],v[56:59]
 buffer_store_dwordx4 v[176:179],v1,s[28:31],s60 offen sc1
 buffer_load_dwordx4 v39,s[72:75],0 offen offset:1024 lds
 v_accvgpr_read_b32 v184,a216
 v_mfma_f32_16x16x32_bf16 v[60:63],a[136:139],a[128:131],v[60:63]
 v_add_u32 v23,0xd000,v42
 v_accvgpr_read_b32 v185,a217
 v_accvgpr_read_b32 v186,a218
 v_accvgpr_read_b32 v187,a219
 v_accvgpr_read_b32 v188,a220
 v_mfma_f32_16x16x32_bf16 v[60:63],a[140:143],a[132:135],v[60:63]
 ds_read_b128 a[48:51],v35 offset:0
 ds_read_b128 a[52:55],v36 offset:0
 v_accvgpr_read_b32 v189,a221
 v_accvgpr_read_b32 v190,a222
 v_accvgpr_read_b32 v191,a223
 v_mfma_f32_16x16x32_bf16 v[64:67],a[104:107],a[144:147],v[64:67]
 buffer_load_dwordx4 v40,s[72:75],0 offen offset:2048 lds
 v_mul_f32 v184,s58,v184
 v_mul_f32 v185,s58,v185
 v_mul_f32 v186,s58,v186
 v_mfma_f32_16x16x32_bf16 v[64:67],a[108:111],a[148:151],v[64:67]
 ds_read_b128 a[56:59],v35 offset:2048
 s_add_u32 m0,s52,114688
 v_mul_f32 v187,s58,v187
 v_mul_f32 v188,s58,v188
 v_mul_f32 v189,s58,v189
 v_mfma_f32_16x16x32_bf16 v[68:71],a[112:115],a[144:147],v[68:71]
 ds_read_b128 a[60:63],v36 offset:2048
 ds_read_b128 a[64:67],v35 offset:4096
 v_mul_f32 v190,s58,v190
 v_mul_f32 v191,s58,v191
 v_cvt_pk_bf16_f32 v184,v184,v185
 v_mfma_f32_16x16x32_bf16 v[68:71],a[116:119],a[148:151],v[68:71]
 buffer_load_dwordx4 v20,s[24:27],s12 offen offset:0 lds
 v_cvt_pk_bf16_f32 v185,v186,v187
 s_add_u32 s60,s56,52224
 v_cvt_pk_bf16_f32 v186,v188,v189
 v_mfma_f32_16x16x32_bf16 v[72:75],a[144:147],a[120:123],v[72:75]
 ds_read_b128 a[68:71],v36 offset:4096
 v_cvt_pk_bf16_f32 v187,v190,v191
 v_mfma_f32_16x16x32_bf16 v[72:75],a[148:151],a[124:127],v[72:75]
 buffer_store_dwordx4 v[184:187],v1,s[28:31],s60 offen sc1
 s_add_u32 m0,s52,115712
 ds_read_b128 a[72:75],v35 offset:6144
 v_accvgpr_read_b32 v176,a224
 v_mfma_f32_16x16x32_bf16 v[76:79],a[144:147],a[128:131],v[76:79]
 ds_read_b128 a[76:79],v36 offset:6144
 v_accvgpr_read_b32 v177,a225
 v_accvgpr_read_b32 v178,a226
 v_accvgpr_read_b32 v179,a227
 v_accvgpr_read_b32 v180,a228
 v_mfma_f32_16x16x32_bf16 v[76:79],a[148:151],a[132:135],v[76:79]
 ds_read_b128 a[80:83],v35 offset:8192
 v_accvgpr_read_b32 v181,a229
 v_accvgpr_read_b32 v182,a230
 v_accvgpr_read_b32 v183,a231
 v_mul_f32 v176,s58,v176
 v_mfma_f32_16x16x32_bf16 v[80:83],a[88:91],a[144:147],v[80:83]
 buffer_load_dwordx4 v21,s[24:27],s13 offen offset:0 lds
 v_mul_f32 v177,s58,v177
 v_mul_f32 v178,s58,v178
 v_mul_f32 v179,s58,v179
 v_mfma_f32_16x16x32_bf16 v[80:83],a[92:95],a[148:151],v[80:83]
 ds_read_b128 a[84:87],v36 offset:8192
 s_add_u32 m0,s52,116736
 v_mul_f32 v180,s58,v180
 v_mul_f32 v181,s58,v181
 v_mul_f32 v182,s58,v182
 v_mfma_f32_16x16x32_bf16 v[84:87],a[96:99],a[144:147],v[84:87]
 ds_read_b64_tr_b16 a[0:1],v22 offset:0
 ds_read_b64_tr_b16 a[2:3],v22 offset:768
 v_mul_f32 v183,s58,v183
 v_cvt_pk_bf16_f32 v176,v176,v177
 v_cvt_pk_bf16_f32 v177,v178,v179
 v_mfma_f32_16x16x32_bf16 v[84:87],a[100:103],a[148:151],v[84:87]
 buffer_load_dwordx4 v20,s[24:27],s14 offen offset:0 lds
 s_add_u32 s60,s56,57344
 v_cvt_pk_bf16_f32 v178,v180,v181
 v_cvt_pk_bf16_f32 v179,v182,v183
 v_mfma_f32_16x16x32_bf16 v[88:91],a[104:107],a[152:155],v[88:91]
 buffer_store_dwordx4 v[176:179],v1,s[28:31],s60 offen sc1
 ds_read_b64_tr_b16 a[4:5],v22 offset:6144
 ds_read_b64_tr_b16 a[6:7],v22 offset:6912
 v_accvgpr_read_b32 v184,a232
 v_mfma_f32_16x16x32_bf16 v[88:91],a[108:111],a[156:159],v[88:91]
 s_add_u32 m0,s52,117760
 ds_read_b64_tr_b16 a[8:9],v23 offset:0
 v_accvgpr_read_b32 v185,a233
 v_accvgpr_read_b32 v186,a234
 v_accvgpr_read_b32 v187,a235
 v_mfma_f32_16x16x32_bf16 v[92:95],a[112:115],a[152:155],v[92:95]
 v_accvgpr_read_b32 v188,a236
 v_accvgpr_read_b32 v189,a237
 v_accvgpr_read_b32 v190,a238
 v_accvgpr_read_b32 v191,a239
 v_mul_f32 v184,s58,v184
 v_mfma_f32_16x16x32_bf16 v[92:95],a[116:119],a[156:159],v[92:95]
 buffer_load_dwordx4 v21,s[24:27],s15 offen offset:0 lds
 v_mul_f32 v185,s58,v185
 v_mul_f32 v186,s58,v186
 v_mul_f32 v187,s58,v187
 v_mfma_f32_16x16x32_bf16 v[96:99],a[152:155],a[120:123],v[96:99]
 ds_read_b64_tr_b16 a[10:11],v23 offset:768
 ds_read_b64_tr_b16 a[12:13],v23 offset:6144
 v_mul_f32 v188,s58,v188
 v_mul_f32 v189,s58,v189
 v_mul_f32 v190,s58,v190
 v_mfma_f32_16x16x32_bf16 v[96:99],a[156:159],a[124:127],v[96:99]
 s_add_u32 m0,s52,118784
 ds_read_b64_tr_b16 a[14:15],v23 offset:6912
 v_mul_f32 v191,s58,v191
 v_cvt_pk_bf16_f32 v184,v184,v185
 v_cvt_pk_bf16_f32 v185,v186,v187
 v_mfma_f32_16x16x32_bf16 v[100:103],a[152:155],a[128:131],v[100:103]
 ds_read_b64_tr_b16 a[16:17],v22 offset:64
 s_add_u32 s60,s56,58368
 v_cvt_pk_bf16_f32 v186,v188,v189
 v_cvt_pk_bf16_f32 v187,v190,v191
 v_mfma_f32_16x16x32_bf16 v[100:103],a[156:159],a[132:135],v[100:103]
 buffer_store_dwordx4 v[184:187],v1,s[28:31],s60 offen sc1
 buffer_load_dwordx4 v20,s[24:27],s16 offen offset:0 lds
 v_accvgpr_read_b32 v176,a240
 v_mfma_f32_16x16x32_bf16 v[104:107],a[88:91],a[152:155],v[104:107]
 ds_read_b64_tr_b16 a[18:19],v22 offset:832
 ds_read_b64_tr_b16 a[20:21],v22 offset:6208
 v_accvgpr_read_b32 v177,a241
 v_accvgpr_read_b32 v178,a242
 v_accvgpr_read_b32 v179,a243
 v_mfma_f32_16x16x32_bf16 v[104:107],a[92:95],a[156:159],v[104:107]
 s_add_u32 m0,s52,119808
 ds_read_b64_tr_b16 a[22:23],v22 offset:6976
 v_accvgpr_read_b32 v180,a244
 v_accvgpr_read_b32 v181,a245
 v_accvgpr_read_b32 v182,a246
 v_mfma_f32_16x16x32_bf16 v[108:111],a[96:99],a[152:155],v[108:111]
 ds_read_b64_tr_b16 a[24:25],v23 offset:64
 v_accvgpr_read_b32 v183,a247
 v_mul_f32 v176,s58,v176
 v_mul_f32 v177,s58,v177
 v_mul_f32 v178,s58,v178
 v_mfma_f32_16x16x32_bf16 v[108:111],a[100:103],a[156:159],v[108:111]
 buffer_load_dwordx4 v21,s[24:27],s17 offen offset:0 lds
 v_mul_f32 v179,s58,v179
 v_mul_f32 v180,s58,v180
 v_mul_f32 v181,s58,v181
 v_mfma_f32_16x16x32_bf16 v[112:115],a[104:107],a[160:163],v[112:115]
 ds_read_b64_tr_b16 a[26:27],v23 offset:832
 ds_read_b64_tr_b16 a[28:29],v23 offset:6208
 v_mul_f32 v182,s58,v182
 v_mul_f32 v183,s58,v183
 v_cvt_pk_bf16_f32 v176,v176,v177
 v_mfma_f32_16x16x32_bf16 v[112:115],a[108:111],a[164:167],v[112:115]
 s_add_u32 m0,s52,120832
 v_cvt_pk_bf16_f32 v177,v178,v179
 s_add_u32 s60,s56,59392
 v_cvt_pk_bf16_f32 v178,v180,v181
 v_cvt_pk_bf16_f32 v179,v182,v183
 v_mfma_f32_16x16x32_bf16 v[116:119],a[112:115],a[160:163],v[116:119]
 buffer_store_dwordx4 v[176:179],v1,s[28:31],s60 offen sc1
 ds_read_b64_tr_b16 a[30:31],v23 offset:6976
 v_accvgpr_read_b32 v184,a248
 v_accvgpr_read_b32 v185,a249
 v_mfma_f32_16x16x32_bf16 v[116:119],a[116:119],a[164:167],v[116:119]
 ds_read_b64_tr_b16 a[32:33],v22 offset:128
 v_accvgpr_read_b32 v186,a250
 v_accvgpr_read_b32 v187,a251
 v_accvgpr_read_b32 v188,a252
 v_accvgpr_read_b32 v189,a253
 v_mfma_f32_16x16x32_bf16 v[120:123],a[160:163],a[120:123],v[120:123]
 ds_read_b64_tr_b16 a[34:35],v22 offset:896
 v_accvgpr_read_b32 v190,a254
 v_accvgpr_read_b32 v191,a255
 v_mul_f32 v184,s58,v184
 v_mul_f32 v185,s58,v185
 v_mfma_f32_16x16x32_bf16 v[120:123],a[164:167],a[124:127],v[120:123]
 buffer_load_dwordx4 v20,s[24:27],s18 offen offset:0 lds
 v_mul_f32 v186,s58,v186
 v_mul_f32 v187,s58,v187
 v_mul_f32 v188,s58,v188
 v_mfma_f32_16x16x32_bf16 v[124:127],a[160:163],a[128:131],v[124:127]
 s_add_u32 m0,s52,121856
 ds_read_b64_tr_b16 a[36:37],v22 offset:6272
 v_mul_f32 v189,s58,v189
 v_mul_f32 v190,s58,v190
 v_mul_f32 v191,s58,v191
 v_mfma_f32_16x16x32_bf16 v[124:127],a[164:167],a[132:135],v[124:127]
 ds_read_b64_tr_b16 a[38:39],v22 offset:7040
 ds_read_b64_tr_b16 a[40:41],v23 offset:128
 v_cvt_pk_bf16_f32 v184,v184,v185
 v_cvt_pk_bf16_f32 v185,v186,v187
 s_add_u32 s60,s56,60416
 v_mfma_f32_16x16x32_bf16 v[128:131],a[88:91],a[160:163],v[128:131]
 buffer_load_dwordx4 v21,s[24:27],s19 offen offset:0 lds
 v_cvt_pk_bf16_f32 v186,v188,v189
 v_cvt_pk_bf16_f32 v187,v190,v191
 v_mfma_f32_16x16x32_bf16 v[128:131],a[92:95],a[164:167],v[128:131]
 buffer_store_dwordx4 v[184:187],v1,s[28:31],s60 offen sc1
 ds_read_b64_tr_b16 a[42:43],v23 offset:896
 s_add_u32 m0,s52,122880
 v_mfma_f32_16x16x32_bf16 v[132:135],a[96:99],a[160:163],v[132:135]
 ds_read_b64_tr_b16 a[44:45],v23 offset:6272
 ds_read_b64_tr_b16 a[46:47],v23 offset:7040
 v_mfma_f32_16x16x32_bf16 v[132:135],a[100:103],a[164:167],v[132:135]
 v_mfma_f32_16x16x32_bf16 v[136:139],a[104:107],a[168:171],v[136:139]
 buffer_load_dwordx4 v20,s[24:27],s20 offen offset:0 lds
 v_mfma_f32_16x16x32_bf16 v[136:139],a[108:111],a[172:175],v[136:139]
 s_add_u32 s24,s24,128
 s_addc_u32 s25,s25,0
 v_mfma_f32_16x16x32_bf16 v[140:143],a[112:115],a[168:171],v[140:143]
 v_mfma_f32_16x16x32_bf16 v[140:143],a[116:119],a[172:175],v[140:143]
 s_sub_u32 s26,s26,128
 v_mfma_f32_16x16x32_bf16 v[144:147],a[168:171],a[120:123],v[144:147]
 v_mfma_f32_16x16x32_bf16 v[144:147],a[172:175],a[124:127],v[144:147]
 s_add_u32 s72,s72,172032
 s_addc_u32 s73,s73,0
 v_mfma_f32_16x16x32_bf16 v[148:151],a[168:171],a[128:131],v[148:151]
 v_mfma_f32_16x16x32_bf16 v[148:151],a[172:175],a[132:135],v[148:151]
 s_sub_u32 s74,s74,172032
 v_mfma_f32_16x16x32_bf16 v[152:155],a[88:91],a[168:171],v[152:155]
 v_mfma_f32_16x16x32_bf16 v[152:155],a[92:95],a[172:175],v[152:155]
 v_mfma_f32_16x16x32_bf16 v[156:159],a[96:99],a[168:171],v[156:159]
 v_mfma_f32_16x16x32_bf16 v[156:159],a[100:103],a[172:175],v[156:159]
 s_waitcnt lgkmcnt(0)
 v_mfma_f32_16x16x32_bf16 v[48:51],a[16:19],a[48:51],v[48:51]
 s_waitcnt vmcnt(1)
 s_barrier
 s_cmp_eq_u32 s45,0
 s_cbranch_scc0 SIG_8
 s_add_u32 s62,s46,0
 s_lshl_b32 s62,s62,7
 s_add_u32 s62,s62,125829120
 v_mov_b32 v25,1
 v_mov_b32 v26,0
 s_mov_b64 exec,1
 buffer_atomic_add v25,v26,s[28:31],s62 offen sc1
 s_mov_b64 exec,-1
SIG_8:
 v_mfma_f32_16x16x32_bf16 v[48:51],a[20:23],a[52:55],v[48:51]
 s_add_u32 s61,s51,65536
 s_add_u32 m0,s53,53248
 v_mfma_f32_16x16x32_bf16 v[52:55],a[24:27],a[48:51],v[52:55]
 v_add_u32 v35,s61,v2
 v_mfma_f32_16x16x32_bf16 v[52:55],a[28:31],a[52:55],v[52:55]
 buffer_load_dwordx4 v38,s[72:75],0 offen offset:0 lds
 v_mfma_f32_16x16x32_bf16 v[56:59],a[48:51],a[32:35],v[56:59]
 v_add_u32 v36,s61,v3
 v_add_u32 v22,0x19000,v41
 v_mfma_f32_16x16x32_bf16 v[56:59],a[52:55],a[36:39],v[56:59]
 buffer_load_dwordx4 v39,s[72:75],0 offen offset:1024 lds
 v_mfma_f32_16x16x32_bf16 v[60:63],a[48:51],a[40:43],v[60:63]
 v_add_u32 v23,0x19000,v42
 v_mfma_f32_16x16x32_bf16 v[60:63],a[52:55],a[44:47],v[60:63]
 ds_read_b128 a[136:139],v35 offset:0
 ds_read_b128 a[140:143],v36 offset:0
 v_mfma_f32_16x16x32_bf16 v[64:67],a[16:19],a[56:59],v[64:67]
 buffer_load_dwordx4 v40,s[72:75],0 offen offset:2048 lds
 v_mfma_f32_16x16x32_bf16 v[64:67],a[20:23],a[60:63],v[64:67]
 ds_read_b128 a[144:147],v35 offset:2048
 s_add_u32 m0,s52,16384
 v_mfma_f32_16x16x32_bf16 v[68:71],a[24:27],a[56:59],v[68:71]
 ds_read_b128 a[148:151],v36 offset:2048
 ds_read_b128 a[152:155],v35 offset:4096
 v_mfma_f32_16x16x32_bf16 v[68:71],a[28:31],a[60:63],v[68:71]
 buffer_load_dwordx4 v20,s[24:27],s12 offen offset:0 lds
 v_mfma_f32_16x16x32_bf16 v[72:75],a[56:59],a[32:35],v[72:75]
 ds_read_b128 a[156:159],v36 offset:4096
 v_mfma_f32_16x16x32_bf16 v[72:75],a[60:63],a[36:39],v[72:75]
 s_add_u32 m0,s52,17408
 ds_read_b128 a[160:163],v35 offset:6144
 v_mfma_f32_16x16x32_bf16 v[76:79],a[56:59],a[40:43],v[76:79]
 ds_read_b128 a[164:167],v36 offset:6144
 v_mfma_f32_16x16x32_bf16 v[76:79],a[60:63],a[44:47],v[76:79]
 buffer_load_dwordx4 v21,s[24:27],s13 offen offset:0 lds
 v_mfma_f32_16x16x32_bf16 v[80:83],a[0:3],a[56:59],v[80:83]
 ds_read_b128 a[168:171],v35 offset:8192
 ds_read_b128 a[172:175],v36 offset:8192
 v_mfma_f32_16x16x32_bf16 v[80:83],a[4:7],a[60:63],v[80:83]
 s_add_u32 m0,s52,18432
 ds_read_b64_tr_b16 a[88:89],v22 offset:0
 v_mfma_f32_16x16x32_bf16 v[84:87],a[8:11],a[56:59],v[84:87]
 ds_read_b64_tr_b16 a[90:91],v22 offset:768
 v_mfma_f32_16x16x32_bf16 v[84:87],a[12:15],a[60:63],v[84:87]
 buffer_load_dwordx4 v20,s[24:27],s14 offen offset:0 lds
 v_mfma_f32_16x16x32_bf16 v[88:91],a[16:19],a[64:67],v[88:91]
 ds_read_b64_tr_b16 a[92:93],v22 offset:6144
 ds_read_b64_tr_b16 a[94:95],v22 offset:6912
 v_mfma_f32_16x16x32_bf16 v[88:91],a[20:23],a[68:71],v[88:91]
 s_add_u32 m0,s52,19456
 ds_read_b64_tr_b16 a[96:97],v23 offset:0
 v_mfma_f32_16x16x32_bf16 v[92:95],a[24:27],a[64:67],v[92:95]
 v_mfma_f32_16x16x32_bf16 v[92:95],a[28:31],a[68:71],v[92:95]
 buffer_load_dwordx4 v21,s[24:27],s15 offen offset:0 lds
 v_mfma_f32_16x16x32_bf16 v[96:99],a[64:67],a[32:35],v[96:99]
 ds_read_b64_tr_b16 a[98:99],v23 offset:768
 ds_read_b64_tr_b16 a[100:101],v23 offset:6144
 v_mfma_f32_16x16x32_bf16 v[96:99],a[68:71],a[36:39],v[96:99]
 s_add_u32 m0,s52,20480
 ds_read_b64_tr_b16 a[102:103],v23 offset:6912
 v_mfma_f32_16x16x32_bf16 v[100:103],a[64:67],a[40:43],v[100:103]
 ds_read_b64_tr_b16 a[104:105],v22 offset:64
 v_mfma_f32_16x16x32_bf16 v[100:103],a[68:71],a[44:47],v[100:103]
 buffer_load_dwordx4 v20,s[24:27],s16 offen offset:0 lds
 v_mfma_f32_16x16x32_bf16 v[104:107],a[0:3],a[64:67],v[104:107]
 ds_read_b64_tr_b16 a[106:107],v22 offset:832
 ds_read_b64_tr_b16 a[108:109],v22 offset:6208
 v_mfma_f32_16x16x32_bf16 v[104:107],a[4:7],a[68:71],v[104:107]
 s_add_u32 m0,s52,21504
 ds_read_b64_tr_b16 a[110:111],v22 offset:6976
 v_mfma_f32_16x16x32_bf16 v[108:111],a[8:11],a[64:67],v[108:111]
 ds_read_b64_tr_b16 a[112:113],v23 offset:64
 v_mfma_f32_16x16x32_bf16 v[108:111],a[12:15],a[68:71],v[108:111]
 buffer_load_dwordx4 v21,s[24:27],s17 offen offset:0 lds
 v_mfma_f32_16x16x32_bf16 v[112:115],a[16:19],a[72:75],v[112:115]
 ds_read_b64_tr_b16 a[114:115],v23 offset:832
 ds_read_b64_tr_b16 a[116:117],v23 offset:6208
 v_mfma_f32_16x16x32_bf16 v[112:115],a[20:23],a[76:79],v[112:115]
 s_add_u32 m0,s52,22528
 v_mfma_f32_16x16x32_bf16 v[116:119],a[24:27],a[72:75],v[116:119]
 ds_read_b64_tr_b16 a[118:119],v23 offset:6976
 v_mfma_f32_16x16x32_bf16 v[116:119],a[28:31],a[76:79],v[116:119]
 buffer_load_dwordx4 v20,s[24:27],s18 offen offset:0 lds
 v_mfma_f32_16x16x32_bf16 v[120:123],a[72:75],a[32:35],v[120:123]
 ds_read_b64_tr_b16 a[120:121],v22 offset:128
 ds_read_b64_tr_b16 a[122:123],v22 offset:896
 v_mfma_f32_16x16x32_bf16 v[120:123],a[76:79],a[36:39],v[120:123]
 s_add_u32 m0,s52,23552
 ds_read_b64_tr_b16 a[124:125],v22 offset:6272
 v_mfma_f32_16x16x32_bf16 v[124:127],a[72:75],a[40:43],v[124:127]
 ds_read_b64_tr_b16 a[126:127],v22 offset:7040
 v_mfma_f32_16x16x32_bf16 v[124:127],a[76:79],a[44:47],v[124:127]
 buffer_load_dwordx4 v21,s[24:27],s19 offen offset:0 lds
 v_mfma_f32_16x16x32_bf16 v[128:131],a[0:3],a[72:75],v[128:131]
 ds_read_b64_tr_b16 a[128:129],v23 offset:128
 ds_read_b64_tr_b16 a[130:131],v23 offset:896
 v_mfma_f32_16x16x32_bf16 v[128:131],a[4:7],a[76:79],v[128:131]
 s_add_u32 m0,s52,24576
 ds_read_b64_tr_b16 a[132:133],v23 offset:6272
 v_mfma_f32_16x16x32_bf16 v[132:135],a[8:11],a[72:75],v[132:135]
 ds_read_b64_tr_b16 a[134:135],v23 offset:7040
 v_mfma_f32_16x16x32_bf16 v[132:135],a[12:15],a[76:79],v[132:135]
 buffer_load_dwordx4 v20,s[24:27],s20 offen offset:0 lds
 v_mfma_f32_16x16x32_bf16 v[136:139],a[16:19],a[80:83],v[136:139]
 v_mfma_f32_16x16x32_bf16 v[136:139],a[20:23],a[84:87],v[136:139]
 s_add_u32 s24,s24,128
 s_addc_u32 s25,s25,0
 v_mfma_f32_16x16x32_bf16 v[140:143],a[24:27],a[80:83],v[140:143]
 v_mfma_f32_16x16x32_bf16 v[140:143],a[28:31],a[84:87],v[140:143]
 s_sub_u32 s26,s26,128
 v_mfma_f32_16x16x32_bf16 v[144:147],a[80:83],a[32:35],v[144:147]
 v_mfma_f32_16x16x32_bf16 v[144:147],a[84:87],a[36:39],v[144:147]
 s_add_u32 s72,s72,172032
 s_addc_u32 s73,s73,0
 v_mfma_f32_16x16x32_bf16 v[148:151],a[80:83],a[40:43],v[148:151]
 v_mfma_f32_16x16x32_bf16 v[148:151],a[84:87],a[44:47],v[148:151]
 s_sub_u32 s74,s74,172032
 v_mfma_f32_16x16x32_bf16 v[152:155],a[0:3],a[80:83],v[152:155]
 v_mfma_f32_16x16x32_bf16 v[152:155],a[4:7],a[84:87],v[152:155]
 v_mfma_f32_16x16x32_bf16 v[156:159],a[8:11],a[80:83],v[156:159]
 v_mfma_f32_16x16x32_bf16 v[156:159],a[12:15],a[84:87],v[156:159]
 s_waitcnt lgkmcnt(0)
 v_mfma_f32_16x16x32_bf16 v[48:51],a[104:107],a[136:139],v[48:51]
 s_waitcnt vmcnt(12)
 s_barrier
 v_mfma_f32_16x16x32_bf16 v[48:51],a[108:111],a[140:143],v[48:51]
 s_add_u32 s61,s51,114688
 s_add_u32 m0,s53,102400
 v_mfma_f32_16x16x32_bf16 v[52:55],a[112:115],a[136:139],v[52:55]
 v_add_u32 v35,s61,v2
 v_mfma_f32_16x16x32_bf16 v[52:55],a[116:119],a[140:143],v[52:55]
 buffer_load_dwordx4 v38,s[72:75],0 offen offset:0 lds
 v_mfma_f32_16x16x32_bf16 v[56:59],a[136:139],a[120:123],v[56:59]
 v_add_u32 v36,s61,v3
 v_add_u32 v22,0x25000,v41
 v_mfma_f32_16x16x32_bf16 v[56:59],a[140:143],a[124:127],v[56:59]
 buffer_load_dwordx4 v39,s[72:75],0 offen offset:1024 lds
 v_mfma_f32_16x16x32_bf16 v[60:63],a[136:139],a[128:131],v[60:63]
 v_add_u32 v23,0x25000,v42
 v_mfma_f32_16x16x32_bf16 v[60:63],a[140:143],a[132:135],v[60:63]
 ds_read_b128 a[48:51],v35 offset:0
 ds_read_b128 a[52:55],v36 offset:0
 v_mfma_f32_16x16x32_bf16 v[64:67],a[104:107],a[144:147],v[64:67]
 buffer_load_dwordx4 v40,s[72:75],0 offen offset:2048 lds
 v_mfma_f32_16x16x32_bf16 v[64:67],a[108:111],a[148:151],v[64:67]
 ds_read_b128 a[56:59],v35 offset:2048
 s_add_u32 m0,s52,65536
 v_mfma_f32_16x16x32_bf16 v[68:71],a[112:115],a[144:147],v[68:71]
 ds_read_b128 a[60:63],v36 offset:2048
 ds_read_b128 a[64:67],v35 offset:4096
 v_mfma_f32_16x16x32_bf16 v[68:71],a[116:119],a[148:151],v[68:71]
 buffer_load_dwordx4 v20,s[24:27],s12 offen offset:0 lds
 v_mfma_f32_16x16x32_bf16 v[72:75],a[144:147],a[120:123],v[72:75]
 ds_read_b128 a[68:71],v36 offset:4096
 v_mfma_f32_16x16x32_bf16 v[72:75],a[148:151],a[124:127],v[72:75]
 s_add_u32 m0,s52,66560
 ds_read_b128 a[72:75],v35 offset:6144
 v_mfma_f32_16x16x32_bf16 v[76:79],a[144:147],a[128:131],v[76:79]
 ds_read_b128 a[76:79],v36 offset:6144
 v_mfma_f32_16x16x32_bf16 v[76:79],a[148:151],a[132:135],v[76:79]
 buffer_load_dwordx4 v21,s[24:27],s13 offen offset:0 lds
 v_mfma_f32_16x16x32_bf16 v[80:83],a[88:91],a[144:147],v[80:83]
 ds_read_b128 a[80:83],v35 offset:8192
 ds_read_b128 a[84:87],v36 offset:8192
 v_mfma_f32_16x16x32_bf16 v[80:83],a[92:95],a[148:151],v[80:83]
 s_add_u32 m0,s52,67584
 ds_read_b64_tr_b16 a[0:1],v22 offset:0
 v_mfma_f32_16x16x32_bf16 v[84:87],a[96:99],a[144:147],v[84:87]
 ds_read_b64_tr_b16 a[2:3],v22 offset:768
 v_mfma_f32_16x16x32_bf16 v[84:87],a[100:103],a[148:151],v[84:87]
 buffer_load_dwordx4 v20,s[24:27],s14 offen offset:0 lds
 v_mfma_f32_16x16x32_bf16 v[88:91],a[104:107],a[152:155],v[88:91]
 ds_read_b64_tr_b16 a[4:5],v22 offset:6144
 ds_read_b64_tr_b16 a[6:7],v22 offset:6912
 v_mfma_f32_16x16x32_bf16 v[88:91],a[108:111],a[156:159],v[88:91]
 s_add_u32 m0,s52,68608
 ds_read_b64_tr_b16 a[8:9],v23 offset:0
 v_mfma_f32_16x16x32_bf16 v[92:95],a[112:115],a[152:155],v[92:95]
 v_mfma_f32_16x16x32_bf16 v[92:95],a[116:119],a[156:159],v[92:95]
 buffer_load_dwordx4 v21,s[24:27],s15 offen offset:0 lds
 v_mfma_f32_16x16x32_bf16 v[96:99],a[152:155],a[120:123],v[96:99]
 ds_read_b64_tr_b16 a[10:11],v23 offset:768
 ds_read_b64_tr_b16 a[12:13],v23 offset:6144
 v_mfma_f32_16x16x32_bf16 v[96:99],a[156:159],a[124:127],v[96:99]
 s_add_u32 m0,s52,69632
 ds_read_b64_tr_b16 a[14:15],v23 offset:6912
 v_mfma_f32_16x16x32_bf16 v[100:103],a[152:155],a[128:131],v[100:103]
 ds_read_b64_tr_b16 a[16:17],v22 offset:64
 v_mfma_f32_16x16x32_bf16 v[100:103],a[156:159],a[132:135],v[100:103]
 buffer_load_dwordx4 v20,s[24:27],s16 offen offset:0 lds
 v_mfma_f32_16x16x32_bf16 v[104:107],a[88:91],a[152:155],v[104:107]
 ds_read_b64_tr_b16 a[18:19],v22 offset:832
 ds_read_b64_tr_b16 a[20:21],v22 offset:6208
 v_mfma_f32_16x16x32_bf16 v[104:107],a[92:95],a[156:159],v[104:107]
 s_add_u32 m0,s52,70656
 ds_read_b64_tr_b16 a[22:23],v22 offset:6976
 v_mfma_f32_16x16x32_bf16 v[108:111],a[96:99],a[152:155],v[108:111]
 ds_read_b64_tr_b16 a[24:25],v23 offset:64
 v_mfma_f32_16x16x32_bf16 v[108:111],a[100:103],a[156:159],v[108:111]
 buffer_load_dwordx4 v21,s[24:27],s17 offen offset:0 lds
 v_mfma_f32_16x16x32_bf16 v[112:115],a[104:107],a[160:163],v[112:115]
 ds_read_b64_tr_b16 a[26:27],v23 offset:832
 ds_read_b64_tr_b16 a[28:29],v23 offset:6208
 v_mfma_f32_16x16x32_bf16 v[112:115],a[108:111],a[164:167],v[112:115]
 s_add_u32 m0,s52,71680
 v_mfma_f32_16x16x32_bf16 v[116:119],a[112:115],a[160:163],v[116:119]
 ds_read_b64_tr_b16 a[30:31],v23 offset:6976
 v_mfma_f32_16x16x32_bf16 v[116:119],a[116:119],a[164:167],v[116:119]
 buffer_load_dwordx4 v20,s[24:27],s18 offen offset:0 lds
 v_mfma_f32_16x16x32_bf16 v[120:123],a[160:163],a[120:123],v[120:123]
 ds_read_b64_tr_b16 a[32:33],v22 offset:128
 ds_read_b64_tr_b16 a[34:35],v22 offset:896
 v_mfma_f32_16x16x32_bf16 v[120:123],a[164:167],a[124:127],v[120:123]
 s_add_u32 m0,s52,72704
 ds_read_b64_tr_b16 a[36:37],v22 offset:6272
 v_mfma_f32_16x16x32_bf16 v[124:127],a[160:163],a[128:131],v[124:127]
 ds_read_b64_tr_b16 a[38:39],v22 offset:7040
 v_mfma_f32_16x16x32_bf16 v[124:127],a[164:167],a[132:135],v[124:127]
 buffer_load_dwordx4 v21,s[24:27],s19 offen offset:0 lds
 v_mfma_f32_16x16x32_bf16 v[128:131],a[88:91],a[160:163],v[128:131]
 ds_read_b64_tr_b16 a[40:41],v23 offset:128
 ds_read_b64_tr_b16 a[42:43],v23 offset:896
 v_mfma_f32_16x16x32_bf16 v[128:131],a[92:95],a[164:167],v[128:131]
 s_add_u32 m0,s52,73728
 ds_read_b64_tr_b16 a[44:45],v23 offset:6272
 v_mfma_f32_16x16x32_bf16 v[132:135],a[96:99],a[160:163],v[132:135]
 ds_read_b64_tr_b16 a[46:47],v23 offset:7040
 v_mfma_f32_16x16x32_bf16 v[132:135],a[100:103],a[164:167],v[132:135]
 buffer_load_dwordx4 v20,s[24:27],s20 offen offset:0 lds
 v_mfma_f32_16x16x32_bf16 v[136:139],a[104:107],a[168:171],v[136:139]
 v_mfma_f32_16x16x32_bf16 v[136:139],a[108:111],a[172:175],v[136:139]
 s_add_u32 s24,s24,128
 s_addc_u32 s25,s25,0
 v_mfma_f32_16x16x32_bf16 v[140:143],a[112:115],a[168:171],v[140:143]
 v_mfma_f32_16x16x32_bf16 v[140:143],a[116:119],a[172:175],v[140:143]
 s_sub_u32 s26,s26,128
 v_mfma_f32_16x16x32_bf16 v[144:147],a[168:171],a[120:123],v[144:147]
 v_mfma_f32_16x16x32_bf16 v[144:147],a[172:175],a[124:127],v[144:147]
 s_add_u32 s72,s72,172032
 s_addc_u32 s73,s73,0
 v_mfma_f32_16x16x32_bf16 v[148:151],a[168:171],a[128:131],v[148:151]
 v_mfma_f32_16x16x32_bf16 v[148:151],a[172:175],a[132:135],v[148:151]
 s_sub_u32 s74,s74,172032
 v_mfma_f32_16x16x32_bf16 v[152:155],a[88:91],a[168:171],v[152:155]
 v_mfma_f32_16x16x32_bf16 v[152:155],a[92:95],a[172:175],v[152:155]
 v_mfma_f32_16x16x32_bf16 v[156:159],a[96:99],a[168:171],v[156:159]
 v_mfma_f32_16x16x32_bf16 v[156:159],a[100:103],a[172:175],v[156:159]
 s_waitcnt lgkmcnt(0)
 v_mfma_f32_16x16x32_bf16 v[48:51],a[16:19],a[48:51],v[48:51]
 s_waitcnt vmcnt(12)
 s_barrier
 v_mfma_f32_16x16x32_bf16 v[48:51],a[20:23],a[52:55],v[48:51]
 s_add_u32 s61,s51,16384
 s_add_u32 m0,s51,114688
 v_mfma_f32_16x16x32_bf16 v[52:55],a[24:27],a[48:51],v[52:55]
 v_add_u32 v35,s61,v2
 v_mfma_f32_16x16x32_bf16 v[52:55],a[28:31],a[52:55],v[52:55]
 v_add_u32 v36,s61,v3
 v_add_u32 v27,0,v43
 v_mfma_f32_16x16x32_bf16 v[56:59],a[48:51],a[32:35],v[56:59]
 v_add_u32 v22,0xd000,v41
 v_mfma_f32_16x16x32_bf16 v[56:59],a[52:55],a[36:39],v[56:59]
 v_add_u32 v23,0xd000,v42
 v_mfma_f32_16x16x32_bf16 v[60:63],a[48:51],a[40:43],v[60:63]
 ds_read_b128 a[136:139],v35 offset:0
 v_mfma_f32_16x16x32_bf16 v[60:63],a[52:55],a[44:47],v[60:63]
 buffer_load_dwordx4 v27,s[40:43],0 offen offset:0 lds
 v_mfma_f32_16x16x32_bf16 v[64:67],a[16:19],a[56:59],v[64:67]
 ds_read_b128 a[140:143],v36 offset:0
 ds_read_b128 a[144:147],v35 offset:2048
 v_mfma_f32_16x16x32_bf16 v[64:67],a[20:23],a[60:63],v[64:67]
 ds_read_b128 a[148:151],v36 offset:2048
 v_add_u32 v28,6144,v43
 v_mfma_f32_16x16x32_bf16 v[68:71],a[24:27],a[56:59],v[68:71]
 ds_read_b128 a[152:155],v35 offset:4096
 v_mfma_f32_16x16x32_bf16 v[68:71],a[28:31],a[60:63],v[68:71]
 v_mfma_f32_16x16x32_bf16 v[72:75],a[56:59],a[32:35],v[72:75]
 ds_read_b128 a[156:159],v36 offset:4096
 v_mfma_f32_16x16x32_bf16 v[72:75],a[60:63],a[36:39],v[72:75]
 buffer_load_dwordx4 v28,s[40:43],0 offen offset:1024 lds
 v_mfma_f32_16x16x32_bf16 v[76:79],a[56:59],a[40:43],v[76:79]
 ds_read_b128 a[160:163],v35 offset:6144
 ds_read_b128 a[164:167],v36 offset:6144
 v_mfma_f32_16x16x32_bf16 v[76:79],a[60:63],a[44:47],v[76:79]
 ds_read_b128 a[168:171],v35 offset:8192
 v_add_u32 v27,12288,v43
 v_mfma_f32_16x16x32_bf16 v[80:83],a[0:3],a[56:59],v[80:83]
 ds_read_b128 a[172:175],v36 offset:8192
 v_mfma_f32_16x16x32_bf16 v[80:83],a[4:7],a[60:63],v[80:83]
 ds_read_b64_tr_b16 a[88:89],v22 offset:0
 v_mfma_f32_16x16x32_bf16 v[84:87],a[8:11],a[56:59],v[84:87]
 buffer_load_dwordx4 v27,s[40:43],0 offen offset:2048 lds
 v_mfma_f32_16x16x32_bf16 v[84:87],a[12:15],a[60:63],v[84:87]
 ds_read_b64_tr_b16 a[90:91],v22 offset:768
 ds_read_b64_tr_b16 a[92:93],v22 offset:6144
 v_mfma_f32_16x16x32_bf16 v[88:91],a[16:19],a[64:67],v[88:91]
 ds_read_b64_tr_b16 a[94:95],v22 offset:6912
 v_mfma_f32_16x16x32_bf16 v[88:91],a[20:23],a[68:71],v[88:91]
 ds_read_b64_tr_b16 a[96:97],v23 offset:0
 v_add_u32 v28,18432,v43
 v_mfma_f32_16x16x32_bf16 v[92:95],a[24:27],a[64:67],v[92:95]
 v_mfma_f32_16x16x32_bf16 v[92:95],a[28:31],a[68:71],v[92:95]
 ds_read_b64_tr_b16 a[98:99],v23 offset:768
 v_mfma_f32_16x16x32_bf16 v[96:99],a[64:67],a[32:35],v[96:99]
 buffer_load_dwordx4 v28,s[40:43],0 offen offset:3072 lds
 v_mfma_f32_16x16x32_bf16 v[96:99],a[68:71],a[36:39],v[96:99]
 ds_read_b64_tr_b16 a[100:101],v23 offset:6144
 ds_read_b64_tr_b16 a[102:103],v23 offset:6912
 v_mfma_f32_16x16x32_bf16 v[100:103],a[64:67],a[40:43],v[100:103]
 ds_read_b64_tr_b16 a[104:105],v22 offset:64
 v_mfma_f32_16x16x32_bf16 v[100:103],a[68:71],a[44:47],v[100:103]
 s_add_u32 m0,s51,118784
 ds_read_b64_tr_b16 a[106:107],v22 offset:832
 v_mfma_f32_16x16x32_bf16 v[104:107],a[0:3],a[64:67],v[104:107]
 ds_read_b64_tr_b16 a[108:109],v22 offset:6208
 v_mfma_f32_16x16x32_bf16 v[104:107],a[4:7],a[68:71],v[104:107]
 ds_read_b64_tr_b16 a[110:111],v22 offset:6976
 v_add_u32 v27,0,v43
 v_mfma_f32_16x16x32_bf16 v[108:111],a[8:11],a[64:67],v[108:111]
 ds_read_b64_tr_b16 a[112:113],v23 offset:64
 v_mfma_f32_16x16x32_bf16 v[108:111],a[12:15],a[68:71],v[108:111]
 ds_read_b64_tr_b16 a[114:115],v23 offset:832
 v_mfma_f32_16x16x32_bf16 v[112:115],a[16:19],a[72:75],v[112:115]
 buffer_load_dwordx4 v27,s[64:67],0 offen offset:0 lds
 v_mfma_f32_16x16x32_bf16 v[112:115],a[20:23],a[76:79],v[112:115]
 ds_read_b64_tr_b16 a[116:117],v23 offset:6208
 v_mfma_f32_16x16x32_bf16 v[116:119],a[24:27],a[72:75],v[116:119]
 ds_read_b64_tr_b16 a[118:119],v23 offset:6976
 v_mfma_f32_16x16x32_bf16 v[116:119],a[28:31],a[76:79],v[116:119]
 ds_read_b64_tr_b16 a[120:121],v22 offset:128
 v_add_u32 v28,6144,v43
 v_mfma_f32_16x16x32_bf16 v[120:123],a[72:75],a[32:35],v[120:123]
 ds_read_b64_tr_b16 a[122:123],v22 offset:896
 v_mfma_f32_16x16x32_bf16 v[120:123],a[76:79],a[36:39],v[120:123]
 ds_read_b64_tr_b16 a[124:125],v22 offset:6272
 v_mfma_f32_16x16x32_bf16 v[124:127],a[72:75],a[40:43],v[124:127]
 ds_read_b64_tr_b16 a[126:127],v22 offset:7040
 v_mfma_f32_16x16x32_bf16 v[124:127],a[76:79],a[44:47],v[124:127]
 buffer_load_dwordx4 v28,s[64:67],0 offen offset:1024 lds
 v_mfma_f32_16x16x32_bf16 v[128:131],a[0:3],a[72:75],v[128:131]
 ds_read_b64_tr_b16 a[128:129],v23 offset:128
 ds_read_b64_tr_b16 a[130:131],v23 offset:896
 v_mfma_f32_16x16x32_bf16 v[128:131],a[4:7],a[76:79],v[128:131]
 ds_read_b64_tr_b16 a[132:133],v23 offset:6272
 v_add_u32 v27,12288,v43
 v_mfma_f32_16x16x32_bf16 v[132:135],a[8:11],a[72:75],v[132:135]
 ds_read_b64_tr_b16 a[134:135],v23 offset:7040
 v_mfma_f32_16x16x32_bf16 v[132:135],a[12:15],a[76:79],v[132:135]
 v_mfma_f32_16x16x32_bf16 v[136:139],a[16:19],a[80:83],v[136:139]
 buffer_load_dwordx4 v27,s[64:67],0 offen offset:2048 lds
 v_mfma_f32_16x16x32_bf16 v[136:139],a[20:23],a[84:87],v[136:139]
 v_mfma_f32_16x16x32_bf16 v[140:143],a[24:27],a[80:83],v[140:143]
 v_mfma_f32_16x16x32_bf16 v[140:143],a[28:31],a[84:87],v[140:143]
 v_add_u32 v28,18432,v43
 v_mfma_f32_16x16x32_bf16 v[144:147],a[80:83],a[32:35],v[144:147]
 v_mfma_f32_16x16x32_bf16 v[144:147],a[84:87],a[36:39],v[144:147]
 v_mfma_f32_16x16x32_bf16 v[148:151],a[80:83],a[40:43],v[148:151]
 buffer_load_dwordx4 v28,s[64:67],0 offen offset:3072 lds
 v_mfma_f32_16x16x32_bf16 v[148:151],a[84:87],a[44:47],v[148:151]
 v_mfma_f32_16x16x32_bf16 v[152:155],a[0:3],a[80:83],v[152:155]
 v_mfma_f32_16x16x32_bf16 v[152:155],a[4:7],a[84:87],v[152:155]
 v_mfma_f32_16x16x32_bf16 v[156:159],a[8:11],a[80:83],v[156:159]
 v_mfma_f32_16x16x32_bf16 v[156:159],a[12:15],a[84:87],v[156:159]
 s_waitcnt lgkmcnt(0)
FL_9:
 v_cmp_lt_u32 vcc,v31,v30
 s_nop 4
 s_cbranch_vccz FL_9D
 s_sleep 2
 buffer_load_dword v31,v29,s[28:31],0 offen sc1
 s_waitcnt vmcnt(0)
 s_branch FL_9
FL_9D:
 v_lshrrev_b32 v16,6,v0
 v_lshl_add_u32 v14,v16,13,v1
 v_add_u32 v15,4096,v14
 s_mov_b32 s49,1103101952
 s_sub_u32 s61,15,s59
 s_min_u32 s48,s61,s59
 s_sub_u32 s41,15,s48
 s_mul_i32 s36,s46,229376
 s_add_u32 s36,s36,104857600
 s_mov_b32 s53,2
 s_mov_b32 s67,0
 s_mov_b32 s72,0
 s_mul_i32 s62,s59,3
 s_min_u32 s62,s62,30
 s_lshr_b32 s73,0x92492,s62
 s_and_b32 s73,s73,7
 s_mov_b32 s74,14
 s_lshl_b32 s62,s59,2
 s_lshr_b32 s62,0xeca86420,s62
 s_and_b32 s62,s62,15
 s_cmp_lt_u32 s59,8
 s_cselect_b32 s74,s62,s74
 s_mov_b32 s42,0
 s_mov_b32 s34,8
 s_mov_b32 s52,8
 s_lshl_b32 s43,s41,1
 s_sub_i32 s43,s43,16
 s_cmp_lt_i32 s43,2
 s_cselect_b32 s43,0,s43
 s_cmp_eq_u32 s43,1
 s_cselect_b32 s43,2,s43
 s_mov_b32 s39,-1
 s_mov_b32 s40,-1
 s_mov_b32 s44,0
 s_mov_b32 s50,1
 s_cmp_lg_u32 s43,0
 s_cbranch_scc1 RB_10
 s_mov_b32 s41,s48
 s_mov_b32 s42,0
 s_lshl_b32 s43,s48,1
 s_add_u32 s43,s43,2
 s_mov_b32 s39,1
 s_mov_b32 s40,2
 s_mov_b32 s44,0
 s_mov_b32 s50,0
 s_mov_b32 s52,0
RB_10:
 s_lshl_b32 s61,s46,3
 s_add_u32 s61,s61,s48
 s_lshl_b32 s66,s61,2
 s_add_u32 s66,s66,s45
 s_lshl_b32 s66,s66,10
 s_add_u32 s66,s66,126877696
 s_lshl_b32 s61,s61,7
 s_add_u32 s61,s61,125837312
 s_lshl_b32 s62,s46,20
 s_lshl_b32 s32,s42,15
 s_add_u32 s32,s32,s62
 s_add_u32 s33,s32,16777216
 s_lshl_b32 s47,s41,3
 s_add_u32 s47,s47,s45
 s_lshl_b32 s47,s47,13
 s_add_u32 s47,s47,s62
 s_add_u32 s47,s47,33554432
 s_lshl_b32 s63,s48,3
 s_add_u32 s63,s63,s45
 s_lshl_b32 s63,s63,13
 s_add_u32 s63,s63,s62
 s_add_u32 s63,s63,33554432
 s_add_u32 s65,s47,16777216
 s_lshl_b32 s64,s46,16
 s_add_u32 s64,s64,s51
 s_add_u32 s64,s64,100663296
 s_cmp_lg_u32 s73,0
 s_cselect_b32 s64,s64,0xf0000000
 s_cmp_eq_u32 s44,1
 s_cselect_b32 s65,s65,s64
 s_add_u32 s64,s36,65536
 s_cmp_eq_u32 s50,1
 s_cselect_b32 s35,s62,s36
 s_cselect_b32 s65,s63,s65
 s_cselect_b32 s64,s33,s64
 s_sub_u32 s38,s43,1
 s_and_b32 s63,s43,1
 s_lshl_b32 s68,s63,15
 s_add_u32 s68,s68,s51
 s_xor_b32 s69,s68,0x8000
 s_sub_u32 s63,s38,s63
 s_sub_i32 s62,s63,2
 s_cmp_ge_i32 s62,3
 s_cselect_b32 s63,s62,s63
 s_sub_i32 s62,s43,5
 s_or_b32 s62,s62,1
 s_cmp_ge_i32 s62,3
 s_cselect_b32 s63,s62,s63
 s_mul_i32 s62,s50,8
 s_cmp_le_u32 s43,s62
 s_cselect_b32 s63,-2,s63
 s_cmp_eq_u32 s53,-1
 s_cselect_b32 s53,-1,s63
 s_lshl_b32 s61,s45,14
 s_sub_u32 s61,57344,s61
 v_add_u32 v243,s61,v1
 s_add_u32 s61,s46,0
 s_lshl_b32 s61,s61,7
 s_add_u32 s61,s61,125829120
 v_mov_b32 v29,s61
 v_mov_b32 v30,8
 v_mfma_f32_16x16x32_bf16 v[48:51],a[104:107],a[136:139],v[48:51]
 s_waitcnt vmcnt(8)
 s_barrier
 v_mfma_f32_16x16x32_bf16 v[48:51],a[108:111],a[140:143],v[48:51]
 s_add_u32 s61,s51,65536
 s_add_u32 s63,s47,0
 v_mfma_f32_16x16x32_bf16 v[52:55],a[112:115],a[136:139],v[52:55]
 v_add_u32 v35,s61,v2
 v_mfma_f32_16x16x32_bf16 v[52:55],a[116:119],a[140:143],v[52:55]
 v_add_u32 v36,s61,v3
 v_mfma_f32_16x16x32_bf16 v[56:59],a[136:139],a[120:123],v[56:59]
 buffer_load_dwordx4 a[192:195],v1,s[28:31],s63 offen offset:0 sc1
 v_mfma_f32_16x16x32_bf16 v[56:59],a[140:143],a[124:127],v[56:59]
 v_add_u32 v22,0x19000,v41
 v_add_u32 v23,0x19000,v42
 v_mfma_f32_16x16x32_bf16 v[60:63],a[136:139],a[128:131],v[60:63]
 buffer_load_dwordx4 a[196:199],v1,s[28:31],s63 offen offset:1024 sc1
 v_mfma_f32_16x16x32_bf16 v[60:63],a[140:143],a[132:135],v[60:63]
 ds_read_b128 a[48:51],v35 offset:0
 ds_read_b128 a[52:55],v36 offset:0
 v_mfma_f32_16x16x32_bf16 v[64:67],a[104:107],a[144:147],v[64:67]
 ds_read_b128 a[56:59],v35 offset:2048
 v_mfma_f32_16x16x32_bf16 v[64:67],a[108:111],a[148:151],v[64:67]
 buffer_load_dwordx4 a[200:203],v1,s[28:31],s63 offen offset:2048 sc1
 v_mfma_f32_16x16x32_bf16 v[68:71],a[112:115],a[144:147],v[68:71]
 ds_read_b128 a[60:63],v36 offset:2048
 ds_read_b128 a[64:67],v35 offset:4096
 v_mfma_f32_16x16x32_bf16 v[68:71],a[116:119],a[148:151],v[68:71]
 buffer_load_dwordx4 a[204:207],v1,s[28:31],s63 offen offset:3072 sc1
 v_mfma_f32_16x16x32_bf16 v[72:75],a[144:147],a[120:123],v[72:75]
 ds_read_b128 a[68:71],v36 offset:4096
 v_mfma_f32_16x16x32_bf16 v[72:75],a[148:151],a[124:127],v[72:75]
 ds_read_b128 a[72:75],v35 offset:6144
 v_mfma_f32_16x16x32_bf16 v[76:79],a[144:147],a[128:131],v[76:79]
 s_add_u32 s63,s47,4096
 ds_read_b128 a[76:79],v36 offset:6144
 v_mfma_f32_16x16x32_bf16 v[76:79],a[148:151],a[132:135],v[76:79]
 ds_read_b128 a[80:83],v35 offset:8192
 v_mfma_f32_16x16x32_bf16 v[80:83],a[88:91],a[144:147],v[80:83]
 ds_read_b128 a[84:87],v36 offset:8192
 v_mfma_f32_16x16x32_bf16 v[80:83],a[92:95],a[148:151],v[80:83]
 buffer_load_dwordx4 a[208:211],v1,s[28:31],s63 offen offset:0 sc1
 v_mfma_f32_16x16x32_bf16 v[84:87],a[96:99],a[144:147],v[84:87]
 ds_read_b64_tr_b16 a[0:1],v22 offset:0
 ds_read_b64_tr_b16 a[2:3],v22 offset:768
 v_mfma_f32_16x16x32_bf16 v[84:87],a[100:103],a[148:151],v[84:87]
 buffer_load_dwordx4 a[212:215],v1,s[28:31],s63 offen offset:1024 sc1
 v_mfma_f32_16x16x32_bf16 v[88:91],a[104:107],a[152:155],v[88:91]
 ds_read_b64_tr_b16 a[4:5],v22 offset:6144
 ds_read_b64_tr_b16 a[6:7],v22 offset:6912
 v_mfma_f32_16x16x32_bf16 v[88:91],a[108:111],a[156:159],v[88:91]
 buffer_load_dwordx4 a[216:219],v1,s[28:31],s63 offen offset:2048 sc1
 v_mfma_f32_16x16x32_bf16 v[92:95],a[112:115],a[152:155],v[92:95]
 ds_read_b64_tr_b16 a[8:9],v23 offset:0
 v_mfma_f32_16x16x32_bf16 v[92:95],a[116:119],a[156:159],v[92:95]
 ds_read_b64_tr_b16 a[10:11],v23 offset:768
 v_mfma_f32_16x16x32_bf16 v[96:99],a[152:155],a[120:123],v[96:99]
 ds_read_b64_tr_b16 a[12:13],v23 offset:6144
 v_mfma_f32_16x16x32_bf16 v[96:99],a[156:159],a[124:127],v[96:99]
 buffer_load_dwordx4 a[220:223],v1,s[28:31],s63 offen offset:3072 sc1
 v_mfma_f32_16x16x32_bf16 v[100:103],a[152:155],a[128:131],v[100:103]
 ds_read_b64_tr_b16 a[14:15],v23 offset:6912
 ds_read_b64_tr_b16 a[16:17],v22 offset:64
 v_mfma_f32_16x16x32_bf16 v[100:103],a[156:159],a[132:135],v[100:103]
 s_add_u32 s63,s47,0
 ds_read_b64_tr_b16 a[18:19],v22 offset:832
 v_mfma_f32_16x16x32_bf16 v[104:107],a[88:91],a[152:155],v[104:107]
 ds_read_b64_tr_b16 a[20:21],v22 offset:6208
 v_mfma_f32_16x16x32_bf16 v[104:107],a[92:95],a[156:159],v[104:107]
 buffer_load_dwordx4 a[224:227],v243,s[28:31],s63 offen offset:0 sc1
 v_mfma_f32_16x16x32_bf16 v[108:111],a[96:99],a[152:155],v[108:111]
 ds_read_b64_tr_b16 a[22:23],v22 offset:6976
 ds_read_b64_tr_b16 a[24:25],v23 offset:64
 v_mfma_f32_16x16x32_bf16 v[108:111],a[100:103],a[156:159],v[108:111]
 ds_read_b64_tr_b16 a[26:27],v23 offset:832
 v_mfma_f32_16x16x32_bf16 v[112:115],a[104:107],a[160:163],v[112:115]
 buffer_load_dwordx4 a[228:231],v243,s[28:31],s63 offen offset:1024 sc1
 v_mfma_f32_16x16x32_bf16 v[112:115],a[108:111],a[164:167],v[112:115]
 ds_read_b64_tr_b16 a[28:29],v23 offset:6208
 v_mfma_f32_16x16x32_bf16 v[116:119],a[112:115],a[160:163],v[116:119]
 ds_read_b64_tr_b16 a[30:31],v23 offset:6976
 v_mfma_f32_16x16x32_bf16 v[116:119],a[116:119],a[164:167],v[116:119]
 buffer_load_dwordx4 a[232:235],v243,s[28:31],s63 offen offset:2048 sc1
 v_mfma_f32_16x16x32_bf16 v[120:123],a[160:163],a[120:123],v[120:123]
 ds_read_b64_tr_b16 a[32:33],v22 offset:128
 ds_read_b64_tr_b16 a[34:35],v22 offset:896
 v_mfma_f32_16x16x32_bf16 v[120:123],a[164:167],a[124:127],v[120:123]
 ds_read_b64_tr_b16 a[36:37],v22 offset:6272
 v_mfma_f32_16x16x32_bf16 v[124:127],a[160:163],a[128:131],v[124:127]
 buffer_load_dwordx4 a[236:239],v243,s[28:31],s63 offen offset:3072 sc1
 v_mfma_f32_16x16x32_bf16 v[124:127],a[164:167],a[132:135],v[124:127]
 ds_read_b64_tr_b16 a[38:39],v22 offset:7040
 ds_read_b64_tr_b16 a[40:41],v23 offset:128
 v_mfma_f32_16x16x32_bf16 v[128:131],a[88:91],a[160:163],v[128:131]
 buffer_load_dword v31,v29,s[28:31],0 offen sc1
 v_mfma_f32_16x16x32_bf16 v[128:131],a[92:95],a[164:167],v[128:131]
 s_add_u32 s63,s47,4096
 ds_read_b64_tr_b16 a[42:43],v23 offset:896
 v_mfma_f32_16x16x32_bf16 v[132:135],a[96:99],a[160:163],v[132:135]
 ds_read_b64_tr_b16 a[44:45],v23 offset:6272
 ds_read_b64_tr_b16 a[46:47],v23 offset:7040
 v_mfma_f32_16x16x32_bf16 v[132:135],a[100:103],a[164:167],v[132:135]
 buffer_load_dwordx4 a[240:243],v243,s[28:31],s63 offen offset:0 sc1
 v_mfma_f32_16x16x32_bf16 v[136:139],a[104:107],a[168:171],v[136:139]
 v_mfma_f32_16x16x32_bf16 v[136:139],a[108:111],a[172:175],v[136:139]
 buffer_load_dwordx4 a[244:247],v243,s[28:31],s63 offen offset:1024 sc1
 v_mfma_f32_16x16x32_bf16 v[140:143],a[112:115],a[168:171],v[140:143]
 v_mfma_f32_16x16x32_bf16 v[140:143],a[116:119],a[172:175],v[140:143]
 buffer_load_dwordx4 a[248:251],v243,s[28:31],s63 offen offset:2048 sc1
 v_mfma_f32_16x16x32_bf16 v[144:147],a[168:171],a[120:123],v[144:147]
 v_mfma_f32_16x16x32_bf16 v[144:147],a[172:175],a[124:127],v[144:147]
 v_mfma_f32_16x16x32_bf16 v[148:151],a[168:171],a[128:131],v[148:151]
 buffer_load_dwordx4 a[252:255],v243,s[28:31],s63 offen offset:3072 sc1
 v_mfma_f32_16x16x32_bf16 v[148:151],a[172:175],a[132:135],v[148:151]
 v_mfma_f32_16x16x32_bf16 v[152:155],a[88:91],a[168:171],v[152:155]
 v_mfma_f32_16x16x32_bf16 v[152:155],a[92:95],a[172:175],v[152:155]
 v_mfma_f32_16x16x32_bf16 v[156:159],a[96:99],a[168:171],v[156:159]
 v_mfma_f32_16x16x32_bf16 v[156:159],a[100:103],a[172:175],v[156:159]
 s_waitcnt lgkmcnt(0)
 v_mfma_f32_16x16x32_bf16 v[48:51],a[16:19],a[48:51],v[48:51]
 v_and_b32 v216,15,v0
 v_bfe_u32 v217,v0,4,2
 v_cmp_ne_u32 s[4:5],3,v217
 v_lshlrev_b32 v217,2,v217
 v_sub_u32 v216,v216,v217
 v_mfma_f32_16x16x32_bf16 v[48:51],a[20:23],a[52:55],v[48:51]
 v_and_b32 v217,1,v0
 v_cmp_eq_u32 s[6:7],1,v217
 v_cmp_le_i32 s[8:9],0,v216
 v_cmp_le_i32 s[10:11],2,v216
 v_mov_b32 v218,0xffff
 v_mfma_f32_16x16x32_bf16 v[52:55],a[24:27],a[48:51],v[52:55]
 v_mov_b32 v219,0xffff0000
 v_cndmask_b32 v219,v218,v219,s[6:7]
 v_mov_b32 v218,0xff800000
 s_or_b32 s16,s76,s45
 s_cselect_b64 s[12:13],-1,0
 v_mfma_f32_16x16x32_bf16 v[52:55],a[28:31],a[52:55],v[52:55]
 s_mov_b32 s14,0x3e41848f
 s_mov_b32 s15,0x3fb8aa3b
 v_mfma_f32_16x16x32_bf16 v[56:59],a[48:51],a[32:35],v[56:59]
 v_mfma_f32_16x16x32_bf16 v[56:59],a[52:55],a[36:39],v[56:59]
 v_mfma_f32_16x16x32_bf16 v[60:63],a[48:51],a[40:43],v[60:63]
 v_mfma_f32_16x16x32_bf16 v[60:63],a[52:55],a[44:47],v[60:63]
 v_mfma_f32_16x16x32_bf16 v[64:67],a[16:19],a[56:59],v[64:67]
 v_mfma_f32_16x16x32_bf16 v[64:67],a[20:23],a[60:63],v[64:67]
 v_cvt_pk_bf16_f32 v160,v48,v49
 v_cvt_pk_bf16_f32 v161,v50,v51
 v_mfma_f32_16x16x32_bf16 v[68:71],a[24:27],a[56:59],v[68:71]
 v_mfma_f32_16x16x32_bf16 v[68:71],a[28:31],a[60:63],v[68:71]
 v_cvt_pk_bf16_f32 v162,v52,v53
 v_cvt_pk_bf16_f32 v163,v54,v55
 v_mfma_f32_16x16x32_bf16 v[72:75],a[56:59],a[32:35],v[72:75]
 v_mfma_f32_16x16x32_bf16 v[72:75],a[60:63],a[36:39],v[72:75]
 v_cvt_pk_bf16_f32 v196,v56,v57
 v_cvt_pk_bf16_f32 v197,v58,v59
 v_mfma_f32_16x16x32_bf16 v[76:79],a[56:59],a[40:43],v[76:79]
 v_mfma_f32_16x16x32_bf16 v[76:79],a[60:63],a[44:47],v[76:79]
 v_cvt_pk_bf16_f32 v206,v60,v61
 v_cvt_pk_bf16_f32 v207,v62,v63
 v_mfma_f32_16x16x32_bf16 v[80:83],a[0:3],a[56:59],v[80:83]
 s_waitcnt vmcnt(4)
 v_cmp_lt_u32 vcc,v31,v30
 v_mfma_f32_16x16x32_bf16 v[80:83],a[4:7],a[60:63],v[80:83]
 v_cvt_pk_bf16_f32 v164,v64,v65
 v_cvt_pk_bf16_f32 v165,v66,v67
 v_mfma_f32_16x16x32_bf16 v[84:87],a[8:11],a[56:59],v[84:87]
 v_mfma_f32_16x16x32_bf16 v[84:87],a[12:15],a[60:63],v[84:87]
 s_cbranch_vccnz FLE_5
FLE_5R:
 v_cvt_pk_bf16_f32 v166,v68,v69
 v_cvt_pk_bf16_f32 v167,v70,v71
 v_mfma_f32_16x16x32_bf16 v[88:91],a[16:19],a[64:67],v[88:91]
 s_add_u32 m0,s68,0
 v_mfma_f32_16x16x32_bf16 v[88:91],a[20:23],a[68:71],v[88:91]
 buffer_load_dwordx4 v14,s[28:31],s32 offen offset:0 sc1 lds
 v_cvt_pk_bf16_f32 v198,v72,v73
 v_cvt_pk_bf16_f32 v199,v74,v75
 v_mfma_f32_16x16x32_bf16 v[92:95],a[24:27],a[64:67],v[92:95]
 v_mfma_f32_16x16x32_bf16 v[92:95],a[28:31],a[68:71],v[92:95]
 buffer_load_dwordx4 v14,s[28:31],s32 offen offset:1024 sc1 lds
 v_cvt_pk_bf16_f32 v208,v76,v77
 v_cvt_pk_bf16_f32 v209,v78,v79
 v_mfma_f32_16x16x32_bf16 v[96:99],a[64:67],a[32:35],v[96:99]
 buffer_load_dwordx4 v14,s[28:31],s32 offen offset:2048 sc1 lds
 v_mfma_f32_16x16x32_bf16 v[96:99],a[68:71],a[36:39],v[96:99]
 v_cvt_pk_bf16_f32 v180,v80,v81
 v_cvt_pk_bf16_f32 v181,v82,v83
 v_mfma_f32_16x16x32_bf16 v[100:103],a[64:67],a[40:43],v[100:103]
 buffer_load_dwordx4 v14,s[28:31],s32 offen offset:3072 sc1 lds
 v_mfma_f32_16x16x32_bf16 v[100:103],a[68:71],a[44:47],v[100:103]
 s_add_u32 m0,s68,4096
 v_cvt_pk_bf16_f32 v182,v84,v85
 v_cvt_pk_bf16_f32 v183,v86,v87
 v_cndmask_b32 v182,0,v182,s[4:5]
 v_cndmask_b32 v183,0,v183,s[4:5]
 v_mfma_f32_16x16x32_bf16 v[104:107],a[0:3],a[64:67],v[104:107]
 v_mfma_f32_16x16x32_bf16 v[104:107],a[4:7],a[68:71],v[104:107]
 buffer_load_dwordx4 v15,s[28:31],s32 offen offset:0 sc1 lds
 v_cvt_pk_bf16_f32 v168,v88,v89
 v_cvt_pk_bf16_f32 v169,v90,v91
 v_mfma_f32_16x16x32_bf16 v[108:111],a[8:11],a[64:67],v[108:111]
 buffer_load_dwordx4 v15,s[28:31],s32 offen offset:1024 sc1 lds
 v_mfma_f32_16x16x32_bf16 v[108:111],a[12:15],a[68:71],v[108:111]
 v_cvt_pk_bf16_f32 v170,v92,v93
 v_cvt_pk_bf16_f32 v171,v94,v95
 v_mfma_f32_16x16x32_bf16 v[112:115],a[16:19],a[72:75],v[112:115]
 buffer_load_dwordx4 v15,s[28:31],s32 offen offset:2048 sc1 lds
 v_mfma_f32_16x16x32_bf16 v[112:115],a[20:23],a[76:79],v[112:115]
 buffer_load_dwordx4 v15,s[28:31],s32 offen offset:3072 sc1 lds
 v_cvt_pk_bf16_f32 v200,v96,v97
 v_cvt_pk_bf16_f32 v201,v98,v99
 v_mfma_f32_16x16x32_bf16 v[116:119],a[24:27],a[72:75],v[116:119]
 v_mfma_f32_16x16x32_bf16 v[116:119],a[28:31],a[76:79],v[116:119]
 s_add_u32 s32,s32,32768
 v_cvt_pk_bf16_f32 v210,v100,v101
 v_cvt_pk_bf16_f32 v211,v102,v103
 v_mfma_f32_16x16x32_bf16 v[120:123],a[72:75],a[32:35],v[120:123]
 s_add_u32 m0,s69,0
 v_mfma_f32_16x16x32_bf16 v[120:123],a[76:79],a[36:39],v[120:123]
 v_cvt_pk_bf16_f32 v184,v104,v105
 v_cvt_pk_bf16_f32 v185,v106,v107
 v_mfma_f32_16x16x32_bf16 v[124:127],a[72:75],a[40:43],v[124:127]
 buffer_load_dwordx4 v14,s[28:31],s32 offen offset:0 sc1 lds
 v_mfma_f32_16x16x32_bf16 v[124:127],a[76:79],a[44:47],v[124:127]
 buffer_load_dwordx4 v14,s[28:31],s32 offen offset:1024 sc1 lds
 v_cvt_pk_bf16_f32 v186,v108,v109
 v_cvt_pk_bf16_f32 v187,v110,v111
 v_cndmask_b32 v186,0,v186,s[4:5]
 v_mfma_f32_16x16x32_bf16 v[128:131],a[0:3],a[72:75],v[128:131]
 v_cndmask_b32 v187,0,v187,s[4:5]
 v_mfma_f32_16x16x32_bf16 v[128:131],a[4:7],a[76:79],v[128:131]
 buffer_load_dwordx4 v14,s[28:31],s32 offen offset:2048 sc1 lds
 v_cvt_pk_bf16_f32 v172,v112,v113
 v_cvt_pk_bf16_f32 v173,v114,v115
 v_mfma_f32_16x16x32_bf16 v[132:135],a[8:11],a[72:75],v[132:135]
 buffer_load_dwordx4 v14,s[28:31],s32 offen offset:3072 sc1 lds
 v_mfma_f32_16x16x32_bf16 v[132:135],a[12:15],a[76:79],v[132:135]
 v_cvt_pk_bf16_f32 v174,v116,v117
 v_cvt_pk_bf16_f32 v175,v118,v119
 v_mfma_f32_16x16x32_bf16 v[136:139],a[16:19],a[80:83],v[136:139]
 s_add_u32 m0,s69,4096
 v_mfma_f32_16x16x32_bf16 v[136:139],a[20:23],a[84:87],v[136:139]
 buffer_load_dwordx4 v15,s[28:31],s32 offen offset:0 sc1 lds
 v_cvt_pk_bf16_f32 v202,v120,v121
 v_cvt_pk_bf16_f32 v203,v122,v123
 v_mfma_f32_16x16x32_bf16 v[140:143],a[24:27],a[80:83],v[140:143]
 v_mfma_f32_16x16x32_bf16 v[140:143],a[28:31],a[84:87],v[140:143]
 buffer_load_dwordx4 v15,s[28:31],s32 offen offset:1024 sc1 lds
 v_cvt_pk_bf16_f32 v212,v124,v125
 v_cvt_pk_bf16_f32 v213,v126,v127
 v_mfma_f32_16x16x32_bf16 v[144:147],a[80:83],a[32:35],v[144:147]
 buffer_load_dwordx4 v15,s[28:31],s32 offen offset:2048 sc1 lds
 v_mfma_f32_16x16x32_bf16 v[144:147],a[84:87],a[36:39],v[144:147]
 v_cvt_pk_bf16_f32 v188,v128,v129
 v_cvt_pk_bf16_f32 v189,v130,v131
 v_mfma_f32_16x16x32_bf16 v[148:151],a[80:83],a[40:43],v[148:151]
 buffer_load_dwordx4 v15,s[28:31],s32 offen offset:3072 sc1 lds
 v_mfma_f32_16x16x32_bf16 v[148:151],a[84:87],a[44:47],v[148:151]
 s_add_u32 s32,s32,32768
 v_cvt_pk_bf16_f32 v190,v132,v133
 v_cvt_pk_bf16_f32 v191,v134,v135
 v_cndmask_b32 v190,0,v190,s[4:5]
 v_cndmask_b32 v191,0,v191,s[4:5]
 v_mfma_f32_16x16x32_bf16 v[152:155],a[0:3],a[80:83],v[152:155]
 v_mfma_f32_16x16x32_bf16 v[152:155],a[4:7],a[84:87],v[152:155]
 v_cvt_pk_bf16_f32 v176,v136,v137
 v_cvt_pk_bf16_f32 v177,v138,v139
 v_mfma_f32_16x16x32_bf16 v[156:159],a[8:11],a[80:83],v[156:159]
 v_mfma_f32_16x16x32_bf16 v[156:159],a[12:15],a[84:87],v[156:159]
 v_cvt_pk_bf16_f32 v178,v140,v141
 v_cvt_pk_bf16_f32 v179,v142,v143
 s_nop 7
 v_cvt_pk_bf16_f32 v204,v144,v145
 v_cvt_pk_bf16_f32 v205,v146,v147
 v_cvt_pk_bf16_f32 v214,v148,v149
 v_cvt_pk_bf16_f32 v215,v150,v151
 v_cvt_pk_bf16_f32 v192,v152,v153
 v_cvt_pk_bf16_f32 v193,v154,v155
 v_cvt_pk_bf16_f32 v194,v156,v157
 v_cvt_pk_bf16_f32 v195,v158,v159
 v_cndmask_b32 v194,0,v194,s[4:5]
 v_cndmask_b32 v195,0,v195,s[4:5]
G1T_3E:
 s_branch G1_TAIL
G1_V:
 v_mfma_f32_16x16x32_bf16 v[48:51],a[192:195],a[64:67],0
 s_add_u32 m0,s50,0
 v_mfma_f32_16x16x32_bf16 v[48:51],a[196:199],a[68:71],v[48:51]
 ds_read_b128 a[200:203],v4 offset:2048
 v_mfma_f32_16x16x32_bf16 v[52:55],a[192:195],a[72:75],0
 buffer_load_dwordx4 v14,s[4:7],s32 offen offset:0 lds
 v_mfma_f32_16x16x32_bf16 v[52:55],a[196:199],a[76:79],v[52:55]
 ds_read_b128 a[204:207],v5 offset:2048
 v_mfma_f32_16x16x32_bf16 v[56:59],a[192:195],a[80:83],0
 v_mfma_f32_16x16x32_bf16 v[56:59],a[196:199],a[84:87],v[56:59]
 buffer_load_dwordx4 v15,s[4:7],s33 offen offset:1024 lds
 v_mfma_f32_16x16x32_bf16 v[60:63],a[192:195],a[88:91],0
 v_mfma_f32_16x16x32_bf16 v[60:63],a[196:199],a[92:95],v[60:63]
 buffer_load_dwordx4 v14,s[4:7],s34 offen offset:2048 lds
 v_mfma_f32_16x16x32_bf16 v[64:67],a[192:195],a[96:99],0
 v_mfma_f32_16x16x32_bf16 v[64:67],a[196:199],a[100:103],v[64:67]
 v_mfma_f32_16x16x32_bf16 v[68:71],a[192:195],a[104:107],0
 buffer_load_dwordx4 v15,s[4:7],s35 offen offset:3072 lds
 v_mfma_f32_16x16x32_bf16 v[68:71],a[196:199],a[108:111],v[68:71]
 v_mfma_f32_16x16x32_bf16 v[72:75],a[192:195],a[112:115],0
 s_add_u32 m0,s50,4096
 v_mfma_f32_16x16x32_bf16 v[72:75],a[196:199],a[116:119],v[72:75]
 v_mfma_f32_16x16x32_bf16 v[76:79],a[192:195],a[120:123],0
 v_mfma_f32_16x16x32_bf16 v[76:79],a[196:199],a[124:127],v[76:79]
 s_waitcnt lgkmcnt(0)
 v_mfma_f32_16x16x32_bf16 v[80:83],a[200:203],a[64:67],0
 buffer_load_dwordx4 v14,s[4:7],s36 offen offset:0 lds
 v_mfma_f32_16x16x32_bf16 v[80:83],a[204:207],a[68:71],v[80:83]
 ds_read_b128 a[192:195],v4 offset:4096
 v_mfma_f32_16x16x32_bf16 v[84:87],a[200:203],a[72:75],0
 buffer_load_dwordx4 v15,s[4:7],s37 offen offset:1024 lds
 v_mfma_f32_16x16x32_bf16 v[84:87],a[204:207],a[76:79],v[84:87]
 ds_read_b128 a[196:199],v5 offset:4096
 v_mfma_f32_16x16x32_bf16 v[88:91],a[200:203],a[80:83],0
 buffer_load_dwordx4 v14,s[4:7],s38 offen offset:2048 lds
 v_mfma_f32_16x16x32_bf16 v[88:91],a[204:207],a[84:87],v[88:91]
 v_mfma_f32_16x16x32_bf16 v[92:95],a[200:203],a[88:91],0
 buffer_load_dwordx4 v15,s[4:7],s39 offen offset:3072 lds
 v_mfma_f32_16x16x32_bf16 v[92:95],a[204:207],a[92:95],v[92:95]
 v_mfma_f32_16x16x32_bf16 v[96:99],a[200:203],a[96:99],0
 v_mfma_f32_16x16x32_bf16 v[96:99],a[204:207],a[100:103],v[96:99]
 s_add_u32 s4,s4,128
 s_addc_u32 s5,s5,0
 v_mfma_f32_16x16x32_bf16 v[100:103],a[200:203],a[104:107],0
 v_mfma_f32_16x16x32_bf16 v[100:103],a[204:207],a[108:111],v[100:103]
 s_sub_u32 s6,s6,128
 v_mfma_f32_16x16x32_bf16 v[104:107],a[200:203],a[112:115],0
 v_mfma_f32_16x16x32_bf16 v[104:107],a[204:207],a[116:119],v[104:107]
 v_mfma_f32_16x16x32_bf16 v[108:111],a[200:203],a[120:123],0
 s_add_u32 s50,s50,32768
 v_mfma_f32_16x16x32_bf16 v[108:111],a[204:207],a[124:127],v[108:111]
 s_waitcnt lgkmcnt(0)
 v_mfma_f32_16x16x32_bf16 v[112:115],a[192:195],a[64:67],0
 s_cmp_ge_u32 s50,98304
 s_cselect_b32 s50,s51,s50
 v_mfma_f32_16x16x32_bf16 v[112:115],a[196:199],a[68:71],v[112:115]
 ds_read_b128 a[200:203],v4 offset:6144
 v_mfma_f32_16x16x32_bf16 v[116:119],a[192:195],a[72:75],0
 v_mfma_f32_16x16x32_bf16 v[116:119],a[196:199],a[76:79],v[116:119]
 ds_read_b128 a[204:207],v5 offset:6144
 s_add_u32 m0,s51,98304
 v_mfma_f32_16x16x32_bf16 v[120:123],a[192:195],a[80:83],0
 v_mfma_f32_16x16x32_bf16 v[120:123],a[196:199],a[84:87],v[120:123]
 buffer_load_dwordx4 v16,s[8:11],s32 offen offset:0 lds
 v_mfma_f32_16x16x32_bf16 v[124:127],a[192:195],a[88:91],0
 v_mfma_f32_16x16x32_bf16 v[124:127],a[196:199],a[92:95],v[124:127]
 v_mfma_f32_16x16x32_bf16 v[128:131],a[192:195],a[96:99],0
 buffer_load_dwordx4 v17,s[8:11],s33 offen offset:1024 lds
 v_mfma_f32_16x16x32_bf16 v[128:131],a[196:199],a[100:103],v[128:131]
 v_mfma_f32_16x16x32_bf16 v[132:135],a[192:195],a[104:107],0
 buffer_load_dwordx4 v16,s[8:11],s34 offen offset:2048 lds
 v_mfma_f32_16x16x32_bf16 v[132:135],a[196:199],a[108:111],v[132:135]
 v_mfma_f32_16x16x32_bf16 v[136:139],a[192:195],a[112:115],0
 v_mfma_f32_16x16x32_bf16 v[136:139],a[196:199],a[116:119],v[136:139]
 buffer_load_dwordx4 v17,s[8:11],s35 offen offset:3072 lds
 v_mfma_f32_16x16x32_bf16 v[140:143],a[192:195],a[120:123],0
 v_mfma_f32_16x16x32_bf16 v[140:143],a[196:199],a[124:127],v[140:143]
 s_waitcnt lgkmcnt(0)
 s_add_u32 m0,s51,102400
 v_mfma_f32_16x16x32_bf16 v[144:147],a[200:203],a[64:67],0
 v_mfma_f32_16x16x32_bf16 v[144:147],a[204:207],a[68:71],v[144:147]
 ds_read_b128 a[192:195],v4 offset:8192
 v_mfma_f32_16x16x32_bf16 v[148:151],a[200:203],a[72:75],0
 buffer_load_dwordx4 v18,s[8:11],s36 offen offset:0 lds
 v_mfma_f32_16x16x32_bf16 v[148:151],a[204:207],a[76:79],v[148:151]
 ds_read_b128 a[196:199],v5 offset:8192
 v_mfma_f32_16x16x32_bf16 v[152:155],a[200:203],a[80:83],0
 buffer_load_dwordx4 v19,s[8:11],s37 offen offset:1024 lds
 v_mfma_f32_16x16x32_bf16 v[152:155],a[204:207],a[84:87],v[152:155]
 v_mfma_f32_16x16x32_bf16 v[156:159],a[200:203],a[88:91],0
 v_mfma_f32_16x16x32_bf16 v[156:159],a[204:207],a[92:95],v[156:159]
 buffer_load_dwordx4 v18,s[8:11],s38 offen offset:2048 lds
 v_mfma_f32_16x16x32_bf16 v[160:163],a[200:203],a[96:99],0
 s_waitcnt vmcnt(17)
 s_barrier
 v_mfma_f32_16x16x32_bf16 v[160:163],a[204:207],a[100:103],v[160:163]
 ds_read_b64_tr_b16 a[128:129],v6 offset:32768
 v_mfma_f32_16x16x32_bf16 v[164:167],a[200:203],a[104:107],0
 buffer_load_dwordx4 v19,s[8:11],s39 offen offset:3072 lds
 v_mfma_f32_16x16x32_bf16 v[164:167],a[204:207],a[108:111],v[164:167]
 ds_read_b64_tr_b16 a[130:131],v6 offset:34816
 ds_read_b64_tr_b16 a[132:133],v6 offset:49152
 v_mfma_f32_16x16x32_bf16 v[168:171],a[200:203],a[112:115],0
 s_add_u32 s8,s8,524288
 s_addc_u32 s9,s9,0
 v_mfma_f32_16x16x32_bf16 v[168:171],a[204:207],a[116:119],v[168:171]
 ds_read_b64_tr_b16 a[134:135],v6 offset:51200
 v_mfma_f32_16x16x32_bf16 v[172:175],a[200:203],a[120:123],0
 s_sub_u32 s10,s10,524288
 ds_read_b64_tr_b16 a[136:137],v7 offset:32768
 v_mfma_f32_16x16x32_bf16 v[172:175],a[204:207],a[124:127],v[172:175]
 s_waitcnt lgkmcnt(5)
 v_mfma_f32_16x16x32_bf16 v[176:179],a[192:195],a[64:67],0
 ds_read_b64_tr_b16 a[138:139],v7 offset:34816
 v_mfma_f32_16x16x32_bf16 v[176:179],a[196:199],a[68:71],v[176:179]
 ds_read_b128 a[200:203],v4 offset:10240
 s_add_u32 m0,s50,0
 v_mfma_f32_16x16x32_bf16 v[180:183],a[192:195],a[72:75],0
 ds_read_b64_tr_b16 a[140:141],v7 offset:49152
 v_mfma_f32_16x16x32_bf16 v[180:183],a[196:199],a[76:79],v[180:183]
 ds_read_b128 a[204:207],v5 offset:10240
 ds_read_b64_tr_b16 a[142:143],v7 offset:51200
 v_mfma_f32_16x16x32_bf16 v[184:187],a[192:195],a[80:83],0
 buffer_load_dwordx4 v14,s[4:7],s32 offen offset:0 lds
 v_mfma_f32_16x16x32_bf16 v[184:187],a[196:199],a[84:87],v[184:187]
 ds_read_b64_tr_b16 a[144:145],v8 offset:32768
 v_mfma_f32_16x16x32_bf16 v[188:191],a[192:195],a[88:91],0
 buffer_load_dwordx4 v15,s[4:7],s33 offen offset:1024 lds
 v_mfma_f32_16x16x32_bf16 v[188:191],a[196:199],a[92:95],v[188:191]
 ds_read_b64_tr_b16 a[146:147],v8 offset:34816
 ds_read_b64_tr_b16 a[148:149],v8 offset:49152
 v_mfma_f32_16x16x32_bf16 v[192:195],a[192:195],a[96:99],0
 buffer_load_dwordx4 v14,s[4:7],s34 offen offset:2048 lds
 v_mfma_f32_16x16x32_bf16 v[192:195],a[196:199],a[100:103],v[192:195]
 ds_read_b64_tr_b16 a[150:151],v8 offset:51200
 v_mfma_f32_16x16x32_bf16 v[196:199],a[192:195],a[104:107],0
 ds_read_b64_tr_b16 a[152:153],v9 offset:32768
 v_mfma_f32_16x16x32_bf16 v[196:199],a[196:199],a[108:111],v[196:199]
 buffer_load_dwordx4 v15,s[4:7],s35 offen offset:3072 lds
 v_mfma_f32_16x16x32_bf16 v[200:203],a[192:195],a[112:115],0
 ds_read_b64_tr_b16 a[154:155],v9 offset:34816
 v_mfma_f32_16x16x32_bf16 v[200:203],a[196:199],a[116:119],v[200:203]
 s_add_u32 m0,s50,4096
 ds_read_b64_tr_b16 a[156:157],v9 offset:49152
 v_mfma_f32_16x16x32_bf16 v[204:207],a[192:195],a[120:123],0
 v_mfma_f32_16x16x32_bf16 v[204:207],a[196:199],a[124:127],v[204:207]
 s_waitcnt lgkmcnt(8)
 ds_read_b64_tr_b16 a[158:159],v9 offset:51200
 v_mfma_f32_16x16x32_bf16 v[208:211],a[200:203],a[64:67],0
 buffer_load_dwordx4 v14,s[4:7],s36 offen offset:0 lds
 v_mfma_f32_16x16x32_bf16 v[208:211],a[204:207],a[68:71],v[208:211]
 ds_read_b64_tr_b16 a[160:161],v10 offset:32768
 ds_read_b128 a[192:195],v4 offset:12288
 v_mfma_f32_16x16x32_bf16 v[212:215],a[200:203],a[72:75],0
 ds_read_b64_tr_b16 a[162:163],v10 offset:34816
 v_mfma_f32_16x16x32_bf16 v[212:215],a[204:207],a[76:79],v[212:215]
 buffer_load_dword v24,v32,s[8:11],0 offen
 v_mfma_f32_16x16x32_bf16 v[216:219],a[200:203],a[80:83],0
 buffer_load_dwordx4 v15,s[4:7],s37 offen offset:1024 lds
 v_mfma_f32_16x16x32_bf16 v[216:219],a[204:207],a[84:87],v[216:219]
 ds_read_b128 a[196:199],v5 offset:12288
 ds_read_b64_tr_b16 a[164:165],v10 offset:49152
 v_mfma_f32_16x16x32_bf16 v[220:223],a[200:203],a[88:91],0
 ds_read_b64_tr_b16 a[166:167],v10 offset:51200
 ds_read_b64_tr_b16 a[168:169],v11 offset:32768
 v_mfma_f32_16x16x32_bf16 v[220:223],a[204:207],a[92:95],v[220:223]
 buffer_load_dwordx4 v14,s[4:7],s38 offen offset:2048 lds
 v_mfma_f32_16x16x32_bf16 v[224:227],a[200:203],a[96:99],0
 buffer_load_dword v24,v33,s[4:7],0 offen
 v_mfma_f32_16x16x32_bf16 v[224:227],a[204:207],a[100:103],v[224:227]
 buffer_load_dwordx4 v15,s[4:7],s39 offen offset:3072 lds
 v_mfma_f32_16x16x32_bf16 v[228:231],a[200:203],a[104:107],0
 ds_read_b64_tr_b16 a[170:171],v11 offset:34816
 ds_read_b64_tr_b16 a[172:173],v11 offset:49152
 v_mfma_f32_16x16x32_bf16 v[228:231],a[204:207],a[108:111],v[228:231]
 s_add_u32 s4,s4,128
 s_addc_u32 s5,s5,0
 v_mfma_f32_16x16x32_bf16 v[232:235],a[200:203],a[112:115],0
 ds_read_b64_tr_b16 a[174:175],v11 offset:51200
 ds_read_b64_tr_b16 a[176:177],v12 offset:32768
 v_mfma_f32_16x16x32_bf16 v[232:235],a[204:207],a[116:119],v[232:235]
 s_sub_u32 s6,s6,128
 ds_read_b64_tr_b16 a[178:179],v12 offset:34816
 v_mfma_f32_16x16x32_bf16 v[236:239],a[200:203],a[120:123],0
 v_mfma_f32_16x16x32_bf16 v[236:239],a[204:207],a[124:127],v[236:239]
 s_waitcnt lgkmcnt(8)
 s_add_u32 s50,s50,32768
 v_mfma_f32_16x16x32_bf16 v[240:243],a[192:195],a[64:67],0
 ds_read_b64_tr_b16 a[180:181],v12 offset:49152
 ds_read_b64_tr_b16 a[182:183],v12 offset:51200
 v_mfma_f32_16x16x32_bf16 v[240:243],a[196:199],a[68:71],v[240:243]
 ds_read_b128 a[200:203],v4 offset:14336
 v_mfma_f32_16x16x32_bf16 v[244:247],a[192:195],a[72:75],0
 s_cmp_ge_u32 s50,98304
 s_cselect_b32 s50,s51,s50
 v_mfma_f32_16x16x32_bf16 v[244:247],a[196:199],a[76:79],v[244:247]
 ds_read_b64_tr_b16 a[184:185],v13 offset:32768
 ds_read_b128 a[204:207],v5 offset:14336
 v_mfma_f32_16x16x32_bf16 v[248:251],a[192:195],a[80:83],0
 ds_read_b64_tr_b16 a[186:187],v13 offset:34816
 v_mfma_f32_16x16x32_bf16 v[248:251],a[196:199],a[84:87],v[248:251]
 ds_read_b64_tr_b16 a[188:189],v13 offset:49152
 v_mfma_f32_16x16x32_bf16 v[252:255],a[192:195],a[88:91],0
 ds_read_b64_tr_b16 a[190:191],v13 offset:51200
 v_mfma_f32_16x16x32_bf16 v[252:255],a[196:199],a[92:95],v[252:255]
 v_mfma_f32_16x16x32_bf16 a[208:211],a[192:195],a[96:99],0
 v_mfma_f32_16x16x32_bf16 a[208:211],a[196:199],a[100:103],a[208:211]
 s_add_u32 s55,s55,32768
 v_mfma_f32_16x16x32_bf16 a[212:215],a[192:195],a[104:107],0
 s_cmp_ge_u32 s55,98304
 s_cselect_b32 s55,s54,s55
 v_mfma_f32_16x16x32_bf16 a[212:215],a[196:199],a[108:111],a[212:215]
 v_add_u32 v4,s55,v2
 v_mfma_f32_16x16x32_bf16 a[216:219],a[192:195],a[112:115],0
 v_add_u32 v5,s55,v3
 v_mfma_f32_16x16x32_bf16 a[216:219],a[196:199],a[116:119],a[216:219]
 v_mfma_f32_16x16x32_bf16 a[220:223],a[192:195],a[120:123],0
 v_mfma_f32_16x16x32_bf16 a[220:223],a[196:199],a[124:127],a[220:223]
 s_waitcnt vmcnt(18) lgkmcnt(0)
 s_barrier
 v_mfma_f32_16x16x32_bf16 a[224:227],a[200:203],a[64:67],0
 ds_read_b128 a[192:195],v4 offset:0
 v_mfma_f32_16x16x32_bf16 a[224:227],a[204:207],a[68:71],a[224:227]
 ds_read_b128 a[196:199],v5 offset:0
 v_mfma_f32_16x16x32_bf16 a[228:231],a[200:203],a[72:75],0
 v_mfma_f32_16x16x32_bf16 a[228:231],a[204:207],a[76:79],a[228:231]
 v_mfma_f32_16x16x32_bf16 a[232:235],a[200:203],a[80:83],0
 v_mfma_f32_16x16x32_bf16 a[232:235],a[204:207],a[84:87],a[232:235]
 v_mfma_f32_16x16x32_bf16 a[236:239],a[200:203],a[88:91],0
 v_mfma_f32_16x16x32_bf16 a[236:239],a[204:207],a[92:95],a[236:239]
 v_mfma_f32_16x16x32_bf16 a[240:243],a[200:203],a[96:99],0
 v_mfma_f32_16x16x32_bf16 a[240:243],a[204:207],a[100:103],a[240:243]
 v_mfma_f32_16x16x32_bf16 a[244:247],a[200:203],a[104:107],0
 v_mfma_f32_16x16x32_bf16 a[244:247],a[204:207],a[108:111],a[244:247]
 v_mfma_f32_16x16x32_bf16 a[248:251],a[200:203],a[112:115],0
 v_mfma_f32_16x16x32_bf16 a[248:251],a[204:207],a[116:119],a[248:251]
 v_mfma_f32_16x16x32_bf16 a[252:255],a[200:203],a[120:123],0
 v_mfma_f32_16x16x32_bf16 a[252:255],a[204:207],a[124:127],a[252:255]
 s_waitcnt lgkmcnt(0)
 v_mfma_f32_16x16x32_bf16 v[48:51],a[192:195],a[128:131],v[48:51]
 s_add_u32 m0,s51,131072
 v_mfma_f32_16x16x32_bf16 v[48:51],a[196:199],a[132:135],v[48:51]
 ds_read_b128 a[200:203],v4 offset:2048
 v_mfma_f32_16x16x32_bf16 v[52:55],a[192:195],a[136:139],v[52:55]
 v_mfma_f32_16x16x32_bf16 v[52:55],a[196:199],a[140:143],v[52:55]
 ds_read_b128 a[204:207],v5 offset:2048
 v_mfma_f32_16x16x32_bf16 v[56:59],a[192:195],a[144:147],v[56:59]
 buffer_load_dwordx4 v16,s[8:11],s32 offen offset:0 lds
 v_mfma_f32_16x16x32_bf16 v[56:59],a[196:199],a[148:151],v[56:59]
 v_mfma_f32_16x16x32_bf16 v[60:63],a[192:195],a[152:155],v[60:63]
 v_mfma_f32_16x16x32_bf16 v[60:63],a[196:199],a[156:159],v[60:63]
 buffer_load_dwordx4 v17,s[8:11],s33 offen offset:1024 lds
 v_mfma_f32_16x16x32_bf16 v[64:67],a[192:195],a[160:163],v[64:67]
 v_mfma_f32_16x16x32_bf16 v[64:67],a[196:199],a[164:167],v[64:67]
 v_mfma_f32_16x16x32_bf16 v[68:71],a[192:195],a[168:171],v[68:71]
 v_mfma_f32_16x16x32_bf16 v[68:71],a[196:199],a[172:175],v[68:71]
 buffer_load_dwordx4 v16,s[8:11],s34 offen offset:2048 lds
 v_mfma_f32_16x16x32_bf16 v[72:75],a[192:195],a[176:179],v[72:75]
 v_mfma_f32_16x16x32_bf16 v[72:75],a[196:199],a[180:183],v[72:75]
 v_mfma_f32_16x16x32_bf16 v[76:79],a[192:195],a[184:187],v[76:79]
 v_mfma_f32_16x16x32_bf16 v[76:79],a[196:199],a[188:191],v[76:79]
 s_waitcnt lgkmcnt(0)
 v_mfma_f32_16x16x32_bf16 v[80:83],a[200:203],a[128:131],v[80:83]
 buffer_load_dwordx4 v17,s[8:11],s35 offen offset:3072 lds
 v_mfma_f32_16x16x32_bf16 v[80:83],a[204:207],a[132:135],v[80:83]
 ds_read_b128 a[192:195],v4 offset:4096
 v_mfma_f32_16x16x32_bf16 v[84:87],a[200:203],a[136:139],v[84:87]
 v_mfma_f32_16x16x32_bf16 v[84:87],a[204:207],a[140:143],v[84:87]
 ds_read_b128 a[196:199],v5 offset:4096
 s_add_u32 m0,s51,135168
 v_mfma_f32_16x16x32_bf16 v[88:91],a[200:203],a[144:147],v[88:91]
 v_mfma_f32_16x16x32_bf16 v[88:91],a[204:207],a[148:151],v[88:91]
 v_mfma_f32_16x16x32_bf16 v[92:95],a[200:203],a[152:155],v[92:95]
 v_mfma_f32_16x16x32_bf16 v[92:95],a[204:207],a[156:159],v[92:95]
 buffer_load_dwordx4 v18,s[8:11],s36 offen offset:0 lds
 v_mfma_f32_16x16x32_bf16 v[96:99],a[200:203],a[160:163],v[96:99]
 v_mfma_f32_16x16x32_bf16 v[96:99],a[204:207],a[164:167],v[96:99]
 v_mfma_f32_16x16x32_bf16 v[100:103],a[200:203],a[168:171],v[100:103]
 buffer_load_dwordx4 v19,s[8:11],s37 offen offset:1024 lds
 v_mfma_f32_16x16x32_bf16 v[100:103],a[204:207],a[172:175],v[100:103]
 v_mfma_f32_16x16x32_bf16 v[104:107],a[200:203],a[176:179],v[104:107]
 v_mfma_f32_16x16x32_bf16 v[104:107],a[204:207],a[180:183],v[104:107]
 v_mfma_f32_16x16x32_bf16 v[108:111],a[200:203],a[184:187],v[108:111]
 buffer_load_dwordx4 v18,s[8:11],s38 offen offset:2048 lds
 v_mfma_f32_16x16x32_bf16 v[108:111],a[204:207],a[188:191],v[108:111]
 s_waitcnt lgkmcnt(0)
 v_mfma_f32_16x16x32_bf16 v[112:115],a[192:195],a[128:131],v[112:115]
 v_mfma_f32_16x16x32_bf16 v[112:115],a[196:199],a[132:135],v[112:115]
 ds_read_b128 a[200:203],v4 offset:6144
 v_mfma_f32_16x16x32_bf16 v[116:119],a[192:195],a[136:139],v[116:119]
 buffer_load_dwordx4 v19,s[8:11],s39 offen offset:3072 lds
 v_mfma_f32_16x16x32_bf16 v[116:119],a[196:199],a[140:143],v[116:119]
 ds_read_b128 a[204:207],v5 offset:6144
 v_mfma_f32_16x16x32_bf16 v[120:123],a[192:195],a[144:147],v[120:123]
 v_mfma_f32_16x16x32_bf16 v[120:123],a[196:199],a[148:151],v[120:123]
 v_mfma_f32_16x16x32_bf16 v[124:127],a[192:195],a[152:155],v[124:127]
 s_add_u32 s8,s8,524288
 s_addc_u32 s9,s9,0
 v_mfma_f32_16x16x32_bf16 v[124:127],a[196:199],a[156:159],v[124:127]
 v_mfma_f32_16x16x32_bf16 v[128:131],a[192:195],a[160:163],v[128:131]
 v_mfma_f32_16x16x32_bf16 v[128:131],a[196:199],a[164:167],v[128:131]
 v_mfma_f32_16x16x32_bf16 v[132:135],a[192:195],a[168:171],v[132:135]
 s_sub_u32 s10,s10,524288
 v_mfma_f32_16x16x32_bf16 v[132:135],a[196:199],a[172:175],v[132:135]
 v_mfma_f32_16x16x32_bf16 v[136:139],a[192:195],a[176:179],v[136:139]
 v_mfma_f32_16x16x32_bf16 v[136:139],a[196:199],a[180:183],v[136:139]
 v_mfma_f32_16x16x32_bf16 v[140:143],a[192:195],a[184:187],v[140:143]
 s_add_u32 m0,s50,0
 v_mfma_f32_16x16x32_bf16 v[140:143],a[196:199],a[188:191],v[140:143]
 s_waitcnt lgkmcnt(0)
 v_mfma_f32_16x16x32_bf16 v[144:147],a[200:203],a[128:131],v[144:147]
 v_mfma_f32_16x16x32_bf16 v[144:147],a[204:207],a[132:135],v[144:147]
 ds_read_b128 a[192:195],v4 offset:8192
 v_mfma_f32_16x16x32_bf16 v[148:151],a[200:203],a[136:139],v[148:151]
 buffer_load_dwordx4 v14,s[4:7],s32 offen offset:0 lds
 v_mfma_f32_16x16x32_bf16 v[148:151],a[204:207],a[140:143],v[148:151]
 ds_read_b128 a[196:199],v5 offset:8192
 v_mfma_f32_16x16x32_bf16 v[152:155],a[200:203],a[144:147],v[152:155]
 v_mfma_f32_16x16x32_bf16 v[152:155],a[204:207],a[148:151],v[152:155]
 buffer_load_dwordx4 v15,s[4:7],s33 offen offset:1024 lds
 v_mfma_f32_16x16x32_bf16 v[156:159],a[200:203],a[152:155],v[156:159]
 v_mfma_f32_16x16x32_bf16 v[156:159],a[204:207],a[156:159],v[156:159]
 v_mfma_f32_16x16x32_bf16 v[160:163],a[200:203],a[160:163],v[160:163]
 s_waitcnt vmcnt(20)
 s_barrier
 v_mfma_f32_16x16x32_bf16 v[160:163],a[204:207],a[164:167],v[160:163]
 ds_read_b64_tr_b16 a[64:65],v6 offset:0
 v_mfma_f32_16x16x32_bf16 v[164:167],a[200:203],a[168:171],v[164:167]
 buffer_load_dwordx4 v14,s[4:7],s34 offen offset:2048 lds
 v_mfma_f32_16x16x32_bf16 v[164:167],a[204:207],a[172:175],v[164:167]
 ds_read_b64_tr_b16 a[66:67],v6 offset:2048
 ds_read_b64_tr_b16 a[68:69],v6 offset:16384
 v_mfma_f32_16x16x32_bf16 v[168:171],a[200:203],a[176:179],v[168:171]
 v_mfma_f32_16x16x32_bf16 v[168:171],a[204:207],a[180:183],v[168:171]
 ds_read_b64_tr_b16 a[70:71],v6 offset:18432
 v_mfma_f32_16x16x32_bf16 v[172:175],a[200:203],a[184:187],v[172:175]
 buffer_load_dwordx4 v15,s[4:7],s35 offen offset:3072 lds
 v_mfma_f32_16x16x32_bf16 v[172:175],a[204:207],a[188:191],v[172:175]
 s_waitcnt lgkmcnt(4)
 ds_read_b64_tr_b16 a[72:73],v7 offset:0
 v_mfma_f32_16x16x32_bf16 v[176:179],a[192:195],a[128:131],v[176:179]
 ds_read_b64_tr_b16 a[74:75],v7 offset:2048
 v_mfma_f32_16x16x32_bf16 v[176:179],a[196:199],a[132:135],v[176:179]
 ds_read_b128 a[200:203],v4 offset:10240
 s_add_u32 m0,s50,4096
 v_mfma_f32_16x16x32_bf16 v[180:183],a[192:195],a[136:139],v[180:183]
 ds_read_b64_tr_b16 a[76:77],v7 offset:16384
 v_mfma_f32_16x16x32_bf16 v[180:183],a[196:199],a[140:143],v[180:183]
 ds_read_b128 a[204:207],v5 offset:10240
 ds_read_b64_tr_b16 a[78:79],v7 offset:18432
 v_mfma_f32_16x16x32_bf16 v[184:187],a[192:195],a[144:147],v[184:187]
 ds_read_b64_tr_b16 a[80:81],v8 offset:0
 v_mfma_f32_16x16x32_bf16 v[184:187],a[196:199],a[148:151],v[184:187]
 buffer_load_dwordx4 v14,s[4:7],s36 offen offset:0 lds
 v_mfma_f32_16x16x32_bf16 v[188:191],a[192:195],a[152:155],v[188:191]
 ds_read_b64_tr_b16 a[82:83],v8 offset:2048
 v_mfma_f32_16x16x32_bf16 v[188:191],a[196:199],a[156:159],v[188:191]
 ds_read_b64_tr_b16 a[84:85],v8 offset:16384
 v_mfma_f32_16x16x32_bf16 v[192:195],a[192:195],a[160:163],v[192:195]
 v_mfma_f32_16x16x32_bf16 v[192:195],a[196:199],a[164:167],v[192:195]
 buffer_load_dwordx4 v15,s[4:7],s37 offen offset:1024 lds
 v_mfma_f32_16x16x32_bf16 v[196:199],a[192:195],a[168:171],v[196:199]
 ds_read_b64_tr_b16 a[86:87],v8 offset:18432
 ds_read_b64_tr_b16 a[88:89],v9 offset:0
 v_mfma_f32_16x16x32_bf16 v[196:199],a[196:199],a[172:175],v[196:199]
 v_mfma_f32_16x16x32_bf16 v[200:203],a[192:195],a[176:179],v[200:203]
 ds_read_b64_tr_b16 a[90:91],v9 offset:2048
 v_mfma_f32_16x16x32_bf16 v[200:203],a[196:199],a[180:183],v[200:203]
 buffer_load_dwordx4 v14,s[4:7],s38 offen offset:2048 lds
 v_mfma_f32_16x16x32_bf16 v[204:207],a[192:195],a[184:187],v[204:207]
 ds_read_b64_tr_b16 a[92:93],v9 offset:16384
 v_mfma_f32_16x16x32_bf16 v[204:207],a[196:199],a[188:191],v[204:207]
 s_waitcnt lgkmcnt(8)
 ds_read_b64_tr_b16 a[94:95],v9 offset:18432
 v_mfma_f32_16x16x32_bf16 v[208:211],a[200:203],a[128:131],v[208:211]
 ds_read_b64_tr_b16 a[96:97],v10 offset:0
 v_mfma_f32_16x16x32_bf16 v[208:211],a[204:207],a[132:135],v[208:211]
 buffer_load_dwordx4 v15,s[4:7],s39 offen offset:3072 lds
 v_mfma_f32_16x16x32_bf16 v[212:215],a[200:203],a[136:139],v[212:215]
 ds_read_b128 a[192:195],v4 offset:12288
 ds_read_b64_tr_b16 a[98:99],v10 offset:2048
 v_mfma_f32_16x16x32_bf16 v[212:215],a[204:207],a[140:143],v[212:215]
 buffer_load_dword v24,v35,s[24:27],0 offen
 v_mfma_f32_16x16x32_bf16 v[216:219],a[200:203],a[144:147],v[216:219]
 ds_read_b128 a[196:199],v5 offset:12288
 v_add_u32 v35,0x80,v35
 v_mfma_f32_16x16x32_bf16 v[216:219],a[204:207],a[148:151],v[216:219]
 ds_read_b64_tr_b16 a[100:101],v10 offset:16384
 ds_read_b64_tr_b16 a[102:103],v10 offset:18432
 v_mfma_f32_16x16x32_bf16 v[220:223],a[200:203],a[152:155],v[220:223]
 s_add_u32 s4,s4,128
 s_addc_u32 s5,s5,0
 v_mfma_f32_16x16x32_bf16 v[220:223],a[204:207],a[156:159],v[220:223]
 buffer_load_dword v24,v36,s[72:75],0 offen
 v_mfma_f32_16x16x32_bf16 v[224:227],a[200:203],a[160:163],v[224:227]
 ds_read_b64_tr_b16 a[104:105],v11 offset:0
 v_add_u32 v36,0x2a000,v36
 v_mfma_f32_16x16x32_bf16 v[224:227],a[204:207],a[164:167],v[224:227]
 buffer_load_dword v24,v37,s[40:43],0 offen
 v_mfma_f32_16x16x32_bf16 v[228:231],a[200:203],a[168:171],v[228:231]
 ds_read_b64_tr_b16 a[106:107],v11 offset:2048
 s_sub_u32 s6,s6,128
 v_mfma_f32_16x16x32_bf16 v[228:231],a[204:207],a[172:175],v[228:231]
 buffer_load_dword v24,v37,s[64:67],0 offen
 v_mfma_f32_16x16x32_bf16 v[232:235],a[200:203],a[176:179],v[232:235]
 ds_read_b64_tr_b16 a[108:109],v11 offset:16384
 v_add_u32 v37,0x1180,v37
 v_mfma_f32_16x16x32_bf16 v[232:235],a[204:207],a[180:183],v[232:235]
 ds_read_b64_tr_b16 a[110:111],v11 offset:18432
 ds_read_b64_tr_b16 a[112:113],v12 offset:0
 v_mfma_f32_16x16x32_bf16 v[236:239],a[200:203],a[184:187],v[236:239]
 s_add_u32 s50,s50,32768
 ds_read_b64_tr_b16 a[114:115],v12 offset:2048
 v_mfma_f32_16x16x32_bf16 v[236:239],a[204:207],a[188:191],v[236:239]
 s_waitcnt lgkmcnt(8)
 ds_read_b64_tr_b16 a[116:117],v12 offset:16384
 v_mfma_f32_16x16x32_bf16 v[240:243],a[192:195],a[128:131],v[240:243]
 s_cmp_ge_u32 s50,98304
 s_cselect_b32 s50,s51,s50
 v_mfma_f32_16x16x32_bf16 v[240:243],a[196:199],a[132:135],v[240:243]
 ds_read_b64_tr_b16 a[118:119],v12 offset:18432
 ds_read_b128 a[200:203],v4 offset:14336
 v_mfma_f32_16x16x32_bf16 v[244:247],a[192:195],a[136:139],v[244:247]
 ds_read_b64_tr_b16 a[120:121],v13 offset:0
 v_mfma_f32_16x16x32_bf16 v[244:247],a[196:199],a[140:143],v[244:247]
 ds_read_b128 a[204:207],v5 offset:14336
 ds_read_b64_tr_b16 a[122:123],v13 offset:2048
 v_mfma_f32_16x16x32_bf16 v[248:251],a[192:195],a[144:147],v[248:251]
 v_mfma_f32_16x16x32_bf16 v[248:251],a[196:199],a[148:151],v[248:251]
 ds_read_b64_tr_b16 a[124:125],v13 offset:16384
 v_mfma_f32_16x16x32_bf16 v[252:255],a[192:195],a[152:155],v[252:255]
 ds_read_b64_tr_b16 a[126:127],v13 offset:18432
 v_mfma_f32_16x16x32_bf16 v[252:255],a[196:199],a[156:159],v[252:255]
 v_mfma_f32_16x16x32_bf16 a[208:211],a[192:195],a[160:163],a[208:211]
 v_mfma_f32_16x16x32_bf16 a[208:211],a[196:199],a[164:167],a[208:211]
 s_add_u32 s55,s55,32768
 v_mfma_f32_16x16x32_bf16 a[212:215],a[192:195],a[168:171],a[212:215]
 s_cmp_ge_u32 s55,98304
 s_cselect_b32 s55,s54,s55
 v_mfma_f32_16x16x32_bf16 a[212:215],a[196:199],a[172:175],a[212:215]
 v_add_u32 v4,s55,v2
 v_mfma_f32_16x16x32_bf16 a[216:219],a[192:195],a[176:179],a[216:219]
 v_add_u32 v5,s55,v3
 v_mfma_f32_16x16x32_bf16 a[216:219],a[196:199],a[180:183],a[216:219]
 v_mfma_f32_16x16x32_bf16 a[220:223],a[192:195],a[184:187],a[220:223]
 v_mfma_f32_16x16x32_bf16 a[220:223],a[196:199],a[188:191],a[220:223]
 s_waitcnt vmcnt(20) lgkmcnt(0)
 s_barrier
 v_mfma_f32_16x16x32_bf16 a[224:227],a[200:203],a[128:131],a[224:227]
 ds_read_b128 a[192:195],v4 offset:0
 v_mfma_f32_16x16x32_bf16 a[224:227],a[204:207],a[132:135],a[224:227]
 ds_read_b128 a[196:199],v5 offset:0
 v_mfma_f32_16x16x32_bf16 a[228:231],a[200:203],a[136:139],a[228:231]
 v_mfma_f32_16x16x32_bf16 a[228:231],a[204:207],a[140:143],a[228:231]
 v_mfma_f32_16x16x32_bf16 a[232:235],a[200:203],a[144:147],a[232:235]
 v_mfma_f32_16x16x32_bf16 a[232:235],a[204:207],a[148:151],a[232:235]
 v_mfma_f32_16x16x32_bf16 a[236:239],a[200:203],a[152:155],a[236:239]
 v_mfma_f32_16x16x32_bf16 a[236:239],a[204:207],a[156:159],a[236:239]
 v_mfma_f32_16x16x32_bf16 a[240:243],a[200:203],a[160:163],a[240:243]
 v_mfma_f32_16x16x32_bf16 a[240:243],a[204:207],a[164:167],a[240:243]
 v_mfma_f32_16x16x32_bf16 a[244:247],a[200:203],a[168:171],a[244:247]
 v_mfma_f32_16x16x32_bf16 a[244:247],a[204:207],a[172:175],a[244:247]
 v_mfma_f32_16x16x32_bf16 a[248:251],a[200:203],a[176:179],a[248:251]
 v_mfma_f32_16x16x32_bf16 a[248:251],a[204:207],a[180:183],a[248:251]
 v_mfma_f32_16x16x32_bf16 a[252:255],a[200:203],a[184:187],a[252:255]
 v_mfma_f32_16x16x32_bf16 a[252:255],a[204:207],a[188:191],a[252:255]
 s_waitcnt lgkmcnt(0)
 s_mov_b32 s49,6
.p2align 6
KVL_11:
 v_mfma_f32_16x16x32_bf16 v[48:51],a[192:195],a[64:67],v[48:51]
 s_add_u32 m0,s51,98304
 v_mfma_f32_16x16x32_bf16 v[48:51],a[196:199],a[68:71],v[48:51]
 ds_read_b128 a[200:203],v4 offset:2048
 v_mfma_f32_16x16x32_bf16 v[52:55],a[192:195],a[72:75],v[52:55]
 v_mfma_f32_16x16x32_bf16 v[52:55],a[196:199],a[76:79],v[52:55]
 ds_read_b128 a[204:207],v5 offset:2048
 v_mfma_f32_16x16x32_bf16 v[56:59],a[192:195],a[80:83],v[56:59]
 buffer_load_dwordx4 v16,s[8:11],s32 offen offset:0 lds
 v_mfma_f32_16x16x32_bf16 v[56:59],a[196:199],a[84:87],v[56:59]
 v_mfma_f32_16x16x32_bf16 v[60:63],a[192:195],a[88:91],v[60:63]
 v_mfma_f32_16x16x32_bf16 v[60:63],a[196:199],a[92:95],v[60:63]
 buffer_load_dwordx4 v17,s[8:11],s33 offen offset:1024 lds
 v_mfma_f32_16x16x32_bf16 v[64:67],a[192:195],a[96:99],v[64:67]
 v_mfma_f32_16x16x32_bf16 v[64:67],a[196:199],a[100:103],v[64:67]
 v_mfma_f32_16x16x32_bf16 v[68:71],a[192:195],a[104:107],v[68:71]
 v_mfma_f32_16x16x32_bf16 v[68:71],a[196:199],a[108:111],v[68:71]
 buffer_load_dwordx4 v16,s[8:11],s34 offen offset:2048 lds
 v_mfma_f32_16x16x32_bf16 v[72:75],a[192:195],a[112:115],v[72:75]
 v_mfma_f32_16x16x32_bf16 v[72:75],a[196:199],a[116:119],v[72:75]
 v_mfma_f32_16x16x32_bf16 v[76:79],a[192:195],a[120:123],v[76:79]
 v_mfma_f32_16x16x32_bf16 v[76:79],a[196:199],a[124:127],v[76:79]
 s_waitcnt lgkmcnt(0)
 v_mfma_f32_16x16x32_bf16 v[80:83],a[200:203],a[64:67],v[80:83]
 buffer_load_dwordx4 v17,s[8:11],s35 offen offset:3072 lds
 v_mfma_f32_16x16x32_bf16 v[80:83],a[204:207],a[68:71],v[80:83]
 ds_read_b128 a[192:195],v4 offset:4096
 v_mfma_f32_16x16x32_bf16 v[84:87],a[200:203],a[72:75],v[84:87]
 v_mfma_f32_16x16x32_bf16 v[84:87],a[204:207],a[76:79],v[84:87]
 ds_read_b128 a[196:199],v5 offset:4096
 s_add_u32 m0,s51,102400
 v_mfma_f32_16x16x32_bf16 v[88:91],a[200:203],a[80:83],v[88:91]
 v_mfma_f32_16x16x32_bf16 v[88:91],a[204:207],a[84:87],v[88:91]
 v_mfma_f32_16x16x32_bf16 v[92:95],a[200:203],a[88:91],v[92:95]
 v_mfma_f32_16x16x32_bf16 v[92:95],a[204:207],a[92:95],v[92:95]
 buffer_load_dwordx4 v18,s[8:11],s36 offen offset:0 lds
 v_mfma_f32_16x16x32_bf16 v[96:99],a[200:203],a[96:99],v[96:99]
 v_mfma_f32_16x16x32_bf16 v[96:99],a[204:207],a[100:103],v[96:99]
 v_mfma_f32_16x16x32_bf16 v[100:103],a[200:203],a[104:107],v[100:103]
 buffer_load_dwordx4 v19,s[8:11],s37 offen offset:1024 lds
 v_mfma_f32_16x16x32_bf16 v[100:103],a[204:207],a[108:111],v[100:103]
 v_mfma_f32_16x16x32_bf16 v[104:107],a[200:203],a[112:115],v[104:107]
 v_mfma_f32_16x16x32_bf16 v[104:107],a[204:207],a[116:119],v[104:107]
 v_mfma_f32_16x16x32_bf16 v[108:111],a[200:203],a[120:123],v[108:111]
 buffer_load_dwordx4 v18,s[8:11],s38 offen offset:2048 lds
 v_mfma_f32_16x16x32_bf16 v[108:111],a[204:207],a[124:127],v[108:111]
 s_waitcnt lgkmcnt(0)
 v_mfma_f32_16x16x32_bf16 v[112:115],a[192:195],a[64:67],v[112:115]
 v_mfma_f32_16x16x32_bf16 v[112:115],a[196:199],a[68:71],v[112:115]
 ds_read_b128 a[200:203],v4 offset:6144
 v_mfma_f32_16x16x32_bf16 v[116:119],a[192:195],a[72:75],v[116:119]
 buffer_load_dwordx4 v19,s[8:11],s39 offen offset:3072 lds
 v_mfma_f32_16x16x32_bf16 v[116:119],a[196:199],a[76:79],v[116:119]
 ds_read_b128 a[204:207],v5 offset:6144
 v_mfma_f32_16x16x32_bf16 v[120:123],a[192:195],a[80:83],v[120:123]
 v_mfma_f32_16x16x32_bf16 v[120:123],a[196:199],a[84:87],v[120:123]
 v_mfma_f32_16x16x32_bf16 v[124:127],a[192:195],a[88:91],v[124:127]
 s_add_u32 s8,s8,524288
 s_addc_u32 s9,s9,0
 v_mfma_f32_16x16x32_bf16 v[124:127],a[196:199],a[92:95],v[124:127]
 v_mfma_f32_16x16x32_bf16 v[128:131],a[192:195],a[96:99],v[128:131]
 v_mfma_f32_16x16x32_bf16 v[128:131],a[196:199],a[100:103],v[128:131]
 v_mfma_f32_16x16x32_bf16 v[132:135],a[192:195],a[104:107],v[132:135]
 s_sub_u32 s10,s10,524288
 v_mfma_f32_16x16x32_bf16 v[132:135],a[196:199],a[108:111],v[132:135]
 v_mfma_f32_16x16x32_bf16 v[136:139],a[192:195],a[112:115],v[136:139]
 v_mfma_f32_16x16x32_bf16 v[136:139],a[196:199],a[116:119],v[136:139]
 v_mfma_f32_16x16x32_bf16 v[140:143],a[192:195],a[120:123],v[140:143]
 s_add_u32 m0,s50,0
 v_mfma_f32_16x16x32_bf16 v[140:143],a[196:199],a[124:127],v[140:143]
 s_waitcnt lgkmcnt(0)
 v_mfma_f32_16x16x32_bf16 v[144:147],a[200:203],a[64:67],v[144:147]
 v_mfma_f32_16x16x32_bf16 v[144:147],a[204:207],a[68:71],v[144:147]
 ds_read_b128 a[192:195],v4 offset:8192
 v_mfma_f32_16x16x32_bf16 v[148:151],a[200:203],a[72:75],v[148:151]
 buffer_load_dwordx4 v14,s[4:7],s32 offen offset:0 lds
 v_mfma_f32_16x16x32_bf16 v[148:151],a[204:207],a[76:79],v[148:151]
 ds_read_b128 a[196:199],v5 offset:8192
 v_mfma_f32_16x16x32_bf16 v[152:155],a[200:203],a[80:83],v[152:155]
 v_mfma_f32_16x16x32_bf16 v[152:155],a[204:207],a[84:87],v[152:155]
 buffer_load_dwordx4 v15,s[4:7],s33 offen offset:1024 lds
 v_mfma_f32_16x16x32_bf16 v[156:159],a[200:203],a[88:91],v[156:159]
 v_mfma_f32_16x16x32_bf16 v[156:159],a[204:207],a[92:95],v[156:159]
 v_mfma_f32_16x16x32_bf16 v[160:163],a[200:203],a[96:99],v[160:163]
 s_waitcnt vmcnt(22)
 s_barrier
 v_mfma_f32_16x16x32_bf16 v[160:163],a[204:207],a[100:103],v[160:163]
 ds_read_b64_tr_b16 a[128:129],v6 offset:32768
 v_mfma_f32_16x16x32_bf16 v[164:167],a[200:203],a[104:107],v[164:167]
 buffer_load_dwordx4 v14,s[4:7],s34 offen offset:2048 lds
 v_mfma_f32_16x16x32_bf16 v[164:167],a[204:207],a[108:111],v[164:167]
 ds_read_b64_tr_b16 a[130:131],v6 offset:34816
 ds_read_b64_tr_b16 a[132:133],v6 offset:49152
 v_mfma_f32_16x16x32_bf16 v[168:171],a[200:203],a[112:115],v[168:171]
 v_mfma_f32_16x16x32_bf16 v[168:171],a[204:207],a[116:119],v[168:171]
 ds_read_b64_tr_b16 a[134:135],v6 offset:51200
 v_mfma_f32_16x16x32_bf16 v[172:175],a[200:203],a[120:123],v[172:175]
 buffer_load_dwordx4 v15,s[4:7],s35 offen offset:3072 lds
 v_mfma_f32_16x16x32_bf16 v[172:175],a[204:207],a[124:127],v[172:175]
 s_waitcnt lgkmcnt(4)
 ds_read_b64_tr_b16 a[136:137],v7 offset:32768
 v_mfma_f32_16x16x32_bf16 v[176:179],a[192:195],a[64:67],v[176:179]
 ds_read_b64_tr_b16 a[138:139],v7 offset:34816
 v_mfma_f32_16x16x32_bf16 v[176:179],a[196:199],a[68:71],v[176:179]
 ds_read_b128 a[200:203],v4 offset:10240
 s_add_u32 m0,s50,4096
 v_mfma_f32_16x16x32_bf16 v[180:183],a[192:195],a[72:75],v[180:183]
 ds_read_b64_tr_b16 a[140:141],v7 offset:49152
 v_mfma_f32_16x16x32_bf16 v[180:183],a[196:199],a[76:79],v[180:183]
 ds_read_b128 a[204:207],v5 offset:10240
 ds_read_b64_tr_b16 a[142:143],v7 offset:51200
 v_mfma_f32_16x16x32_bf16 v[184:187],a[192:195],a[80:83],v[184:187]
 ds_read_b64_tr_b16 a[144:145],v8 offset:32768
 v_mfma_f32_16x16x32_bf16 v[184:187],a[196:199],a[84:87],v[184:187]
 buffer_load_dwordx4 v14,s[4:7],s36 offen offset:0 lds
 v_mfma_f32_16x16x32_bf16 v[188:191],a[192:195],a[88:91],v[188:191]
 ds_read_b64_tr_b16 a[146:147],v8 offset:34816
 v_mfma_f32_16x16x32_bf16 v[188:191],a[196:199],a[92:95],v[188:191]
 ds_read_b64_tr_b16 a[148:149],v8 offset:49152
 v_mfma_f32_16x16x32_bf16 v[192:195],a[192:195],a[96:99],v[192:195]
 v_mfma_f32_16x16x32_bf16 v[192:195],a[196:199],a[100:103],v[192:195]
 buffer_load_dwordx4 v15,s[4:7],s37 offen offset:1024 lds
 v_mfma_f32_16x16x32_bf16 v[196:199],a[192:195],a[104:107],v[196:199]
 ds_read_b64_tr_b16 a[150:151],v8 offset:51200
 ds_read_b64_tr_b16 a[152:153],v9 offset:32768
 v_mfma_f32_16x16x32_bf16 v[196:199],a[196:199],a[108:111],v[196:199]
 v_mfma_f32_16x16x32_bf16 v[200:203],a[192:195],a[112:115],v[200:203]
 ds_read_b64_tr_b16 a[154:155],v9 offset:34816
 v_mfma_f32_16x16x32_bf16 v[200:203],a[196:199],a[116:119],v[200:203]
 buffer_load_dwordx4 v14,s[4:7],s38 offen offset:2048 lds
 v_mfma_f32_16x16x32_bf16 v[204:207],a[192:195],a[120:123],v[204:207]
 ds_read_b64_tr_b16 a[156:157],v9 offset:49152
 v_mfma_f32_16x16x32_bf16 v[204:207],a[196:199],a[124:127],v[204:207]
 s_waitcnt lgkmcnt(8)
 ds_read_b64_tr_b16 a[158:159],v9 offset:51200
 v_mfma_f32_16x16x32_bf16 v[208:211],a[200:203],a[64:67],v[208:211]
 ds_read_b64_tr_b16 a[160:161],v10 offset:32768
 v_mfma_f32_16x16x32_bf16 v[208:211],a[204:207],a[68:71],v[208:211]
 buffer_load_dwordx4 v15,s[4:7],s39 offen offset:3072 lds
 v_mfma_f32_16x16x32_bf16 v[212:215],a[200:203],a[72:75],v[212:215]
 ds_read_b128 a[192:195],v4 offset:12288
 ds_read_b64_tr_b16 a[162:163],v10 offset:34816
 v_mfma_f32_16x16x32_bf16 v[212:215],a[204:207],a[76:79],v[212:215]
 buffer_load_dword v24,v32,s[8:11],0 offen
 v_mfma_f32_16x16x32_bf16 v[216:219],a[200:203],a[80:83],v[216:219]
 ds_read_b128 a[196:199],v5 offset:12288
 ds_read_b64_tr_b16 a[164:165],v10 offset:49152
 v_mfma_f32_16x16x32_bf16 v[216:219],a[204:207],a[84:87],v[216:219]
 s_add_u32 s4,s4,128
 s_addc_u32 s5,s5,0
 v_mfma_f32_16x16x32_bf16 v[220:223],a[200:203],a[88:91],v[220:223]
 ds_read_b64_tr_b16 a[166:167],v10 offset:51200
 ds_read_b64_tr_b16 a[168:169],v11 offset:32768
 v_mfma_f32_16x16x32_bf16 v[220:223],a[204:207],a[92:95],v[220:223]
 buffer_load_dword v24,v33,s[4:7],0 offen
 v_mfma_f32_16x16x32_bf16 v[224:227],a[200:203],a[96:99],v[224:227]
 ds_read_b64_tr_b16 a[170:171],v11 offset:34816
 s_sub_u32 s6,s6,128
 v_mfma_f32_16x16x32_bf16 v[224:227],a[204:207],a[100:103],v[224:227]
 ds_read_b64_tr_b16 a[172:173],v11 offset:49152
 v_mfma_f32_16x16x32_bf16 v[228:231],a[200:203],a[104:107],v[228:231]
 ds_read_b64_tr_b16 a[174:175],v11 offset:51200
 v_mfma_f32_16x16x32_bf16 v[228:231],a[204:207],a[108:111],v[228:231]
 v_mfma_f32_16x16x32_bf16 v[232:235],a[200:203],a[112:115],v[232:235]
 ds_read_b64_tr_b16 a[176:177],v12 offset:32768
 s_add_u32 s50,s50,32768
 v_mfma_f32_16x16x32_bf16 v[232:235],a[204:207],a[116:119],v[232:235]
 ds_read_b64_tr_b16 a[178:179],v12 offset:34816
 v_mfma_f32_16x16x32_bf16 v[236:239],a[200:203],a[120:123],v[236:239]
 v_mfma_f32_16x16x32_bf16 v[236:239],a[204:207],a[124:127],v[236:239]
 s_waitcnt lgkmcnt(8)
 ds_read_b64_tr_b16 a[180:181],v12 offset:49152
 v_mfma_f32_16x16x32_bf16 v[240:243],a[192:195],a[64:67],v[240:243]
 s_cmp_ge_u32 s50,98304
 s_cselect_b32 s50,s51,s50
 v_mfma_f32_16x16x32_bf16 v[240:243],a[196:199],a[68:71],v[240:243]
 ds_read_b64_tr_b16 a[182:183],v12 offset:51200
 ds_read_b128 a[200:203],v4 offset:14336
 v_mfma_f32_16x16x32_bf16 v[244:247],a[192:195],a[72:75],v[244:247]
 ds_read_b64_tr_b16 a[184:185],v13 offset:32768
 v_mfma_f32_16x16x32_bf16 v[244:247],a[196:199],a[76:79],v[244:247]
 ds_read_b128 a[204:207],v5 offset:14336
 ds_read_b64_tr_b16 a[186:187],v13 offset:34816
 v_mfma_f32_16x16x32_bf16 v[248:251],a[192:195],a[80:83],v[248:251]
 v_mfma_f32_16x16x32_bf16 v[248:251],a[196:199],a[84:87],v[248:251]
 ds_read_b64_tr_b16 a[188:189],v13 offset:49152
 v_mfma_f32_16x16x32_bf16 v[252:255],a[192:195],a[88:91],v[252:255]
 ds_read_b64_tr_b16 a[190:191],v13 offset:51200
 v_mfma_f32_16x16x32_bf16 v[252:255],a[196:199],a[92:95],v[252:255]
 v_mfma_f32_16x16x32_bf16 a[208:211],a[192:195],a[96:99],a[208:211]
 v_mfma_f32_16x16x32_bf16 a[208:211],a[196:199],a[100:103],a[208:211]
 s_add_u32 s55,s55,32768
 v_mfma_f32_16x16x32_bf16 a[212:215],a[192:195],a[104:107],a[212:215]
 s_cmp_ge_u32 s55,98304
 s_cselect_b32 s55,s54,s55
 v_mfma_f32_16x16x32_bf16 a[212:215],a[196:199],a[108:111],a[212:215]
 v_add_u32 v4,s55,v2
 v_mfma_f32_16x16x32_bf16 a[216:219],a[192:195],a[112:115],a[216:219]
 v_add_u32 v5,s55,v3
 v_mfma_f32_16x16x32_bf16 a[216:219],a[196:199],a[116:119],a[216:219]
 v_mfma_f32_16x16x32_bf16 a[220:223],a[192:195],a[120:123],a[220:223]
 v_mfma_f32_16x16x32_bf16 a[220:223],a[196:199],a[124:127],a[220:223]
 s_waitcnt vmcnt(22) lgkmcnt(0)
 s_barrier
 v_mfma_f32_16x16x32_bf16 a[224:227],a[200:203],a[64:67],a[224:227]
 ds_read_b128 a[192:195],v4 offset:0
 v_mfma_f32_16x16x32_bf16 a[224:227],a[204:207],a[68:71],a[224:227]
 ds_read_b128 a[196:199],v5 offset:0
 v_mfma_f32_16x16x32_bf16 a[228:231],a[200:203],a[72:75],a[228:231]
 v_mfma_f32_16x16x32_bf16 a[228:231],a[204:207],a[76:79],a[228:231]
 v_mfma_f32_16x16x32_bf16 a[232:235],a[200:203],a[80:83],a[232:235]
 v_mfma_f32_16x16x32_bf16 a[232:235],a[204:207],a[84:87],a[232:235]
 v_mfma_f32_16x16x32_bf16 a[236:239],a[200:203],a[88:91],a[236:239]
 v_mfma_f32_16x16x32_bf16 a[236:239],a[204:207],a[92:95],a[236:239]
 v_mfma_f32_16x16x32_bf16 a[240:243],a[200:203],a[96:99],a[240:243]
 v_mfma_f32_16x16x32_bf16 a[240:243],a[204:207],a[100:103],a[240:243]
 v_mfma_f32_16x16x32_bf16 a[244:247],a[200:203],a[104:107],a[244:247]
 v_mfma_f32_16x16x32_bf16 a[244:247],a[204:207],a[108:111],a[244:247]
 v_mfma_f32_16x16x32_bf16 a[248:251],a[200:203],a[112:115],a[248:251]
 v_mfma_f32_16x16x32_bf16 a[248:251],a[204:207],a[116:119],a[248:251]
 v_mfma_f32_16x16x32_bf16 a[252:255],a[200:203],a[120:123],a[252:255]
 v_mfma_f32_16x16x32_bf16 a[252:255],a[204:207],a[124:127],a[252:255]
 s_waitcnt lgkmcnt(0)
 v_mfma_f32_16x16x32_bf16 v[48:51],a[192:195],a[128:131],v[48:51]
 s_add_u32 m0,s51,131072
 v_mfma_f32_16x16x32_bf16 v[48:51],a[196:199],a[132:135],v[48:51]
 ds_read_b128 a[200:203],v4 offset:2048
 v_mfma_f32_16x16x32_bf16 v[52:55],a[192:195],a[136:139],v[52:55]
 v_mfma_f32_16x16x32_bf16 v[52:55],a[196:199],a[140:143],v[52:55]
 ds_read_b128 a[204:207],v5 offset:2048
 v_mfma_f32_16x16x32_bf16 v[56:59],a[192:195],a[144:147],v[56:59]
 buffer_load_dwordx4 v16,s[8:11],s32 offen offset:0 lds
 v_mfma_f32_16x16x32_bf16 v[56:59],a[196:199],a[148:151],v[56:59]
 v_mfma_f32_16x16x32_bf16 v[60:63],a[192:195],a[152:155],v[60:63]
 v_mfma_f32_16x16x32_bf16 v[60:63],a[196:199],a[156:159],v[60:63]
 buffer_load_dwordx4 v17,s[8:11],s33 offen offset:1024 lds
 v_mfma_f32_16x16x32_bf16 v[64:67],a[192:195],a[160:163],v[64:67]
 v_mfma_f32_16x16x32_bf16 v[64:67],a[196:199],a[164:167],v[64:67]
 v_mfma_f32_16x16x32_bf16 v[68:71],a[192:195],a[168:171],v[68:71]
 v_mfma_f32_16x16x32_bf16 v[68:71],a[196:199],a[172:175],v[68:71]
 buffer_load_dwordx4 v16,s[8:11],s34 offen offset:2048 lds
 v_mfma_f32_16x16x32_bf16 v[72:75],a[192:195],a[176:179],v[72:75]
 v_mfma_f32_16x16x32_bf16 v[72:75],a[196:199],a[180:183],v[72:75]
 v_mfma_f32_16x16x32_bf16 v[76:79],a[192:195],a[184:187],v[76:79]
 v_mfma_f32_16x16x32_bf16 v[76:79],a[196:199],a[188:191],v[76:79]
 s_waitcnt lgkmcnt(0)
 v_mfma_f32_16x16x32_bf16 v[80:83],a[200:203],a[128:131],v[80:83]
 buffer_load_dwordx4 v17,s[8:11],s35 offen offset:3072 lds
 v_mfma_f32_16x16x32_bf16 v[80:83],a[204:207],a[132:135],v[80:83]
 ds_read_b128 a[192:195],v4 offset:4096
 v_mfma_f32_16x16x32_bf16 v[84:87],a[200:203],a[136:139],v[84:87]
 v_mfma_f32_16x16x32_bf16 v[84:87],a[204:207],a[140:143],v[84:87]
 ds_read_b128 a[196:199],v5 offset:4096
 s_add_u32 m0,s51,135168
 v_mfma_f32_16x16x32_bf16 v[88:91],a[200:203],a[144:147],v[88:91]
 v_mfma_f32_16x16x32_bf16 v[88:91],a[204:207],a[148:151],v[88:91]
 v_mfma_f32_16x16x32_bf16 v[92:95],a[200:203],a[152:155],v[92:95]
 v_mfma_f32_16x16x32_bf16 v[92:95],a[204:207],a[156:159],v[92:95]
 buffer_load_dwordx4 v18,s[8:11],s36 offen offset:0 lds
 v_mfma_f32_16x16x32_bf16 v[96:99],a[200:203],a[160:163],v[96:99]
 v_mfma_f32_16x16x32_bf16 v[96:99],a[204:207],a[164:167],v[96:99]
 v_mfma_f32_16x16x32_bf16 v[100:103],a[200:203],a[168:171],v[100:103]
 buffer_load_dwordx4 v19,s[8:11],s37 offen offset:1024 lds
 v_mfma_f32_16x16x32_bf16 v[100:103],a[204:207],a[172:175],v[100:103]
 v_mfma_f32_16x16x32_bf16 v[104:107],a[200:203],a[176:179],v[104:107]
 v_mfma_f32_16x16x32_bf16 v[104:107],a[204:207],a[180:183],v[104:107]
 v_mfma_f32_16x16x32_bf16 v[108:111],a[200:203],a[184:187],v[108:111]
 buffer_load_dwordx4 v18,s[8:11],s38 offen offset:2048 lds
 v_mfma_f32_16x16x32_bf16 v[108:111],a[204:207],a[188:191],v[108:111]
 s_waitcnt lgkmcnt(0)
 v_mfma_f32_16x16x32_bf16 v[112:115],a[192:195],a[128:131],v[112:115]
 v_mfma_f32_16x16x32_bf16 v[112:115],a[196:199],a[132:135],v[112:115]
 ds_read_b128 a[200:203],v4 offset:6144
 v_mfma_f32_16x16x32_bf16 v[116:119],a[192:195],a[136:139],v[116:119]
 buffer_load_dwordx4 v19,s[8:11],s39 offen offset:3072 lds
 v_mfma_f32_16x16x32_bf16 v[116:119],a[196:199],a[140:143],v[116:119]
 ds_read_b128 a[204:207],v5 offset:6144
 v_mfma_f32_16x16x32_bf16 v[120:123],a[192:195],a[144:147],v[120:123]
 v_mfma_f32_16x16x32_bf16 v[120:123],a[196:199],a[148:151],v[120:123]
 v_mfma_f32_16x16x32_bf16 v[124:127],a[192:195],a[152:155],v[124:127]
 s_add_u32 s8,s8,524288
 s_addc_u32 s9,s9,0
 v_mfma_f32_16x16x32_bf16 v[124:127],a[196:199],a[156:159],v[124:127]
 v_mfma_f32_16x16x32_bf16 v[128:131],a[192:195],a[160:163],v[128:131]
 v_mfma_f32_16x16x32_bf16 v[128:131],a[196:199],a[164:167],v[128:131]
 v_mfma_f32_16x16x32_bf16 v[132:135],a[192:195],a[168:171],v[132:135]
 s_sub_u32 s10,s10,524288
 v_mfma_f32_16x16x32_bf16 v[132:135],a[196:199],a[172:175],v[132:135]
 v_mfma_f32_16x16x32_bf16 v[136:139],a[192:195],a[176:179],v[136:139]
 v_mfma_f32_16x16x32_bf16 v[136:139],a[196:199],a[180:183],v[136:139]
 v_mfma_f32_16x16x32_bf16 v[140:143],a[192:195],a[184:187],v[140:143]
 s_add_u32 m0,s50,0
 v_mfma_f32_16x16x32_bf16 v[140:143],a[196:199],a[188:191],v[140:143]
 s_waitcnt lgkmcnt(0)
 v_mfma_f32_16x16x32_bf16 v[144:147],a[200:203],a[128:131],v[144:147]
 v_mfma_f32_16x16x32_bf16 v[144:147],a[204:207],a[132:135],v[144:147]
 ds_read_b128 a[192:195],v4 offset:8192
 v_mfma_f32_16x16x32_bf16 v[148:151],a[200:203],a[136:139],v[148:151]
 buffer_load_dwordx4 v14,s[4:7],s32 offen offset:0 lds
 v_mfma_f32_16x16x32_bf16 v[148:151],a[204:207],a[140:143],v[148:151]
 ds_read_b128 a[196:199],v5 offset:8192
 v_mfma_f32_16x16x32_bf16 v[152:155],a[200:203],a[144:147],v[152:155]
 v_mfma_f32_16x16x32_bf16 v[152:155],a[204:207],a[148:151],v[152:155]
 buffer_load_dwordx4 v15,s[4:7],s33 offen offset:1024 lds
 v_mfma_f32_16x16x32_bf16 v[156:159],a[200:203],a[152:155],v[156:159]
 v_mfma_f32_16x16x32_bf16 v[156:159],a[204:207],a[156:159],v[156:159]
 v_mfma_f32_16x16x32_bf16 v[160:163],a[200:203],a[160:163],v[160:163]
 s_waitcnt vmcnt(20)
 s_barrier
 v_mfma_f32_16x16x32_bf16 v[160:163],a[204:207],a[164:167],v[160:163]
 ds_read_b64_tr_b16 a[64:65],v6 offset:0
 v_mfma_f32_16x16x32_bf16 v[164:167],a[200:203],a[168:171],v[164:167]
 buffer_load_dwordx4 v14,s[4:7],s34 offen offset:2048 lds
 v_mfma_f32_16x16x32_bf16 v[164:167],a[204:207],a[172:175],v[164:167]
 ds_read_b64_tr_b16 a[66:67],v6 offset:2048
 ds_read_b64_tr_b16 a[68:69],v6 offset:16384
 v_mfma_f32_16x16x32_bf16 v[168:171],a[200:203],a[176:179],v[168:171]
 v_mfma_f32_16x16x32_bf16 v[168:171],a[204:207],a[180:183],v[168:171]
 ds_read_b64_tr_b16 a[70:71],v6 offset:18432
 v_mfma_f32_16x16x32_bf16 v[172:175],a[200:203],a[184:187],v[172:175]
 buffer_load_dwordx4 v15,s[4:7],s35 offen offset:3072 lds
 v_mfma_f32_16x16x32_bf16 v[172:175],a[204:207],a[188:191],v[172:175]
 s_waitcnt lgkmcnt(4)
 ds_read_b64_tr_b16 a[72:73],v7 offset:0
 v_mfma_f32_16x16x32_bf16 v[176:179],a[192:195],a[128:131],v[176:179]
 ds_read_b64_tr_b16 a[74:75],v7 offset:2048
 v_mfma_f32_16x16x32_bf16 v[176:179],a[196:199],a[132:135],v[176:179]
 ds_read_b128 a[200:203],v4 offset:10240
 s_add_u32 m0,s50,4096
 v_mfma_f32_16x16x32_bf16 v[180:183],a[192:195],a[136:139],v[180:183]
 ds_read_b64_tr_b16 a[76:77],v7 offset:16384
 v_mfma_f32_16x16x32_bf16 v[180:183],a[196:199],a[140:143],v[180:183]
 ds_read_b128 a[204:207],v5 offset:10240
 ds_read_b64_tr_b16 a[78:79],v7 offset:18432
 v_mfma_f32_16x16x32_bf16 v[184:187],a[192:195],a[144:147],v[184:187]
 ds_read_b64_tr_b16 a[80:81],v8 offset:0
 v_mfma_f32_16x16x32_bf16 v[184:187],a[196:199],a[148:151],v[184:187]
 buffer_load_dwordx4 v14,s[4:7],s36 offen offset:0 lds
 v_mfma_f32_16x16x32_bf16 v[188:191],a[192:195],a[152:155],v[188:191]
 ds_read_b64_tr_b16 a[82:83],v8 offset:2048
 v_mfma_f32_16x16x32_bf16 v[188:191],a[196:199],a[156:159],v[188:191]
 ds_read_b64_tr_b16 a[84:85],v8 offset:16384
 v_mfma_f32_16x16x32_bf16 v[192:195],a[192:195],a[160:163],v[192:195]
 v_mfma_f32_16x16x32_bf16 v[192:195],a[196:199],a[164:167],v[192:195]
 buffer_load_dwordx4 v15,s[4:7],s37 offen offset:1024 lds
 v_mfma_f32_16x16x32_bf16 v[196:199],a[192:195],a[168:171],v[196:199]
 ds_read_b64_tr_b16 a[86:87],v8 offset:18432
 ds_read_b64_tr_b16 a[88:89],v9 offset:0
 v_mfma_f32_16x16x32_bf16 v[196:199],a[196:199],a[172:175],v[196:199]
 v_mfma_f32_16x16x32_bf16 v[200:203],a[192:195],a[176:179],v[200:203]
 ds_read_b64_tr_b16 a[90:91],v9 offset:2048
 v_mfma_f32_16x16x32_bf16 v[200:203],a[196:199],a[180:183],v[200:203]
 buffer_load_dwordx4 v14,s[4:7],s38 offen offset:2048 lds
 v_mfma_f32_16x16x32_bf16 v[204:207],a[192:195],a[184:187],v[204:207]
 ds_read_b64_tr_b16 a[92:93],v9 offset:16384
 v_mfma_f32_16x16x32_bf16 v[204:207],a[196:199],a[188:191],v[204:207]
 s_waitcnt lgkmcnt(8)
 ds_read_b64_tr_b16 a[94:95],v9 offset:18432
 v_mfma_f32_16x16x32_bf16 v[208:211],a[200:203],a[128:131],v[208:211]
 ds_read_b64_tr_b16 a[96:97],v10 offset:0
 v_mfma_f32_16x16x32_bf16 v[208:211],a[204:207],a[132:135],v[208:211]
 buffer_load_dwordx4 v15,s[4:7],s39 offen offset:3072 lds
 v_mfma_f32_16x16x32_bf16 v[212:215],a[200:203],a[136:139],v[212:215]
 ds_read_b128 a[192:195],v4 offset:12288
 ds_read_b64_tr_b16 a[98:99],v10 offset:2048
 v_mfma_f32_16x16x32_bf16 v[212:215],a[204:207],a[140:143],v[212:215]
 buffer_load_dword v24,v35,s[24:27],0 offen
 v_mfma_f32_16x16x32_bf16 v[216:219],a[200:203],a[144:147],v[216:219]
 ds_read_b128 a[196:199],v5 offset:12288
 v_add_u32 v35,0x80,v35
 v_mfma_f32_16x16x32_bf16 v[216:219],a[204:207],a[148:151],v[216:219]
 ds_read_b64_tr_b16 a[100:101],v10 offset:16384
 ds_read_b64_tr_b16 a[102:103],v10 offset:18432
 v_mfma_f32_16x16x32_bf16 v[220:223],a[200:203],a[152:155],v[220:223]
 s_add_u32 s4,s4,128
 s_addc_u32 s5,s5,0
 v_mfma_f32_16x16x32_bf16 v[220:223],a[204:207],a[156:159],v[220:223]
 buffer_load_dword v24,v36,s[72:75],0 offen
 v_mfma_f32_16x16x32_bf16 v[224:227],a[200:203],a[160:163],v[224:227]
 ds_read_b64_tr_b16 a[104:105],v11 offset:0
 v_add_u32 v36,0x2a000,v36
 v_mfma_f32_16x16x32_bf16 v[224:227],a[204:207],a[164:167],v[224:227]
 buffer_load_dword v24,v37,s[40:43],0 offen
 v_mfma_f32_16x16x32_bf16 v[228:231],a[200:203],a[168:171],v[228:231]
 ds_read_b64_tr_b16 a[106:107],v11 offset:2048
 s_sub_u32 s6,s6,128
 v_mfma_f32_16x16x32_bf16 v[228:231],a[204:207],a[172:175],v[228:231]
 buffer_load_dword v24,v37,s[64:67],0 offen
 v_mfma_f32_16x16x32_bf16 v[232:235],a[200:203],a[176:179],v[232:235]
 ds_read_b64_tr_b16 a[108:109],v11 offset:16384
 v_add_u32 v37,0x1180,v37
 v_mfma_f32_16x16x32_bf16 v[232:235],a[204:207],a[180:183],v[232:235]
 ds_read_b64_tr_b16 a[110:111],v11 offset:18432
 ds_read_b64_tr_b16 a[112:113],v12 offset:0
 v_mfma_f32_16x16x32_bf16 v[236:239],a[200:203],a[184:187],v[236:239]
 s_add_u32 s50,s50,32768
 ds_read_b64_tr_b16 a[114:115],v12 offset:2048
 v_mfma_f32_16x16x32_bf16 v[236:239],a[204:207],a[188:191],v[236:239]
 s_waitcnt lgkmcnt(8)
 ds_read_b64_tr_b16 a[116:117],v12 offset:16384
 v_mfma_f32_16x16x32_bf16 v[240:243],a[192:195],a[128:131],v[240:243]
 s_cmp_ge_u32 s50,98304
 s_cselect_b32 s50,s51,s50
 v_mfma_f32_16x16x32_bf16 v[240:243],a[196:199],a[132:135],v[240:243]
 ds_read_b64_tr_b16 a[118:119],v12 offset:18432
 ds_read_b128 a[200:203],v4 offset:14336
 v_mfma_f32_16x16x32_bf16 v[244:247],a[192:195],a[136:139],v[244:247]
 ds_read_b64_tr_b16 a[120:121],v13 offset:0
 v_mfma_f32_16x16x32_bf16 v[244:247],a[196:199],a[140:143],v[244:247]
 ds_read_b128 a[204:207],v5 offset:14336
 ds_read_b64_tr_b16 a[122:123],v13 offset:2048
 v_mfma_f32_16x16x32_bf16 v[248:251],a[192:195],a[144:147],v[248:251]
 v_mfma_f32_16x16x32_bf16 v[248:251],a[196:199],a[148:151],v[248:251]
 ds_read_b64_tr_b16 a[124:125],v13 offset:16384
 v_mfma_f32_16x16x32_bf16 v[252:255],a[192:195],a[152:155],v[252:255]
 ds_read_b64_tr_b16 a[126:127],v13 offset:18432
 v_mfma_f32_16x16x32_bf16 v[252:255],a[196:199],a[156:159],v[252:255]
 v_mfma_f32_16x16x32_bf16 a[208:211],a[192:195],a[160:163],a[208:211]
 v_mfma_f32_16x16x32_bf16 a[208:211],a[196:199],a[164:167],a[208:211]
 s_add_u32 s55,s55,32768
 v_mfma_f32_16x16x32_bf16 a[212:215],a[192:195],a[168:171],a[212:215]
 s_cmp_ge_u32 s55,98304
 s_cselect_b32 s55,s54,s55
 v_mfma_f32_16x16x32_bf16 a[212:215],a[196:199],a[172:175],a[212:215]
 v_add_u32 v4,s55,v2
 v_mfma_f32_16x16x32_bf16 a[216:219],a[192:195],a[176:179],a[216:219]
 v_add_u32 v5,s55,v3
 v_mfma_f32_16x16x32_bf16 a[216:219],a[196:199],a[180:183],a[216:219]
 v_mfma_f32_16x16x32_bf16 a[220:223],a[192:195],a[184:187],a[220:223]
 v_mfma_f32_16x16x32_bf16 a[220:223],a[196:199],a[188:191],a[220:223]
 s_waitcnt vmcnt(22) lgkmcnt(0)
 s_barrier
 v_mfma_f32_16x16x32_bf16 a[224:227],a[200:203],a[128:131],a[224:227]
 ds_read_b128 a[192:195],v4 offset:0
 v_mfma_f32_16x16x32_bf16 a[224:227],a[204:207],a[132:135],a[224:227]
 ds_read_b128 a[196:199],v5 offset:0
 v_mfma_f32_16x16x32_bf16 a[228:231],a[200:203],a[136:139],a[228:231]
 v_mfma_f32_16x16x32_bf16 a[228:231],a[204:207],a[140:143],a[228:231]
 v_mfma_f32_16x16x32_bf16 a[232:235],a[200:203],a[144:147],a[232:235]
 v_mfma_f32_16x16x32_bf16 a[232:235],a[204:207],a[148:151],a[232:235]
 v_mfma_f32_16x16x32_bf16 a[236:239],a[200:203],a[152:155],a[236:239]
 v_mfma_f32_16x16x32_bf16 a[236:239],a[204:207],a[156:159],a[236:239]
 v_mfma_f32_16x16x32_bf16 a[240:243],a[200:203],a[160:163],a[240:243]
 v_mfma_f32_16x16x32_bf16 a[240:243],a[204:207],a[164:167],a[240:243]
 v_mfma_f32_16x16x32_bf16 a[244:247],a[200:203],a[168:171],a[244:247]
 v_mfma_f32_16x16x32_bf16 a[244:247],a[204:207],a[172:175],a[244:247]
 v_mfma_f32_16x16x32_bf16 a[248:251],a[200:203],a[176:179],a[248:251]
 v_mfma_f32_16x16x32_bf16 a[248:251],a[204:207],a[180:183],a[248:251]
 v_mfma_f32_16x16x32_bf16 a[252:255],a[200:203],a[184:187],a[252:255]
 v_mfma_f32_16x16x32_bf16 a[252:255],a[204:207],a[188:191],a[252:255]
 s_waitcnt lgkmcnt(0)
 s_sub_u32 s49,s49,1
 s_cmp_lg_u32 s49,0
 s_cbranch_scc1 KVL_11
 v_mov_b32 v26,0
 global_load_dword v34,v26,s[70:71] sc1
 s_getpc_b64 s[60:61]
PC_13:
 s_add_u32 s60,s60,G1T_12-PC_13
 s_addc_u32 s61,s61,(G1T_12-PC_13)>>32
 s_bfe_u32 s62,s2,0x30004
 s_lshl_b32 s62,s62,2
 s_add_u32 s62,s62,s45
 v_and_b32 v25,63,v0
 v_mul_u32_u24 v25,32,v25
 v_add_lshl_u32 v25,v25,s62,7
 v_min_u32 v25,G1T_12E-G1T_12-4,v25
 global_load_dword v24,v25,s[60:61]
 s_getpc_b64 s[60:61]
PC_14:
 s_add_u32 s60,s60,G1_TAIL-PC_14
 s_addc_u32 s61,s61,(G1_TAIL-PC_14)>>32
 s_bfe_u32 s62,s2,0x30004
 s_lshl_b32 s62,s62,2
 s_add_u32 s62,s62,s45
 v_and_b32 v25,63,v0
 v_mul_u32_u24 v25,32,v25
 v_add_lshl_u32 v25,v25,s62,7
 v_min_u32 v25,K2_LAST-G1_TAIL-4,v25
 global_load_dword v24,v25,s[60:61]
G1T_12:
 v_mfma_f32_16x16x32_bf16 v[48:51],a[192:195],a[64:67],v[48:51]
 s_add_u32 m0,s53,102400
 v_mfma_f32_16x16x32_bf16 v[48:51],a[196:199],a[68:71],v[48:51]
 ds_read_b128 a[200:203],v4 offset:2048
 v_mfma_f32_16x16x32_bf16 v[52:55],a[192:195],a[72:75],v[52:55]
 v_mfma_f32_16x16x32_bf16 v[52:55],a[196:199],a[76:79],v[52:55]
 ds_read_b128 a[204:207],v5 offset:2048
 v_mfma_f32_16x16x32_bf16 v[56:59],a[192:195],a[80:83],v[56:59]
 buffer_load_dwordx4 v38,s[72:75],0 offen offset:0 lds
 v_mfma_f32_16x16x32_bf16 v[56:59],a[196:199],a[84:87],v[56:59]
 v_mfma_f32_16x16x32_bf16 v[60:63],a[192:195],a[88:91],v[60:63]
 v_mfma_f32_16x16x32_bf16 v[60:63],a[196:199],a[92:95],v[60:63]
 buffer_load_dwordx4 v39,s[72:75],0 offen offset:1024 lds
 v_mfma_f32_16x16x32_bf16 v[64:67],a[192:195],a[96:99],v[64:67]
 v_mfma_f32_16x16x32_bf16 v[64:67],a[196:199],a[100:103],v[64:67]
 v_mfma_f32_16x16x32_bf16 v[68:71],a[192:195],a[104:107],v[68:71]
 v_mfma_f32_16x16x32_bf16 v[68:71],a[196:199],a[108:111],v[68:71]
 buffer_load_dwordx4 v40,s[72:75],0 offen offset:2048 lds
 v_mfma_f32_16x16x32_bf16 v[72:75],a[192:195],a[112:115],v[72:75]
 v_mfma_f32_16x16x32_bf16 v[72:75],a[196:199],a[116:119],v[72:75]
 v_mfma_f32_16x16x32_bf16 v[76:79],a[192:195],a[120:123],v[76:79]
 v_mfma_f32_16x16x32_bf16 v[76:79],a[196:199],a[124:127],v[76:79]
 s_waitcnt lgkmcnt(0)
 s_add_u32 m0,s52,65536
 v_mfma_f32_16x16x32_bf16 v[80:83],a[200:203],a[64:67],v[80:83]
 v_mfma_f32_16x16x32_bf16 v[80:83],a[204:207],a[68:71],v[80:83]
 ds_read_b128 a[192:195],v4 offset:4096
 v_mfma_f32_16x16x32_bf16 v[84:87],a[200:203],a[72:75],v[84:87]
 v_mfma_f32_16x16x32_bf16 v[84:87],a[204:207],a[76:79],v[84:87]
 ds_read_b128 a[196:199],v5 offset:4096
 v_mfma_f32_16x16x32_bf16 v[88:91],a[200:203],a[80:83],v[88:91]
 buffer_load_dwordx4 v20,s[24:27],s12 offen offset:0 lds
 v_mfma_f32_16x16x32_bf16 v[88:91],a[204:207],a[84:87],v[88:91]
 v_mfma_f32_16x16x32_bf16 v[92:95],a[200:203],a[88:91],v[92:95]
 v_mfma_f32_16x16x32_bf16 v[92:95],a[204:207],a[92:95],v[92:95]
 s_add_u32 m0,s52,66560
 v_mfma_f32_16x16x32_bf16 v[96:99],a[200:203],a[96:99],v[96:99]
 v_mfma_f32_16x16x32_bf16 v[96:99],a[204:207],a[100:103],v[96:99]
 v_mfma_f32_16x16x32_bf16 v[100:103],a[200:203],a[104:107],v[100:103]
 buffer_load_dwordx4 v21,s[24:27],s13 offen offset:0 lds
 v_mfma_f32_16x16x32_bf16 v[100:103],a[204:207],a[108:111],v[100:103]
 v_mfma_f32_16x16x32_bf16 v[104:107],a[200:203],a[112:115],v[104:107]
 v_mfma_f32_16x16x32_bf16 v[104:107],a[204:207],a[116:119],v[104:107]
 v_mfma_f32_16x16x32_bf16 v[108:111],a[200:203],a[120:123],v[108:111]
 s_add_u32 m0,s52,67584
 v_mfma_f32_16x16x32_bf16 v[108:111],a[204:207],a[124:127],v[108:111]
 s_waitcnt lgkmcnt(0)
 v_mfma_f32_16x16x32_bf16 v[112:115],a[192:195],a[64:67],v[112:115]
 v_mfma_f32_16x16x32_bf16 v[112:115],a[196:199],a[68:71],v[112:115]
 ds_read_b128 a[200:203],v4 offset:6144
 v_mfma_f32_16x16x32_bf16 v[116:119],a[192:195],a[72:75],v[116:119]
 buffer_load_dwordx4 v20,s[24:27],s14 offen offset:0 lds
 v_mfma_f32_16x16x32_bf16 v[116:119],a[196:199],a[76:79],v[116:119]
 ds_read_b128 a[204:207],v5 offset:6144
 v_mfma_f32_16x16x32_bf16 v[120:123],a[192:195],a[80:83],v[120:123]
 v_mfma_f32_16x16x32_bf16 v[120:123],a[196:199],a[84:87],v[120:123]
 v_mfma_f32_16x16x32_bf16 v[124:127],a[192:195],a[88:91],v[124:127]
 s_add_u32 m0,s52,68608
 v_mfma_f32_16x16x32_bf16 v[124:127],a[196:199],a[92:95],v[124:127]
 v_mfma_f32_16x16x32_bf16 v[128:131],a[192:195],a[96:99],v[128:131]
 v_mfma_f32_16x16x32_bf16 v[128:131],a[196:199],a[100:103],v[128:131]
 v_mfma_f32_16x16x32_bf16 v[132:135],a[192:195],a[104:107],v[132:135]
 buffer_load_dwordx4 v21,s[24:27],s15 offen offset:0 lds
 v_mfma_f32_16x16x32_bf16 v[132:135],a[196:199],a[108:111],v[132:135]
 v_mfma_f32_16x16x32_bf16 v[136:139],a[192:195],a[112:115],v[136:139]
 v_mfma_f32_16x16x32_bf16 v[136:139],a[196:199],a[116:119],v[136:139]
 v_mfma_f32_16x16x32_bf16 v[140:143],a[192:195],a[120:123],v[140:143]
 s_add_u32 m0,s52,69632
 v_mfma_f32_16x16x32_bf16 v[140:143],a[196:199],a[124:127],v[140:143]
 s_waitcnt lgkmcnt(0)
 v_mfma_f32_16x16x32_bf16 v[144:147],a[200:203],a[64:67],v[144:147]
 v_mfma_f32_16x16x32_bf16 v[144:147],a[204:207],a[68:71],v[144:147]
 ds_read_b128 a[192:195],v4 offset:8192
 v_mfma_f32_16x16x32_bf16 v[148:151],a[200:203],a[72:75],v[148:151]
 buffer_load_dwordx4 v20,s[24:27],s16 offen offset:0 lds
 v_mfma_f32_16x16x32_bf16 v[148:151],a[204:207],a[76:79],v[148:151]
 ds_read_b128 a[196:199],v5 offset:8192
 v_mfma_f32_16x16x32_bf16 v[152:155],a[200:203],a[80:83],v[152:155]
 v_mfma_f32_16x16x32_bf16 v[152:155],a[204:207],a[84:87],v[152:155]
 s_add_u32 m0,s52,70656
 v_mfma_f32_16x16x32_bf16 v[156:159],a[200:203],a[88:91],v[156:159]
 v_mfma_f32_16x16x32_bf16 v[156:159],a[204:207],a[92:95],v[156:159]
 v_mfma_f32_16x16x32_bf16 v[160:163],a[200:203],a[96:99],v[160:163]
 s_waitcnt vmcnt(23)
 s_barrier
 v_mfma_f32_16x16x32_bf16 v[160:163],a[204:207],a[100:103],v[160:163]
 ds_read_b64_tr_b16 a[128:129],v6 offset:32768
 v_mfma_f32_16x16x32_bf16 v[164:167],a[200:203],a[104:107],v[164:167]
 buffer_load_dwordx4 v21,s[24:27],s17 offen offset:0 lds
 v_mfma_f32_16x16x32_bf16 v[164:167],a[204:207],a[108:111],v[164:167]
 ds_read_b64_tr_b16 a[130:131],v6 offset:34816
 ds_read_b64_tr_b16 a[132:133],v6 offset:49152
 v_mfma_f32_16x16x32_bf16 v[168:171],a[200:203],a[112:115],v[168:171]
 v_mfma_f32_16x16x32_bf16 v[168:171],a[204:207],a[116:119],v[168:171]
 ds_read_b64_tr_b16 a[134:135],v6 offset:51200
 s_add_u32 m0,s52,71680
 v_mfma_f32_16x16x32_bf16 v[172:175],a[200:203],a[120:123],v[172:175]
 ds_read_b64_tr_b16 a[136:137],v7 offset:32768
 v_mfma_f32_16x16x32_bf16 v[172:175],a[204:207],a[124:127],v[172:175]
 s_waitcnt lgkmcnt(5)
 v_mfma_f32_16x16x32_bf16 v[176:179],a[192:195],a[64:67],v[176:179]
 ds_read_b64_tr_b16 a[138:139],v7 offset:34816
 v_mfma_f32_16x16x32_bf16 v[176:179],a[196:199],a[68:71],v[176:179]
 ds_read_b128 a[200:203],v4 offset:10240
 ds_read_b64_tr_b16 a[140:141],v7 offset:49152
 v_mfma_f32_16x16x32_bf16 v[180:183],a[192:195],a[72:75],v[180:183]
 buffer_load_dwordx4 v20,s[24:27],s18 offen offset:0 lds
 v_mfma_f32_16x16x32_bf16 v[180:183],a[196:199],a[76:79],v[180:183]
 ds_read_b128 a[204:207],v5 offset:10240
 ds_read_b64_tr_b16 a[142:143],v7 offset:51200
 v_mfma_f32_16x16x32_bf16 v[184:187],a[192:195],a[80:83],v[184:187]
 ds_read_b64_tr_b16 a[144:145],v8 offset:32768
 v_mfma_f32_16x16x32_bf16 v[184:187],a[196:199],a[84:87],v[184:187]
 s_add_u32 m0,s52,72704
 v_mfma_f32_16x16x32_bf16 v[188:191],a[192:195],a[88:91],v[188:191]
 ds_read_b64_tr_b16 a[146:147],v8 offset:34816
 v_mfma_f32_16x16x32_bf16 v[188:191],a[196:199],a[92:95],v[188:191]
 ds_read_b64_tr_b16 a[148:149],v8 offset:49152
 v_mfma_f32_16x16x32_bf16 v[192:195],a[192:195],a[96:99],v[192:195]
 v_mfma_f32_16x16x32_bf16 v[192:195],a[196:199],a[100:103],v[192:195]
 buffer_load_dwordx4 v21,s[24:27],s19 offen offset:0 lds
 v_mfma_f32_16x16x32_bf16 v[196:199],a[192:195],a[104:107],v[196:199]
 ds_read_b64_tr_b16 a[150:151],v8 offset:51200
 ds_read_b64_tr_b16 a[152:153],v9 offset:32768
 v_mfma_f32_16x16x32_bf16 v[196:199],a[196:199],a[108:111],v[196:199]
 v_mfma_f32_16x16x32_bf16 v[200:203],a[192:195],a[112:115],v[200:203]
 ds_read_b64_tr_b16 a[154:155],v9 offset:34816
 s_add_u32 m0,s52,73728
 v_mfma_f32_16x16x32_bf16 v[200:203],a[196:199],a[116:119],v[200:203]
 ds_read_b64_tr_b16 a[156:157],v9 offset:49152
 v_mfma_f32_16x16x32_bf16 v[204:207],a[192:195],a[120:123],v[204:207]
 v_mfma_f32_16x16x32_bf16 v[204:207],a[196:199],a[124:127],v[204:207]
 s_waitcnt lgkmcnt(8)
 ds_read_b64_tr_b16 a[158:159],v9 offset:51200
 v_mfma_f32_16x16x32_bf16 v[208:211],a[200:203],a[64:67],v[208:211]
 ds_read_b64_tr_b16 a[160:161],v10 offset:32768
 v_mfma_f32_16x16x32_bf16 v[208:211],a[204:207],a[68:71],v[208:211]
 buffer_load_dwordx4 v20,s[24:27],s20 offen offset:0 lds
 v_mfma_f32_16x16x32_bf16 v[212:215],a[200:203],a[72:75],v[212:215]
 ds_read_b128 a[192:195],v4 offset:12288
 ds_read_b64_tr_b16 a[162:163],v10 offset:34816
 v_mfma_f32_16x16x32_bf16 v[212:215],a[204:207],a[76:79],v[212:215]
 ds_read_b128 a[196:199],v5 offset:12288
 ds_read_b64_tr_b16 a[164:165],v10 offset:49152
 v_mfma_f32_16x16x32_bf16 v[216:219],a[200:203],a[80:83],v[216:219]
 s_add_u32 s24,s24,128
 s_addc_u32 s25,s25,0
 v_mfma_f32_16x16x32_bf16 v[216:219],a[204:207],a[84:87],v[216:219]
 ds_read_b64_tr_b16 a[166:167],v10 offset:51200
 v_mfma_f32_16x16x32_bf16 v[220:223],a[200:203],a[88:91],v[220:223]
 ds_read_b64_tr_b16 a[168:169],v11 offset:32768
 v_mfma_f32_16x16x32_bf16 v[220:223],a[204:207],a[92:95],v[220:223]
 ds_read_b64_tr_b16 a[170:171],v11 offset:34816
 v_mfma_f32_16x16x32_bf16 v[224:227],a[200:203],a[96:99],v[224:227]
 s_sub_u32 s26,s26,128
 v_mfma_f32_16x16x32_bf16 v[224:227],a[204:207],a[100:103],v[224:227]
 ds_read_b64_tr_b16 a[172:173],v11 offset:49152
 v_mfma_f32_16x16x32_bf16 v[228:231],a[200:203],a[104:107],v[228:231]
 ds_read_b64_tr_b16 a[174:175],v11 offset:51200
 v_mfma_f32_16x16x32_bf16 v[228:231],a[204:207],a[108:111],v[228:231]
 v_mfma_f32_16x16x32_bf16 v[232:235],a[200:203],a[112:115],v[232:235]
 ds_read_b64_tr_b16 a[176:177],v12 offset:32768
 v_mfma_f32_16x16x32_bf16 v[232:235],a[204:207],a[116:119],v[232:235]
 s_add_u32 s72,s72,172032
 s_addc_u32 s73,s73,0
 v_mfma_f32_16x16x32_bf16 v[236:239],a[200:203],a[120:123],v[236:239]
 ds_read_b64_tr_b16 a[178:179],v12 offset:34816
 v_mfma_f32_16x16x32_bf16 v[236:239],a[204:207],a[124:127],v[236:239]
 s_waitcnt lgkmcnt(8)
 ds_read_b64_tr_b16 a[180:181],v12 offset:49152
 v_mfma_f32_16x16x32_bf16 v[240:243],a[192:195],a[64:67],v[240:243]
 s_sub_u32 s74,s74,172032
 ds_read_b64_tr_b16 a[182:183],v12 offset:51200
 v_mfma_f32_16x16x32_bf16 v[240:243],a[196:199],a[68:71],v[240:243]
 ds_read_b128 a[200:203],v4 offset:14336
 v_mfma_f32_16x16x32_bf16 v[244:247],a[192:195],a[72:75],v[244:247]
 ds_read_b64_tr_b16 a[184:185],v13 offset:32768
 v_mfma_f32_16x16x32_bf16 v[244:247],a[196:199],a[76:79],v[244:247]
 ds_read_b128 a[204:207],v5 offset:14336
 ds_read_b64_tr_b16 a[186:187],v13 offset:34816
 v_mfma_f32_16x16x32_bf16 v[248:251],a[192:195],a[80:83],v[248:251]
 v_mfma_f32_16x16x32_bf16 v[248:251],a[196:199],a[84:87],v[248:251]
 ds_read_b64_tr_b16 a[188:189],v13 offset:49152
 v_mfma_f32_16x16x32_bf16 v[252:255],a[192:195],a[88:91],v[252:255]
 ds_read_b64_tr_b16 a[190:191],v13 offset:51200
 v_mfma_f32_16x16x32_bf16 v[252:255],a[196:199],a[92:95],v[252:255]
 v_mfma_f32_16x16x32_bf16 a[208:211],a[192:195],a[96:99],a[208:211]
 v_mfma_f32_16x16x32_bf16 a[208:211],a[196:199],a[100:103],a[208:211]
 s_add_u32 s55,s55,32768
 v_mfma_f32_16x16x32_bf16 a[212:215],a[192:195],a[104:107],a[212:215]
 s_cmp_ge_u32 s55,98304
 s_cselect_b32 s55,s54,s55
 v_mfma_f32_16x16x32_bf16 a[212:215],a[196:199],a[108:111],a[212:215]
 v_add_u32 v4,s55,v2
 v_mfma_f32_16x16x32_bf16 a[216:219],a[192:195],a[112:115],a[216:219]
 v_add_u32 v5,s55,v3
 v_mfma_f32_16x16x32_bf16 a[216:219],a[196:199],a[116:119],a[216:219]
 v_mfma_f32_16x16x32_bf16 a[220:223],a[192:195],a[120:123],a[220:223]
 v_mfma_f32_16x16x32_bf16 a[220:223],a[196:199],a[124:127],a[220:223]
 s_waitcnt vmcnt(14) lgkmcnt(0)
 s_barrier
 v_mfma_f32_16x16x32_bf16 a[224:227],a[200:203],a[64:67],a[224:227]
 ds_read_b128 a[192:195],v4 offset:0
 v_mfma_f32_16x16x32_bf16 a[224:227],a[204:207],a[68:71],a[224:227]
 ds_read_b128 a[196:199],v5 offset:0
 v_mfma_f32_16x16x32_bf16 a[228:231],a[200:203],a[72:75],a[228:231]
 v_mfma_f32_16x16x32_bf16 a[228:231],a[204:207],a[76:79],a[228:231]
 v_mfma_f32_16x16x32_bf16 a[232:235],a[200:203],a[80:83],a[232:235]
 v_mfma_f32_16x16x32_bf16 a[232:235],a[204:207],a[84:87],a[232:235]
 v_mfma_f32_16x16x32_bf16 a[236:239],a[200:203],a[88:91],a[236:239]
 v_mfma_f32_16x16x32_bf16 a[236:239],a[204:207],a[92:95],a[236:239]
 v_mfma_f32_16x16x32_bf16 a[240:243],a[200:203],a[96:99],a[240:243]
 v_mfma_f32_16x16x32_bf16 a[240:243],a[204:207],a[100:103],a[240:243]
 v_mfma_f32_16x16x32_bf16 a[244:247],a[200:203],a[104:107],a[244:247]
 v_mfma_f32_16x16x32_bf16 a[244:247],a[204:207],a[108:111],a[244:247]
 v_mfma_f32_16x16x32_bf16 a[248:251],a[200:203],a[112:115],a[248:251]
 v_mfma_f32_16x16x32_bf16 a[248:251],a[204:207],a[116:119],a[248:251]
 v_mfma_f32_16x16x32_bf16 a[252:255],a[200:203],a[120:123],a[252:255]
 v_mfma_f32_16x16x32_bf16 a[252:255],a[204:207],a[124:127],a[252:255]
 s_waitcnt lgkmcnt(0)
ZP_17:
 v_readfirstlane_b32 s61,v34
 s_nop 3
 s_cmp_lg_u32 s61,0
 s_cbranch_scc1 ZC_16
 v_mov_b32 v26,0
 global_load_dword v34,v26,s[70:71] sc1
 s_waitcnt vmcnt(0)
 s_branch ZP_17
ZC_16:
 s_add_u32 s61,s46,224
 s_lshl_b32 s61,s61,7
 s_add_u32 s61,s61,125829120
 v_mov_b32 v29,s61
 v_mov_b32 v30,8
 buffer_load_dword v31,v29,s[28:31],0 offen sc1
 v_mfma_f32_16x16x32_bf16 v[48:51],a[192:195],a[128:131],v[48:51]
 s_add_u32 m0,s53,151552
 v_mfma_f32_16x16x32_bf16 v[48:51],a[196:199],a[132:135],v[48:51]
 ds_read_b128 a[200:203],v4 offset:2048
 v_mfma_f32_16x16x32_bf16 v[52:55],a[192:195],a[136:139],v[52:55]
 v_mfma_f32_16x16x32_bf16 v[52:55],a[196:199],a[140:143],v[52:55]
 ds_read_b128 a[204:207],v5 offset:2048
 v_mfma_f32_16x16x32_bf16 v[56:59],a[192:195],a[144:147],v[56:59]
 buffer_load_dwordx4 v38,s[72:75],0 offen offset:0 lds
 v_mfma_f32_16x16x32_bf16 v[56:59],a[196:199],a[148:151],v[56:59]
 v_mfma_f32_16x16x32_bf16 v[60:63],a[192:195],a[152:155],v[60:63]
 v_mfma_f32_16x16x32_bf16 v[60:63],a[196:199],a[156:159],v[60:63]
 buffer_load_dwordx4 v39,s[72:75],0 offen offset:1024 lds
 v_mfma_f32_16x16x32_bf16 v[64:67],a[192:195],a[160:163],v[64:67]
 v_mfma_f32_16x16x32_bf16 v[64:67],a[196:199],a[164:167],v[64:67]
 v_mfma_f32_16x16x32_bf16 v[68:71],a[192:195],a[168:171],v[68:71]
 v_mfma_f32_16x16x32_bf16 v[68:71],a[196:199],a[172:175],v[68:71]
 buffer_load_dwordx4 v40,s[72:75],0 offen offset:2048 lds
 v_mfma_f32_16x16x32_bf16 v[72:75],a[192:195],a[176:179],v[72:75]
 v_mfma_f32_16x16x32_bf16 v[72:75],a[196:199],a[180:183],v[72:75]
 v_mfma_f32_16x16x32_bf16 v[76:79],a[192:195],a[184:187],v[76:79]
 v_mfma_f32_16x16x32_bf16 v[76:79],a[196:199],a[188:191],v[76:79]
 s_waitcnt lgkmcnt(0)
 s_add_u32 m0,s52,114688
 v_mfma_f32_16x16x32_bf16 v[80:83],a[200:203],a[128:131],v[80:83]
 v_mfma_f32_16x16x32_bf16 v[80:83],a[204:207],a[132:135],v[80:83]
 ds_read_b128 a[192:195],v4 offset:4096
 v_mfma_f32_16x16x32_bf16 v[84:87],a[200:203],a[136:139],v[84:87]
 v_mfma_f32_16x16x32_bf16 v[84:87],a[204:207],a[140:143],v[84:87]
 ds_read_b128 a[196:199],v5 offset:4096
 v_mfma_f32_16x16x32_bf16 v[88:91],a[200:203],a[144:147],v[88:91]
 buffer_load_dwordx4 v20,s[24:27],s12 offen offset:0 lds
 v_mfma_f32_16x16x32_bf16 v[88:91],a[204:207],a[148:151],v[88:91]
 v_mfma_f32_16x16x32_bf16 v[92:95],a[200:203],a[152:155],v[92:95]
 v_mfma_f32_16x16x32_bf16 v[92:95],a[204:207],a[156:159],v[92:95]
 s_add_u32 m0,s52,115712
 v_mfma_f32_16x16x32_bf16 v[96:99],a[200:203],a[160:163],v[96:99]
 v_mfma_f32_16x16x32_bf16 v[96:99],a[204:207],a[164:167],v[96:99]
 v_cvt_pk_bf16_f32 v48,v48,v49
 v_cvt_pk_bf16_f32 v49,v50,v51
 s_add_u32 s60,s56,0
 v_mfma_f32_16x16x32_bf16 v[100:103],a[200:203],a[168:171],v[100:103]
 buffer_load_dwordx4 v21,s[24:27],s13 offen offset:0 lds
 v_cvt_pk_bf16_f32 v50,v80,v81
 v_mfma_f32_16x16x32_bf16 v[100:103],a[204:207],a[172:175],v[100:103]
 v_cvt_pk_bf16_f32 v51,v82,v83
 v_mfma_f32_16x16x32_bf16 v[104:107],a[200:203],a[176:179],v[104:107]
 buffer_store_dwordx4 v[48:51],v1,s[28:31],s60 offen sc1
 v_cvt_pk_bf16_f32 v52,v52,v53
 v_mfma_f32_16x16x32_bf16 v[104:107],a[204:207],a[180:183],v[104:107]
 v_cvt_pk_bf16_f32 v53,v54,v55
 s_add_u32 s60,s56,2048
 v_cvt_pk_bf16_f32 v54,v84,v85
 v_mfma_f32_16x16x32_bf16 v[108:111],a[200:203],a[184:187],v[108:111]
 s_add_u32 m0,s52,116736
 v_cvt_pk_bf16_f32 v55,v86,v87
 v_mfma_f32_16x16x32_bf16 v[108:111],a[204:207],a[188:191],v[108:111]
 s_waitcnt lgkmcnt(0)
 buffer_store_dwordx4 v[52:55],v1,s[28:31],s60 offen sc1
 v_mfma_f32_16x16x32_bf16 v[112:115],a[192:195],a[128:131],v[112:115]
 v_cvt_pk_bf16_f32 v56,v56,v57
 v_cvt_pk_bf16_f32 v57,v58,v59
 s_add_u32 s60,s56,4096
 v_mfma_f32_16x16x32_bf16 v[112:115],a[196:199],a[132:135],v[112:115]
 ds_read_b128 a[200:203],v4 offset:6144
 v_cvt_pk_bf16_f32 v58,v88,v89
 v_cvt_pk_bf16_f32 v59,v90,v91
 v_mfma_f32_16x16x32_bf16 v[116:119],a[192:195],a[136:139],v[116:119]
 buffer_load_dwordx4 v20,s[24:27],s14 offen offset:0 lds
 v_mfma_f32_16x16x32_bf16 v[116:119],a[196:199],a[140:143],v[116:119]
 buffer_store_dwordx4 v[56:59],v1,s[28:31],s60 offen sc1
 ds_read_b128 a[204:207],v5 offset:6144
 v_mfma_f32_16x16x32_bf16 v[120:123],a[192:195],a[144:147],v[120:123]
 v_cvt_pk_bf16_f32 v60,v60,v61
 v_cvt_pk_bf16_f32 v61,v62,v63
 s_add_u32 s60,s56,6144
 v_mfma_f32_16x16x32_bf16 v[120:123],a[196:199],a[148:151],v[120:123]
 v_cvt_pk_bf16_f32 v62,v92,v93
 v_cvt_pk_bf16_f32 v63,v94,v95
 v_mfma_f32_16x16x32_bf16 v[124:127],a[192:195],a[152:155],v[124:127]
 s_add_u32 m0,s52,117760
 v_mfma_f32_16x16x32_bf16 v[124:127],a[196:199],a[156:159],v[124:127]
 v_mfma_f32_16x16x32_bf16 v[128:131],a[192:195],a[160:163],v[128:131]
 buffer_store_dwordx4 v[60:63],v1,s[28:31],s60 offen sc1
 v_cvt_pk_bf16_f32 v64,v64,v65
 v_mfma_f32_16x16x32_bf16 v[128:131],a[196:199],a[164:167],v[128:131]
 v_cvt_pk_bf16_f32 v65,v66,v67
 s_add_u32 s60,s56,8192
 v_cvt_pk_bf16_f32 v66,v96,v97
 v_mfma_f32_16x16x32_bf16 v[132:135],a[192:195],a[168:171],v[132:135]
 v_cvt_pk_bf16_f32 v67,v98,v99
 v_mfma_f32_16x16x32_bf16 v[132:135],a[196:199],a[172:175],v[132:135]
 buffer_load_dwordx4 v21,s[24:27],s15 offen offset:0 lds
 v_mfma_f32_16x16x32_bf16 v[136:139],a[192:195],a[176:179],v[136:139]
 v_mfma_f32_16x16x32_bf16 v[136:139],a[196:199],a[180:183],v[136:139]
 buffer_store_dwordx4 v[64:67],v1,s[28:31],s60 offen sc1
 v_cvt_pk_bf16_f32 v68,v68,v69
 v_mfma_f32_16x16x32_bf16 v[140:143],a[192:195],a[184:187],v[140:143]
 s_add_u32 m0,s52,118784
 v_cvt_pk_bf16_f32 v69,v70,v71
 s_add_u32 s60,s56,10240
 v_mfma_f32_16x16x32_bf16 v[140:143],a[196:199],a[188:191],v[140:143]
 s_waitcnt lgkmcnt(0)
 v_cvt_pk_bf16_f32 v70,v100,v101
 v_cvt_pk_bf16_f32 v71,v102,v103
 v_mfma_f32_16x16x32_bf16 v[144:147],a[200:203],a[128:131],v[144:147]
 v_mfma_f32_16x16x32_bf16 v[144:147],a[204:207],a[132:135],v[144:147]
 ds_read_b128 a[192:195],v4 offset:8192
 v_mfma_f32_16x16x32_bf16 v[148:151],a[200:203],a[136:139],v[148:151]
 buffer_load_dwordx4 v20,s[24:27],s16 offen offset:0 lds
 v_mfma_f32_16x16x32_bf16 v[148:151],a[204:207],a[140:143],v[148:151]
 ds_read_b128 a[196:199],v5 offset:8192
 s_add_u32 s61,s51,65536
 v_mfma_f32_16x16x32_bf16 v[152:155],a[200:203],a[144:147],v[152:155]
 buffer_store_dwordx4 v[68:71],v1,s[28:31],s60 offen sc1
 v_add_u32 v35,s61,v2
 v_mfma_f32_16x16x32_bf16 v[152:155],a[204:207],a[148:151],v[152:155]
 v_add_u32 v36,s61,v3
 s_add_u32 m0,s52,119808
 v_cvt_pk_bf16_f32 v72,v72,v73
 v_mfma_f32_16x16x32_bf16 v[156:159],a[200:203],a[152:155],v[156:159]
 v_add_u32 v22,0x19000,v41
 v_cvt_pk_bf16_f32 v73,v74,v75
 s_add_u32 s60,s56,12288
 v_mfma_f32_16x16x32_bf16 v[156:159],a[204:207],a[156:159],v[156:159]
 v_add_u32 v23,0x19000,v42
 v_cvt_pk_bf16_f32 v74,v104,v105
 v_cvt_pk_bf16_f32 v75,v106,v107
 v_mfma_f32_16x16x32_bf16 v[160:163],a[200:203],a[160:163],v[160:163]
 s_waitcnt vmcnt(15)
 s_barrier
 v_mfma_f32_16x16x32_bf16 v[160:163],a[204:207],a[164:167],v[160:163]
 buffer_store_dwordx4 v[72:75],v1,s[28:31],s60 offen sc1
 ds_read_b128 a[48:51],v35 offset:0
 v_mfma_f32_16x16x32_bf16 v[164:167],a[200:203],a[168:171],v[164:167]
 ds_read_b128 a[52:55],v36 offset:0
 v_cvt_pk_bf16_f32 v76,v76,v77
 v_cvt_pk_bf16_f32 v77,v78,v79
 v_mfma_f32_16x16x32_bf16 v[164:167],a[204:207],a[172:175],v[164:167]
 ds_read_b128 a[56:59],v35 offset:2048
 s_add_u32 s60,s56,14336
 v_cvt_pk_bf16_f32 v78,v108,v109
 v_mfma_f32_16x16x32_bf16 v[168:171],a[200:203],a[176:179],v[168:171]
 buffer_load_dwordx4 v21,s[24:27],s17 offen offset:0 lds
 v_cvt_pk_bf16_f32 v79,v110,v111
 v_mfma_f32_16x16x32_bf16 v[168:171],a[204:207],a[180:183],v[168:171]
 ds_read_b128 a[60:63],v36 offset:2048
 s_add_u32 m0,s52,120832
 v_mfma_f32_16x16x32_bf16 v[172:175],a[200:203],a[184:187],v[172:175]
 buffer_store_dwordx4 v[76:79],v1,s[28:31],s60 offen sc1
 ds_read_b128 a[64:67],v35 offset:4096
 v_mfma_f32_16x16x32_bf16 v[172:175],a[204:207],a[188:191],v[172:175]
 s_waitcnt lgkmcnt(5)
 ds_read_b128 a[68:71],v36 offset:4096
 v_cvt_pk_bf16_f32 v112,v112,v113
 v_mfma_f32_16x16x32_bf16 v[176:179],a[192:195],a[128:131],v[176:179]
 v_cvt_pk_bf16_f32 v113,v114,v115
 s_add_u32 s60,s56,1024
 v_cvt_pk_bf16_f32 v114,v144,v145
 v_mfma_f32_16x16x32_bf16 v[176:179],a[196:199],a[132:135],v[176:179]
 ds_read_b128 a[200:203],v4 offset:10240
 ds_read_b128 a[72:75],v35 offset:6144
 v_cvt_pk_bf16_f32 v115,v146,v147
 v_mfma_f32_16x16x32_bf16 v[180:183],a[192:195],a[136:139],v[180:183]
 buffer_load_dwordx4 v20,s[24:27],s18 offen offset:0 lds
 v_mfma_f32_16x16x32_bf16 v[180:183],a[196:199],a[140:143],v[180:183]
 ds_read_b128 a[76:79],v36 offset:6144
 ds_read_b128 a[204:207],v5 offset:10240
 v_mfma_f32_16x16x32_bf16 v[184:187],a[192:195],a[144:147],v[184:187]
 buffer_store_dwordx4 v[112:115],v1,s[28:31],s60 offen sc1
 ds_read_b128 a[80:83],v35 offset:8192
 v_mfma_f32_16x16x32_bf16 v[184:187],a[196:199],a[148:151],v[184:187]
 s_add_u32 m0,s52,121856
 ds_read_b128 a[84:87],v36 offset:8192
 v_cvt_pk_bf16_f32 v116,v116,v117
 v_mfma_f32_16x16x32_bf16 v[188:191],a[192:195],a[152:155],v[188:191]
 ds_read_b64_tr_b16 a[0:1],v22 offset:0
 v_cvt_pk_bf16_f32 v117,v118,v119
 s_add_u32 s60,s56,3072
 v_mfma_f32_16x16x32_bf16 v[188:191],a[196:199],a[156:159],v[188:191]
 v_cvt_pk_bf16_f32 v118,v148,v149
 v_cvt_pk_bf16_f32 v119,v150,v151
 v_mfma_f32_16x16x32_bf16 v[192:195],a[192:195],a[160:163],v[192:195]
 buffer_store_dwordx4 v[116:119],v1,s[28:31],s60 offen sc1
 ds_read_b64_tr_b16 a[2:3],v22 offset:768
 v_mfma_f32_16x16x32_bf16 v[192:195],a[196:199],a[164:167],v[192:195]
 ds_read_b64_tr_b16 a[4:5],v22 offset:6144
 v_cvt_pk_bf16_f32 v120,v120,v121
 v_cvt_pk_bf16_f32 v121,v122,v123
 v_mfma_f32_16x16x32_bf16 v[196:199],a[192:195],a[168:171],v[196:199]
 ds_read_b64_tr_b16 a[6:7],v22 offset:6912
 s_add_u32 s60,s56,5120
 v_cvt_pk_bf16_f32 v122,v152,v153
 v_mfma_f32_16x16x32_bf16 v[196:199],a[196:199],a[172:175],v[196:199]
 buffer_load_dwordx4 v21,s[24:27],s19 offen offset:0 lds
 v_cvt_pk_bf16_f32 v123,v154,v155
 v_mfma_f32_16x16x32_bf16 v[200:203],a[192:195],a[176:179],v[200:203]
 ds_read_b64_tr_b16 a[8:9],v23 offset:0
 s_add_u32 m0,s52,122880
 v_mfma_f32_16x16x32_bf16 v[200:203],a[196:199],a[180:183],v[200:203]
 buffer_store_dwordx4 v[120:123],v1,s[28:31],s60 offen sc1
 ds_read_b64_tr_b16 a[10:11],v23 offset:768
 v_mfma_f32_16x16x32_bf16 v[204:207],a[192:195],a[184:187],v[204:207]
 v_cvt_pk_bf16_f32 v124,v124,v125
 v_cvt_pk_bf16_f32 v125,v126,v127
 s_add_u32 s60,s56,7168
 v_mfma_f32_16x16x32_bf16 v[204:207],a[196:199],a[188:191],v[204:207]
 s_waitcnt lgkmcnt(8)
 ds_read_b64_tr_b16 a[12:13],v23 offset:6144
 v_cvt_pk_bf16_f32 v126,v156,v157
 v_mfma_f32_16x16x32_bf16 v[208:211],a[200:203],a[128:131],v[208:211]
 ds_read_b64_tr_b16 a[14:15],v23 offset:6912
 v_cvt_pk_bf16_f32 v127,v158,v159
 v_mfma_f32_16x16x32_bf16 v[208:211],a[204:207],a[132:135],v[208:211]
 buffer_load_dwordx4 v20,s[24:27],s20 offen offset:0 lds
 v_mfma_f32_16x16x32_bf16 v[212:215],a[200:203],a[136:139],v[212:215]
 ds_read_b128 a[192:195],v4 offset:12288
 ds_read_b64_tr_b16 a[16:17],v22 offset:64
 v_mfma_f32_16x16x32_bf16 v[212:215],a[204:207],a[140:143],v[212:215]
 ds_read_b128 a[196:199],v5 offset:12288
 ds_read_b64_tr_b16 a[18:19],v22 offset:832
 v_mfma_f32_16x16x32_bf16 v[216:219],a[200:203],a[144:147],v[216:219]
 s_add_u32 s24,s24,128
 s_addc_u32 s25,s25,0
 v_mfma_f32_16x16x32_bf16 v[216:219],a[204:207],a[148:151],v[216:219]
 buffer_store_dwordx4 v[124:127],v1,s[28:31],s60 offen sc1
 ds_read_b64_tr_b16 a[20:21],v22 offset:6208
 v_mfma_f32_16x16x32_bf16 v[220:223],a[200:203],a[152:155],v[220:223]
 ds_read_b64_tr_b16 a[22:23],v22 offset:6976
 v_cvt_pk_bf16_f32 v128,v128,v129
 v_cvt_pk_bf16_f32 v129,v130,v131
 v_mfma_f32_16x16x32_bf16 v[220:223],a[204:207],a[156:159],v[220:223]
 ds_read_b64_tr_b16 a[24:25],v23 offset:64
 s_add_u32 s60,s56,9216
 v_cvt_pk_bf16_f32 v130,v160,v161
 v_mfma_f32_16x16x32_bf16 v[224:227],a[200:203],a[160:163],v[224:227]
 s_sub_u32 s26,s26,128
 ds_read_b64_tr_b16 a[26:27],v23 offset:832
 v_cvt_pk_bf16_f32 v131,v162,v163
 v_mfma_f32_16x16x32_bf16 v[224:227],a[204:207],a[164:167],v[224:227]
 buffer_store_dwordx4 v[128:131],v1,s[28:31],s60 offen sc1
 v_cvt_pk_bf16_f32 v132,v132,v133
 v_mfma_f32_16x16x32_bf16 v[228:231],a[200:203],a[168:171],v[228:231]
 ds_read_b64_tr_b16 a[28:29],v23 offset:6208
 v_cvt_pk_bf16_f32 v133,v134,v135
 s_add_u32 s60,s56,11264
 v_mfma_f32_16x16x32_bf16 v[228:231],a[204:207],a[172:175],v[228:231]
 ds_read_b64_tr_b16 a[30:31],v23 offset:6976
 v_cvt_pk_bf16_f32 v134,v164,v165
 v_cvt_pk_bf16_f32 v135,v166,v167
 v_mfma_f32_16x16x32_bf16 v[232:235],a[200:203],a[176:179],v[232:235]
 s_add_u32 s72,s72,172032
 s_addc_u32 s73,s73,0
 v_mfma_f32_16x16x32_bf16 v[232:235],a[204:207],a[180:183],v[232:235]
 buffer_store_dwordx4 v[132:135],v1,s[28:31],s60 offen sc1
 ds_read_b64_tr_b16 a[32:33],v22 offset:128
 v_mfma_f32_16x16x32_bf16 v[236:239],a[200:203],a[184:187],v[236:239]
 ds_read_b64_tr_b16 a[34:35],v22 offset:896
 v_cvt_pk_bf16_f32 v136,v136,v137
 v_cvt_pk_bf16_f32 v137,v138,v139
 v_mfma_f32_16x16x32_bf16 v[236:239],a[204:207],a[188:191],v[236:239]
 s_waitcnt lgkmcnt(9)
 ds_read_b64_tr_b16 a[36:37],v22 offset:6272
 s_add_u32 s60,s56,13312
 v_mfma_f32_16x16x32_bf16 v[240:243],a[192:195],a[128:131],v[240:243]
 s_sub_u32 s74,s74,172032
 v_cvt_pk_bf16_f32 v138,v168,v169
 v_cvt_pk_bf16_f32 v139,v170,v171
 v_mfma_f32_16x16x32_bf16 v[240:243],a[196:199],a[132:135],v[240:243]
 ds_read_b128 a[200:203],v4 offset:14336
 ds_read_b64_tr_b16 a[38:39],v22 offset:7040
 v_mfma_f32_16x16x32_bf16 v[244:247],a[192:195],a[136:139],v[244:247]
 buffer_store_dwordx4 v[136:139],v1,s[28:31],s60 offen sc1
 ds_read_b64_tr_b16 a[40:41],v23 offset:128
 v_mfma_f32_16x16x32_bf16 v[244:247],a[196:199],a[140:143],v[244:247]
 ds_read_b128 a[204:207],v5 offset:14336
 ds_read_b64_tr_b16 a[42:43],v23 offset:896
 v_cvt_pk_bf16_f32 v140,v140,v141
 v_mfma_f32_16x16x32_bf16 v[248:251],a[192:195],a[144:147],v[248:251]
 v_cvt_pk_bf16_f32 v141,v142,v143
 s_add_u32 s60,s56,15360
 v_cvt_pk_bf16_f32 v142,v172,v173
 v_mfma_f32_16x16x32_bf16 v[248:251],a[196:199],a[148:151],v[248:251]
 ds_read_b64_tr_b16 a[44:45],v23 offset:6272
 v_cvt_pk_bf16_f32 v143,v174,v175
 v_mfma_f32_16x16x32_bf16 v[252:255],a[192:195],a[152:155],v[252:255]
 buffer_store_dwordx4 v[140:143],v1,s[28:31],s60 offen sc1
 ds_read_b64_tr_b16 a[46:47],v23 offset:7040
 v_mfma_f32_16x16x32_bf16 v[252:255],a[196:199],a[156:159],v[252:255]
 v_cvt_pk_bf16_f32 v176,v176,v177
 v_cvt_pk_bf16_f32 v177,v178,v179
 s_add_u32 s60,s56,32768
 v_mfma_f32_16x16x32_bf16 a[208:211],a[192:195],a[160:163],a[208:211]
 v_cvt_pk_bf16_f32 v178,v208,v209
 v_cvt_pk_bf16_f32 v179,v210,v211
 v_mfma_f32_16x16x32_bf16 a[208:211],a[196:199],a[164:167],a[208:211]
 buffer_store_dwordx4 v[176:179],v1,s[28:31],s60 offen sc1
 v_cvt_pk_bf16_f32 v180,v180,v181
 v_mfma_f32_16x16x32_bf16 a[212:215],a[192:195],a[168:171],a[212:215]
 v_cvt_pk_bf16_f32 v181,v182,v183
 s_add_u32 s60,s56,34816
 v_cvt_pk_bf16_f32 v182,v212,v213
 v_mfma_f32_16x16x32_bf16 a[212:215],a[196:199],a[172:175],a[212:215]
 v_cvt_pk_bf16_f32 v183,v214,v215
 v_mfma_f32_16x16x32_bf16 a[216:219],a[192:195],a[176:179],a[216:219]
 v_mfma_f32_16x16x32_bf16 a[216:219],a[196:199],a[180:183],a[216:219]
 v_mfma_f32_16x16x32_bf16 a[220:223],a[192:195],a[184:187],a[220:223]
 buffer_store_dwordx4 v[180:183],v1,s[28:31],s60 offen sc1
 v_cvt_pk_bf16_f32 v184,v184,v185
 v_mfma_f32_16x16x32_bf16 a[220:223],a[196:199],a[188:191],a[220:223]
 s_waitcnt lgkmcnt(0)
 s_barrier
 v_cvt_pk_bf16_f32 v185,v186,v187
 v_mfma_f32_16x16x32_bf16 a[224:227],a[200:203],a[128:131],a[224:227]
 s_add_u32 m0,s53,53248
 s_add_u32 s60,s56,36864
 v_cvt_pk_bf16_f32 v186,v216,v217
 v_mfma_f32_16x16x32_bf16 a[224:227],a[204:207],a[132:135],a[224:227]
 buffer_load_dwordx4 v38,s[72:75],0 offen offset:0 lds
 v_cvt_pk_bf16_f32 v187,v218,v219
 v_mfma_f32_16x16x32_bf16 a[228:231],a[200:203],a[136:139],a[228:231]
 buffer_load_dwordx4 v39,s[72:75],0 offen offset:1024 lds
 v_mfma_f32_16x16x32_bf16 a[228:231],a[204:207],a[140:143],a[228:231]
 buffer_load_dwordx4 v40,s[72:75],0 offen offset:2048 lds
 v_mfma_f32_16x16x32_bf16 a[232:235],a[200:203],a[144:147],a[232:235]
 buffer_store_dwordx4 v[184:187],v1,s[28:31],s60 offen sc1
 s_add_u32 m0,s52,16384
 v_mfma_f32_16x16x32_bf16 a[232:235],a[204:207],a[148:151],a[232:235]
 v_cvt_pk_bf16_f32 v188,v188,v189
 v_cvt_pk_bf16_f32 v189,v190,v191
 s_add_u32 s60,s56,38912
 v_mfma_f32_16x16x32_bf16 a[236:239],a[200:203],a[152:155],a[236:239]
 v_cvt_pk_bf16_f32 v190,v220,v221
 v_cvt_pk_bf16_f32 v191,v222,v223
 v_mfma_f32_16x16x32_bf16 a[236:239],a[204:207],a[156:159],a[236:239]
 buffer_load_dwordx4 v20,s[24:27],s12 offen offset:0 lds
 v_mfma_f32_16x16x32_bf16 a[240:243],a[200:203],a[160:163],a[240:243]
 buffer_store_dwordx4 v[188:191],v1,s[28:31],s60 offen sc1
 s_add_u32 m0,s52,17408
 v_mfma_f32_16x16x32_bf16 a[240:243],a[204:207],a[164:167],a[240:243]
 v_cvt_pk_bf16_f32 v192,v192,v193
 v_cvt_pk_bf16_f32 v193,v194,v195
 s_add_u32 s60,s56,40960
 v_mfma_f32_16x16x32_bf16 a[244:247],a[200:203],a[168:171],a[244:247]
 v_cvt_pk_bf16_f32 v194,v224,v225
 v_cvt_pk_bf16_f32 v195,v226,v227
 v_mfma_f32_16x16x32_bf16 a[244:247],a[204:207],a[172:175],a[244:247]
 buffer_load_dwordx4 v21,s[24:27],s13 offen offset:0 lds
 v_mfma_f32_16x16x32_bf16 a[248:251],a[200:203],a[176:179],a[248:251]
 s_add_u32 m0,s52,18432
 v_mfma_f32_16x16x32_bf16 a[248:251],a[204:207],a[180:183],a[248:251]
 buffer_load_dwordx4 v20,s[24:27],s14 offen offset:0 lds
 v_mfma_f32_16x16x32_bf16 a[252:255],a[200:203],a[184:187],a[252:255]
 buffer_store_dwordx4 v[192:195],v1,s[28:31],s60 offen sc1
 s_add_u32 m0,s52,19456
 v_mfma_f32_16x16x32_bf16 a[252:255],a[204:207],a[188:191],a[252:255]
 buffer_load_dwordx4 v21,s[24:27],s15 offen offset:0 lds
 v_cvt_pk_bf16_f32 v196,v196,v197
 v_mfma_f32_16x16x32_bf16 v[48:51],a[16:19],a[48:51],0
 s_waitcnt vmcnt(17)
 s_barrier
 v_cvt_pk_bf16_f32 v197,v198,v199
 s_add_u32 s60,s56,43008
 v_cvt_pk_bf16_f32 v198,v228,v229
 v_mfma_f32_16x16x32_bf16 v[48:51],a[20:23],a[52:55],v[48:51]
 s_add_u32 s61,s51,114688
 s_add_u32 m0,s52,20480
 v_cvt_pk_bf16_f32 v199,v230,v231
 v_mfma_f32_16x16x32_bf16 v[52:55],a[24:27],a[48:51],0
 buffer_store_dwordx4 v[196:199],v1,s[28:31],s60 offen sc1
 v_add_u32 v35,s61,v2
 v_cvt_pk_bf16_f32 v200,v200,v201
 v_cvt_pk_bf16_f32 v201,v202,v203
 v_mfma_f32_16x16x32_bf16 v[52:55],a[28:31],a[52:55],v[52:55]
 v_add_u32 v36,s61,v3
 s_add_u32 s60,s56,45056
 v_cvt_pk_bf16_f32 v202,v232,v233
 v_cvt_pk_bf16_f32 v203,v234,v235
 v_mfma_f32_16x16x32_bf16 v[56:59],a[48:51],a[32:35],0
 v_add_u32 v22,0x25000,v41
 v_mfma_f32_16x16x32_bf16 v[56:59],a[52:55],a[36:39],v[56:59]
 buffer_load_dwordx4 v20,s[24:27],s16 offen offset:0 lds
 v_mfma_f32_16x16x32_bf16 v[60:63],a[48:51],a[40:43],0
 s_add_u32 m0,s52,21504
 v_add_u32 v23,0x25000,v42
 v_mfma_f32_16x16x32_bf16 v[60:63],a[52:55],a[44:47],v[60:63]
 buffer_store_dwordx4 v[200:203],v1,s[28:31],s60 offen sc1
 buffer_load_dwordx4 v21,s[24:27],s17 offen offset:0 lds
 v_cvt_pk_bf16_f32 v204,v204,v205
 v_mfma_f32_16x16x32_bf16 v[64:67],a[16:19],a[56:59],0
 s_add_u32 m0,s52,22528
 ds_read_b128 a[136:139],v35 offset:0
 v_cvt_pk_bf16_f32 v205,v206,v207
 s_add_u32 s60,s56,47104
 v_cvt_pk_bf16_f32 v206,v236,v237
 v_mfma_f32_16x16x32_bf16 v[64:67],a[20:23],a[60:63],v[64:67]
 ds_read_b128 a[140:143],v36 offset:0
 ds_read_b128 a[144:147],v35 offset:2048
 v_cvt_pk_bf16_f32 v207,v238,v239
 v_mfma_f32_16x16x32_bf16 v[68:71],a[24:27],a[56:59],0
 buffer_load_dwordx4 v20,s[24:27],s18 offen offset:0 lds
 v_mfma_f32_16x16x32_bf16 v[68:71],a[28:31],a[60:63],v[68:71]
 s_add_u32 m0,s52,23552
 ds_read_b128 a[148:151],v36 offset:2048
 v_mfma_f32_16x16x32_bf16 v[72:75],a[56:59],a[32:35],0
 buffer_store_dwordx4 v[204:207],v1,s[28:31],s60 offen sc1
 buffer_load_dwordx4 v21,s[24:27],s19 offen offset:0 lds
 v_accvgpr_read_b32 v180,a224
 v_mfma_f32_16x16x32_bf16 v[72:75],a[60:63],a[36:39],v[72:75]
 ds_read_b128 a[152:155],v35 offset:4096
 s_add_u32 m0,s52,24576
 v_accvgpr_read_b32 v181,a225
 v_accvgpr_read_b32 v182,a226
 v_accvgpr_read_b32 v183,a227
 v_mfma_f32_16x16x32_bf16 v[76:79],a[56:59],a[40:43],0
 ds_read_b128 a[156:159],v36 offset:4096
 ds_read_b128 a[160:163],v35 offset:6144
 v_cvt_pk_bf16_f32 v240,v240,v241
 v_cvt_pk_bf16_f32 v241,v242,v243
 s_add_u32 s60,s56,33792
 v_mfma_f32_16x16x32_bf16 v[76:79],a[60:63],a[44:47],v[76:79]
 buffer_load_dwordx4 v20,s[24:27],s20 offen offset:0 lds
 v_cvt_pk_bf16_f32 v242,v180,v181
 v_cvt_pk_bf16_f32 v243,v182,v183
 v_mfma_f32_16x16x32_bf16 v[80:83],a[0:3],a[56:59],0
 s_add_u32 s24,s24,128
 s_addc_u32 s25,s25,0
 v_mfma_f32_16x16x32_bf16 v[80:83],a[4:7],a[60:63],v[80:83]
 buffer_store_dwordx4 v[240:243],v1,s[28:31],s60 offen sc1
 ds_read_b128 a[164:167],v36 offset:6144
 s_sub_u32 s26,s26,128
 v_accvgpr_read_b32 v188,a228
 v_mfma_f32_16x16x32_bf16 v[84:87],a[8:11],a[56:59],0
 ds_read_b128 a[168:171],v35 offset:8192
 ds_read_b128 a[172:175],v36 offset:8192
 v_accvgpr_read_b32 v189,a229
 v_accvgpr_read_b32 v190,a230
 v_accvgpr_read_b32 v191,a231
 v_mfma_f32_16x16x32_bf16 v[84:87],a[12:15],a[60:63],v[84:87]
 s_add_u32 s72,s72,172032
 s_addc_u32 s73,s73,0
 v_cvt_pk_bf16_f32 v244,v244,v245
 v_cvt_pk_bf16_f32 v245,v246,v247
 s_add_u32 s60,s56,35840
 v_mfma_f32_16x16x32_bf16 v[88:91],a[16:19],a[64:67],0
 ds_read_b64_tr_b16 a[88:89],v22 offset:0
 s_sub_u32 s74,s74,172032
 v_cvt_pk_bf16_f32 v246,v188,v189
 v_cvt_pk_bf16_f32 v247,v190,v191
 v_mfma_f32_16x16x32_bf16 v[88:91],a[20:23],a[68:71],v[88:91]
 ds_read_b64_tr_b16 a[90:91],v22 offset:768
 s_add_u32 m0,s53,102400
 v_mfma_f32_16x16x32_bf16 v[92:95],a[24:27],a[64:67],0
 buffer_store_dwordx4 v[244:247],v1,s[28:31],s60 offen sc1
 ds_read_b64_tr_b16 a[92:93],v22 offset:6144
 ds_read_b64_tr_b16 a[94:95],v22 offset:6912
 v_accvgpr_read_b32 v180,a232
 v_mfma_f32_16x16x32_bf16 v[92:95],a[28:31],a[68:71],v[92:95]
 ds_read_b64_tr_b16 a[96:97],v23 offset:0
 ds_read_b64_tr_b16 a[98:99],v23 offset:768
 v_accvgpr_read_b32 v181,a233
 v_accvgpr_read_b32 v182,a234
 v_accvgpr_read_b32 v183,a235
 v_mfma_f32_16x16x32_bf16 v[96:99],a[64:67],a[32:35],0
 ds_read_b64_tr_b16 a[100:101],v23 offset:6144
 v_cvt_pk_bf16_f32 v248,v248,v249
 v_cvt_pk_bf16_f32 v249,v250,v251
 s_add_u32 s60,s56,37888
 v_cvt_pk_bf16_f32 v250,v180,v181
 v_mfma_f32_16x16x32_bf16 v[96:99],a[68:71],a[36:39],v[96:99]
 buffer_load_dwordx4 v38,s[72:75],0 offen offset:0 lds
 v_cvt_pk_bf16_f32 v251,v182,v183
 v_mfma_f32_16x16x32_bf16 v[100:103],a[64:67],a[40:43],0
 buffer_load_dwordx4 v39,s[72:75],0 offen offset:1024 lds
 v_mfma_f32_16x16x32_bf16 v[100:103],a[68:71],a[44:47],v[100:103]
 buffer_store_dwordx4 v[248:251],v1,s[28:31],s60 offen sc1
 buffer_load_dwordx4 v40,s[72:75],0 offen offset:2048 lds
 v_accvgpr_read_b32 v188,a236
 v_mfma_f32_16x16x32_bf16 v[104:107],a[0:3],a[64:67],0
 s_add_u32 m0,s52,65536
 ds_read_b64_tr_b16 a[102:103],v23 offset:6912
 v_accvgpr_read_b32 v189,a237
 v_accvgpr_read_b32 v190,a238
 v_accvgpr_read_b32 v191,a239
 v_mfma_f32_16x16x32_bf16 v[104:107],a[4:7],a[68:71],v[104:107]
 ds_read_b64_tr_b16 a[104:105],v22 offset:64
 ds_read_b64_tr_b16 a[106:107],v22 offset:832
 v_cvt_pk_bf16_f32 v252,v252,v253
 v_cvt_pk_bf16_f32 v253,v254,v255
 s_add_u32 s60,s56,39936
 v_mfma_f32_16x16x32_bf16 v[108:111],a[8:11],a[64:67],0
 buffer_load_dwordx4 v20,s[24:27],s12 offen offset:0 lds
 v_cvt_pk_bf16_f32 v254,v188,v189
 v_cvt_pk_bf16_f32 v255,v190,v191
 v_mfma_f32_16x16x32_bf16 v[108:111],a[12:15],a[68:71],v[108:111]
 s_add_u32 m0,s52,66560
 ds_read_b64_tr_b16 a[108:109],v22 offset:6208
 v_mfma_f32_16x16x32_bf16 v[112:115],a[16:19],a[72:75],0
 buffer_store_dwordx4 v[252:255],v1,s[28:31],s60 offen sc1
 buffer_load_dwordx4 v21,s[24:27],s13 offen offset:0 lds
 v_accvgpr_read_b32 v176,a208
 v_mfma_f32_16x16x32_bf16 v[112:115],a[20:23],a[76:79],v[112:115]
 s_add_u32 m0,s52,67584
 ds_read_b64_tr_b16 a[110:111],v22 offset:6976
 v_accvgpr_read_b32 v177,a209
 v_accvgpr_read_b32 v178,a210
 v_accvgpr_read_b32 v179,a211
 v_mfma_f32_16x16x32_bf16 v[116:119],a[24:27],a[72:75],0
 ds_read_b64_tr_b16 a[112:113],v23 offset:64
 ds_read_b64_tr_b16 a[114:115],v23 offset:832
 v_accvgpr_read_b32 v180,a240
 v_accvgpr_read_b32 v181,a241
 v_accvgpr_read_b32 v182,a242
 v_mfma_f32_16x16x32_bf16 v[116:119],a[28:31],a[76:79],v[116:119]
 buffer_load_dwordx4 v20,s[24:27],s14 offen offset:0 lds
 v_accvgpr_read_b32 v183,a243
 v_cvt_pk_bf16_f32 v176,v176,v177
 v_cvt_pk_bf16_f32 v177,v178,v179
 v_mfma_f32_16x16x32_bf16 v[120:123],a[72:75],a[32:35],0
 s_add_u32 m0,s52,68608
 ds_read_b64_tr_b16 a[116:117],v23 offset:6208
 s_add_u32 s60,s56,41984
 v_cvt_pk_bf16_f32 v178,v180,v181
 v_cvt_pk_bf16_f32 v179,v182,v183
 v_mfma_f32_16x16x32_bf16 v[120:123],a[76:79],a[36:39],v[120:123]
 buffer_store_dwordx4 v[176:179],v1,s[28:31],s60 offen sc1
 buffer_load_dwordx4 v21,s[24:27],s15 offen offset:0 lds
 v_accvgpr_read_b32 v184,a212
 v_mfma_f32_16x16x32_bf16 v[124:127],a[72:75],a[40:43],0
 ds_read_b64_tr_b16 a[118:119],v23 offset:6976
 s_add_u32 m0,s52,69632
 v_accvgpr_read_b32 v185,a213
 v_accvgpr_read_b32 v186,a214
 v_accvgpr_read_b32 v187,a215
 v_mfma_f32_16x16x32_bf16 v[124:127],a[76:79],a[44:47],v[124:127]
 ds_read_b64_tr_b16 a[120:121],v22 offset:128
 ds_read_b64_tr_b16 a[122:123],v22 offset:896
 v_accvgpr_read_b32 v188,a244
 v_accvgpr_read_b32 v189,a245
 v_accvgpr_read_b32 v190,a246
 v_mfma_f32_16x16x32_bf16 v[128:131],a[0:3],a[72:75],0
 buffer_load_dwordx4 v20,s[24:27],s16 offen offset:0 lds
 v_accvgpr_read_b32 v191,a247
 v_cvt_pk_bf16_f32 v184,v184,v185
 v_cvt_pk_bf16_f32 v185,v186,v187
 v_mfma_f32_16x16x32_bf16 v[128:131],a[4:7],a[76:79],v[128:131]
 ds_read_b64_tr_b16 a[124:125],v22 offset:6272
 s_add_u32 m0,s52,70656
 s_add_u32 s60,s56,44032
 v_cvt_pk_bf16_f32 v186,v188,v189
 v_cvt_pk_bf16_f32 v187,v190,v191
 v_mfma_f32_16x16x32_bf16 v[132:135],a[8:11],a[72:75],0
 buffer_store_dwordx4 v[184:187],v1,s[28:31],s60 offen sc1
 ds_read_b64_tr_b16 a[126:127],v22 offset:7040
 ds_read_b64_tr_b16 a[128:129],v23 offset:128
 v_accvgpr_read_b32 v176,a216
 v_mfma_f32_16x16x32_bf16 v[132:135],a[12:15],a[76:79],v[132:135]
 ds_read_b64_tr_b16 a[130:131],v23 offset:896
 ds_read_b64_tr_b16 a[132:133],v23 offset:6272
 v_accvgpr_read_b32 v177,a217
 v_accvgpr_read_b32 v178,a218
 v_accvgpr_read_b32 v179,a219
 v_mfma_f32_16x16x32_bf16 v[136:139],a[16:19],a[80:83],0
 ds_read_b64_tr_b16 a[134:135],v23 offset:7040
 v_accvgpr_read_b32 v180,a248
 v_accvgpr_read_b32 v181,a249
 v_accvgpr_read_b32 v182,a250
 v_accvgpr_read_b32 v183,a251
 v_mfma_f32_16x16x32_bf16 v[136:139],a[20:23],a[84:87],v[136:139]
 buffer_load_dwordx4 v21,s[24:27],s17 offen offset:0 lds
 v_cvt_pk_bf16_f32 v176,v176,v177
 v_cvt_pk_bf16_f32 v177,v178,v179
 s_add_u32 s60,s56,46080
 v_mfma_f32_16x16x32_bf16 v[140:143],a[24:27],a[80:83],0
 s_add_u32 m0,s52,71680
 v_cvt_pk_bf16_f32 v178,v180,v181
 v_cvt_pk_bf16_f32 v179,v182,v183
 v_mfma_f32_16x16x32_bf16 v[140:143],a[28:31],a[84:87],v[140:143]
 buffer_store_dwordx4 v[176:179],v1,s[28:31],s60 offen sc1
 buffer_load_dwordx4 v20,s[24:27],s18 offen offset:0 lds
 v_accvgpr_read_b32 v184,a220
 v_mfma_f32_16x16x32_bf16 v[144:147],a[80:83],a[32:35],0
 s_add_u32 m0,s52,72704
 v_accvgpr_read_b32 v185,a221
 v_accvgpr_read_b32 v186,a222
 v_accvgpr_read_b32 v187,a223
 v_accvgpr_read_b32 v188,a252
 v_mfma_f32_16x16x32_bf16 v[144:147],a[84:87],a[36:39],v[144:147]
 buffer_load_dwordx4 v21,s[24:27],s19 offen offset:0 lds
 v_accvgpr_read_b32 v189,a253
 v_accvgpr_read_b32 v190,a254
 v_accvgpr_read_b32 v191,a255
 v_mfma_f32_16x16x32_bf16 v[148:151],a[80:83],a[40:43],0
 s_add_u32 m0,s52,73728
 v_cvt_pk_bf16_f32 v184,v184,v185
 v_cvt_pk_bf16_f32 v185,v186,v187
 s_add_u32 s60,s56,48128
 v_cvt_pk_bf16_f32 v186,v188,v189
 v_mfma_f32_16x16x32_bf16 v[148:151],a[84:87],a[44:47],v[148:151]
 buffer_load_dwordx4 v20,s[24:27],s20 offen offset:0 lds
 v_cvt_pk_bf16_f32 v187,v190,v191
 v_mfma_f32_16x16x32_bf16 v[152:155],a[0:3],a[80:83],0
 buffer_store_dwordx4 v[184:187],v1,s[28:31],s60 offen sc1
 s_add_u32 s24,s24,128
 s_addc_u32 s25,s25,0
 v_mfma_f32_16x16x32_bf16 v[152:155],a[4:7],a[84:87],v[152:155]
 s_sub_u32 s26,s26,128
 v_mfma_f32_16x16x32_bf16 v[156:159],a[8:11],a[80:83],0
 s_add_u32 s72,s72,172032
 s_addc_u32 s73,s73,0
 v_mfma_f32_16x16x32_bf16 v[156:159],a[12:15],a[84:87],v[156:159]
 s_waitcnt lgkmcnt(0)
 s_sub_u32 s74,s74,172032
 v_mfma_f32_16x16x32_bf16 v[48:51],a[104:107],a[136:139],v[48:51]
 s_waitcnt vmcnt(0)
 s_barrier
 s_cmp_eq_u32 s45,0
 s_cbranch_scc0 SIG_18
 s_add_u32 s62,s46,0
 s_lshl_b32 s62,s62,7
 s_add_u32 s62,s62,125829120
 v_mov_b32 v25,1
 v_mov_b32 v26,0
 s_mov_b64 exec,1
 buffer_atomic_add v25,v26,s[28:31],s62 offen sc1
 s_mov_b64 exec,-1
SIG_18:
 v_mfma_f32_16x16x32_bf16 v[48:51],a[108:111],a[140:143],v[48:51]
 s_add_u32 s61,s51,16384
 s_add_u32 m0,s53,151552
 v_mfma_f32_16x16x32_bf16 v[52:55],a[112:115],a[136:139],v[52:55]
 v_add_u32 v35,s61,v2
 v_mfma_f32_16x16x32_bf16 v[52:55],a[116:119],a[140:143],v[52:55]
 buffer_load_dwordx4 v38,s[72:75],0 offen offset:0 lds
 v_mfma_f32_16x16x32_bf16 v[56:59],a[136:139],a[120:123],v[56:59]
 v_add_u32 v36,s61,v3
 v_add_u32 v22,0xd000,v41
 v_mfma_f32_16x16x32_bf16 v[56:59],a[140:143],a[124:127],v[56:59]
 buffer_load_dwordx4 v39,s[72:75],0 offen offset:1024 lds
 v_mfma_f32_16x16x32_bf16 v[60:63],a[136:139],a[128:131],v[60:63]
 v_add_u32 v23,0xd000,v42
 v_mfma_f32_16x16x32_bf16 v[60:63],a[140:143],a[132:135],v[60:63]
 ds_read_b128 a[48:51],v35 offset:0
 ds_read_b128 a[52:55],v36 offset:0
 v_mfma_f32_16x16x32_bf16 v[64:67],a[104:107],a[144:147],v[64:67]
 buffer_load_dwordx4 v40,s[72:75],0 offen offset:2048 lds
 v_mfma_f32_16x16x32_bf16 v[64:67],a[108:111],a[148:151],v[64:67]
 ds_read_b128 a[56:59],v35 offset:2048
 s_add_u32 m0,s52,114688
 v_mfma_f32_16x16x32_bf16 v[68:71],a[112:115],a[144:147],v[68:71]
 ds_read_b128 a[60:63],v36 offset:2048
 ds_read_b128 a[64:67],v35 offset:4096
 v_mfma_f32_16x16x32_bf16 v[68:71],a[116:119],a[148:151],v[68:71]
 buffer_load_dwordx4 v20,s[24:27],s12 offen offset:0 lds
 v_mfma_f32_16x16x32_bf16 v[72:75],a[144:147],a[120:123],v[72:75]
 ds_read_b128 a[68:71],v36 offset:4096
 v_mfma_f32_16x16x32_bf16 v[72:75],a[148:151],a[124:127],v[72:75]
 s_add_u32 m0,s52,115712
 ds_read_b128 a[72:75],v35 offset:6144
 v_mfma_f32_16x16x32_bf16 v[76:79],a[144:147],a[128:131],v[76:79]
 ds_read_b128 a[76:79],v36 offset:6144
 v_mfma_f32_16x16x32_bf16 v[76:79],a[148:151],a[132:135],v[76:79]
 buffer_load_dwordx4 v21,s[24:27],s13 offen offset:0 lds
 v_mfma_f32_16x16x32_bf16 v[80:83],a[88:91],a[144:147],v[80:83]
 ds_read_b128 a[80:83],v35 offset:8192
 ds_read_b128 a[84:87],v36 offset:8192
 v_mfma_f32_16x16x32_bf16 v[80:83],a[92:95],a[148:151],v[80:83]
 s_add_u32 m0,s52,116736
 ds_read_b64_tr_b16 a[0:1],v22 offset:0
 v_mfma_f32_16x16x32_bf16 v[84:87],a[96:99],a[144:147],v[84:87]
 ds_read_b64_tr_b16 a[2:3],v22 offset:768
 v_mfma_f32_16x16x32_bf16 v[84:87],a[100:103],a[148:151],v[84:87]
 buffer_load_dwordx4 v20,s[24:27],s14 offen offset:0 lds
 v_mfma_f32_16x16x32_bf16 v[88:91],a[104:107],a[152:155],v[88:91]
 ds_read_b64_tr_b16 a[4:5],v22 offset:6144
 ds_read_b64_tr_b16 a[6:7],v22 offset:6912
 v_mfma_f32_16x16x32_bf16 v[88:91],a[108:111],a[156:159],v[88:91]
 s_add_u32 m0,s52,117760
 ds_read_b64_tr_b16 a[8:9],v23 offset:0
 v_mfma_f32_16x16x32_bf16 v[92:95],a[112:115],a[152:155],v[92:95]
 v_mfma_f32_16x16x32_bf16 v[92:95],a[116:119],a[156:159],v[92:95]
 buffer_load_dwordx4 v21,s[24:27],s15 offen offset:0 lds
 v_mfma_f32_16x16x32_bf16 v[96:99],a[152:155],a[120:123],v[96:99]
 ds_read_b64_tr_b16 a[10:11],v23 offset:768
 ds_read_b64_tr_b16 a[12:13],v23 offset:6144
 v_mfma_f32_16x16x32_bf16 v[96:99],a[156:159],a[124:127],v[96:99]
 s_add_u32 m0,s52,118784
 ds_read_b64_tr_b16 a[14:15],v23 offset:6912
 v_mfma_f32_16x16x32_bf16 v[100:103],a[152:155],a[128:131],v[100:103]
 ds_read_b64_tr_b16 a[16:17],v22 offset:64
 v_mfma_f32_16x16x32_bf16 v[100:103],a[156:159],a[132:135],v[100:103]
 buffer_load_dwordx4 v20,s[24:27],s16 offen offset:0 lds
 v_mfma_f32_16x16x32_bf16 v[104:107],a[88:91],a[152:155],v[104:107]
 ds_read_b64_tr_b16 a[18:19],v22 offset:832
 ds_read_b64_tr_b16 a[20:21],v22 offset:6208
 v_mfma_f32_16x16x32_bf16 v[104:107],a[92:95],a[156:159],v[104:107]
 s_add_u32 m0,s52,119808
 ds_read_b64_tr_b16 a[22:23],v22 offset:6976
 v_mfma_f32_16x16x32_bf16 v[108:111],a[96:99],a[152:155],v[108:111]
 ds_read_b64_tr_b16 a[24:25],v23 offset:64
 v_mfma_f32_16x16x32_bf16 v[108:111],a[100:103],a[156:159],v[108:111]
 buffer_load_dwordx4 v21,s[24:27],s17 offen offset:0 lds
 v_mfma_f32_16x16x32_bf16 v[112:115],a[104:107],a[160:163],v[112:115]
 ds_read_b64_tr_b16 a[26:27],v23 offset:832
 ds_read_b64_tr_b16 a[28:29],v23 offset:6208
 v_mfma_f32_16x16x32_bf16 v[112:115],a[108:111],a[164:167],v[112:115]
 s_add_u32 m0,s52,120832
 v_mfma_f32_16x16x32_bf16 v[116:119],a[112:115],a[160:163],v[116:119]
 ds_read_b64_tr_b16 a[30:31],v23 offset:6976
 v_mfma_f32_16x16x32_bf16 v[116:119],a[116:119],a[164:167],v[116:119]
 buffer_load_dwordx4 v20,s[24:27],s18 offen offset:0 lds
 v_mfma_f32_16x16x32_bf16 v[120:123],a[160:163],a[120:123],v[120:123]
 ds_read_b64_tr_b16 a[32:33],v22 offset:128
 ds_read_b64_tr_b16 a[34:35],v22 offset:896
 v_mfma_f32_16x16x32_bf16 v[120:123],a[164:167],a[124:127],v[120:123]
 s_add_u32 m0,s52,121856
 ds_read_b64_tr_b16 a[36:37],v22 offset:6272
 v_mfma_f32_16x16x32_bf16 v[124:127],a[160:163],a[128:131],v[124:127]
 ds_read_b64_tr_b16 a[38:39],v22 offset:7040
 v_mfma_f32_16x16x32_bf16 v[124:127],a[164:167],a[132:135],v[124:127]
 buffer_load_dwordx4 v21,s[24:27],s19 offen offset:0 lds
 v_mfma_f32_16x16x32_bf16 v[128:131],a[88:91],a[160:163],v[128:131]
 ds_read_b64_tr_b16 a[40:41],v23 offset:128
 ds_read_b64_tr_b16 a[42:43],v23 offset:896
 v_mfma_f32_16x16x32_bf16 v[128:131],a[92:95],a[164:167],v[128:131]
 s_add_u32 m0,s52,122880
 ds_read_b64_tr_b16 a[44:45],v23 offset:6272
 v_mfma_f32_16x16x32_bf16 v[132:135],a[96:99],a[160:163],v[132:135]
 ds_read_b64_tr_b16 a[46:47],v23 offset:7040
 v_mfma_f32_16x16x32_bf16 v[132:135],a[100:103],a[164:167],v[132:135]
 buffer_load_dwordx4 v20,s[24:27],s20 offen offset:0 lds
 v_mfma_f32_16x16x32_bf16 v[136:139],a[104:107],a[168:171],v[136:139]
 v_mfma_f32_16x16x32_bf16 v[136:139],a[108:111],a[172:175],v[136:139]
 s_add_u32 s24,s24,128
 s_addc_u32 s25,s25,0
 v_mfma_f32_16x16x32_bf16 v[140:143],a[112:115],a[168:171],v[140:143]
 v_mfma_f32_16x16x32_bf16 v[140:143],a[116:119],a[172:175],v[140:143]
 s_sub_u32 s26,s26,128
 v_mfma_f32_16x16x32_bf16 v[144:147],a[168:171],a[120:123],v[144:147]
 v_mfma_f32_16x16x32_bf16 v[144:147],a[172:175],a[124:127],v[144:147]
 s_add_u32 s72,s72,172032
 s_addc_u32 s73,s73,0
 v_mfma_f32_16x16x32_bf16 v[148:151],a[168:171],a[128:131],v[148:151]
 v_mfma_f32_16x16x32_bf16 v[148:151],a[172:175],a[132:135],v[148:151]
 s_sub_u32 s74,s74,172032
 v_mfma_f32_16x16x32_bf16 v[152:155],a[88:91],a[168:171],v[152:155]
 v_mfma_f32_16x16x32_bf16 v[152:155],a[92:95],a[172:175],v[152:155]
 v_mfma_f32_16x16x32_bf16 v[156:159],a[96:99],a[168:171],v[156:159]
 v_mfma_f32_16x16x32_bf16 v[156:159],a[100:103],a[172:175],v[156:159]
 s_waitcnt lgkmcnt(0)
 v_mfma_f32_16x16x32_bf16 v[48:51],a[16:19],a[48:51],v[48:51]
 s_waitcnt vmcnt(13)
 s_barrier
 v_mfma_f32_16x16x32_bf16 v[48:51],a[20:23],a[52:55],v[48:51]
 s_add_u32 s61,s51,65536
 s_add_u32 m0,s53,53248
 v_mfma_f32_16x16x32_bf16 v[52:55],a[24:27],a[48:51],v[52:55]
 v_add_u32 v35,s61,v2
 v_mfma_f32_16x16x32_bf16 v[52:55],a[28:31],a[52:55],v[52:55]
 buffer_load_dwordx4 v38,s[72:75],0 offen offset:0 lds
 v_mfma_f32_16x16x32_bf16 v[56:59],a[48:51],a[32:35],v[56:59]
 v_add_u32 v36,s61,v3
 v_add_u32 v22,0x19000,v41
 v_mfma_f32_16x16x32_bf16 v[56:59],a[52:55],a[36:39],v[56:59]
 buffer_load_dwordx4 v39,s[72:75],0 offen offset:1024 lds
 v_mfma_f32_16x16x32_bf16 v[60:63],a[48:51],a[40:43],v[60:63]
 v_add_u32 v23,0x19000,v42
 v_mfma_f32_16x16x32_bf16 v[60:63],a[52:55],a[44:47],v[60:63]
 ds_read_b128 a[136:139],v35 offset:0
 ds_read_b128 a[140:143],v36 offset:0
 v_mfma_f32_16x16x32_bf16 v[64:67],a[16:19],a[56:59],v[64:67]
 buffer_load_dwordx4 v40,s[72:75],0 offen offset:2048 lds
 v_mfma_f32_16x16x32_bf16 v[64:67],a[20:23],a[60:63],v[64:67]
 ds_read_b128 a[144:147],v35 offset:2048
 s_add_u32 m0,s52,16384
 v_mfma_f32_16x16x32_bf16 v[68:71],a[24:27],a[56:59],v[68:71]
 ds_read_b128 a[148:151],v36 offset:2048
 ds_read_b128 a[152:155],v35 offset:4096
 v_mfma_f32_16x16x32_bf16 v[68:71],a[28:31],a[60:63],v[68:71]
 buffer_load_dwordx4 v20,s[24:27],s12 offen offset:0 lds
 v_mfma_f32_16x16x32_bf16 v[72:75],a[56:59],a[32:35],v[72:75]
 ds_read_b128 a[156:159],v36 offset:4096
 v_mfma_f32_16x16x32_bf16 v[72:75],a[60:63],a[36:39],v[72:75]
 s_add_u32 m0,s52,17408
 ds_read_b128 a[160:163],v35 offset:6144
 v_mfma_f32_16x16x32_bf16 v[76:79],a[56:59],a[40:43],v[76:79]
 ds_read_b128 a[164:167],v36 offset:6144
 v_mfma_f32_16x16x32_bf16 v[76:79],a[60:63],a[44:47],v[76:79]
 buffer_load_dwordx4 v21,s[24:27],s13 offen offset:0 lds
 v_mfma_f32_16x16x32_bf16 v[80:83],a[0:3],a[56:59],v[80:83]
 ds_read_b128 a[168:171],v35 offset:8192
 ds_read_b128 a[172:175],v36 offset:8192
 v_mfma_f32_16x16x32_bf16 v[80:83],a[4:7],a[60:63],v[80:83]
 s_add_u32 m0,s52,18432
 ds_read_b64_tr_b16 a[88:89],v22 offset:0
 v_mfma_f32_16x16x32_bf16 v[84:87],a[8:11],a[56:59],v[84:87]
 ds_read_b64_tr_b16 a[90:91],v22 offset:768
 v_mfma_f32_16x16x32_bf16 v[84:87],a[12:15],a[60:63],v[84:87]
 buffer_load_dwordx4 v20,s[24:27],s14 offen offset:0 lds
 v_mfma_f32_16x16x32_bf16 v[88:91],a[16:19],a[64:67],v[88:91]
 ds_read_b64_tr_b16 a[92:93],v22 offset:6144
 ds_read_b64_tr_b16 a[94:95],v22 offset:6912
 v_mfma_f32_16x16x32_bf16 v[88:91],a[20:23],a[68:71],v[88:91]
 s_add_u32 m0,s52,19456
 ds_read_b64_tr_b16 a[96:97],v23 offset:0
 v_mfma_f32_16x16x32_bf16 v[92:95],a[24:27],a[64:67],v[92:95]
 v_mfma_f32_16x16x32_bf16 v[92:95],a[28:31],a[68:71],v[92:95]
 buffer_load_dwordx4 v21,s[24:27],s15 offen offset:0 lds
 v_mfma_f32_16x16x32_bf16 v[96:99],a[64:67],a[32:35],v[96:99]
 ds_read_b64_tr_b16 a[98:99],v23 offset:768
 ds_read_b64_tr_b16 a[100:101],v23 offset:6144
 v_mfma_f32_16x16x32_bf16 v[96:99],a[68:71],a[36:39],v[96:99]
 s_add_u32 m0,s52,20480
 ds_read_b64_tr_b16 a[102:103],v23 offset:6912
 v_mfma_f32_16x16x32_bf16 v[100:103],a[64:67],a[40:43],v[100:103]
 ds_read_b64_tr_b16 a[104:105],v22 offset:64
 v_mfma_f32_16x16x32_bf16 v[100:103],a[68:71],a[44:47],v[100:103]
 buffer_load_dwordx4 v20,s[24:27],s16 offen offset:0 lds
 v_mfma_f32_16x16x32_bf16 v[104:107],a[0:3],a[64:67],v[104:107]
 ds_read_b64_tr_b16 a[106:107],v22 offset:832
 ds_read_b64_tr_b16 a[108:109],v22 offset:6208
 v_mfma_f32_16x16x32_bf16 v[104:107],a[4:7],a[68:71],v[104:107]
 s_add_u32 m0,s52,21504
 ds_read_b64_tr_b16 a[110:111],v22 offset:6976
 v_mfma_f32_16x16x32_bf16 v[108:111],a[8:11],a[64:67],v[108:111]
 ds_read_b64_tr_b16 a[112:113],v23 offset:64
 v_mfma_f32_16x16x32_bf16 v[108:111],a[12:15],a[68:71],v[108:111]
 buffer_load_dwordx4 v21,s[24:27],s17 offen offset:0 lds
 v_mfma_f32_16x16x32_bf16 v[112:115],a[16:19],a[72:75],v[112:115]
 ds_read_b64_tr_b16 a[114:115],v23 offset:832
 ds_read_b64_tr_b16 a[116:117],v23 offset:6208
 v_mfma_f32_16x16x32_bf16 v[112:115],a[20:23],a[76:79],v[112:115]
 s_add_u32 m0,s52,22528
 v_mfma_f32_16x16x32_bf16 v[116:119],a[24:27],a[72:75],v[116:119]
 ds_read_b64_tr_b16 a[118:119],v23 offset:6976
 v_mfma_f32_16x16x32_bf16 v[116:119],a[28:31],a[76:79],v[116:119]
 buffer_load_dwordx4 v20,s[24:27],s18 offen offset:0 lds
 v_mfma_f32_16x16x32_bf16 v[120:123],a[72:75],a[32:35],v[120:123]
 ds_read_b64_tr_b16 a[120:121],v22 offset:128
 ds_read_b64_tr_b16 a[122:123],v22 offset:896
 v_mfma_f32_16x16x32_bf16 v[120:123],a[76:79],a[36:39],v[120:123]
 s_add_u32 m0,s52,23552
 ds_read_b64_tr_b16 a[124:125],v22 offset:6272
 v_mfma_f32_16x16x32_bf16 v[124:127],a[72:75],a[40:43],v[124:127]
 ds_read_b64_tr_b16 a[126:127],v22 offset:7040
 v_mfma_f32_16x16x32_bf16 v[124:127],a[76:79],a[44:47],v[124:127]
 buffer_load_dwordx4 v21,s[24:27],s19 offen offset:0 lds
 v_mfma_f32_16x16x32_bf16 v[128:131],a[0:3],a[72:75],v[128:131]
 ds_read_b64_tr_b16 a[128:129],v23 offset:128
 ds_read_b64_tr_b16 a[130:131],v23 offset:896
 v_mfma_f32_16x16x32_bf16 v[128:131],a[4:7],a[76:79],v[128:131]
 s_add_u32 m0,s52,24576
 ds_read_b64_tr_b16 a[132:133],v23 offset:6272
 v_mfma_f32_16x16x32_bf16 v[132:135],a[8:11],a[72:75],v[132:135]
 ds_read_b64_tr_b16 a[134:135],v23 offset:7040
 v_mfma_f32_16x16x32_bf16 v[132:135],a[12:15],a[76:79],v[132:135]
 buffer_load_dwordx4 v20,s[24:27],s20 offen offset:0 lds
 v_mfma_f32_16x16x32_bf16 v[136:139],a[16:19],a[80:83],v[136:139]
 v_mfma_f32_16x16x32_bf16 v[136:139],a[20:23],a[84:87],v[136:139]
 s_add_u32 s24,s24,128
 s_addc_u32 s25,s25,0
 v_mfma_f32_16x16x32_bf16 v[140:143],a[24:27],a[80:83],v[140:143]
 v_mfma_f32_16x16x32_bf16 v[140:143],a[28:31],a[84:87],v[140:143]
 s_sub_u32 s26,s26,128
 v_mfma_f32_16x16x32_bf16 v[144:147],a[80:83],a[32:35],v[144:147]
 v_mfma_f32_16x16x32_bf16 v[144:147],a[84:87],a[36:39],v[144:147]
 s_add_u32 s72,s72,172032
 s_addc_u32 s73,s73,0
 v_mfma_f32_16x16x32_bf16 v[148:151],a[80:83],a[40:43],v[148:151]
 v_mfma_f32_16x16x32_bf16 v[148:151],a[84:87],a[44:47],v[148:151]
 s_sub_u32 s74,s74,172032
 v_mfma_f32_16x16x32_bf16 v[152:155],a[0:3],a[80:83],v[152:155]
 v_mfma_f32_16x16x32_bf16 v[152:155],a[4:7],a[84:87],v[152:155]
 v_mfma_f32_16x16x32_bf16 v[156:159],a[8:11],a[80:83],v[156:159]
 v_mfma_f32_16x16x32_bf16 v[156:159],a[12:15],a[84:87],v[156:159]
 s_waitcnt lgkmcnt(0)
 v_mfma_f32_16x16x32_bf16 v[48:51],a[104:107],a[136:139],v[48:51]
 s_waitcnt vmcnt(12)
 s_barrier
 v_mfma_f32_16x16x32_bf16 v[48:51],a[108:111],a[140:143],v[48:51]
 s_add_u32 s61,s51,114688
 s_add_u32 m0,s53,102400
 v_mfma_f32_16x16x32_bf16 v[52:55],a[112:115],a[136:139],v[52:55]
 v_add_u32 v35,s61,v2
 v_mfma_f32_16x16x32_bf16 v[52:55],a[116:119],a[140:143],v[52:55]
 buffer_load_dwordx4 v38,s[72:75],0 offen offset:0 lds
 v_mfma_f32_16x16x32_bf16 v[56:59],a[136:139],a[120:123],v[56:59]
 v_add_u32 v36,s61,v3
 v_add_u32 v22,0x25000,v41
 v_mfma_f32_16x16x32_bf16 v[56:59],a[140:143],a[124:127],v[56:59]
 buffer_load_dwordx4 v39,s[72:75],0 offen offset:1024 lds
 v_mfma_f32_16x16x32_bf16 v[60:63],a[136:139],a[128:131],v[60:63]
 v_add_u32 v23,0x25000,v42
 v_mfma_f32_16x16x32_bf16 v[60:63],a[140:143],a[132:135],v[60:63]
 ds_read_b128 a[48:51],v35 offset:0
 ds_read_b128 a[52:55],v36 offset:0
 v_mfma_f32_16x16x32_bf16 v[64:67],a[104:107],a[144:147],v[64:67]
 buffer_load_dwordx4 v40,s[72:75],0 offen offset:2048 lds
 v_mfma_f32_16x16x32_bf16 v[64:67],a[108:111],a[148:151],v[64:67]
 ds_read_b128 a[56:59],v35 offset:2048
 s_add_u32 m0,s52,65536
 v_mfma_f32_16x16x32_bf16 v[68:71],a[112:115],a[144:147],v[68:71]
 ds_read_b128 a[60:63],v36 offset:2048
 ds_read_b128 a[64:67],v35 offset:4096
 v_mfma_f32_16x16x32_bf16 v[68:71],a[116:119],a[148:151],v[68:71]
 buffer_load_dwordx4 v20,s[24:27],s12 offen offset:0 lds
 v_mfma_f32_16x16x32_bf16 v[72:75],a[144:147],a[120:123],v[72:75]
 ds_read_b128 a[68:71],v36 offset:4096
 v_mfma_f32_16x16x32_bf16 v[72:75],a[148:151],a[124:127],v[72:75]
 s_add_u32 m0,s52,66560
 ds_read_b128 a[72:75],v35 offset:6144
 v_mfma_f32_16x16x32_bf16 v[76:79],a[144:147],a[128:131],v[76:79]
 ds_read_b128 a[76:79],v36 offset:6144
 v_mfma_f32_16x16x32_bf16 v[76:79],a[148:151],a[132:135],v[76:79]
 buffer_load_dwordx4 v21,s[24:27],s13 offen offset:0 lds
 v_mfma_f32_16x16x32_bf16 v[80:83],a[88:91],a[144:147],v[80:83]
 ds_read_b128 a[80:83],v35 offset:8192
 ds_read_b128 a[84:87],v36 offset:8192
 v_mfma_f32_16x16x32_bf16 v[80:83],a[92:95],a[148:151],v[80:83]
 s_add_u32 m0,s52,67584
 ds_read_b64_tr_b16 a[0:1],v22 offset:0
 v_mfma_f32_16x16x32_bf16 v[84:87],a[96:99],a[144:147],v[84:87]
 ds_read_b64_tr_b16 a[2:3],v22 offset:768
 v_mfma_f32_16x16x32_bf16 v[84:87],a[100:103],a[148:151],v[84:87]
 buffer_load_dwordx4 v20,s[24:27],s14 offen offset:0 lds
 v_mfma_f32_16x16x32_bf16 v[88:91],a[104:107],a[152:155],v[88:91]
 ds_read_b64_tr_b16 a[4:5],v22 offset:6144
 ds_read_b64_tr_b16 a[6:7],v22 offset:6912
 v_mfma_f32_16x16x32_bf16 v[88:91],a[108:111],a[156:159],v[88:91]
 s_add_u32 m0,s52,68608
 ds_read_b64_tr_b16 a[8:9],v23 offset:0
 v_mfma_f32_16x16x32_bf16 v[92:95],a[112:115],a[152:155],v[92:95]
 v_mfma_f32_16x16x32_bf16 v[92:95],a[116:119],a[156:159],v[92:95]
 buffer_load_dwordx4 v21,s[24:27],s15 offen offset:0 lds
 v_mfma_f32_16x16x32_bf16 v[96:99],a[152:155],a[120:123],v[96:99]
 ds_read_b64_tr_b16 a[10:11],v23 offset:768
 ds_read_b64_tr_b16 a[12:13],v23 offset:6144
 v_mfma_f32_16x16x32_bf16 v[96:99],a[156:159],a[124:127],v[96:99]
 s_add_u32 m0,s52,69632
 ds_read_b64_tr_b16 a[14:15],v23 offset:6912
 v_mfma_f32_16x16x32_bf16 v[100:103],a[152:155],a[128:131],v[100:103]
 ds_read_b64_tr_b16 a[16:17],v22 offset:64
 v_mfma_f32_16x16x32_bf16 v[100:103],a[156:159],a[132:135],v[100:103]
 buffer_load_dwordx4 v20,s[24:27],s16 offen offset:0 lds
 v_mfma_f32_16x16x32_bf16 v[104:107],a[88:91],a[152:155],v[104:107]
 ds_read_b64_tr_b16 a[18:19],v22 offset:832
 ds_read_b64_tr_b16 a[20:21],v22 offset:6208
 v_mfma_f32_16x16x32_bf16 v[104:107],a[92:95],a[156:159],v[104:107]
 s_add_u32 m0,s52,70656
 ds_read_b64_tr_b16 a[22:23],v22 offset:6976
 v_mfma_f32_16x16x32_bf16 v[108:111],a[96:99],a[152:155],v[108:111]
 ds_read_b64_tr_b16 a[24:25],v23 offset:64
 v_mfma_f32_16x16x32_bf16 v[108:111],a[100:103],a[156:159],v[108:111]
 buffer_load_dwordx4 v21,s[24:27],s17 offen offset:0 lds
 v_mfma_f32_16x16x32_bf16 v[112:115],a[104:107],a[160:163],v[112:115]
 ds_read_b64_tr_b16 a[26:27],v23 offset:832
 ds_read_b64_tr_b16 a[28:29],v23 offset:6208
 v_mfma_f32_16x16x32_bf16 v[112:115],a[108:111],a[164:167],v[112:115]
 s_add_u32 m0,s52,71680
 v_mfma_f32_16x16x32_bf16 v[116:119],a[112:115],a[160:163],v[116:119]
 ds_read_b64_tr_b16 a[30:31],v23 offset:6976
 v_mfma_f32_16x16x32_bf16 v[116:119],a[116:119],a[164:167],v[116:119]
 buffer_load_dwordx4 v20,s[24:27],s18 offen offset:0 lds
 v_mfma_f32_16x16x32_bf16 v[120:123],a[160:163],a[120:123],v[120:123]
 ds_read_b64_tr_b16 a[32:33],v22 offset:128
 ds_read_b64_tr_b16 a[34:35],v22 offset:896
 v_mfma_f32_16x16x32_bf16 v[120:123],a[164:167],a[124:127],v[120:123]
 s_add_u32 m0,s52,72704
 ds_read_b64_tr_b16 a[36:37],v22 offset:6272
 v_mfma_f32_16x16x32_bf16 v[124:127],a[160:163],a[128:131],v[124:127]
 ds_read_b64_tr_b16 a[38:39],v22 offset:7040
 v_mfma_f32_16x16x32_bf16 v[124:127],a[164:167],a[132:135],v[124:127]
 buffer_load_dwordx4 v21,s[24:27],s19 offen offset:0 lds
 v_mfma_f32_16x16x32_bf16 v[128:131],a[88:91],a[160:163],v[128:131]
 ds_read_b64_tr_b16 a[40:41],v23 offset:128
 ds_read_b64_tr_b16 a[42:43],v23 offset:896
 v_mfma_f32_16x16x32_bf16 v[128:131],a[92:95],a[164:167],v[128:131]
 s_add_u32 m0,s52,73728
 ds_read_b64_tr_b16 a[44:45],v23 offset:6272
 v_mfma_f32_16x16x32_bf16 v[132:135],a[96:99],a[160:163],v[132:135]
 ds_read_b64_tr_b16 a[46:47],v23 offset:7040
 v_mfma_f32_16x16x32_bf16 v[132:135],a[100:103],a[164:167],v[132:135]
 buffer_load_dwordx4 v20,s[24:27],s20 offen offset:0 lds
 v_mfma_f32_16x16x32_bf16 v[136:139],a[104:107],a[168:171],v[136:139]
 v_mfma_f32_16x16x32_bf16 v[136:139],a[108:111],a[172:175],v[136:139]
 s_add_u32 s24,s24,128
 s_addc_u32 s25,s25,0
 v_mfma_f32_16x16x32_bf16 v[140:143],a[112:115],a[168:171],v[140:143]
 v_mfma_f32_16x16x32_bf16 v[140:143],a[116:119],a[172:175],v[140:143]
 s_sub_u32 s26,s26,128
 v_mfma_f32_16x16x32_bf16 v[144:147],a[168:171],a[120:123],v[144:147]
 v_mfma_f32_16x16x32_bf16 v[144:147],a[172:175],a[124:127],v[144:147]
 s_add_u32 s72,s72,172032
 s_addc_u32 s73,s73,0
 v_mfma_f32_16x16x32_bf16 v[148:151],a[168:171],a[128:131],v[148:151]
 v_mfma_f32_16x16x32_bf16 v[148:151],a[172:175],a[132:135],v[148:151]
 s_sub_u32 s74,s74,172032
 v_mfma_f32_16x16x32_bf16 v[152:155],a[88:91],a[168:171],v[152:155]
 v_mfma_f32_16x16x32_bf16 v[152:155],a[92:95],a[172:175],v[152:155]
 v_mfma_f32_16x16x32_bf16 v[156:159],a[96:99],a[168:171],v[156:159]
 v_mfma_f32_16x16x32_bf16 v[156:159],a[100:103],a[172:175],v[156:159]
 s_waitcnt lgkmcnt(0)
 v_mfma_f32_16x16x32_bf16 v[48:51],a[16:19],a[48:51],v[48:51]
 s_waitcnt vmcnt(12)
 s_barrier
 v_mfma_f32_16x16x32_bf16 v[48:51],a[20:23],a[52:55],v[48:51]
 s_add_u32 s61,s51,16384
 s_add_u32 m0,s51,114688
 v_mfma_f32_16x16x32_bf16 v[52:55],a[24:27],a[48:51],v[52:55]
 v_add_u32 v35,s61,v2
 v_mfma_f32_16x16x32_bf16 v[52:55],a[28:31],a[52:55],v[52:55]
 v_add_u32 v36,s61,v3
 v_add_u32 v27,0,v43
 v_mfma_f32_16x16x32_bf16 v[56:59],a[48:51],a[32:35],v[56:59]
 v_add_u32 v22,0xd000,v41
 v_mfma_f32_16x16x32_bf16 v[56:59],a[52:55],a[36:39],v[56:59]
 v_add_u32 v23,0xd000,v42
 v_mfma_f32_16x16x32_bf16 v[60:63],a[48:51],a[40:43],v[60:63]
 ds_read_b128 a[136:139],v35 offset:0
 v_mfma_f32_16x16x32_bf16 v[60:63],a[52:55],a[44:47],v[60:63]
 buffer_load_dwordx4 v27,s[40:43],0 offen offset:0 lds
 v_mfma_f32_16x16x32_bf16 v[64:67],a[16:19],a[56:59],v[64:67]
 ds_read_b128 a[140:143],v36 offset:0
 ds_read_b128 a[144:147],v35 offset:2048
 v_mfma_f32_16x16x32_bf16 v[64:67],a[20:23],a[60:63],v[64:67]
 ds_read_b128 a[148:151],v36 offset:2048
 v_add_u32 v28,6144,v43
 v_mfma_f32_16x16x32_bf16 v[68:71],a[24:27],a[56:59],v[68:71]
 ds_read_b128 a[152:155],v35 offset:4096
 v_mfma_f32_16x16x32_bf16 v[68:71],a[28:31],a[60:63],v[68:71]
 v_mfma_f32_16x16x32_bf16 v[72:75],a[56:59],a[32:35],v[72:75]
 ds_read_b128 a[156:159],v36 offset:4096
 v_mfma_f32_16x16x32_bf16 v[72:75],a[60:63],a[36:39],v[72:75]
 buffer_load_dwordx4 v28,s[40:43],0 offen offset:1024 lds
 v_mfma_f32_16x16x32_bf16 v[76:79],a[56:59],a[40:43],v[76:79]
 ds_read_b128 a[160:163],v35 offset:6144
 ds_read_b128 a[164:167],v36 offset:6144
 v_mfma_f32_16x16x32_bf16 v[76:79],a[60:63],a[44:47],v[76:79]
 ds_read_b128 a[168:171],v35 offset:8192
 v_add_u32 v27,12288,v43
 v_mfma_f32_16x16x32_bf16 v[80:83],a[0:3],a[56:59],v[80:83]
 ds_read_b128 a[172:175],v36 offset:8192
 v_mfma_f32_16x16x32_bf16 v[80:83],a[4:7],a[60:63],v[80:83]
 ds_read_b64_tr_b16 a[88:89],v22 offset:0
 v_mfma_f32_16x16x32_bf16 v[84:87],a[8:11],a[56:59],v[84:87]
 buffer_load_dwordx4 v27,s[40:43],0 offen offset:2048 lds
 v_mfma_f32_16x16x32_bf16 v[84:87],a[12:15],a[60:63],v[84:87]
 ds_read_b64_tr_b16 a[90:91],v22 offset:768
 ds_read_b64_tr_b16 a[92:93],v22 offset:6144
 v_mfma_f32_16x16x32_bf16 v[88:91],a[16:19],a[64:67],v[88:91]
 ds_read_b64_tr_b16 a[94:95],v22 offset:6912
 v_mfma_f32_16x16x32_bf16 v[88:91],a[20:23],a[68:71],v[88:91]
 ds_read_b64_tr_b16 a[96:97],v23 offset:0
 v_add_u32 v28,18432,v43
 v_mfma_f32_16x16x32_bf16 v[92:95],a[24:27],a[64:67],v[92:95]
 v_mfma_f32_16x16x32_bf16 v[92:95],a[28:31],a[68:71],v[92:95]
 ds_read_b64_tr_b16 a[98:99],v23 offset:768
 v_mfma_f32_16x16x32_bf16 v[96:99],a[64:67],a[32:35],v[96:99]
 buffer_load_dwordx4 v28,s[40:43],0 offen offset:3072 lds
 v_mfma_f32_16x16x32_bf16 v[96:99],a[68:71],a[36:39],v[96:99]
 ds_read_b64_tr_b16 a[100:101],v23 offset:6144
 ds_read_b64_tr_b16 a[102:103],v23 offset:6912
 v_mfma_f32_16x16x32_bf16 v[100:103],a[64:67],a[40:43],v[100:103]
 ds_read_b64_tr_b16 a[104:105],v22 offset:64
 v_mfma_f32_16x16x32_bf16 v[100:103],a[68:71],a[44:47],v[100:103]
 s_add_u32 m0,s51,118784
 ds_read_b64_tr_b16 a[106:107],v22 offset:832
 v_mfma_f32_16x16x32_bf16 v[104:107],a[0:3],a[64:67],v[104:107]
 ds_read_b64_tr_b16 a[108:109],v22 offset:6208
 v_mfma_f32_16x16x32_bf16 v[104:107],a[4:7],a[68:71],v[104:107]
 ds_read_b64_tr_b16 a[110:111],v22 offset:6976
 v_add_u32 v27,0,v43
 v_mfma_f32_16x16x32_bf16 v[108:111],a[8:11],a[64:67],v[108:111]
 ds_read_b64_tr_b16 a[112:113],v23 offset:64
 v_mfma_f32_16x16x32_bf16 v[108:111],a[12:15],a[68:71],v[108:111]
 ds_read_b64_tr_b16 a[114:115],v23 offset:832
 v_mfma_f32_16x16x32_bf16 v[112:115],a[16:19],a[72:75],v[112:115]
 buffer_load_dwordx4 v27,s[64:67],0 offen offset:0 lds
 v_mfma_f32_16x16x32_bf16 v[112:115],a[20:23],a[76:79],v[112:115]
 ds_read_b64_tr_b16 a[116:117],v23 offset:6208
 v_mfma_f32_16x16x32_bf16 v[116:119],a[24:27],a[72:75],v[116:119]
 ds_read_b64_tr_b16 a[118:119],v23 offset:6976
 v_mfma_f32_16x16x32_bf16 v[116:119],a[28:31],a[76:79],v[116:119]
 ds_read_b64_tr_b16 a[120:121],v22 offset:128
 v_add_u32 v28,6144,v43
 v_mfma_f32_16x16x32_bf16 v[120:123],a[72:75],a[32:35],v[120:123]
 ds_read_b64_tr_b16 a[122:123],v22 offset:896
 v_mfma_f32_16x16x32_bf16 v[120:123],a[76:79],a[36:39],v[120:123]
 ds_read_b64_tr_b16 a[124:125],v22 offset:6272
 v_mfma_f32_16x16x32_bf16 v[124:127],a[72:75],a[40:43],v[124:127]
 ds_read_b64_tr_b16 a[126:127],v22 offset:7040
 v_mfma_f32_16x16x32_bf16 v[124:127],a[76:79],a[44:47],v[124:127]
 buffer_load_dwordx4 v28,s[64:67],0 offen offset:1024 lds
 v_mfma_f32_16x16x32_bf16 v[128:131],a[0:3],a[72:75],v[128:131]
 ds_read_b64_tr_b16 a[128:129],v23 offset:128
 ds_read_b64_tr_b16 a[130:131],v23 offset:896
 v_mfma_f32_16x16x32_bf16 v[128:131],a[4:7],a[76:79],v[128:131]
 ds_read_b64_tr_b16 a[132:133],v23 offset:6272
 v_add_u32 v27,12288,v43
 v_mfma_f32_16x16x32_bf16 v[132:135],a[8:11],a[72:75],v[132:135]
 ds_read_b64_tr_b16 a[134:135],v23 offset:7040
 v_mfma_f32_16x16x32_bf16 v[132:135],a[12:15],a[76:79],v[132:135]
 v_mfma_f32_16x16x32_bf16 v[136:139],a[16:19],a[80:83],v[136:139]
 buffer_load_dwordx4 v27,s[64:67],0 offen offset:2048 lds
 v_mfma_f32_16x16x32_bf16 v[136:139],a[20:23],a[84:87],v[136:139]
 v_mfma_f32_16x16x32_bf16 v[140:143],a[24:27],a[80:83],v[140:143]
 v_mfma_f32_16x16x32_bf16 v[140:143],a[28:31],a[84:87],v[140:143]
 v_add_u32 v28,18432,v43
 v_mfma_f32_16x16x32_bf16 v[144:147],a[80:83],a[32:35],v[144:147]
 v_mfma_f32_16x16x32_bf16 v[144:147],a[84:87],a[36:39],v[144:147]
 v_mfma_f32_16x16x32_bf16 v[148:151],a[80:83],a[40:43],v[148:151]
 buffer_load_dwordx4 v28,s[64:67],0 offen offset:3072 lds
 v_mfma_f32_16x16x32_bf16 v[148:151],a[84:87],a[44:47],v[148:151]
 v_mfma_f32_16x16x32_bf16 v[152:155],a[0:3],a[80:83],v[152:155]
 v_mfma_f32_16x16x32_bf16 v[152:155],a[4:7],a[84:87],v[152:155]
 v_mfma_f32_16x16x32_bf16 v[156:159],a[8:11],a[80:83],v[156:159]
 v_mfma_f32_16x16x32_bf16 v[156:159],a[12:15],a[84:87],v[156:159]
 s_waitcnt lgkmcnt(0)
FL_19:
 v_cmp_lt_u32 vcc,v31,v30
 s_nop 4
 s_cbranch_vccz FL_19D
 s_sleep 2
 buffer_load_dword v31,v29,s[28:31],0 offen sc1
 s_waitcnt vmcnt(0)
 s_branch FL_19
FL_19D:
 v_lshrrev_b32 v16,6,v0
 v_lshl_add_u32 v14,v16,13,v1
 v_add_u32 v15,4096,v14
 s_mov_b32 s49,1103101952
 s_sub_u32 s61,15,s59
 s_min_u32 s48,s61,s59
 s_sub_u32 s41,15,s48
 s_mul_i32 s36,s46,229376
 s_add_u32 s36,s36,104857600
 s_mov_b32 s53,2
 s_mov_b32 s67,0
 s_mov_b32 s72,0
 s_mul_i32 s62,s59,3
 s_min_u32 s62,s62,30
 s_lshr_b32 s73,0x92492,s62
 s_and_b32 s73,s73,7
 s_mov_b32 s74,14
 s_lshl_b32 s62,s59,2
 s_lshr_b32 s62,0xeca86420,s62
 s_and_b32 s62,s62,15
 s_cmp_lt_u32 s59,8
 s_cselect_b32 s74,s62,s74
 s_mov_b32 s42,0
 s_mov_b32 s34,8
 s_mov_b32 s52,8
 s_lshl_b32 s43,s41,1
 s_sub_i32 s43,s43,16
 s_cmp_lt_i32 s43,2
 s_cselect_b32 s43,0,s43
 s_cmp_eq_u32 s43,1
 s_cselect_b32 s43,2,s43
 s_mov_b32 s39,-1
 s_mov_b32 s40,-1
 s_mov_b32 s44,0
 s_mov_b32 s50,1
 s_cmp_lg_u32 s43,0
 s_cbranch_scc1 RB_20
 s_mov_b32 s41,s48
 s_mov_b32 s42,0
 s_lshl_b32 s43,s48,1
 s_add_u32 s43,s43,2
 s_mov_b32 s39,1
 s_mov_b32 s40,2
 s_mov_b32 s44,0
 s_mov_b32 s50,0
 s_mov_b32 s52,0
RB_20:
 s_lshl_b32 s61,s46,3
 s_add_u32 s61,s61,s48
 s_lshl_b32 s66,s61,2
 s_add_u32 s66,s66,s45
 s_lshl_b32 s66,s66,10
 s_add_u32 s66,s66,126877696
 s_lshl_b32 s61,s61,7
 s_add_u32 s61,s61,125837312
 s_lshl_b32 s62,s46,20
 s_lshl_b32 s32,s42,15
 s_add_u32 s32,s32,s62
 s_add_u32 s33,s32,16777216
 s_lshl_b32 s47,s41,3
 s_add_u32 s47,s47,s45
 s_lshl_b32 s47,s47,13
 s_add_u32 s47,s47,s62
 s_add_u32 s47,s47,33554432
 s_lshl_b32 s63,s48,3
 s_add_u32 s63,s63,s45
 s_lshl_b32 s63,s63,13
 s_add_u32 s63,s63,s62
 s_add_u32 s63,s63,33554432
 s_add_u32 s65,s47,16777216
 s_lshl_b32 s64,s46,16
 s_add_u32 s64,s64,s51
 s_add_u32 s64,s64,100663296
 s_cmp_lg_u32 s73,0
 s_cselect_b32 s64,s64,0xf0000000
 s_cmp_eq_u32 s44,1
 s_cselect_b32 s65,s65,s64
 s_add_u32 s64,s36,65536
 s_cmp_eq_u32 s50,1
 s_cselect_b32 s35,s62,s36
 s_cselect_b32 s65,s63,s65
 s_cselect_b32 s64,s33,s64
 s_sub_u32 s38,s43,1
 s_and_b32 s63,s43,1
 s_lshl_b32 s68,s63,15
 s_add_u32 s68,s68,s51
 s_xor_b32 s69,s68,0x8000
 s_sub_u32 s63,s38,s63
 s_sub_i32 s62,s63,2
 s_cmp_ge_i32 s62,3
 s_cselect_b32 s63,s62,s63
 s_sub_i32 s62,s43,5
 s_or_b32 s62,s62,1
 s_cmp_ge_i32 s62,3
 s_cselect_b32 s63,s62,s63
 s_mul_i32 s62,s50,8
 s_cmp_le_u32 s43,s62
 s_cselect_b32 s63,-2,s63
 s_cmp_eq_u32 s53,-1
 s_cselect_b32 s53,-1,s63
 s_lshl_b32 s61,s45,14
 s_sub_u32 s61,57344,s61
 v_add_u32 v243,s61,v1
 s_add_u32 s61,s46,0
 s_lshl_b32 s61,s61,7
 s_add_u32 s61,s61,125829120
 v_mov_b32 v29,s61
 v_mov_b32 v30,8
 v_mfma_f32_16x16x32_bf16 v[48:51],a[104:107],a[136:139],v[48:51]
 s_waitcnt vmcnt(8)
 s_barrier
 v_mfma_f32_16x16x32_bf16 v[48:51],a[108:111],a[140:143],v[48:51]
 s_add_u32 s61,s51,65536
 s_add_u32 s63,s47,0
 v_mfma_f32_16x16x32_bf16 v[52:55],a[112:115],a[136:139],v[52:55]
 v_add_u32 v35,s61,v2
 v_mfma_f32_16x16x32_bf16 v[52:55],a[116:119],a[140:143],v[52:55]
 v_add_u32 v36,s61,v3
 v_mfma_f32_16x16x32_bf16 v[56:59],a[136:139],a[120:123],v[56:59]
 buffer_load_dwordx4 a[192:195],v1,s[28:31],s63 offen offset:0 sc1
 v_mfma_f32_16x16x32_bf16 v[56:59],a[140:143],a[124:127],v[56:59]
 v_add_u32 v22,0x19000,v41
 v_add_u32 v23,0x19000,v42
 v_mfma_f32_16x16x32_bf16 v[60:63],a[136:139],a[128:131],v[60:63]
 buffer_load_dwordx4 a[196:199],v1,s[28:31],s63 offen offset:1024 sc1
 v_mfma_f32_16x16x32_bf16 v[60:63],a[140:143],a[132:135],v[60:63]
 ds_read_b128 a[48:51],v35 offset:0
 ds_read_b128 a[52:55],v36 offset:0
 v_mfma_f32_16x16x32_bf16 v[64:67],a[104:107],a[144:147],v[64:67]
 ds_read_b128 a[56:59],v35 offset:2048
 v_mfma_f32_16x16x32_bf16 v[64:67],a[108:111],a[148:151],v[64:67]
 buffer_load_dwordx4 a[200:203],v1,s[28:31],s63 offen offset:2048 sc1
 v_mfma_f32_16x16x32_bf16 v[68:71],a[112:115],a[144:147],v[68:71]
 ds_read_b128 a[60:63],v36 offset:2048
 ds_read_b128 a[64:67],v35 offset:4096
 v_mfma_f32_16x16x32_bf16 v[68:71],a[116:119],a[148:151],v[68:71]
 buffer_load_dwordx4 a[204:207],v1,s[28:31],s63 offen offset:3072 sc1
 v_mfma_f32_16x16x32_bf16 v[72:75],a[144:147],a[120:123],v[72:75]
 ds_read_b128 a[68:71],v36 offset:4096
 v_mfma_f32_16x16x32_bf16 v[72:75],a[148:151],a[124:127],v[72:75]
 ds_read_b128 a[72:75],v35 offset:6144
 v_mfma_f32_16x16x32_bf16 v[76:79],a[144:147],a[128:131],v[76:79]
 s_add_u32 s63,s47,4096
 ds_read_b128 a[76:79],v36 offset:6144
 v_mfma_f32_16x16x32_bf16 v[76:79],a[148:151],a[132:135],v[76:79]
 ds_read_b128 a[80:83],v35 offset:8192
 v_mfma_f32_16x16x32_bf16 v[80:83],a[88:91],a[144:147],v[80:83]
 ds_read_b128 a[84:87],v36 offset:8192
 v_mfma_f32_16x16x32_bf16 v[80:83],a[92:95],a[148:151],v[80:83]
 buffer_load_dwordx4 a[208:211],v1,s[28:31],s63 offen offset:0 sc1
 v_mfma_f32_16x16x32_bf16 v[84:87],a[96:99],a[144:147],v[84:87]
 ds_read_b64_tr_b16 a[0:1],v22 offset:0
 ds_read_b64_tr_b16 a[2:3],v22 offset:768
 v_mfma_f32_16x16x32_bf16 v[84:87],a[100:103],a[148:151],v[84:87]
 buffer_load_dwordx4 a[212:215],v1,s[28:31],s63 offen offset:1024 sc1
 v_mfma_f32_16x16x32_bf16 v[88:91],a[104:107],a[152:155],v[88:91]
 ds_read_b64_tr_b16 a[4:5],v22 offset:6144
 ds_read_b64_tr_b16 a[6:7],v22 offset:6912
 v_mfma_f32_16x16x32_bf16 v[88:91],a[108:111],a[156:159],v[88:91]
 buffer_load_dwordx4 a[216:219],v1,s[28:31],s63 offen offset:2048 sc1
 v_mfma_f32_16x16x32_bf16 v[92:95],a[112:115],a[152:155],v[92:95]
 ds_read_b64_tr_b16 a[8:9],v23 offset:0
 v_mfma_f32_16x16x32_bf16 v[92:95],a[116:119],a[156:159],v[92:95]
 ds_read_b64_tr_b16 a[10:11],v23 offset:768
 v_mfma_f32_16x16x32_bf16 v[96:99],a[152:155],a[120:123],v[96:99]
 ds_read_b64_tr_b16 a[12:13],v23 offset:6144
 v_mfma_f32_16x16x32_bf16 v[96:99],a[156:159],a[124:127],v[96:99]
 buffer_load_dwordx4 a[220:223],v1,s[28:31],s63 offen offset:3072 sc1
 v_mfma_f32_16x16x32_bf16 v[100:103],a[152:155],a[128:131],v[100:103]
 ds_read_b64_tr_b16 a[14:15],v23 offset:6912
 ds_read_b64_tr_b16 a[16:17],v22 offset:64
 v_mfma_f32_16x16x32_bf16 v[100:103],a[156:159],a[132:135],v[100:103]
 s_add_u32 s63,s47,0
 ds_read_b64_tr_b16 a[18:19],v22 offset:832
 v_mfma_f32_16x16x32_bf16 v[104:107],a[88:91],a[152:155],v[104:107]
 ds_read_b64_tr_b16 a[20:21],v22 offset:6208
 v_mfma_f32_16x16x32_bf16 v[104:107],a[92:95],a[156:159],v[104:107]
 buffer_load_dwordx4 a[224:227],v243,s[28:31],s63 offen offset:0 sc1
 v_mfma_f32_16x16x32_bf16 v[108:111],a[96:99],a[152:155],v[108:111]
 ds_read_b64_tr_b16 a[22:23],v22 offset:6976
 ds_read_b64_tr_b16 a[24:25],v23 offset:64
 v_mfma_f32_16x16x32_bf16 v[108:111],a[100:103],a[156:159],v[108:111]
 ds_read_b64_tr_b16 a[26:27],v23 offset:832
 v_mfma_f32_16x16x32_bf16 v[112:115],a[104:107],a[160:163],v[112:115]
 buffer_load_dwordx4 a[228:231],v243,s[28:31],s63 offen offset:1024 sc1
 v_mfma_f32_16x16x32_bf16 v[112:115],a[108:111],a[164:167],v[112:115]
 ds_read_b64_tr_b16 a[28:29],v23 offset:6208
 v_mfma_f32_16x16x32_bf16 v[116:119],a[112:115],a[160:163],v[116:119]
 ds_read_b64_tr_b16 a[30:31],v23 offset:6976
 v_mfma_f32_16x16x32_bf16 v[116:119],a[116:119],a[164:167],v[116:119]
 buffer_load_dwordx4 a[232:235],v243,s[28:31],s63 offen offset:2048 sc1
 v_mfma_f32_16x16x32_bf16 v[120:123],a[160:163],a[120:123],v[120:123]
 ds_read_b64_tr_b16 a[32:33],v22 offset:128
 ds_read_b64_tr_b16 a[34:35],v22 offset:896
 v_mfma_f32_16x16x32_bf16 v[120:123],a[164:167],a[124:127],v[120:123]
 ds_read_b64_tr_b16 a[36:37],v22 offset:6272
 v_mfma_f32_16x16x32_bf16 v[124:127],a[160:163],a[128:131],v[124:127]
 buffer_load_dwordx4 a[236:239],v243,s[28:31],s63 offen offset:3072 sc1
 v_mfma_f32_16x16x32_bf16 v[124:127],a[164:167],a[132:135],v[124:127]
 ds_read_b64_tr_b16 a[38:39],v22 offset:7040
 ds_read_b64_tr_b16 a[40:41],v23 offset:128
 v_mfma_f32_16x16x32_bf16 v[128:131],a[88:91],a[160:163],v[128:131]
 buffer_load_dword v31,v29,s[28:31],0 offen sc1
 v_mfma_f32_16x16x32_bf16 v[128:131],a[92:95],a[164:167],v[128:131]
 s_add_u32 s63,s47,4096
 ds_read_b64_tr_b16 a[42:43],v23 offset:896
 v_mfma_f32_16x16x32_bf16 v[132:135],a[96:99],a[160:163],v[132:135]
 ds_read_b64_tr_b16 a[44:45],v23 offset:6272
 ds_read_b64_tr_b16 a[46:47],v23 offset:7040
 v_mfma_f32_16x16x32_bf16 v[132:135],a[100:103],a[164:167],v[132:135]
 buffer_load_dwordx4 a[240:243],v243,s[28:31],s63 offen offset:0 sc1
 v_mfma_f32_16x16x32_bf16 v[136:139],a[104:107],a[168:171],v[136:139]
 v_mfma_f32_16x16x32_bf16 v[136:139],a[108:111],a[172:175],v[136:139]
 buffer_load_dwordx4 a[244:247],v243,s[28:31],s63 offen offset:1024 sc1
 v_mfma_f32_16x16x32_bf16 v[140:143],a[112:115],a[168:171],v[140:143]
 v_mfma_f32_16x16x32_bf16 v[140:143],a[116:119],a[172:175],v[140:143]
 buffer_load_dwordx4 a[248:251],v243,s[28:31],s63 offen offset:2048 sc1
 v_mfma_f32_16x16x32_bf16 v[144:147],a[168:171],a[120:123],v[144:147]
 v_mfma_f32_16x16x32_bf16 v[144:147],a[172:175],a[124:127],v[144:147]
 v_mfma_f32_16x16x32_bf16 v[148:151],a[168:171],a[128:131],v[148:151]
 buffer_load_dwordx4 a[252:255],v243,s[28:31],s63 offen offset:3072 sc1
 v_mfma_f32_16x16x32_bf16 v[148:151],a[172:175],a[132:135],v[148:151]
 v_mfma_f32_16x16x32_bf16 v[152:155],a[88:91],a[168:171],v[152:155]
 v_mfma_f32_16x16x32_bf16 v[152:155],a[92:95],a[172:175],v[152:155]
 v_mfma_f32_16x16x32_bf16 v[156:159],a[96:99],a[168:171],v[156:159]
 v_mfma_f32_16x16x32_bf16 v[156:159],a[100:103],a[172:175],v[156:159]
 s_waitcnt lgkmcnt(0)
 v_mfma_f32_16x16x32_bf16 v[48:51],a[16:19],a[48:51],v[48:51]
 v_and_b32 v216,15,v0
 v_bfe_u32 v217,v0,4,2
 v_cmp_ne_u32 s[4:5],3,v217
 v_lshlrev_b32 v217,2,v217
 v_sub_u32 v216,v216,v217
 v_mfma_f32_16x16x32_bf16 v[48:51],a[20:23],a[52:55],v[48:51]
 v_and_b32 v217,1,v0
 v_cmp_eq_u32 s[6:7],1,v217
 v_cmp_le_i32 s[8:9],0,v216
 v_cmp_le_i32 s[10:11],2,v216
 v_mov_b32 v218,0xffff
 v_mfma_f32_16x16x32_bf16 v[52:55],a[24:27],a[48:51],v[52:55]
 v_mov_b32 v219,0xffff0000
 v_cndmask_b32 v219,v218,v219,s[6:7]
 v_mov_b32 v218,0xff800000
 s_or_b32 s16,s76,s45
 s_cselect_b64 s[12:13],-1,0
 v_mfma_f32_16x16x32_bf16 v[52:55],a[28:31],a[52:55],v[52:55]
 s_mov_b32 s14,0x3e41848f
 s_mov_b32 s15,0x3fb8aa3b
 v_mfma_f32_16x16x32_bf16 v[56:59],a[48:51],a[32:35],v[56:59]
 v_mfma_f32_16x16x32_bf16 v[56:59],a[52:55],a[36:39],v[56:59]
 v_mfma_f32_16x16x32_bf16 v[60:63],a[48:51],a[40:43],v[60:63]
 v_mfma_f32_16x16x32_bf16 v[60:63],a[52:55],a[44:47],v[60:63]
 v_mfma_f32_16x16x32_bf16 v[64:67],a[16:19],a[56:59],v[64:67]
 v_mfma_f32_16x16x32_bf16 v[64:67],a[20:23],a[60:63],v[64:67]
 v_cvt_pk_bf16_f32 v160,v48,v49
 v_cvt_pk_bf16_f32 v161,v50,v51
 v_mfma_f32_16x16x32_bf16 v[68:71],a[24:27],a[56:59],v[68:71]
 v_mfma_f32_16x16x32_bf16 v[68:71],a[28:31],a[60:63],v[68:71]
 v_cvt_pk_bf16_f32 v162,v52,v53
 v_cvt_pk_bf16_f32 v163,v54,v55
 v_mfma_f32_16x16x32_bf16 v[72:75],a[56:59],a[32:35],v[72:75]
 v_mfma_f32_16x16x32_bf16 v[72:75],a[60:63],a[36:39],v[72:75]
 v_cvt_pk_bf16_f32 v196,v56,v57
 v_cvt_pk_bf16_f32 v197,v58,v59
 v_mfma_f32_16x16x32_bf16 v[76:79],a[56:59],a[40:43],v[76:79]
 v_mfma_f32_16x16x32_bf16 v[76:79],a[60:63],a[44:47],v[76:79]
 v_cvt_pk_bf16_f32 v206,v60,v61
 v_cvt_pk_bf16_f32 v207,v62,v63
 v_mfma_f32_16x16x32_bf16 v[80:83],a[0:3],a[56:59],v[80:83]
 s_waitcnt vmcnt(4)
 v_cmp_lt_u32 vcc,v31,v30
 v_mfma_f32_16x16x32_bf16 v[80:83],a[4:7],a[60:63],v[80:83]
 v_cvt_pk_bf16_f32 v164,v64,v65
 v_cvt_pk_bf16_f32 v165,v66,v67
 v_mfma_f32_16x16x32_bf16 v[84:87],a[8:11],a[56:59],v[84:87]
 v_mfma_f32_16x16x32_bf16 v[84:87],a[12:15],a[60:63],v[84:87]
 s_cbranch_vccnz FLE_15
FLE_15R:
 v_cvt_pk_bf16_f32 v166,v68,v69
 v_cvt_pk_bf16_f32 v167,v70,v71
 v_mfma_f32_16x16x32_bf16 v[88:91],a[16:19],a[64:67],v[88:91]
 s_add_u32 m0,s68,0
 v_mfma_f32_16x16x32_bf16 v[88:91],a[20:23],a[68:71],v[88:91]
 buffer_load_dwordx4 v14,s[28:31],s32 offen offset:0 sc1 lds
 v_cvt_pk_bf16_f32 v198,v72,v73
 v_cvt_pk_bf16_f32 v199,v74,v75
 v_mfma_f32_16x16x32_bf16 v[92:95],a[24:27],a[64:67],v[92:95]
 v_mfma_f32_16x16x32_bf16 v[92:95],a[28:31],a[68:71],v[92:95]
 buffer_load_dwordx4 v14,s[28:31],s32 offen offset:1024 sc1 lds
 v_cvt_pk_bf16_f32 v208,v76,v77
 v_cvt_pk_bf16_f32 v209,v78,v79
 v_mfma_f32_16x16x32_bf16 v[96:99],a[64:67],a[32:35],v[96:99]
 buffer_load_dwordx4 v14,s[28:31],s32 offen offset:2048 sc1 lds
 v_mfma_f32_16x16x32_bf16 v[96:99],a[68:71],a[36:39],v[96:99]
 v_cvt_pk_bf16_f32 v180,v80,v81
 v_cvt_pk_bf16_f32 v181,v82,v83
 v_mfma_f32_16x16x32_bf16 v[100:103],a[64:67],a[40:43],v[100:103]
 buffer_load_dwordx4 v14,s[28:31],s32 offen offset:3072 sc1 lds
 v_mfma_f32_16x16x32_bf16 v[100:103],a[68:71],a[44:47],v[100:103]
 s_add_u32 m0,s68,4096
 v_cvt_pk_bf16_f32 v182,v84,v85
 v_cvt_pk_bf16_f32 v183,v86,v87
 v_cndmask_b32 v182,0,v182,s[4:5]
 v_cndmask_b32 v183,0,v183,s[4:5]
 v_mfma_f32_16x16x32_bf16 v[104:107],a[0:3],a[64:67],v[104:107]
 v_mfma_f32_16x16x32_bf16 v[104:107],a[4:7],a[68:71],v[104:107]
 buffer_load_dwordx4 v15,s[28:31],s32 offen offset:0 sc1 lds
 v_cvt_pk_bf16_f32 v168,v88,v89
 v_cvt_pk_bf16_f32 v169,v90,v91
 v_mfma_f32_16x16x32_bf16 v[108:111],a[8:11],a[64:67],v[108:111]
 buffer_load_dwordx4 v15,s[28:31],s32 offen offset:1024 sc1 lds
 v_mfma_f32_16x16x32_bf16 v[108:111],a[12:15],a[68:71],v[108:111]
 v_cvt_pk_bf16_f32 v170,v92,v93
 v_cvt_pk_bf16_f32 v171,v94,v95
 v_mfma_f32_16x16x32_bf16 v[112:115],a[16:19],a[72:75],v[112:115]
 buffer_load_dwordx4 v15,s[28:31],s32 offen offset:2048 sc1 lds
 v_mfma_f32_16x16x32_bf16 v[112:115],a[20:23],a[76:79],v[112:115]
 buffer_load_dwordx4 v15,s[28:31],s32 offen offset:3072 sc1 lds
 v_cvt_pk_bf16_f32 v200,v96,v97
 v_cvt_pk_bf16_f32 v201,v98,v99
 v_mfma_f32_16x16x32_bf16 v[116:119],a[24:27],a[72:75],v[116:119]
 v_mfma_f32_16x16x32_bf16 v[116:119],a[28:31],a[76:79],v[116:119]
 s_add_u32 s32,s32,32768
 v_cvt_pk_bf16_f32 v210,v100,v101
 v_cvt_pk_bf16_f32 v211,v102,v103
 v_mfma_f32_16x16x32_bf16 v[120:123],a[72:75],a[32:35],v[120:123]
 s_add_u32 m0,s69,0
 v_mfma_f32_16x16x32_bf16 v[120:123],a[76:79],a[36:39],v[120:123]
 v_cvt_pk_bf16_f32 v184,v104,v105
 v_cvt_pk_bf16_f32 v185,v106,v107
 v_mfma_f32_16x16x32_bf16 v[124:127],a[72:75],a[40:43],v[124:127]
 buffer_load_dwordx4 v14,s[28:31],s32 offen offset:0 sc1 lds
 v_mfma_f32_16x16x32_bf16 v[124:127],a[76:79],a[44:47],v[124:127]
 buffer_load_dwordx4 v14,s[28:31],s32 offen offset:1024 sc1 lds
 v_cvt_pk_bf16_f32 v186,v108,v109
 v_cvt_pk_bf16_f32 v187,v110,v111
 v_cndmask_b32 v186,0,v186,s[4:5]
 v_mfma_f32_16x16x32_bf16 v[128:131],a[0:3],a[72:75],v[128:131]
 v_cndmask_b32 v187,0,v187,s[4:5]
 v_mfma_f32_16x16x32_bf16 v[128:131],a[4:7],a[76:79],v[128:131]
 buffer_load_dwordx4 v14,s[28:31],s32 offen offset:2048 sc1 lds
 v_cvt_pk_bf16_f32 v172,v112,v113
 v_cvt_pk_bf16_f32 v173,v114,v115
 v_mfma_f32_16x16x32_bf16 v[132:135],a[8:11],a[72:75],v[132:135]
 buffer_load_dwordx4 v14,s[28:31],s32 offen offset:3072 sc1 lds
 v_mfma_f32_16x16x32_bf16 v[132:135],a[12:15],a[76:79],v[132:135]
 v_cvt_pk_bf16_f32 v174,v116,v117
 v_cvt_pk_bf16_f32 v175,v118,v119
 v_mfma_f32_16x16x32_bf16 v[136:139],a[16:19],a[80:83],v[136:139]
 s_add_u32 m0,s69,4096
 v_mfma_f32_16x16x32_bf16 v[136:139],a[20:23],a[84:87],v[136:139]
 buffer_load_dwordx4 v15,s[28:31],s32 offen offset:0 sc1 lds
 v_cvt_pk_bf16_f32 v202,v120,v121
 v_cvt_pk_bf16_f32 v203,v122,v123
 v_mfma_f32_16x16x32_bf16 v[140:143],a[24:27],a[80:83],v[140:143]
 v_mfma_f32_16x16x32_bf16 v[140:143],a[28:31],a[84:87],v[140:143]
 buffer_load_dwordx4 v15,s[28:31],s32 offen offset:1024 sc1 lds
 v_cvt_pk_bf16_f32 v212,v124,v125
 v_cvt_pk_bf16_f32 v213,v126,v127
 v_mfma_f32_16x16x32_bf16 v[144:147],a[80:83],a[32:35],v[144:147]
 buffer_load_dwordx4 v15,s[28:31],s32 offen offset:2048 sc1 lds
 v_mfma_f32_16x16x32_bf16 v[144:147],a[84:87],a[36:39],v[144:147]
 v_cvt_pk_bf16_f32 v188,v128,v129
 v_cvt_pk_bf16_f32 v189,v130,v131
 v_mfma_f32_16x16x32_bf16 v[148:151],a[80:83],a[40:43],v[148:151]
 buffer_load_dwordx4 v15,s[28:31],s32 offen offset:3072 sc1 lds
 v_mfma_f32_16x16x32_bf16 v[148:151],a[84:87],a[44:47],v[148:151]
 s_add_u32 s32,s32,32768
 v_cvt_pk_bf16_f32 v190,v132,v133
 v_cvt_pk_bf16_f32 v191,v134,v135
 v_cndmask_b32 v190,0,v190,s[4:5]
 v_cndmask_b32 v191,0,v191,s[4:5]
 v_mfma_f32_16x16x32_bf16 v[152:155],a[0:3],a[80:83],v[152:155]
 v_mfma_f32_16x16x32_bf16 v[152:155],a[4:7],a[84:87],v[152:155]
 v_cvt_pk_bf16_f32 v176,v136,v137
 v_cvt_pk_bf16_f32 v177,v138,v139
 v_mfma_f32_16x16x32_bf16 v[156:159],a[8:11],a[80:83],v[156:159]
 v_mfma_f32_16x16x32_bf16 v[156:159],a[12:15],a[84:87],v[156:159]
 v_cvt_pk_bf16_f32 v178,v140,v141
 v_cvt_pk_bf16_f32 v179,v142,v143
 s_nop 7
 v_cvt_pk_bf16_f32 v204,v144,v145
 v_cvt_pk_bf16_f32 v205,v146,v147
 v_cvt_pk_bf16_f32 v214,v148,v149
 v_cvt_pk_bf16_f32 v215,v150,v151
 v_cvt_pk_bf16_f32 v192,v152,v153
 v_cvt_pk_bf16_f32 v193,v154,v155
 v_cvt_pk_bf16_f32 v194,v156,v157
 v_cvt_pk_bf16_f32 v195,v158,v159
 v_cndmask_b32 v194,0,v194,s[4:5]
 v_cndmask_b32 v195,0,v195,s[4:5]
G1T_12E:
G1_TAIL:
 v_bfe_u32 v27,v0,2,4
 v_lshlrev_b32 v27,7,v27
 v_and_b32 v28,3,v0
 v_lshl_add_u32 v27,v28,4,v27
 s_add_u32 s61,s51,114688
 v_add_u32 v27,s61,v27
 ds_read_b64_tr_b16 v[112:113],v27 offset:0
 ds_read_b64_tr_b16 v[114:115],v27 offset:2048
 ds_read_b64_tr_b16 v[116:117],v27 offset:8
 ds_read_b64_tr_b16 v[118:119],v27 offset:2056
 ds_read_b64_tr_b16 v[120:121],v27 offset:64
 ds_read_b64_tr_b16 v[122:123],v27 offset:2112
 ds_read_b64_tr_b16 v[124:125],v27 offset:72
 ds_read_b64_tr_b16 v[126:127],v27 offset:2120
 ds_read_b64_tr_b16 v[128:129],v27 offset:4096
 ds_read_b64_tr_b16 v[130:131],v27 offset:6144
 ds_read_b64_tr_b16 v[132:133],v27 offset:4104
 ds_read_b64_tr_b16 v[134:135],v27 offset:6152
 ds_read_b64_tr_b16 v[136:137],v27 offset:4160
 ds_read_b64_tr_b16 v[138:139],v27 offset:6208
 ds_read_b64_tr_b16 v[140:141],v27 offset:4168
 ds_read_b64_tr_b16 v[142:143],v27 offset:6216
 s_waitcnt lgkmcnt(0)
 s_barrier
 s_nop 1
 v_mfma_f32_16x16x32_bf16 v[48:51],v[160:163],v[180:183],0
 s_add_u32 m0,s68,65536
 v_mfma_f32_16x16x32_bf16 v[52:55],v[164:167],v[180:183],0
 v_mfma_f32_16x16x32_bf16 v[56:59],v[164:167],v[184:187],0
 v_mfma_f32_16x16x32_bf16 v[60:63],v[168:171],v[184:187],0
 v_mfma_f32_16x16x32_bf16 v[64:67],v[168:171],v[188:191],0
 v_mfma_f32_16x16x32_bf16 v[68:71],v[172:175],v[188:191],0
 v_mfma_f32_16x16x32_bf16 v[72:75],v[172:175],v[192:195],0
 buffer_load_dwordx4 v14,s[28:31],s33 offen offset:0 sc1 lds
 v_mfma_f32_16x16x32_bf16 v[76:79],v[176:179],v[192:195],0
 s_nop 1
 v_cndmask_b32 v48,v48,v49,s[6:7]
 v_cndmask_b32 v50,v50,v51,s[6:7]
 v_cndmask_b32 v52,v52,v53,s[6:7]
 v_cndmask_b32 v54,v54,v55,s[6:7]
 v_cndmask_b32 v40,v48,v52,s[8:9]
 v_cndmask_b32 v41,v50,v54,s[10:11]
 buffer_load_dwordx4 v14,s[28:31],s33 offen offset:1024 sc1 lds
 v_cndmask_b32 v56,v56,v57,s[6:7]
 v_cndmask_b32 v58,v58,v59,s[6:7]
 v_cndmask_b32 v60,v60,v61,s[6:7]
 v_cndmask_b32 v62,v62,v63,s[6:7]
 v_cndmask_b32 v42,v56,v60,s[8:9]
 v_cndmask_b32 v43,v58,v62,s[10:11]
 v_cndmask_b32 v64,v64,v65,s[6:7]
 v_cndmask_b32 v66,v66,v67,s[6:7]
 buffer_load_dwordx4 v14,s[28:31],s33 offen offset:2048 sc1 lds
 v_cndmask_b32 v68,v68,v69,s[6:7]
 v_cndmask_b32 v70,v70,v71,s[6:7]
 v_cndmask_b32 v44,v64,v68,s[8:9]
 v_cndmask_b32 v45,v66,v70,s[10:11]
 v_cndmask_b32 v72,v72,v73,s[6:7]
 v_cndmask_b32 v74,v74,v75,s[6:7]
 v_cndmask_b32 v76,v76,v77,s[6:7]
 v_cndmask_b32 v78,v78,v79,s[6:7]
 buffer_load_dwordx4 v14,s[28:31],s33 offen offset:3072 sc1 lds
 v_cndmask_b32 v46,v72,v76,s[8:9]
 v_cndmask_b32 v47,v74,v78,s[10:11]
 v_cvt_pk_bf16_f32 v32,v40,v41
 v_cvt_pk_bf16_f32 v33,v42,v43
 v_cvt_pk_bf16_f32 v34,v44,v45
 v_cvt_pk_bf16_f32 v35,v46,v47
 v_lshlrev_b32 v40,16,v32
 v_and_b32 v41,0xffff0000,v32
 s_add_u32 m0,s68,69632
 v_lshlrev_b32 v42,16,v33
 v_and_b32 v43,0xffff0000,v33
 v_lshlrev_b32 v44,16,v34
 v_and_b32 v45,0xffff0000,v34
 v_lshlrev_b32 v46,16,v35
 v_and_b32 v47,0xffff0000,v35
 v_mul_f32 v40,s14,v40
 buffer_load_dwordx4 v15,s[28:31],s33 offen offset:0 sc1 lds
 v_mul_f32 v41,s14,v41
 v_mul_f32 v42,s14,v42
 v_mul_f32 v43,s14,v43
 v_mul_f32 v44,s14,v44
 v_mul_f32 v45,s14,v45
 v_mul_f32 v46,s14,v46
 v_mul_f32 v47,s14,v47
 v_cvt_pk_bf16_f32 v32,v40,v41
 buffer_load_dwordx4 v15,s[28:31],s33 offen offset:1024 sc1 lds
 v_cvt_pk_bf16_f32 v33,v42,v43
 v_cvt_pk_bf16_f32 v34,v44,v45
 v_cvt_pk_bf16_f32 v35,v46,v47
 v_lshlrev_b32 v40,16,v32
 v_and_b32 v41,0xffff0000,v32
 v_lshlrev_b32 v42,16,v33
 v_and_b32 v43,0xffff0000,v33
 v_lshlrev_b32 v44,16,v34
 buffer_load_dwordx4 v15,s[28:31],s33 offen offset:2048 sc1 lds
 v_and_b32 v45,0xffff0000,v34
 v_lshlrev_b32 v46,16,v35
 v_and_b32 v47,0xffff0000,v35
 s_or_b64 s[16:17],s[8:9],s[12:13]
 v_cndmask_b32 v40,v218,v40,s[16:17]
 s_or_b64 s[16:17],s[10:11],s[12:13]
 v_cndmask_b32 v41,v218,v41,s[16:17]
 v_max_f32 v32,v40,v41
 buffer_load_dwordx4 v15,s[28:31],s33 offen offset:3072 sc1 lds
 v_max_f32 v33,v42,v43
 v_max_f32 v34,v44,v45
 v_max_f32 v35,v46,v47
 v_mov_b32 v36,v32
 v_mov_b32 v37,v33
 v_mov_b32 v38,v34
 v_mov_b32 v39,v35
 s_nop 0
 v_permlane16_swap_b32 v36,v32
 s_add_u32 s33,s33,32768
 v_permlane16_swap_b32 v37,v33
 v_permlane16_swap_b32 v38,v34
 v_permlane16_swap_b32 v39,v35
 v_max_f32 v32,v32,v36
 v_max_f32 v33,v33,v37
 v_max_f32 v34,v34,v38
 buffer_store_dwordx4 v[112:115],v1,s[28:31],s100 offen sc1
 v_max_f32 v35,v35,v39
 v_mov_b32 v36,v32
 v_mov_b32 v37,v33
 v_mov_b32 v38,v34
 v_mov_b32 v39,v35
 s_nop 0
 v_permlane32_swap_b32 v36,v32
 v_permlane32_swap_b32 v37,v33
 s_add_u32 s100,s100,8192
 v_permlane32_swap_b32 v38,v34
 v_permlane32_swap_b32 v39,v35
 v_max_f32 v32,v32,v36
 v_max_f32 v33,v33,v37
 v_max_f32 v34,v34,v38
 v_max_f32 v35,v35,v39
 v_sub_f32 v40,v40,v32
 v_sub_f32 v41,v41,v32
 buffer_store_dwordx4 v[116:119],v1,s[28:31],s100 offen sc1
 v_sub_f32 v42,v42,v33
 v_sub_f32 v43,v43,v33
 v_sub_f32 v44,v44,v34
 v_sub_f32 v45,v45,v34
 v_sub_f32 v46,v46,v35
 v_sub_f32 v47,v47,v35
 v_mul_f32 v40,s15,v40
 v_mul_f32 v41,s15,v41
 s_add_u32 s100,s100,8192
 v_mul_f32 v42,s15,v42
 v_mul_f32 v43,s15,v43
 v_mul_f32 v44,s15,v44
 v_mul_f32 v45,s15,v45
 v_mul_f32 v46,s15,v46
 v_mul_f32 v47,s15,v47
 v_exp_f32 v40,v40
 v_exp_f32 v41,v41
 buffer_store_dwordx4 v[120:123],v1,s[28:31],s100 offen sc1
 v_exp_f32 v42,v42
 v_exp_f32 v43,v43
 v_exp_f32 v44,v44
 v_exp_f32 v45,v45
 v_exp_f32 v46,v46
 v_exp_f32 v47,v47
 v_add_f32 v32,v40,v41
 v_add_f32 v33,v42,v43
 s_add_u32 s100,s100,8192
 v_add_f32 v34,v44,v45
 v_add_f32 v35,v46,v47
 v_mov_b32 v36,v32
 v_mov_b32 v37,v33
 v_mov_b32 v38,v34
 v_mov_b32 v39,v35
 s_nop 0
 v_permlane16_swap_b32 v36,v32
 buffer_store_dwordx4 v[124:127],v1,s[28:31],s100 offen sc1
 v_permlane16_swap_b32 v37,v33
 v_permlane16_swap_b32 v38,v34
 v_permlane16_swap_b32 v39,v35
 v_add_f32 v32,v32,v36
 v_add_f32 v33,v33,v37
 v_add_f32 v34,v34,v38
 v_add_f32 v35,v35,v39
 s_add_u32 s100,s100,8192
 v_mov_b32 v36,v32
 v_mov_b32 v37,v33
 v_mov_b32 v38,v34
 v_mov_b32 v39,v35
 s_nop 0
 v_permlane32_swap_b32 v36,v32
 v_permlane32_swap_b32 v37,v33
 v_permlane32_swap_b32 v38,v34
 buffer_store_dwordx4 v[128:131],v1,s[28:31],s101 offen sc1
 v_permlane32_swap_b32 v39,v35
 v_add_f32 v32,v32,v36
 v_add_f32 v33,v33,v37
 v_add_f32 v34,v34,v38
 v_add_f32 v35,v35,v39
 v_rcp_f32 v32,v32
 v_rcp_f32 v33,v33
 v_rcp_f32 v34,v34
 s_add_u32 s101,s101,8192
 v_rcp_f32 v35,v35
 s_nop 0
 v_mul_f32 v40,v40,v32
 v_mul_f32 v41,v41,v32
 v_mul_f32 v42,v42,v33
 v_mul_f32 v43,v43,v33
 v_mul_f32 v44,v44,v34
 v_mul_f32 v45,v45,v34
 buffer_store_dwordx4 v[132:135],v1,s[28:31],s101 offen sc1
 v_mul_f32 v46,v46,v35
 v_mul_f32 v47,v47,v35
 v_cvt_pk_bf16_f32 v40,v40,v40
 v_cvt_pk_bf16_f32 v41,v41,v41
 v_cvt_pk_bf16_f32 v42,v42,v42
 v_cvt_pk_bf16_f32 v43,v43,v43
 v_cvt_pk_bf16_f32 v44,v44,v44
 s_add_u32 s101,s101,s57
 v_cvt_pk_bf16_f32 v45,v45,v45
 v_cvt_pk_bf16_f32 v46,v46,v46
 v_cvt_pk_bf16_f32 v47,v47,v47
 v_and_b32 v40,v40,v219
 v_and_b32 v41,v41,v219
 v_and_b32 v42,v42,v219
 v_and_b32 v43,v43,v219
 v_and_b32 v44,v44,v219
 buffer_store_dwordx4 v[136:139],v1,s[28:31],s101 offen sc1
 v_and_b32 v45,v45,v219
 v_and_b32 v46,v46,v219
 v_and_b32 v47,v47,v219
 v_cndmask_b32 v48,v40,0,s[8:9]
 v_cndmask_b32 v50,0,v40,s[8:9]
 v_cndmask_b32 v49,v41,0,s[10:11]
 v_cndmask_b32 v51,0,v41,s[10:11]
 v_cndmask_b32 v56,v42,0,s[8:9]
 s_add_u32 s101,s101,8192
 v_cndmask_b32 v58,0,v42,s[8:9]
 v_cndmask_b32 v57,v43,0,s[10:11]
 v_cndmask_b32 v59,0,v43,s[10:11]
 v_cndmask_b32 v64,v44,0,s[8:9]
 v_cndmask_b32 v66,0,v44,s[8:9]
 v_cndmask_b32 v65,v45,0,s[10:11]
 v_cndmask_b32 v67,0,v45,s[10:11]
 v_cndmask_b32 v72,v46,0,s[8:9]
 buffer_store_dwordx4 v[140:143],v1,s[28:31],s101 offen sc1
 v_cndmask_b32 v74,0,v46,s[8:9]
 v_cndmask_b32 v73,v47,0,s[10:11]
 v_cndmask_b32 v75,0,v47,s[10:11]
 s_nop 1
 v_mfma_f32_16x16x32_bf16 v[80:83],v[196:199],v[48:51],0
 v_mfma_f32_16x16x32_bf16 v[84:87],v[206:209],v[48:51],0
 v_mfma_f32_16x16x32_bf16 v[88:91],v[198:201],v[56:59],0
 v_mfma_f32_16x16x32_bf16 v[92:95],v[208:211],v[56:59],0
 s_add_u32 s101,s101,8192
 v_mfma_f32_16x16x32_bf16 v[96:99],v[200:203],v[64:67],0
 v_mfma_f32_16x16x32_bf16 v[100:103],v[210:213],v[64:67],0
 v_mfma_f32_16x16x32_bf16 v[104:107],v[202:205],v[72:75],0
 v_mfma_f32_16x16x32_bf16 v[108:111],v[212:215],v[72:75],0
 s_lshl_b32 s24,s76,2
 s_add_u32 s24,s24,s45
 s_lshl_b32 s24,s24,5
 s_and_b32 s25,s77,7
 s_add_u32 s24,s24,s25
 s_lshl_b32 s24,s24,10
 s_lshr_b32 s25,s77,3
 s_lshl_b32 s25,s25,20
 s_add_u32 s24,s24,s25
 s_add_u32 s24,s24,100663296
 s_nop 3
 v_cvt_pk_bf16_f32 v80,v80,v81
 v_cvt_pk_bf16_f32 v81,v82,v83
 v_cvt_pk_bf16_f32 v82,v84,v85
 v_cvt_pk_bf16_f32 v83,v86,v87
 v_cndmask_b32 v82,0,v82,s[4:5]
 v_cndmask_b32 v83,0,v83,s[4:5]
 buffer_store_dwordx4 v[80:83],v1,s[28:31],s24 offen sc1
 s_add_u32 s24,s24,8192
 v_cvt_pk_bf16_f32 v88,v88,v89
 v_cvt_pk_bf16_f32 v89,v90,v91
 v_cvt_pk_bf16_f32 v90,v92,v93
 v_cvt_pk_bf16_f32 v91,v94,v95
 v_cndmask_b32 v90,0,v90,s[4:5]
 v_cndmask_b32 v91,0,v91,s[4:5]
 buffer_store_dwordx4 v[88:91],v1,s[28:31],s24 offen sc1
 s_add_u32 s24,s24,8192
 v_cvt_pk_bf16_f32 v96,v96,v97
 v_cvt_pk_bf16_f32 v97,v98,v99
 v_cvt_pk_bf16_f32 v98,v100,v101
 v_cvt_pk_bf16_f32 v99,v102,v103
 v_cndmask_b32 v98,0,v98,s[4:5]
 v_cndmask_b32 v99,0,v99,s[4:5]
 buffer_store_dwordx4 v[96:99],v1,s[28:31],s24 offen sc1
 s_add_u32 s24,s24,8192
 v_cvt_pk_bf16_f32 v104,v104,v105
 v_cvt_pk_bf16_f32 v105,v106,v107
 v_cvt_pk_bf16_f32 v106,v108,v109
 v_cvt_pk_bf16_f32 v107,v110,v111
 v_cndmask_b32 v106,0,v106,s[4:5]
 v_cndmask_b32 v107,0,v107,s[4:5]
 buffer_store_dwordx4 v[104:107],v1,s[28:31],s24 offen sc1
 s_add_u32 s24,s24,8192
 v_lshrrev_b32 v16,6,v0
 v_add_u32 v2,0x10000,v1
 v_and_b32 v3,15,v0
 v_bfe_u32 v17,v0,4,2
 v_lshlrev_b32 v17,2,v17
 v_sub_u32 v3,v3,v17
 v_sub_u32 v17,3,v16
 v_lshl_add_u32 v255,v17,4,v3
 v_lshl_add_u32 v3,v16,4,v3
 s_lshl_b32 s61,s45,1
 s_sub_u32 s61,7,s61
 s_mul_i32 s62,s61,229376
 v_add_u32 v249,s62,v1
 v_mov_b32 v4,0xff800000
 s_mov_b32 s12,s78
 s_and_b32 s13,s79,0xffff
 s_mov_b32 s14,3670016
 s_mov_b32 s15,0x20000
 s_lshl_b32 s61,s46,3
 s_add_u32 s61,s61,s48
 s_lshl_b32 s66,s61,2
 s_add_u32 s66,s66,s45
 s_lshl_b32 s66,s66,10
 s_add_u32 s66,s66,126877696
 s_lshl_b32 s61,s61,7
 s_add_u32 s61,s61,125837312
 v_mov_b32 v240,s61
 v_mov_b32 v241,s44
 v_mov_b32 v242,0
 s_lshr_b32 s62,s46,1
 s_add_u32 s61,s62,48
 s_lshl_b32 s61,s61,7
 s_add_u32 s61,s61,125829120
 v_writelane_b32 v240,s61,1
 s_mov_b32 s61,125836032
 v_writelane_b32 v240,s61,2
 s_mov_b32 s61,125836160
 v_writelane_b32 v240,s61,3
 s_mov_b32 s61,125835520
 v_writelane_b32 v240,s61,4
 s_mov_b32 s61,125835648
 v_writelane_b32 v240,s61,5
 v_writelane_b32 v241,16,1
 v_writelane_b32 v241,16,2
 v_writelane_b32 v241,16,3
 v_writelane_b32 v241,16,4
 v_writelane_b32 v241,16,5
 s_add_u32 s67,s46,16
 s_add_u32 s72,s76,48
 v_mov_b32 v112,0
 v_mov_b32 v113,0
 v_mov_b32 v114,0
 v_mov_b32 v115,0
 v_mov_b32 v116,0
 v_mov_b32 v117,0
 v_mov_b32 v118,0
 v_mov_b32 v119,0
 v_mov_b32 v120,0
 v_mov_b32 v121,0
 v_mov_b32 v122,0
 v_mov_b32 v123,0
 v_mov_b32 v124,0
 v_mov_b32 v125,0
 v_mov_b32 v126,0
 v_mov_b32 v127,0
 v_mov_b32 v128,0
 v_mov_b32 v129,0
 v_mov_b32 v130,0
 v_mov_b32 v131,0
 v_mov_b32 v132,0
 v_mov_b32 v133,0
 v_mov_b32 v134,0
 v_mov_b32 v135,0
 v_mov_b32 v136,0
 v_mov_b32 v137,0
 v_mov_b32 v138,0
 v_mov_b32 v139,0
 v_mov_b32 v140,0
 v_mov_b32 v141,0
 v_mov_b32 v142,0
 v_mov_b32 v143,0
 v_mov_b32 v144,0
 v_mov_b32 v145,0
 v_mov_b32 v146,0
 v_mov_b32 v147,0
 v_mov_b32 v148,0
 v_mov_b32 v149,0
 v_mov_b32 v150,0
 v_mov_b32 v151,0
 v_mov_b32 v152,0
 v_mov_b32 v153,0
 v_mov_b32 v154,0
 v_mov_b32 v155,0
 v_mov_b32 v156,0
 v_mov_b32 v157,0
 v_mov_b32 v158,0
 v_mov_b32 v159,0
 v_mov_b32 v160,0
 v_mov_b32 v161,0
 v_mov_b32 v162,0
 v_mov_b32 v163,0
 v_mov_b32 v164,0
 v_mov_b32 v165,0
 v_mov_b32 v166,0
 v_mov_b32 v167,0
 v_mov_b32 v168,0
 v_mov_b32 v169,0
 v_mov_b32 v170,0
 v_mov_b32 v171,0
 v_mov_b32 v172,0
 v_mov_b32 v173,0
 v_mov_b32 v174,0
 v_mov_b32 v175,0
 s_waitcnt vmcnt(28)
 s_branch K2_QK0B
K2_QK0B:
 v_mov_b32 v24,0
 v_mov_b32 v25,0
 v_mov_b32 v26,0
 v_mov_b32 v27,0
 v_mov_b32 v28,0
 v_mov_b32 v29,0
 v_mov_b32 v30,0
 v_mov_b32 v31,0
 s_and_b32 s61,s68,0x8000
 v_add_u32 v20,s61,v1
 v_xor_b32 v21,0x8000,v20
 s_barrier
 ds_read_b128 a[64:67],v20 offset:0
 ds_read_b128 a[68:71],v20 offset:1024
 ds_read_b128 a[72:75],v20 offset:2048
 ds_read_b128 a[76:79],v20 offset:3072
 ds_read_b128 a[80:83],v20 offset:4096
 ds_read_b128 a[84:87],v20 offset:5120
 ds_read_b128 a[88:91],v20 offset:6144
 ds_read_b128 a[92:95],v20 offset:7168
 ds_read_b128 a[96:99],v20 offset:8192
 ds_read_b128 a[100:103],v20 offset:9216
 ds_read_b128 a[104:107],v20 offset:10240
 ds_read_b128 a[108:111],v20 offset:11264
 ds_read_b128 a[112:115],v20 offset:12288
 v_mov_b32 v6,0
 v_mov_b32 v7,0
 v_lshrrev_b32 v16,4,v1
 s_add_u32 s63,s43,s42
 s_lshl_b32 s62,s46,20
 v_sub_u32 v17,s63,v16
 v_add_u32 v17,2,v17
 v_cmp_le_i32 vcc,s34,v17
 v_add_u32 v18,s52,v17
 s_add_u32 s61,s62,0
 v_cndmask_b32 v17,v17,v18,vcc
 v_lshl_add_u32 v252,v17,15,s61
 v_sub_u32 v17,s63,v16
 v_add_u32 v17,1,v17
 v_cmp_le_i32 vcc,s34,v17
 v_add_u32 v18,s52,v17
 s_add_u32 s61,s62,16777216
 v_cndmask_b32 v17,v17,v18,vcc
 v_lshl_add_u32 v253,v17,15,s61
 s_add_u32 s61,s35,32768
 v_writelane_b32 v252,s35,2
 v_writelane_b32 v252,s61,1
 s_add_u32 s61,s46,16
 s_lshl_b32 s61,s61,7
 s_add_u32 s61,s61,125829120
 v_mov_b32 v5,s61
 s_add_u32 s61,s46,192
 s_lshl_b32 s61,s61,7
 s_add_u32 s61,s61,125829120
 v_writelane_b32 v5,s61,1
 v_readlane_b32 s32,v252,s43
 v_mov_b32 v96,0
 v_mov_b32 v97,0
 v_mov_b32 v98,0
 v_mov_b32 v99,0
 v_mov_b32 v100,0
 v_mov_b32 v101,0
 v_mov_b32 v102,0
 v_mov_b32 v103,0
 v_mov_b32 v104,0
 v_mov_b32 v105,0
 v_mov_b32 v106,0
 v_mov_b32 v107,0
 v_mov_b32 v108,0
 v_mov_b32 v109,0
 v_mov_b32 v110,0
 v_mov_b32 v111,0
 v_mov_b32 v176,0
 v_mov_b32 v177,0
 v_mov_b32 v178,0
 v_mov_b32 v179,0
 v_mov_b32 v180,0
 v_mov_b32 v181,0
 v_mov_b32 v182,0
 v_mov_b32 v183,0
 s_waitcnt lgkmcnt(5)
 v_mfma_f32_16x16x32_bf16 v[32:35],a[64:67],a[192:195],v[24:27]
 ds_read_b128 a[116:119],v20 offset:13312
 v_mov_b32 v184,0
 v_mfma_f32_16x16x32_bf16 v[32:35],a[68:71],a[196:199],v[32:35]
 v_mov_b32 v185,0
 v_mov_b32 v186,0
 v_mfma_f32_16x16x32_bf16 v[32:35],a[72:75],a[200:203],v[32:35]
 ds_read_b128 a[120:123],v20 offset:14336
 v_mov_b32 v187,0
 v_mfma_f32_16x16x32_bf16 v[32:35],a[76:79],a[204:207],v[32:35]
 v_mov_b32 v188,0
 v_mov_b32 v189,0
 v_mfma_f32_16x16x32_bf16 v[48:51],a[64:67],a[224:227],v[28:31]
 ds_read_b128 a[124:127],v20 offset:15360
 v_mov_b32 v190,0
 v_mfma_f32_16x16x32_bf16 v[48:51],a[68:71],a[228:231],v[48:51]
 v_mov_b32 v191,0
 v_mov_b32 v192,0
 v_mfma_f32_16x16x32_bf16 v[48:51],a[72:75],a[232:235],v[48:51]
 v_mov_b32 v193,0
 v_mov_b32 v194,0
 v_mfma_f32_16x16x32_bf16 v[48:51],a[76:79],a[236:239],v[48:51]
 ds_read_b128 a[128:131],v20 offset:16384
 v_mov_b32 v195,0
 v_mfma_f32_16x16x32_bf16 v[32:35],a[80:83],a[208:211],v[32:35]
 v_mov_b32 v196,0
 v_mov_b32 v197,0
 v_mfma_f32_16x16x32_bf16 v[32:35],a[84:87],a[212:215],v[32:35]
 ds_read_b128 a[132:135],v20 offset:17408
 v_mov_b32 v198,0
 v_mfma_f32_16x16x32_bf16 v[32:35],a[88:91],a[216:219],v[32:35]
 v_mov_b32 v199,0
 v_mov_b32 v200,0
 v_mfma_f32_16x16x32_bf16 v[32:35],a[92:95],a[220:223],v[32:35]
 ds_read_b128 a[136:139],v20 offset:18432
 v_mov_b32 v201,0
 v_mfma_f32_16x16x32_bf16 v[48:51],a[80:83],a[240:243],v[48:51]
 v_mov_b32 v202,0
 v_mov_b32 v203,0
 v_mfma_f32_16x16x32_bf16 v[48:51],a[84:87],a[244:247],v[48:51]
 ds_read_b128 a[140:143],v20 offset:19456
 v_mov_b32 v204,0
 v_mfma_f32_16x16x32_bf16 v[48:51],a[88:91],a[248:251],v[48:51]
 v_mov_b32 v205,0
 v_mov_b32 v206,0
 v_mfma_f32_16x16x32_bf16 v[48:51],a[92:95],a[252:255],v[48:51]
 s_waitcnt lgkmcnt(4)
 v_mov_b32 v207,0
 v_mfma_f32_16x16x32_bf16 v[36:39],a[96:99],a[192:195],v[24:27]
 ds_read_b128 a[144:147],v20 offset:20480
 v_mov_b32 v208,0
 v_mfma_f32_16x16x32_bf16 v[36:39],a[100:103],a[196:199],v[36:39]
 v_mov_b32 v209,0
 v_mov_b32 v210,0
 v_mfma_f32_16x16x32_bf16 v[36:39],a[104:107],a[200:203],v[36:39]
 ds_read_b128 a[148:151],v20 offset:21504
 v_mov_b32 v211,0
 v_mfma_f32_16x16x32_bf16 v[36:39],a[108:111],a[204:207],v[36:39]
 v_mov_b32 v212,0
 v_mov_b32 v213,0
 v_mfma_f32_16x16x32_bf16 v[52:55],a[96:99],a[224:227],v[28:31]
 v_mov_b32 v214,0
 v_mov_b32 v215,0
 v_mfma_f32_16x16x32_bf16 v[52:55],a[100:103],a[228:231],v[52:55]
 ds_read_b128 a[152:155],v20 offset:22528
 v_mov_b32 v216,0
 v_mfma_f32_16x16x32_bf16 v[52:55],a[104:107],a[232:235],v[52:55]
 v_mov_b32 v217,0
 v_mov_b32 v218,0
 v_mfma_f32_16x16x32_bf16 v[52:55],a[108:111],a[236:239],v[52:55]
 ds_read_b128 a[156:159],v20 offset:23552
 v_mov_b32 v219,0
 v_mfma_f32_16x16x32_bf16 v[36:39],a[112:115],a[208:211],v[36:39]
 v_mov_b32 v220,0
 v_mov_b32 v221,0
 v_mfma_f32_16x16x32_bf16 v[36:39],a[116:119],a[212:215],v[36:39]
 ds_read_b128 a[160:163],v20 offset:24576
 v_mov_b32 v222,0
 v_mfma_f32_16x16x32_bf16 v[36:39],a[120:123],a[216:219],v[36:39]
 v_mov_b32 v223,0
 v_accvgpr_mov_b32 a0,a192
 v_mfma_f32_16x16x32_bf16 v[36:39],a[124:127],a[220:223],v[36:39]
 ds_read_b128 a[164:167],v20 offset:25600
 v_accvgpr_mov_b32 a1,a193
 v_mfma_f32_16x16x32_bf16 v[52:55],a[112:115],a[240:243],v[52:55]
 v_accvgpr_mov_b32 a2,a194
 v_accvgpr_mov_b32 a3,a195
 v_mfma_f32_16x16x32_bf16 v[52:55],a[116:119],a[244:247],v[52:55]
 v_accvgpr_mov_b32 a4,a196
 v_accvgpr_mov_b32 a5,a197
 v_mfma_f32_16x16x32_bf16 v[52:55],a[120:123],a[248:251],v[52:55]
 ds_read_b128 a[168:171],v20 offset:26624
 v_accvgpr_mov_b32 a6,a198
 v_mfma_f32_16x16x32_bf16 v[52:55],a[124:127],a[252:255],v[52:55]
 s_waitcnt lgkmcnt(3)
 v_accvgpr_mov_b32 a7,a199
 v_mfma_f32_16x16x32_bf16 v[40:43],a[128:131],a[192:195],v[24:27]
 ds_read_b128 a[172:175],v20 offset:27648
 v_accvgpr_mov_b32 a8,a200
 v_mfma_f32_16x16x32_bf16 v[40:43],a[132:135],a[196:199],v[40:43]
 v_accvgpr_mov_b32 a9,a201
 v_accvgpr_mov_b32 a10,a202
 v_mfma_f32_16x16x32_bf16 v[40:43],a[136:139],a[200:203],v[40:43]
 ds_read_b128 a[176:179],v20 offset:28672
 v_accvgpr_mov_b32 a11,a203
 v_mfma_f32_16x16x32_bf16 v[40:43],a[140:143],a[204:207],v[40:43]
 v_accvgpr_mov_b32 a12,a204
 v_accvgpr_mov_b32 a13,a205
 v_mfma_f32_16x16x32_bf16 v[56:59],a[128:131],a[224:227],v[28:31]
 ds_read_b128 a[180:183],v20 offset:29696
 v_accvgpr_mov_b32 a14,a206
 v_mfma_f32_16x16x32_bf16 v[56:59],a[132:135],a[228:231],v[56:59]
 v_accvgpr_mov_b32 a15,a207
 v_accvgpr_mov_b32 a16,a208
 v_mfma_f32_16x16x32_bf16 v[56:59],a[136:139],a[232:235],v[56:59]
 ds_read_b128 a[184:187],v20 offset:30720
 v_accvgpr_mov_b32 a17,a209
 v_mfma_f32_16x16x32_bf16 v[56:59],a[140:143],a[236:239],v[56:59]
 v_accvgpr_mov_b32 a18,a210
 v_accvgpr_mov_b32 a19,a211
 v_mfma_f32_16x16x32_bf16 v[40:43],a[144:147],a[208:211],v[40:43]
 ds_read_b128 a[188:191],v20 offset:31744
 v_accvgpr_mov_b32 a20,a212
 v_mfma_f32_16x16x32_bf16 v[40:43],a[148:151],a[212:215],v[40:43]
 v_accvgpr_mov_b32 a21,a213
 v_accvgpr_mov_b32 a22,a214
 v_mfma_f32_16x16x32_bf16 v[40:43],a[152:155],a[216:219],v[40:43]
 v_accvgpr_mov_b32 a23,a215
 v_accvgpr_mov_b32 a24,a216
 v_mfma_f32_16x16x32_bf16 v[40:43],a[156:159],a[220:223],v[40:43]
 v_accvgpr_mov_b32 a25,a217
 v_accvgpr_mov_b32 a26,a218
 v_mfma_f32_16x16x32_bf16 v[56:59],a[144:147],a[240:243],v[56:59]
 v_accvgpr_mov_b32 a27,a219
 v_accvgpr_mov_b32 a28,a220
 v_mfma_f32_16x16x32_bf16 v[56:59],a[148:151],a[244:247],v[56:59]
 v_accvgpr_mov_b32 a29,a221
 v_accvgpr_mov_b32 a30,a222
 v_mfma_f32_16x16x32_bf16 v[56:59],a[152:155],a[248:251],v[56:59]
 v_accvgpr_mov_b32 a31,a223
 v_accvgpr_mov_b32 a32,a224
 v_mfma_f32_16x16x32_bf16 v[56:59],a[156:159],a[252:255],v[56:59]
 s_waitcnt lgkmcnt(0)
 v_accvgpr_mov_b32 a33,a225
 v_mfma_f32_16x16x32_bf16 v[44:47],a[160:163],a[192:195],v[24:27]
 v_accvgpr_mov_b32 a34,a226
 v_accvgpr_mov_b32 a35,a227
 v_mfma_f32_16x16x32_bf16 v[44:47],a[164:167],a[196:199],v[44:47]
 v_accvgpr_mov_b32 a36,a228
 v_accvgpr_mov_b32 a37,a229
 v_mfma_f32_16x16x32_bf16 v[44:47],a[168:171],a[200:203],v[44:47]
 v_accvgpr_mov_b32 a38,a230
 v_accvgpr_mov_b32 a39,a231
 v_mfma_f32_16x16x32_bf16 v[44:47],a[172:175],a[204:207],v[44:47]
 v_accvgpr_mov_b32 a40,a232
 v_accvgpr_mov_b32 a41,a233
 v_mfma_f32_16x16x32_bf16 v[60:63],a[160:163],a[224:227],v[28:31]
 v_accvgpr_mov_b32 a42,a234
 v_accvgpr_mov_b32 a43,a235
 v_mfma_f32_16x16x32_bf16 v[60:63],a[164:167],a[228:231],v[60:63]
 v_accvgpr_mov_b32 a44,a236
 v_accvgpr_mov_b32 a45,a237
 v_mfma_f32_16x16x32_bf16 v[60:63],a[168:171],a[232:235],v[60:63]
 v_accvgpr_mov_b32 a46,a238
 v_accvgpr_mov_b32 a47,a239
 v_mfma_f32_16x16x32_bf16 v[60:63],a[172:175],a[236:239],v[60:63]
 v_accvgpr_mov_b32 a48,a240
 v_accvgpr_mov_b32 a49,a241
 v_mfma_f32_16x16x32_bf16 v[44:47],a[176:179],a[208:211],v[44:47]
 v_accvgpr_mov_b32 a50,a242
 v_accvgpr_mov_b32 a51,a243
 v_mfma_f32_16x16x32_bf16 v[44:47],a[180:183],a[212:215],v[44:47]
 v_accvgpr_mov_b32 a52,a244
 v_accvgpr_mov_b32 a53,a245
 v_mfma_f32_16x16x32_bf16 v[44:47],a[184:187],a[216:219],v[44:47]
 v_accvgpr_mov_b32 a54,a246
 v_accvgpr_mov_b32 a55,a247
 v_mfma_f32_16x16x32_bf16 v[44:47],a[188:191],a[220:223],v[44:47]
 v_accvgpr_mov_b32 a56,a248
 v_accvgpr_mov_b32 a57,a249
 v_mfma_f32_16x16x32_bf16 v[60:63],a[176:179],a[240:243],v[60:63]
 v_accvgpr_mov_b32 a58,a250
 v_accvgpr_mov_b32 a59,a251
 v_mfma_f32_16x16x32_bf16 v[60:63],a[180:183],a[244:247],v[60:63]
 v_accvgpr_mov_b32 a60,a252
 v_accvgpr_mov_b32 a61,a253
 v_mfma_f32_16x16x32_bf16 v[60:63],a[184:187],a[248:251],v[60:63]
 v_accvgpr_mov_b32 a62,a254
 v_accvgpr_mov_b32 a63,a255
 v_mfma_f32_16x16x32_bf16 v[60:63],a[188:191],a[252:255],v[60:63]
 s_waitcnt vmcnt(20)
K2_QK0E:
 s_barrier
 ds_read_b128 a[64:67],v21 offset:0
 ds_read_b128 a[68:71],v21 offset:1024
 ds_read_b128 a[72:75],v21 offset:2048
 ds_read_b128 a[76:79],v21 offset:3072
 ds_read_b128 a[80:83],v21 offset:4096
 ds_read_b128 a[84:87],v21 offset:5120
 ds_read_b128 a[88:91],v21 offset:6144
 ds_read_b128 a[92:95],v21 offset:7168
 ds_read_b128 a[96:99],v21 offset:8192
 ds_read_b128 a[100:103],v21 offset:9216
 ds_read_b128 a[104:107],v21 offset:10240
 ds_read_b128 a[108:111],v21 offset:11264
 ds_read_b128 a[112:115],v21 offset:12288
 s_cmp_eq_u32 s43,s40
 s_cbranch_scc0 K2_NOM0
 v_cmp_gt_i32 s[22:23],0,v3
 v_cmp_gt_i32 s[24:25],1,v3
 v_cmp_gt_i32 s[26:27],2,v3
 v_cndmask_b32 v32,v32,v4,s[22:23]
 v_cmp_gt_i32 s[22:23],3,v3
 v_cndmask_b32 v33,v33,v4,s[24:25]
 v_cmp_gt_i32 s[24:25],16,v3
 v_cndmask_b32 v34,v34,v4,s[26:27]
 v_cmp_gt_i32 s[26:27],17,v3
 v_cndmask_b32 v35,v35,v4,s[22:23]
 v_cmp_gt_i32 s[22:23],18,v3
 v_cndmask_b32 v36,v36,v4,s[24:25]
 v_cmp_gt_i32 s[24:25],19,v3
 v_cndmask_b32 v37,v37,v4,s[26:27]
 v_cmp_gt_i32 s[26:27],32,v3
 v_cndmask_b32 v38,v38,v4,s[22:23]
 v_cmp_gt_i32 s[22:23],33,v3
 v_cndmask_b32 v39,v39,v4,s[24:25]
 v_cmp_gt_i32 s[24:25],34,v3
 v_cndmask_b32 v40,v40,v4,s[26:27]
 v_cmp_gt_i32 s[26:27],35,v3
 v_cndmask_b32 v41,v41,v4,s[22:23]
 v_cmp_gt_i32 s[22:23],48,v3
 v_cndmask_b32 v42,v42,v4,s[24:25]
 v_cmp_gt_i32 s[24:25],49,v3
 v_cndmask_b32 v43,v43,v4,s[26:27]
 v_cmp_gt_i32 s[26:27],50,v3
 v_cndmask_b32 v44,v44,v4,s[22:23]
 v_cmp_gt_i32 s[22:23],51,v3
 v_cndmask_b32 v45,v45,v4,s[24:25]
 s_nop 0
 v_cndmask_b32 v46,v46,v4,s[26:27]
 s_nop 0
 v_cndmask_b32 v47,v47,v4,s[22:23]
 s_nop 0
K2_NOM0:
 v_max3_f32 v8,v32,v33,v34
 v_max3_f32 v9,v48,v49,v50
 v_max3_f32 v8,v8,v35,v36
 s_add_u32 m0,s68,0
 v_max3_f32 v9,v9,v51,v52
 v_max3_f32 v8,v8,v37,v38
 v_max3_f32 v9,v9,v53,v54
 v_max3_f32 v8,v8,v39,v40
 v_max3_f32 v9,v9,v55,v56
 v_max3_f32 v8,v8,v41,v42
 v_max3_f32 v9,v9,v57,v58
 v_max3_f32 v8,v8,v43,v44
 v_max3_f32 v9,v9,v59,v60
 buffer_load_dwordx4 v14,s[28:31],s32 offen offset:0 sc1 lds
 v_max3_f32 v8,v8,v45,v46
 v_max3_f32 v9,v9,v61,v62
 v_max_f32 v8,v8,v47
 v_max_f32 v9,v9,v63
 v_mov_b32 v17,v8
 v_mov_b32 v18,v9
 s_nop 1
 v_permlane16_swap_b32 v17,v8
 v_permlane16_swap_b32 v18,v9
 buffer_load_dwordx4 v14,s[28:31],s32 offen offset:1024 sc1 lds
 s_nop 0
 v_max_f32 v8,v8,v17
 v_max_f32 v9,v9,v18
 v_mov_b32 v17,v8
 v_mov_b32 v18,v9
 s_nop 1
 v_permlane32_swap_b32 v17,v8
 v_permlane32_swap_b32 v18,v9
 s_nop 0
 buffer_load_dwordx4 v14,s[28:31],s32 offen offset:2048 sc1 lds
 v_max_f32 v8,v8,v17
 v_max_f32 v9,v9,v18
 v_sub_f32 v32,v32,v8
 v_sub_f32 v33,v33,v8
 v_sub_f32 v34,v34,v8
 v_sub_f32 v35,v35,v8
 v_sub_f32 v36,v36,v8
 v_sub_f32 v37,v37,v8
 v_sub_f32 v38,v38,v8
 buffer_load_dwordx4 v14,s[28:31],s32 offen offset:3072 sc1 lds
 v_sub_f32 v39,v39,v8
 v_sub_f32 v40,v40,v8
 v_sub_f32 v41,v41,v8
 v_sub_f32 v42,v42,v8
 v_sub_f32 v43,v43,v8
 v_sub_f32 v44,v44,v8
 v_sub_f32 v45,v45,v8
 v_sub_f32 v46,v46,v8
 v_sub_f32 v47,v47,v8
 s_add_u32 m0,s68,4096
 v_sub_f32 v24,v24,v8
 v_sub_f32 v25,v25,v8
 v_sub_f32 v26,v26,v8
 v_sub_f32 v27,v27,v8
 v_sub_f32 v48,v48,v9
 v_sub_f32 v49,v49,v9
 v_sub_f32 v50,v50,v9
 v_sub_f32 v51,v51,v9
 v_sub_f32 v52,v52,v9
 buffer_load_dwordx4 v15,s[28:31],s32 offen offset:0 sc1 lds
 v_sub_f32 v53,v53,v9
 v_sub_f32 v54,v54,v9
 v_sub_f32 v55,v55,v9
 v_sub_f32 v56,v56,v9
 v_sub_f32 v57,v57,v9
 v_sub_f32 v58,v58,v9
 v_sub_f32 v59,v59,v9
 v_sub_f32 v60,v60,v9
 v_sub_f32 v61,v61,v9
 buffer_load_dwordx4 v15,s[28:31],s32 offen offset:1024 sc1 lds
 v_sub_f32 v62,v62,v9
 v_sub_f32 v63,v63,v9
 v_sub_f32 v28,v28,v9
 v_sub_f32 v29,v29,v9
 v_sub_f32 v30,v30,v9
 v_sub_f32 v31,v31,v9
 v_exp_f32 v32,v32
 v_exp_f32 v33,v33
 v_exp_f32 v48,v48
 buffer_load_dwordx4 v15,s[28:31],s32 offen offset:2048 sc1 lds
 v_add_f32 v6,v6,v32
 v_exp_f32 v49,v49
 v_add_f32 v6,v6,v33
 v_cvt_pk_bf16_f32 v32,v32,v33
 v_exp_f32 v34,v34
 v_add_f32 v7,v7,v48
 v_exp_f32 v35,v35
 v_add_f32 v7,v7,v49
 v_cvt_pk_bf16_f32 v48,v48,v49
 buffer_load_dwordx4 v15,s[28:31],s32 offen offset:3072 sc1 lds
 v_exp_f32 v50,v50
 v_add_f32 v6,v6,v34
 v_exp_f32 v51,v51
 v_add_f32 v6,v6,v35
 v_cvt_pk_bf16_f32 v33,v34,v35
 v_exp_f32 v36,v36
 v_add_f32 v7,v7,v50
 v_exp_f32 v37,v37
 v_add_f32 v7,v7,v51
 v_cvt_pk_bf16_f32 v49,v50,v51
 v_exp_f32 v52,v52
 v_add_f32 v6,v6,v36
 v_exp_f32 v53,v53
 v_add_f32 v6,v6,v37
 v_cvt_pk_bf16_f32 v34,v36,v37
 v_exp_f32 v38,v38
 v_add_f32 v7,v7,v52
 v_exp_f32 v39,v39
 v_add_f32 v7,v7,v53
 v_cvt_pk_bf16_f32 v50,v52,v53
 v_add_f32 v6,v6,v38
 v_add_f32 v6,v6,v39
 v_cvt_pk_bf16_f32 v35,v38,v39
K2_PENDS:
 s_waitcnt vmcnt(8)
 s_barrier
 s_cmp_eq_u32 s45,0
 s_cbranch_scc0 PS_21A
 s_add_u32 s60,s67,0
 s_lshl_b32 s60,s60,7
 s_add_u32 s60,s60,125829120
 v_mov_b32 v22,1
 v_mov_b32 v23,0
 s_mov_b64 exec,1
 buffer_atomic_add v22,v23,s[28:31],s60 offen sc1
 s_mov_b64 exec,-1
PS_21A:
 s_mov_b32 s67,0
 s_cmp_eq_u32 s72,0
 s_cbranch_scc1 PS_21
 s_cmp_eq_u32 s45,0
 s_cbranch_scc0 PS_21B
 s_add_u32 s60,s72,0
 s_lshl_b32 s60,s60,7
 s_add_u32 s60,s60,125829120
 v_mov_b32 v22,1
 v_mov_b32 v23,0
 s_mov_b64 exec,1
 buffer_atomic_add v22,v23,s[28:31],s60 offen sc1
 s_mov_b64 exec,-1
PS_21B:
 s_mov_b32 s72,0
PS_21:
K2_ST:
 s_waitcnt lgkmcnt(0)
 s_cmp_eq_u32 s38,s39
 s_cbranch_scc1 K2_FIN
 s_bitcmp1_b32 s43,0
 s_cbranch_scc0 K2_LOOP
 v_mov_b32 v64,v32
 v_mov_b32 v65,v33
 v_mov_b32 v66,v34
 v_mov_b32 v67,v35
 v_mov_b32 v68,v36
 v_mov_b32 v69,v37
 v_mov_b32 v70,v38
 v_mov_b32 v71,v39
 v_mov_b32 v72,v40
 v_mov_b32 v73,v41
 v_mov_b32 v74,v42
 v_mov_b32 v75,v43
 v_mov_b32 v76,v44
 v_mov_b32 v77,v45
 v_mov_b32 v78,v46
 v_mov_b32 v79,v47
 v_mov_b32 v80,v48
 v_mov_b32 v81,v49
 v_mov_b32 v82,v50
 v_mov_b32 v83,v51
 v_mov_b32 v84,v52
 v_mov_b32 v85,v53
 v_mov_b32 v86,v54
 v_mov_b32 v87,v55
 v_mov_b32 v88,v56
 v_mov_b32 v89,v57
 v_mov_b32 v90,v58
 v_mov_b32 v91,v59
 v_mov_b32 v92,v60
 v_mov_b32 v93,v61
 v_mov_b32 v94,v62
 v_mov_b32 v95,v63
 s_branch K2_ODD
.p2align 6
K2_LOOP:
 v_mfma_f32_16x16x32_bf16 v[64:67],a[64:67],a[0:3],v[24:27]
 ds_read_b128 a[116:119],v1 offset:46080
 v_mfma_f32_16x16x32_bf16 v[64:67],a[68:71],a[4:7],v[64:67]
 v_exp_f32 v54,v54
 v_mfma_f32_16x16x32_bf16 v[64:67],a[72:75],a[8:11],v[64:67]
 ds_read_b128 a[120:123],v1 offset:47104
 v_mfma_f32_16x16x32_bf16 v[64:67],a[76:79],a[12:15],v[64:67]
 v_exp_f32 v55,v55
 v_mfma_f32_16x16x32_bf16 v[80:83],a[64:67],a[32:35],v[28:31]
 ds_read_b128 a[124:127],v1 offset:48128
 v_mfma_f32_16x16x32_bf16 v[80:83],a[68:71],a[36:39],v[80:83]
 v_exp_f32 v40,v40
 v_mfma_f32_16x16x32_bf16 v[80:83],a[72:75],a[40:43],v[80:83]
 ds_read_b128 a[128:131],v1 offset:49152
 v_add_f32 v7,v7,v54
 v_mfma_f32_16x16x32_bf16 v[80:83],a[76:79],a[44:47],v[80:83]
 v_exp_f32 v41,v41
 v_mfma_f32_16x16x32_bf16 v[64:67],a[80:83],a[16:19],v[64:67]
 ds_read_b128 a[132:135],v1 offset:50176
 v_add_f32 v7,v7,v55
 v_mfma_f32_16x16x32_bf16 v[64:67],a[84:87],a[20:23],v[64:67]
 v_cvt_pk_bf16_f32 v51,v54,v55
 v_mfma_f32_16x16x32_bf16 v[64:67],a[88:91],a[24:27],v[64:67]
 v_exp_f32 v56,v56
 v_mfma_f32_16x16x32_bf16 v[64:67],a[92:95],a[28:31],v[64:67]
 ds_read_b128 a[136:139],v1 offset:51200
 v_add_f32 v6,v6,v40
 v_mfma_f32_16x16x32_bf16 v[80:83],a[80:83],a[48:51],v[80:83]
 v_exp_f32 v57,v57
 v_mfma_f32_16x16x32_bf16 v[80:83],a[84:87],a[52:55],v[80:83]
 ds_read_b128 a[140:143],v1 offset:52224
 v_add_f32 v6,v6,v41
 v_mfma_f32_16x16x32_bf16 v[80:83],a[88:91],a[56:59],v[80:83]
 ds_read_b128 a[144:147],v1 offset:53248
 v_cvt_pk_bf16_f32 v40,v40,v41
 v_mfma_f32_16x16x32_bf16 v[80:83],a[92:95],a[60:63],v[80:83]
 s_waitcnt lgkmcnt(5)
 v_mfma_f32_16x16x32_bf16 v[68:71],a[96:99],a[0:3],v[24:27]
 v_exp_f32 v42,v42
 v_mfma_f32_16x16x32_bf16 v[68:71],a[100:103],a[4:7],v[68:71]
 ds_read_b128 a[148:151],v1 offset:54272
 v_add_f32 v7,v7,v56
 v_mfma_f32_16x16x32_bf16 v[68:71],a[104:107],a[8:11],v[68:71]
 v_exp_f32 v43,v43
 v_mfma_f32_16x16x32_bf16 v[68:71],a[108:111],a[12:15],v[68:71]
 v_add_f32 v7,v7,v57
 v_cvt_pk_bf16_f32 v56,v56,v57
 v_mfma_f32_16x16x32_bf16 v[84:87],a[96:99],a[32:35],v[28:31]
 ds_read_b128 a[152:155],v1 offset:55296
 ds_read_b128 a[156:159],v1 offset:56320
 v_mfma_f32_16x16x32_bf16 v[84:87],a[100:103],a[36:39],v[84:87]
 v_exp_f32 v58,v58
 v_mfma_f32_16x16x32_bf16 v[84:87],a[104:107],a[40:43],v[84:87]
 v_add_f32 v6,v6,v42
 v_max3_f32 v8,v64,v65,v66
 v_mfma_f32_16x16x32_bf16 v[84:87],a[108:111],a[44:47],v[84:87]
 v_exp_f32 v59,v59
 v_mfma_f32_16x16x32_bf16 v[68:71],a[112:115],a[16:19],v[68:71]
 v_max3_f32 v9,v80,v81,v82
 v_add_f32 v6,v6,v43
 v_mfma_f32_16x16x32_bf16 v[68:71],a[116:119],a[20:23],v[68:71]
 ds_read_b128 a[160:163],v1 offset:57344
 v_cvt_pk_bf16_f32 v41,v42,v43
 v_mfma_f32_16x16x32_bf16 v[68:71],a[120:123],a[24:27],v[68:71]
 v_exp_f32 v44,v44
 v_mfma_f32_16x16x32_bf16 v[68:71],a[124:127],a[28:31],v[68:71]
 ds_read_b128 a[164:167],v1 offset:58368
 v_add_f32 v7,v7,v58
 v_mfma_f32_16x16x32_bf16 v[84:87],a[112:115],a[48:51],v[84:87]
 v_exp_f32 v45,v45
 v_mfma_f32_16x16x32_bf16 v[84:87],a[116:119],a[52:55],v[84:87]
 ds_read_b128 a[168:171],v1 offset:59392
 v_add_f32 v7,v7,v59
 v_mfma_f32_16x16x32_bf16 v[84:87],a[120:123],a[56:59],v[84:87]
 ds_read_b128 a[172:175],v1 offset:60416
 v_cvt_pk_bf16_f32 v57,v58,v59
 v_mfma_f32_16x16x32_bf16 v[84:87],a[124:127],a[60:63],v[84:87]
 s_waitcnt lgkmcnt(4)
 ds_read_b128 a[176:179],v1 offset:61440
 v_mfma_f32_16x16x32_bf16 v[72:75],a[128:131],a[0:3],v[24:27]
 v_exp_f32 v60,v60
 v_mfma_f32_16x16x32_bf16 v[72:75],a[132:135],a[4:7],v[72:75]
 ds_read_b128 a[180:183],v1 offset:62464
 v_add_f32 v6,v6,v44
 v_mfma_f32_16x16x32_bf16 v[72:75],a[136:139],a[8:11],v[72:75]
 v_exp_f32 v61,v61
 v_mfma_f32_16x16x32_bf16 v[72:75],a[140:143],a[12:15],v[72:75]
 v_add_f32 v6,v6,v45
 v_cvt_pk_bf16_f32 v42,v44,v45
 v_mfma_f32_16x16x32_bf16 v[88:91],a[128:131],a[32:35],v[28:31]
 v_exp_f32 v46,v46
 v_mfma_f32_16x16x32_bf16 v[88:91],a[132:135],a[36:39],v[88:91]
 v_readlane_b32 s32,v252,s38
 v_mfma_f32_16x16x32_bf16 v[88:91],a[136:139],a[40:43],v[88:91]
 ds_read_b128 a[184:187],v1 offset:63488
 v_add_f32 v7,v7,v60
 v_mfma_f32_16x16x32_bf16 v[88:91],a[140:143],a[44:47],v[88:91]
 v_exp_f32 v47,v47
 v_mfma_f32_16x16x32_bf16 v[72:75],a[144:147],a[16:19],v[72:75]
 ds_read_b128 a[188:191],v1 offset:64512
 v_add_f32 v7,v7,v61
 v_mfma_f32_16x16x32_bf16 v[72:75],a[148:151],a[20:23],v[72:75]
 v_cvt_pk_bf16_f32 v58,v60,v61
 v_max3_f32 v8,v8,v67,v68
 v_mfma_f32_16x16x32_bf16 v[72:75],a[152:155],a[24:27],v[72:75]
 v_max3_f32 v9,v9,v83,v84
 v_max3_f32 v8,v8,v69,v70
 v_mfma_f32_16x16x32_bf16 v[72:75],a[156:159],a[28:31],v[72:75]
 v_max3_f32 v9,v9,v85,v86
 v_mfma_f32_16x16x32_bf16 v[88:91],a[144:147],a[48:51],v[88:91]
 v_exp_f32 v62,v62
 v_mfma_f32_16x16x32_bf16 v[88:91],a[148:151],a[52:55],v[88:91]
 s_waitcnt vmcnt(0) lgkmcnt(0)
 s_barrier
 v_mfma_f32_16x16x32_bf16 v[88:91],a[152:155],a[56:59],v[88:91]
 ds_read_b128 a[64:67],v2 offset:0
 v_add_f32 v6,v6,v46
 v_mfma_f32_16x16x32_bf16 v[88:91],a[156:159],a[60:63],v[88:91]
 v_exp_f32 v63,v63
 v_mfma_f32_16x16x32_bf16 v[76:79],a[160:163],a[0:3],v[24:27]
 v_add_f32 v6,v6,v47
 v_cvt_pk_bf16_f32 v43,v46,v47
 v_mfma_f32_16x16x32_bf16 v[76:79],a[164:167],a[4:7],v[76:79]
 v_add_f32 v7,v7,v62
 v_add_f32 v7,v7,v63
 v_mfma_f32_16x16x32_bf16 v[76:79],a[168:171],a[8:11],v[76:79]
 ds_read_b128 a[68:71],v2 offset:1024
 v_cvt_pk_bf16_f32 v59,v62,v63
 v_mfma_f32_16x16x32_bf16 v[76:79],a[172:175],a[12:15],v[76:79]
 ds_read_b128 a[72:75],v2 offset:2048
 ds_read_b128 a[76:79],v2 offset:3072
 v_mfma_f32_16x16x32_bf16 v[92:95],a[160:163],a[32:35],v[28:31]
 s_add_u32 m0,s51,98304
 ds_read_b128 a[80:83],v2 offset:4096
 v_mfma_f32_16x16x32_bf16 v[92:95],a[164:167],a[36:39],v[92:95]
 ds_read_b128 a[84:87],v2 offset:5120
 ds_read_b128 a[88:91],v2 offset:6144
 v_mfma_f32_16x16x32_bf16 v[92:95],a[168:171],a[40:43],v[92:95]
 buffer_load_dwordx4 v14,s[28:31],s33 offen offset:0 sc1 lds
 v_mfma_f32_16x16x32_bf16 v[92:95],a[172:175],a[44:47],v[92:95]
 ds_read_b128 a[92:95],v2 offset:7168
 v_max3_f32 v8,v8,v71,v72
 v_mfma_f32_16x16x32_bf16 v[76:79],a[176:179],a[16:19],v[76:79]
 v_max3_f32 v9,v9,v87,v88
 v_max3_f32 v8,v8,v73,v74
 v_mfma_f32_16x16x32_bf16 v[76:79],a[180:183],a[20:23],v[76:79]
 ds_read_b128 a[96:99],v2 offset:8192
 v_max3_f32 v9,v9,v89,v90
 v_mfma_f32_16x16x32_bf16 v[76:79],a[184:187],a[24:27],v[76:79]
 buffer_load_dwordx4 v14,s[28:31],s33 offen offset:1024 sc1 lds
 v_mfma_f32_16x16x32_bf16 v[76:79],a[188:191],a[28:31],v[76:79]
 ds_read_b128 a[100:103],v2 offset:9216
 ds_read_b128 a[104:107],v2 offset:10240
 v_mfma_f32_16x16x32_bf16 v[92:95],a[176:179],a[48:51],v[92:95]
 buffer_load_dwordx4 v14,s[28:31],s33 offen offset:2048 sc1 lds
 v_mfma_f32_16x16x32_bf16 v[92:95],a[180:183],a[52:55],v[92:95]
 ds_read_b128 a[108:111],v2 offset:11264
 v_mfma_f32_16x16x32_bf16 v[92:95],a[184:187],a[56:59],v[92:95]
 buffer_load_dwordx4 v14,s[28:31],s33 offen offset:3072 sc1 lds
 v_mfma_f32_16x16x32_bf16 v[92:95],a[188:191],a[60:63],v[92:95]
 s_waitcnt lgkmcnt(4)
 ds_read_b128 a[112:115],v2 offset:12288
 v_mfma_f32_16x16x32_bf16 v[96:99],a[64:67],v[32:35],v[96:99]
 s_add_u32 m0,s51,102400
 v_max3_f32 v8,v8,v75,v76
 v_mfma_f32_16x16x32_bf16 v[96:99],a[68:71],v[40:43],v[96:99]
 ds_read_b128 a[116:119],v2 offset:13312
 v_max3_f32 v8,v8,v77,v78
 v_mfma_f32_16x16x32_bf16 v[160:163],a[64:67],v[48:51],v[160:163]
 ds_read_b128 a[120:123],v2 offset:14336
 v_max3_f32 v9,v9,v91,v92
 v_mfma_f32_16x16x32_bf16 v[160:163],a[68:71],v[56:59],v[160:163]
 v_max3_f32 v9,v9,v93,v94
 v_mfma_f32_16x16x32_bf16 v[100:103],a[72:75],v[32:35],v[100:103]
 ds_read_b128 a[124:127],v2 offset:15360
 v_max3_f32 v16,v8,v79,v95
 v_mfma_f32_16x16x32_bf16 v[100:103],a[76:79],v[40:43],v[100:103]
 v_max_f32 v16,v16,v9
 v_mfma_f32_16x16x32_bf16 v[164:167],a[72:75],v[48:51],v[164:167]
 ds_read_b128 a[128:131],v2 offset:16384
 v_cmp_lt_f32 vcc,s49,v16
 v_mfma_f32_16x16x32_bf16 v[164:167],a[76:79],v[56:59],v[164:167]
 buffer_load_dwordx4 v15,s[28:31],s33 offen offset:0 sc1 lds
 v_mfma_f32_16x16x32_bf16 v[104:107],a[80:83],v[32:35],v[104:107]
 s_cmp_eq_u32 s53,s38
 s_cbranch_scc1 VCH_22
VCH_22R:
 v_mfma_f32_16x16x32_bf16 v[104:107],a[84:87],v[40:43],v[104:107]
 s_cbranch_vccnz RESC_25
RESCR_26:
 ds_read_b128 a[132:135],v2 offset:17408
 v_mfma_f32_16x16x32_bf16 v[168:171],a[80:83],v[48:51],v[168:171]
 buffer_load_dwordx4 v15,s[28:31],s33 offen offset:1024 sc1 lds
 v_mfma_f32_16x16x32_bf16 v[168:171],a[84:87],v[56:59],v[168:171]
 buffer_load_dwordx4 v15,s[28:31],s33 offen offset:2048 sc1 lds
 v_mfma_f32_16x16x32_bf16 v[108:111],a[88:91],v[32:35],v[108:111]
 ds_read_b128 a[136:139],v2 offset:18432
 ds_read_b128 a[140:143],v2 offset:19456
 v_mfma_f32_16x16x32_bf16 v[108:111],a[92:95],v[40:43],v[108:111]
 buffer_load_dwordx4 v15,s[28:31],s33 offen offset:3072 sc1 lds
 v_mfma_f32_16x16x32_bf16 v[172:175],a[88:91],v[48:51],v[172:175]
 v_exp_f32 v64,v64
 v_mfma_f32_16x16x32_bf16 v[172:175],a[92:95],v[56:59],v[172:175]
 s_waitcnt lgkmcnt(4)
 ds_read_b128 a[144:147],v2 offset:20480
 v_mfma_f32_16x16x32_bf16 v[112:115],a[96:99],v[32:35],v[112:115]
 s_add_u32 m0,s51,32768
 ds_read_b128 a[148:151],v2 offset:21504
 v_mfma_f32_16x16x32_bf16 v[112:115],a[100:103],v[40:43],v[112:115]
 v_exp_f32 v65,v65
 v_mfma_f32_16x16x32_bf16 v[176:179],a[96:99],v[48:51],v[176:179]
 v_exp_f32 v80,v80
 v_mfma_f32_16x16x32_bf16 v[176:179],a[100:103],v[56:59],v[176:179]
 buffer_load_dwordx4 v14,s[28:31],s32 offen offset:0 sc1 lds
 v_mfma_f32_16x16x32_bf16 v[116:119],a[104:107],v[32:35],v[116:119]
 ds_read_b128 a[152:155],v2 offset:22528
 v_add_f32 v6,v6,v64
 v_mfma_f32_16x16x32_bf16 v[116:119],a[108:111],v[40:43],v[116:119]
 v_exp_f32 v81,v81
 v_mfma_f32_16x16x32_bf16 v[180:183],a[104:107],v[48:51],v[180:183]
 ds_read_b128 a[156:159],v2 offset:23552
 v_add_f32 v6,v6,v65
 v_mfma_f32_16x16x32_bf16 v[180:183],a[108:111],v[56:59],v[180:183]
 buffer_load_dwordx4 v14,s[28:31],s32 offen offset:1024 sc1 lds
 v_mfma_f32_16x16x32_bf16 v[120:123],a[112:115],v[32:35],v[120:123]
 ds_read_b128 a[160:163],v2 offset:24576
 v_cvt_pk_bf16_f32 v64,v64,v65
 v_mfma_f32_16x16x32_bf16 v[120:123],a[116:119],v[40:43],v[120:123]
 v_exp_f32 v66,v66
 v_mfma_f32_16x16x32_bf16 v[184:187],a[112:115],v[48:51],v[184:187]
 buffer_load_dwordx4 v14,s[28:31],s32 offen offset:2048 sc1 lds
 v_mfma_f32_16x16x32_bf16 v[184:187],a[116:119],v[56:59],v[184:187]
 ds_read_b128 a[164:167],v2 offset:25600
 v_add_f32 v7,v7,v80
 v_mfma_f32_16x16x32_bf16 v[124:127],a[120:123],v[32:35],v[124:127]
 v_exp_f32 v67,v67
 v_mfma_f32_16x16x32_bf16 v[124:127],a[124:127],v[40:43],v[124:127]
 buffer_load_dwordx4 v14,s[28:31],s32 offen offset:3072 sc1 lds
 v_mfma_f32_16x16x32_bf16 v[188:191],a[120:123],v[48:51],v[188:191]
 ds_read_b128 a[168:171],v2 offset:26624
 v_add_f32 v7,v7,v81
 v_mfma_f32_16x16x32_bf16 v[188:191],a[124:127],v[56:59],v[188:191]
 s_waitcnt lgkmcnt(3)
 v_cvt_pk_bf16_f32 v80,v80,v81
 v_mfma_f32_16x16x32_bf16 v[128:131],a[128:131],v[32:35],v[128:131]
 ds_read_b128 a[172:175],v2 offset:27648
 s_add_u32 m0,s51,36864
 v_mfma_f32_16x16x32_bf16 v[128:131],a[132:135],v[40:43],v[128:131]
 v_exp_f32 v82,v82
 v_mfma_f32_16x16x32_bf16 v[192:195],a[128:131],v[48:51],v[192:195]
 ds_read_b128 a[176:179],v2 offset:28672
 v_add_f32 v6,v6,v66
 v_mfma_f32_16x16x32_bf16 v[192:195],a[132:135],v[56:59],v[192:195]
 buffer_load_dwordx4 v15,s[28:31],s32 offen offset:0 sc1 lds
 v_mfma_f32_16x16x32_bf16 v[132:135],a[136:139],v[32:35],v[132:135]
 ds_read_b128 a[180:183],v2 offset:29696
 ds_read_b128 a[184:187],v2 offset:30720
 v_mfma_f32_16x16x32_bf16 v[132:135],a[140:143],v[40:43],v[132:135]
 v_exp_f32 v83,v83
 v_mfma_f32_16x16x32_bf16 v[196:199],a[136:139],v[48:51],v[196:199]
 v_add_f32 v6,v6,v67
 v_cvt_pk_bf16_f32 v65,v66,v67
 v_mfma_f32_16x16x32_bf16 v[196:199],a[140:143],v[56:59],v[196:199]
 buffer_load_dwordx4 v15,s[28:31],s32 offen offset:1024 sc1 lds
 v_mfma_f32_16x16x32_bf16 v[136:139],a[144:147],v[32:35],v[136:139]
 ds_read_b128 a[188:191],v2 offset:31744
 ds_read_b128 a[64:67],v1 offset:0
 v_mfma_f32_16x16x32_bf16 v[136:139],a[148:151],v[40:43],v[136:139]
 v_exp_f32 v68,v68
 v_mfma_f32_16x16x32_bf16 v[200:203],a[144:147],v[48:51],v[200:203]
 ds_read_b128 a[68:71],v1 offset:1024
 v_add_f32 v7,v7,v82
 v_mfma_f32_16x16x32_bf16 v[200:203],a[148:151],v[56:59],v[200:203]
 buffer_load_dwordx4 v15,s[28:31],s32 offen offset:2048 sc1 lds
 v_mfma_f32_16x16x32_bf16 v[140:143],a[152:155],v[32:35],v[140:143]
 v_exp_f32 v69,v69
 v_mfma_f32_16x16x32_bf16 v[140:143],a[156:159],v[40:43],v[140:143]
 v_add_f32 v7,v7,v83
 v_cvt_pk_bf16_f32 v81,v82,v83
 v_mfma_f32_16x16x32_bf16 v[204:207],a[152:155],v[48:51],v[204:207]
 ds_read_b128 a[72:75],v1 offset:2048
 ds_read_b128 a[76:79],v1 offset:3072
 v_mfma_f32_16x16x32_bf16 v[204:207],a[156:159],v[56:59],v[204:207]
 s_waitcnt lgkmcnt(4)
 buffer_load_dwordx4 v15,s[28:31],s32 offen offset:3072 sc1 lds
 v_mfma_f32_16x16x32_bf16 v[144:147],a[160:163],v[32:35],v[144:147]
 v_exp_f32 v84,v84
 v_mfma_f32_16x16x32_bf16 v[144:147],a[164:167],v[40:43],v[144:147]
 ds_read_b128 a[80:83],v1 offset:4096
 v_add_f32 v6,v6,v68
 v_mfma_f32_16x16x32_bf16 v[208:211],a[160:163],v[48:51],v[208:211]
 v_exp_f32 v85,v85
 v_mfma_f32_16x16x32_bf16 v[208:211],a[164:167],v[56:59],v[208:211]
 v_add_f32 v6,v6,v69
 v_cvt_pk_bf16_f32 v66,v68,v69
 v_mfma_f32_16x16x32_bf16 v[148:151],a[168:171],v[32:35],v[148:151]
 ds_read_b128 a[84:87],v1 offset:5120
 ds_read_b128 a[88:91],v1 offset:6144
 v_mfma_f32_16x16x32_bf16 v[148:151],a[172:175],v[40:43],v[148:151]
 v_exp_f32 v70,v70
 v_mfma_f32_16x16x32_bf16 v[212:215],a[168:171],v[48:51],v[212:215]
 ds_read_b128 a[92:95],v1 offset:7168
 v_add_f32 v7,v7,v84
 v_mfma_f32_16x16x32_bf16 v[212:215],a[172:175],v[56:59],v[212:215]
 v_readlane_b32 s33,v253,s38
 v_mfma_f32_16x16x32_bf16 v[152:155],a[176:179],v[32:35],v[152:155]
 v_exp_f32 v71,v71
 v_mfma_f32_16x16x32_bf16 v[152:155],a[180:183],v[40:43],v[152:155]
 v_add_f32 v7,v7,v85
 v_cvt_pk_bf16_f32 v82,v84,v85
 v_mfma_f32_16x16x32_bf16 v[216:219],a[176:179],v[48:51],v[216:219]
 ds_read_b128 a[96:99],v1 offset:8192
 v_add_f32 v6,v6,v70
 v_mfma_f32_16x16x32_bf16 v[216:219],a[180:183],v[56:59],v[216:219]
 s_sub_u32 s38,s38,1
 ds_read_b128 a[100:103],v1 offset:9216
 v_mfma_f32_16x16x32_bf16 v[156:159],a[184:187],v[32:35],v[156:159]
 v_add_f32 v6,v6,v71
 v_cvt_pk_bf16_f32 v67,v70,v71
 v_mfma_f32_16x16x32_bf16 v[156:159],a[188:191],v[40:43],v[156:159]
 s_cmp_eq_u32 s38,0
 ds_read_b128 a[104:107],v1 offset:10240
 v_mfma_f32_16x16x32_bf16 v[220:223],a[184:187],v[48:51],v[220:223]
 ds_read_b128 a[108:111],v1 offset:11264
 ds_read_b128 a[112:115],v1 offset:12288
 v_mfma_f32_16x16x32_bf16 v[220:223],a[188:191],v[56:59],v[220:223]
 s_waitcnt lgkmcnt(5)
 s_cbranch_vccnz RESO_27
RESOR_28:
 s_cbranch_scc1 K2_LASTU
K2_ODD:
 s_cmp_eq_u32 s53,s38
 s_cbranch_scc1 VCH_29
VCH_29R:
 v_mfma_f32_16x16x32_bf16 v[32:35],a[64:67],a[0:3],v[24:27]
 ds_read_b128 a[116:119],v1 offset:13312
 v_mfma_f32_16x16x32_bf16 v[32:35],a[68:71],a[4:7],v[32:35]
 v_exp_f32 v86,v86
 v_mfma_f32_16x16x32_bf16 v[32:35],a[72:75],a[8:11],v[32:35]
 ds_read_b128 a[120:123],v1 offset:14336
 v_mfma_f32_16x16x32_bf16 v[32:35],a[76:79],a[12:15],v[32:35]
 v_exp_f32 v87,v87
 v_mfma_f32_16x16x32_bf16 v[48:51],a[64:67],a[32:35],v[28:31]
 ds_read_b128 a[124:127],v1 offset:15360
 v_mfma_f32_16x16x32_bf16 v[48:51],a[68:71],a[36:39],v[48:51]
 v_exp_f32 v72,v72
 v_mfma_f32_16x16x32_bf16 v[48:51],a[72:75],a[40:43],v[48:51]
 ds_read_b128 a[128:131],v1 offset:16384
 v_add_f32 v7,v7,v86
 v_mfma_f32_16x16x32_bf16 v[48:51],a[76:79],a[44:47],v[48:51]
 v_exp_f32 v73,v73
 v_mfma_f32_16x16x32_bf16 v[32:35],a[80:83],a[16:19],v[32:35]
 ds_read_b128 a[132:135],v1 offset:17408
 v_add_f32 v7,v7,v87
 v_mfma_f32_16x16x32_bf16 v[32:35],a[84:87],a[20:23],v[32:35]
 v_cvt_pk_bf16_f32 v83,v86,v87
 v_mfma_f32_16x16x32_bf16 v[32:35],a[88:91],a[24:27],v[32:35]
 v_exp_f32 v88,v88
 v_mfma_f32_16x16x32_bf16 v[32:35],a[92:95],a[28:31],v[32:35]
 ds_read_b128 a[136:139],v1 offset:18432
 v_add_f32 v6,v6,v72
 v_mfma_f32_16x16x32_bf16 v[48:51],a[80:83],a[48:51],v[48:51]
 v_exp_f32 v89,v89
 v_mfma_f32_16x16x32_bf16 v[48:51],a[84:87],a[52:55],v[48:51]
 ds_read_b128 a[140:143],v1 offset:19456
 v_add_f32 v6,v6,v73
 v_mfma_f32_16x16x32_bf16 v[48:51],a[88:91],a[56:59],v[48:51]
 ds_read_b128 a[144:147],v1 offset:20480
 v_cvt_pk_bf16_f32 v72,v72,v73
 v_mfma_f32_16x16x32_bf16 v[48:51],a[92:95],a[60:63],v[48:51]
 s_waitcnt lgkmcnt(5)
 v_mfma_f32_16x16x32_bf16 v[36:39],a[96:99],a[0:3],v[24:27]
 v_exp_f32 v74,v74
 v_mfma_f32_16x16x32_bf16 v[36:39],a[100:103],a[4:7],v[36:39]
 ds_read_b128 a[148:151],v1 offset:21504
 v_add_f32 v7,v7,v88
 v_mfma_f32_16x16x32_bf16 v[36:39],a[104:107],a[8:11],v[36:39]
 v_exp_f32 v75,v75
 v_mfma_f32_16x16x32_bf16 v[36:39],a[108:111],a[12:15],v[36:39]
 v_add_f32 v7,v7,v89
 v_cvt_pk_bf16_f32 v88,v88,v89
 v_mfma_f32_16x16x32_bf16 v[52:55],a[96:99],a[32:35],v[28:31]
 ds_read_b128 a[152:155],v1 offset:22528
 ds_read_b128 a[156:159],v1 offset:23552
 v_mfma_f32_16x16x32_bf16 v[52:55],a[100:103],a[36:39],v[52:55]
 v_exp_f32 v90,v90
 v_mfma_f32_16x16x32_bf16 v[52:55],a[104:107],a[40:43],v[52:55]
 v_add_f32 v6,v6,v74
 v_max3_f32 v8,v32,v33,v34
 v_mfma_f32_16x16x32_bf16 v[52:55],a[108:111],a[44:47],v[52:55]
 v_exp_f32 v91,v91
 v_mfma_f32_16x16x32_bf16 v[36:39],a[112:115],a[16:19],v[36:39]
 v_max3_f32 v9,v48,v49,v50
 v_add_f32 v6,v6,v75
 v_mfma_f32_16x16x32_bf16 v[36:39],a[116:119],a[20:23],v[36:39]
 ds_read_b128 a[160:163],v1 offset:24576
 v_cvt_pk_bf16_f32 v73,v74,v75
 v_mfma_f32_16x16x32_bf16 v[36:39],a[120:123],a[24:27],v[36:39]
 v_exp_f32 v76,v76
 v_mfma_f32_16x16x32_bf16 v[36:39],a[124:127],a[28:31],v[36:39]
 ds_read_b128 a[164:167],v1 offset:25600
 v_add_f32 v7,v7,v90
 v_mfma_f32_16x16x32_bf16 v[52:55],a[112:115],a[48:51],v[52:55]
 v_exp_f32 v77,v77
 v_mfma_f32_16x16x32_bf16 v[52:55],a[116:119],a[52:55],v[52:55]
 ds_read_b128 a[168:171],v1 offset:26624
 v_add_f32 v7,v7,v91
 v_mfma_f32_16x16x32_bf16 v[52:55],a[120:123],a[56:59],v[52:55]
 ds_read_b128 a[172:175],v1 offset:27648
 v_cvt_pk_bf16_f32 v89,v90,v91
 v_mfma_f32_16x16x32_bf16 v[52:55],a[124:127],a[60:63],v[52:55]
 s_waitcnt lgkmcnt(4)
 ds_read_b128 a[176:179],v1 offset:28672
 v_mfma_f32_16x16x32_bf16 v[40:43],a[128:131],a[0:3],v[24:27]
 v_exp_f32 v92,v92
 v_mfma_f32_16x16x32_bf16 v[40:43],a[132:135],a[4:7],v[40:43]
 ds_read_b128 a[180:183],v1 offset:29696
 v_add_f32 v6,v6,v76
 v_mfma_f32_16x16x32_bf16 v[40:43],a[136:139],a[8:11],v[40:43]
 v_exp_f32 v93,v93
 v_mfma_f32_16x16x32_bf16 v[40:43],a[140:143],a[12:15],v[40:43]
 v_add_f32 v6,v6,v77
 v_cvt_pk_bf16_f32 v74,v76,v77
 v_mfma_f32_16x16x32_bf16 v[56:59],a[128:131],a[32:35],v[28:31]
 v_exp_f32 v78,v78
 v_mfma_f32_16x16x32_bf16 v[56:59],a[132:135],a[36:39],v[56:59]
 v_readlane_b32 s32,v252,s38
 v_mfma_f32_16x16x32_bf16 v[56:59],a[136:139],a[40:43],v[56:59]
 ds_read_b128 a[184:187],v1 offset:30720
 v_add_f32 v7,v7,v92
 v_mfma_f32_16x16x32_bf16 v[56:59],a[140:143],a[44:47],v[56:59]
 v_exp_f32 v79,v79
 v_mfma_f32_16x16x32_bf16 v[40:43],a[144:147],a[16:19],v[40:43]
 ds_read_b128 a[188:191],v1 offset:31744
 v_add_f32 v7,v7,v93
 v_mfma_f32_16x16x32_bf16 v[40:43],a[148:151],a[20:23],v[40:43]
 v_cvt_pk_bf16_f32 v90,v92,v93
 v_max3_f32 v8,v8,v35,v36
 v_mfma_f32_16x16x32_bf16 v[40:43],a[152:155],a[24:27],v[40:43]
 v_max3_f32 v9,v9,v51,v52
 v_max3_f32 v8,v8,v37,v38
 v_mfma_f32_16x16x32_bf16 v[40:43],a[156:159],a[28:31],v[40:43]
 v_max3_f32 v9,v9,v53,v54
 v_mfma_f32_16x16x32_bf16 v[56:59],a[144:147],a[48:51],v[56:59]
 v_exp_f32 v94,v94
 v_mfma_f32_16x16x32_bf16 v[56:59],a[148:151],a[52:55],v[56:59]
 s_waitcnt vmcnt(0) lgkmcnt(0)
 s_barrier
 v_mfma_f32_16x16x32_bf16 v[56:59],a[152:155],a[56:59],v[56:59]
 ds_read_b128 a[64:67],v2 offset:32768
 v_add_f32 v6,v6,v78
 v_mfma_f32_16x16x32_bf16 v[56:59],a[156:159],a[60:63],v[56:59]
 v_exp_f32 v95,v95
 v_mfma_f32_16x16x32_bf16 v[44:47],a[160:163],a[0:3],v[24:27]
 v_add_f32 v6,v6,v79
 v_cvt_pk_bf16_f32 v75,v78,v79
 v_mfma_f32_16x16x32_bf16 v[44:47],a[164:167],a[4:7],v[44:47]
 v_add_f32 v7,v7,v94
 v_add_f32 v7,v7,v95
 v_mfma_f32_16x16x32_bf16 v[44:47],a[168:171],a[8:11],v[44:47]
 ds_read_b128 a[68:71],v2 offset:33792
 v_cvt_pk_bf16_f32 v91,v94,v95
 v_mfma_f32_16x16x32_bf16 v[44:47],a[172:175],a[12:15],v[44:47]
 ds_read_b128 a[72:75],v2 offset:34816
 ds_read_b128 a[76:79],v2 offset:35840
 v_mfma_f32_16x16x32_bf16 v[60:63],a[160:163],a[32:35],v[28:31]
 s_add_u32 m0,s51,65536
 ds_read_b128 a[80:83],v2 offset:36864
 v_mfma_f32_16x16x32_bf16 v[60:63],a[164:167],a[36:39],v[60:63]
 ds_read_b128 a[84:87],v2 offset:37888
 ds_read_b128 a[88:91],v2 offset:38912
 v_mfma_f32_16x16x32_bf16 v[60:63],a[168:171],a[40:43],v[60:63]
 buffer_load_dwordx4 v14,s[28:31],s33 offen offset:0 sc1 lds
 v_mfma_f32_16x16x32_bf16 v[60:63],a[172:175],a[44:47],v[60:63]
 ds_read_b128 a[92:95],v2 offset:39936
 v_max3_f32 v8,v8,v39,v40
 v_mfma_f32_16x16x32_bf16 v[44:47],a[176:179],a[16:19],v[44:47]
 v_max3_f32 v9,v9,v55,v56
 v_max3_f32 v8,v8,v41,v42
 v_mfma_f32_16x16x32_bf16 v[44:47],a[180:183],a[20:23],v[44:47]
 ds_read_b128 a[96:99],v2 offset:40960
 v_max3_f32 v9,v9,v57,v58
 v_mfma_f32_16x16x32_bf16 v[44:47],a[184:187],a[24:27],v[44:47]
 buffer_load_dwordx4 v14,s[28:31],s33 offen offset:1024 sc1 lds
 v_mfma_f32_16x16x32_bf16 v[44:47],a[188:191],a[28:31],v[44:47]
 ds_read_b128 a[100:103],v2 offset:41984
 ds_read_b128 a[104:107],v2 offset:43008
 v_mfma_f32_16x16x32_bf16 v[60:63],a[176:179],a[48:51],v[60:63]
 buffer_load_dwordx4 v14,s[28:31],s33 offen offset:2048 sc1 lds
 v_mfma_f32_16x16x32_bf16 v[60:63],a[180:183],a[52:55],v[60:63]
 ds_read_b128 a[108:111],v2 offset:44032
 v_mfma_f32_16x16x32_bf16 v[60:63],a[184:187],a[56:59],v[60:63]
 buffer_load_dwordx4 v14,s[28:31],s33 offen offset:3072 sc1 lds
 v_mfma_f32_16x16x32_bf16 v[60:63],a[188:191],a[60:63],v[60:63]
 s_waitcnt lgkmcnt(4)
 ds_read_b128 a[112:115],v2 offset:45056
 v_mfma_f32_16x16x32_bf16 v[96:99],a[64:67],v[64:67],v[96:99]
 s_add_u32 m0,s51,69632
 v_max3_f32 v8,v8,v43,v44
 v_mfma_f32_16x16x32_bf16 v[96:99],a[68:71],v[72:75],v[96:99]
 ds_read_b128 a[116:119],v2 offset:46080
 v_max3_f32 v8,v8,v45,v46
 v_mfma_f32_16x16x32_bf16 v[160:163],a[64:67],v[80:83],v[160:163]
 ds_read_b128 a[120:123],v2 offset:47104
 v_max3_f32 v9,v9,v59,v60
 v_mfma_f32_16x16x32_bf16 v[160:163],a[68:71],v[88:91],v[160:163]
 v_max3_f32 v9,v9,v61,v62
 v_mfma_f32_16x16x32_bf16 v[100:103],a[72:75],v[64:67],v[100:103]
 ds_read_b128 a[124:127],v2 offset:48128
 v_max3_f32 v16,v8,v47,v63
 v_mfma_f32_16x16x32_bf16 v[100:103],a[76:79],v[72:75],v[100:103]
 v_max_f32 v16,v16,v9
 v_mfma_f32_16x16x32_bf16 v[164:167],a[72:75],v[80:83],v[164:167]
 ds_read_b128 a[128:131],v2 offset:49152
 v_cmp_lt_f32 vcc,s49,v16
 v_mfma_f32_16x16x32_bf16 v[164:167],a[76:79],v[88:91],v[164:167]
 buffer_load_dwordx4 v15,s[28:31],s33 offen offset:0 sc1 lds
 v_mfma_f32_16x16x32_bf16 v[104:107],a[80:83],v[64:67],v[104:107]
 s_cmp_eq_u32 s38,s40
 s_cbranch_scc1 MASK_30
MASKR_31:
 v_mfma_f32_16x16x32_bf16 v[104:107],a[84:87],v[72:75],v[104:107]
 s_cbranch_vccnz RESC_32
RESCR_33:
 ds_read_b128 a[132:135],v2 offset:50176
 v_mfma_f32_16x16x32_bf16 v[168:171],a[80:83],v[80:83],v[168:171]
 buffer_load_dwordx4 v15,s[28:31],s33 offen offset:1024 sc1 lds
 v_mfma_f32_16x16x32_bf16 v[168:171],a[84:87],v[88:91],v[168:171]
 buffer_load_dwordx4 v15,s[28:31],s33 offen offset:2048 sc1 lds
 v_mfma_f32_16x16x32_bf16 v[108:111],a[88:91],v[64:67],v[108:111]
 ds_read_b128 a[136:139],v2 offset:51200
 ds_read_b128 a[140:143],v2 offset:52224
 v_mfma_f32_16x16x32_bf16 v[108:111],a[92:95],v[72:75],v[108:111]
 buffer_load_dwordx4 v15,s[28:31],s33 offen offset:3072 sc1 lds
 v_mfma_f32_16x16x32_bf16 v[172:175],a[88:91],v[80:83],v[172:175]
 v_exp_f32 v32,v32
 v_mfma_f32_16x16x32_bf16 v[172:175],a[92:95],v[88:91],v[172:175]
 s_waitcnt lgkmcnt(4)
 ds_read_b128 a[144:147],v2 offset:53248
 v_mfma_f32_16x16x32_bf16 v[112:115],a[96:99],v[64:67],v[112:115]
 s_add_u32 m0,s51,0
 ds_read_b128 a[148:151],v2 offset:54272
 v_mfma_f32_16x16x32_bf16 v[112:115],a[100:103],v[72:75],v[112:115]
 v_exp_f32 v33,v33
 v_mfma_f32_16x16x32_bf16 v[176:179],a[96:99],v[80:83],v[176:179]
 v_exp_f32 v48,v48
 v_mfma_f32_16x16x32_bf16 v[176:179],a[100:103],v[88:91],v[176:179]
 buffer_load_dwordx4 v14,s[28:31],s32 offen offset:0 sc1 lds
 v_mfma_f32_16x16x32_bf16 v[116:119],a[104:107],v[64:67],v[116:119]
 ds_read_b128 a[152:155],v2 offset:55296
 v_add_f32 v6,v6,v32
 v_mfma_f32_16x16x32_bf16 v[116:119],a[108:111],v[72:75],v[116:119]
 v_exp_f32 v49,v49
 v_mfma_f32_16x16x32_bf16 v[180:183],a[104:107],v[80:83],v[180:183]
 ds_read_b128 a[156:159],v2 offset:56320
 v_add_f32 v6,v6,v33
 v_mfma_f32_16x16x32_bf16 v[180:183],a[108:111],v[88:91],v[180:183]
 buffer_load_dwordx4 v14,s[28:31],s32 offen offset:1024 sc1 lds
 v_mfma_f32_16x16x32_bf16 v[120:123],a[112:115],v[64:67],v[120:123]
 ds_read_b128 a[160:163],v2 offset:57344
 v_cvt_pk_bf16_f32 v32,v32,v33
 v_mfma_f32_16x16x32_bf16 v[120:123],a[116:119],v[72:75],v[120:123]
 v_exp_f32 v34,v34
 v_mfma_f32_16x16x32_bf16 v[184:187],a[112:115],v[80:83],v[184:187]
 buffer_load_dwordx4 v14,s[28:31],s32 offen offset:2048 sc1 lds
 v_mfma_f32_16x16x32_bf16 v[184:187],a[116:119],v[88:91],v[184:187]
 ds_read_b128 a[164:167],v2 offset:58368
 v_add_f32 v7,v7,v48
 v_mfma_f32_16x16x32_bf16 v[124:127],a[120:123],v[64:67],v[124:127]
 v_exp_f32 v35,v35
 v_mfma_f32_16x16x32_bf16 v[124:127],a[124:127],v[72:75],v[124:127]
 buffer_load_dwordx4 v14,s[28:31],s32 offen offset:3072 sc1 lds
 v_mfma_f32_16x16x32_bf16 v[188:191],a[120:123],v[80:83],v[188:191]
 ds_read_b128 a[168:171],v2 offset:59392
 v_add_f32 v7,v7,v49
 v_mfma_f32_16x16x32_bf16 v[188:191],a[124:127],v[88:91],v[188:191]
 s_waitcnt lgkmcnt(3)
 v_cvt_pk_bf16_f32 v48,v48,v49
 v_mfma_f32_16x16x32_bf16 v[128:131],a[128:131],v[64:67],v[128:131]
 ds_read_b128 a[172:175],v2 offset:60416
 s_add_u32 m0,s51,4096
 v_mfma_f32_16x16x32_bf16 v[128:131],a[132:135],v[72:75],v[128:131]
 v_exp_f32 v50,v50
 v_mfma_f32_16x16x32_bf16 v[192:195],a[128:131],v[80:83],v[192:195]
 ds_read_b128 a[176:179],v2 offset:61440
 v_add_f32 v6,v6,v34
 v_mfma_f32_16x16x32_bf16 v[192:195],a[132:135],v[88:91],v[192:195]
 buffer_load_dwordx4 v15,s[28:31],s32 offen offset:0 sc1 lds
 v_mfma_f32_16x16x32_bf16 v[132:135],a[136:139],v[64:67],v[132:135]
 ds_read_b128 a[180:183],v2 offset:62464
 ds_read_b128 a[184:187],v2 offset:63488
 v_mfma_f32_16x16x32_bf16 v[132:135],a[140:143],v[72:75],v[132:135]
 v_exp_f32 v51,v51
 v_mfma_f32_16x16x32_bf16 v[196:199],a[136:139],v[80:83],v[196:199]
 v_add_f32 v6,v6,v35
 v_cvt_pk_bf16_f32 v33,v34,v35
 v_mfma_f32_16x16x32_bf16 v[196:199],a[140:143],v[88:91],v[196:199]
 buffer_load_dwordx4 v15,s[28:31],s32 offen offset:1024 sc1 lds
 v_mfma_f32_16x16x32_bf16 v[136:139],a[144:147],v[64:67],v[136:139]
 ds_read_b128 a[188:191],v2 offset:64512
 ds_read_b128 a[64:67],v1 offset:32768
 v_mfma_f32_16x16x32_bf16 v[136:139],a[148:151],v[72:75],v[136:139]
 v_exp_f32 v36,v36
 v_mfma_f32_16x16x32_bf16 v[200:203],a[144:147],v[80:83],v[200:203]
 ds_read_b128 a[68:71],v1 offset:33792
 v_add_f32 v7,v7,v50
 v_mfma_f32_16x16x32_bf16 v[200:203],a[148:151],v[88:91],v[200:203]
 buffer_load_dwordx4 v15,s[28:31],s32 offen offset:2048 sc1 lds
 v_mfma_f32_16x16x32_bf16 v[140:143],a[152:155],v[64:67],v[140:143]
 v_exp_f32 v37,v37
 v_mfma_f32_16x16x32_bf16 v[140:143],a[156:159],v[72:75],v[140:143]
 v_add_f32 v7,v7,v51
 v_cvt_pk_bf16_f32 v49,v50,v51
 v_mfma_f32_16x16x32_bf16 v[204:207],a[152:155],v[80:83],v[204:207]
 ds_read_b128 a[72:75],v1 offset:34816
 ds_read_b128 a[76:79],v1 offset:35840
 v_mfma_f32_16x16x32_bf16 v[204:207],a[156:159],v[88:91],v[204:207]
 s_waitcnt lgkmcnt(4)
 buffer_load_dwordx4 v15,s[28:31],s32 offen offset:3072 sc1 lds
 v_mfma_f32_16x16x32_bf16 v[144:147],a[160:163],v[64:67],v[144:147]
 v_exp_f32 v52,v52
 v_mfma_f32_16x16x32_bf16 v[144:147],a[164:167],v[72:75],v[144:147]
 ds_read_b128 a[80:83],v1 offset:36864
 v_add_f32 v6,v6,v36
 v_mfma_f32_16x16x32_bf16 v[208:211],a[160:163],v[80:83],v[208:211]
 v_exp_f32 v53,v53
 v_mfma_f32_16x16x32_bf16 v[208:211],a[164:167],v[88:91],v[208:211]
 v_add_f32 v6,v6,v37
 v_cvt_pk_bf16_f32 v34,v36,v37
 v_mfma_f32_16x16x32_bf16 v[148:151],a[168:171],v[64:67],v[148:151]
 ds_read_b128 a[84:87],v1 offset:37888
 ds_read_b128 a[88:91],v1 offset:38912
 v_mfma_f32_16x16x32_bf16 v[148:151],a[172:175],v[72:75],v[148:151]
 v_exp_f32 v38,v38
 v_mfma_f32_16x16x32_bf16 v[212:215],a[168:171],v[80:83],v[212:215]
 ds_read_b128 a[92:95],v1 offset:39936
 v_add_f32 v7,v7,v52
 v_mfma_f32_16x16x32_bf16 v[212:215],a[172:175],v[88:91],v[212:215]
 v_readlane_b32 s33,v253,s38
 v_mfma_f32_16x16x32_bf16 v[152:155],a[176:179],v[64:67],v[152:155]
 v_exp_f32 v39,v39
 v_mfma_f32_16x16x32_bf16 v[152:155],a[180:183],v[72:75],v[152:155]
 v_add_f32 v7,v7,v53
 v_cvt_pk_bf16_f32 v50,v52,v53
 v_mfma_f32_16x16x32_bf16 v[216:219],a[176:179],v[80:83],v[216:219]
 ds_read_b128 a[96:99],v1 offset:40960
 v_add_f32 v6,v6,v38
 v_mfma_f32_16x16x32_bf16 v[216:219],a[180:183],v[88:91],v[216:219]
 s_sub_u32 s38,s38,1
 ds_read_b128 a[100:103],v1 offset:41984
 v_mfma_f32_16x16x32_bf16 v[156:159],a[184:187],v[64:67],v[156:159]
 v_add_f32 v6,v6,v39
 v_cvt_pk_bf16_f32 v35,v38,v39
 v_mfma_f32_16x16x32_bf16 v[156:159],a[188:191],v[72:75],v[156:159]
 s_cmp_eq_u32 s38,s39
 ds_read_b128 a[104:107],v1 offset:43008
 v_mfma_f32_16x16x32_bf16 v[220:223],a[184:187],v[80:83],v[220:223]
 ds_read_b128 a[108:111],v1 offset:44032
 ds_read_b128 a[112:115],v1 offset:45056
 v_mfma_f32_16x16x32_bf16 v[220:223],a[188:191],v[88:91],v[220:223]
 s_waitcnt lgkmcnt(5)
 s_cbranch_vccnz RESO_34
RESOR_35:
 s_cbranch_scc0 K2_LOOP
 s_branch K2_FIN
VCH_22:
 buffer_load_dword v254,v5,s[28:31],0 offen sc1
 s_sub_u32 s53,s53,1
 s_branch VCH_22R
RESC_25:
 v_max3_f32 v8,v64,v65,v66
 v_max3_f32 v9,v80,v81,v82
 v_max3_f32 v8,v8,v67,v68
 v_max3_f32 v9,v9,v83,v84
 v_max3_f32 v8,v8,v69,v70
 v_max3_f32 v9,v9,v85,v86
 v_max3_f32 v8,v8,v71,v72
 v_max3_f32 v9,v9,v87,v88
 v_max3_f32 v8,v8,v73,v74
 v_max3_f32 v9,v9,v89,v90
 v_max3_f32 v8,v8,v75,v76
 v_max3_f32 v9,v9,v91,v92
 v_max3_f32 v8,v8,v77,v78
 v_max3_f32 v9,v9,v93,v94
 v_max_f32 v8,v8,v79
 v_max_f32 v9,v9,v95
 v_mov_b32 v17,v8
 v_mov_b32 v18,v9
 s_nop 1
 v_permlane16_swap_b32 v17,v8
 v_permlane16_swap_b32 v18,v9
 s_nop 0
 v_max_f32 v8,v8,v17
 v_max_f32 v9,v9,v18
 v_mov_b32 v17,v8
 v_mov_b32 v18,v9
 s_nop 1
 v_permlane32_swap_b32 v17,v8
 v_permlane32_swap_b32 v18,v9
 s_nop 0
 v_max_f32 v8,v8,v17
 v_max_f32 v9,v9,v18
 v_max_f32 v8,0,v8
 v_exp_f32 v10,-v8
 v_max_f32 v9,0,v9
 v_exp_f32 v12,-v9
 v_sub_f32 v64,v64,v8
 v_sub_f32 v65,v65,v8
 v_sub_f32 v66,v66,v8
 v_sub_f32 v67,v67,v8
 v_sub_f32 v68,v68,v8
 v_sub_f32 v69,v69,v8
 v_sub_f32 v70,v70,v8
 v_sub_f32 v71,v71,v8
 v_sub_f32 v72,v72,v8
 v_sub_f32 v73,v73,v8
 v_sub_f32 v74,v74,v8
 v_sub_f32 v75,v75,v8
 v_sub_f32 v76,v76,v8
 v_sub_f32 v77,v77,v8
 v_sub_f32 v78,v78,v8
 v_sub_f32 v79,v79,v8
 v_sub_f32 v24,v24,v8
 v_sub_f32 v25,v25,v8
 v_sub_f32 v26,v26,v8
 v_sub_f32 v27,v27,v8
 v_sub_f32 v80,v80,v9
 v_sub_f32 v81,v81,v9
 v_sub_f32 v82,v82,v9
 v_sub_f32 v83,v83,v9
 v_sub_f32 v84,v84,v9
 v_sub_f32 v85,v85,v9
 v_sub_f32 v86,v86,v9
 v_sub_f32 v87,v87,v9
 v_sub_f32 v88,v88,v9
 v_sub_f32 v89,v89,v9
 v_sub_f32 v90,v90,v9
 v_sub_f32 v91,v91,v9
 v_sub_f32 v92,v92,v9
 v_sub_f32 v93,v93,v9
 v_sub_f32 v94,v94,v9
 v_sub_f32 v95,v95,v9
 v_sub_f32 v28,v28,v9
 v_sub_f32 v29,v29,v9
 v_sub_f32 v30,v30,v9
 v_sub_f32 v31,v31,v9
 v_mul_f32 v6,v6,v10
 v_mul_f32 v7,v7,v12
 s_branch RESCR_26
RESO_27:
 s_nop 7
 v_mul_f32 v96,v96,v10
 v_mul_f32 v97,v97,v10
 v_mul_f32 v98,v98,v10
 v_mul_f32 v99,v99,v10
 v_mul_f32 v100,v100,v10
 v_mul_f32 v101,v101,v10
 v_mul_f32 v102,v102,v10
 v_mul_f32 v103,v103,v10
 v_mul_f32 v104,v104,v10
 v_mul_f32 v105,v105,v10
 v_mul_f32 v106,v106,v10
 v_mul_f32 v107,v107,v10
 v_mul_f32 v108,v108,v10
 v_mul_f32 v109,v109,v10
 v_mul_f32 v110,v110,v10
 v_mul_f32 v111,v111,v10
 v_mul_f32 v112,v112,v10
 v_mul_f32 v113,v113,v10
 v_mul_f32 v114,v114,v10
 v_mul_f32 v115,v115,v10
 v_mul_f32 v116,v116,v10
 v_mul_f32 v117,v117,v10
 v_mul_f32 v118,v118,v10
 v_mul_f32 v119,v119,v10
 v_mul_f32 v120,v120,v10
 v_mul_f32 v121,v121,v10
 v_mul_f32 v122,v122,v10
 v_mul_f32 v123,v123,v10
 v_mul_f32 v124,v124,v10
 v_mul_f32 v125,v125,v10
 v_mul_f32 v126,v126,v10
 v_mul_f32 v127,v127,v10
 v_mul_f32 v128,v128,v10
 v_mul_f32 v129,v129,v10
 v_mul_f32 v130,v130,v10
 v_mul_f32 v131,v131,v10
 v_mul_f32 v132,v132,v10
 v_mul_f32 v133,v133,v10
 v_mul_f32 v134,v134,v10
 v_mul_f32 v135,v135,v10
 v_mul_f32 v136,v136,v10
 v_mul_f32 v137,v137,v10
 v_mul_f32 v138,v138,v10
 v_mul_f32 v139,v139,v10
 v_mul_f32 v140,v140,v10
 v_mul_f32 v141,v141,v10
 v_mul_f32 v142,v142,v10
 v_mul_f32 v143,v143,v10
 v_mul_f32 v144,v144,v10
 v_mul_f32 v145,v145,v10
 v_mul_f32 v146,v146,v10
 v_mul_f32 v147,v147,v10
 v_mul_f32 v148,v148,v10
 v_mul_f32 v149,v149,v10
 v_mul_f32 v150,v150,v10
 v_mul_f32 v151,v151,v10
 v_mul_f32 v152,v152,v10
 v_mul_f32 v153,v153,v10
 v_mul_f32 v154,v154,v10
 v_mul_f32 v155,v155,v10
 v_mul_f32 v156,v156,v10
 v_mul_f32 v157,v157,v10
 v_mul_f32 v158,v158,v10
 v_mul_f32 v159,v159,v10
 v_mul_f32 v160,v160,v12
 v_mul_f32 v161,v161,v12
 v_mul_f32 v162,v162,v12
 v_mul_f32 v163,v163,v12
 v_mul_f32 v164,v164,v12
 v_mul_f32 v165,v165,v12
 v_mul_f32 v166,v166,v12
 v_mul_f32 v167,v167,v12
 v_mul_f32 v168,v168,v12
 v_mul_f32 v169,v169,v12
 v_mul_f32 v170,v170,v12
 v_mul_f32 v171,v171,v12
 v_mul_f32 v172,v172,v12
 v_mul_f32 v173,v173,v12
 v_mul_f32 v174,v174,v12
 v_mul_f32 v175,v175,v12
 v_mul_f32 v176,v176,v12
 v_mul_f32 v177,v177,v12
 v_mul_f32 v178,v178,v12
 v_mul_f32 v179,v179,v12
 v_mul_f32 v180,v180,v12
 v_mul_f32 v181,v181,v12
 v_mul_f32 v182,v182,v12
 v_mul_f32 v183,v183,v12
 v_mul_f32 v184,v184,v12
 v_mul_f32 v185,v185,v12
 v_mul_f32 v186,v186,v12
 v_mul_f32 v187,v187,v12
 v_mul_f32 v188,v188,v12
 v_mul_f32 v189,v189,v12
 v_mul_f32 v190,v190,v12
 v_mul_f32 v191,v191,v12
 v_mul_f32 v192,v192,v12
 v_mul_f32 v193,v193,v12
 v_mul_f32 v194,v194,v12
 v_mul_f32 v195,v195,v12
 v_mul_f32 v196,v196,v12
 v_mul_f32 v197,v197,v12
 v_mul_f32 v198,v198,v12
 v_mul_f32 v199,v199,v12
 v_mul_f32 v200,v200,v12
 v_mul_f32 v201,v201,v12
 v_mul_f32 v202,v202,v12
 v_mul_f32 v203,v203,v12
 v_mul_f32 v204,v204,v12
 v_mul_f32 v205,v205,v12
 v_mul_f32 v206,v206,v12
 v_mul_f32 v207,v207,v12
 v_mul_f32 v208,v208,v12
 v_mul_f32 v209,v209,v12
 v_mul_f32 v210,v210,v12
 v_mul_f32 v211,v211,v12
 v_mul_f32 v212,v212,v12
 v_mul_f32 v213,v213,v12
 v_mul_f32 v214,v214,v12
 v_mul_f32 v215,v215,v12
 v_mul_f32 v216,v216,v12
 v_mul_f32 v217,v217,v12
 v_mul_f32 v218,v218,v12
 v_mul_f32 v219,v219,v12
 v_mul_f32 v220,v220,v12
 v_mul_f32 v221,v221,v12
 v_mul_f32 v222,v222,v12
 v_mul_f32 v223,v223,v12
 s_branch RESOR_28
VCH_29:
 s_waitcnt vmcnt(11)
VCH_29L:
 v_cmp_gt_u32 vcc,8,v254
 s_nop 4
 s_cbranch_vccz VCH_29D
 buffer_load_dword v254,v5,s[28:31],0 offen sc1
 s_waitcnt vmcnt(0)
 s_branch VCH_29L
VCH_29D:
 s_mov_b32 s53,-1
 s_branch VCH_29R
MASK_30:
 buffer_load_dword v242,v240,s[28:31],0 offen sc1
 s_getpc_b64 s[60:61]
PC_36:
 s_add_u32 s60,s60,K2_LAST-PC_36
 s_addc_u32 s61,s61,(K2_LAST-PC_36)>>32
 s_bfe_u32 s62,s2,0x10003
 s_lshl_b32 s62,s62,2
 s_add_u32 s62,s62,s45
 v_and_b32 v250,63,v0
 v_mul_u32_u24 v250,8,v250
 v_add_lshl_u32 v250,v250,s62,7
 v_min_u32 v250,F_END-K2_LAST-4,v250
 global_load_dword v251,v250,s[60:61]
 v_cmp_gt_i32 s[22:23],0,v3
 v_cmp_gt_i32 s[24:25],1,v3
 v_cmp_gt_i32 s[26:27],2,v3
 v_cndmask_b32 v32,v32,v4,s[22:23]
 v_cmp_gt_i32 s[22:23],3,v3
 v_cndmask_b32 v33,v33,v4,s[24:25]
 v_cmp_gt_i32 s[24:25],16,v3
 v_cndmask_b32 v34,v34,v4,s[26:27]
 v_cmp_gt_i32 s[26:27],17,v3
 v_cndmask_b32 v35,v35,v4,s[22:23]
 v_cmp_gt_i32 s[22:23],18,v3
 v_cndmask_b32 v36,v36,v4,s[24:25]
 v_cmp_gt_i32 s[24:25],19,v3
 v_cndmask_b32 v37,v37,v4,s[26:27]
 v_cmp_gt_i32 s[26:27],32,v3
 v_cndmask_b32 v38,v38,v4,s[22:23]
 v_cmp_gt_i32 s[22:23],33,v3
 v_cndmask_b32 v39,v39,v4,s[24:25]
 v_cmp_gt_i32 s[24:25],34,v3
 v_cndmask_b32 v40,v40,v4,s[26:27]
 v_cmp_gt_i32 s[26:27],35,v3
 v_cndmask_b32 v41,v41,v4,s[22:23]
 v_cmp_gt_i32 s[22:23],48,v3
 v_cndmask_b32 v42,v42,v4,s[24:25]
 v_cmp_gt_i32 s[24:25],49,v3
 v_cndmask_b32 v43,v43,v4,s[26:27]
 v_cmp_gt_i32 s[26:27],50,v3
 v_cndmask_b32 v44,v44,v4,s[22:23]
 v_cmp_gt_i32 s[22:23],51,v3
 v_cndmask_b32 v45,v45,v4,s[24:25]
 s_nop 0
 v_cndmask_b32 v46,v46,v4,s[26:27]
 s_nop 0
 v_cndmask_b32 v47,v47,v4,s[22:23]
 s_nop 0
 s_branch MASKR_31
RESC_32:
 v_max3_f32 v8,v32,v33,v34
 v_max3_f32 v9,v48,v49,v50
 v_max3_f32 v8,v8,v35,v36
 v_max3_f32 v9,v9,v51,v52
 v_max3_f32 v8,v8,v37,v38
 v_max3_f32 v9,v9,v53,v54
 v_max3_f32 v8,v8,v39,v40
 v_max3_f32 v9,v9,v55,v56
 v_max3_f32 v8,v8,v41,v42
 v_max3_f32 v9,v9,v57,v58
 v_max3_f32 v8,v8,v43,v44
 v_max3_f32 v9,v9,v59,v60
 v_max3_f32 v8,v8,v45,v46
 v_max3_f32 v9,v9,v61,v62
 v_max_f32 v8,v8,v47
 v_max_f32 v9,v9,v63
 v_mov_b32 v17,v8
 v_mov_b32 v18,v9
 s_nop 1
 v_permlane16_swap_b32 v17,v8
 v_permlane16_swap_b32 v18,v9
 s_nop 0
 v_max_f32 v8,v8,v17
 v_max_f32 v9,v9,v18
 v_mov_b32 v17,v8
 v_mov_b32 v18,v9
 s_nop 1
 v_permlane32_swap_b32 v17,v8
 v_permlane32_swap_b32 v18,v9
 s_nop 0
 v_max_f32 v8,v8,v17
 v_max_f32 v9,v9,v18
 v_max_f32 v8,0,v8
 v_exp_f32 v10,-v8
 v_max_f32 v9,0,v9
 v_exp_f32 v12,-v9
 v_sub_f32 v32,v32,v8
 v_sub_f32 v33,v33,v8
 v_sub_f32 v34,v34,v8
 v_sub_f32 v35,v35,v8
 v_sub_f32 v36,v36,v8
 v_sub_f32 v37,v37,v8
 v_sub_f32 v38,v38,v8
 v_sub_f32 v39,v39,v8
 v_sub_f32 v40,v40,v8
 v_sub_f32 v41,v41,v8
 v_sub_f32 v42,v42,v8
 v_sub_f32 v43,v43,v8
 v_sub_f32 v44,v44,v8
 v_sub_f32 v45,v45,v8
 v_sub_f32 v46,v46,v8
 v_sub_f32 v47,v47,v8
 v_sub_f32 v24,v24,v8
 v_sub_f32 v25,v25,v8
 v_sub_f32 v26,v26,v8
 v_sub_f32 v27,v27,v8
 v_sub_f32 v48,v48,v9
 v_sub_f32 v49,v49,v9
 v_sub_f32 v50,v50,v9
 v_sub_f32 v51,v51,v9
 v_sub_f32 v52,v52,v9
 v_sub_f32 v53,v53,v9
 v_sub_f32 v54,v54,v9
 v_sub_f32 v55,v55,v9
 v_sub_f32 v56,v56,v9
 v_sub_f32 v57,v57,v9
 v_sub_f32 v58,v58,v9
 v_sub_f32 v59,v59,v9
 v_sub_f32 v60,v60,v9
 v_sub_f32 v61,v61,v9
 v_sub_f32 v62,v62,v9
 v_sub_f32 v63,v63,v9
 v_sub_f32 v28,v28,v9
 v_sub_f32 v29,v29,v9
 v_sub_f32 v30,v30,v9
 v_sub_f32 v31,v31,v9
 v_mul_f32 v6,v6,v10
 v_mul_f32 v7,v7,v12
 s_branch RESCR_33
RESO_34:
 s_nop 7
 v_mul_f32 v96,v96,v10
 v_mul_f32 v97,v97,v10
 v_mul_f32 v98,v98,v10
 v_mul_f32 v99,v99,v10
 v_mul_f32 v100,v100,v10
 v_mul_f32 v101,v101,v10
 v_mul_f32 v102,v102,v10
 v_mul_f32 v103,v103,v10
 v_mul_f32 v104,v104,v10
 v_mul_f32 v105,v105,v10
 v_mul_f32 v106,v106,v10
 v_mul_f32 v107,v107,v10
 v_mul_f32 v108,v108,v10
 v_mul_f32 v109,v109,v10
 v_mul_f32 v110,v110,v10
 v_mul_f32 v111,v111,v10
 v_mul_f32 v112,v112,v10
 v_mul_f32 v113,v113,v10
 v_mul_f32 v114,v114,v10
 v_mul_f32 v115,v115,v10
 v_mul_f32 v116,v116,v10
 v_mul_f32 v117,v117,v10
 v_mul_f32 v118,v118,v10
 v_mul_f32 v119,v119,v10
 v_mul_f32 v120,v120,v10
 v_mul_f32 v121,v121,v10
 v_mul_f32 v122,v122,v10
 v_mul_f32 v123,v123,v10
 v_mul_f32 v124,v124,v10
 v_mul_f32 v125,v125,v10
 v_mul_f32 v126,v126,v10
 v_mul_f32 v127,v127,v10
 v_mul_f32 v128,v128,v10
 v_mul_f32 v129,v129,v10
 v_mul_f32 v130,v130,v10
 v_mul_f32 v131,v131,v10
 v_mul_f32 v132,v132,v10
 v_mul_f32 v133,v133,v10
 v_mul_f32 v134,v134,v10
 v_mul_f32 v135,v135,v10
 v_mul_f32 v136,v136,v10
 v_mul_f32 v137,v137,v10
 v_mul_f32 v138,v138,v10
 v_mul_f32 v139,v139,v10
 v_mul_f32 v140,v140,v10
 v_mul_f32 v141,v141,v10
 v_mul_f32 v142,v142,v10
 v_mul_f32 v143,v143,v10
 v_mul_f32 v144,v144,v10
 v_mul_f32 v145,v145,v10
 v_mul_f32 v146,v146,v10
 v_mul_f32 v147,v147,v10
 v_mul_f32 v148,v148,v10
 v_mul_f32 v149,v149,v10
 v_mul_f32 v150,v150,v10
 v_mul_f32 v151,v151,v10
 v_mul_f32 v152,v152,v10
 v_mul_f32 v153,v153,v10
 v_mul_f32 v154,v154,v10
 v_mul_f32 v155,v155,v10
 v_mul_f32 v156,v156,v10
 v_mul_f32 v157,v157,v10
 v_mul_f32 v158,v158,v10
 v_mul_f32 v159,v159,v10
 v_mul_f32 v160,v160,v12
 v_mul_f32 v161,v161,v12
 v_mul_f32 v162,v162,v12
 v_mul_f32 v163,v163,v12
 v_mul_f32 v164,v164,v12
 v_mul_f32 v165,v165,v12
 v_mul_f32 v166,v166,v12
 v_mul_f32 v167,v167,v12
 v_mul_f32 v168,v168,v12
 v_mul_f32 v169,v169,v12
 v_mul_f32 v170,v170,v12
 v_mul_f32 v171,v171,v12
 v_mul_f32 v172,v172,v12
 v_mul_f32 v173,v173,v12
 v_mul_f32 v174,v174,v12
 v_mul_f32 v175,v175,v12
 v_mul_f32 v176,v176,v12
 v_mul_f32 v177,v177,v12
 v_mul_f32 v178,v178,v12
 v_mul_f32 v179,v179,v12
 v_mul_f32 v180,v180,v12
 v_mul_f32 v181,v181,v12
 v_mul_f32 v182,v182,v12
 v_mul_f32 v183,v183,v12
 v_mul_f32 v184,v184,v12
 v_mul_f32 v185,v185,v12
 v_mul_f32 v186,v186,v12
 v_mul_f32 v187,v187,v12
 v_mul_f32 v188,v188,v12
 v_mul_f32 v189,v189,v12
 v_mul_f32 v190,v190,v12
 v_mul_f32 v191,v191,v12
 v_mul_f32 v192,v192,v12
 v_mul_f32 v193,v193,v12
 v_mul_f32 v194,v194,v12
 v_mul_f32 v195,v195,v12
 v_mul_f32 v196,v196,v12
 v_mul_f32 v197,v197,v12
 v_mul_f32 v198,v198,v12
 v_mul_f32 v199,v199,v12
 v_mul_f32 v200,v200,v12
 v_mul_f32 v201,v201,v12
 v_mul_f32 v202,v202,v12
 v_mul_f32 v203,v203,v12
 v_mul_f32 v204,v204,v12
 v_mul_f32 v205,v205,v12
 v_mul_f32 v206,v206,v12
 v_mul_f32 v207,v207,v12
 v_mul_f32 v208,v208,v12
 v_mul_f32 v209,v209,v12
 v_mul_f32 v210,v210,v12
 v_mul_f32 v211,v211,v12
 v_mul_f32 v212,v212,v12
 v_mul_f32 v213,v213,v12
 v_mul_f32 v214,v214,v12
 v_mul_f32 v215,v215,v12
 v_mul_f32 v216,v216,v12
 v_mul_f32 v217,v217,v12
 v_mul_f32 v218,v218,v12
 v_mul_f32 v219,v219,v12
 v_mul_f32 v220,v220,v12
 v_mul_f32 v221,v221,v12
 v_mul_f32 v222,v222,v12
 v_mul_f32 v223,v223,v12
 s_branch RESOR_35
K2_LASTU:
 s_waitcnt vmcnt(0) lgkmcnt(0)
 s_barrier
 ds_read_b128 a[64:67],v2 offset:32768
 ds_read_b128 a[68:71],v2 offset:33792
 ds_read_b128 a[72:75],v2 offset:34816
 ds_read_b128 a[76:79],v2 offset:35840
 ds_read_b128 a[80:83],v2 offset:36864
 ds_read_b128 a[84:87],v2 offset:37888
 ds_read_b128 a[88:91],v2 offset:38912
 ds_read_b128 a[92:95],v2 offset:39936
 ds_read_b128 a[96:99],v2 offset:40960
 ds_read_b128 a[100:103],v2 offset:41984
 ds_read_b128 a[104:107],v2 offset:43008
 ds_read_b128 a[108:111],v2 offset:44032
 ds_read_b128 a[112:115],v2 offset:45056
 v_exp_f32 v86,v86
 v_exp_f32 v87,v87
 v_exp_f32 v72,v72
 v_add_f32 v7,v7,v86
 s_add_u32 s60,s65,0
 v_exp_f32 v73,v73
 v_add_f32 v7,v7,v87
 v_cvt_pk_bf16_f32 v83,v86,v87
 v_exp_f32 v88,v88
 buffer_load_dwordx4 a[0:3],v1,s[28:31],s60 offen offset:0 sc1
 v_add_f32 v6,v6,v72
 v_exp_f32 v89,v89
 v_add_f32 v6,v6,v73
 v_cvt_pk_bf16_f32 v72,v72,v73
 buffer_load_dwordx4 a[4:7],v1,s[28:31],s60 offen offset:1024 sc1
 v_exp_f32 v74,v74
 v_add_f32 v7,v7,v88
 v_exp_f32 v75,v75
 v_add_f32 v7,v7,v89
 buffer_load_dwordx4 a[8:11],v1,s[28:31],s60 offen offset:2048 sc1
 v_cvt_pk_bf16_f32 v88,v88,v89
 v_exp_f32 v90,v90
 v_add_f32 v6,v6,v74
 v_exp_f32 v91,v91
 buffer_load_dwordx4 a[12:15],v1,s[28:31],s60 offen offset:3072 sc1
 v_add_f32 v6,v6,v75
 v_cvt_pk_bf16_f32 v73,v74,v75
 v_exp_f32 v76,v76
 v_add_f32 v7,v7,v90
 s_add_u32 s60,s65,4096
 v_exp_f32 v77,v77
 v_add_f32 v7,v7,v91
 v_cvt_pk_bf16_f32 v89,v90,v91
 v_exp_f32 v92,v92
 buffer_load_dwordx4 a[16:19],v1,s[28:31],s60 offen offset:0 sc1
 v_add_f32 v6,v6,v76
 v_exp_f32 v93,v93
 v_add_f32 v6,v6,v77
 v_cvt_pk_bf16_f32 v74,v76,v77
 buffer_load_dwordx4 a[20:23],v1,s[28:31],s60 offen offset:1024 sc1
 v_exp_f32 v78,v78
 v_add_f32 v7,v7,v92
 v_exp_f32 v79,v79
 v_add_f32 v7,v7,v93
 buffer_load_dwordx4 a[24:27],v1,s[28:31],s60 offen offset:2048 sc1
 v_cvt_pk_bf16_f32 v90,v92,v93
 v_exp_f32 v94,v94
 v_add_f32 v6,v6,v78
 v_exp_f32 v95,v95
 buffer_load_dwordx4 a[28:31],v1,s[28:31],s60 offen offset:3072 sc1
 v_add_f32 v6,v6,v79
 v_cvt_pk_bf16_f32 v75,v78,v79
 v_add_f32 v7,v7,v94
 v_add_f32 v7,v7,v95
 s_add_u32 s60,s65,0
 v_cvt_pk_bf16_f32 v91,v94,v95
 s_add_u32 s75,s47,16777216
 s_waitcnt lgkmcnt(5)
 v_mfma_f32_16x16x32_bf16 v[96:99],a[64:67],v[64:67],v[96:99]
 ds_read_b128 a[116:119],v2 offset:46080
 v_mov_b32 v19,v6
 s_nop 1
 v_permlane16_swap_b32 v19,v6
 v_mfma_f32_16x16x32_bf16 v[96:99],a[68:71],v[72:75],v[96:99]
 buffer_load_dwordx4 a[32:35],v243,s[28:31],s60 offen offset:0 sc1
 v_add_f32 v6,v6,v19
 v_mfma_f32_16x16x32_bf16 v[160:163],a[64:67],v[80:83],v[160:163]
 buffer_load_dwordx4 a[36:39],v243,s[28:31],s60 offen offset:1024 sc1
 v_mfma_f32_16x16x32_bf16 v[160:163],a[68:71],v[88:91],v[160:163]
 ds_read_b128 a[120:123],v2 offset:47104
 v_mov_b32 v19,v6
 s_nop 1
 v_permlane32_swap_b32 v19,v6
 v_mfma_f32_16x16x32_bf16 v[100:103],a[72:75],v[64:67],v[100:103]
 buffer_load_dwordx4 a[40:43],v243,s[28:31],s60 offen offset:2048 sc1
 v_add_f32 v6,v6,v19
 v_mfma_f32_16x16x32_bf16 v[100:103],a[76:79],v[72:75],v[100:103]
 ds_read_b128 a[124:127],v2 offset:48128
 v_mov_b32 v19,v7
 s_nop 1
 v_permlane16_swap_b32 v19,v7
 v_mfma_f32_16x16x32_bf16 v[164:167],a[72:75],v[80:83],v[164:167]
 buffer_load_dwordx4 a[44:47],v243,s[28:31],s60 offen offset:3072 sc1
 v_add_f32 v7,v7,v19
 v_mfma_f32_16x16x32_bf16 v[164:167],a[76:79],v[88:91],v[164:167]
 ds_read_b128 a[128:131],v2 offset:49152
 s_add_u32 s60,s65,4096
 v_mfma_f32_16x16x32_bf16 v[104:107],a[80:83],v[64:67],v[104:107]
 buffer_load_dwordx4 a[48:51],v243,s[28:31],s60 offen offset:0 sc1
 v_mfma_f32_16x16x32_bf16 v[104:107],a[84:87],v[72:75],v[104:107]
 ds_read_b128 a[132:135],v2 offset:50176
 v_mov_b32 v19,v7
 s_nop 1
 v_permlane32_swap_b32 v19,v7
 v_mfma_f32_16x16x32_bf16 v[168:171],a[80:83],v[80:83],v[168:171]
 buffer_load_dwordx4 a[52:55],v243,s[28:31],s60 offen offset:1024 sc1
 v_add_f32 v7,v7,v19
 v_mov_b32 v244,v24
 v_mfma_f32_16x16x32_bf16 v[168:171],a[84:87],v[88:91],v[168:171]
 ds_read_b128 a[136:139],v2 offset:51200
 v_mov_b32 v245,v28
 v_mov_b32 v246,v6
 v_mov_b32 v247,v7
 v_mfma_f32_16x16x32_bf16 v[108:111],a[88:91],v[64:67],v[108:111]
 buffer_load_dwordx4 a[56:59],v243,s[28:31],s60 offen offset:2048 sc1
 v_mov_b32 v24,0
 v_mov_b32 v25,0
 v_mfma_f32_16x16x32_bf16 v[108:111],a[92:95],v[72:75],v[108:111]
 ds_read_b128 a[140:143],v2 offset:52224
 v_mov_b32 v26,0
 v_mov_b32 v27,0
 v_mov_b32 v28,0
 v_mfma_f32_16x16x32_bf16 v[172:175],a[88:91],v[80:83],v[172:175]
 buffer_load_dwordx4 a[60:63],v243,s[28:31],s60 offen offset:3072 sc1
 v_mov_b32 v29,0
 v_mov_b32 v30,0
 v_mfma_f32_16x16x32_bf16 v[172:175],a[92:95],v[88:91],v[172:175]
 s_waitcnt lgkmcnt(4)
 ds_read_b128 a[144:147],v2 offset:53248
 v_mov_b32 v31,0
 v_mfma_f32_16x16x32_bf16 v[112:115],a[96:99],v[64:67],v[112:115]
 s_add_u32 m0,s51,65536
 ds_read_b128 a[148:151],v2 offset:54272
 v_mfma_f32_16x16x32_bf16 v[112:115],a[100:103],v[72:75],v[112:115]
 buffer_load_dwordx4 v14,s[28:31],s64 offen offset:0 sc1 lds
 v_mfma_f32_16x16x32_bf16 v[176:179],a[96:99],v[80:83],v[176:179]
 buffer_load_dwordx4 v14,s[28:31],s64 offen offset:1024 sc1 lds
 v_mfma_f32_16x16x32_bf16 v[176:179],a[100:103],v[88:91],v[176:179]
 ds_read_b128 a[152:155],v2 offset:55296
 v_mfma_f32_16x16x32_bf16 v[116:119],a[104:107],v[64:67],v[116:119]
 buffer_load_dwordx4 v14,s[28:31],s64 offen offset:2048 sc1 lds
 v_mfma_f32_16x16x32_bf16 v[116:119],a[108:111],v[72:75],v[116:119]
 ds_read_b128 a[156:159],v2 offset:56320
 v_mfma_f32_16x16x32_bf16 v[180:183],a[104:107],v[80:83],v[180:183]
 buffer_load_dwordx4 v14,s[28:31],s64 offen offset:3072 sc1 lds
 v_mfma_f32_16x16x32_bf16 v[180:183],a[108:111],v[88:91],v[180:183]
 ds_read_b128 a[160:163],v2 offset:57344
 s_add_u32 m0,s51,69632
 v_mfma_f32_16x16x32_bf16 v[120:123],a[112:115],v[64:67],v[120:123]
 buffer_load_dwordx4 v15,s[28:31],s64 offen offset:0 sc1 lds
 v_mfma_f32_16x16x32_bf16 v[120:123],a[116:119],v[72:75],v[120:123]
 ds_read_b128 a[164:167],v2 offset:58368
 v_mfma_f32_16x16x32_bf16 v[184:187],a[112:115],v[80:83],v[184:187]
 buffer_load_dwordx4 v15,s[28:31],s64 offen offset:1024 sc1 lds
 v_mfma_f32_16x16x32_bf16 v[184:187],a[116:119],v[88:91],v[184:187]
 ds_read_b128 a[168:171],v2 offset:59392
 v_mfma_f32_16x16x32_bf16 v[124:127],a[120:123],v[64:67],v[124:127]
 buffer_load_dwordx4 v15,s[28:31],s64 offen offset:2048 sc1 lds
 v_mfma_f32_16x16x32_bf16 v[124:127],a[124:127],v[72:75],v[124:127]
 ds_read_b128 a[172:175],v2 offset:60416
 v_mfma_f32_16x16x32_bf16 v[188:191],a[120:123],v[80:83],v[188:191]
 buffer_load_dwordx4 v15,s[28:31],s64 offen offset:3072 sc1 lds
 v_mfma_f32_16x16x32_bf16 v[188:191],a[124:127],v[88:91],v[188:191]
 s_waitcnt lgkmcnt(4)
 ds_read_b128 a[176:179],v2 offset:61440
 v_mfma_f32_16x16x32_bf16 v[128:131],a[128:131],v[64:67],v[128:131]
 ds_read_b128 a[180:183],v2 offset:62464
 v_mfma_f32_16x16x32_bf16 v[128:131],a[132:135],v[72:75],v[128:131]
 v_mfma_f32_16x16x32_bf16 v[192:195],a[128:131],v[80:83],v[192:195]
 ds_read_b128 a[184:187],v2 offset:63488
 v_mfma_f32_16x16x32_bf16 v[192:195],a[132:135],v[88:91],v[192:195]
 buffer_store_dwordx4 v[244:247],v1,s[28:31],s66 offen sc1
 s_mov_b32 s41,s48
 s_mov_b32 s42,0
 v_mfma_f32_16x16x32_bf16 v[132:135],a[136:139],v[64:67],v[132:135]
 ds_read_b128 a[188:191],v2 offset:64512
 s_lshl_b32 s43,s48,1
 s_add_u32 s43,s43,2
 s_mov_b32 s39,1
 v_mfma_f32_16x16x32_bf16 v[132:135],a[140:143],v[72:75],v[132:135]
 s_mov_b32 s40,2
 s_mov_b32 s44,0
 s_mov_b32 s50,0
 s_mov_b32 s52,0
 v_mfma_f32_16x16x32_bf16 v[196:199],a[136:139],v[80:83],v[196:199]
 ds_read_b128 a[64:67],v1 offset:0
 s_lshl_b32 s61,s46,3
 s_add_u32 s61,s61,s48
 s_lshl_b32 s66,s61,2
 v_mfma_f32_16x16x32_bf16 v[196:199],a[140:143],v[88:91],v[196:199]
 s_add_u32 s66,s66,s45
 s_lshl_b32 s66,s66,10
 s_add_u32 s66,s66,126877696
 s_lshl_b32 s61,s61,7
 v_mfma_f32_16x16x32_bf16 v[136:139],a[144:147],v[64:67],v[136:139]
 ds_read_b128 a[68:71],v1 offset:1024
 s_add_u32 s61,s61,125837312
 s_lshl_b32 s62,s46,20
 s_lshl_b32 s32,s42,15
 v_mfma_f32_16x16x32_bf16 v[136:139],a[148:151],v[72:75],v[136:139]
 s_add_u32 s32,s32,s62
 s_add_u32 s33,s32,16777216
 s_lshl_b32 s47,s41,3
 s_add_u32 s47,s47,s45
 v_mfma_f32_16x16x32_bf16 v[200:203],a[144:147],v[80:83],v[200:203]
 ds_read_b128 a[72:75],v1 offset:2048
 s_lshl_b32 s47,s47,13
 s_add_u32 s47,s47,s62
 s_add_u32 s47,s47,33554432
 v_mfma_f32_16x16x32_bf16 v[200:203],a[148:151],v[88:91],v[200:203]
 s_lshl_b32 s63,s48,3
 s_add_u32 s63,s63,s45
 s_lshl_b32 s63,s63,13
 s_add_u32 s63,s63,s62
 v_mfma_f32_16x16x32_bf16 v[140:143],a[152:155],v[64:67],v[140:143]
 ds_read_b128 a[76:79],v1 offset:3072
 s_add_u32 s63,s63,33554432
 s_add_u32 s65,s47,16777216
 s_lshl_b32 s64,s46,16
 v_mfma_f32_16x16x32_bf16 v[140:143],a[156:159],v[72:75],v[140:143]
 s_add_u32 s64,s64,s51
 s_add_u32 s64,s64,100663296
 s_cmp_lg_u32 s73,0
 s_cselect_b32 s64,s64,0xf0000000
 v_mfma_f32_16x16x32_bf16 v[204:207],a[152:155],v[80:83],v[204:207]
 ds_read_b128 a[80:83],v1 offset:4096
 s_cmp_eq_u32 s44,1
 s_cselect_b32 s65,s65,s64
 s_add_u32 s64,s36,65536
 v_mfma_f32_16x16x32_bf16 v[204:207],a[156:159],v[88:91],v[204:207]
 s_waitcnt lgkmcnt(5)
 v_mfma_f32_16x16x32_bf16 v[144:147],a[160:163],v[64:67],v[144:147]
 ds_read_b128 a[84:87],v1 offset:5120
 v_mfma_f32_16x16x32_bf16 v[144:147],a[164:167],v[72:75],v[144:147]
 s_cmp_eq_u32 s50,1
 s_cselect_b32 s35,s62,s36
 s_cselect_b32 s65,s63,s65
 s_cselect_b32 s64,s33,s64
 v_mfma_f32_16x16x32_bf16 v[208:211],a[160:163],v[80:83],v[208:211]
 ds_read_b128 a[88:91],v1 offset:6144
 s_sub_u32 s38,s43,1
 s_and_b32 s63,s43,1
 s_lshl_b32 s68,s63,15
 v_mfma_f32_16x16x32_bf16 v[208:211],a[164:167],v[88:91],v[208:211]
 s_add_u32 s68,s68,s51
 s_xor_b32 s69,s68,0x8000
 s_sub_u32 s63,s38,s63
 s_sub_i32 s62,s63,2
 v_mfma_f32_16x16x32_bf16 v[148:151],a[168:171],v[64:67],v[148:151]
 ds_read_b128 a[92:95],v1 offset:7168
 s_cmp_ge_i32 s62,3
 s_cselect_b32 s63,s62,s63
 s_sub_i32 s62,s43,5
 v_mfma_f32_16x16x32_bf16 v[148:151],a[172:175],v[72:75],v[148:151]
 s_or_b32 s62,s62,1
 s_cmp_ge_i32 s62,3
 s_cselect_b32 s63,s62,s63
 s_mul_i32 s62,s50,8
 v_mfma_f32_16x16x32_bf16 v[212:215],a[168:171],v[80:83],v[212:215]
 ds_read_b128 a[96:99],v1 offset:8192
 s_cmp_le_u32 s43,s62
 s_cselect_b32 s63,-2,s63
 v_mfma_f32_16x16x32_bf16 v[212:215],a[172:175],v[88:91],v[212:215]
 s_cmp_eq_u32 s53,-1
 s_cselect_b32 s53,-1,s63
 s_add_u32 s33,s33,32768
 s_lshl_b32 s67,s46,3
 v_mfma_f32_16x16x32_bf16 v[152:155],a[176:179],v[64:67],v[152:155]
 ds_read_b128 a[100:103],v1 offset:9216
 s_add_u32 s67,s67,s48
 s_add_u32 s67,s67,64
 s_and_b32 s61,s68,0x8000
 v_mfma_f32_16x16x32_bf16 v[152:155],a[180:183],v[72:75],v[152:155]
 v_add_u32 v20,s61,v1
 v_xor_b32 v21,0x8000,v20
 v_mov_b32 v6,0
 v_mov_b32 v7,0
 v_mfma_f32_16x16x32_bf16 v[216:219],a[176:179],v[80:83],v[216:219]
 ds_read_b128 a[104:107],v1 offset:10240
 v_lshrrev_b32 v16,4,v1
 s_add_u32 s63,s43,s42
 s_lshl_b32 s62,s46,20
 v_mfma_f32_16x16x32_bf16 v[216:219],a[180:183],v[88:91],v[216:219]
 v_sub_u32 v17,s63,v16
 v_add_u32 v17,2,v17
 v_cmp_le_i32 vcc,s34,v17
 v_add_u32 v18,s52,v17
 v_mfma_f32_16x16x32_bf16 v[156:159],a[184:187],v[64:67],v[156:159]
 ds_read_b128 a[108:111],v1 offset:11264
 s_add_u32 s61,s62,0
 v_cndmask_b32 v17,v17,v18,vcc
 v_lshl_add_u32 v252,v17,15,s61
 v_mfma_f32_16x16x32_bf16 v[156:159],a[188:191],v[72:75],v[156:159]
 v_sub_u32 v17,s63,v16
 v_add_u32 v17,1,v17
 v_cmp_le_i32 vcc,s34,v17
 v_add_u32 v18,s52,v17
 v_mfma_f32_16x16x32_bf16 v[220:223],a[184:187],v[80:83],v[220:223]
 s_waitcnt vmcnt(9)
 ds_read_b128 a[112:115],v1 offset:12288
 s_add_u32 s61,s62,16777216
 v_cndmask_b32 v17,v17,v18,vcc
 v_mfma_f32_16x16x32_bf16 v[220:223],a[188:191],v[88:91],v[220:223]
 s_waitcnt lgkmcnt(5)
 v_lshl_add_u32 v253,v17,15,s61
 s_add_u32 s61,s35,32768
 v_writelane_b32 v252,s35,2
 v_mfma_f32_16x16x32_bf16 v[32:35],a[64:67],a[0:3],0
 ds_read_b128 a[116:119],v1 offset:13312
 v_writelane_b32 v252,s61,1
 s_add_u32 s61,s46,16
 s_lshl_b32 s61,s61,7
 v_mfma_f32_16x16x32_bf16 v[32:35],a[68:71],a[4:7],v[32:35]
 s_add_u32 s61,s61,125829120
 v_mov_b32 v5,s61
 s_add_u32 s61,s46,192
 s_lshl_b32 s61,s61,7
 v_mfma_f32_16x16x32_bf16 v[32:35],a[72:75],a[8:11],v[32:35]
 ds_read_b128 a[120:123],v1 offset:14336
 s_add_u32 s61,s61,125829120
 v_writelane_b32 v5,s61,1
 v_mfma_f32_16x16x32_bf16 v[32:35],a[76:79],a[12:15],v[32:35]
 v_readlane_b32 s32,v252,s43
 v_cvt_pk_bf16_f32 v224,v96,v97
 v_cvt_pk_bf16_f32 v225,v98,v99
 v_mfma_f32_16x16x32_bf16 v[48:51],a[64:67],a[32:35],0
 ds_read_b128 a[124:127],v1 offset:15360
 v_cvt_pk_bf16_f32 v226,v100,v101
 v_cvt_pk_bf16_f32 v227,v102,v103
 v_mfma_f32_16x16x32_bf16 v[48:51],a[68:71],a[36:39],v[48:51]
 buffer_store_dwordx4 v[224:227],v1,s[28:31],s75 offen offset:0 sc1
 v_mov_b32 v96,0
 v_mov_b32 v97,0
 v_mfma_f32_16x16x32_bf16 v[48:51],a[72:75],a[40:43],v[48:51]
 ds_read_b128 a[128:131],v1 offset:16384
 v_mov_b32 v98,0
 v_mov_b32 v99,0
 v_mov_b32 v100,0
 v_mfma_f32_16x16x32_bf16 v[48:51],a[76:79],a[44:47],v[48:51]
 v_mov_b32 v101,0
 v_mov_b32 v102,0
 v_mov_b32 v103,0
 v_cvt_pk_bf16_f32 v228,v160,v161
 v_mfma_f32_16x16x32_bf16 v[32:35],a[80:83],a[16:19],v[32:35]
 ds_read_b128 a[132:135],v1 offset:17408
 v_cvt_pk_bf16_f32 v229,v162,v163
 v_cvt_pk_bf16_f32 v230,v164,v165
 v_cvt_pk_bf16_f32 v231,v166,v167
 v_mfma_f32_16x16x32_bf16 v[32:35],a[84:87],a[20:23],v[32:35]
 buffer_store_dwordx4 v[228:231],v243,s[28:31],s75 offen offset:0 sc1
 v_mov_b32 v160,0
 v_mov_b32 v161,0
 v_mfma_f32_16x16x32_bf16 v[32:35],a[88:91],a[24:27],v[32:35]
 ds_read_b128 a[136:139],v1 offset:18432
 v_mov_b32 v162,0
 v_mov_b32 v163,0
 v_mov_b32 v164,0
 v_mfma_f32_16x16x32_bf16 v[32:35],a[92:95],a[28:31],v[32:35]
 v_mov_b32 v165,0
 v_mov_b32 v166,0
 v_mov_b32 v167,0
 v_cvt_pk_bf16_f32 v232,v104,v105
 v_mfma_f32_16x16x32_bf16 v[48:51],a[80:83],a[48:51],v[48:51]
 ds_read_b128 a[140:143],v1 offset:19456
 v_cvt_pk_bf16_f32 v233,v106,v107
 v_cvt_pk_bf16_f32 v234,v108,v109
 v_cvt_pk_bf16_f32 v235,v110,v111
 v_mfma_f32_16x16x32_bf16 v[48:51],a[84:87],a[52:55],v[48:51]
 buffer_store_dwordx4 v[232:235],v1,s[28:31],s75 offen offset:1024 sc1
 v_mov_b32 v104,0
 v_mov_b32 v105,0
 v_mfma_f32_16x16x32_bf16 v[48:51],a[88:91],a[56:59],v[48:51]
 ds_read_b128 a[144:147],v1 offset:20480
 v_mov_b32 v106,0
 v_mov_b32 v107,0
 v_mov_b32 v108,0
 v_mfma_f32_16x16x32_bf16 v[48:51],a[92:95],a[60:63],v[48:51]
 s_waitcnt lgkmcnt(5)
 v_mov_b32 v109,0
 v_mov_b32 v110,0
 v_mov_b32 v111,0
 v_mfma_f32_16x16x32_bf16 v[36:39],a[96:99],a[0:3],0
 ds_read_b128 a[148:151],v1 offset:21504
 v_cvt_pk_bf16_f32 v236,v168,v169
 v_cvt_pk_bf16_f32 v237,v170,v171
 v_cvt_pk_bf16_f32 v238,v172,v173
 v_mfma_f32_16x16x32_bf16 v[36:39],a[100:103],a[4:7],v[36:39]
 v_cvt_pk_bf16_f32 v239,v174,v175
 v_mfma_f32_16x16x32_bf16 v[36:39],a[104:107],a[8:11],v[36:39]
 buffer_store_dwordx4 v[236:239],v243,s[28:31],s75 offen offset:1024 sc1
 ds_read_b128 a[152:155],v1 offset:22528
 v_mov_b32 v168,0
 v_mfma_f32_16x16x32_bf16 v[36:39],a[108:111],a[12:15],v[36:39]
 v_mov_b32 v169,0
 v_mov_b32 v170,0
 v_mov_b32 v171,0
 v_mov_b32 v172,0
 v_mfma_f32_16x16x32_bf16 v[52:55],a[96:99],a[32:35],0
 ds_read_b128 a[156:159],v1 offset:23552
 v_mov_b32 v173,0
 v_mov_b32 v174,0
 v_mov_b32 v175,0
 v_mfma_f32_16x16x32_bf16 v[52:55],a[100:103],a[36:39],v[52:55]
 v_cvt_pk_bf16_f32 v224,v112,v113
 v_cvt_pk_bf16_f32 v225,v114,v115
 v_cvt_pk_bf16_f32 v226,v116,v117
 v_cvt_pk_bf16_f32 v227,v118,v119
 v_mfma_f32_16x16x32_bf16 v[52:55],a[104:107],a[40:43],v[52:55]
 buffer_store_dwordx4 v[224:227],v1,s[28:31],s75 offen offset:2048 sc1
 ds_read_b128 a[160:163],v1 offset:24576
 v_mov_b32 v112,0
 v_mfma_f32_16x16x32_bf16 v[52:55],a[108:111],a[44:47],v[52:55]
 v_mov_b32 v113,0
 v_mov_b32 v114,0
 v_mov_b32 v115,0
 v_mov_b32 v116,0
 v_mfma_f32_16x16x32_bf16 v[36:39],a[112:115],a[16:19],v[36:39]
 ds_read_b128 a[164:167],v1 offset:25600
 v_mov_b32 v117,0
 v_mov_b32 v118,0
 v_mov_b32 v119,0
 v_mfma_f32_16x16x32_bf16 v[36:39],a[116:119],a[20:23],v[36:39]
 v_cvt_pk_bf16_f32 v228,v176,v177
 v_cvt_pk_bf16_f32 v229,v178,v179
 v_cvt_pk_bf16_f32 v230,v180,v181
 v_cvt_pk_bf16_f32 v231,v182,v183
 v_mfma_f32_16x16x32_bf16 v[36:39],a[120:123],a[24:27],v[36:39]
 buffer_store_dwordx4 v[228:231],v243,s[28:31],s75 offen offset:2048 sc1
 ds_read_b128 a[168:171],v1 offset:26624
 v_mov_b32 v176,0
 v_mfma_f32_16x16x32_bf16 v[36:39],a[124:127],a[28:31],v[36:39]
 v_mov_b32 v177,0
 v_mov_b32 v178,0
 v_mov_b32 v179,0
 v_mov_b32 v180,0
 v_mfma_f32_16x16x32_bf16 v[52:55],a[112:115],a[48:51],v[52:55]
 ds_read_b128 a[172:175],v1 offset:27648
 v_mov_b32 v181,0
 v_mov_b32 v182,0
 v_mov_b32 v183,0
 v_mfma_f32_16x16x32_bf16 v[52:55],a[116:119],a[52:55],v[52:55]
 v_cvt_pk_bf16_f32 v232,v120,v121
 v_cvt_pk_bf16_f32 v233,v122,v123
 v_cvt_pk_bf16_f32 v234,v124,v125
 v_cvt_pk_bf16_f32 v235,v126,v127
 v_mfma_f32_16x16x32_bf16 v[52:55],a[120:123],a[56:59],v[52:55]
 buffer_store_dwordx4 v[232:235],v1,s[28:31],s75 offen offset:3072 sc1
 ds_read_b128 a[176:179],v1 offset:28672
 v_mov_b32 v120,0
 v_mfma_f32_16x16x32_bf16 v[52:55],a[124:127],a[60:63],v[52:55]
 s_waitcnt lgkmcnt(5)
 v_mov_b32 v121,0
 v_mov_b32 v122,0
 v_mov_b32 v123,0
 v_mfma_f32_16x16x32_bf16 v[40:43],a[128:131],a[0:3],0
 ds_read_b128 a[180:183],v1 offset:29696
 v_mov_b32 v124,0
 v_mov_b32 v125,0
 v_mov_b32 v126,0
 v_mfma_f32_16x16x32_bf16 v[40:43],a[132:135],a[4:7],v[40:43]
 v_mov_b32 v127,0
 v_cvt_pk_bf16_f32 v236,v184,v185
 v_cvt_pk_bf16_f32 v237,v186,v187
 v_cvt_pk_bf16_f32 v238,v188,v189
 v_mfma_f32_16x16x32_bf16 v[40:43],a[136:139],a[8:11],v[40:43]
 ds_read_b128 a[184:187],v1 offset:30720
 v_cvt_pk_bf16_f32 v239,v190,v191
 v_mfma_f32_16x16x32_bf16 v[40:43],a[140:143],a[12:15],v[40:43]
 buffer_store_dwordx4 v[236:239],v243,s[28:31],s75 offen offset:3072 sc1
 v_mov_b32 v184,0
 v_mov_b32 v185,0
 v_mfma_f32_16x16x32_bf16 v[56:59],a[128:131],a[32:35],0
 ds_read_b128 a[188:191],v1 offset:31744
 v_mov_b32 v186,0
 v_mov_b32 v187,0
 v_mov_b32 v188,0
 v_mfma_f32_16x16x32_bf16 v[56:59],a[132:135],a[36:39],v[56:59]
 v_mov_b32 v189,0
 v_mov_b32 v190,0
 v_mov_b32 v191,0
 v_cvt_pk_bf16_f32 v224,v128,v129
 v_mfma_f32_16x16x32_bf16 v[56:59],a[136:139],a[40:43],v[56:59]
 v_cvt_pk_bf16_f32 v225,v130,v131
 v_cvt_pk_bf16_f32 v226,v132,v133
 v_cvt_pk_bf16_f32 v227,v134,v135
 s_add_u32 s75,s75,4096
 v_mfma_f32_16x16x32_bf16 v[56:59],a[140:143],a[44:47],v[56:59]
 buffer_store_dwordx4 v[224:227],v1,s[28:31],s75 offen offset:0 sc1
 v_mov_b32 v128,0
 v_mov_b32 v129,0
 v_mfma_f32_16x16x32_bf16 v[40:43],a[144:147],a[16:19],v[40:43]
 v_mov_b32 v130,0
 v_mov_b32 v131,0
 v_mov_b32 v132,0
 v_mov_b32 v133,0
 v_mfma_f32_16x16x32_bf16 v[40:43],a[148:151],a[20:23],v[40:43]
 v_mov_b32 v134,0
 v_mov_b32 v135,0
 v_cvt_pk_bf16_f32 v228,v192,v193
 v_cvt_pk_bf16_f32 v229,v194,v195
 v_mfma_f32_16x16x32_bf16 v[40:43],a[152:155],a[24:27],v[40:43]
 v_cvt_pk_bf16_f32 v230,v196,v197
 v_cvt_pk_bf16_f32 v231,v198,v199
 v_mfma_f32_16x16x32_bf16 v[40:43],a[156:159],a[28:31],v[40:43]
 buffer_store_dwordx4 v[228:231],v243,s[28:31],s75 offen offset:0 sc1
 v_mov_b32 v192,0
 v_mov_b32 v193,0
 v_mfma_f32_16x16x32_bf16 v[56:59],a[144:147],a[48:51],v[56:59]
 v_mov_b32 v194,0
 v_mov_b32 v195,0
 v_mov_b32 v196,0
 v_mov_b32 v197,0
 v_mfma_f32_16x16x32_bf16 v[56:59],a[148:151],a[52:55],v[56:59]
 v_mov_b32 v198,0
 v_mov_b32 v199,0
 v_cvt_pk_bf16_f32 v232,v136,v137
 v_cvt_pk_bf16_f32 v233,v138,v139
 v_mfma_f32_16x16x32_bf16 v[56:59],a[152:155],a[56:59],v[56:59]
 v_cvt_pk_bf16_f32 v234,v140,v141
 v_cvt_pk_bf16_f32 v235,v142,v143
 v_mfma_f32_16x16x32_bf16 v[56:59],a[156:159],a[60:63],v[56:59]
 s_waitcnt lgkmcnt(0)
 buffer_store_dwordx4 v[232:235],v1,s[28:31],s75 offen offset:1024 sc1
 v_mov_b32 v136,0
 v_mfma_f32_16x16x32_bf16 v[44:47],a[160:163],a[0:3],0
 v_mov_b32 v137,0
 v_mov_b32 v138,0
 v_mov_b32 v139,0
 v_mov_b32 v140,0
 v_mfma_f32_16x16x32_bf16 v[44:47],a[164:167],a[4:7],v[44:47]
 v_mov_b32 v141,0
 v_mov_b32 v142,0
 v_mov_b32 v143,0
 v_cvt_pk_bf16_f32 v236,v200,v201
 v_mfma_f32_16x16x32_bf16 v[44:47],a[168:171],a[8:11],v[44:47]
 v_cvt_pk_bf16_f32 v237,v202,v203
 v_cvt_pk_bf16_f32 v238,v204,v205
 v_cvt_pk_bf16_f32 v239,v206,v207
 v_mfma_f32_16x16x32_bf16 v[44:47],a[172:175],a[12:15],v[44:47]
 buffer_store_dwordx4 v[236:239],v243,s[28:31],s75 offen offset:1024 sc1
 v_mov_b32 v200,0
 v_mov_b32 v201,0
 v_mfma_f32_16x16x32_bf16 v[60:63],a[160:163],a[32:35],0
 v_mov_b32 v202,0
 v_mov_b32 v203,0
 v_mov_b32 v204,0
 v_mov_b32 v205,0
 v_mfma_f32_16x16x32_bf16 v[60:63],a[164:167],a[36:39],v[60:63]
 v_mov_b32 v206,0
 v_mov_b32 v207,0
 v_cvt_pk_bf16_f32 v224,v144,v145
 v_cvt_pk_bf16_f32 v225,v146,v147
 v_mfma_f32_16x16x32_bf16 v[60:63],a[168:171],a[40:43],v[60:63]
 v_cvt_pk_bf16_f32 v226,v148,v149
 v_cvt_pk_bf16_f32 v227,v150,v151
 v_mfma_f32_16x16x32_bf16 v[60:63],a[172:175],a[44:47],v[60:63]
 buffer_store_dwordx4 v[224:227],v1,s[28:31],s75 offen offset:2048 sc1
 v_mov_b32 v144,0
 v_mov_b32 v145,0
 v_mfma_f32_16x16x32_bf16 v[44:47],a[176:179],a[16:19],v[44:47]
 v_mov_b32 v146,0
 v_mov_b32 v147,0
 v_mov_b32 v148,0
 v_mov_b32 v149,0
 v_mfma_f32_16x16x32_bf16 v[44:47],a[180:183],a[20:23],v[44:47]
 v_mov_b32 v150,0
 v_mov_b32 v151,0
 v_cvt_pk_bf16_f32 v228,v208,v209
 v_cvt_pk_bf16_f32 v229,v210,v211
 v_mfma_f32_16x16x32_bf16 v[44:47],a[184:187],a[24:27],v[44:47]
 v_cvt_pk_bf16_f32 v230,v212,v213
 v_cvt_pk_bf16_f32 v231,v214,v215
 v_mfma_f32_16x16x32_bf16 v[44:47],a[188:191],a[28:31],v[44:47]
 buffer_store_dwordx4 v[228:231],v243,s[28:31],s75 offen offset:2048 sc1
 v_mov_b32 v208,0
 v_mov_b32 v209,0
 v_mfma_f32_16x16x32_bf16 v[60:63],a[176:179],a[48:51],v[60:63]
 v_mov_b32 v210,0
 v_mov_b32 v211,0
 v_mov_b32 v212,0
 v_mov_b32 v213,0
 v_mfma_f32_16x16x32_bf16 v[60:63],a[180:183],a[52:55],v[60:63]
 v_mov_b32 v214,0
 v_mov_b32 v215,0
 v_cvt_pk_bf16_f32 v232,v152,v153
 v_cvt_pk_bf16_f32 v233,v154,v155
 v_mfma_f32_16x16x32_bf16 v[60:63],a[184:187],a[56:59],v[60:63]
 v_cvt_pk_bf16_f32 v234,v156,v157
 v_cvt_pk_bf16_f32 v235,v158,v159
 v_mfma_f32_16x16x32_bf16 v[60:63],a[188:191],a[60:63],v[60:63]
 buffer_store_dwordx4 v[232:235],v1,s[28:31],s75 offen offset:3072 sc1
 v_mov_b32 v152,0
 v_mov_b32 v153,0
 v_mov_b32 v154,0
 v_mov_b32 v155,0
 v_mov_b32 v156,0
 v_mov_b32 v157,0
 v_mov_b32 v158,0
 v_mov_b32 v159,0
 v_cvt_pk_bf16_f32 v236,v216,v217
 v_cvt_pk_bf16_f32 v237,v218,v219
 v_cvt_pk_bf16_f32 v238,v220,v221
 v_cvt_pk_bf16_f32 v239,v222,v223
 buffer_store_dwordx4 v[236:239],v243,s[28:31],s75 offen offset:3072 sc1
 v_mov_b32 v216,0
 v_mov_b32 v217,0
 v_mov_b32 v218,0
 v_mov_b32 v219,0
 v_mov_b32 v220,0
 v_mov_b32 v221,0
 v_mov_b32 v222,0
 v_mov_b32 v223,0
 s_branch K2_QK0E
K2_LAST:
K2_FIN:
 s_barrier
 v_mfma_f32_16x16x32_bf16 v[80:83],a[64:67],a[32:35],v[28:31]
 ds_read_b128 a[116:119],v1 offset:46080
 ds_read_b128 a[120:123],v1 offset:47104
 ds_read_b128 a[124:127],v1 offset:48128
 v_mfma_f32_16x16x32_bf16 v[80:83],a[68:71],a[36:39],v[80:83]
 ds_read_b128 a[128:131],v1 offset:49152
 ds_read_b128 a[132:135],v1 offset:50176
 s_add_u32 m0,s51,98304
 v_mfma_f32_16x16x32_bf16 v[80:83],a[72:75],a[40:43],v[80:83]
 ds_read_b128 a[136:139],v1 offset:51200
 v_exp_f32 v54,v54
 v_mfma_f32_16x16x32_bf16 v[80:83],a[76:79],a[44:47],v[80:83]
 ds_read_b128 a[140:143],v1 offset:52224
 v_exp_f32 v55,v55
 v_mfma_f32_16x16x32_bf16 v[80:83],a[80:83],a[48:51],v[80:83]
 v_exp_f32 v40,v40
 v_add_f32 v7,v7,v54
 v_mfma_f32_16x16x32_bf16 v[80:83],a[84:87],a[52:55],v[80:83]
 buffer_load_dwordx4 v14,s[28:31],s33 offen offset:0 sc1 lds
 ds_read_b128 a[144:147],v1 offset:53248
 v_mfma_f32_16x16x32_bf16 v[80:83],a[88:91],a[56:59],v[80:83]
 v_exp_f32 v41,v41
 v_add_f32 v7,v7,v55
 v_mfma_f32_16x16x32_bf16 v[80:83],a[92:95],a[60:63],v[80:83]
 s_waitcnt lgkmcnt(5)
 ds_read_b128 a[148:151],v1 offset:54272
 v_cvt_pk_bf16_f32 v51,v54,v55
 v_mfma_f32_16x16x32_bf16 v[84:87],a[96:99],a[32:35],v[28:31]
 buffer_load_dwordx4 v14,s[28:31],s33 offen offset:1024 sc1 lds
 ds_read_b128 a[152:155],v1 offset:55296
 v_mfma_f32_16x16x32_bf16 v[84:87],a[100:103],a[36:39],v[84:87]
 v_exp_f32 v56,v56
 v_add_f32 v6,v6,v40
 v_mfma_f32_16x16x32_bf16 v[84:87],a[104:107],a[40:43],v[84:87]
 ds_read_b128 a[156:159],v1 offset:56320
 v_exp_f32 v57,v57
 v_mfma_f32_16x16x32_bf16 v[84:87],a[108:111],a[44:47],v[84:87]
 buffer_load_dwordx4 v14,s[28:31],s33 offen offset:2048 sc1 lds
 v_add_f32 v6,v6,v41
 v_mfma_f32_16x16x32_bf16 v[84:87],a[112:115],a[48:51],v[84:87]
 ds_read_b128 a[160:163],v1 offset:57344
 v_cvt_pk_bf16_f32 v40,v40,v41
 ds_read_b128 a[164:167],v1 offset:58368
 v_mfma_f32_16x16x32_bf16 v[84:87],a[116:119],a[52:55],v[84:87]
 v_exp_f32 v42,v42
 v_add_f32 v7,v7,v56
 v_mfma_f32_16x16x32_bf16 v[84:87],a[120:123],a[56:59],v[84:87]
 ds_read_b128 a[168:171],v1 offset:59392
 buffer_load_dwordx4 v14,s[28:31],s33 offen offset:3072 sc1 lds
 v_mfma_f32_16x16x32_bf16 v[84:87],a[124:127],a[60:63],v[84:87]
 s_waitcnt lgkmcnt(3)
 ds_read_b128 a[172:175],v1 offset:60416
 s_add_u32 m0,s51,102400
 v_mfma_f32_16x16x32_bf16 v[88:91],a[128:131],a[32:35],v[28:31]
 ds_read_b128 a[176:179],v1 offset:61440
 v_exp_f32 v43,v43
 v_mfma_f32_16x16x32_bf16 v[88:91],a[132:135],a[36:39],v[88:91]
 ds_read_b128 a[180:183],v1 offset:62464
 v_add_f32 v7,v7,v57
 v_cvt_pk_bf16_f32 v56,v56,v57
 v_mfma_f32_16x16x32_bf16 v[88:91],a[136:139],a[40:43],v[88:91]
 ds_read_b128 a[184:187],v1 offset:63488
 v_exp_f32 v58,v58
 v_mfma_f32_16x16x32_bf16 v[88:91],a[140:143],a[44:47],v[88:91]
 buffer_load_dwordx4 v15,s[28:31],s33 offen offset:0 sc1 lds
 ds_read_b128 a[188:191],v1 offset:64512
 v_mfma_f32_16x16x32_bf16 v[88:91],a[144:147],a[48:51],v[88:91]
 buffer_load_dwordx4 v15,s[28:31],s33 offen offset:1024 sc1 lds
 v_add_f32 v6,v6,v42
 v_mfma_f32_16x16x32_bf16 v[88:91],a[148:151],a[52:55],v[88:91]
 buffer_load_dwordx4 v15,s[28:31],s33 offen offset:2048 sc1 lds
 v_mfma_f32_16x16x32_bf16 v[88:91],a[152:155],a[56:59],v[88:91]
 buffer_load_dwordx4 v15,s[28:31],s33 offen offset:3072 sc1 lds
 v_mfma_f32_16x16x32_bf16 v[88:91],a[156:159],a[60:63],v[88:91]
 s_waitcnt vmcnt(16) lgkmcnt(0)
 s_barrier
 v_mfma_f32_16x16x32_bf16 v[92:95],a[160:163],a[32:35],v[28:31]
 v_exp_f32 v59,v59
 v_add_f32 v6,v6,v43
 v_mfma_f32_16x16x32_bf16 v[92:95],a[164:167],a[36:39],v[92:95]
 v_cvt_pk_bf16_f32 v41,v42,v43
 v_exp_f32 v44,v44
 v_mfma_f32_16x16x32_bf16 v[92:95],a[168:171],a[40:43],v[92:95]
 ds_read_b128 a[64:67],v2 offset:0
 v_readlane_b32 s32,v252,s38
 v_mfma_f32_16x16x32_bf16 v[92:95],a[172:175],a[44:47],v[92:95]
 ds_read_b128 a[68:71],v2 offset:1024
 v_add_f32 v7,v7,v58
 ds_read_b128 a[72:75],v2 offset:2048
 v_mfma_f32_16x16x32_bf16 v[92:95],a[176:179],a[48:51],v[92:95]
 v_exp_f32 v45,v45
 v_add_f32 v7,v7,v59
 v_mfma_f32_16x16x32_bf16 v[92:95],a[180:183],a[52:55],v[92:95]
 ds_read_b128 a[76:79],v2 offset:3072
 v_cvt_pk_bf16_f32 v57,v58,v59
 v_exp_f32 v60,v60
 v_add_f32 v6,v6,v44
 v_exp_f32 v61,v61
 v_add_f32 v6,v6,v45
 v_cvt_pk_bf16_f32 v42,v44,v45
 v_exp_f32 v46,v46
 v_add_f32 v7,v7,v60
 v_exp_f32 v47,v47
 v_add_f32 v7,v7,v61
 v_cvt_pk_bf16_f32 v58,v60,v61
 v_exp_f32 v62,v62
 v_add_f32 v6,v6,v46
 v_exp_f32 v63,v63
 v_add_f32 v6,v6,v47
 v_cvt_pk_bf16_f32 v43,v46,v47
 v_add_f32 v7,v7,v62
 v_add_f32 v7,v7,v63
 v_cvt_pk_bf16_f32 v59,v62,v63
 v_mfma_f32_16x16x32_bf16 v[92:95],a[184:187],a[56:59],v[92:95]
 ds_read_b128 a[80:83],v2 offset:4096
 ds_read_b128 a[84:87],v2 offset:5120
 v_cmp_lt_u32 vcc,v242,v241
 v_mfma_f32_16x16x32_bf16 v[92:95],a[188:191],a[60:63],v[92:95]
 s_waitcnt lgkmcnt(2)
 ds_read_b128 a[88:91],v2 offset:6144
 ds_read_b128 a[92:95],v2 offset:7168
 v_mfma_f32_16x16x32_bf16 v[96:99],a[64:67],v[32:35],v[96:99]
 ds_read_b128 a[96:99],v2 offset:8192
 v_mfma_f32_16x16x32_bf16 v[96:99],a[68:71],v[40:43],v[96:99]
 s_cbranch_vccnz FF_37
FF_37R:
 ds_read_b128 a[100:103],v2 offset:9216
 v_mfma_f32_16x16x32_bf16 v[160:163],a[64:67],v[48:51],v[160:163]
 ds_read_b128 a[104:107],v2 offset:10240
 s_add_u32 m0,s51,32768
 v_mfma_f32_16x16x32_bf16 v[160:163],a[68:71],v[56:59],v[160:163]
 ds_read_b128 a[108:111],v2 offset:11264
 v_cmp_gt_i32 s[22:23],0,v255
 v_cmp_gt_i32 s[24:25],1,v255
 v_mfma_f32_16x16x32_bf16 v[100:103],a[72:75],v[32:35],v[100:103]
 ds_read_b128 a[112:115],v2 offset:12288
 v_cmp_gt_i32 s[26:27],2,v255
 v_cndmask_b32 v80,v80,v4,s[22:23]
 v_mfma_f32_16x16x32_bf16 v[100:103],a[76:79],v[40:43],v[100:103]
 buffer_load_dwordx4 v14,s[28:31],s32 offen offset:0 sc1 lds
 ds_read_b128 a[116:119],v2 offset:13312
 v_mfma_f32_16x16x32_bf16 v[164:167],a[72:75],v[48:51],v[164:167]
 ds_read_b128 a[120:123],v2 offset:14336
 v_cmp_gt_i32 s[22:23],3,v255
 v_cndmask_b32 v81,v81,v4,s[24:25]
 v_mfma_f32_16x16x32_bf16 v[164:167],a[76:79],v[56:59],v[164:167]
 s_waitcnt lgkmcnt(7)
 v_cmp_gt_i32 s[24:25],16,v255
 v_cndmask_b32 v82,v82,v4,s[26:27]
 v_mfma_f32_16x16x32_bf16 v[104:107],a[80:83],v[32:35],v[104:107]
 buffer_load_dwordx4 v14,s[28:31],s32 offen offset:1024 sc1 lds
 ds_read_b128 a[124:127],v2 offset:15360
 v_mfma_f32_16x16x32_bf16 v[104:107],a[84:87],v[40:43],v[104:107]
 ds_read_b128 a[128:131],v2 offset:16384
 v_cmp_gt_i32 s[26:27],17,v255
 v_cndmask_b32 v83,v83,v4,s[22:23]
 v_mfma_f32_16x16x32_bf16 v[168:171],a[80:83],v[48:51],v[168:171]
 buffer_load_dwordx4 v14,s[28:31],s32 offen offset:2048 sc1 lds
 v_cmp_gt_i32 s[22:23],18,v255
 v_mfma_f32_16x16x32_bf16 v[168:171],a[84:87],v[56:59],v[168:171]
 ds_read_b128 a[132:135],v2 offset:17408
 v_cndmask_b32 v84,v84,v4,s[24:25]
 v_cmp_gt_i32 s[24:25],19,v255
 v_mfma_f32_16x16x32_bf16 v[108:111],a[88:91],v[32:35],v[108:111]
 ds_read_b128 a[136:139],v2 offset:18432
 v_cndmask_b32 v85,v85,v4,s[26:27]
 v_cmp_gt_i32 s[26:27],32,v255
 v_mfma_f32_16x16x32_bf16 v[108:111],a[92:95],v[40:43],v[108:111]
 buffer_load_dwordx4 v14,s[28:31],s32 offen offset:3072 sc1 lds
 v_cndmask_b32 v86,v86,v4,s[22:23]
 v_mfma_f32_16x16x32_bf16 v[172:175],a[88:91],v[48:51],v[172:175]
 ds_read_b128 a[140:143],v2 offset:19456
 v_cmp_gt_i32 s[22:23],33,v255
 v_cndmask_b32 v87,v87,v4,s[24:25]
 v_mfma_f32_16x16x32_bf16 v[172:175],a[92:95],v[56:59],v[172:175]
 s_waitcnt lgkmcnt(4)
 s_add_u32 m0,s51,36864
 v_cmp_gt_i32 s[24:25],34,v255
 v_mfma_f32_16x16x32_bf16 v[112:115],a[96:99],v[32:35],v[112:115]
 ds_read_b128 a[144:147],v2 offset:20480
 v_cndmask_b32 v88,v88,v4,s[26:27]
 v_cmp_gt_i32 s[26:27],35,v255
 v_mfma_f32_16x16x32_bf16 v[112:115],a[100:103],v[40:43],v[112:115]
 buffer_load_dwordx4 v15,s[28:31],s32 offen offset:0 sc1 lds
 v_cndmask_b32 v89,v89,v4,s[22:23]
 v_mfma_f32_16x16x32_bf16 v[176:179],a[96:99],v[48:51],v[176:179]
 ds_read_b128 a[148:151],v2 offset:21504
 v_cmp_gt_i32 s[22:23],48,v255
 v_cndmask_b32 v90,v90,v4,s[24:25]
 v_mfma_f32_16x16x32_bf16 v[176:179],a[100:103],v[56:59],v[176:179]
 v_cmp_gt_i32 s[24:25],49,v255
 v_cndmask_b32 v91,v91,v4,s[26:27]
 v_cmp_gt_i32 s[26:27],50,v255
 v_mfma_f32_16x16x32_bf16 v[116:119],a[104:107],v[32:35],v[116:119]
 buffer_load_dwordx4 v15,s[28:31],s32 offen offset:1024 sc1 lds
 ds_read_b128 a[152:155],v2 offset:22528
 v_mfma_f32_16x16x32_bf16 v[116:119],a[108:111],v[40:43],v[116:119]
 v_cndmask_b32 v92,v92,v4,s[22:23]
 v_cmp_gt_i32 s[22:23],51,v255
 v_cndmask_b32 v93,v93,v4,s[24:25]
 v_mfma_f32_16x16x32_bf16 v[180:183],a[104:107],v[48:51],v[180:183]
 buffer_load_dwordx4 v15,s[28:31],s32 offen offset:2048 sc1 lds
 ds_read_b128 a[156:159],v2 offset:23552
 v_mfma_f32_16x16x32_bf16 v[180:183],a[108:111],v[56:59],v[180:183]
 s_nop 0
 v_cndmask_b32 v94,v94,v4,s[26:27]
 s_nop 0
 v_mfma_f32_16x16x32_bf16 v[120:123],a[112:115],v[32:35],v[120:123]
 buffer_load_dwordx4 v15,s[28:31],s32 offen offset:3072 sc1 lds
 v_cndmask_b32 v95,v95,v4,s[22:23]
 v_mfma_f32_16x16x32_bf16 v[120:123],a[116:119],v[40:43],v[120:123]
 ds_read_b128 a[160:163],v2 offset:24576
 s_nop 0
 v_max3_f32 v9,v80,v81,v82
 v_mfma_f32_16x16x32_bf16 v[184:187],a[112:115],v[48:51],v[184:187]
 ds_read_b128 a[164:167],v2 offset:25600
 v_max3_f32 v16,v83,v84,v85
 v_max3_f32 v9,v9,v86,v87
 v_mfma_f32_16x16x32_bf16 v[184:187],a[116:119],v[56:59],v[184:187]
 buffer_load_dwordx4 v[244:247],v1,s[28:31],s66 offen sc1
 v_max3_f32 v16,v16,v88,v89
 v_mfma_f32_16x16x32_bf16 v[124:127],a[120:123],v[32:35],v[124:127]
 ds_read_b128 a[168:171],v2 offset:26624
 v_max3_f32 v9,v9,v90,v91
 v_max3_f32 v16,v16,v92,v93
 v_mfma_f32_16x16x32_bf16 v[124:127],a[124:127],v[40:43],v[124:127]
 v_max3_f32 v9,v9,v94,v95
 s_add_u32 s61,s65,0
 v_max_f32 v9,v9,v16
 v_mfma_f32_16x16x32_bf16 v[188:191],a[120:123],v[48:51],v[188:191]
 ds_read_b128 a[172:175],v2 offset:27648
 v_cmp_lt_f32 vcc,s49,v9
 ds_read_b128 a[176:179],v2 offset:28672
 v_mfma_f32_16x16x32_bf16 v[188:191],a[124:127],v[56:59],v[188:191]
 s_waitcnt lgkmcnt(5)
 buffer_load_dwordx4 a[0:3],v1,s[28:31],s61 offen offset:0 sc1
 v_mfma_f32_16x16x32_bf16 v[128:131],a[128:131],v[32:35],v[128:131]
 buffer_load_dwordx4 a[4:7],v1,s[28:31],s61 offen offset:1024 sc1
 ds_read_b128 a[180:183],v2 offset:29696
 v_mfma_f32_16x16x32_bf16 v[128:131],a[132:135],v[40:43],v[128:131]
 s_cbranch_vccnz FR_38
FR_38R:
 buffer_load_dwordx4 a[8:11],v1,s[28:31],s61 offen offset:2048 sc1
 v_mfma_f32_16x16x32_bf16 v[192:195],a[128:131],v[48:51],v[192:195]
 ds_read_b128 a[184:187],v2 offset:30720
 v_exp_f32 v80,v80
 v_mfma_f32_16x16x32_bf16 v[192:195],a[132:135],v[56:59],v[192:195]
 v_exp_f32 v81,v81
 v_mfma_f32_16x16x32_bf16 v[132:135],a[136:139],v[32:35],v[132:135]
 buffer_load_dwordx4 a[12:15],v1,s[28:31],s61 offen offset:3072 sc1
 ds_read_b128 a[188:191],v2 offset:31744
 v_mfma_f32_16x16x32_bf16 v[132:135],a[140:143],v[40:43],v[132:135]
 v_exp_f32 v82,v82
 v_add_f32 v7,v7,v80
 v_mfma_f32_16x16x32_bf16 v[196:199],a[136:139],v[48:51],v[196:199]
 v_exp_f32 v83,v83
 v_add_f32 v7,v7,v81
 v_mfma_f32_16x16x32_bf16 v[196:199],a[140:143],v[56:59],v[196:199]
 s_add_u32 s61,s65,4096
 v_cvt_pk_bf16_f32 v80,v80,v81
 v_mfma_f32_16x16x32_bf16 v[136:139],a[144:147],v[32:35],v[136:139]
 v_exp_f32 v84,v84
 v_add_f32 v7,v7,v82
 v_mfma_f32_16x16x32_bf16 v[136:139],a[148:151],v[40:43],v[136:139]
 buffer_load_dwordx4 a[16:19],v1,s[28:31],s61 offen offset:0 sc1
 v_mfma_f32_16x16x32_bf16 v[200:203],a[144:147],v[48:51],v[200:203]
 v_exp_f32 v85,v85
 v_add_f32 v7,v7,v83
 v_mfma_f32_16x16x32_bf16 v[200:203],a[148:151],v[56:59],v[200:203]
 buffer_load_dwordx4 a[20:23],v1,s[28:31],s61 offen offset:1024 sc1
 v_cvt_pk_bf16_f32 v81,v82,v83
 v_mfma_f32_16x16x32_bf16 v[140:143],a[152:155],v[32:35],v[140:143]
 v_exp_f32 v86,v86
 v_add_f32 v7,v7,v84
 v_mfma_f32_16x16x32_bf16 v[140:143],a[156:159],v[40:43],v[140:143]
 v_exp_f32 v87,v87
 v_add_f32 v7,v7,v85
 v_mfma_f32_16x16x32_bf16 v[204:207],a[152:155],v[48:51],v[204:207]
 s_waitcnt vmcnt(15) lgkmcnt(0)
 s_barrier
 v_cvt_pk_bf16_f32 v82,v84,v85
 v_mfma_f32_16x16x32_bf16 v[204:207],a[156:159],v[56:59],v[204:207]
 v_exp_f32 v88,v88
 v_add_f32 v7,v7,v86
 v_mfma_f32_16x16x32_bf16 v[144:147],a[160:163],v[32:35],v[144:147]
 v_exp_f32 v89,v89
 v_add_f32 v7,v7,v87
 v_mfma_f32_16x16x32_bf16 v[144:147],a[164:167],v[40:43],v[144:147]
 ds_read_b128 a[64:67],v2 offset:32768
 buffer_load_dwordx4 a[24:27],v1,s[28:31],s61 offen offset:2048 sc1
 v_mfma_f32_16x16x32_bf16 v[208:211],a[160:163],v[48:51],v[208:211]
 ds_read_b128 a[68:71],v2 offset:33792
 v_cvt_pk_bf16_f32 v83,v86,v87
 ds_read_b128 a[72:75],v2 offset:34816
 v_mfma_f32_16x16x32_bf16 v[208:211],a[164:167],v[56:59],v[208:211]
 v_exp_f32 v90,v90
 v_add_f32 v7,v7,v88
 v_mfma_f32_16x16x32_bf16 v[148:151],a[168:171],v[32:35],v[148:151]
 buffer_load_dwordx4 a[28:31],v1,s[28:31],s61 offen offset:3072 sc1
 ds_read_b128 a[76:79],v2 offset:35840
 v_mfma_f32_16x16x32_bf16 v[148:151],a[172:175],v[40:43],v[148:151]
 v_exp_f32 v91,v91
 v_add_f32 v7,v7,v89
 v_mfma_f32_16x16x32_bf16 v[212:215],a[168:171],v[48:51],v[212:215]
 ds_read_b128 a[80:83],v2 offset:36864
 v_cvt_pk_bf16_f32 v88,v88,v89
 s_add_u32 s61,s65,0
 v_mfma_f32_16x16x32_bf16 v[212:215],a[172:175],v[56:59],v[212:215]
 ds_read_b128 a[84:87],v2 offset:37888
 v_exp_f32 v92,v92
 v_mfma_f32_16x16x32_bf16 v[152:155],a[176:179],v[32:35],v[152:155]
 ds_read_b128 a[88:91],v2 offset:38912
 v_add_f32 v7,v7,v90
 ds_read_b128 a[92:95],v2 offset:39936
 v_mfma_f32_16x16x32_bf16 v[152:155],a[180:183],v[40:43],v[152:155]
 v_exp_f32 v93,v93
 v_add_f32 v7,v7,v91
 v_mfma_f32_16x16x32_bf16 v[216:219],a[176:179],v[48:51],v[216:219]
 ds_read_b128 a[96:99],v2 offset:40960
 buffer_load_dwordx4 a[32:35],v243,s[28:31],s61 offen offset:0 sc1
 v_mfma_f32_16x16x32_bf16 v[216:219],a[180:183],v[56:59],v[216:219]
 ds_read_b128 a[100:103],v2 offset:41984
 v_cvt_pk_bf16_f32 v89,v90,v91
 ds_read_b128 a[104:107],v2 offset:43008
 v_mfma_f32_16x16x32_bf16 v[156:159],a[184:187],v[32:35],v[156:159]
 v_exp_f32 v94,v94
 v_add_f32 v7,v7,v92
 v_mfma_f32_16x16x32_bf16 v[156:159],a[188:191],v[40:43],v[156:159]
 ds_read_b128 a[108:111],v2 offset:44032
 v_exp_f32 v95,v95
 v_add_f32 v7,v7,v93
 v_cvt_pk_bf16_f32 v90,v92,v93
 v_add_f32 v7,v7,v94
 v_add_f32 v7,v7,v95
 v_cvt_pk_bf16_f32 v91,v94,v95
 v_mfma_f32_16x16x32_bf16 v[220:223],a[184:187],v[48:51],v[220:223]
 ds_read_b128 a[112:115],v2 offset:45056
 buffer_load_dwordx4 a[36:39],v243,s[28:31],s61 offen offset:1024 sc1
 v_mfma_f32_16x16x32_bf16 v[220:223],a[188:191],v[56:59],v[220:223]
 s_waitcnt lgkmcnt(5)
 s_cbranch_vccnz FO_39
FO_39R:
 ds_read_b128 a[116:119],v2 offset:46080
 v_mfma_f32_16x16x32_bf16 v[160:163],a[64:67],v[80:83],v[160:163]
 ds_read_b128 a[120:123],v2 offset:47104
 buffer_load_dwordx4 a[40:43],v243,s[28:31],s61 offen offset:2048 sc1
 v_mfma_f32_16x16x32_bf16 v[160:163],a[68:71],v[88:91],v[160:163]
 ds_read_b128 a[124:127],v2 offset:48128
 buffer_load_dwordx4 a[44:47],v243,s[28:31],s61 offen offset:3072 sc1
 v_mfma_f32_16x16x32_bf16 v[164:167],a[72:75],v[80:83],v[164:167]
 ds_read_b128 a[128:131],v2 offset:49152
 s_add_u32 s61,s65,4096
 ds_read_b128 a[132:135],v2 offset:50176
 v_mfma_f32_16x16x32_bf16 v[164:167],a[76:79],v[88:91],v[164:167]
 buffer_load_dwordx4 a[48:51],v243,s[28:31],s61 offen offset:0 sc1
 ds_read_b128 a[136:139],v2 offset:51200
 v_mfma_f32_16x16x32_bf16 v[168:171],a[80:83],v[80:83],v[168:171]
 buffer_load_dwordx4 a[52:55],v243,s[28:31],s61 offen offset:1024 sc1
 ds_read_b128 a[140:143],v2 offset:52224
 v_mfma_f32_16x16x32_bf16 v[168:171],a[84:87],v[88:91],v[168:171]
 buffer_load_dwordx4 a[56:59],v243,s[28:31],s61 offen offset:2048 sc1
 ds_read_b128 a[144:147],v2 offset:53248
 v_mfma_f32_16x16x32_bf16 v[172:175],a[88:91],v[80:83],v[172:175]
 ds_read_b128 a[148:151],v2 offset:54272
 buffer_load_dwordx4 a[60:63],v243,s[28:31],s61 offen offset:3072 sc1
 v_mfma_f32_16x16x32_bf16 v[172:175],a[92:95],v[88:91],v[172:175]
 s_waitcnt lgkmcnt(6)
 ds_read_b128 a[152:155],v2 offset:55296
 ds_read_b128 a[156:159],v2 offset:56320
 v_mfma_f32_16x16x32_bf16 v[176:179],a[96:99],v[80:83],v[176:179]
 s_add_u32 m0,s51,65536
 ds_read_b128 a[160:163],v2 offset:57344
 ds_read_b128 a[164:167],v2 offset:58368
 v_mfma_f32_16x16x32_bf16 v[176:179],a[100:103],v[88:91],v[176:179]
 buffer_load_dwordx4 v14,s[28:31],s64 offen offset:0 sc1 lds
 ds_read_b128 a[168:171],v2 offset:59392
 v_mfma_f32_16x16x32_bf16 v[180:183],a[104:107],v[80:83],v[180:183]
 ds_read_b128 a[172:175],v2 offset:60416
 buffer_load_dwordx4 v14,s[28:31],s64 offen offset:1024 sc1 lds
 v_mfma_f32_16x16x32_bf16 v[180:183],a[108:111],v[88:91],v[180:183]
 ds_read_b128 a[176:179],v2 offset:61440
 v_mfma_f32_16x16x32_bf16 v[184:187],a[112:115],v[80:83],v[184:187]
 ds_read_b128 a[180:183],v2 offset:62464
 buffer_load_dwordx4 v14,s[28:31],s64 offen offset:2048 sc1 lds
 v_mfma_f32_16x16x32_bf16 v[184:187],a[116:119],v[88:91],v[184:187]
 ds_read_b128 a[184:187],v2 offset:63488
 v_mfma_f32_16x16x32_bf16 v[188:191],a[120:123],v[80:83],v[188:191]
 ds_read_b128 a[188:191],v2 offset:64512
 buffer_load_dwordx4 v14,s[28:31],s64 offen offset:3072 sc1 lds
 v_mfma_f32_16x16x32_bf16 v[188:191],a[124:127],v[88:91],v[188:191]
 s_waitcnt lgkmcnt(8)
 v_mfma_f32_16x16x32_bf16 v[192:195],a[128:131],v[80:83],v[192:195]
 s_add_u32 m0,s51,69632
 v_mfma_f32_16x16x32_bf16 v[192:195],a[132:135],v[88:91],v[192:195]
 ds_read_b128 a[64:67],v1 offset:0
 v_mfma_f32_16x16x32_bf16 v[196:199],a[136:139],v[80:83],v[196:199]
 ds_read_b128 a[68:71],v1 offset:1024
 buffer_load_dwordx4 v15,s[28:31],s64 offen offset:0 sc1 lds
 v_mfma_f32_16x16x32_bf16 v[196:199],a[140:143],v[88:91],v[196:199]
 ds_read_b128 a[72:75],v1 offset:2048
 v_mfma_f32_16x16x32_bf16 v[200:203],a[144:147],v[80:83],v[200:203]
 ds_read_b128 a[76:79],v1 offset:3072
 buffer_load_dwordx4 v15,s[28:31],s64 offen offset:1024 sc1 lds
 v_mfma_f32_16x16x32_bf16 v[200:203],a[148:151],v[88:91],v[200:203]
 ds_read_b128 a[80:83],v1 offset:4096
 v_mfma_f32_16x16x32_bf16 v[204:207],a[152:155],v[80:83],v[204:207]
 ds_read_b128 a[84:87],v1 offset:5120
 buffer_load_dwordx4 v15,s[28:31],s64 offen offset:2048 sc1 lds
 v_mfma_f32_16x16x32_bf16 v[204:207],a[156:159],v[88:91],v[204:207]
 s_waitcnt lgkmcnt(6)
 ds_read_b128 a[88:91],v1 offset:6144
 v_mfma_f32_16x16x32_bf16 v[208:211],a[160:163],v[80:83],v[208:211]
 ds_read_b128 a[92:95],v1 offset:7168
 buffer_load_dwordx4 v15,s[28:31],s64 offen offset:3072 sc1 lds
 v_mfma_f32_16x16x32_bf16 v[208:211],a[164:167],v[88:91],v[208:211]
 ds_read_b128 a[96:99],v1 offset:8192
 v_mfma_f32_16x16x32_bf16 v[212:215],a[168:171],v[80:83],v[212:215]
 ds_read_b128 a[100:103],v1 offset:9216
 s_add_u32 s64,s64,32768
 v_mfma_f32_16x16x32_bf16 v[212:215],a[172:175],v[88:91],v[212:215]
 ds_read_b128 a[104:107],v1 offset:10240
 v_mfma_f32_16x16x32_bf16 v[216:219],a[176:179],v[80:83],v[216:219]
 ds_read_b128 a[108:111],v1 offset:11264
 v_mfma_f32_16x16x32_bf16 v[216:219],a[180:183],v[88:91],v[216:219]
 ds_read_b128 a[112:115],v1 offset:12288
 v_mfma_f32_16x16x32_bf16 v[220:223],a[184:187],v[80:83],v[220:223]
 v_mfma_f32_16x16x32_bf16 v[220:223],a[188:191],v[88:91],v[220:223]
 s_cmp_eq_u32 s44,1
 s_cbranch_scc1 K2_COMB
 v_mov_b32 v11,0
 v_mov_b32 v13,0
 v_cvt_pk_bf16_f32 v96,v96,v97
 v_cvt_pk_bf16_f32 v97,v98,v99
 v_cvt_pk_bf16_f32 v98,v100,v101
 v_cvt_pk_bf16_f32 v99,v102,v103
 v_cvt_pk_bf16_f32 v100,v104,v105
 v_cvt_pk_bf16_f32 v101,v106,v107
 v_cvt_pk_bf16_f32 v102,v108,v109
 v_cvt_pk_bf16_f32 v103,v110,v111
 v_cvt_pk_bf16_f32 v104,v112,v113
 v_cvt_pk_bf16_f32 v105,v114,v115
 v_cvt_pk_bf16_f32 v106,v116,v117
 v_cvt_pk_bf16_f32 v107,v118,v119
 v_cvt_pk_bf16_f32 v108,v120,v121
 v_cvt_pk_bf16_f32 v109,v122,v123
 v_cvt_pk_bf16_f32 v110,v124,v125
 v_cvt_pk_bf16_f32 v111,v126,v127
 v_cvt_pk_bf16_f32 v112,v128,v129
 v_cvt_pk_bf16_f32 v113,v130,v131
 v_cvt_pk_bf16_f32 v114,v132,v133
 v_cvt_pk_bf16_f32 v115,v134,v135
 v_cvt_pk_bf16_f32 v116,v136,v137
 v_cvt_pk_bf16_f32 v117,v138,v139
 v_cvt_pk_bf16_f32 v118,v140,v141
 v_cvt_pk_bf16_f32 v119,v142,v143
 v_cvt_pk_bf16_f32 v120,v144,v145
 v_cvt_pk_bf16_f32 v121,v146,v147
 v_cvt_pk_bf16_f32 v122,v148,v149
 v_cvt_pk_bf16_f32 v123,v150,v151
 v_cvt_pk_bf16_f32 v124,v152,v153
 v_cvt_pk_bf16_f32 v125,v154,v155
 v_cvt_pk_bf16_f32 v126,v156,v157
 v_cvt_pk_bf16_f32 v127,v158,v159
 v_cvt_pk_bf16_f32 v128,v160,v161
 v_cvt_pk_bf16_f32 v129,v162,v163
 v_cvt_pk_bf16_f32 v130,v164,v165
 v_cvt_pk_bf16_f32 v131,v166,v167
 v_cvt_pk_bf16_f32 v132,v168,v169
 v_cvt_pk_bf16_f32 v133,v170,v171
 v_cvt_pk_bf16_f32 v134,v172,v173
 v_cvt_pk_bf16_f32 v135,v174,v175
 v_cvt_pk_bf16_f32 v136,v176,v177
 v_cvt_pk_bf16_f32 v137,v178,v179
 v_cvt_pk_bf16_f32 v138,v180,v181
 v_cvt_pk_bf16_f32 v139,v182,v183
 v_cvt_pk_bf16_f32 v140,v184,v185
 v_cvt_pk_bf16_f32 v141,v186,v187
 v_cvt_pk_bf16_f32 v142,v188,v189
 v_cvt_pk_bf16_f32 v143,v190,v191
 v_cvt_pk_bf16_f32 v144,v192,v193
 v_cvt_pk_bf16_f32 v145,v194,v195
 v_cvt_pk_bf16_f32 v146,v196,v197
 v_cvt_pk_bf16_f32 v147,v198,v199
 v_cvt_pk_bf16_f32 v148,v200,v201
 v_cvt_pk_bf16_f32 v149,v202,v203
 v_cvt_pk_bf16_f32 v150,v204,v205
 v_cvt_pk_bf16_f32 v151,v206,v207
 v_cvt_pk_bf16_f32 v152,v208,v209
 v_cvt_pk_bf16_f32 v153,v210,v211
 v_cvt_pk_bf16_f32 v154,v212,v213
 v_cvt_pk_bf16_f32 v155,v214,v215
 v_cvt_pk_bf16_f32 v156,v216,v217
 v_cvt_pk_bf16_f32 v157,v218,v219
 v_cvt_pk_bf16_f32 v158,v220,v221
 v_cvt_pk_bf16_f32 v159,v222,v223
 s_branch K2_PACKED
K2_COMB:
 s_waitcnt vmcnt(8)
 v_sub_f32 v11,v24,v244
 v_sub_f32 v13,v28,v245
 v_max_f32 v16,v11,v13
 v_cmp_lt_f32 vcc,s49,v16
 s_nop 4
 s_cbranch_vccnz K2_CRS
K2_CRSR:
 v_exp_f32 v11,v11
 v_exp_f32 v13,v13
 s_nop 0
 v_accvgpr_read_b32 v18,a0
 v_lshlrev_b32 v16,16,v18
 v_and_b32 v17,0xffff0000,v18
 v_pk_fma_f32 v[96:97],v[16:17],v[10:11],v[96:97] op_sel:[0,1,0] op_sel_hi:[1,1,1]
 v_accvgpr_read_b32 v22,a1
 v_cvt_pk_bf16_f32 v96,v96,v97
 v_lshlrev_b32 v20,16,v22
 v_and_b32 v21,0xffff0000,v22
 v_pk_fma_f32 v[98:99],v[20:21],v[10:11],v[98:99] op_sel:[0,1,0] op_sel_hi:[1,1,1]
 v_accvgpr_read_b32 v18,a2
 v_cvt_pk_bf16_f32 v97,v98,v99
 v_lshlrev_b32 v16,16,v18
 v_and_b32 v17,0xffff0000,v18
 v_pk_fma_f32 v[100:101],v[16:17],v[10:11],v[100:101] op_sel:[0,1,0] op_sel_hi:[1,1,1]
 v_accvgpr_read_b32 v22,a3
 v_cvt_pk_bf16_f32 v98,v100,v101
 v_lshlrev_b32 v20,16,v22
 v_and_b32 v21,0xffff0000,v22
 v_pk_fma_f32 v[102:103],v[20:21],v[10:11],v[102:103] op_sel:[0,1,0] op_sel_hi:[1,1,1]
 v_cvt_pk_bf16_f32 v99,v102,v103
 v_accvgpr_read_b32 v18,a4
 v_lshlrev_b32 v16,16,v18
 v_and_b32 v17,0xffff0000,v18
 v_pk_fma_f32 v[104:105],v[16:17],v[10:11],v[104:105] op_sel:[0,1,0] op_sel_hi:[1,1,1]
 v_accvgpr_read_b32 v22,a5
 v_cvt_pk_bf16_f32 v100,v104,v105
 v_lshlrev_b32 v20,16,v22
 v_and_b32 v21,0xffff0000,v22
 v_pk_fma_f32 v[106:107],v[20:21],v[10:11],v[106:107] op_sel:[0,1,0] op_sel_hi:[1,1,1]
 v_accvgpr_read_b32 v18,a6
 v_cvt_pk_bf16_f32 v101,v106,v107
 v_lshlrev_b32 v16,16,v18
 v_and_b32 v17,0xffff0000,v18
 v_pk_fma_f32 v[108:109],v[16:17],v[10:11],v[108:109] op_sel:[0,1,0] op_sel_hi:[1,1,1]
 v_accvgpr_read_b32 v22,a7
 v_cvt_pk_bf16_f32 v102,v108,v109
 v_lshlrev_b32 v20,16,v22
 v_and_b32 v21,0xffff0000,v22
 v_pk_fma_f32 v[110:111],v[20:21],v[10:11],v[110:111] op_sel:[0,1,0] op_sel_hi:[1,1,1]
 v_cvt_pk_bf16_f32 v103,v110,v111
 v_accvgpr_read_b32 v18,a8
 v_lshlrev_b32 v16,16,v18
 v_and_b32 v17,0xffff0000,v18
 v_pk_fma_f32 v[112:113],v[16:17],v[10:11],v[112:113] op_sel:[0,1,0] op_sel_hi:[1,1,1]
 v_accvgpr_read_b32 v22,a9
 v_cvt_pk_bf16_f32 v104,v112,v113
 v_lshlrev_b32 v20,16,v22
 v_and_b32 v21,0xffff0000,v22
 v_pk_fma_f32 v[114:115],v[20:21],v[10:11],v[114:115] op_sel:[0,1,0] op_sel_hi:[1,1,1]
 v_accvgpr_read_b32 v18,a10
 v_cvt_pk_bf16_f32 v105,v114,v115
 v_lshlrev_b32 v16,16,v18
 v_and_b32 v17,0xffff0000,v18
 v_pk_fma_f32 v[116:117],v[16:17],v[10:11],v[116:117] op_sel:[0,1,0] op_sel_hi:[1,1,1]
 v_accvgpr_read_b32 v22,a11
 v_cvt_pk_bf16_f32 v106,v116,v117
 v_lshlrev_b32 v20,16,v22
 v_and_b32 v21,0xffff0000,v22
 v_pk_fma_f32 v[118:119],v[20:21],v[10:11],v[118:119] op_sel:[0,1,0] op_sel_hi:[1,1,1]
 v_cvt_pk_bf16_f32 v107,v118,v119
 v_accvgpr_read_b32 v18,a12
 v_lshlrev_b32 v16,16,v18
 v_and_b32 v17,0xffff0000,v18
 v_pk_fma_f32 v[120:121],v[16:17],v[10:11],v[120:121] op_sel:[0,1,0] op_sel_hi:[1,1,1]
 v_accvgpr_read_b32 v22,a13
 v_cvt_pk_bf16_f32 v108,v120,v121
 v_lshlrev_b32 v20,16,v22
 v_and_b32 v21,0xffff0000,v22
 v_pk_fma_f32 v[122:123],v[20:21],v[10:11],v[122:123] op_sel:[0,1,0] op_sel_hi:[1,1,1]
 v_accvgpr_read_b32 v18,a14
 v_cvt_pk_bf16_f32 v109,v122,v123
 v_lshlrev_b32 v16,16,v18
 v_and_b32 v17,0xffff0000,v18
 v_pk_fma_f32 v[124:125],v[16:17],v[10:11],v[124:125] op_sel:[0,1,0] op_sel_hi:[1,1,1]
 v_accvgpr_read_b32 v22,a15
 v_cvt_pk_bf16_f32 v110,v124,v125
 v_lshlrev_b32 v20,16,v22
 v_and_b32 v21,0xffff0000,v22
 v_pk_fma_f32 v[126:127],v[20:21],v[10:11],v[126:127] op_sel:[0,1,0] op_sel_hi:[1,1,1]
 v_cvt_pk_bf16_f32 v111,v126,v127
 v_accvgpr_read_b32 v18,a16
 v_lshlrev_b32 v16,16,v18
 v_and_b32 v17,0xffff0000,v18
 v_pk_fma_f32 v[128:129],v[16:17],v[10:11],v[128:129] op_sel:[0,1,0] op_sel_hi:[1,1,1]
 v_accvgpr_read_b32 v22,a17
 v_cvt_pk_bf16_f32 v112,v128,v129
 v_lshlrev_b32 v20,16,v22
 v_and_b32 v21,0xffff0000,v22
 v_pk_fma_f32 v[130:131],v[20:21],v[10:11],v[130:131] op_sel:[0,1,0] op_sel_hi:[1,1,1]
 v_accvgpr_read_b32 v18,a18
 v_cvt_pk_bf16_f32 v113,v130,v131
 v_lshlrev_b32 v16,16,v18
 v_and_b32 v17,0xffff0000,v18
 v_pk_fma_f32 v[132:133],v[16:17],v[10:11],v[132:133] op_sel:[0,1,0] op_sel_hi:[1,1,1]
 v_accvgpr_read_b32 v22,a19
 v_cvt_pk_bf16_f32 v114,v132,v133
 v_lshlrev_b32 v20,16,v22
 v_and_b32 v21,0xffff0000,v22
 v_pk_fma_f32 v[134:135],v[20:21],v[10:11],v[134:135] op_sel:[0,1,0] op_sel_hi:[1,1,1]
 v_cvt_pk_bf16_f32 v115,v134,v135
 v_accvgpr_read_b32 v18,a20
 v_lshlrev_b32 v16,16,v18
 v_and_b32 v17,0xffff0000,v18
 v_pk_fma_f32 v[136:137],v[16:17],v[10:11],v[136:137] op_sel:[0,1,0] op_sel_hi:[1,1,1]
 v_accvgpr_read_b32 v22,a21
 v_cvt_pk_bf16_f32 v116,v136,v137
 v_lshlrev_b32 v20,16,v22
 v_and_b32 v21,0xffff0000,v22
 v_pk_fma_f32 v[138:139],v[20:21],v[10:11],v[138:139] op_sel:[0,1,0] op_sel_hi:[1,1,1]
 v_accvgpr_read_b32 v18,a22
 v_cvt_pk_bf16_f32 v117,v138,v139
 v_lshlrev_b32 v16,16,v18
 v_and_b32 v17,0xffff0000,v18
 v_pk_fma_f32 v[140:141],v[16:17],v[10:11],v[140:141] op_sel:[0,1,0] op_sel_hi:[1,1,1]
 v_accvgpr_read_b32 v22,a23
 v_cvt_pk_bf16_f32 v118,v140,v141
 v_lshlrev_b32 v20,16,v22
 v_and_b32 v21,0xffff0000,v22
 v_pk_fma_f32 v[142:143],v[20:21],v[10:11],v[142:143] op_sel:[0,1,0] op_sel_hi:[1,1,1]
 v_cvt_pk_bf16_f32 v119,v142,v143
 v_accvgpr_read_b32 v18,a24
 v_lshlrev_b32 v16,16,v18
 v_and_b32 v17,0xffff0000,v18
 v_pk_fma_f32 v[144:145],v[16:17],v[10:11],v[144:145] op_sel:[0,1,0] op_sel_hi:[1,1,1]
 v_accvgpr_read_b32 v22,a25
 v_cvt_pk_bf16_f32 v120,v144,v145
 v_lshlrev_b32 v20,16,v22
 v_and_b32 v21,0xffff0000,v22
 v_pk_fma_f32 v[146:147],v[20:21],v[10:11],v[146:147] op_sel:[0,1,0] op_sel_hi:[1,1,1]
 v_accvgpr_read_b32 v18,a26
 v_cvt_pk_bf16_f32 v121,v146,v147
 v_lshlrev_b32 v16,16,v18
 v_and_b32 v17,0xffff0000,v18
 v_pk_fma_f32 v[148:149],v[16:17],v[10:11],v[148:149] op_sel:[0,1,0] op_sel_hi:[1,1,1]
 v_accvgpr_read_b32 v22,a27
 v_cvt_pk_bf16_f32 v122,v148,v149
 v_lshlrev_b32 v20,16,v22
 v_and_b32 v21,0xffff0000,v22
 v_pk_fma_f32 v[150:151],v[20:21],v[10:11],v[150:151] op_sel:[0,1,0] op_sel_hi:[1,1,1]
 v_cvt_pk_bf16_f32 v123,v150,v151
 v_accvgpr_read_b32 v18,a28
 v_lshlrev_b32 v16,16,v18
 v_and_b32 v17,0xffff0000,v18
 v_pk_fma_f32 v[152:153],v[16:17],v[10:11],v[152:153] op_sel:[0,1,0] op_sel_hi:[1,1,1]
 v_accvgpr_read_b32 v22,a29
 v_cvt_pk_bf16_f32 v124,v152,v153
 v_lshlrev_b32 v20,16,v22
 v_and_b32 v21,0xffff0000,v22
 v_pk_fma_f32 v[154:155],v[20:21],v[10:11],v[154:155] op_sel:[0,1,0] op_sel_hi:[1,1,1]
 v_accvgpr_read_b32 v18,a30
 v_cvt_pk_bf16_f32 v125,v154,v155
 v_lshlrev_b32 v16,16,v18
 v_and_b32 v17,0xffff0000,v18
 v_pk_fma_f32 v[156:157],v[16:17],v[10:11],v[156:157] op_sel:[0,1,0] op_sel_hi:[1,1,1]
 v_accvgpr_read_b32 v22,a31
 v_cvt_pk_bf16_f32 v126,v156,v157
 v_lshlrev_b32 v20,16,v22
 v_and_b32 v21,0xffff0000,v22
 v_pk_fma_f32 v[158:159],v[20:21],v[10:11],v[158:159] op_sel:[0,1,0] op_sel_hi:[1,1,1]
 v_cvt_pk_bf16_f32 v127,v158,v159
 v_accvgpr_read_b32 v18,a32
 v_lshlrev_b32 v16,16,v18
 v_and_b32 v17,0xffff0000,v18
 v_pk_fma_f32 v[160:161],v[16:17],v[12:13],v[160:161] op_sel:[0,1,0] op_sel_hi:[1,1,1]
 v_accvgpr_read_b32 v22,a33
 v_cvt_pk_bf16_f32 v128,v160,v161
 v_lshlrev_b32 v20,16,v22
 v_and_b32 v21,0xffff0000,v22
 v_pk_fma_f32 v[162:163],v[20:21],v[12:13],v[162:163] op_sel:[0,1,0] op_sel_hi:[1,1,1]
 v_accvgpr_read_b32 v18,a34
 v_cvt_pk_bf16_f32 v129,v162,v163
 v_lshlrev_b32 v16,16,v18
 v_and_b32 v17,0xffff0000,v18
 v_pk_fma_f32 v[164:165],v[16:17],v[12:13],v[164:165] op_sel:[0,1,0] op_sel_hi:[1,1,1]
 v_accvgpr_read_b32 v22,a35
 v_cvt_pk_bf16_f32 v130,v164,v165
 v_lshlrev_b32 v20,16,v22
 v_and_b32 v21,0xffff0000,v22
 v_pk_fma_f32 v[166:167],v[20:21],v[12:13],v[166:167] op_sel:[0,1,0] op_sel_hi:[1,1,1]
 v_cvt_pk_bf16_f32 v131,v166,v167
 v_accvgpr_read_b32 v18,a36
 v_lshlrev_b32 v16,16,v18
 v_and_b32 v17,0xffff0000,v18
 v_pk_fma_f32 v[168:169],v[16:17],v[12:13],v[168:169] op_sel:[0,1,0] op_sel_hi:[1,1,1]
 v_accvgpr_read_b32 v22,a37
 v_cvt_pk_bf16_f32 v132,v168,v169
 v_lshlrev_b32 v20,16,v22
 v_and_b32 v21,0xffff0000,v22
 v_pk_fma_f32 v[170:171],v[20:21],v[12:13],v[170:171] op_sel:[0,1,0] op_sel_hi:[1,1,1]
 v_accvgpr_read_b32 v18,a38
 v_cvt_pk_bf16_f32 v133,v170,v171
 v_lshlrev_b32 v16,16,v18
 v_and_b32 v17,0xffff0000,v18
 v_pk_fma_f32 v[172:173],v[16:17],v[12:13],v[172:173] op_sel:[0,1,0] op_sel_hi:[1,1,1]
 v_accvgpr_read_b32 v22,a39
 v_cvt_pk_bf16_f32 v134,v172,v173
 v_lshlrev_b32 v20,16,v22
 v_and_b32 v21,0xffff0000,v22
 v_pk_fma_f32 v[174:175],v[20:21],v[12:13],v[174:175] op_sel:[0,1,0] op_sel_hi:[1,1,1]
 v_cvt_pk_bf16_f32 v135,v174,v175
 v_accvgpr_read_b32 v18,a40
 v_lshlrev_b32 v16,16,v18
 v_and_b32 v17,0xffff0000,v18
 v_pk_fma_f32 v[176:177],v[16:17],v[12:13],v[176:177] op_sel:[0,1,0] op_sel_hi:[1,1,1]
 v_accvgpr_read_b32 v22,a41
 v_cvt_pk_bf16_f32 v136,v176,v177
 v_lshlrev_b32 v20,16,v22
 v_and_b32 v21,0xffff0000,v22
 v_pk_fma_f32 v[178:179],v[20:21],v[12:13],v[178:179] op_sel:[0,1,0] op_sel_hi:[1,1,1]
 v_accvgpr_read_b32 v18,a42
 v_cvt_pk_bf16_f32 v137,v178,v179
 v_lshlrev_b32 v16,16,v18
 v_and_b32 v17,0xffff0000,v18
 v_pk_fma_f32 v[180:181],v[16:17],v[12:13],v[180:181] op_sel:[0,1,0] op_sel_hi:[1,1,1]
 v_accvgpr_read_b32 v22,a43
 v_cvt_pk_bf16_f32 v138,v180,v181
 v_lshlrev_b32 v20,16,v22
 v_and_b32 v21,0xffff0000,v22
 v_pk_fma_f32 v[182:183],v[20:21],v[12:13],v[182:183] op_sel:[0,1,0] op_sel_hi:[1,1,1]
 v_cvt_pk_bf16_f32 v139,v182,v183
 v_accvgpr_read_b32 v18,a44
 v_lshlrev_b32 v16,16,v18
 v_and_b32 v17,0xffff0000,v18
 v_pk_fma_f32 v[184:185],v[16:17],v[12:13],v[184:185] op_sel:[0,1,0] op_sel_hi:[1,1,1]
 v_accvgpr_read_b32 v22,a45
 v_cvt_pk_bf16_f32 v140,v184,v185
 v_lshlrev_b32 v20,16,v22
 v_and_b32 v21,0xffff0000,v22
 v_pk_fma_f32 v[186:187],v[20:21],v[12:13],v[186:187] op_sel:[0,1,0] op_sel_hi:[1,1,1]
 v_accvgpr_read_b32 v18,a46
 v_cvt_pk_bf16_f32 v141,v186,v187
 v_lshlrev_b32 v16,16,v18
 v_and_b32 v17,0xffff0000,v18
 v_pk_fma_f32 v[188:189],v[16:17],v[12:13],v[188:189] op_sel:[0,1,0] op_sel_hi:[1,1,1]
 v_accvgpr_read_b32 v22,a47
 v_cvt_pk_bf16_f32 v142,v188,v189
 v_lshlrev_b32 v20,16,v22
 v_and_b32 v21,0xffff0000,v22
 v_pk_fma_f32 v[190:191],v[20:21],v[12:13],v[190:191] op_sel:[0,1,0] op_sel_hi:[1,1,1]
 v_cvt_pk_bf16_f32 v143,v190,v191
 v_accvgpr_read_b32 v18,a48
 v_lshlrev_b32 v16,16,v18
 v_and_b32 v17,0xffff0000,v18
 v_pk_fma_f32 v[192:193],v[16:17],v[12:13],v[192:193] op_sel:[0,1,0] op_sel_hi:[1,1,1]
 v_accvgpr_read_b32 v22,a49
 v_cvt_pk_bf16_f32 v144,v192,v193
 v_lshlrev_b32 v20,16,v22
 v_and_b32 v21,0xffff0000,v22
 v_pk_fma_f32 v[194:195],v[20:21],v[12:13],v[194:195] op_sel:[0,1,0] op_sel_hi:[1,1,1]
 v_accvgpr_read_b32 v18,a50
 v_cvt_pk_bf16_f32 v145,v194,v195
 v_lshlrev_b32 v16,16,v18
 v_and_b32 v17,0xffff0000,v18
 v_pk_fma_f32 v[196:197],v[16:17],v[12:13],v[196:197] op_sel:[0,1,0] op_sel_hi:[1,1,1]
 v_accvgpr_read_b32 v22,a51
 v_cvt_pk_bf16_f32 v146,v196,v197
 v_lshlrev_b32 v20,16,v22
 v_and_b32 v21,0xffff0000,v22
 v_pk_fma_f32 v[198:199],v[20:21],v[12:13],v[198:199] op_sel:[0,1,0] op_sel_hi:[1,1,1]
 v_cvt_pk_bf16_f32 v147,v198,v199
 v_accvgpr_read_b32 v18,a52
 v_lshlrev_b32 v16,16,v18
 v_and_b32 v17,0xffff0000,v18
 v_pk_fma_f32 v[200:201],v[16:17],v[12:13],v[200:201] op_sel:[0,1,0] op_sel_hi:[1,1,1]
 v_accvgpr_read_b32 v22,a53
 v_cvt_pk_bf16_f32 v148,v200,v201
 v_lshlrev_b32 v20,16,v22
 v_and_b32 v21,0xffff0000,v22
 v_pk_fma_f32 v[202:203],v[20:21],v[12:13],v[202:203] op_sel:[0,1,0] op_sel_hi:[1,1,1]
 v_accvgpr_read_b32 v18,a54
 v_cvt_pk_bf16_f32 v149,v202,v203
 v_lshlrev_b32 v16,16,v18
 v_and_b32 v17,0xffff0000,v18
 v_pk_fma_f32 v[204:205],v[16:17],v[12:13],v[204:205] op_sel:[0,1,0] op_sel_hi:[1,1,1]
 v_accvgpr_read_b32 v22,a55
 v_cvt_pk_bf16_f32 v150,v204,v205
 v_lshlrev_b32 v20,16,v22
 v_and_b32 v21,0xffff0000,v22
 v_pk_fma_f32 v[206:207],v[20:21],v[12:13],v[206:207] op_sel:[0,1,0] op_sel_hi:[1,1,1]
 v_cvt_pk_bf16_f32 v151,v206,v207
 v_accvgpr_read_b32 v18,a56
 v_lshlrev_b32 v16,16,v18
 v_and_b32 v17,0xffff0000,v18
 v_pk_fma_f32 v[208:209],v[16:17],v[12:13],v[208:209] op_sel:[0,1,0] op_sel_hi:[1,1,1]
 v_accvgpr_read_b32 v22,a57
 v_cvt_pk_bf16_f32 v152,v208,v209
 v_lshlrev_b32 v20,16,v22
 v_and_b32 v21,0xffff0000,v22
 v_pk_fma_f32 v[210:211],v[20:21],v[12:13],v[210:211] op_sel:[0,1,0] op_sel_hi:[1,1,1]
 v_accvgpr_read_b32 v18,a58
 v_cvt_pk_bf16_f32 v153,v210,v211
 v_lshlrev_b32 v16,16,v18
 v_and_b32 v17,0xffff0000,v18
 v_pk_fma_f32 v[212:213],v[16:17],v[12:13],v[212:213] op_sel:[0,1,0] op_sel_hi:[1,1,1]
 v_accvgpr_read_b32 v22,a59
 v_cvt_pk_bf16_f32 v154,v212,v213
 v_lshlrev_b32 v20,16,v22
 v_and_b32 v21,0xffff0000,v22
 v_pk_fma_f32 v[214:215],v[20:21],v[12:13],v[214:215] op_sel:[0,1,0] op_sel_hi:[1,1,1]
 v_cvt_pk_bf16_f32 v155,v214,v215
 v_accvgpr_read_b32 v18,a60
 v_lshlrev_b32 v16,16,v18
 v_and_b32 v17,0xffff0000,v18
 v_pk_fma_f32 v[216:217],v[16:17],v[12:13],v[216:217] op_sel:[0,1,0] op_sel_hi:[1,1,1]
 v_accvgpr_read_b32 v22,a61
 v_cvt_pk_bf16_f32 v156,v216,v217
 v_lshlrev_b32 v20,16,v22
 v_and_b32 v21,0xffff0000,v22
 v_pk_fma_f32 v[218:219],v[20:21],v[12:13],v[218:219] op_sel:[0,1,0] op_sel_hi:[1,1,1]
 v_accvgpr_read_b32 v18,a62
 v_cvt_pk_bf16_f32 v157,v218,v219
 v_lshlrev_b32 v16,16,v18
 v_and_b32 v17,0xffff0000,v18
 v_pk_fma_f32 v[220:221],v[16:17],v[12:13],v[220:221] op_sel:[0,1,0] op_sel_hi:[1,1,1]
 v_accvgpr_read_b32 v22,a63
 v_cvt_pk_bf16_f32 v158,v220,v221
 v_lshlrev_b32 v20,16,v22
 v_and_b32 v21,0xffff0000,v22
 v_pk_fma_f32 v[222:223],v[20:21],v[12:13],v[222:223] op_sel:[0,1,0] op_sel_hi:[1,1,1]
 v_cvt_pk_bf16_f32 v159,v222,v223
 v_mul_f32 v11,v11,v246
 v_mul_f32 v13,v13,v247
K2_PACKED:
 s_nop 0
 s_waitcnt lgkmcnt(5)
 v_mfma_f32_16x16x32_bf16 v[32:35],a[64:67],v[96:99],0
 ds_read_b128 a[116:119],v1 offset:13312
 v_mfma_f32_16x16x32_bf16 v[32:35],a[68:71],v[100:103],v[32:35]
 v_mov_b32 v21,v6
 s_nop 1
 v_permlane16_swap_b32 v21,v6
 v_mfma_f32_16x16x32_bf16 v[32:35],a[72:75],v[104:107],v[32:35]
 ds_read_b128 a[120:123],v1 offset:14336
 v_add_f32 v6,v6,v21
 v_mfma_f32_16x16x32_bf16 v[32:35],a[76:79],v[108:111],v[32:35]
 v_mov_b32 v21,v6
 s_nop 1
 v_permlane32_swap_b32 v21,v6
 v_mfma_f32_16x16x32_bf16 v[48:51],a[64:67],v[128:131],0
 v_add_f32 v6,v6,v21
 v_add_f32 v6,v6,v11
 v_mfma_f32_16x16x32_bf16 v[48:51],a[68:71],v[132:135],v[48:51]
 ds_read_b128 a[124:127],v1 offset:15360
 v_mfma_f32_16x16x32_bf16 v[48:51],a[72:75],v[136:139],v[48:51]
 v_rcp_f32 v10,v6
 v_mfma_f32_16x16x32_bf16 v[48:51],a[76:79],v[140:143],v[48:51]
 v_mov_b32 v21,v7
 s_nop 1
 v_permlane16_swap_b32 v21,v7
 v_mfma_f32_16x16x32_bf16 v[32:35],a[80:83],v[112:115],v[32:35]
 ds_read_b128 a[128:131],v1 offset:16384
 v_add_f32 v7,v7,v21
 v_mfma_f32_16x16x32_bf16 v[32:35],a[84:87],v[116:119],v[32:35]
 v_mov_b32 v21,v7
 s_nop 1
 v_permlane32_swap_b32 v21,v7
 v_mfma_f32_16x16x32_bf16 v[32:35],a[88:91],v[120:123],v[32:35]
 ds_read_b128 a[132:135],v1 offset:17408
 v_add_f32 v7,v7,v21
 v_mfma_f32_16x16x32_bf16 v[32:35],a[92:95],v[124:127],v[32:35]
 ds_read_b128 a[136:139],v1 offset:18432
 v_add_f32 v7,v7,v13
 v_mfma_f32_16x16x32_bf16 v[48:51],a[80:83],v[144:147],v[48:51]
 v_rcp_f32 v12,v7
 v_mfma_f32_16x16x32_bf16 v[48:51],a[84:87],v[148:151],v[48:51]
 s_add_u32 s32,s36,98304
 s_lshl_b32 s60,s41,3
 v_mfma_f32_16x16x32_bf16 v[48:51],a[88:91],v[152:155],v[48:51]
 ds_read_b128 a[140:143],v1 offset:19456
 s_add_u32 s60,s60,s45
 v_mfma_f32_16x16x32_bf16 v[48:51],a[92:95],v[156:159],v[48:51]
 s_waitcnt lgkmcnt(4)
 s_mul_i32 s37,s60,229376
 v_mfma_f32_16x16x32_bf16 v[36:39],a[96:99],v[96:99],0
 ds_read_b128 a[144:147],v1 offset:20480
 s_lshl_b32 s60,s46,10
 v_mfma_f32_16x16x32_bf16 v[36:39],a[100:103],v[100:103],v[36:39]
 s_add_u32 s37,s37,s60
 ds_read_b128 a[148:151],v1 offset:21504
 v_mfma_f32_16x16x32_bf16 v[36:39],a[104:107],v[104:107],v[36:39]
 s_add_u32 s37,s37,67108864
 s_lshl_b32 s64,s74,15
 v_mfma_f32_16x16x32_bf16 v[36:39],a[108:111],v[108:111],v[36:39]
 ds_read_b128 a[152:155],v1 offset:22528
 s_add_u32 s64,s64,109051904
 v_mfma_f32_16x16x32_bf16 v[52:55],a[96:99],v[128:131],0
 s_add_u32 s65,s65,1048576
 ds_read_b128 a[156:159],v1 offset:23552
 v_mfma_f32_16x16x32_bf16 v[52:55],a[100:103],v[132:135],v[52:55]
 s_lshl_b32 s66,s46,3
 s_add_u32 s66,s66,s45
 v_mfma_f32_16x16x32_bf16 v[52:55],a[104:107],v[136:139],v[52:55]
 s_mul_i32 s66,s66,28672
 ds_read_b128 a[160:163],v1 offset:24576
 v_mfma_f32_16x16x32_bf16 v[52:55],a[108:111],v[140:143],v[52:55]
 s_lshl_b32 s60,s74,6
 s_add_u32 s66,s66,s60
 v_mfma_f32_16x16x32_bf16 v[36:39],a[112:115],v[112:115],v[36:39]
 ds_read_b128 a[164:167],v1 offset:25600
 v_mfma_f32_16x16x32_bf16 v[36:39],a[116:119],v[116:119],v[36:39]
 s_cmp_eq_u32 s73,0
 s_cselect_b32 s64,0xf0000000,s64
 v_mfma_f32_16x16x32_bf16 v[36:39],a[120:123],v[120:123],v[36:39]
 s_cmp_eq_u32 s73,0
 s_cselect_b32 s65,0xf0000000,s65
 v_mfma_f32_16x16x32_bf16 v[36:39],a[124:127],v[124:127],v[36:39]
 ds_read_b128 a[168:171],v1 offset:26624
 v_mfma_f32_16x16x32_bf16 v[52:55],a[112:115],v[144:147],v[52:55]
 s_cmp_eq_u32 s73,0
 s_cselect_b32 s66,0xf0000000,s66
 v_mfma_f32_16x16x32_bf16 v[52:55],a[116:119],v[148:151],v[52:55]
 ds_read_b128 a[172:175],v1 offset:27648
 v_and_b32 v248,15,v0
 v_mfma_f32_16x16x32_bf16 v[52:55],a[120:123],v[152:155],v[52:55]
 v_mul_u32_u24 v248,1792,v248
 v_bfe_u32 v16,v0,4,2
 v_mfma_f32_16x16x32_bf16 v[52:55],a[124:127],v[156:159],v[52:55]
 s_waitcnt lgkmcnt(4)
 ds_read_b128 a[176:179],v1 offset:28672
 v_mfma_f32_16x16x32_bf16 v[40:43],a[128:131],v[96:99],0
 v_lshl_add_u32 v248,v16,4,v248
 s_add_u32 s20,s59,208
 v_mfma_f32_16x16x32_bf16 v[40:43],a[132:135],v[100:103],v[40:43]
 s_lshl_b32 s20,s20,7
 ds_read_b128 a[180:183],v1 offset:29696
 v_mfma_f32_16x16x32_bf16 v[40:43],a[136:139],v[104:107],v[40:43]
 s_add_u32 s20,s20,125829120
 v_mov_b32 v18,s20
 v_mfma_f32_16x16x32_bf16 v[40:43],a[140:143],v[108:111],v[40:43]
 ds_read_b128 a[184:187],v1 offset:30720
 v_mov_b32 v19,16
 v_mfma_f32_16x16x32_bf16 v[56:59],a[128:131],v[128:131],0
 ds_read_b128 a[188:191],v1 offset:31744
 v_mov_b32 v20,0
 v_mfma_f32_16x16x32_bf16 v[56:59],a[132:135],v[132:135],v[56:59]
 s_lshl_b32 s16,s59,4
 s_add_u32 s16,s16,s46
 v_mfma_f32_16x16x32_bf16 v[56:59],a[136:139],v[136:139],v[56:59]
 s_and_b32 s22,s16,1
 v_mfma_f32_16x16x32_bf16 v[56:59],a[140:143],v[140:143],v[56:59]
 s_lshr_b32 s16,s16,1
 v_mfma_f32_16x16x32_bf16 v[40:43],a[144:147],v[112:115],v[40:43]
 v_mfma_f32_16x16x32_bf16 v[40:43],a[148:151],v[116:119],v[40:43]
 v_mfma_f32_16x16x32_bf16 v[40:43],a[152:155],v[120:123],v[40:43]
 v_mfma_f32_16x16x32_bf16 v[40:43],a[156:159],v[124:127],v[40:43]
 v_mfma_f32_16x16x32_bf16 v[56:59],a[144:147],v[144:147],v[56:59]
 v_mfma_f32_16x16x32_bf16 v[56:59],a[148:151],v[148:151],v[56:59]
 s_waitcnt vmcnt(25) lgkmcnt(0)
 s_barrier
 v_mfma_f32_16x16x32_bf16 v[56:59],a[152:155],v[152:155],v[56:59]
 ds_read_b128 a[64:67],v1 offset:32768
 s_add_u32 m0,s51,98304
 v_mfma_f32_16x16x32_bf16 v[56:59],a[156:159],v[156:159],v[56:59]
 ds_read_b128 a[68:71],v1 offset:33792
 v_mfma_f32_16x16x32_bf16 v[44:47],a[160:163],v[96:99],0
 buffer_load_dwordx4 v14,s[28:31],s32 offen offset:0 sc1 lds
 v_mfma_f32_16x16x32_bf16 v[44:47],a[164:167],v[100:103],v[44:47]
 ds_read_b128 a[72:75],v1 offset:34816
 ds_read_b128 a[76:79],v1 offset:35840
 v_mfma_f32_16x16x32_bf16 v[44:47],a[168:171],v[104:107],v[44:47]
 buffer_load_dwordx4 v14,s[28:31],s32 offen offset:1024 sc1 lds
 v_mfma_f32_16x16x32_bf16 v[44:47],a[172:175],v[108:111],v[44:47]
 ds_read_b128 a[80:83],v1 offset:36864
 ds_read_b128 a[84:87],v1 offset:37888
 v_mfma_f32_16x16x32_bf16 v[60:63],a[160:163],v[128:131],0
 buffer_load_dwordx4 v14,s[28:31],s32 offen offset:2048 sc1 lds
 v_mfma_f32_16x16x32_bf16 v[60:63],a[164:167],v[132:135],v[60:63]
 ds_read_b128 a[88:91],v1 offset:38912
 ds_read_b128 a[92:95],v1 offset:39936
 v_mfma_f32_16x16x32_bf16 v[60:63],a[168:171],v[136:139],v[60:63]
 buffer_load_dwordx4 v14,s[28:31],s32 offen offset:3072 sc1 lds
 v_mfma_f32_16x16x32_bf16 v[60:63],a[172:175],v[140:143],v[60:63]
 s_add_u32 m0,s51,102400
 ds_read_b128 a[96:99],v1 offset:40960
 v_mfma_f32_16x16x32_bf16 v[44:47],a[176:179],v[112:115],v[44:47]
 buffer_load_dwordx4 v15,s[28:31],s32 offen offset:0 sc1 lds
 v_mfma_f32_16x16x32_bf16 v[44:47],a[180:183],v[116:119],v[44:47]
 ds_read_b128 a[100:103],v1 offset:41984
 v_mfma_f32_16x16x32_bf16 v[44:47],a[184:187],v[120:123],v[44:47]
 buffer_load_dwordx4 v15,s[28:31],s32 offen offset:1024 sc1 lds
 v_mfma_f32_16x16x32_bf16 v[44:47],a[188:191],v[124:127],v[44:47]
 ds_read_b128 a[104:107],v1 offset:43008
 v_mfma_f32_16x16x32_bf16 v[60:63],a[176:179],v[144:147],v[60:63]
 buffer_load_dwordx4 v15,s[28:31],s32 offen offset:2048 sc1 lds
 v_mfma_f32_16x16x32_bf16 v[60:63],a[180:183],v[148:151],v[60:63]
 buffer_load_dwordx4 v15,s[28:31],s32 offen offset:3072 sc1 lds
 v_mfma_f32_16x16x32_bf16 v[60:63],a[184:187],v[152:155],v[60:63]
 ds_read_b128 a[108:111],v1 offset:44032
 s_add_u32 s32,s32,32768
 v_mfma_f32_16x16x32_bf16 v[60:63],a[188:191],v[156:159],v[60:63]
 s_waitcnt lgkmcnt(4)
 ds_read_b128 a[112:115],v1 offset:45056
 v_mfma_f32_16x16x32_bf16 v[64:67],a[64:67],v[96:99],0
 ds_read_b128 a[116:119],v1 offset:46080
 s_add_u32 m0,s51,0
 v_mfma_f32_16x16x32_bf16 v[64:67],a[68:71],v[100:103],v[64:67]
 v_mfma_f32_16x16x32_bf16 v[64:67],a[72:75],v[104:107],v[64:67]
 ds_read_b128 a[120:123],v1 offset:47104
 v_mfma_f32_16x16x32_bf16 v[64:67],a[76:79],v[108:111],v[64:67]
 buffer_load_dwordx4 v14,s[28:31],s32 offen offset:0 sc1 lds
 v_mfma_f32_16x16x32_bf16 v[80:83],a[64:67],v[128:131],0
 ds_read_b128 a[124:127],v1 offset:48128
 v_mul_f32 v32,v32,v10
 v_mfma_f32_16x16x32_bf16 v[80:83],a[68:71],v[132:135],v[80:83]
 v_mul_f32 v33,v33,v10
 v_mfma_f32_16x16x32_bf16 v[80:83],a[72:75],v[136:139],v[80:83]
 ds_read_b128 a[128:131],v1 offset:49152
 v_mul_f32 v34,v34,v10
 v_mfma_f32_16x16x32_bf16 v[80:83],a[76:79],v[140:143],v[80:83]
 v_mul_f32 v35,v35,v10
 v_mfma_f32_16x16x32_bf16 v[64:67],a[80:83],v[112:115],v[64:67]
 buffer_load_dwordx4 v14,s[28:31],s32 offen offset:1024 sc1 lds
 v_mfma_f32_16x16x32_bf16 v[64:67],a[84:87],v[116:119],v[64:67]
 ds_read_b128 a[132:135],v1 offset:50176
 v_mul_f32 v36,v36,v10
 v_mfma_f32_16x16x32_bf16 v[64:67],a[88:91],v[120:123],v[64:67]
 ds_read_b128 a[136:139],v1 offset:51200
 v_mul_f32 v37,v37,v10
 v_mfma_f32_16x16x32_bf16 v[64:67],a[92:95],v[124:127],v[64:67]
 v_mul_f32 v38,v38,v10
 v_mul_f32 v39,v39,v10
 v_mfma_f32_16x16x32_bf16 v[80:83],a[80:83],v[144:147],v[80:83]
 buffer_load_dwordx4 v14,s[28:31],s32 offen offset:2048 sc1 lds
 v_mfma_f32_16x16x32_bf16 v[80:83],a[84:87],v[148:151],v[80:83]
 ds_read_b128 a[140:143],v1 offset:52224
 v_cvt_pk_bf16_f32 v224,v32,v33
 v_mfma_f32_16x16x32_bf16 v[80:83],a[88:91],v[152:155],v[80:83]
 ds_read_b128 a[144:147],v1 offset:53248
 v_cvt_pk_bf16_f32 v225,v34,v35
 v_mfma_f32_16x16x32_bf16 v[80:83],a[92:95],v[156:159],v[80:83]
 s_waitcnt lgkmcnt(5)
 s_add_u32 s60,s37,0
 v_mfma_f32_16x16x32_bf16 v[68:71],a[96:99],v[96:99],0
 ds_read_b128 a[148:151],v1 offset:54272
 v_cvt_pk_bf16_f32 v226,v36,v37
 v_mfma_f32_16x16x32_bf16 v[68:71],a[100:103],v[100:103],v[68:71]
 buffer_load_dwordx4 v14,s[28:31],s32 offen offset:3072 sc1 lds
 v_mfma_f32_16x16x32_bf16 v[68:71],a[104:107],v[104:107],v[68:71]
 ds_read_b128 a[152:155],v1 offset:55296
 v_cvt_pk_bf16_f32 v227,v38,v39
 v_mfma_f32_16x16x32_bf16 v[68:71],a[108:111],v[108:111],v[68:71]
 buffer_store_dwordx4 v[224:227],v1,s[28:31],s60 offen sc1
 v_mfma_f32_16x16x32_bf16 v[84:87],a[96:99],v[128:131],0
 v_mul_f32 v48,v48,v12
 s_add_u32 m0,s51,4096
 v_mfma_f32_16x16x32_bf16 v[84:87],a[100:103],v[132:135],v[84:87]
 ds_read_b128 a[156:159],v1 offset:56320
 v_mul_f32 v49,v49,v12
 v_mfma_f32_16x16x32_bf16 v[84:87],a[104:107],v[136:139],v[84:87]
 v_mul_f32 v50,v50,v12
 v_mul_f32 v51,v51,v12
 v_mfma_f32_16x16x32_bf16 v[84:87],a[108:111],v[140:143],v[84:87]
 ds_read_b128 a[160:163],v1 offset:57344
 v_mul_f32 v52,v52,v12
 v_mfma_f32_16x16x32_bf16 v[68:71],a[112:115],v[112:115],v[68:71]
 buffer_load_dwordx4 v15,s[28:31],s32 offen offset:0 sc1 lds
 v_mfma_f32_16x16x32_bf16 v[68:71],a[116:119],v[116:119],v[68:71]
 ds_read_b128 a[164:167],v1 offset:58368
 v_mul_f32 v53,v53,v12
 v_mfma_f32_16x16x32_bf16 v[68:71],a[120:123],v[120:123],v[68:71]
 v_mul_f32 v54,v54,v12
 v_mul_f32 v55,v55,v12
 v_mfma_f32_16x16x32_bf16 v[68:71],a[124:127],v[124:127],v[68:71]
 ds_read_b128 a[168:171],v1 offset:59392
 v_cvt_pk_bf16_f32 v228,v48,v49
 v_mfma_f32_16x16x32_bf16 v[84:87],a[112:115],v[144:147],v[84:87]
 buffer_load_dwordx4 v15,s[28:31],s32 offen offset:1024 sc1 lds
 v_mfma_f32_16x16x32_bf16 v[84:87],a[116:119],v[148:151],v[84:87]
 ds_read_b128 a[172:175],v1 offset:60416
 v_cvt_pk_bf16_f32 v229,v50,v51
 v_mfma_f32_16x16x32_bf16 v[84:87],a[120:123],v[152:155],v[84:87]
 v_cvt_pk_bf16_f32 v230,v52,v53
 v_cvt_pk_bf16_f32 v231,v54,v55
 v_mfma_f32_16x16x32_bf16 v[84:87],a[124:127],v[156:159],v[84:87]
 s_waitcnt lgkmcnt(4)
 ds_read_b128 a[176:179],v1 offset:61440
 v_mfma_f32_16x16x32_bf16 v[72:75],a[128:131],v[96:99],0
 buffer_store_dwordx4 v[228:231],v249,s[28:31],s60 offen sc1
 v_mfma_f32_16x16x32_bf16 v[72:75],a[132:135],v[100:103],v[72:75]
 ds_read_b128 a[180:183],v1 offset:62464
 v_mul_f32 v40,v40,v10
 v_mfma_f32_16x16x32_bf16 v[72:75],a[136:139],v[104:107],v[72:75]
 ds_read_b128 a[184:187],v1 offset:63488
 v_mul_f32 v41,v41,v10
 v_mfma_f32_16x16x32_bf16 v[72:75],a[140:143],v[108:111],v[72:75]
 buffer_load_dwordx4 v15,s[28:31],s32 offen offset:2048 sc1 lds
 v_mfma_f32_16x16x32_bf16 v[88:91],a[128:131],v[128:131],0
 v_mul_f32 v42,v42,v10
 v_mul_f32 v43,v43,v10
 v_mfma_f32_16x16x32_bf16 v[88:91],a[132:135],v[132:135],v[88:91]
 buffer_load_dwordx4 v15,s[28:31],s32 offen offset:3072 sc1 lds
 v_mfma_f32_16x16x32_bf16 v[88:91],a[136:139],v[136:139],v[88:91]
 ds_read_b128 a[188:191],v1 offset:64512
 v_mul_f32 v44,v44,v10
 v_mfma_f32_16x16x32_bf16 v[88:91],a[140:143],v[140:143],v[88:91]
 v_mul_f32 v45,v45,v10
 v_mul_f32 v46,v46,v10
 v_mfma_f32_16x16x32_bf16 v[72:75],a[144:147],v[112:115],v[72:75]
 s_add_u32 s32,s32,32768
 v_mul_f32 v47,v47,v10
 v_mfma_f32_16x16x32_bf16 v[72:75],a[148:151],v[116:119],v[72:75]
 v_cvt_pk_bf16_f32 v232,v40,v41
 v_cvt_pk_bf16_f32 v233,v42,v43
 v_mfma_f32_16x16x32_bf16 v[72:75],a[152:155],v[120:123],v[72:75]
 s_add_u32 s60,s37,16384
 v_mfma_f32_16x16x32_bf16 v[72:75],a[156:159],v[124:127],v[72:75]
 v_cvt_pk_bf16_f32 v234,v44,v45
 v_mfma_f32_16x16x32_bf16 v[88:91],a[144:147],v[144:147],v[88:91]
 v_cvt_pk_bf16_f32 v235,v46,v47
 v_mfma_f32_16x16x32_bf16 v[88:91],a[148:151],v[148:151],v[88:91]
 s_waitcnt vmcnt(18) lgkmcnt(0)
 s_barrier
 v_mfma_f32_16x16x32_bf16 v[88:91],a[152:155],v[152:155],v[88:91]
 buffer_store_dwordx4 v[232:235],v1,s[28:31],s60 offen sc1
 v_mfma_f32_16x16x32_bf16 v[88:91],a[156:159],v[156:159],v[88:91]
 ds_read_b128 a[64:67],v2 offset:0
 v_mul_f32 v56,v56,v12
 v_mfma_f32_16x16x32_bf16 v[76:79],a[160:163],v[96:99],0
 ds_read_b128 a[68:71],v2 offset:1024
 v_mul_f32 v57,v57,v12
 v_mfma_f32_16x16x32_bf16 v[76:79],a[164:167],v[100:103],v[76:79]
 ds_read_b128 a[72:75],v2 offset:2048
 v_mul_f32 v58,v58,v12
 v_mfma_f32_16x16x32_bf16 v[76:79],a[168:171],v[104:107],v[76:79]
 ds_read_b128 a[76:79],v2 offset:3072
 v_mul_f32 v59,v59,v12
 v_mfma_f32_16x16x32_bf16 v[76:79],a[172:175],v[108:111],v[76:79]
 ds_read_b128 a[80:83],v2 offset:4096
 v_mul_f32 v60,v60,v12
 v_mfma_f32_16x16x32_bf16 v[92:95],a[160:163],v[128:131],0
 ds_read_b128 a[84:87],v2 offset:5120
 v_mul_f32 v61,v61,v12
 v_mfma_f32_16x16x32_bf16 v[92:95],a[164:167],v[132:135],v[92:95]
 ds_read_b128 a[88:91],v2 offset:6144
 v_mul_f32 v62,v62,v12
 v_mfma_f32_16x16x32_bf16 v[92:95],a[168:171],v[136:139],v[92:95]
 ds_read_b128 a[92:95],v2 offset:7168
 v_mul_f32 v63,v63,v12
 v_mfma_f32_16x16x32_bf16 v[92:95],a[172:175],v[140:143],v[92:95]
 ds_read_b128 a[96:99],v2 offset:8192
 v_cvt_pk_bf16_f32 v236,v56,v57
 v_mfma_f32_16x16x32_bf16 v[76:79],a[176:179],v[112:115],v[76:79]
 ds_read_b128 a[100:103],v2 offset:9216
 v_cvt_pk_bf16_f32 v237,v58,v59
 v_mfma_f32_16x16x32_bf16 v[76:79],a[180:183],v[116:119],v[76:79]
 v_cvt_pk_bf16_f32 v238,v60,v61
 v_cvt_pk_bf16_f32 v239,v62,v63
 v_mfma_f32_16x16x32_bf16 v[76:79],a[184:187],v[120:123],v[76:79]
 ds_read_b128 a[104:107],v2 offset:10240
 v_mfma_f32_16x16x32_bf16 v[76:79],a[188:191],v[124:127],v[76:79]
 buffer_store_dwordx4 v[236:239],v249,s[28:31],s60 offen sc1
 v_mfma_f32_16x16x32_bf16 v[92:95],a[176:179],v[144:147],v[92:95]
 ds_read_b128 a[108:111],v2 offset:11264
 v_mfma_f32_16x16x32_bf16 v[92:95],a[180:183],v[148:151],v[92:95]
 v_mfma_f32_16x16x32_bf16 v[92:95],a[184:187],v[152:155],v[92:95]
 ds_read_b128 a[112:115],v2 offset:12288
 v_mfma_f32_16x16x32_bf16 v[92:95],a[188:191],v[156:159],v[92:95]
 s_waitcnt lgkmcnt(5)
 v_mfma_f32_16x16x32_bf16 v[32:35],a[64:67],v[96:99],0
 ds_read_b128 a[116:119],v2 offset:13312
 s_add_u32 m0,s51,32768
 v_mfma_f32_16x16x32_bf16 v[32:35],a[68:71],v[100:103],v[32:35]
 v_mfma_f32_16x16x32_bf16 v[32:35],a[72:75],v[104:107],v[32:35]
 ds_read_b128 a[120:123],v2 offset:14336
 v_mfma_f32_16x16x32_bf16 v[32:35],a[76:79],v[108:111],v[32:35]
 buffer_load_dwordx4 v14,s[28:31],s32 offen offset:0 sc1 lds
 v_mfma_f32_16x16x32_bf16 v[48:51],a[64:67],v[128:131],0
 ds_read_b128 a[124:127],v2 offset:15360
 v_mul_f32 v64,v64,v10
 v_mfma_f32_16x16x32_bf16 v[48:51],a[68:71],v[132:135],v[48:51]
 v_mul_f32 v65,v65,v10
 v_mfma_f32_16x16x32_bf16 v[48:51],a[72:75],v[136:139],v[48:51]
 ds_read_b128 a[128:131],v2 offset:16384
 v_mul_f32 v66,v66,v10
 v_mfma_f32_16x16x32_bf16 v[48:51],a[76:79],v[140:143],v[48:51]
 v_mul_f32 v67,v67,v10
 v_mfma_f32_16x16x32_bf16 v[32:35],a[80:83],v[112:115],v[32:35]
 buffer_load_dwordx4 v14,s[28:31],s32 offen offset:1024 sc1 lds
 v_mfma_f32_16x16x32_bf16 v[32:35],a[84:87],v[116:119],v[32:35]
 ds_read_b128 a[132:135],v2 offset:17408
 v_mul_f32 v68,v68,v10
 v_mfma_f32_16x16x32_bf16 v[32:35],a[88:91],v[120:123],v[32:35]
 ds_read_b128 a[136:139],v2 offset:18432
 v_mul_f32 v69,v69,v10
 v_mfma_f32_16x16x32_bf16 v[32:35],a[92:95],v[124:127],v[32:35]
 v_mul_f32 v70,v70,v10
 v_mul_f32 v71,v71,v10
 v_mfma_f32_16x16x32_bf16 v[48:51],a[80:83],v[144:147],v[48:51]
 buffer_load_dwordx4 v14,s[28:31],s32 offen offset:2048 sc1 lds
 v_mfma_f32_16x16x32_bf16 v[48:51],a[84:87],v[148:151],v[48:51]
 ds_read_b128 a[140:143],v2 offset:19456
 v_cvt_pk_bf16_f32 v224,v64,v65
 v_mfma_f32_16x16x32_bf16 v[48:51],a[88:91],v[152:155],v[48:51]
 ds_read_b128 a[144:147],v2 offset:20480
 v_cvt_pk_bf16_f32 v225,v66,v67
 v_mfma_f32_16x16x32_bf16 v[48:51],a[92:95],v[156:159],v[48:51]
 s_waitcnt lgkmcnt(5)
 s_add_u32 s60,s37,32768
 v_mfma_f32_16x16x32_bf16 v[36:39],a[96:99],v[96:99],0
 ds_read_b128 a[148:151],v2 offset:21504
 v_cvt_pk_bf16_f32 v226,v68,v69
 v_mfma_f32_16x16x32_bf16 v[36:39],a[100:103],v[100:103],v[36:39]
 buffer_load_dwordx4 v14,s[28:31],s32 offen offset:3072 sc1 lds
 v_mfma_f32_16x16x32_bf16 v[36:39],a[104:107],v[104:107],v[36:39]
 ds_read_b128 a[152:155],v2 offset:22528
 v_cvt_pk_bf16_f32 v227,v70,v71
 v_mfma_f32_16x16x32_bf16 v[36:39],a[108:111],v[108:111],v[36:39]
 buffer_store_dwordx4 v[224:227],v1,s[28:31],s60 offen sc1
 v_mfma_f32_16x16x32_bf16 v[52:55],a[96:99],v[128:131],0
 v_mul_f32 v80,v80,v12
 s_add_u32 m0,s51,36864
 v_mfma_f32_16x16x32_bf16 v[52:55],a[100:103],v[132:135],v[52:55]
 ds_read_b128 a[156:159],v2 offset:23552
 v_mul_f32 v81,v81,v12
 v_mfma_f32_16x16x32_bf16 v[52:55],a[104:107],v[136:139],v[52:55]
 v_mul_f32 v82,v82,v12
 v_mul_f32 v83,v83,v12
 v_mfma_f32_16x16x32_bf16 v[52:55],a[108:111],v[140:143],v[52:55]
 ds_read_b128 a[160:163],v2 offset:24576
 v_mul_f32 v84,v84,v12
 v_mfma_f32_16x16x32_bf16 v[36:39],a[112:115],v[112:115],v[36:39]
 buffer_load_dwordx4 v15,s[28:31],s32 offen offset:0 sc1 lds
 v_mfma_f32_16x16x32_bf16 v[36:39],a[116:119],v[116:119],v[36:39]
 ds_read_b128 a[164:167],v2 offset:25600
 v_mul_f32 v85,v85,v12
 v_mfma_f32_16x16x32_bf16 v[36:39],a[120:123],v[120:123],v[36:39]
 v_mul_f32 v86,v86,v12
 v_mul_f32 v87,v87,v12
 v_mfma_f32_16x16x32_bf16 v[36:39],a[124:127],v[124:127],v[36:39]
 ds_read_b128 a[168:171],v2 offset:26624
 v_cvt_pk_bf16_f32 v228,v80,v81
 v_mfma_f32_16x16x32_bf16 v[52:55],a[112:115],v[144:147],v[52:55]
 buffer_load_dwordx4 v15,s[28:31],s32 offen offset:1024 sc1 lds
 v_mfma_f32_16x16x32_bf16 v[52:55],a[116:119],v[148:151],v[52:55]
 ds_read_b128 a[172:175],v2 offset:27648
 v_cvt_pk_bf16_f32 v229,v82,v83
 v_mfma_f32_16x16x32_bf16 v[52:55],a[120:123],v[152:155],v[52:55]
 v_cvt_pk_bf16_f32 v230,v84,v85
 v_cvt_pk_bf16_f32 v231,v86,v87
 v_mfma_f32_16x16x32_bf16 v[52:55],a[124:127],v[156:159],v[52:55]
 s_waitcnt lgkmcnt(4)
 ds_read_b128 a[176:179],v2 offset:28672
 v_mfma_f32_16x16x32_bf16 v[40:43],a[128:131],v[96:99],0
 buffer_store_dwordx4 v[228:231],v249,s[28:31],s60 offen sc1
 v_mfma_f32_16x16x32_bf16 v[40:43],a[132:135],v[100:103],v[40:43]
 ds_read_b128 a[180:183],v2 offset:29696
 v_mul_f32 v72,v72,v10
 v_mfma_f32_16x16x32_bf16 v[40:43],a[136:139],v[104:107],v[40:43]
 ds_read_b128 a[184:187],v2 offset:30720
 v_mul_f32 v73,v73,v10
 v_mfma_f32_16x16x32_bf16 v[40:43],a[140:143],v[108:111],v[40:43]
 buffer_load_dwordx4 v15,s[28:31],s32 offen offset:2048 sc1 lds
 v_mfma_f32_16x16x32_bf16 v[56:59],a[128:131],v[128:131],0
 v_mul_f32 v74,v74,v10
 v_mul_f32 v75,v75,v10
 v_mfma_f32_16x16x32_bf16 v[56:59],a[132:135],v[132:135],v[56:59]
 buffer_load_dwordx4 v15,s[28:31],s32 offen offset:3072 sc1 lds
 v_mfma_f32_16x16x32_bf16 v[56:59],a[136:139],v[136:139],v[56:59]
 ds_read_b128 a[188:191],v2 offset:31744
 v_mul_f32 v76,v76,v10
 v_mfma_f32_16x16x32_bf16 v[56:59],a[140:143],v[140:143],v[56:59]
 v_mul_f32 v77,v77,v10
 v_mul_f32 v78,v78,v10
 v_mfma_f32_16x16x32_bf16 v[40:43],a[144:147],v[112:115],v[40:43]
 s_add_u32 s32,s32,32768
 v_mul_f32 v79,v79,v10
 v_mfma_f32_16x16x32_bf16 v[40:43],a[148:151],v[116:119],v[40:43]
 v_cvt_pk_bf16_f32 v232,v72,v73
 v_cvt_pk_bf16_f32 v233,v74,v75
 v_mfma_f32_16x16x32_bf16 v[40:43],a[152:155],v[120:123],v[40:43]
 s_add_u32 s60,s37,49152
 v_mfma_f32_16x16x32_bf16 v[40:43],a[156:159],v[124:127],v[40:43]
 v_cvt_pk_bf16_f32 v234,v76,v77
 v_mfma_f32_16x16x32_bf16 v[56:59],a[144:147],v[144:147],v[56:59]
 v_cvt_pk_bf16_f32 v235,v78,v79
 v_mfma_f32_16x16x32_bf16 v[56:59],a[148:151],v[148:151],v[56:59]
 s_waitcnt vmcnt(22) lgkmcnt(0)
 s_barrier
 v_mfma_f32_16x16x32_bf16 v[56:59],a[152:155],v[152:155],v[56:59]
 buffer_store_dwordx4 v[232:235],v1,s[28:31],s60 offen sc1
 v_mfma_f32_16x16x32_bf16 v[56:59],a[156:159],v[156:159],v[56:59]
 ds_read_b128 a[64:67],v2 offset:32768
 v_mul_f32 v88,v88,v12
 v_mfma_f32_16x16x32_bf16 v[44:47],a[160:163],v[96:99],0
 ds_read_b128 a[68:71],v2 offset:33792
 v_mul_f32 v89,v89,v12
 v_mfma_f32_16x16x32_bf16 v[44:47],a[164:167],v[100:103],v[44:47]
 ds_read_b128 a[72:75],v2 offset:34816
 v_mul_f32 v90,v90,v12
 v_mfma_f32_16x16x32_bf16 v[44:47],a[168:171],v[104:107],v[44:47]
 ds_read_b128 a[76:79],v2 offset:35840
 v_mul_f32 v91,v91,v12
 v_mfma_f32_16x16x32_bf16 v[44:47],a[172:175],v[108:111],v[44:47]
 ds_read_b128 a[80:83],v2 offset:36864
 v_mul_f32 v92,v92,v12
 v_mfma_f32_16x16x32_bf16 v[60:63],a[160:163],v[128:131],0
 ds_read_b128 a[84:87],v2 offset:37888
 v_mul_f32 v93,v93,v12
 v_mfma_f32_16x16x32_bf16 v[60:63],a[164:167],v[132:135],v[60:63]
 ds_read_b128 a[88:91],v2 offset:38912
 v_mul_f32 v94,v94,v12
 v_mfma_f32_16x16x32_bf16 v[60:63],a[168:171],v[136:139],v[60:63]
 ds_read_b128 a[92:95],v2 offset:39936
 v_mul_f32 v95,v95,v12
 v_mfma_f32_16x16x32_bf16 v[60:63],a[172:175],v[140:143],v[60:63]
 ds_read_b128 a[96:99],v2 offset:40960
 v_cvt_pk_bf16_f32 v236,v88,v89
 v_mfma_f32_16x16x32_bf16 v[44:47],a[176:179],v[112:115],v[44:47]
 ds_read_b128 a[100:103],v2 offset:41984
 v_cvt_pk_bf16_f32 v237,v90,v91
 v_mfma_f32_16x16x32_bf16 v[44:47],a[180:183],v[116:119],v[44:47]
 v_cvt_pk_bf16_f32 v238,v92,v93
 v_cvt_pk_bf16_f32 v239,v94,v95
 v_mfma_f32_16x16x32_bf16 v[44:47],a[184:187],v[120:123],v[44:47]
 ds_read_b128 a[104:107],v2 offset:43008
 v_mfma_f32_16x16x32_bf16 v[44:47],a[188:191],v[124:127],v[44:47]
 buffer_store_dwordx4 v[236:239],v249,s[28:31],s60 offen sc1
 v_mfma_f32_16x16x32_bf16 v[60:63],a[176:179],v[144:147],v[60:63]
 ds_read_b128 a[108:111],v2 offset:44032
 v_mfma_f32_16x16x32_bf16 v[60:63],a[180:183],v[148:151],v[60:63]
 v_mfma_f32_16x16x32_bf16 v[60:63],a[184:187],v[152:155],v[60:63]
 ds_read_b128 a[112:115],v2 offset:45056
 v_mfma_f32_16x16x32_bf16 v[60:63],a[188:191],v[156:159],v[60:63]
 s_waitcnt lgkmcnt(5)
 v_mfma_f32_16x16x32_bf16 v[64:67],a[64:67],v[96:99],0
 ds_read_b128 a[116:119],v2 offset:46080
 s_add_u32 m0,s51,65536
 v_mfma_f32_16x16x32_bf16 v[64:67],a[68:71],v[100:103],v[64:67]
 v_mfma_f32_16x16x32_bf16 v[64:67],a[72:75],v[104:107],v[64:67]
 ds_read_b128 a[120:123],v2 offset:47104
 v_mfma_f32_16x16x32_bf16 v[64:67],a[76:79],v[108:111],v[64:67]
 buffer_load_dwordx4 v14,s[28:31],s32 offen offset:0 sc1 lds
 v_mfma_f32_16x16x32_bf16 v[80:83],a[64:67],v[128:131],0
 ds_read_b128 a[124:127],v2 offset:48128
 v_mul_f32 v32,v32,v10
 v_mfma_f32_16x16x32_bf16 v[80:83],a[68:71],v[132:135],v[80:83]
 v_mul_f32 v33,v33,v10
 v_mfma_f32_16x16x32_bf16 v[80:83],a[72:75],v[136:139],v[80:83]
 ds_read_b128 a[128:131],v2 offset:49152
 v_mul_f32 v34,v34,v10
 v_mfma_f32_16x16x32_bf16 v[80:83],a[76:79],v[140:143],v[80:83]
 v_mul_f32 v35,v35,v10
 v_mfma_f32_16x16x32_bf16 v[64:67],a[80:83],v[112:115],v[64:67]
 buffer_load_dwordx4 v14,s[28:31],s32 offen offset:1024 sc1 lds
 v_mfma_f32_16x16x32_bf16 v[64:67],a[84:87],v[116:119],v[64:67]
 ds_read_b128 a[132:135],v2 offset:50176
 v_mul_f32 v36,v36,v10
 v_mfma_f32_16x16x32_bf16 v[64:67],a[88:91],v[120:123],v[64:67]
 ds_read_b128 a[136:139],v2 offset:51200
 v_mul_f32 v37,v37,v10
 v_mfma_f32_16x16x32_bf16 v[64:67],a[92:95],v[124:127],v[64:67]
 v_mul_f32 v38,v38,v10
 v_mul_f32 v39,v39,v10
 v_mfma_f32_16x16x32_bf16 v[80:83],a[80:83],v[144:147],v[80:83]
 buffer_load_dwordx4 v14,s[28:31],s32 offen offset:2048 sc1 lds
 v_mfma_f32_16x16x32_bf16 v[80:83],a[84:87],v[148:151],v[80:83]
 ds_read_b128 a[140:143],v2 offset:52224
 v_cvt_pk_bf16_f32 v224,v32,v33
 v_mfma_f32_16x16x32_bf16 v[80:83],a[88:91],v[152:155],v[80:83]
 ds_read_b128 a[144:147],v2 offset:53248
 v_cvt_pk_bf16_f32 v225,v34,v35
 v_mfma_f32_16x16x32_bf16 v[80:83],a[92:95],v[156:159],v[80:83]
 s_waitcnt lgkmcnt(5)
 s_add_u32 s60,s37,65536
 v_mfma_f32_16x16x32_bf16 v[68:71],a[96:99],v[96:99],0
 ds_read_b128 a[148:151],v2 offset:54272
 v_cvt_pk_bf16_f32 v226,v36,v37
 v_mfma_f32_16x16x32_bf16 v[68:71],a[100:103],v[100:103],v[68:71]
 buffer_load_dwordx4 v14,s[28:31],s32 offen offset:3072 sc1 lds
 v_mfma_f32_16x16x32_bf16 v[68:71],a[104:107],v[104:107],v[68:71]
 ds_read_b128 a[152:155],v2 offset:55296
 v_cvt_pk_bf16_f32 v227,v38,v39
 v_mfma_f32_16x16x32_bf16 v[68:71],a[108:111],v[108:111],v[68:71]
 buffer_store_dwordx4 v[224:227],v1,s[28:31],s60 offen sc1
 v_mfma_f32_16x16x32_bf16 v[84:87],a[96:99],v[128:131],0
 v_mul_f32 v48,v48,v12
 s_add_u32 m0,s51,69632
 v_mfma_f32_16x16x32_bf16 v[84:87],a[100:103],v[132:135],v[84:87]
 ds_read_b128 a[156:159],v2 offset:56320
 v_mul_f32 v49,v49,v12
 v_mfma_f32_16x16x32_bf16 v[84:87],a[104:107],v[136:139],v[84:87]
 v_mul_f32 v50,v50,v12
 v_mul_f32 v51,v51,v12
 v_mfma_f32_16x16x32_bf16 v[84:87],a[108:111],v[140:143],v[84:87]
 ds_read_b128 a[160:163],v2 offset:57344
 v_mul_f32 v52,v52,v12
 v_mfma_f32_16x16x32_bf16 v[68:71],a[112:115],v[112:115],v[68:71]
 buffer_load_dwordx4 v15,s[28:31],s32 offen offset:0 sc1 lds
 v_mfma_f32_16x16x32_bf16 v[68:71],a[116:119],v[116:119],v[68:71]
 ds_read_b128 a[164:167],v2 offset:58368
 v_mul_f32 v53,v53,v12
 v_mfma_f32_16x16x32_bf16 v[68:71],a[120:123],v[120:123],v[68:71]
 v_mul_f32 v54,v54,v12
 v_mul_f32 v55,v55,v12
 v_mfma_f32_16x16x32_bf16 v[68:71],a[124:127],v[124:127],v[68:71]
 ds_read_b128 a[168:171],v2 offset:59392
 v_cvt_pk_bf16_f32 v228,v48,v49
 v_mfma_f32_16x16x32_bf16 v[84:87],a[112:115],v[144:147],v[84:87]
 buffer_load_dwordx4 v15,s[28:31],s32 offen offset:1024 sc1 lds
 v_mfma_f32_16x16x32_bf16 v[84:87],a[116:119],v[148:151],v[84:87]
 ds_read_b128 a[172:175],v2 offset:60416
 v_cvt_pk_bf16_f32 v229,v50,v51
 v_mfma_f32_16x16x32_bf16 v[84:87],a[120:123],v[152:155],v[84:87]
 v_cvt_pk_bf16_f32 v230,v52,v53
 v_cvt_pk_bf16_f32 v231,v54,v55
 v_mfma_f32_16x16x32_bf16 v[84:87],a[124:127],v[156:159],v[84:87]
 s_waitcnt lgkmcnt(4)
 ds_read_b128 a[176:179],v2 offset:61440
 v_mfma_f32_16x16x32_bf16 v[72:75],a[128:131],v[96:99],0
 buffer_store_dwordx4 v[228:231],v249,s[28:31],s60 offen sc1
 v_mfma_f32_16x16x32_bf16 v[72:75],a[132:135],v[100:103],v[72:75]
 ds_read_b128 a[180:183],v2 offset:62464
 v_mul_f32 v40,v40,v10
 v_mfma_f32_16x16x32_bf16 v[72:75],a[136:139],v[104:107],v[72:75]
 ds_read_b128 a[184:187],v2 offset:63488
 v_mul_f32 v41,v41,v10
 v_mfma_f32_16x16x32_bf16 v[72:75],a[140:143],v[108:111],v[72:75]
 buffer_load_dwordx4 v15,s[28:31],s32 offen offset:2048 sc1 lds
 v_mfma_f32_16x16x32_bf16 v[88:91],a[128:131],v[128:131],0
 v_mul_f32 v42,v42,v10
 v_mul_f32 v43,v43,v10
 v_mfma_f32_16x16x32_bf16 v[88:91],a[132:135],v[132:135],v[88:91]
 buffer_load_dwordx4 v15,s[28:31],s32 offen offset:3072 sc1 lds
 v_mfma_f32_16x16x32_bf16 v[88:91],a[136:139],v[136:139],v[88:91]
 ds_read_b128 a[188:191],v2 offset:64512
 v_mul_f32 v44,v44,v10
 v_mfma_f32_16x16x32_bf16 v[88:91],a[140:143],v[140:143],v[88:91]
 v_mul_f32 v45,v45,v10
 v_mul_f32 v46,v46,v10
 v_mfma_f32_16x16x32_bf16 v[72:75],a[144:147],v[112:115],v[72:75]
 s_add_u32 s32,s32,32768
 v_mul_f32 v47,v47,v10
 v_mfma_f32_16x16x32_bf16 v[72:75],a[148:151],v[116:119],v[72:75]
 v_cvt_pk_bf16_f32 v232,v40,v41
 v_cvt_pk_bf16_f32 v233,v42,v43
 v_mfma_f32_16x16x32_bf16 v[72:75],a[152:155],v[120:123],v[72:75]
 s_add_u32 s60,s37,81920
 v_mfma_f32_16x16x32_bf16 v[72:75],a[156:159],v[124:127],v[72:75]
 v_cvt_pk_bf16_f32 v234,v44,v45
 v_mfma_f32_16x16x32_bf16 v[88:91],a[144:147],v[144:147],v[88:91]
 v_cvt_pk_bf16_f32 v235,v46,v47
 v_mfma_f32_16x16x32_bf16 v[88:91],a[148:151],v[148:151],v[88:91]
 s_waitcnt vmcnt(24) lgkmcnt(0)
 s_barrier
 v_mfma_f32_16x16x32_bf16 v[88:91],a[152:155],v[152:155],v[88:91]
 buffer_store_dwordx4 v[232:235],v1,s[28:31],s60 offen sc1
 v_mfma_f32_16x16x32_bf16 v[88:91],a[156:159],v[156:159],v[88:91]
 ds_read_b128 a[64:67],v1 offset:0
 v_mul_f32 v56,v56,v12
 v_mfma_f32_16x16x32_bf16 v[76:79],a[160:163],v[96:99],0
 ds_read_b128 a[68:71],v1 offset:1024
 v_mul_f32 v57,v57,v12
 v_mfma_f32_16x16x32_bf16 v[76:79],a[164:167],v[100:103],v[76:79]
 ds_read_b128 a[72:75],v1 offset:2048
 v_mul_f32 v58,v58,v12
 v_mfma_f32_16x16x32_bf16 v[76:79],a[168:171],v[104:107],v[76:79]
 ds_read_b128 a[76:79],v1 offset:3072
 v_mul_f32 v59,v59,v12
 v_mfma_f32_16x16x32_bf16 v[76:79],a[172:175],v[108:111],v[76:79]
 ds_read_b128 a[80:83],v1 offset:4096
 v_mul_f32 v60,v60,v12
 v_mfma_f32_16x16x32_bf16 v[92:95],a[160:163],v[128:131],0
 ds_read_b128 a[84:87],v1 offset:5120
 v_mul_f32 v61,v61,v12
 v_mfma_f32_16x16x32_bf16 v[92:95],a[164:167],v[132:135],v[92:95]
 ds_read_b128 a[88:91],v1 offset:6144
 v_mul_f32 v62,v62,v12
 v_mfma_f32_16x16x32_bf16 v[92:95],a[168:171],v[136:139],v[92:95]
 ds_read_b128 a[92:95],v1 offset:7168
 v_mul_f32 v63,v63,v12
 v_mfma_f32_16x16x32_bf16 v[92:95],a[172:175],v[140:143],v[92:95]
 ds_read_b128 a[96:99],v1 offset:8192
 v_cvt_pk_bf16_f32 v236,v56,v57
 v_mfma_f32_16x16x32_bf16 v[76:79],a[176:179],v[112:115],v[76:79]
 ds_read_b128 a[100:103],v1 offset:9216
 v_cvt_pk_bf16_f32 v237,v58,v59
 v_mfma_f32_16x16x32_bf16 v[76:79],a[180:183],v[116:119],v[76:79]
 v_cvt_pk_bf16_f32 v238,v60,v61
 v_cvt_pk_bf16_f32 v239,v62,v63
 v_mfma_f32_16x16x32_bf16 v[76:79],a[184:187],v[120:123],v[76:79]
 ds_read_b128 a[104:107],v1 offset:10240
 v_mfma_f32_16x16x32_bf16 v[76:79],a[188:191],v[124:127],v[76:79]
 buffer_store_dwordx4 v[236:239],v249,s[28:31],s60 offen sc1
 v_mfma_f32_16x16x32_bf16 v[92:95],a[176:179],v[144:147],v[92:95]
 ds_read_b128 a[108:111],v1 offset:11264
 v_mfma_f32_16x16x32_bf16 v[92:95],a[180:183],v[148:151],v[92:95]
 v_mfma_f32_16x16x32_bf16 v[92:95],a[184:187],v[152:155],v[92:95]
 ds_read_b128 a[112:115],v1 offset:12288
 v_mfma_f32_16x16x32_bf16 v[92:95],a[188:191],v[156:159],v[92:95]
 s_waitcnt lgkmcnt(5)
 s_cmp_eq_u32 s73,0
 s_cbranch_scc1 K2_LEAN
 v_mfma_f32_16x16x32_bf16 v[32:35],a[64:67],v[96:99],0
 ds_read_b128 a[116:119],v1 offset:13312
 s_add_u32 m0,s51,98304
 v_mfma_f32_16x16x32_bf16 v[32:35],a[68:71],v[100:103],v[32:35]
 v_mfma_f32_16x16x32_bf16 v[32:35],a[72:75],v[104:107],v[32:35]
 ds_read_b128 a[120:123],v1 offset:14336
 v_mfma_f32_16x16x32_bf16 v[32:35],a[76:79],v[108:111],v[32:35]
 buffer_load_dwordx4 v14,s[28:31],s64 offen offset:0 sc1 lds
 v_mfma_f32_16x16x32_bf16 v[48:51],a[64:67],v[128:131],0
 ds_read_b128 a[124:127],v1 offset:15360
 v_mul_f32 v64,v64,v10
 v_mfma_f32_16x16x32_bf16 v[48:51],a[68:71],v[132:135],v[48:51]
 v_mul_f32 v65,v65,v10
 v_mfma_f32_16x16x32_bf16 v[48:51],a[72:75],v[136:139],v[48:51]
 ds_read_b128 a[128:131],v1 offset:16384
 v_mul_f32 v66,v66,v10
 v_mfma_f32_16x16x32_bf16 v[48:51],a[76:79],v[140:143],v[48:51]
 buffer_load_dwordx4 v14,s[28:31],s64 offen offset:1024 sc1 lds
 v_mfma_f32_16x16x32_bf16 v[32:35],a[80:83],v[112:115],v[32:35]
 ds_read_b128 a[132:135],v1 offset:17408
 v_mul_f32 v67,v67,v10
 v_mfma_f32_16x16x32_bf16 v[32:35],a[84:87],v[116:119],v[32:35]
 v_mul_f32 v68,v68,v10
 v_mul_f32 v69,v69,v10
 v_mfma_f32_16x16x32_bf16 v[32:35],a[88:91],v[120:123],v[32:35]
 ds_read_b128 a[136:139],v1 offset:18432
 v_mul_f32 v70,v70,v10
 v_mfma_f32_16x16x32_bf16 v[32:35],a[92:95],v[124:127],v[32:35]
 buffer_load_dwordx4 v14,s[28:31],s64 offen offset:2048 sc1 lds
 v_mfma_f32_16x16x32_bf16 v[48:51],a[80:83],v[144:147],v[48:51]
 ds_read_b128 a[140:143],v1 offset:19456
 v_mul_f32 v71,v71,v10
 v_mfma_f32_16x16x32_bf16 v[48:51],a[84:87],v[148:151],v[48:51]
 v_cvt_pk_bf16_f32 v224,v64,v65
 v_cvt_pk_bf16_f32 v225,v66,v67
 v_mfma_f32_16x16x32_bf16 v[48:51],a[88:91],v[152:155],v[48:51]
 ds_read_b128 a[144:147],v1 offset:20480
 s_add_u32 s60,s37,98304
 v_mfma_f32_16x16x32_bf16 v[48:51],a[92:95],v[156:159],v[48:51]
 s_waitcnt lgkmcnt(5)
 v_cvt_pk_bf16_f32 v226,v68,v69
 v_mfma_f32_16x16x32_bf16 v[36:39],a[96:99],v[96:99],0
 buffer_load_dwordx4 v14,s[28:31],s64 offen offset:3072 sc1 lds
 v_mfma_f32_16x16x32_bf16 v[36:39],a[100:103],v[100:103],v[36:39]
 ds_read_b128 a[148:151],v1 offset:21504
 v_cvt_pk_bf16_f32 v227,v70,v71
 v_mfma_f32_16x16x32_bf16 v[36:39],a[104:107],v[104:107],v[36:39]
 buffer_store_dwordx4 v[224:227],v1,s[28:31],s60 offen sc1
 v_mfma_f32_16x16x32_bf16 v[36:39],a[108:111],v[108:111],v[36:39]
 s_add_u32 m0,s51,102400
 ds_read_b128 a[152:155],v1 offset:22528
 v_mfma_f32_16x16x32_bf16 v[52:55],a[96:99],v[128:131],0
 v_mul_f32 v80,v80,v12
 v_mul_f32 v81,v81,v12
 v_mfma_f32_16x16x32_bf16 v[52:55],a[100:103],v[132:135],v[52:55]
 ds_read_b128 a[156:159],v1 offset:23552
 v_mul_f32 v82,v82,v12
 v_mfma_f32_16x16x32_bf16 v[52:55],a[104:107],v[136:139],v[52:55]
 buffer_load_dwordx4 v15,s[28:31],s64 offen offset:0 sc1 lds
 v_mfma_f32_16x16x32_bf16 v[52:55],a[108:111],v[140:143],v[52:55]
 ds_read_b128 a[160:163],v1 offset:24576
 v_mul_f32 v83,v83,v12
 v_mfma_f32_16x16x32_bf16 v[36:39],a[112:115],v[112:115],v[36:39]
 v_mul_f32 v84,v84,v12
 v_mul_f32 v85,v85,v12
 v_mfma_f32_16x16x32_bf16 v[36:39],a[116:119],v[116:119],v[36:39]
 ds_read_b128 a[164:167],v1 offset:25600
 v_mul_f32 v86,v86,v12
 v_mfma_f32_16x16x32_bf16 v[36:39],a[120:123],v[120:123],v[36:39]
 buffer_load_dwordx4 v15,s[28:31],s64 offen offset:1024 sc1 lds
 v_mfma_f32_16x16x32_bf16 v[36:39],a[124:127],v[124:127],v[36:39]
 ds_read_b128 a[168:171],v1 offset:26624
 v_mul_f32 v87,v87,v12
 v_mfma_f32_16x16x32_bf16 v[52:55],a[112:115],v[144:147],v[52:55]
 v_cvt_pk_bf16_f32 v228,v80,v81
 v_cvt_pk_bf16_f32 v229,v82,v83
 v_mfma_f32_16x16x32_bf16 v[52:55],a[116:119],v[148:151],v[52:55]
 ds_read_b128 a[172:175],v1 offset:27648
 v_cvt_pk_bf16_f32 v230,v84,v85
 v_mfma_f32_16x16x32_bf16 v[52:55],a[120:123],v[152:155],v[52:55]
 buffer_load_dwordx4 v15,s[28:31],s64 offen offset:2048 sc1 lds
 v_mfma_f32_16x16x32_bf16 v[52:55],a[124:127],v[156:159],v[52:55]
 s_waitcnt lgkmcnt(4)
 v_cvt_pk_bf16_f32 v231,v86,v87
 v_mfma_f32_16x16x32_bf16 v[40:43],a[128:131],v[96:99],0
 ds_read_b128 a[176:179],v1 offset:28672
 ds_read_b128 a[180:183],v1 offset:29696
 v_mfma_f32_16x16x32_bf16 v[40:43],a[132:135],v[100:103],v[40:43]
 buffer_store_dwordx4 v[228:231],v249,s[28:31],s60 offen sc1
 v_mfma_f32_16x16x32_bf16 v[40:43],a[136:139],v[104:107],v[40:43]
 v_mul_f32 v72,v72,v10
 v_mul_f32 v73,v73,v10
 v_mfma_f32_16x16x32_bf16 v[40:43],a[140:143],v[108:111],v[40:43]
 ds_read_b128 a[184:187],v1 offset:30720
 v_mul_f32 v74,v74,v10
 v_mfma_f32_16x16x32_bf16 v[56:59],a[128:131],v[128:131],0
 buffer_load_dwordx4 v15,s[28:31],s64 offen offset:3072 sc1 lds
 v_mfma_f32_16x16x32_bf16 v[56:59],a[132:135],v[132:135],v[56:59]
 v_mul_f32 v75,v75,v10
 s_add_u32 s64,s64,32768
 v_mfma_f32_16x16x32_bf16 v[56:59],a[136:139],v[136:139],v[56:59]
 ds_read_b128 a[188:191],v1 offset:31744
 v_mul_f32 v76,v76,v10
 v_mfma_f32_16x16x32_bf16 v[56:59],a[140:143],v[140:143],v[56:59]
 v_mul_f32 v77,v77,v10
 v_mul_f32 v78,v78,v10
 v_mfma_f32_16x16x32_bf16 v[40:43],a[144:147],v[112:115],v[40:43]
 s_cmp_ge_u32 s73,2
 s_cselect_b32 s64,s64,0xf0000000
 v_mfma_f32_16x16x32_bf16 v[40:43],a[148:151],v[116:119],v[40:43]
 v_mul_f32 v79,v79,v10
 v_cvt_pk_bf16_f32 v232,v72,v73
 v_mfma_f32_16x16x32_bf16 v[40:43],a[152:155],v[120:123],v[40:43]
 v_cvt_pk_bf16_f32 v233,v74,v75
 s_add_u32 s62,s65,0
 v_mfma_f32_16x16x32_bf16 v[40:43],a[156:159],v[124:127],v[40:43]
 s_add_u32 s60,s37,114688
 v_cvt_pk_bf16_f32 v234,v76,v77
 v_mfma_f32_16x16x32_bf16 v[56:59],a[144:147],v[144:147],v[56:59]
 v_cvt_pk_bf16_f32 v235,v78,v79
 v_mfma_f32_16x16x32_bf16 v[56:59],a[148:151],v[148:151],v[56:59]
 s_waitcnt vmcnt(24) lgkmcnt(0)
 s_barrier
 v_mfma_f32_16x16x32_bf16 v[56:59],a[152:155],v[152:155],v[56:59]
 buffer_store_dwordx4 v[232:235],v1,s[28:31],s60 offen sc1
 v_mfma_f32_16x16x32_bf16 v[56:59],a[156:159],v[156:159],v[56:59]
 ds_read_b128 a[64:67],v1 offset:32768
 v_mul_f32 v88,v88,v12
 v_mfma_f32_16x16x32_bf16 v[44:47],a[160:163],v[96:99],0
 ds_read_b128 a[68:71],v1 offset:33792
 v_mul_f32 v89,v89,v12
 v_mfma_f32_16x16x32_bf16 v[44:47],a[164:167],v[100:103],v[44:47]
 buffer_load_dwordx4 a[192:195],v1,s[28:31],s62 offen offset:0 sc1
 v_mfma_f32_16x16x32_bf16 v[44:47],a[168:171],v[104:107],v[44:47]
 ds_read_b128 a[72:75],v1 offset:34816
 v_mul_f32 v90,v90,v12
 v_mfma_f32_16x16x32_bf16 v[44:47],a[172:175],v[108:111],v[44:47]
 ds_read_b128 a[76:79],v1 offset:35840
 v_mul_f32 v91,v91,v12
 v_mfma_f32_16x16x32_bf16 v[60:63],a[160:163],v[128:131],0
 buffer_load_dwordx4 a[196:199],v1,s[28:31],s62 offen offset:1024 sc1
 v_mfma_f32_16x16x32_bf16 v[60:63],a[164:167],v[132:135],v[60:63]
 ds_read_b128 a[80:83],v1 offset:36864
 v_mul_f32 v92,v92,v12
 v_mfma_f32_16x16x32_bf16 v[60:63],a[168:171],v[136:139],v[60:63]
 ds_read_b128 a[84:87],v1 offset:37888
 v_mul_f32 v93,v93,v12
 v_mfma_f32_16x16x32_bf16 v[60:63],a[172:175],v[140:143],v[60:63]
 ds_read_b128 a[88:91],v1 offset:38912
 v_mul_f32 v94,v94,v12
 v_mfma_f32_16x16x32_bf16 v[44:47],a[176:179],v[112:115],v[44:47]
 buffer_load_dwordx4 a[200:203],v1,s[28:31],s62 offen offset:2048 sc1
 v_mfma_f32_16x16x32_bf16 v[44:47],a[180:183],v[116:119],v[44:47]
 ds_read_b128 a[92:95],v1 offset:39936
 v_mul_f32 v95,v95,v12
 v_mfma_f32_16x16x32_bf16 v[44:47],a[184:187],v[120:123],v[44:47]
 ds_read_b128 a[96:99],v1 offset:40960
 v_cvt_pk_bf16_f32 v236,v88,v89
 v_mfma_f32_16x16x32_bf16 v[44:47],a[188:191],v[124:127],v[44:47]
 ds_read_b128 a[100:103],v1 offset:41984
 v_cvt_pk_bf16_f32 v237,v90,v91
 v_mfma_f32_16x16x32_bf16 v[60:63],a[176:179],v[144:147],v[60:63]
 buffer_load_dwordx4 a[204:207],v1,s[28:31],s62 offen offset:3072 sc1
 v_mfma_f32_16x16x32_bf16 v[60:63],a[180:183],v[148:151],v[60:63]
 v_cvt_pk_bf16_f32 v238,v92,v93
 v_cvt_pk_bf16_f32 v239,v94,v95
 v_mfma_f32_16x16x32_bf16 v[60:63],a[184:187],v[152:155],v[60:63]
 ds_read_b128 a[104:107],v1 offset:43008
 ds_read_b128 a[108:111],v1 offset:44032
 v_mfma_f32_16x16x32_bf16 v[60:63],a[188:191],v[156:159],v[60:63]
 s_waitcnt lgkmcnt(4)
 buffer_store_dwordx4 v[236:239],v249,s[28:31],s60 offen sc1
 ds_read_b128 a[112:115],v1 offset:45056
 v_mfma_f32_16x16x32_bf16 v[64:67],a[64:67],v[96:99],0
 ds_read_b128 a[116:119],v1 offset:46080
 s_add_u32 m0,s51,0
 v_mfma_f32_16x16x32_bf16 v[64:67],a[68:71],v[100:103],v[64:67]
 v_mfma_f32_16x16x32_bf16 v[64:67],a[72:75],v[104:107],v[64:67]
 ds_read_b128 a[120:123],v1 offset:47104
 v_mfma_f32_16x16x32_bf16 v[64:67],a[76:79],v[108:111],v[64:67]
 buffer_load_dwordx4 v14,s[28:31],s64 offen offset:0 sc1 lds
 v_mfma_f32_16x16x32_bf16 v[80:83],a[64:67],v[128:131],0
 ds_read_b128 a[124:127],v1 offset:48128
 v_mul_f32 v32,v32,v10
 v_mfma_f32_16x16x32_bf16 v[80:83],a[68:71],v[132:135],v[80:83]
 v_mul_f32 v33,v33,v10
 v_mfma_f32_16x16x32_bf16 v[80:83],a[72:75],v[136:139],v[80:83]
 ds_read_b128 a[128:131],v1 offset:49152
 v_mul_f32 v34,v34,v10
 v_mfma_f32_16x16x32_bf16 v[80:83],a[76:79],v[140:143],v[80:83]
 v_mul_f32 v35,v35,v10
 v_mfma_f32_16x16x32_bf16 v[64:67],a[80:83],v[112:115],v[64:67]
 buffer_load_dwordx4 v14,s[28:31],s64 offen offset:1024 sc1 lds
 v_mfma_f32_16x16x32_bf16 v[64:67],a[84:87],v[116:119],v[64:67]
 ds_read_b128 a[132:135],v1 offset:50176
 v_mul_f32 v36,v36,v10
 v_mfma_f32_16x16x32_bf16 v[64:67],a[88:91],v[120:123],v[64:67]
 ds_read_b128 a[136:139],v1 offset:51200
 v_mul_f32 v37,v37,v10
 v_mfma_f32_16x16x32_bf16 v[64:67],a[92:95],v[124:127],v[64:67]
 v_mul_f32 v38,v38,v10
 v_mul_f32 v39,v39,v10
 v_mfma_f32_16x16x32_bf16 v[80:83],a[80:83],v[144:147],v[80:83]
 buffer_load_dwordx4 v14,s[28:31],s64 offen offset:2048 sc1 lds
 v_mfma_f32_16x16x32_bf16 v[80:83],a[84:87],v[148:151],v[80:83]
 ds_read_b128 a[140:143],v1 offset:52224
 v_cvt_pk_bf16_f32 v224,v32,v33
 v_mfma_f32_16x16x32_bf16 v[80:83],a[88:91],v[152:155],v[80:83]
 ds_read_b128 a[144:147],v1 offset:53248
 v_cvt_pk_bf16_f32 v225,v34,v35
 v_mfma_f32_16x16x32_bf16 v[80:83],a[92:95],v[156:159],v[80:83]
 s_waitcnt lgkmcnt(5)
 s_add_u32 s60,s37,131072
 v_mfma_f32_16x16x32_bf16 v[68:71],a[96:99],v[96:99],0
 buffer_load_dwordx4 v14,s[28:31],s64 offen offset:3072 sc1 lds
 v_mfma_f32_16x16x32_bf16 v[68:71],a[100:103],v[100:103],v[68:71]
 ds_read_b128 a[148:151],v1 offset:54272
 v_cvt_pk_bf16_f32 v226,v36,v37
 v_mfma_f32_16x16x32_bf16 v[68:71],a[104:107],v[104:107],v[68:71]
 ds_read_b128 a[152:155],v1 offset:55296
 v_cvt_pk_bf16_f32 v227,v38,v39
 v_mfma_f32_16x16x32_bf16 v[68:71],a[108:111],v[108:111],v[68:71]
 buffer_store_dwordx4 v[224:227],v1,s[28:31],s60 offen sc1
 v_mfma_f32_16x16x32_bf16 v[84:87],a[96:99],v[128:131],0
 v_mul_f32 v48,v48,v12
 s_add_u32 m0,s51,4096
 v_mfma_f32_16x16x32_bf16 v[84:87],a[100:103],v[132:135],v[84:87]
 ds_read_b128 a[156:159],v1 offset:56320
 v_mul_f32 v49,v49,v12
 v_mfma_f32_16x16x32_bf16 v[84:87],a[104:107],v[136:139],v[84:87]
 v_mul_f32 v50,v50,v12
 v_mul_f32 v51,v51,v12
 v_mfma_f32_16x16x32_bf16 v[84:87],a[108:111],v[140:143],v[84:87]
 ds_read_b128 a[160:163],v1 offset:57344
 v_mul_f32 v52,v52,v12
 v_mfma_f32_16x16x32_bf16 v[68:71],a[112:115],v[112:115],v[68:71]
 buffer_load_dwordx4 v15,s[28:31],s64 offen offset:0 sc1 lds
 v_mfma_f32_16x16x32_bf16 v[68:71],a[116:119],v[116:119],v[68:71]
 ds_read_b128 a[164:167],v1 offset:58368
 v_mul_f32 v53,v53,v12
 v_mfma_f32_16x16x32_bf16 v[68:71],a[120:123],v[120:123],v[68:71]
 v_mul_f32 v54,v54,v12
 v_mul_f32 v55,v55,v12
 v_mfma_f32_16x16x32_bf16 v[68:71],a[124:127],v[124:127],v[68:71]
 ds_read_b128 a[168:171],v1 offset:59392
 v_cvt_pk_bf16_f32 v228,v48,v49
 v_mfma_f32_16x16x32_bf16 v[84:87],a[112:115],v[144:147],v[84:87]
 buffer_load_dwordx4 v15,s[28:31],s64 offen offset:1024 sc1 lds
 v_mfma_f32_16x16x32_bf16 v[84:87],a[116:119],v[148:151],v[84:87]
 ds_read_b128 a[172:175],v1 offset:60416
 v_cvt_pk_bf16_f32 v229,v50,v51
 v_mfma_f32_16x16x32_bf16 v[84:87],a[120:123],v[152:155],v[84:87]
 v_cvt_pk_bf16_f32 v230,v52,v53
 v_cvt_pk_bf16_f32 v231,v54,v55
 v_mfma_f32_16x16x32_bf16 v[84:87],a[124:127],v[156:159],v[84:87]
 s_waitcnt lgkmcnt(4)
 ds_read_b128 a[176:179],v1 offset:61440
 v_mfma_f32_16x16x32_bf16 v[72:75],a[128:131],v[96:99],0
 buffer_load_dwordx4 v15,s[28:31],s64 offen offset:2048 sc1 lds
 v_mfma_f32_16x16x32_bf16 v[72:75],a[132:135],v[100:103],v[72:75]
 buffer_store_dwordx4 v[228:231],v249,s[28:31],s60 offen sc1
 v_mfma_f32_16x16x32_bf16 v[72:75],a[136:139],v[104:107],v[72:75]
 ds_read_b128 a[180:183],v1 offset:62464
 v_mul_f32 v40,v40,v10
 v_mfma_f32_16x16x32_bf16 v[72:75],a[140:143],v[108:111],v[72:75]
 ds_read_b128 a[184:187],v1 offset:63488
 v_mul_f32 v41,v41,v10
 v_mfma_f32_16x16x32_bf16 v[88:91],a[128:131],v[128:131],0
 buffer_load_dwordx4 v15,s[28:31],s64 offen offset:3072 sc1 lds
 v_mfma_f32_16x16x32_bf16 v[88:91],a[132:135],v[132:135],v[88:91]
 v_mul_f32 v42,v42,v10
 v_mul_f32 v43,v43,v10
 v_mfma_f32_16x16x32_bf16 v[88:91],a[136:139],v[136:139],v[88:91]
 ds_read_b128 a[188:191],v1 offset:64512
 v_mul_f32 v44,v44,v10
 v_mfma_f32_16x16x32_bf16 v[88:91],a[140:143],v[140:143],v[88:91]
 v_mul_f32 v45,v45,v10
 s_add_u32 s64,s64,32768
 v_mfma_f32_16x16x32_bf16 v[72:75],a[144:147],v[112:115],v[72:75]
 v_mul_f32 v46,v46,v10
 v_mul_f32 v47,v47,v10
 v_mfma_f32_16x16x32_bf16 v[72:75],a[148:151],v[116:119],v[72:75]
 v_cvt_pk_bf16_f32 v232,v40,v41
 s_add_u32 s62,s65,4096
 v_mfma_f32_16x16x32_bf16 v[72:75],a[152:155],v[120:123],v[72:75]
 v_cvt_pk_bf16_f32 v233,v42,v43
 s_add_u32 s60,s37,147456
 v_mfma_f32_16x16x32_bf16 v[72:75],a[156:159],v[124:127],v[72:75]
 v_cvt_pk_bf16_f32 v234,v44,v45
 v_mfma_f32_16x16x32_bf16 v[88:91],a[144:147],v[144:147],v[88:91]
 v_cvt_pk_bf16_f32 v235,v46,v47
 v_mfma_f32_16x16x32_bf16 v[88:91],a[148:151],v[148:151],v[88:91]
 s_waitcnt vmcnt(10) lgkmcnt(0)
 s_barrier
 v_mfma_f32_16x16x32_bf16 v[88:91],a[152:155],v[152:155],v[88:91]
 buffer_load_dwordx4 a[208:211],v1,s[28:31],s62 offen offset:0 sc1
 v_mfma_f32_16x16x32_bf16 v[88:91],a[156:159],v[156:159],v[88:91]
 buffer_store_dwordx4 v[232:235],v1,s[28:31],s60 offen sc1
 v_mfma_f32_16x16x32_bf16 v[76:79],a[160:163],v[96:99],0
 ds_read_b128 a[64:67],v2 offset:0
 v_mul_f32 v56,v56,v12
 v_mfma_f32_16x16x32_bf16 v[76:79],a[164:167],v[100:103],v[76:79]
 ds_read_b128 a[68:71],v2 offset:1024
 v_mul_f32 v57,v57,v12
 v_mfma_f32_16x16x32_bf16 v[76:79],a[168:171],v[104:107],v[76:79]
 ds_read_b128 a[72:75],v2 offset:2048
 v_mul_f32 v58,v58,v12
 v_mfma_f32_16x16x32_bf16 v[76:79],a[172:175],v[108:111],v[76:79]
 buffer_load_dwordx4 a[212:215],v1,s[28:31],s62 offen offset:1024 sc1
 v_mfma_f32_16x16x32_bf16 v[92:95],a[160:163],v[128:131],0
 ds_read_b128 a[76:79],v2 offset:3072
 v_mul_f32 v59,v59,v12
 v_mfma_f32_16x16x32_bf16 v[92:95],a[164:167],v[132:135],v[92:95]
 ds_read_b128 a[80:83],v2 offset:4096
 v_mul_f32 v60,v60,v12
 v_mfma_f32_16x16x32_bf16 v[92:95],a[168:171],v[136:139],v[92:95]
 ds_read_b128 a[84:87],v2 offset:5120
 v_mul_f32 v61,v61,v12
 v_mfma_f32_16x16x32_bf16 v[92:95],a[172:175],v[140:143],v[92:95]
 ds_read_b128 a[88:91],v2 offset:6144
 v_mul_f32 v62,v62,v12
 v_mfma_f32_16x16x32_bf16 v[76:79],a[176:179],v[112:115],v[76:79]
 buffer_load_dwordx4 a[216:219],v1,s[28:31],s62 offen offset:2048 sc1
 v_mfma_f32_16x16x32_bf16 v[76:79],a[180:183],v[116:119],v[76:79]
 ds_read_b128 a[92:95],v2 offset:7168
 v_mul_f32 v63,v63,v12
 v_mfma_f32_16x16x32_bf16 v[76:79],a[184:187],v[120:123],v[76:79]
 ds_read_b128 a[96:99],v2 offset:8192
 v_cvt_pk_bf16_f32 v236,v56,v57
 v_mfma_f32_16x16x32_bf16 v[76:79],a[188:191],v[124:127],v[76:79]
 ds_read_b128 a[100:103],v2 offset:9216
 v_cvt_pk_bf16_f32 v237,v58,v59
 v_mfma_f32_16x16x32_bf16 v[92:95],a[176:179],v[144:147],v[92:95]
 buffer_load_dwordx4 a[220:223],v1,s[28:31],s62 offen offset:3072 sc1
 v_mfma_f32_16x16x32_bf16 v[92:95],a[180:183],v[148:151],v[92:95]
 v_cvt_pk_bf16_f32 v238,v60,v61
 v_cvt_pk_bf16_f32 v239,v62,v63
 v_mfma_f32_16x16x32_bf16 v[92:95],a[184:187],v[152:155],v[92:95]
 ds_read_b128 a[104:107],v2 offset:10240
 ds_read_b128 a[108:111],v2 offset:11264
 v_mfma_f32_16x16x32_bf16 v[92:95],a[188:191],v[156:159],v[92:95]
 s_waitcnt lgkmcnt(4)
 buffer_store_dwordx4 v[236:239],v249,s[28:31],s60 offen sc1
 ds_read_b128 a[112:115],v2 offset:12288
 s_cmp_eq_u32 s45,0
 s_cbranch_scc0 SIG_40
 s_add_u32 s61,s41,208
 s_lshl_b32 s61,s61,7
 s_add_u32 s61,s61,125829120
 v_mov_b32 v16,1
 v_mov_b32 v17,0
 s_mov_b64 exec,1
 buffer_atomic_add v16,v17,s[28:31],s61 offen sc1
 s_mov_b64 exec,-1
SIG_40:
 v_mfma_f32_16x16x32_bf16 v[32:35],a[64:67],v[96:99],0
 ds_read_b128 a[116:119],v2 offset:13312
 s_add_u32 s62,s65,0
 v_mfma_f32_16x16x32_bf16 v[32:35],a[68:71],v[100:103],v[32:35]
 v_mfma_f32_16x16x32_bf16 v[32:35],a[72:75],v[104:107],v[32:35]
 ds_read_b128 a[120:123],v2 offset:14336
 v_mfma_f32_16x16x32_bf16 v[32:35],a[76:79],v[108:111],v[32:35]
 v_mfma_f32_16x16x32_bf16 v[48:51],a[64:67],v[128:131],0
 ds_read_b128 a[124:127],v2 offset:15360
 v_mul_f32 v64,v64,v10
 v_mfma_f32_16x16x32_bf16 v[48:51],a[68:71],v[132:135],v[48:51]
 buffer_load_dwordx4 a[224:227],v243,s[28:31],s62 offen offset:0 sc1
 v_mfma_f32_16x16x32_bf16 v[48:51],a[72:75],v[136:139],v[48:51]
 ds_read_b128 a[128:131],v2 offset:16384
 v_mul_f32 v65,v65,v10
 v_mfma_f32_16x16x32_bf16 v[48:51],a[76:79],v[140:143],v[48:51]
 v_mul_f32 v66,v66,v10
 v_mul_f32 v67,v67,v10
 v_mfma_f32_16x16x32_bf16 v[32:35],a[80:83],v[112:115],v[32:35]
 ds_read_b128 a[132:135],v2 offset:17408
 v_mul_f32 v68,v68,v10
 v_mfma_f32_16x16x32_bf16 v[32:35],a[84:87],v[116:119],v[32:35]
 buffer_load_dwordx4 a[228:231],v243,s[28:31],s62 offen offset:1024 sc1
 v_mfma_f32_16x16x32_bf16 v[32:35],a[88:91],v[120:123],v[32:35]
 ds_read_b128 a[136:139],v2 offset:18432
 v_mul_f32 v69,v69,v10
 v_mfma_f32_16x16x32_bf16 v[32:35],a[92:95],v[124:127],v[32:35]
 v_mul_f32 v70,v70,v10
 v_mul_f32 v71,v71,v10
 v_mfma_f32_16x16x32_bf16 v[48:51],a[80:83],v[144:147],v[48:51]
 ds_read_b128 a[140:143],v2 offset:19456
 v_cvt_pk_bf16_f32 v224,v64,v65
 v_mfma_f32_16x16x32_bf16 v[48:51],a[84:87],v[148:151],v[48:51]
 buffer_load_dwordx4 a[232:235],v243,s[28:31],s62 offen offset:2048 sc1
 v_mfma_f32_16x16x32_bf16 v[48:51],a[88:91],v[152:155],v[48:51]
 ds_read_b128 a[144:147],v2 offset:20480
 v_cvt_pk_bf16_f32 v225,v66,v67
 v_mfma_f32_16x16x32_bf16 v[48:51],a[92:95],v[156:159],v[48:51]
 s_waitcnt lgkmcnt(5)
 s_add_u32 s60,s37,163840
 v_mfma_f32_16x16x32_bf16 v[36:39],a[96:99],v[96:99],0
 ds_read_b128 a[148:151],v2 offset:21504
 v_cvt_pk_bf16_f32 v226,v68,v69
 v_mfma_f32_16x16x32_bf16 v[36:39],a[100:103],v[100:103],v[36:39]
 buffer_load_dwordx4 a[236:239],v243,s[28:31],s62 offen offset:3072 sc1
 v_mfma_f32_16x16x32_bf16 v[36:39],a[104:107],v[104:107],v[36:39]
 ds_read_b128 a[152:155],v2 offset:22528
 v_cvt_pk_bf16_f32 v227,v70,v71
 v_mfma_f32_16x16x32_bf16 v[36:39],a[108:111],v[108:111],v[36:39]
 buffer_store_dwordx4 v[224:227],v1,s[28:31],s60 offen sc1
 v_mfma_f32_16x16x32_bf16 v[52:55],a[96:99],v[128:131],0
 v_mul_f32 v80,v80,v12
 v_mul_f32 v81,v81,v12
 v_mfma_f32_16x16x32_bf16 v[52:55],a[100:103],v[132:135],v[52:55]
 ds_read_b128 a[156:159],v2 offset:23552
 s_add_u32 s62,s65,4096
 v_mfma_f32_16x16x32_bf16 v[52:55],a[104:107],v[136:139],v[52:55]
 v_mul_f32 v82,v82,v12
 v_mul_f32 v83,v83,v12
 v_mfma_f32_16x16x32_bf16 v[52:55],a[108:111],v[140:143],v[52:55]
 ds_read_b128 a[160:163],v2 offset:24576
 v_mul_f32 v84,v84,v12
 v_mfma_f32_16x16x32_bf16 v[36:39],a[112:115],v[112:115],v[36:39]
 ds_read_b128 a[164:167],v2 offset:25600
 v_mul_f32 v85,v85,v12
 v_mfma_f32_16x16x32_bf16 v[36:39],a[116:119],v[116:119],v[36:39]
 buffer_load_dwordx4 a[240:243],v243,s[28:31],s62 offen offset:0 sc1
 v_mfma_f32_16x16x32_bf16 v[36:39],a[120:123],v[120:123],v[36:39]
 v_mul_f32 v86,v86,v12
 v_mul_f32 v87,v87,v12
 v_mfma_f32_16x16x32_bf16 v[36:39],a[124:127],v[124:127],v[36:39]
 ds_read_b128 a[168:171],v2 offset:26624
 v_cvt_pk_bf16_f32 v228,v80,v81
 v_mfma_f32_16x16x32_bf16 v[52:55],a[112:115],v[144:147],v[52:55]
 ds_read_b128 a[172:175],v2 offset:27648
 v_cvt_pk_bf16_f32 v229,v82,v83
 v_mfma_f32_16x16x32_bf16 v[52:55],a[116:119],v[148:151],v[52:55]
 buffer_load_dwordx4 a[244:247],v243,s[28:31],s62 offen offset:1024 sc1
 v_mfma_f32_16x16x32_bf16 v[52:55],a[120:123],v[152:155],v[52:55]
 v_cvt_pk_bf16_f32 v230,v84,v85
 v_cvt_pk_bf16_f32 v231,v86,v87
 v_mfma_f32_16x16x32_bf16 v[52:55],a[124:127],v[156:159],v[52:55]
 s_waitcnt lgkmcnt(4)
 ds_read_b128 a[176:179],v2 offset:28672
 v_mfma_f32_16x16x32_bf16 v[40:43],a[128:131],v[96:99],0
 buffer_store_dwordx4 v[228:231],v249,s[28:31],s60 offen sc1
 v_mfma_f32_16x16x32_bf16 v[40:43],a[132:135],v[100:103],v[40:43]
 ds_read_b128 a[180:183],v2 offset:29696
 v_mul_f32 v72,v72,v10
 v_mfma_f32_16x16x32_bf16 v[40:43],a[136:139],v[104:107],v[40:43]
 ds_read_b128 a[184:187],v2 offset:30720
 v_mul_f32 v73,v73,v10
 v_mfma_f32_16x16x32_bf16 v[40:43],a[140:143],v[108:111],v[40:43]
 buffer_load_dwordx4 a[248:251],v243,s[28:31],s62 offen offset:2048 sc1
 v_mfma_f32_16x16x32_bf16 v[56:59],a[128:131],v[128:131],0
 v_mul_f32 v74,v74,v10
 v_mul_f32 v75,v75,v10
 v_mfma_f32_16x16x32_bf16 v[56:59],a[132:135],v[132:135],v[56:59]
 ds_read_b128 a[188:191],v2 offset:31744
 v_mul_f32 v76,v76,v10
 v_mfma_f32_16x16x32_bf16 v[56:59],a[136:139],v[136:139],v[56:59]
 buffer_load_dwordx4 a[252:255],v243,s[28:31],s62 offen offset:3072 sc1
 v_mfma_f32_16x16x32_bf16 v[56:59],a[140:143],v[140:143],v[56:59]
 v_mul_f32 v77,v77,v10
 v_mul_f32 v78,v78,v10
 v_mfma_f32_16x16x32_bf16 v[40:43],a[144:147],v[112:115],v[40:43]
 v_mul_f32 v79,v79,v10
 v_cvt_pk_bf16_f32 v232,v72,v73
 v_mfma_f32_16x16x32_bf16 v[40:43],a[148:151],v[116:119],v[40:43]
 v_cvt_pk_bf16_f32 v233,v74,v75
 v_mfma_f32_16x16x32_bf16 v[40:43],a[152:155],v[120:123],v[40:43]
 s_add_u32 s60,s37,180224
 v_mfma_f32_16x16x32_bf16 v[40:43],a[156:159],v[124:127],v[40:43]
 v_cvt_pk_bf16_f32 v234,v76,v77
 v_mfma_f32_16x16x32_bf16 v[56:59],a[144:147],v[144:147],v[56:59]
 v_cvt_pk_bf16_f32 v235,v78,v79
 v_mfma_f32_16x16x32_bf16 v[56:59],a[148:151],v[148:151],v[56:59]
 s_waitcnt vmcnt(32) lgkmcnt(0)
 s_barrier
 v_mfma_f32_16x16x32_bf16 v[56:59],a[152:155],v[152:155],v[56:59]
 buffer_store_dwordx4 v[232:235],v1,s[28:31],s60 offen sc1
 v_mfma_f32_16x16x32_bf16 v[56:59],a[156:159],v[156:159],v[56:59]
 ds_read_b128 a[64:67],v2 offset:32768
 v_mul_f32 v88,v88,v12
 v_mfma_f32_16x16x32_bf16 v[44:47],a[160:163],v[96:99],0
 ds_read_b128 a[68:71],v2 offset:33792
 v_mul_f32 v89,v89,v12
 v_mfma_f32_16x16x32_bf16 v[44:47],a[164:167],v[100:103],v[44:47]
 ds_read_b128 a[72:75],v2 offset:34816
 v_mul_f32 v90,v90,v12
 v_mfma_f32_16x16x32_bf16 v[44:47],a[168:171],v[104:107],v[44:47]
 ds_read_b128 a[76:79],v2 offset:35840
 v_mul_f32 v91,v91,v12
 v_mfma_f32_16x16x32_bf16 v[44:47],a[172:175],v[108:111],v[44:47]
 ds_read_b128 a[80:83],v2 offset:36864
 v_mul_f32 v92,v92,v12
 v_mfma_f32_16x16x32_bf16 v[60:63],a[160:163],v[128:131],0
 ds_read_b128 a[84:87],v2 offset:37888
 v_mul_f32 v93,v93,v12
 v_mfma_f32_16x16x32_bf16 v[60:63],a[164:167],v[132:135],v[60:63]
 ds_read_b128 a[88:91],v2 offset:38912
 v_mul_f32 v94,v94,v12
 v_mfma_f32_16x16x32_bf16 v[60:63],a[168:171],v[136:139],v[60:63]
 ds_read_b128 a[92:95],v2 offset:39936
 v_mul_f32 v95,v95,v12
 v_mfma_f32_16x16x32_bf16 v[60:63],a[172:175],v[140:143],v[60:63]
 ds_read_b128 a[96:99],v2 offset:40960
 v_cvt_pk_bf16_f32 v236,v88,v89
 v_mfma_f32_16x16x32_bf16 v[44:47],a[176:179],v[112:115],v[44:47]
 ds_read_b128 a[100:103],v2 offset:41984
 v_cvt_pk_bf16_f32 v237,v90,v91
 v_mfma_f32_16x16x32_bf16 v[44:47],a[180:183],v[116:119],v[44:47]
 v_cvt_pk_bf16_f32 v238,v92,v93
 v_cvt_pk_bf16_f32 v239,v94,v95
 v_mfma_f32_16x16x32_bf16 v[44:47],a[184:187],v[120:123],v[44:47]
 ds_read_b128 a[104:107],v2 offset:43008
 v_mfma_f32_16x16x32_bf16 v[44:47],a[188:191],v[124:127],v[44:47]
 buffer_store_dwordx4 v[236:239],v249,s[28:31],s60 offen sc1
 v_mfma_f32_16x16x32_bf16 v[60:63],a[176:179],v[144:147],v[60:63]
 ds_read_b128 a[108:111],v2 offset:44032
 v_mfma_f32_16x16x32_bf16 v[60:63],a[180:183],v[148:151],v[60:63]
 v_mfma_f32_16x16x32_bf16 v[60:63],a[184:187],v[152:155],v[60:63]
 ds_read_b128 a[112:115],v2 offset:45056
 v_mfma_f32_16x16x32_bf16 v[60:63],a[188:191],v[156:159],v[60:63]
 s_waitcnt lgkmcnt(5)
 s_cmp_eq_u32 s73,0
 s_cbranch_scc1 K2_PA
 s_cmp_eq_u32 s73,2
 s_cbranch_scc0 NOA_41
 s_waitcnt vmcnt(2)
 v_mfma_f32_16x16x32_bf16 v[64:67],a[64:67],a[0:3],0
 ds_read_b128 a[116:119],v2 offset:46080
 v_mfma_f32_16x16x32_bf16 v[64:67],a[68:71],a[4:7],v[64:67]
 s_mul_i32 s62,s45,57344
 s_sub_u32 s65,s66,s62
 v_mfma_f32_16x16x32_bf16 v[64:67],a[72:75],a[8:11],v[64:67]
 s_add_u32 s65,s65,200704
 ds_read_b128 a[120:123],v2 offset:47104
 v_mfma_f32_16x16x32_bf16 v[64:67],a[76:79],a[12:15],v[64:67]
 v_mfma_f32_16x16x32_bf16 v[80:83],a[64:67],a[32:35],0
 ds_read_b128 a[124:127],v2 offset:48128
 v_mul_f32 v32,v32,v10
 v_mfma_f32_16x16x32_bf16 v[80:83],a[68:71],a[36:39],v[80:83]
 v_mul_f32 v33,v33,v10
 v_mul_f32 v34,v34,v10
 v_mfma_f32_16x16x32_bf16 v[80:83],a[72:75],a[40:43],v[80:83]
 ds_read_b128 a[128:131],v2 offset:49152
 v_mul_f32 v35,v35,v10
 v_mfma_f32_16x16x32_bf16 v[80:83],a[76:79],a[44:47],v[80:83]
 v_mul_f32 v36,v36,v10
 v_mul_f32 v37,v37,v10
 v_mfma_f32_16x16x32_bf16 v[64:67],a[80:83],a[16:19],v[64:67]
 v_mul_f32 v38,v38,v10
 v_mul_f32 v39,v39,v10
 v_mfma_f32_16x16x32_bf16 v[64:67],a[84:87],a[20:23],v[64:67]
 ds_read_b128 a[132:135],v2 offset:50176
 v_cvt_pk_bf16_f32 v224,v32,v33
 v_mfma_f32_16x16x32_bf16 v[64:67],a[88:91],a[24:27],v[64:67]
 v_cvt_pk_bf16_f32 v225,v34,v35
 s_add_u32 s60,s37,196608
 v_mfma_f32_16x16x32_bf16 v[64:67],a[92:95],a[28:31],v[64:67]
 ds_read_b128 a[136:139],v2 offset:51200
 v_cvt_pk_bf16_f32 v226,v36,v37
 v_mfma_f32_16x16x32_bf16 v[80:83],a[80:83],a[48:51],v[80:83]
 ds_read_b128 a[140:143],v2 offset:52224
 v_cvt_pk_bf16_f32 v227,v38,v39
 v_mfma_f32_16x16x32_bf16 v[80:83],a[84:87],a[52:55],v[80:83]
 buffer_store_dwordx4 v[224:227],v1,s[28:31],s60 offen sc1
 v_mfma_f32_16x16x32_bf16 v[80:83],a[88:91],a[56:59],v[80:83]
 v_mul_f32 v48,v48,v12
 v_mul_f32 v49,v49,v12
 v_mfma_f32_16x16x32_bf16 v[80:83],a[92:95],a[60:63],v[80:83]
 s_waitcnt lgkmcnt(4)
 v_mul_f32 v50,v50,v12
 v_mfma_f32_16x16x32_bf16 v[68:71],a[96:99],a[0:3],0
 ds_read_b128 a[144:147],v2 offset:53248
 v_mul_f32 v51,v51,v12
 v_mfma_f32_16x16x32_bf16 v[68:71],a[100:103],a[4:7],v[68:71]
 v_mul_f32 v52,v52,v12
 v_mul_f32 v53,v53,v12
 v_mfma_f32_16x16x32_bf16 v[68:71],a[104:107],a[8:11],v[68:71]
 v_mul_f32 v54,v54,v12
 v_mul_f32 v55,v55,v12
 v_mfma_f32_16x16x32_bf16 v[68:71],a[108:111],a[12:15],v[68:71]
 ds_read_b128 a[148:151],v2 offset:54272
 v_cvt_pk_bf16_f32 v228,v48,v49
 v_mfma_f32_16x16x32_bf16 v[84:87],a[96:99],a[32:35],0
 v_cvt_pk_bf16_f32 v229,v50,v51
 v_cvt_pk_bf16_f32 v230,v52,v53
 v_mfma_f32_16x16x32_bf16 v[84:87],a[100:103],a[36:39],v[84:87]
 ds_read_b128 a[152:155],v2 offset:55296
 v_cvt_pk_bf16_f32 v231,v54,v55
 v_mfma_f32_16x16x32_bf16 v[84:87],a[104:107],a[40:43],v[84:87]
 buffer_store_dwordx4 v[228:231],v249,s[28:31],s60 offen sc1
 v_mfma_f32_16x16x32_bf16 v[84:87],a[108:111],a[44:47],v[84:87]
 v_mul_f32 v40,v40,v10
 v_mul_f32 v41,v41,v10
 v_mfma_f32_16x16x32_bf16 v[68:71],a[112:115],a[16:19],v[68:71]
 ds_read_b128 a[156:159],v2 offset:56320
 v_mul_f32 v42,v42,v10
 v_mfma_f32_16x16x32_bf16 v[68:71],a[116:119],a[20:23],v[68:71]
 v_mul_f32 v43,v43,v10
 v_mul_f32 v44,v44,v10
 v_mfma_f32_16x16x32_bf16 v[68:71],a[120:123],a[24:27],v[68:71]
 ds_read_b128 a[160:163],v2 offset:57344
 v_mul_f32 v45,v45,v10
 v_mfma_f32_16x16x32_bf16 v[68:71],a[124:127],a[28:31],v[68:71]
 v_mul_f32 v46,v46,v10
 v_mul_f32 v47,v47,v10
 v_mfma_f32_16x16x32_bf16 v[84:87],a[112:115],a[48:51],v[84:87]
 ds_read_b128 a[164:167],v2 offset:58368
 v_cvt_pk_bf16_f32 v232,v40,v41
 v_mfma_f32_16x16x32_bf16 v[84:87],a[116:119],a[52:55],v[84:87]
 v_cvt_pk_bf16_f32 v233,v42,v43
 s_add_u32 s60,s37,212992
 v_mfma_f32_16x16x32_bf16 v[84:87],a[120:123],a[56:59],v[84:87]
 buffer_load_dword v20,v18,s[28:31],0 offen sc1
 ds_read_b128 a[168:171],v2 offset:59392
 v_mfma_f32_16x16x32_bf16 v[84:87],a[124:127],a[60:63],v[84:87]
 s_waitcnt lgkmcnt(3)
 v_cvt_pk_bf16_f32 v234,v44,v45
 v_mfma_f32_16x16x32_bf16 v[64:67],a[128:131],a[192:195],v[64:67]
 ds_read_b128 a[172:175],v2 offset:60416
 v_cvt_pk_bf16_f32 v235,v46,v47
 v_mfma_f32_16x16x32_bf16 v[64:67],a[132:135],a[196:199],v[64:67]
 buffer_store_dwordx4 v[232:235],v1,s[28:31],s60 offen sc1
 v_mfma_f32_16x16x32_bf16 v[64:67],a[136:139],a[200:203],v[64:67]
 ds_read_b128 a[176:179],v2 offset:61440
 v_mul_f32 v56,v56,v12
 v_mfma_f32_16x16x32_bf16 v[64:67],a[140:143],a[204:207],v[64:67]
 v_mul_f32 v57,v57,v12
 v_mul_f32 v58,v58,v12
 v_mfma_f32_16x16x32_bf16 v[80:83],a[128:131],a[224:227],v[80:83]
 ds_read_b128 a[180:183],v2 offset:62464
 v_mul_f32 v59,v59,v12
 v_mfma_f32_16x16x32_bf16 v[80:83],a[132:135],a[228:231],v[80:83]
 v_mul_f32 v60,v60,v12
 v_mul_f32 v61,v61,v12
 v_mfma_f32_16x16x32_bf16 v[80:83],a[136:139],a[232:235],v[80:83]
 ds_read_b128 a[184:187],v2 offset:63488
 v_mul_f32 v62,v62,v12
 v_mfma_f32_16x16x32_bf16 v[80:83],a[140:143],a[236:239],v[80:83]
 v_mul_f32 v63,v63,v12
 v_cvt_pk_bf16_f32 v236,v56,v57
 v_mfma_f32_16x16x32_bf16 v[64:67],a[144:147],a[208:211],v[64:67]
 ds_read_b128 a[188:191],v2 offset:64512
 v_cvt_pk_bf16_f32 v237,v58,v59
 v_mfma_f32_16x16x32_bf16 v[64:67],a[148:151],a[212:215],v[64:67]
 v_cvt_pk_bf16_f32 v238,v60,v61
 v_cvt_pk_bf16_f32 v239,v62,v63
 v_mfma_f32_16x16x32_bf16 v[64:67],a[152:155],a[216:219],v[64:67]
 buffer_store_dwordx4 v[236:239],v249,s[28:31],s60 offen sc1
 v_mfma_f32_16x16x32_bf16 v[64:67],a[156:159],a[220:223],v[64:67]
 v_mfma_f32_16x16x32_bf16 v[80:83],a[144:147],a[240:243],v[80:83]
 v_mfma_f32_16x16x32_bf16 v[80:83],a[148:151],a[244:247],v[80:83]
 s_waitcnt vmcnt(23) lgkmcnt(0)
 s_barrier
 v_mfma_f32_16x16x32_bf16 v[80:83],a[152:155],a[248:251],v[80:83]
 ds_read_b128 a[64:67],v1 offset:0
 v_mfma_f32_16x16x32_bf16 v[80:83],a[156:159],a[252:255],v[80:83]
 ds_read_b128 a[68:71],v1 offset:1024
 v_mfma_f32_16x16x32_bf16 v[68:71],a[160:163],a[192:195],v[68:71]
 ds_read_b128 a[72:75],v1 offset:2048
 v_mfma_f32_16x16x32_bf16 v[68:71],a[164:167],a[196:199],v[68:71]
 ds_read_b128 a[76:79],v1 offset:3072
 v_mfma_f32_16x16x32_bf16 v[68:71],a[168:171],a[200:203],v[68:71]
 ds_read_b128 a[80:83],v1 offset:4096
 v_mfma_f32_16x16x32_bf16 v[68:71],a[172:175],a[204:207],v[68:71]
 ds_read_b128 a[84:87],v1 offset:5120
 v_mfma_f32_16x16x32_bf16 v[84:87],a[160:163],a[224:227],v[84:87]
 ds_read_b128 a[88:91],v1 offset:6144
 v_mfma_f32_16x16x32_bf16 v[84:87],a[164:167],a[228:231],v[84:87]
 ds_read_b128 a[92:95],v1 offset:7168
 v_mfma_f32_16x16x32_bf16 v[84:87],a[168:171],a[232:235],v[84:87]
 ds_read_b128 a[96:99],v1 offset:8192
 v_mfma_f32_16x16x32_bf16 v[84:87],a[172:175],a[236:239],v[84:87]
 v_mfma_f32_16x16x32_bf16 v[68:71],a[176:179],a[208:211],v[68:71]
 ds_read_b128 a[100:103],v1 offset:9216
 v_mfma_f32_16x16x32_bf16 v[68:71],a[180:183],a[212:215],v[68:71]
 v_mfma_f32_16x16x32_bf16 v[68:71],a[184:187],a[216:219],v[68:71]
 ds_read_b128 a[104:107],v1 offset:10240
 v_mfma_f32_16x16x32_bf16 v[68:71],a[188:191],a[220:223],v[68:71]
 v_mfma_f32_16x16x32_bf16 v[84:87],a[176:179],a[240:243],v[84:87]
 ds_read_b128 a[108:111],v1 offset:11264
 v_mfma_f32_16x16x32_bf16 v[84:87],a[180:183],a[244:247],v[84:87]
 v_mfma_f32_16x16x32_bf16 v[84:87],a[184:187],a[248:251],v[84:87]
 ds_read_b128 a[112:115],v1 offset:12288
 v_mfma_f32_16x16x32_bf16 v[84:87],a[188:191],a[252:255],v[84:87]
 s_waitcnt lgkmcnt(5)
 v_mfma_f32_16x16x32_bf16 v[32:35],a[64:67],a[0:3],0
 ds_read_b128 a[116:119],v1 offset:13312
 v_mfma_f32_16x16x32_bf16 v[32:35],a[68:71],a[4:7],v[32:35]
 v_mfma_f32_16x16x32_bf16 v[32:35],a[72:75],a[8:11],v[32:35]
 ds_read_b128 a[120:123],v1 offset:14336
 v_mfma_f32_16x16x32_bf16 v[32:35],a[76:79],a[12:15],v[32:35]
 v_mfma_f32_16x16x32_bf16 v[48:51],a[64:67],a[32:35],0
 ds_read_b128 a[124:127],v1 offset:15360
 v_mfma_f32_16x16x32_bf16 v[48:51],a[68:71],a[36:39],v[48:51]
 v_mfma_f32_16x16x32_bf16 v[48:51],a[72:75],a[40:43],v[48:51]
 ds_read_b128 a[128:131],v1 offset:16384
 v_mfma_f32_16x16x32_bf16 v[48:51],a[76:79],a[44:47],v[48:51]
 v_mfma_f32_16x16x32_bf16 v[32:35],a[80:83],a[16:19],v[32:35]
 ds_read_b128 a[132:135],v1 offset:17408
 v_mfma_f32_16x16x32_bf16 v[32:35],a[84:87],a[20:23],v[32:35]
 v_mfma_f32_16x16x32_bf16 v[32:35],a[88:91],a[24:27],v[32:35]
 ds_read_b128 a[136:139],v1 offset:18432
 v_mfma_f32_16x16x32_bf16 v[32:35],a[92:95],a[28:31],v[32:35]
 v_mfma_f32_16x16x32_bf16 v[48:51],a[80:83],a[48:51],v[48:51]
 ds_read_b128 a[140:143],v1 offset:19456
 v_mfma_f32_16x16x32_bf16 v[48:51],a[84:87],a[52:55],v[48:51]
 v_mfma_f32_16x16x32_bf16 v[48:51],a[88:91],a[56:59],v[48:51]
 ds_read_b128 a[144:147],v1 offset:20480
 v_mfma_f32_16x16x32_bf16 v[48:51],a[92:95],a[60:63],v[48:51]
 s_waitcnt lgkmcnt(5)
 v_mfma_f32_16x16x32_bf16 v[36:39],a[96:99],a[0:3],0
 ds_read_b128 a[148:151],v1 offset:21504
 v_mfma_f32_16x16x32_bf16 v[36:39],a[100:103],a[4:7],v[36:39]
 v_mfma_f32_16x16x32_bf16 v[36:39],a[104:107],a[8:11],v[36:39]
 ds_read_b128 a[152:155],v1 offset:22528
 v_mfma_f32_16x16x32_bf16 v[36:39],a[108:111],a[12:15],v[36:39]
 v_mfma_f32_16x16x32_bf16 v[52:55],a[96:99],a[32:35],0
 s_waitcnt vmcnt(0)
 s_barrier
 s_cmp_eq_u32 s45,0
 s_cbranch_scc0 SIG_42
 s_add_u32 s60,s41,32
 s_lshl_b32 s60,s60,7
 s_add_u32 s60,s60,125829120
 v_mov_b32 v16,1
 v_mov_b32 v17,0
 s_mov_b64 exec,1
 buffer_atomic_add v16,v17,s[28:31],s60 offen sc1
 s_mov_b64 exec,-1
SIG_42:
 v_mfma_f32_16x16x32_bf16 v[52:55],a[100:103],a[36:39],v[52:55]
 ds_read_b128 a[156:159],v1 offset:23552
 v_mfma_f32_16x16x32_bf16 v[52:55],a[104:107],a[40:43],v[52:55]
 ds_read_b128 a[160:163],v1 offset:24576
 v_mfma_f32_16x16x32_bf16 v[52:55],a[108:111],a[44:47],v[52:55]
 v_mfma_f32_16x16x32_bf16 v[36:39],a[112:115],a[16:19],v[36:39]
 ds_read_b128 a[164:167],v1 offset:25600
 v_cvt_pk_bf16_f32 v224,v64,v65
 v_mfma_f32_16x16x32_bf16 v[36:39],a[116:119],a[20:23],v[36:39]
 v_mfma_f32_16x16x32_bf16 v[36:39],a[120:123],a[24:27],v[36:39]
 ds_read_b128 a[168:171],v1 offset:26624
 v_cvt_pk_bf16_f32 v225,v66,v67
 v_mfma_f32_16x16x32_bf16 v[36:39],a[124:127],a[28:31],v[36:39]
 v_mfma_f32_16x16x32_bf16 v[52:55],a[112:115],a[48:51],v[52:55]
 ds_read_b128 a[172:175],v1 offset:27648
 v_cvt_pk_bf16_f32 v226,v68,v69
 v_mfma_f32_16x16x32_bf16 v[52:55],a[116:119],a[52:55],v[52:55]
 v_mfma_f32_16x16x32_bf16 v[52:55],a[120:123],a[56:59],v[52:55]
 ds_read_b128 a[176:179],v1 offset:28672
 v_cvt_pk_bf16_f32 v227,v70,v71
 v_mfma_f32_16x16x32_bf16 v[52:55],a[124:127],a[60:63],v[52:55]
 s_waitcnt lgkmcnt(5)
 v_mfma_f32_16x16x32_bf16 v[32:35],a[128:131],a[192:195],v[32:35]
 ds_read_b128 a[180:183],v1 offset:29696
 v_mfma_f32_16x16x32_bf16 v[32:35],a[132:135],a[196:199],v[32:35]
 buffer_store_dwordx4 v[224:227],v248,s[12:15],s66 offen offset:0 sc1
 v_mfma_f32_16x16x32_bf16 v[32:35],a[136:139],a[200:203],v[32:35]
 ds_read_b128 a[184:187],v1 offset:30720
 v_cvt_pk_bf16_f32 v228,v80,v81
 v_mfma_f32_16x16x32_bf16 v[32:35],a[140:143],a[204:207],v[32:35]
 v_mfma_f32_16x16x32_bf16 v[48:51],a[128:131],a[224:227],v[48:51]
 ds_read_b128 a[188:191],v1 offset:31744
 v_cvt_pk_bf16_f32 v229,v82,v83
 v_mfma_f32_16x16x32_bf16 v[48:51],a[132:135],a[228:231],v[48:51]
 v_mfma_f32_16x16x32_bf16 v[48:51],a[136:139],a[232:235],v[48:51]
 v_cvt_pk_bf16_f32 v230,v84,v85
 v_mfma_f32_16x16x32_bf16 v[48:51],a[140:143],a[236:239],v[48:51]
 v_mfma_f32_16x16x32_bf16 v[32:35],a[144:147],a[208:211],v[32:35]
 v_cvt_pk_bf16_f32 v231,v86,v87
 v_mfma_f32_16x16x32_bf16 v[32:35],a[148:151],a[212:215],v[32:35]
 v_mfma_f32_16x16x32_bf16 v[32:35],a[152:155],a[216:219],v[32:35]
 buffer_store_dwordx4 v[228:231],v248,s[12:15],s65 offen offset:0 sc1
 v_mfma_f32_16x16x32_bf16 v[32:35],a[156:159],a[220:223],v[32:35]
 v_mfma_f32_16x16x32_bf16 v[48:51],a[144:147],a[240:243],v[48:51]
 v_mfma_f32_16x16x32_bf16 v[48:51],a[148:151],a[244:247],v[48:51]
 v_mfma_f32_16x16x32_bf16 v[48:51],a[152:155],a[248:251],v[48:51]
 v_mfma_f32_16x16x32_bf16 v[48:51],a[156:159],a[252:255],v[48:51]
 s_waitcnt lgkmcnt(0)
 v_mfma_f32_16x16x32_bf16 v[36:39],a[160:163],a[192:195],v[36:39]
 v_mfma_f32_16x16x32_bf16 v[36:39],a[164:167],a[196:199],v[36:39]
 v_mfma_f32_16x16x32_bf16 v[36:39],a[168:171],a[200:203],v[36:39]
 v_mfma_f32_16x16x32_bf16 v[36:39],a[172:175],a[204:207],v[36:39]
 v_mfma_f32_16x16x32_bf16 v[52:55],a[160:163],a[224:227],v[52:55]
 v_mfma_f32_16x16x32_bf16 v[52:55],a[164:167],a[228:231],v[52:55]
 v_mfma_f32_16x16x32_bf16 v[52:55],a[168:171],a[232:235],v[52:55]
 v_mfma_f32_16x16x32_bf16 v[52:55],a[172:175],a[236:239],v[52:55]
 v_mfma_f32_16x16x32_bf16 v[36:39],a[176:179],a[208:211],v[36:39]
 v_mfma_f32_16x16x32_bf16 v[36:39],a[180:183],a[212:215],v[36:39]
 v_mfma_f32_16x16x32_bf16 v[36:39],a[184:187],a[216:219],v[36:39]
 v_mfma_f32_16x16x32_bf16 v[36:39],a[188:191],a[220:223],v[36:39]
 v_mfma_f32_16x16x32_bf16 v[52:55],a[176:179],a[240:243],v[52:55]
 v_mfma_f32_16x16x32_bf16 v[52:55],a[180:183],a[244:247],v[52:55]
 v_mfma_f32_16x16x32_bf16 v[52:55],a[184:187],a[248:251],v[52:55]
 v_mfma_f32_16x16x32_bf16 v[52:55],a[188:191],a[252:255],v[52:55]
 s_nop 7
 v_cvt_pk_bf16_f32 v224,v32,v33
 v_cvt_pk_bf16_f32 v225,v34,v35
 v_cvt_pk_bf16_f32 v226,v36,v37
 v_cvt_pk_bf16_f32 v227,v38,v39
 buffer_store_dwordx4 v[224:227],v248,s[12:15],s66 offen offset:64 sc1
 v_cvt_pk_bf16_f32 v228,v48,v49
 v_cvt_pk_bf16_f32 v229,v50,v51
 v_cvt_pk_bf16_f32 v230,v52,v53
 v_cvt_pk_bf16_f32 v231,v54,v55
 buffer_store_dwordx4 v[228:231],v248,s[12:15],s65 offen offset:64 sc1
 s_branch K2_PC
NOA_41:
K2_PC:
FL_43:
 v_cmp_lt_u32 vcc,v20,v19
 s_nop 4
 s_cbranch_vccz FL_43D
 s_sleep 2
 buffer_load_dword v20,v18,s[28:31],0 offen sc1
 s_waitcnt vmcnt(0)
 s_branch FL_43
FL_43D:
 s_lshl_b32 s19,s22,2
 s_add_u32 s19,s19,s45
 s_mul_i32 s17,s16,14
 s_add_u32 s17,s17,s19
 s_lshl_b32 s17,s17,14
 s_add_u32 s17,s17,67108864
 s_mul_i32 s18,s16,28672
 s_lshl_b32 s19,s19,6
 s_add_u32 s18,s18,s19
 buffer_load_dwordx4 v[96:99],v1,s[28:31],s17 offen offset:0 sc1
 buffer_load_dwordx4 v[100:103],v1,s[28:31],s17 offen offset:1024 sc1
 buffer_load_dwordx4 v[104:107],v1,s[28:31],s17 offen offset:2048 sc1
 buffer_load_dwordx4 v[108:111],v1,s[28:31],s17 offen offset:3072 sc1
 s_add_u32 s17,s17,4096
 buffer_load_dwordx4 v[112:115],v1,s[28:31],s17 offen offset:0 sc1
 buffer_load_dwordx4 v[116:119],v1,s[28:31],s17 offen offset:1024 sc1
 buffer_load_dwordx4 v[120:123],v1,s[28:31],s17 offen offset:2048 sc1
 buffer_load_dwordx4 v[124:127],v1,s[28:31],s17 offen offset:3072 sc1
 s_add_u32 s17,s17,4096
 buffer_load_dwordx4 v[128:131],v1,s[28:31],s17 offen offset:0 sc1
 buffer_load_dwordx4 v[132:135],v1,s[28:31],s17 offen offset:1024 sc1
 buffer_load_dwordx4 v[136:139],v1,s[28:31],s17 offen offset:2048 sc1
 buffer_load_dwordx4 v[140:143],v1,s[28:31],s17 offen offset:3072 sc1
 s_add_u32 s17,s17,4096
 buffer_load_dwordx4 v[144:147],v1,s[28:31],s17 offen offset:0 sc1
 buffer_load_dwordx4 v[148:151],v1,s[28:31],s17 offen offset:1024 sc1
 buffer_load_dwordx4 v[152:155],v1,s[28:31],s17 offen offset:2048 sc1
 buffer_load_dwordx4 v[156:159],v1,s[28:31],s17 offen offset:3072 sc1
 s_add_u32 s17,s17,4096
 s_branch K2_PEND
K2_LEAN:
 v_mfma_f32_16x16x32_bf16 v[32:35],a[64:67],v[96:99],0
 ds_read_b128 a[116:119],v1 offset:13312
 v_mfma_f32_16x16x32_bf16 v[32:35],a[68:71],v[100:103],v[32:35]
 v_mfma_f32_16x16x32_bf16 v[32:35],a[72:75],v[104:107],v[32:35]
 ds_read_b128 a[120:123],v1 offset:14336
 v_mfma_f32_16x16x32_bf16 v[32:35],a[76:79],v[108:111],v[32:35]
 v_mfma_f32_16x16x32_bf16 v[48:51],a[64:67],v[128:131],0
 ds_read_b128 a[124:127],v1 offset:15360
 v_mul_f32 v64,v64,v10
 v_mfma_f32_16x16x32_bf16 v[48:51],a[68:71],v[132:135],v[48:51]
 v_mul_f32 v65,v65,v10
 v_mfma_f32_16x16x32_bf16 v[48:51],a[72:75],v[136:139],v[48:51]
 ds_read_b128 a[128:131],v1 offset:16384
 v_mul_f32 v66,v66,v10
 v_mfma_f32_16x16x32_bf16 v[48:51],a[76:79],v[140:143],v[48:51]
 v_mul_f32 v67,v67,v10
 v_mfma_f32_16x16x32_bf16 v[32:35],a[80:83],v[112:115],v[32:35]
 ds_read_b128 a[132:135],v1 offset:17408
 v_mul_f32 v68,v68,v10
 v_mfma_f32_16x16x32_bf16 v[32:35],a[84:87],v[116:119],v[32:35]
 v_mul_f32 v69,v69,v10
 v_mfma_f32_16x16x32_bf16 v[32:35],a[88:91],v[120:123],v[32:35]
 ds_read_b128 a[136:139],v1 offset:18432
 v_mul_f32 v70,v70,v10
 v_mfma_f32_16x16x32_bf16 v[32:35],a[92:95],v[124:127],v[32:35]
 v_mul_f32 v71,v71,v10
 v_mfma_f32_16x16x32_bf16 v[48:51],a[80:83],v[144:147],v[48:51]
 ds_read_b128 a[140:143],v1 offset:19456
 v_cvt_pk_bf16_f32 v224,v64,v65
 v_mfma_f32_16x16x32_bf16 v[48:51],a[84:87],v[148:151],v[48:51]
 v_cvt_pk_bf16_f32 v225,v66,v67
 v_mfma_f32_16x16x32_bf16 v[48:51],a[88:91],v[152:155],v[48:51]
 ds_read_b128 a[144:147],v1 offset:20480
 s_add_u32 s60,s37,98304
 v_mfma_f32_16x16x32_bf16 v[48:51],a[92:95],v[156:159],v[48:51]
 s_waitcnt lgkmcnt(5)
 v_cvt_pk_bf16_f32 v226,v68,v69
 v_mfma_f32_16x16x32_bf16 v[36:39],a[96:99],v[96:99],0
 ds_read_b128 a[148:151],v1 offset:21504
 v_cvt_pk_bf16_f32 v227,v70,v71
 v_mfma_f32_16x16x32_bf16 v[36:39],a[100:103],v[100:103],v[36:39]
 buffer_store_dwordx4 v[224:227],v1,s[28:31],s60 offen sc1
 v_mfma_f32_16x16x32_bf16 v[36:39],a[104:107],v[104:107],v[36:39]
 ds_read_b128 a[152:155],v1 offset:22528
 v_mul_f32 v80,v80,v12
 v_mfma_f32_16x16x32_bf16 v[36:39],a[108:111],v[108:111],v[36:39]
 v_mul_f32 v81,v81,v12
 v_mfma_f32_16x16x32_bf16 v[52:55],a[96:99],v[128:131],0
 ds_read_b128 a[156:159],v1 offset:23552
 v_mul_f32 v82,v82,v12
 v_mfma_f32_16x16x32_bf16 v[52:55],a[100:103],v[132:135],v[52:55]
 v_mul_f32 v83,v83,v12
 v_mfma_f32_16x16x32_bf16 v[52:55],a[104:107],v[136:139],v[52:55]
 ds_read_b128 a[160:163],v1 offset:24576
 v_mul_f32 v84,v84,v12
 v_mfma_f32_16x16x32_bf16 v[52:55],a[108:111],v[140:143],v[52:55]
 v_mul_f32 v85,v85,v12
 v_mfma_f32_16x16x32_bf16 v[36:39],a[112:115],v[112:115],v[36:39]
 ds_read_b128 a[164:167],v1 offset:25600
 v_mul_f32 v86,v86,v12
 v_mfma_f32_16x16x32_bf16 v[36:39],a[116:119],v[116:119],v[36:39]
 v_mul_f32 v87,v87,v12
 v_mfma_f32_16x16x32_bf16 v[36:39],a[120:123],v[120:123],v[36:39]
 ds_read_b128 a[168:171],v1 offset:26624
 v_cvt_pk_bf16_f32 v228,v80,v81
 v_mfma_f32_16x16x32_bf16 v[36:39],a[124:127],v[124:127],v[36:39]
 v_cvt_pk_bf16_f32 v229,v82,v83
 v_mfma_f32_16x16x32_bf16 v[52:55],a[112:115],v[144:147],v[52:55]
 ds_read_b128 a[172:175],v1 offset:27648
 v_cvt_pk_bf16_f32 v230,v84,v85
 v_mfma_f32_16x16x32_bf16 v[52:55],a[116:119],v[148:151],v[52:55]
 v_cvt_pk_bf16_f32 v231,v86,v87
 v_mfma_f32_16x16x32_bf16 v[52:55],a[120:123],v[152:155],v[52:55]
 ds_read_b128 a[176:179],v1 offset:28672
 v_mfma_f32_16x16x32_bf16 v[52:55],a[124:127],v[156:159],v[52:55]
 s_waitcnt lgkmcnt(5)
 v_mfma_f32_16x16x32_bf16 v[40:43],a[128:131],v[96:99],0
 buffer_store_dwordx4 v[228:231],v249,s[28:31],s60 offen sc1
 v_mfma_f32_16x16x32_bf16 v[40:43],a[132:135],v[100:103],v[40:43]
 ds_read_b128 a[180:183],v1 offset:29696
 v_mul_f32 v72,v72,v10
 v_mfma_f32_16x16x32_bf16 v[40:43],a[136:139],v[104:107],v[40:43]
 ds_read_b128 a[184:187],v1 offset:30720
 v_mul_f32 v73,v73,v10
 v_mfma_f32_16x16x32_bf16 v[40:43],a[140:143],v[108:111],v[40:43]
 v_mul_f32 v74,v74,v10
 v_mul_f32 v75,v75,v10
 v_mfma_f32_16x16x32_bf16 v[56:59],a[128:131],v[128:131],0
 ds_read_b128 a[188:191],v1 offset:31744
 v_mul_f32 v76,v76,v10
 v_mfma_f32_16x16x32_bf16 v[56:59],a[132:135],v[132:135],v[56:59]
 v_mul_f32 v77,v77,v10
 v_mfma_f32_16x16x32_bf16 v[56:59],a[136:139],v[136:139],v[56:59]
 v_mul_f32 v78,v78,v10
 v_mfma_f32_16x16x32_bf16 v[56:59],a[140:143],v[140:143],v[56:59]
 v_mul_f32 v79,v79,v10
 v_mfma_f32_16x16x32_bf16 v[40:43],a[144:147],v[112:115],v[40:43]
 v_cvt_pk_bf16_f32 v232,v72,v73
 v_mfma_f32_16x16x32_bf16 v[40:43],a[148:151],v[116:119],v[40:43]
 v_cvt_pk_bf16_f32 v233,v74,v75
 v_mfma_f32_16x16x32_bf16 v[40:43],a[152:155],v[120:123],v[40:43]
 s_add_u32 s60,s37,114688
 v_mfma_f32_16x16x32_bf16 v[40:43],a[156:159],v[124:127],v[40:43]
 v_cvt_pk_bf16_f32 v234,v76,v77
 v_mfma_f32_16x16x32_bf16 v[56:59],a[144:147],v[144:147],v[56:59]
 v_cvt_pk_bf16_f32 v235,v78,v79
 v_mfma_f32_16x16x32_bf16 v[56:59],a[148:151],v[148:151],v[56:59]
 s_waitcnt vmcnt(16) lgkmcnt(0)
 s_barrier
 v_mfma_f32_16x16x32_bf16 v[56:59],a[152:155],v[152:155],v[56:59]
 buffer_store_dwordx4 v[232:235],v1,s[28:31],s60 offen sc1
 v_mfma_f32_16x16x32_bf16 v[56:59],a[156:159],v[156:159],v[56:59]
 ds_read_b128 a[64:67],v1 offset:32768
 v_mul_f32 v88,v88,v12
 v_mfma_f32_16x16x32_bf16 v[44:47],a[160:163],v[96:99],0
 ds_read_b128 a[68:71],v1 offset:33792
 v_mul_f32 v89,v89,v12
 v_mfma_f32_16x16x32_bf16 v[44:47],a[164:167],v[100:103],v[44:47]
 ds_read_b128 a[72:75],v1 offset:34816
 v_mul_f32 v90,v90,v12
 v_mfma_f32_16x16x32_bf16 v[44:47],a[168:171],v[104:107],v[44:47]
 ds_read_b128 a[76:79],v1 offset:35840
 v_mul_f32 v91,v91,v12
 v_mfma_f32_16x16x32_bf16 v[44:47],a[172:175],v[108:111],v[44:47]
 ds_read_b128 a[80:83],v1 offset:36864
 v_mul_f32 v92,v92,v12
 v_mfma_f32_16x16x32_bf16 v[60:63],a[160:163],v[128:131],0
 ds_read_b128 a[84:87],v1 offset:37888
 v_mul_f32 v93,v93,v12
 v_mfma_f32_16x16x32_bf16 v[60:63],a[164:167],v[132:135],v[60:63]
 ds_read_b128 a[88:91],v1 offset:38912
 v_mul_f32 v94,v94,v12
 v_mfma_f32_16x16x32_bf16 v[60:63],a[168:171],v[136:139],v[60:63]
 ds_read_b128 a[92:95],v1 offset:39936
 v_mul_f32 v95,v95,v12
 v_mfma_f32_16x16x32_bf16 v[60:63],a[172:175],v[140:143],v[60:63]
 ds_read_b128 a[96:99],v1 offset:40960
 v_cvt_pk_bf16_f32 v236,v88,v89
 v_mfma_f32_16x16x32_bf16 v[44:47],a[176:179],v[112:115],v[44:47]
 ds_read_b128 a[100:103],v1 offset:41984
 v_cvt_pk_bf16_f32 v237,v90,v91
 v_mfma_f32_16x16x32_bf16 v[44:47],a[180:183],v[116:119],v[44:47]
 v_cvt_pk_bf16_f32 v238,v92,v93
 v_cvt_pk_bf16_f32 v239,v94,v95
 v_mfma_f32_16x16x32_bf16 v[44:47],a[184:187],v[120:123],v[44:47]
 ds_read_b128 a[104:107],v1 offset:43008
 v_mfma_f32_16x16x32_bf16 v[44:47],a[188:191],v[124:127],v[44:47]
 buffer_store_dwordx4 v[236:239],v249,s[28:31],s60 offen sc1
 v_mfma_f32_16x16x32_bf16 v[60:63],a[176:179],v[144:147],v[60:63]
 ds_read_b128 a[108:111],v1 offset:44032
 v_mfma_f32_16x16x32_bf16 v[60:63],a[180:183],v[148:151],v[60:63]
 v_mfma_f32_16x16x32_bf16 v[60:63],a[184:187],v[152:155],v[60:63]
 ds_read_b128 a[112:115],v1 offset:45056
 v_mfma_f32_16x16x32_bf16 v[60:63],a[188:191],v[156:159],v[60:63]
 s_waitcnt lgkmcnt(5)
 v_mfma_f32_16x16x32_bf16 v[64:67],a[64:67],v[96:99],0
 ds_read_b128 a[116:119],v1 offset:46080
 v_mfma_f32_16x16x32_bf16 v[64:67],a[68:71],v[100:103],v[64:67]
 v_mfma_f32_16x16x32_bf16 v[64:67],a[72:75],v[104:107],v[64:67]
 ds_read_b128 a[120:123],v1 offset:47104
 v_mfma_f32_16x16x32_bf16 v[64:67],a[76:79],v[108:111],v[64:67]
 v_mfma_f32_16x16x32_bf16 v[80:83],a[64:67],v[128:131],0
 ds_read_b128 a[124:127],v1 offset:48128
 v_mul_f32 v32,v32,v10
 v_mfma_f32_16x16x32_bf16 v[80:83],a[68:71],v[132:135],v[80:83]
 v_mul_f32 v33,v33,v10
 v_mfma_f32_16x16x32_bf16 v[80:83],a[72:75],v[136:139],v[80:83]
 ds_read_b128 a[128:131],v1 offset:49152
 v_mul_f32 v34,v34,v10
 v_mfma_f32_16x16x32_bf16 v[80:83],a[76:79],v[140:143],v[80:83]
 v_mul_f32 v35,v35,v10
 v_mfma_f32_16x16x32_bf16 v[64:67],a[80:83],v[112:115],v[64:67]
 ds_read_b128 a[132:135],v1 offset:50176
 v_mul_f32 v36,v36,v10
 v_mfma_f32_16x16x32_bf16 v[64:67],a[84:87],v[116:119],v[64:67]
 v_mul_f32 v37,v37,v10
 v_mfma_f32_16x16x32_bf16 v[64:67],a[88:91],v[120:123],v[64:67]
 ds_read_b128 a[136:139],v1 offset:51200
 v_mul_f32 v38,v38,v10
 v_mfma_f32_16x16x32_bf16 v[64:67],a[92:95],v[124:127],v[64:67]
 v_mul_f32 v39,v39,v10
 v_mfma_f32_16x16x32_bf16 v[80:83],a[80:83],v[144:147],v[80:83]
 ds_read_b128 a[140:143],v1 offset:52224
 v_cvt_pk_bf16_f32 v224,v32,v33
 v_mfma_f32_16x16x32_bf16 v[80:83],a[84:87],v[148:151],v[80:83]
 v_cvt_pk_bf16_f32 v225,v34,v35
 v_mfma_f32_16x16x32_bf16 v[80:83],a[88:91],v[152:155],v[80:83]
 ds_read_b128 a[144:147],v1 offset:53248
 s_add_u32 s60,s37,131072
 v_mfma_f32_16x16x32_bf16 v[80:83],a[92:95],v[156:159],v[80:83]
 s_waitcnt lgkmcnt(5)
 v_cvt_pk_bf16_f32 v226,v36,v37
 v_mfma_f32_16x16x32_bf16 v[68:71],a[96:99],v[96:99],0
 ds_read_b128 a[148:151],v1 offset:54272
 v_cvt_pk_bf16_f32 v227,v38,v39
 v_mfma_f32_16x16x32_bf16 v[68:71],a[100:103],v[100:103],v[68:71]
 buffer_store_dwordx4 v[224:227],v1,s[28:31],s60 offen sc1
 v_mfma_f32_16x16x32_bf16 v[68:71],a[104:107],v[104:107],v[68:71]
 ds_read_b128 a[152:155],v1 offset:55296
 v_mul_f32 v48,v48,v12
 v_mfma_f32_16x16x32_bf16 v[68:71],a[108:111],v[108:111],v[68:71]
 v_mul_f32 v49,v49,v12
 v_mfma_f32_16x16x32_bf16 v[84:87],a[96:99],v[128:131],0
 ds_read_b128 a[156:159],v1 offset:56320
 v_mul_f32 v50,v50,v12
 v_mfma_f32_16x16x32_bf16 v[84:87],a[100:103],v[132:135],v[84:87]
 v_mul_f32 v51,v51,v12
 v_mfma_f32_16x16x32_bf16 v[84:87],a[104:107],v[136:139],v[84:87]
 ds_read_b128 a[160:163],v1 offset:57344
 v_mul_f32 v52,v52,v12
 v_mfma_f32_16x16x32_bf16 v[84:87],a[108:111],v[140:143],v[84:87]
 v_mul_f32 v53,v53,v12
 v_mfma_f32_16x16x32_bf16 v[68:71],a[112:115],v[112:115],v[68:71]
 ds_read_b128 a[164:167],v1 offset:58368
 v_mul_f32 v54,v54,v12
 v_mfma_f32_16x16x32_bf16 v[68:71],a[116:119],v[116:119],v[68:71]
 v_mul_f32 v55,v55,v12
 v_mfma_f32_16x16x32_bf16 v[68:71],a[120:123],v[120:123],v[68:71]
 ds_read_b128 a[168:171],v1 offset:59392
 v_cvt_pk_bf16_f32 v228,v48,v49
 v_mfma_f32_16x16x32_bf16 v[68:71],a[124:127],v[124:127],v[68:71]
 v_cvt_pk_bf16_f32 v229,v50,v51
 v_mfma_f32_16x16x32_bf16 v[84:87],a[112:115],v[144:147],v[84:87]
 ds_read_b128 a[172:175],v1 offset:60416
 v_cvt_pk_bf16_f32 v230,v52,v53
 v_mfma_f32_16x16x32_bf16 v[84:87],a[116:119],v[148:151],v[84:87]
 v_cvt_pk_bf16_f32 v231,v54,v55
 v_mfma_f32_16x16x32_bf16 v[84:87],a[120:123],v[152:155],v[84:87]
 ds_read_b128 a[176:179],v1 offset:61440
 v_mfma_f32_16x16x32_bf16 v[84:87],a[124:127],v[156:159],v[84:87]
 s_waitcnt lgkmcnt(5)
 v_mfma_f32_16x16x32_bf16 v[72:75],a[128:131],v[96:99],0
 buffer_store_dwordx4 v[228:231],v249,s[28:31],s60 offen sc1
 v_mfma_f32_16x16x32_bf16 v[72:75],a[132:135],v[100:103],v[72:75]
 ds_read_b128 a[180:183],v1 offset:62464
 v_mul_f32 v40,v40,v10
 v_mfma_f32_16x16x32_bf16 v[72:75],a[136:139],v[104:107],v[72:75]
 ds_read_b128 a[184:187],v1 offset:63488
 v_mul_f32 v41,v41,v10
 v_mfma_f32_16x16x32_bf16 v[72:75],a[140:143],v[108:111],v[72:75]
 v_mul_f32 v42,v42,v10
 v_mul_f32 v43,v43,v10
 v_mfma_f32_16x16x32_bf16 v[88:91],a[128:131],v[128:131],0
 ds_read_b128 a[188:191],v1 offset:64512
 v_mul_f32 v44,v44,v10
 v_mfma_f32_16x16x32_bf16 v[88:91],a[132:135],v[132:135],v[88:91]
 v_mul_f32 v45,v45,v10
 v_mfma_f32_16x16x32_bf16 v[88:91],a[136:139],v[136:139],v[88:91]
 v_mul_f32 v46,v46,v10
 v_mfma_f32_16x16x32_bf16 v[88:91],a[140:143],v[140:143],v[88:91]
 v_mul_f32 v47,v47,v10
 v_mfma_f32_16x16x32_bf16 v[72:75],a[144:147],v[112:115],v[72:75]
 v_cvt_pk_bf16_f32 v232,v40,v41
 v_mfma_f32_16x16x32_bf16 v[72:75],a[148:151],v[116:119],v[72:75]
 v_cvt_pk_bf16_f32 v233,v42,v43
 v_mfma_f32_16x16x32_bf16 v[72:75],a[152:155],v[120:123],v[72:75]
 s_add_u32 s60,s37,147456
 v_mfma_f32_16x16x32_bf16 v[72:75],a[156:159],v[124:127],v[72:75]
 v_cvt_pk_bf16_f32 v234,v44,v45
 v_mfma_f32_16x16x32_bf16 v[88:91],a[144:147],v[144:147],v[88:91]
 v_cvt_pk_bf16_f32 v235,v46,v47
 v_mfma_f32_16x16x32_bf16 v[88:91],a[148:151],v[148:151],v[88:91]
 s_waitcnt vmcnt(2) lgkmcnt(0)
 s_barrier
 v_mfma_f32_16x16x32_bf16 v[88:91],a[152:155],v[152:155],v[88:91]
 buffer_store_dwordx4 v[232:235],v1,s[28:31],s60 offen sc1
 v_mfma_f32_16x16x32_bf16 v[88:91],a[156:159],v[156:159],v[88:91]
 ds_read_b128 a[64:67],v2 offset:0
 v_mul_f32 v56,v56,v12
 v_mfma_f32_16x16x32_bf16 v[76:79],a[160:163],v[96:99],0
 ds_read_b128 a[68:71],v2 offset:1024
 v_mul_f32 v57,v57,v12
 v_mfma_f32_16x16x32_bf16 v[76:79],a[164:167],v[100:103],v[76:79]
 ds_read_b128 a[72:75],v2 offset:2048
 v_mul_f32 v58,v58,v12
 v_mfma_f32_16x16x32_bf16 v[76:79],a[168:171],v[104:107],v[76:79]
 ds_read_b128 a[76:79],v2 offset:3072
 v_mul_f32 v59,v59,v12
 v_mfma_f32_16x16x32_bf16 v[76:79],a[172:175],v[108:111],v[76:79]
 ds_read_b128 a[80:83],v2 offset:4096
 v_mul_f32 v60,v60,v12
 v_mfma_f32_16x16x32_bf16 v[92:95],a[160:163],v[128:131],0
 ds_read_b128 a[84:87],v2 offset:5120
 v_mul_f32 v61,v61,v12
 v_mfma_f32_16x16x32_bf16 v[92:95],a[164:167],v[132:135],v[92:95]
 ds_read_b128 a[88:91],v2 offset:6144
 v_mul_f32 v62,v62,v12
 v_mfma_f32_16x16x32_bf16 v[92:95],a[168:171],v[136:139],v[92:95]
 ds_read_b128 a[92:95],v2 offset:7168
 v_mul_f32 v63,v63,v12
 v_mfma_f32_16x16x32_bf16 v[92:95],a[172:175],v[140:143],v[92:95]
 ds_read_b128 a[96:99],v2 offset:8192
 v_cvt_pk_bf16_f32 v236,v56,v57
 v_mfma_f32_16x16x32_bf16 v[76:79],a[176:179],v[112:115],v[76:79]
 ds_read_b128 a[100:103],v2 offset:9216
 v_cvt_pk_bf16_f32 v237,v58,v59
 v_mfma_f32_16x16x32_bf16 v[76:79],a[180:183],v[116:119],v[76:79]
 v_cvt_pk_bf16_f32 v238,v60,v61
 v_cvt_pk_bf16_f32 v239,v62,v63
 v_mfma_f32_16x16x32_bf16 v[76:79],a[184:187],v[120:123],v[76:79]
 ds_read_b128 a[104:107],v2 offset:10240
 v_mfma_f32_16x16x32_bf16 v[76:79],a[188:191],v[124:127],v[76:79]
 buffer_store_dwordx4 v[236:239],v249,s[28:31],s60 offen sc1
 v_mfma_f32_16x16x32_bf16 v[92:95],a[176:179],v[144:147],v[92:95]
 ds_read_b128 a[108:111],v2 offset:11264
 v_mfma_f32_16x16x32_bf16 v[92:95],a[180:183],v[148:151],v[92:95]
 v_mfma_f32_16x16x32_bf16 v[92:95],a[184:187],v[152:155],v[92:95]
 ds_read_b128 a[112:115],v2 offset:12288
 v_mfma_f32_16x16x32_bf16 v[92:95],a[188:191],v[156:159],v[92:95]
 s_waitcnt lgkmcnt(5)
 s_cmp_eq_u32 s45,0
 s_cbranch_scc0 SIG_44
 s_add_u32 s61,s41,208
 s_lshl_b32 s61,s61,7
 s_add_u32 s61,s61,125829120
 v_mov_b32 v16,1
 v_mov_b32 v17,0
 s_mov_b64 exec,1
 buffer_atomic_add v16,v17,s[28:31],s61 offen sc1
 s_mov_b64 exec,-1
SIG_44:
 v_mfma_f32_16x16x32_bf16 v[32:35],a[64:67],v[96:99],0
 ds_read_b128 a[116:119],v2 offset:13312
 v_mfma_f32_16x16x32_bf16 v[32:35],a[68:71],v[100:103],v[32:35]
 v_mfma_f32_16x16x32_bf16 v[32:35],a[72:75],v[104:107],v[32:35]
 ds_read_b128 a[120:123],v2 offset:14336
 v_mfma_f32_16x16x32_bf16 v[32:35],a[76:79],v[108:111],v[32:35]
 v_mfma_f32_16x16x32_bf16 v[48:51],a[64:67],v[128:131],0
 ds_read_b128 a[124:127],v2 offset:15360
 v_mul_f32 v64,v64,v10
 v_mfma_f32_16x16x32_bf16 v[48:51],a[68:71],v[132:135],v[48:51]
 v_mul_f32 v65,v65,v10
 v_mfma_f32_16x16x32_bf16 v[48:51],a[72:75],v[136:139],v[48:51]
 ds_read_b128 a[128:131],v2 offset:16384
 v_mul_f32 v66,v66,v10
 v_mfma_f32_16x16x32_bf16 v[48:51],a[76:79],v[140:143],v[48:51]
 v_mul_f32 v67,v67,v10
 v_mfma_f32_16x16x32_bf16 v[32:35],a[80:83],v[112:115],v[32:35]
 ds_read_b128 a[132:135],v2 offset:17408
 v_mul_f32 v68,v68,v10
 v_mfma_f32_16x16x32_bf16 v[32:35],a[84:87],v[116:119],v[32:35]
 v_mul_f32 v69,v69,v10
 v_mfma_f32_16x16x32_bf16 v[32:35],a[88:91],v[120:123],v[32:35]
 ds_read_b128 a[136:139],v2 offset:18432
 v_mul_f32 v70,v70,v10
 v_mfma_f32_16x16x32_bf16 v[32:35],a[92:95],v[124:127],v[32:35]
 v_mul_f32 v71,v71,v10
 v_mfma_f32_16x16x32_bf16 v[48:51],a[80:83],v[144:147],v[48:51]
 ds_read_b128 a[140:143],v2 offset:19456
 v_cvt_pk_bf16_f32 v224,v64,v65
 v_mfma_f32_16x16x32_bf16 v[48:51],a[84:87],v[148:151],v[48:51]
 v_cvt_pk_bf16_f32 v225,v66,v67
 v_mfma_f32_16x16x32_bf16 v[48:51],a[88:91],v[152:155],v[48:51]
 ds_read_b128 a[144:147],v2 offset:20480
 s_add_u32 s60,s37,163840
 v_mfma_f32_16x16x32_bf16 v[48:51],a[92:95],v[156:159],v[48:51]
 s_waitcnt lgkmcnt(5)
 v_cvt_pk_bf16_f32 v226,v68,v69
 v_mfma_f32_16x16x32_bf16 v[36:39],a[96:99],v[96:99],0
 ds_read_b128 a[148:151],v2 offset:21504
 v_cvt_pk_bf16_f32 v227,v70,v71
 v_mfma_f32_16x16x32_bf16 v[36:39],a[100:103],v[100:103],v[36:39]
 buffer_store_dwordx4 v[224:227],v1,s[28:31],s60 offen sc1
 v_mfma_f32_16x16x32_bf16 v[36:39],a[104:107],v[104:107],v[36:39]
 ds_read_b128 a[152:155],v2 offset:22528
 v_mul_f32 v80,v80,v12
 v_mfma_f32_16x16x32_bf16 v[36:39],a[108:111],v[108:111],v[36:39]
 v_mul_f32 v81,v81,v12
 v_mfma_f32_16x16x32_bf16 v[52:55],a[96:99],v[128:131],0
 ds_read_b128 a[156:159],v2 offset:23552
 v_mul_f32 v82,v82,v12
 v_mfma_f32_16x16x32_bf16 v[52:55],a[100:103],v[132:135],v[52:55]
 v_mul_f32 v83,v83,v12
 v_mfma_f32_16x16x32_bf16 v[52:55],a[104:107],v[136:139],v[52:55]
 ds_read_b128 a[160:163],v2 offset:24576
 v_mul_f32 v84,v84,v12
 v_mfma_f32_16x16x32_bf16 v[52:55],a[108:111],v[140:143],v[52:55]
 v_mul_f32 v85,v85,v12
 v_mfma_f32_16x16x32_bf16 v[36:39],a[112:115],v[112:115],v[36:39]
 ds_read_b128 a[164:167],v2 offset:25600
 v_mul_f32 v86,v86,v12
 v_mfma_f32_16x16x32_bf16 v[36:39],a[116:119],v[116:119],v[36:39]
 v_mul_f32 v87,v87,v12
 v_mfma_f32_16x16x32_bf16 v[36:39],a[120:123],v[120:123],v[36:39]
 ds_read_b128 a[168:171],v2 offset:26624
 v_cvt_pk_bf16_f32 v228,v80,v81
 v_mfma_f32_16x16x32_bf16 v[36:39],a[124:127],v[124:127],v[36:39]
 v_cvt_pk_bf16_f32 v229,v82,v83
 v_mfma_f32_16x16x32_bf16 v[52:55],a[112:115],v[144:147],v[52:55]
 ds_read_b128 a[172:175],v2 offset:27648
 v_cvt_pk_bf16_f32 v230,v84,v85
 v_mfma_f32_16x16x32_bf16 v[52:55],a[116:119],v[148:151],v[52:55]
 v_cvt_pk_bf16_f32 v231,v86,v87
 v_mfma_f32_16x16x32_bf16 v[52:55],a[120:123],v[152:155],v[52:55]
 ds_read_b128 a[176:179],v2 offset:28672
 v_mfma_f32_16x16x32_bf16 v[52:55],a[124:127],v[156:159],v[52:55]
 s_waitcnt lgkmcnt(5)
 v_mfma_f32_16x16x32_bf16 v[40:43],a[128:131],v[96:99],0
 buffer_store_dwordx4 v[228:231],v249,s[28:31],s60 offen sc1
 v_mfma_f32_16x16x32_bf16 v[40:43],a[132:135],v[100:103],v[40:43]
 ds_read_b128 a[180:183],v2 offset:29696
 v_mul_f32 v72,v72,v10
 v_mfma_f32_16x16x32_bf16 v[40:43],a[136:139],v[104:107],v[40:43]
 ds_read_b128 a[184:187],v2 offset:30720
 v_mul_f32 v73,v73,v10
 v_mfma_f32_16x16x32_bf16 v[40:43],a[140:143],v[108:111],v[40:43]
 v_mul_f32 v74,v74,v10
 v_mul_f32 v75,v75,v10
 v_mfma_f32_16x16x32_bf16 v[56:59],a[128:131],v[128:131],0
 ds_read_b128 a[188:191],v2 offset:31744
 v_mul_f32 v76,v76,v10
 v_mfma_f32_16x16x32_bf16 v[56:59],a[132:135],v[132:135],v[56:59]
 v_mul_f32 v77,v77,v10
 v_mfma_f32_16x16x32_bf16 v[56:59],a[136:139],v[136:139],v[56:59]
 v_mul_f32 v78,v78,v10
 v_mfma_f32_16x16x32_bf16 v[56:59],a[140:143],v[140:143],v[56:59]
 v_mul_f32 v79,v79,v10
 v_mfma_f32_16x16x32_bf16 v[40:43],a[144:147],v[112:115],v[40:43]
 v_cvt_pk_bf16_f32 v232,v72,v73
 v_mfma_f32_16x16x32_bf16 v[40:43],a[148:151],v[116:119],v[40:43]
 v_cvt_pk_bf16_f32 v233,v74,v75
 v_mfma_f32_16x16x32_bf16 v[40:43],a[152:155],v[120:123],v[40:43]
 s_add_u32 s60,s37,180224
 v_mfma_f32_16x16x32_bf16 v[40:43],a[156:159],v[124:127],v[40:43]
 v_cvt_pk_bf16_f32 v234,v76,v77
 v_mfma_f32_16x16x32_bf16 v[56:59],a[144:147],v[144:147],v[56:59]
 v_cvt_pk_bf16_f32 v235,v78,v79
 v_mfma_f32_16x16x32_bf16 v[56:59],a[148:151],v[148:151],v[56:59]
 buffer_store_dwordx4 v[232:235],v1,s[28:31],s60 offen sc1
 v_mfma_f32_16x16x32_bf16 v[56:59],a[152:155],v[152:155],v[56:59]
 v_mul_f32 v88,v88,v12
 v_mfma_f32_16x16x32_bf16 v[56:59],a[156:159],v[156:159],v[56:59]
 s_waitcnt lgkmcnt(0)
 v_mul_f32 v89,v89,v12
 v_mfma_f32_16x16x32_bf16 v[44:47],a[160:163],v[96:99],0
 v_mul_f32 v90,v90,v12
 v_mfma_f32_16x16x32_bf16 v[44:47],a[164:167],v[100:103],v[44:47]
 v_mul_f32 v91,v91,v12
 v_mfma_f32_16x16x32_bf16 v[44:47],a[168:171],v[104:107],v[44:47]
 v_mul_f32 v92,v92,v12
 v_mfma_f32_16x16x32_bf16 v[44:47],a[172:175],v[108:111],v[44:47]
 v_mul_f32 v93,v93,v12
 v_mfma_f32_16x16x32_bf16 v[60:63],a[160:163],v[128:131],0
 v_mul_f32 v94,v94,v12
 v_mfma_f32_16x16x32_bf16 v[60:63],a[164:167],v[132:135],v[60:63]
 v_mul_f32 v95,v95,v12
 v_mfma_f32_16x16x32_bf16 v[60:63],a[168:171],v[136:139],v[60:63]
 v_cvt_pk_bf16_f32 v236,v88,v89
 v_mfma_f32_16x16x32_bf16 v[60:63],a[172:175],v[140:143],v[60:63]
 v_cvt_pk_bf16_f32 v237,v90,v91
 v_mfma_f32_16x16x32_bf16 v[44:47],a[176:179],v[112:115],v[44:47]
 v_cvt_pk_bf16_f32 v238,v92,v93
 v_mfma_f32_16x16x32_bf16 v[44:47],a[180:183],v[116:119],v[44:47]
 v_cvt_pk_bf16_f32 v239,v94,v95
 v_mfma_f32_16x16x32_bf16 v[44:47],a[184:187],v[120:123],v[44:47]
 buffer_store_dwordx4 v[236:239],v249,s[28:31],s60 offen sc1
 v_mfma_f32_16x16x32_bf16 v[44:47],a[188:191],v[124:127],v[44:47]
 v_mfma_f32_16x16x32_bf16 v[60:63],a[176:179],v[144:147],v[60:63]
 v_mfma_f32_16x16x32_bf16 v[60:63],a[180:183],v[148:151],v[60:63]
 v_mfma_f32_16x16x32_bf16 v[60:63],a[184:187],v[152:155],v[60:63]
 v_mfma_f32_16x16x32_bf16 v[60:63],a[188:191],v[156:159],v[60:63]
K2_PA:
 s_nop 5
 v_mul_f32 v32,v32,v10
 v_mul_f32 v33,v33,v10
 v_mul_f32 v34,v34,v10
 v_mul_f32 v35,v35,v10
 v_mul_f32 v36,v36,v10
 v_mul_f32 v37,v37,v10
 v_mul_f32 v38,v38,v10
 v_mul_f32 v39,v39,v10
 v_cvt_pk_bf16_f32 v224,v32,v33
 v_cvt_pk_bf16_f32 v225,v34,v35
 s_add_u32 s60,s37,196608
 v_cvt_pk_bf16_f32 v226,v36,v37
 v_cvt_pk_bf16_f32 v227,v38,v39
 buffer_store_dwordx4 v[224:227],v1,s[28:31],s60 offen sc1
 v_mul_f32 v48,v48,v12
 v_mul_f32 v49,v49,v12
 v_mul_f32 v50,v50,v12
 v_mul_f32 v51,v51,v12
 v_mul_f32 v52,v52,v12
 v_mul_f32 v53,v53,v12
 v_mul_f32 v54,v54,v12
 v_mul_f32 v55,v55,v12
 v_cvt_pk_bf16_f32 v228,v48,v49
 v_cvt_pk_bf16_f32 v229,v50,v51
 v_cvt_pk_bf16_f32 v230,v52,v53
 v_cvt_pk_bf16_f32 v231,v54,v55
 buffer_store_dwordx4 v[228:231],v249,s[28:31],s60 offen sc1
 v_mul_f32 v40,v40,v10
 v_mul_f32 v41,v41,v10
 v_mul_f32 v42,v42,v10
 v_mul_f32 v43,v43,v10
 v_mul_f32 v44,v44,v10
 v_mul_f32 v45,v45,v10
 v_mul_f32 v46,v46,v10
 v_mul_f32 v47,v47,v10
 v_cvt_pk_bf16_f32 v232,v40,v41
 v_cvt_pk_bf16_f32 v233,v42,v43
 s_add_u32 s60,s37,212992
 v_cvt_pk_bf16_f32 v234,v44,v45
 v_cvt_pk_bf16_f32 v235,v46,v47
 buffer_store_dwordx4 v[232:235],v1,s[28:31],s60 offen sc1
 v_mul_f32 v56,v56,v12
 v_mul_f32 v57,v57,v12
 v_mul_f32 v58,v58,v12
 v_mul_f32 v59,v59,v12
 v_mul_f32 v60,v60,v12
 v_mul_f32 v61,v61,v12
 v_mul_f32 v62,v62,v12
 v_mul_f32 v63,v63,v12
 v_cvt_pk_bf16_f32 v236,v56,v57
 v_cvt_pk_bf16_f32 v237,v58,v59
 v_cvt_pk_bf16_f32 v238,v60,v61
 v_cvt_pk_bf16_f32 v239,v62,v63
 buffer_store_dwordx4 v[236:239],v249,s[28:31],s60 offen sc1
 buffer_load_dword v20,v18,s[28:31],0 offen sc1
 s_waitcnt vmcnt(0) lgkmcnt(0)
 s_barrier
 s_cmp_eq_u32 s45,0
 s_cbranch_scc0 SIG_45
 s_add_u32 s60,s41,32
 s_lshl_b32 s60,s60,7
 s_add_u32 s60,s60,125829120
 v_mov_b32 v16,1
 v_mov_b32 v17,0
 s_mov_b64 exec,1
 buffer_atomic_add v16,v17,s[28:31],s60 offen sc1
 s_mov_b64 exec,-1
SIG_45:
FL_46:
 v_cmp_lt_u32 vcc,v20,v19
 s_nop 4
 s_cbranch_vccz FL_46D
 s_sleep 2
 buffer_load_dword v20,v18,s[28:31],0 offen sc1
 s_waitcnt vmcnt(0)
 s_branch FL_46
FL_46D:
 s_lshl_b32 s19,s22,2
 s_add_u32 s19,s19,s45
 s_mul_i32 s17,s16,14
 s_add_u32 s17,s17,s19
 s_lshl_b32 s17,s17,14
 s_add_u32 s17,s17,67108864
 s_mul_i32 s18,s16,28672
 s_lshl_b32 s19,s19,6
 s_add_u32 s18,s18,s19
 buffer_load_dwordx4 v[96:99],v1,s[28:31],s17 offen offset:0 sc1
 buffer_load_dwordx4 v[100:103],v1,s[28:31],s17 offen offset:1024 sc1
 buffer_load_dwordx4 v[104:107],v1,s[28:31],s17 offen offset:2048 sc1
 buffer_load_dwordx4 v[108:111],v1,s[28:31],s17 offen offset:3072 sc1
 s_add_u32 s17,s17,4096
 buffer_load_dwordx4 v[112:115],v1,s[28:31],s17 offen offset:0 sc1
 buffer_load_dwordx4 v[116:119],v1,s[28:31],s17 offen offset:1024 sc1
 buffer_load_dwordx4 v[120:123],v1,s[28:31],s17 offen offset:2048 sc1
 buffer_load_dwordx4 v[124:127],v1,s[28:31],s17 offen offset:3072 sc1
 s_add_u32 s17,s17,4096
 buffer_load_dwordx4 v[128:131],v1,s[28:31],s17 offen offset:0 sc1
 buffer_load_dwordx4 v[132:135],v1,s[28:31],s17 offen offset:1024 sc1
 buffer_load_dwordx4 v[136:139],v1,s[28:31],s17 offen offset:2048 sc1
 buffer_load_dwordx4 v[140:143],v1,s[28:31],s17 offen offset:3072 sc1
 s_add_u32 s17,s17,4096
 buffer_load_dwordx4 v[144:147],v1,s[28:31],s17 offen offset:0 sc1
 buffer_load_dwordx4 v[148:151],v1,s[28:31],s17 offen offset:1024 sc1
 buffer_load_dwordx4 v[152:155],v1,s[28:31],s17 offen offset:2048 sc1
 buffer_load_dwordx4 v[156:159],v1,s[28:31],s17 offen offset:3072 sc1
 s_add_u32 s17,s17,4096
K2_PEND:
 s_add_u32 s20,s59,32
 s_lshl_b32 s20,s20,7
 s_add_u32 s20,s20,125829120
 v_mov_b32 v18,s20
 v_mov_b32 v19,16
 buffer_load_dword v20,v18,s[28:31],0 offen sc1
 s_waitcnt vmcnt(16)
 v_lshlrev_b32 v32,16,v96
 v_and_b32 v33,0xffff0000,v96
 v_lshlrev_b32 v34,16,v97
 v_and_b32 v35,0xffff0000,v97
 v_lshlrev_b32 v36,16,v98
 v_and_b32 v37,0xffff0000,v98
 v_lshlrev_b32 v38,16,v99
 v_and_b32 v39,0xffff0000,v99
 s_waitcnt vmcnt(15)
 v_lshlrev_b32 v40,16,v100
 v_and_b32 v41,0xffff0000,v100
 v_pk_add_f32 v[32:33],v[32:33],v[40:41]
 v_lshlrev_b32 v42,16,v101
 v_and_b32 v43,0xffff0000,v101
 v_pk_add_f32 v[34:35],v[34:35],v[42:43]
 v_lshlrev_b32 v40,16,v102
 v_and_b32 v41,0xffff0000,v102
 v_pk_add_f32 v[36:37],v[36:37],v[40:41]
 v_lshlrev_b32 v42,16,v103
 v_and_b32 v43,0xffff0000,v103
 v_pk_add_f32 v[38:39],v[38:39],v[42:43]
 s_waitcnt vmcnt(14)
 v_lshlrev_b32 v40,16,v104
 v_and_b32 v41,0xffff0000,v104
 v_pk_add_f32 v[32:33],v[32:33],v[40:41]
 v_lshlrev_b32 v42,16,v105
 v_and_b32 v43,0xffff0000,v105
 v_pk_add_f32 v[34:35],v[34:35],v[42:43]
 v_lshlrev_b32 v40,16,v106
 v_and_b32 v41,0xffff0000,v106
 v_pk_add_f32 v[36:37],v[36:37],v[40:41]
 v_lshlrev_b32 v42,16,v107
 v_and_b32 v43,0xffff0000,v107
 v_pk_add_f32 v[38:39],v[38:39],v[42:43]
 s_waitcnt vmcnt(13)
 v_lshlrev_b32 v40,16,v108
 v_and_b32 v41,0xffff0000,v108
 v_pk_add_f32 v[32:33],v[32:33],v[40:41]
 v_lshlrev_b32 v42,16,v109
 v_and_b32 v43,0xffff0000,v109
 v_pk_add_f32 v[34:35],v[34:35],v[42:43]
 v_lshlrev_b32 v40,16,v110
 v_and_b32 v41,0xffff0000,v110
 v_pk_add_f32 v[36:37],v[36:37],v[40:41]
 v_lshlrev_b32 v42,16,v111
 v_and_b32 v43,0xffff0000,v111
 v_pk_add_f32 v[38:39],v[38:39],v[42:43]
 s_waitcnt vmcnt(12)
 v_lshlrev_b32 v40,16,v112
 v_and_b32 v41,0xffff0000,v112
 v_pk_add_f32 v[32:33],v[32:33],v[40:41]
 v_lshlrev_b32 v42,16,v113
 v_and_b32 v43,0xffff0000,v113
 v_pk_add_f32 v[34:35],v[34:35],v[42:43]
 v_lshlrev_b32 v40,16,v114
 v_and_b32 v41,0xffff0000,v114
 v_pk_add_f32 v[36:37],v[36:37],v[40:41]
 v_lshlrev_b32 v42,16,v115
 v_and_b32 v43,0xffff0000,v115
 v_pk_add_f32 v[38:39],v[38:39],v[42:43]
 s_waitcnt vmcnt(11)
 v_lshlrev_b32 v40,16,v116
 v_and_b32 v41,0xffff0000,v116
 v_pk_add_f32 v[32:33],v[32:33],v[40:41]
 v_lshlrev_b32 v42,16,v117
 v_and_b32 v43,0xffff0000,v117
 v_pk_add_f32 v[34:35],v[34:35],v[42:43]
 v_lshlrev_b32 v40,16,v118
 v_and_b32 v41,0xffff0000,v118
 v_pk_add_f32 v[36:37],v[36:37],v[40:41]
 v_lshlrev_b32 v42,16,v119
 v_and_b32 v43,0xffff0000,v119
 v_pk_add_f32 v[38:39],v[38:39],v[42:43]
 s_waitcnt vmcnt(10)
 v_lshlrev_b32 v40,16,v120
 v_and_b32 v41,0xffff0000,v120
 v_pk_add_f32 v[32:33],v[32:33],v[40:41]
 v_lshlrev_b32 v42,16,v121
 v_and_b32 v43,0xffff0000,v121
 v_pk_add_f32 v[34:35],v[34:35],v[42:43]
 v_lshlrev_b32 v40,16,v122
 v_and_b32 v41,0xffff0000,v122
 v_pk_add_f32 v[36:37],v[36:37],v[40:41]
 v_lshlrev_b32 v42,16,v123
 v_and_b32 v43,0xffff0000,v123
 v_pk_add_f32 v[38:39],v[38:39],v[42:43]
 s_waitcnt vmcnt(9)
 v_lshlrev_b32 v40,16,v124
 v_and_b32 v41,0xffff0000,v124
 v_pk_add_f32 v[32:33],v[32:33],v[40:41]
 v_lshlrev_b32 v42,16,v125
 v_and_b32 v43,0xffff0000,v125
 v_pk_add_f32 v[34:35],v[34:35],v[42:43]
 v_lshlrev_b32 v40,16,v126
 v_and_b32 v41,0xffff0000,v126
 v_pk_add_f32 v[36:37],v[36:37],v[40:41]
 v_lshlrev_b32 v42,16,v127
 v_and_b32 v43,0xffff0000,v127
 v_pk_add_f32 v[38:39],v[38:39],v[42:43]
 s_waitcnt vmcnt(8)
 v_lshlrev_b32 v40,16,v128
 v_and_b32 v41,0xffff0000,v128
 v_pk_add_f32 v[32:33],v[32:33],v[40:41]
 v_lshlrev_b32 v42,16,v129
 v_and_b32 v43,0xffff0000,v129
 v_pk_add_f32 v[34:35],v[34:35],v[42:43]
 v_lshlrev_b32 v40,16,v130
 v_and_b32 v41,0xffff0000,v130
 v_pk_add_f32 v[36:37],v[36:37],v[40:41]
 v_lshlrev_b32 v42,16,v131
 v_and_b32 v43,0xffff0000,v131
 v_pk_add_f32 v[38:39],v[38:39],v[42:43]
 s_waitcnt vmcnt(7)
 v_lshlrev_b32 v40,16,v132
 v_and_b32 v41,0xffff0000,v132
 v_pk_add_f32 v[32:33],v[32:33],v[40:41]
 v_lshlrev_b32 v42,16,v133
 v_and_b32 v43,0xffff0000,v133
 v_pk_add_f32 v[34:35],v[34:35],v[42:43]
 v_lshlrev_b32 v40,16,v134
 v_and_b32 v41,0xffff0000,v134
 v_pk_add_f32 v[36:37],v[36:37],v[40:41]
 v_lshlrev_b32 v42,16,v135
 v_and_b32 v43,0xffff0000,v135
 v_pk_add_f32 v[38:39],v[38:39],v[42:43]
 s_waitcnt vmcnt(6)
 v_lshlrev_b32 v40,16,v136
 v_and_b32 v41,0xffff0000,v136
 v_pk_add_f32 v[32:33],v[32:33],v[40:41]
 v_lshlrev_b32 v42,16,v137
 v_and_b32 v43,0xffff0000,v137
 v_pk_add_f32 v[34:35],v[34:35],v[42:43]
 v_lshlrev_b32 v40,16,v138
 v_and_b32 v41,0xffff0000,v138
 v_pk_add_f32 v[36:37],v[36:37],v[40:41]
 v_lshlrev_b32 v42,16,v139
 v_and_b32 v43,0xffff0000,v139
 v_pk_add_f32 v[38:39],v[38:39],v[42:43]
 s_waitcnt vmcnt(5)
 v_lshlrev_b32 v40,16,v140
 v_and_b32 v41,0xffff0000,v140
 v_pk_add_f32 v[32:33],v[32:33],v[40:41]
 v_lshlrev_b32 v42,16,v141
 v_and_b32 v43,0xffff0000,v141
 v_pk_add_f32 v[34:35],v[34:35],v[42:43]
 v_lshlrev_b32 v40,16,v142
 v_and_b32 v41,0xffff0000,v142
 v_pk_add_f32 v[36:37],v[36:37],v[40:41]
 v_lshlrev_b32 v42,16,v143
 v_and_b32 v43,0xffff0000,v143
 v_pk_add_f32 v[38:39],v[38:39],v[42:43]
 s_waitcnt vmcnt(4)
 v_lshlrev_b32 v40,16,v144
 v_and_b32 v41,0xffff0000,v144
 v_pk_add_f32 v[32:33],v[32:33],v[40:41]
 v_lshlrev_b32 v42,16,v145
 v_and_b32 v43,0xffff0000,v145
 v_pk_add_f32 v[34:35],v[34:35],v[42:43]
 v_lshlrev_b32 v40,16,v146
 v_and_b32 v41,0xffff0000,v146
 v_pk_add_f32 v[36:37],v[36:37],v[40:41]
 v_lshlrev_b32 v42,16,v147
 v_and_b32 v43,0xffff0000,v147
 v_pk_add_f32 v[38:39],v[38:39],v[42:43]
 s_waitcnt vmcnt(3)
 v_lshlrev_b32 v40,16,v148
 v_and_b32 v41,0xffff0000,v148
 v_pk_add_f32 v[32:33],v[32:33],v[40:41]
 v_lshlrev_b32 v42,16,v149
 v_and_b32 v43,0xffff0000,v149
 v_pk_add_f32 v[34:35],v[34:35],v[42:43]
 v_lshlrev_b32 v40,16,v150
 v_and_b32 v41,0xffff0000,v150
 v_pk_add_f32 v[36:37],v[36:37],v[40:41]
 v_lshlrev_b32 v42,16,v151
 v_and_b32 v43,0xffff0000,v151
 v_pk_add_f32 v[38:39],v[38:39],v[42:43]
 s_waitcnt vmcnt(2)
 v_lshlrev_b32 v40,16,v152
 v_and_b32 v41,0xffff0000,v152
 v_pk_add_f32 v[32:33],v[32:33],v[40:41]
 v_lshlrev_b32 v42,16,v153
 v_and_b32 v43,0xffff0000,v153
 v_pk_add_f32 v[34:35],v[34:35],v[42:43]
 v_lshlrev_b32 v40,16,v154
 v_and_b32 v41,0xffff0000,v154
 v_pk_add_f32 v[36:37],v[36:37],v[40:41]
 v_lshlrev_b32 v42,16,v155
 v_and_b32 v43,0xffff0000,v155
 v_pk_add_f32 v[38:39],v[38:39],v[42:43]
 s_waitcnt vmcnt(1)
 v_lshlrev_b32 v40,16,v156
 v_and_b32 v41,0xffff0000,v156
 v_pk_add_f32 v[32:33],v[32:33],v[40:41]
 v_lshlrev_b32 v42,16,v157
 v_and_b32 v43,0xffff0000,v157
 v_pk_add_f32 v[34:35],v[34:35],v[42:43]
 v_lshlrev_b32 v40,16,v158
 v_and_b32 v41,0xffff0000,v158
 v_pk_add_f32 v[36:37],v[36:37],v[40:41]
 v_lshlrev_b32 v42,16,v159
 v_and_b32 v43,0xffff0000,v159
 v_pk_add_f32 v[38:39],v[38:39],v[42:43]
 v_cvt_pk_bf16_f32 v44,v32,v33
 v_cvt_pk_bf16_f32 v45,v34,v35
 v_cvt_pk_bf16_f32 v46,v36,v37
 v_cvt_pk_bf16_f32 v47,v38,v39
 s_cmp_eq_u32 s45,3
 s_cbranch_scc1 K3_W3
 s_waitcnt vmcnt(0)
FL_47:
 v_cmp_lt_u32 vcc,v20,v19
 s_nop 4
 s_cbranch_vccz FL_47D
 s_sleep 2
 buffer_load_dword v20,v18,s[28:31],0 offen sc1
 s_waitcnt vmcnt(0)
 s_branch FL_47
FL_47D:
 s_mul_i32 s19,s22,3
 s_add_u32 s19,s19,8
 s_add_u32 s19,s19,s45
 s_mul_i32 s17,s16,14
 s_add_u32 s17,s17,s19
 s_lshl_b32 s17,s17,14
 s_add_u32 s17,s17,67108864
 s_mul_i32 s23,s16,28672
 s_lshl_b32 s19,s19,6
 s_add_u32 s23,s23,s19
 buffer_load_dwordx4 v[160:163],v1,s[28:31],s17 offen offset:0 sc1
 buffer_load_dwordx4 v[164:167],v1,s[28:31],s17 offen offset:1024 sc1
 buffer_load_dwordx4 v[168:171],v1,s[28:31],s17 offen offset:2048 sc1
 buffer_load_dwordx4 v[172:175],v1,s[28:31],s17 offen offset:3072 sc1
 s_add_u32 s17,s17,4096
 buffer_load_dwordx4 v[176:179],v1,s[28:31],s17 offen offset:0 sc1
 buffer_load_dwordx4 v[180:183],v1,s[28:31],s17 offen offset:1024 sc1
 buffer_load_dwordx4 v[184:187],v1,s[28:31],s17 offen offset:2048 sc1
 buffer_load_dwordx4 v[188:191],v1,s[28:31],s17 offen offset:3072 sc1
 s_add_u32 s17,s17,4096
 buffer_load_dwordx4 v[192:195],v1,s[28:31],s17 offen offset:0 sc1
 buffer_load_dwordx4 v[196:199],v1,s[28:31],s17 offen offset:1024 sc1
 buffer_load_dwordx4 v[200:203],v1,s[28:31],s17 offen offset:2048 sc1
 buffer_load_dwordx4 v[204:207],v1,s[28:31],s17 offen offset:3072 sc1
 s_add_u32 s17,s17,4096
 buffer_load_dwordx4 v[208:211],v1,s[28:31],s17 offen offset:0 sc1
 buffer_load_dwordx4 v[212:215],v1,s[28:31],s17 offen offset:1024 sc1
 buffer_load_dwordx4 v[216:219],v1,s[28:31],s17 offen offset:2048 sc1
 buffer_load_dwordx4 v[220:223],v1,s[28:31],s17 offen offset:3072 sc1
 s_add_u32 s17,s17,4096
K3_RB:
 s_waitcnt vmcnt(15)
 v_lshlrev_b32 v48,16,v160
 v_and_b32 v49,0xffff0000,v160
 v_lshlrev_b32 v50,16,v161
 v_and_b32 v51,0xffff0000,v161
 v_lshlrev_b32 v52,16,v162
 v_and_b32 v53,0xffff0000,v162
 v_lshlrev_b32 v54,16,v163
 v_and_b32 v55,0xffff0000,v163
 s_waitcnt vmcnt(14)
 v_lshlrev_b32 v56,16,v164
 v_and_b32 v57,0xffff0000,v164
 v_pk_add_f32 v[48:49],v[48:49],v[56:57]
 v_lshlrev_b32 v58,16,v165
 v_and_b32 v59,0xffff0000,v165
 v_pk_add_f32 v[50:51],v[50:51],v[58:59]
 v_lshlrev_b32 v56,16,v166
 v_and_b32 v57,0xffff0000,v166
 v_pk_add_f32 v[52:53],v[52:53],v[56:57]
 v_lshlrev_b32 v58,16,v167
 v_and_b32 v59,0xffff0000,v167
 v_pk_add_f32 v[54:55],v[54:55],v[58:59]
 s_waitcnt vmcnt(13)
 v_lshlrev_b32 v56,16,v168
 v_and_b32 v57,0xffff0000,v168
 v_pk_add_f32 v[48:49],v[48:49],v[56:57]
 v_lshlrev_b32 v58,16,v169
 v_and_b32 v59,0xffff0000,v169
 v_pk_add_f32 v[50:51],v[50:51],v[58:59]
 v_lshlrev_b32 v56,16,v170
 v_and_b32 v57,0xffff0000,v170
 v_pk_add_f32 v[52:53],v[52:53],v[56:57]
 v_lshlrev_b32 v58,16,v171
 v_and_b32 v59,0xffff0000,v171
 v_pk_add_f32 v[54:55],v[54:55],v[58:59]
 s_waitcnt vmcnt(12)
 v_lshlrev_b32 v56,16,v172
 v_and_b32 v57,0xffff0000,v172
 v_pk_add_f32 v[48:49],v[48:49],v[56:57]
 v_lshlrev_b32 v58,16,v173
 v_and_b32 v59,0xffff0000,v173
 v_pk_add_f32 v[50:51],v[50:51],v[58:59]
 v_lshlrev_b32 v56,16,v174
 v_and_b32 v57,0xffff0000,v174
 v_pk_add_f32 v[52:53],v[52:53],v[56:57]
 v_lshlrev_b32 v58,16,v175
 v_and_b32 v59,0xffff0000,v175
 v_pk_add_f32 v[54:55],v[54:55],v[58:59]
 s_waitcnt vmcnt(11)
 v_lshlrev_b32 v56,16,v176
 v_and_b32 v57,0xffff0000,v176
 v_pk_add_f32 v[48:49],v[48:49],v[56:57]
 v_lshlrev_b32 v58,16,v177
 v_and_b32 v59,0xffff0000,v177
 v_pk_add_f32 v[50:51],v[50:51],v[58:59]
 v_lshlrev_b32 v56,16,v178
 v_and_b32 v57,0xffff0000,v178
 v_pk_add_f32 v[52:53],v[52:53],v[56:57]
 v_lshlrev_b32 v58,16,v179
 v_and_b32 v59,0xffff0000,v179
 v_pk_add_f32 v[54:55],v[54:55],v[58:59]
 s_waitcnt vmcnt(10)
 v_lshlrev_b32 v56,16,v180
 v_and_b32 v57,0xffff0000,v180
 v_pk_add_f32 v[48:49],v[48:49],v[56:57]
 v_lshlrev_b32 v58,16,v181
 v_and_b32 v59,0xffff0000,v181
 v_pk_add_f32 v[50:51],v[50:51],v[58:59]
 v_lshlrev_b32 v56,16,v182
 v_and_b32 v57,0xffff0000,v182
 v_pk_add_f32 v[52:53],v[52:53],v[56:57]
 v_lshlrev_b32 v58,16,v183
 v_and_b32 v59,0xffff0000,v183
 v_pk_add_f32 v[54:55],v[54:55],v[58:59]
 s_waitcnt vmcnt(9)
 v_lshlrev_b32 v56,16,v184
 v_and_b32 v57,0xffff0000,v184
 v_pk_add_f32 v[48:49],v[48:49],v[56:57]
 v_lshlrev_b32 v58,16,v185
 v_and_b32 v59,0xffff0000,v185
 v_pk_add_f32 v[50:51],v[50:51],v[58:59]
 v_lshlrev_b32 v56,16,v186
 v_and_b32 v57,0xffff0000,v186
 v_pk_add_f32 v[52:53],v[52:53],v[56:57]
 v_lshlrev_b32 v58,16,v187
 v_and_b32 v59,0xffff0000,v187
 v_pk_add_f32 v[54:55],v[54:55],v[58:59]
 s_waitcnt vmcnt(8)
 v_lshlrev_b32 v56,16,v188
 v_and_b32 v57,0xffff0000,v188
 v_pk_add_f32 v[48:49],v[48:49],v[56:57]
 v_lshlrev_b32 v58,16,v189
 v_and_b32 v59,0xffff0000,v189
 v_pk_add_f32 v[50:51],v[50:51],v[58:59]
 v_lshlrev_b32 v56,16,v190
 v_and_b32 v57,0xffff0000,v190
 v_pk_add_f32 v[52:53],v[52:53],v[56:57]
 v_lshlrev_b32 v58,16,v191
 v_and_b32 v59,0xffff0000,v191
 v_pk_add_f32 v[54:55],v[54:55],v[58:59]
 s_waitcnt vmcnt(7)
 v_lshlrev_b32 v56,16,v192
 v_and_b32 v57,0xffff0000,v192
 v_pk_add_f32 v[48:49],v[48:49],v[56:57]
 v_lshlrev_b32 v58,16,v193
 v_and_b32 v59,0xffff0000,v193
 v_pk_add_f32 v[50:51],v[50:51],v[58:59]
 v_lshlrev_b32 v56,16,v194
 v_and_b32 v57,0xffff0000,v194
 v_pk_add_f32 v[52:53],v[52:53],v[56:57]
 v_lshlrev_b32 v58,16,v195
 v_and_b32 v59,0xffff0000,v195
 v_pk_add_f32 v[54:55],v[54:55],v[58:59]
 s_waitcnt vmcnt(6)
 v_lshlrev_b32 v56,16,v196
 v_and_b32 v57,0xffff0000,v196
 v_pk_add_f32 v[48:49],v[48:49],v[56:57]
 v_lshlrev_b32 v58,16,v197
 v_and_b32 v59,0xffff0000,v197
 v_pk_add_f32 v[50:51],v[50:51],v[58:59]
 v_lshlrev_b32 v56,16,v198
 v_and_b32 v57,0xffff0000,v198
 v_pk_add_f32 v[52:53],v[52:53],v[56:57]
 v_lshlrev_b32 v58,16,v199
 v_and_b32 v59,0xffff0000,v199
 v_pk_add_f32 v[54:55],v[54:55],v[58:59]
 s_waitcnt vmcnt(5)
 v_lshlrev_b32 v56,16,v200
 v_and_b32 v57,0xffff0000,v200
 v_pk_add_f32 v[48:49],v[48:49],v[56:57]
 v_lshlrev_b32 v58,16,v201
 v_and_b32 v59,0xffff0000,v201
 v_pk_add_f32 v[50:51],v[50:51],v[58:59]
 v_lshlrev_b32 v56,16,v202
 v_and_b32 v57,0xffff0000,v202
 v_pk_add_f32 v[52:53],v[52:53],v[56:57]
 v_lshlrev_b32 v58,16,v203
 v_and_b32 v59,0xffff0000,v203
 v_pk_add_f32 v[54:55],v[54:55],v[58:59]
 s_waitcnt vmcnt(4)
 v_lshlrev_b32 v56,16,v204
 v_and_b32 v57,0xffff0000,v204
 v_pk_add_f32 v[48:49],v[48:49],v[56:57]
 v_lshlrev_b32 v58,16,v205
 v_and_b32 v59,0xffff0000,v205
 v_pk_add_f32 v[50:51],v[50:51],v[58:59]
 v_lshlrev_b32 v56,16,v206
 v_and_b32 v57,0xffff0000,v206
 v_pk_add_f32 v[52:53],v[52:53],v[56:57]
 v_lshlrev_b32 v58,16,v207
 v_and_b32 v59,0xffff0000,v207
 v_pk_add_f32 v[54:55],v[54:55],v[58:59]
 s_waitcnt vmcnt(3)
 v_lshlrev_b32 v56,16,v208
 v_and_b32 v57,0xffff0000,v208
 v_pk_add_f32 v[48:49],v[48:49],v[56:57]
 v_lshlrev_b32 v58,16,v209
 v_and_b32 v59,0xffff0000,v209
 v_pk_add_f32 v[50:51],v[50:51],v[58:59]
 v_lshlrev_b32 v56,16,v210
 v_and_b32 v57,0xffff0000,v210
 v_pk_add_f32 v[52:53],v[52:53],v[56:57]
 v_lshlrev_b32 v58,16,v211
 v_and_b32 v59,0xffff0000,v211
 v_pk_add_f32 v[54:55],v[54:55],v[58:59]
 s_waitcnt vmcnt(2)
 v_lshlrev_b32 v56,16,v212
 v_and_b32 v57,0xffff0000,v212
 v_pk_add_f32 v[48:49],v[48:49],v[56:57]
 v_lshlrev_b32 v58,16,v213
 v_and_b32 v59,0xffff0000,v213
 v_pk_add_f32 v[50:51],v[50:51],v[58:59]
 v_lshlrev_b32 v56,16,v214
 v_and_b32 v57,0xffff0000,v214
 v_pk_add_f32 v[52:53],v[52:53],v[56:57]
 v_lshlrev_b32 v58,16,v215
 v_and_b32 v59,0xffff0000,v215
 v_pk_add_f32 v[54:55],v[54:55],v[58:59]
 s_waitcnt vmcnt(1)
 v_lshlrev_b32 v56,16,v216
 v_and_b32 v57,0xffff0000,v216
 v_pk_add_f32 v[48:49],v[48:49],v[56:57]
 v_lshlrev_b32 v58,16,v217
 v_and_b32 v59,0xffff0000,v217
 v_pk_add_f32 v[50:51],v[50:51],v[58:59]
 v_lshlrev_b32 v56,16,v218
 v_and_b32 v57,0xffff0000,v218
 v_pk_add_f32 v[52:53],v[52:53],v[56:57]
 v_lshlrev_b32 v58,16,v219
 v_and_b32 v59,0xffff0000,v219
 v_pk_add_f32 v[54:55],v[54:55],v[58:59]
 s_waitcnt vmcnt(0)
 v_lshlrev_b32 v56,16,v220
 v_and_b32 v57,0xffff0000,v220
 v_pk_add_f32 v[48:49],v[48:49],v[56:57]
 v_lshlrev_b32 v58,16,v221
 v_and_b32 v59,0xffff0000,v221
 v_pk_add_f32 v[50:51],v[50:51],v[58:59]
 v_lshlrev_b32 v56,16,v222
 v_and_b32 v57,0xffff0000,v222
 v_pk_add_f32 v[52:53],v[52:53],v[56:57]
 v_lshlrev_b32 v58,16,v223
 v_and_b32 v59,0xffff0000,v223
 v_pk_add_f32 v[54:55],v[54:55],v[58:59]
 v_cvt_pk_bf16_f32 v60,v48,v49
 v_cvt_pk_bf16_f32 v61,v50,v51
 v_cvt_pk_bf16_f32 v62,v52,v53
 v_cvt_pk_bf16_f32 v63,v54,v55
 buffer_store_dwordx4 v[60:63],v248,s[12:15],s23 offen offset:896 sc1
K3_W3:
 buffer_store_dwordx4 v[44:47],v248,s[12:15],s18 offen offset:896 sc1
K3_END:
 s_endpgm
FLE_5:
FL_48:
 v_cmp_lt_u32 vcc,v31,v30
 s_nop 4
 s_cbranch_vccz FL_48D
 s_sleep 2
 buffer_load_dword v31,v29,s[28:31],0 offen sc1
 s_waitcnt vmcnt(0)
 s_branch FL_48
FL_48D:
 s_branch FLE_5R
FLE_15:
FL_49:
 v_cmp_lt_u32 vcc,v31,v30
 s_nop 4
 s_cbranch_vccz FL_49D
 s_sleep 2
 buffer_load_dword v31,v29,s[28:31],0 offen sc1
 s_waitcnt vmcnt(0)
 s_branch FL_49
FL_49D:
 s_branch FLE_15R
K2_CRS:
 v_max_f32 v16,0,v11
 v_exp_f32 v17,-v16
 v_sub_f32 v11,v11,v16
 v_mul_f32 v6,v6,v17
 v_mul_f32 v96,v96,v17
 v_mul_f32 v97,v97,v17
 v_mul_f32 v98,v98,v17
 v_mul_f32 v99,v99,v17
 v_mul_f32 v100,v100,v17
 v_mul_f32 v101,v101,v17
 v_mul_f32 v102,v102,v17
 v_mul_f32 v103,v103,v17
 v_mul_f32 v104,v104,v17
 v_mul_f32 v105,v105,v17
 v_mul_f32 v106,v106,v17
 v_mul_f32 v107,v107,v17
 v_mul_f32 v108,v108,v17
 v_mul_f32 v109,v109,v17
 v_mul_f32 v110,v110,v17
 v_mul_f32 v111,v111,v17
 v_mul_f32 v112,v112,v17
 v_mul_f32 v113,v113,v17
 v_mul_f32 v114,v114,v17
 v_mul_f32 v115,v115,v17
 v_mul_f32 v116,v116,v17
 v_mul_f32 v117,v117,v17
 v_mul_f32 v118,v118,v17
 v_mul_f32 v119,v119,v17
 v_mul_f32 v120,v120,v17
 v_mul_f32 v121,v121,v17
 v_mul_f32 v122,v122,v17
 v_mul_f32 v123,v123,v17
 v_mul_f32 v124,v124,v17
 v_mul_f32 v125,v125,v17
 v_mul_f32 v126,v126,v17
 v_mul_f32 v127,v127,v17
 v_mul_f32 v128,v128,v17
 v_mul_f32 v129,v129,v17
 v_mul_f32 v130,v130,v17
 v_mul_f32 v131,v131,v17
 v_mul_f32 v132,v132,v17
 v_mul_f32 v133,v133,v17
 v_mul_f32 v134,v134,v17
 v_mul_f32 v135,v135,v17
 v_mul_f32 v136,v136,v17
 v_mul_f32 v137,v137,v17
 v_mul_f32 v138,v138,v17
 v_mul_f32 v139,v139,v17
 v_mul_f32 v140,v140,v17
 v_mul_f32 v141,v141,v17
 v_mul_f32 v142,v142,v17
 v_mul_f32 v143,v143,v17
 v_mul_f32 v144,v144,v17
 v_mul_f32 v145,v145,v17
 v_mul_f32 v146,v146,v17
 v_mul_f32 v147,v147,v17
 v_mul_f32 v148,v148,v17
 v_mul_f32 v149,v149,v17
 v_mul_f32 v150,v150,v17
 v_mul_f32 v151,v151,v17
 v_mul_f32 v152,v152,v17
 v_mul_f32 v153,v153,v17
 v_mul_f32 v154,v154,v17
 v_mul_f32 v155,v155,v17
 v_mul_f32 v156,v156,v17
 v_mul_f32 v157,v157,v17
 v_mul_f32 v158,v158,v17
 v_mul_f32 v159,v159,v17
 v_max_f32 v16,0,v13
 v_exp_f32 v17,-v16
 v_sub_f32 v13,v13,v16
 v_mul_f32 v7,v7,v17
 v_mul_f32 v160,v160,v17
 v_mul_f32 v161,v161,v17
 v_mul_f32 v162,v162,v17
 v_mul_f32 v163,v163,v17
 v_mul_f32 v164,v164,v17
 v_mul_f32 v165,v165,v17
 v_mul_f32 v166,v166,v17
 v_mul_f32 v167,v167,v17
 v_mul_f32 v168,v168,v17
 v_mul_f32 v169,v169,v17
 v_mul_f32 v170,v170,v17
 v_mul_f32 v171,v171,v17
 v_mul_f32 v172,v172,v17
 v_mul_f32 v173,v173,v17
 v_mul_f32 v174,v174,v17
 v_mul_f32 v175,v175,v17
 v_mul_f32 v176,v176,v17
 v_mul_f32 v177,v177,v17
 v_mul_f32 v178,v178,v17
 v_mul_f32 v179,v179,v17
 v_mul_f32 v180,v180,v17
 v_mul_f32 v181,v181,v17
 v_mul_f32 v182,v182,v17
 v_mul_f32 v183,v183,v17
 v_mul_f32 v184,v184,v17
 v_mul_f32 v185,v185,v17
 v_mul_f32 v186,v186,v17
 v_mul_f32 v187,v187,v17
 v_mul_f32 v188,v188,v17
 v_mul_f32 v189,v189,v17
 v_mul_f32 v190,v190,v17
 v_mul_f32 v191,v191,v17
 v_mul_f32 v192,v192,v17
 v_mul_f32 v193,v193,v17
 v_mul_f32 v194,v194,v17
 v_mul_f32 v195,v195,v17
 v_mul_f32 v196,v196,v17
 v_mul_f32 v197,v197,v17
 v_mul_f32 v198,v198,v17
 v_mul_f32 v199,v199,v17
 v_mul_f32 v200,v200,v17
 v_mul_f32 v201,v201,v17
 v_mul_f32 v202,v202,v17
 v_mul_f32 v203,v203,v17
 v_mul_f32 v204,v204,v17
 v_mul_f32 v205,v205,v17
 v_mul_f32 v206,v206,v17
 v_mul_f32 v207,v207,v17
 v_mul_f32 v208,v208,v17
 v_mul_f32 v209,v209,v17
 v_mul_f32 v210,v210,v17
 v_mul_f32 v211,v211,v17
 v_mul_f32 v212,v212,v17
 v_mul_f32 v213,v213,v17
 v_mul_f32 v214,v214,v17
 v_mul_f32 v215,v215,v17
 v_mul_f32 v216,v216,v17
 v_mul_f32 v217,v217,v17
 v_mul_f32 v218,v218,v17
 v_mul_f32 v219,v219,v17
 v_mul_f32 v220,v220,v17
 v_mul_f32 v221,v221,v17
 v_mul_f32 v222,v222,v17
 v_mul_f32 v223,v223,v17
 s_branch K2_CRSR
FF_37:
FL_50:
 v_cmp_lt_u32 vcc,v242,v241
 s_nop 4
 s_cbranch_vccz FL_50D
 s_sleep 2
 buffer_load_dword v242,v240,s[28:31],0 offen sc1
 s_waitcnt vmcnt(0)
 s_branch FL_50
FL_50D:
 s_branch FF_37R
FR_38:
 v_mov_b32 v17,v9
 s_nop 1
 v_permlane16_swap_b32 v17,v9
 s_nop 1
 v_max_f32 v9,v9,v17
 v_mov_b32 v17,v9
 s_nop 1
 v_permlane32_swap_b32 v17,v9
 s_nop 1
 v_max_f32 v9,v9,v17
 v_max_f32 v9,0,v9
 v_exp_f32 v12,-v9
 v_sub_f32 v80,v80,v9
 v_sub_f32 v81,v81,v9
 v_sub_f32 v82,v82,v9
 v_sub_f32 v83,v83,v9
 v_sub_f32 v84,v84,v9
 v_sub_f32 v85,v85,v9
 v_sub_f32 v86,v86,v9
 v_sub_f32 v87,v87,v9
 v_sub_f32 v88,v88,v9
 v_sub_f32 v89,v89,v9
 v_sub_f32 v90,v90,v9
 v_sub_f32 v91,v91,v9
 v_sub_f32 v92,v92,v9
 v_sub_f32 v93,v93,v9
 v_sub_f32 v94,v94,v9
 v_sub_f32 v95,v95,v9
 v_sub_f32 v28,v28,v9
 v_sub_f32 v29,v29,v9
 v_sub_f32 v30,v30,v9
 v_sub_f32 v31,v31,v9
 v_mul_f32 v7,v7,v12
 s_branch FR_38R
FO_39:
 s_nop 7
 v_mul_f32 v160,v160,v12
 v_mul_f32 v161,v161,v12
 v_mul_f32 v162,v162,v12
 v_mul_f32 v163,v163,v12
 v_mul_f32 v164,v164,v12
 v_mul_f32 v165,v165,v12
 v_mul_f32 v166,v166,v12
 v_mul_f32 v167,v167,v12
 v_mul_f32 v168,v168,v12
 v_mul_f32 v169,v169,v12
 v_mul_f32 v170,v170,v12
 v_mul_f32 v171,v171,v12
 v_mul_f32 v172,v172,v12
 v_mul_f32 v173,v173,v12
 v_mul_f32 v174,v174,v12
 v_mul_f32 v175,v175,v12
 v_mul_f32 v176,v176,v12
 v_mul_f32 v177,v177,v12
 v_mul_f32 v178,v178,v12
 v_mul_f32 v179,v179,v12
 v_mul_f32 v180,v180,v12
 v_mul_f32 v181,v181,v12
 v_mul_f32 v182,v182,v12
 v_mul_f32 v183,v183,v12
 v_mul_f32 v184,v184,v12
 v_mul_f32 v185,v185,v12
 v_mul_f32 v186,v186,v12
 v_mul_f32 v187,v187,v12
 v_mul_f32 v188,v188,v12
 v_mul_f32 v189,v189,v12
 v_mul_f32 v190,v190,v12
 v_mul_f32 v191,v191,v12
 v_mul_f32 v192,v192,v12
 v_mul_f32 v193,v193,v12
 v_mul_f32 v194,v194,v12
 v_mul_f32 v195,v195,v12
 v_mul_f32 v196,v196,v12
 v_mul_f32 v197,v197,v12
 v_mul_f32 v198,v198,v12
 v_mul_f32 v199,v199,v12
 v_mul_f32 v200,v200,v12
 v_mul_f32 v201,v201,v12
 v_mul_f32 v202,v202,v12
 v_mul_f32 v203,v203,v12
 v_mul_f32 v204,v204,v12
 v_mul_f32 v205,v205,v12
 v_mul_f32 v206,v206,v12
 v_mul_f32 v207,v207,v12
 v_mul_f32 v208,v208,v12
 v_mul_f32 v209,v209,v12
 v_mul_f32 v210,v210,v12
 v_mul_f32 v211,v211,v12
 v_mul_f32 v212,v212,v12
 v_mul_f32 v213,v213,v12
 v_mul_f32 v214,v214,v12
 v_mul_f32 v215,v215,v12
 v_mul_f32 v216,v216,v12
 v_mul_f32 v217,v217,v12
 v_mul_f32 v218,v218,v12
 v_mul_f32 v219,v219,v12
 v_mul_f32 v220,v220,v12
 v_mul_f32 v221,v221,v12
 v_mul_f32 v222,v222,v12
 v_mul_f32 v223,v223,v12
 s_nop 1
 s_branch FO_39R
F_END:
K1_V:
 s_bfe_u32 s76,s2,0x10000
 s_lshl_b32 s76,s76,2
 s_and_b32 s49,s47,3
 s_add_u32 s76,s76,s49
 s_andn2_b32 s77,s46,2
 s_lshr_b32 s49,s47,1
 s_and_b32 s49,s49,2
 s_add_u32 s77,s77,s49
 s_lshl_b32 s49,s77,9
 s_add_u32 s16,s70,s49
 s_addc_u32 s17,s71,0
 s_and_b32 s17,s17,0xffff
 s_sub_u32 s18,3670016,s49
 s_mov_b32 s19,0x20000
 s_mul_i32 s49,s76,229376
 s_add_u32 s12,s66,s49
 s_addc_u32 s13,s67,0
 s_and_b32 s13,s13,0xffff
 s_sub_u32 s14,1835008,s49
 s_mov_b32 s15,0x20000
 s_mov_b32 s20,0
 s_mov_b32 s21,6144
 s_mov_b32 s22,12288
 s_mov_b32 s23,18432
 s_mov_b32 s24,28672
 s_mov_b32 s25,34816
 s_mov_b32 s26,40960
 s_mov_b32 s27,47104
 s_add_u32 s50,s51,32768
 s_add_u32 m0,s51,131072
 s_nop 0
 buffer_load_dwordx4 v16,s[16:19],s32 offen offset:0 lds
 buffer_load_dwordx4 v17,s[16:19],s33 offen offset:1024 lds
 buffer_load_dwordx4 v16,s[16:19],s34 offen offset:2048 lds
 buffer_load_dwordx4 v17,s[16:19],s35 offen offset:3072 lds
 s_add_u32 m0,s51,135168
 s_nop 0
 buffer_load_dwordx4 v18,s[16:19],s36 offen offset:0 lds
 buffer_load_dwordx4 v19,s[16:19],s37 offen offset:1024 lds
 buffer_load_dwordx4 v18,s[16:19],s38 offen offset:2048 lds
 buffer_load_dwordx4 v19,s[16:19],s39 offen offset:3072 lds
 s_add_u32 s16,s16,524288
 s_addc_u32 s17,s17,0
 s_sub_u32 s18,s18,524288
 s_add_u32 m0,s50,0
 s_nop 0
 buffer_load_dwordx4 v20,s[12:15],s20 offen offset:0 lds
 buffer_load_dwordx4 v21,s[12:15],s21 offen offset:1024 lds
 buffer_load_dwordx4 v20,s[12:15],s22 offen offset:2048 lds
 buffer_load_dwordx4 v21,s[12:15],s23 offen offset:3072 lds
 s_add_u32 m0,s50,4096
 s_nop 0
 buffer_load_dwordx4 v20,s[12:15],s24 offen offset:0 lds
 buffer_load_dwordx4 v21,s[12:15],s25 offen offset:1024 lds
 buffer_load_dwordx4 v20,s[12:15],s26 offen offset:2048 lds
 buffer_load_dwordx4 v21,s[12:15],s27 offen offset:3072 lds
 s_add_u32 s12,s12,128
 s_addc_u32 s13,s13,0
 s_sub_u32 s14,s14,128
 s_add_u32 s50,s50,32768
 s_cmp_ge_u32 s50,98304
 s_cselect_b32 s50,s51,s50
 s_bitcmp0_b32 s47,0
 s_cselect_b64 s[72:73],s[72:73],s[74:75]
 s_lshl_b32 s49,s46,9
 s_add_u32 s8,s72,s49
 s_addc_u32 s9,s73,0
 s_and_b32 s9,s9,0xffff
 s_sub_u32 s10,8388608,s49
 s_mov_b32 s11,0x20000
 s_lshl_b32 s49,s44,19
 s_add_u32 s4,s68,s49
 s_addc_u32 s5,s69,0
 s_and_b32 s5,s5,0xffff
 s_sub_u32 s6,4194304,s49
 s_mov_b32 s7,0x20000
 v_and_b32 v27,15,v0
 v_bfe_u32 v28,v0,1,3
 v_bfe_u32 v29,v0,4,2
 v_xor_b32 v28,v28,v29
 v_lshlrev_b32 v28,4,v28
 v_lshl_add_u32 v2,v27,7,v28
 v_xor_b32 v3,64,v2
 v_bfe_u32 v27,v0,2,2
 v_lshl_add_u32 v28,v29,3,v27
 v_lshlrev_b32 v28,9,v28
 v_add_u32 v28,0x18000,v28
 v_bfe_u32 v30,v0,6,1
 v_lshl_add_u32 v28,v30,8,v28
 v_and_b32 v30,3,v0
 v_lshl_add_u32 v28,v30,3,v28
 v_bfe_u32 v27,v0,2,3
 v_xor_b32 v30,0,v27
 v_lshl_add_u32 v6,v30,5,v28
 v_xor_b32 v30,1,v27
 v_lshl_add_u32 v7,v30,5,v28
 v_xor_b32 v30,2,v27
 v_lshl_add_u32 v8,v30,5,v28
 v_xor_b32 v30,3,v27
 v_lshl_add_u32 v9,v30,5,v28
 v_xor_b32 v30,4,v27
 v_lshl_add_u32 v10,v30,5,v28
 v_xor_b32 v30,5,v27
 v_lshl_add_u32 v11,v30,5,v28
 v_xor_b32 v30,6,v27
 v_lshl_add_u32 v12,v30,5,v28
 v_xor_b32 v30,7,v27
 v_lshl_add_u32 v13,v30,5,v28
 s_and_b32 s29,s29,0xffff
 s_mov_b32 s30,134217728
 s_mov_b32 s31,0x20000
 s_add_u32 s59,s47,8
 s_lshr_b32 s54,s45,1
 s_lshl_b32 s54,s54,14
 s_lshl_b32 s56,s46,20
 s_lshl_b32 s49,s54,2
 s_add_u32 s56,s56,s49
 s_and_b32 s49,s45,1
 s_lshl_b32 s49,s49,12
 s_lshl_b32 s57,s76,17
 s_add_u32 s57,s57,s56
 s_sub_u32 s98,s77,s46
 s_lshl_b32 s98,s98,20
 s_add_u32 s57,s57,s98
 s_add_u32 s57,s57,s49
 s_add_u32 s57,s57,33554432
 s_lshl_b32 s58,s49,2
 s_add_u32 s58,s58,16777216
 s_bitcmp0_b32 s47,0
 s_cselect_b32 s49,s49,s58
 s_add_u32 s56,s56,s49
 s_lshl_b32 s49,s44,17
 s_add_u32 s56,s56,s49
 s_mov_b32 s58,0x3db8aa3b
 s_load_dwordx2 s[70:71],s[0:1],80
 s_and_b32 s49,s44,3
 s_lshl_b32 s49,s49,2
 s_add_u32 s49,s49,s45
 s_lshl_b32 s49,s49,16
 v_bfe_u32 v25,v0,2,3
 v_lshlrev_b32 v25,13,v25
 v_and_b32 v26,3,v0
 v_lshl_add_u32 v25,v26,7,v25
 v_add_u32 v32,s49,v25
 s_add_u32 m0,s51,98304
 s_nop 0
 buffer_load_dwordx4 v16,s[16:19],s32 offen offset:0 lds
 buffer_load_dwordx4 v17,s[16:19],s33 offen offset:1024 lds
 buffer_load_dwordx4 v16,s[16:19],s34 offen offset:2048 lds
 buffer_load_dwordx4 v17,s[16:19],s35 offen offset:3072 lds
 s_add_u32 m0,s51,102400
 s_nop 0
 buffer_load_dwordx4 v18,s[16:19],s36 offen offset:0 lds
 buffer_load_dwordx4 v19,s[16:19],s37 offen offset:1024 lds
 buffer_load_dwordx4 v18,s[16:19],s38 offen offset:2048 lds
 buffer_load_dwordx4 v19,s[16:19],s39 offen offset:3072 lds
 s_add_u32 s16,s16,524288
 s_addc_u32 s17,s17,0
 s_sub_u32 s18,s18,524288
 v_bfe_u32 v26,v0,5,1
 v_min_u32 v26,1,v26
 v_lshl_add_u32 v37,v26,20,v32
 v_add_u32 v32,0x80000,v32
 s_lshl_b32 s61,s46,1
 s_and_b32 s62,s47,1
 s_add_u32 s61,s61,s62
 s_lshl_b32 s61,s61,2
 s_add_u32 s61,s61,s45
 s_lshl_b32 s61,s61,12
 v_and_b32 v25,1,v0
 v_lshlrev_b32 v25,11,v25
 v_bfe_u32 v26,v0,1,5
 v_lshl_add_u32 v25,v26,7,v25
 v_add_u32 v25,s61,v25
 v_bfrev_b32 v27,1
 v_cmp_gt_u32 vcc,4,v26
 v_add_u32 v28,128,v25
 s_nop 0
 v_cndmask_b32 v38,v27,v25,vcc
 v_cmp_gt_u32 vcc,2,v26
 s_nop 0
 s_nop 0
 v_cndmask_b32 v33,v27,v28,vcc
 s_add_u32 s55,s54,32768
 v_add_u32 v4,s55,v2
 v_add_u32 v5,s55,v3
 s_waitcnt vmcnt(8)
 s_barrier
 ds_read_b64_tr_b16 a[128:129],v6 offset:32768
 ds_read_b64_tr_b16 a[130:131],v6 offset:34816
 ds_read_b64_tr_b16 a[132:133],v6 offset:49152
 ds_read_b64_tr_b16 a[134:135],v6 offset:51200
 ds_read_b64_tr_b16 a[136:137],v7 offset:32768
 ds_read_b64_tr_b16 a[138:139],v7 offset:34816
 ds_read_b64_tr_b16 a[140:141],v7 offset:49152
 ds_read_b64_tr_b16 a[142:143],v7 offset:51200
 ds_read_b64_tr_b16 a[144:145],v8 offset:32768
 ds_read_b64_tr_b16 a[146:147],v8 offset:34816
 ds_read_b64_tr_b16 a[148:149],v8 offset:49152
 ds_read_b64_tr_b16 a[150:151],v8 offset:51200
 ds_read_b64_tr_b16 a[152:153],v9 offset:32768
 ds_read_b64_tr_b16 a[154:155],v9 offset:34816
 ds_read_b64_tr_b16 a[156:157],v9 offset:49152
 ds_read_b64_tr_b16 a[158:159],v9 offset:51200
 ds_read_b64_tr_b16 a[160:161],v10 offset:32768
 ds_read_b64_tr_b16 a[162:163],v10 offset:34816
 ds_read_b64_tr_b16 a[164:165],v10 offset:49152
 ds_read_b64_tr_b16 a[166:167],v10 offset:51200
 ds_read_b64_tr_b16 a[168:169],v11 offset:32768
 ds_read_b64_tr_b16 a[170:171],v11 offset:34816
 ds_read_b64_tr_b16 a[172:173],v11 offset:49152
 ds_read_b64_tr_b16 a[174:175],v11 offset:51200
 ds_read_b64_tr_b16 a[176:177],v12 offset:32768
 ds_read_b64_tr_b16 a[178:179],v12 offset:34816
 ds_read_b64_tr_b16 a[180:181],v12 offset:49152
 ds_read_b64_tr_b16 a[182:183],v12 offset:51200
 ds_read_b64_tr_b16 a[184:185],v13 offset:32768
 ds_read_b64_tr_b16 a[186:187],v13 offset:34816
 ds_read_b64_tr_b16 a[188:189],v13 offset:49152
 ds_read_b64_tr_b16 a[190:191],v13 offset:51200
 ds_read_b128 a[192:195],v4 offset:0
 ds_read_b128 a[196:199],v5 offset:0
 s_waitcnt lgkmcnt(0)
 s_barrier
 v_mfma_f32_16x16x32_bf16 v[48:51],a[128:131],a[192:195],0
 s_add_u32 m0,s50,0
 v_mfma_f32_16x16x32_bf16 v[48:51],a[132:135],a[196:199],v[48:51]
 ds_read_b128 a[200:203],v4 offset:2048
 v_mfma_f32_16x16x32_bf16 v[52:55],a[136:139],a[192:195],0
 buffer_load_dwordx4 v20,s[12:15],s20 offen offset:0 lds
 v_mfma_f32_16x16x32_bf16 v[52:55],a[140:143],a[196:199],v[52:55]
 ds_read_b128 a[204:207],v5 offset:2048
 v_mfma_f32_16x16x32_bf16 v[56:59],a[144:147],a[192:195],0
 v_mfma_f32_16x16x32_bf16 v[56:59],a[148:151],a[196:199],v[56:59]
 buffer_load_dwordx4 v21,s[12:15],s21 offen offset:1024 lds
 v_mfma_f32_16x16x32_bf16 v[60:63],a[152:155],a[192:195],0
 v_mfma_f32_16x16x32_bf16 v[60:63],a[156:159],a[196:199],v[60:63]
 buffer_load_dwordx4 v20,s[12:15],s22 offen offset:2048 lds
 v_mfma_f32_16x16x32_bf16 v[64:67],a[160:163],a[192:195],0
 v_mfma_f32_16x16x32_bf16 v[64:67],a[164:167],a[196:199],v[64:67]
 v_mfma_f32_16x16x32_bf16 v[68:71],a[168:171],a[192:195],0
 buffer_load_dwordx4 v21,s[12:15],s23 offen offset:3072 lds
 v_mfma_f32_16x16x32_bf16 v[68:71],a[172:175],a[196:199],v[68:71]
 v_mfma_f32_16x16x32_bf16 v[72:75],a[176:179],a[192:195],0
 s_add_u32 m0,s50,4096
 v_mfma_f32_16x16x32_bf16 v[72:75],a[180:183],a[196:199],v[72:75]
 v_mfma_f32_16x16x32_bf16 v[76:79],a[184:187],a[192:195],0
 v_mfma_f32_16x16x32_bf16 v[76:79],a[188:191],a[196:199],v[76:79]
 s_waitcnt lgkmcnt(0)
 v_mfma_f32_16x16x32_bf16 v[80:83],a[128:131],a[200:203],0
 buffer_load_dwordx4 v20,s[12:15],s24 offen offset:0 lds
 v_mfma_f32_16x16x32_bf16 v[80:83],a[132:135],a[204:207],v[80:83]
 ds_read_b128 a[192:195],v4 offset:4096
 v_mfma_f32_16x16x32_bf16 v[84:87],a[136:139],a[200:203],0
 buffer_load_dwordx4 v21,s[12:15],s25 offen offset:1024 lds
 v_mfma_f32_16x16x32_bf16 v[84:87],a[140:143],a[204:207],v[84:87]
 ds_read_b128 a[196:199],v5 offset:4096
 v_mfma_f32_16x16x32_bf16 v[88:91],a[144:147],a[200:203],0
 buffer_load_dwordx4 v20,s[12:15],s26 offen offset:2048 lds
 v_mfma_f32_16x16x32_bf16 v[88:91],a[148:151],a[204:207],v[88:91]
 v_mfma_f32_16x16x32_bf16 v[92:95],a[152:155],a[200:203],0
 buffer_load_dwordx4 v21,s[12:15],s27 offen offset:3072 lds
 v_mfma_f32_16x16x32_bf16 v[92:95],a[156:159],a[204:207],v[92:95]
 v_mfma_f32_16x16x32_bf16 v[96:99],a[160:163],a[200:203],0
 v_mfma_f32_16x16x32_bf16 v[96:99],a[164:167],a[204:207],v[96:99]
 s_add_u32 s12,s12,128
 s_addc_u32 s13,s13,0
 v_mfma_f32_16x16x32_bf16 v[100:103],a[168:171],a[200:203],0
 v_mfma_f32_16x16x32_bf16 v[100:103],a[172:175],a[204:207],v[100:103]
 s_sub_u32 s14,s14,128
 v_mfma_f32_16x16x32_bf16 v[104:107],a[176:179],a[200:203],0
 v_mfma_f32_16x16x32_bf16 v[104:107],a[180:183],a[204:207],v[104:107]
 v_mfma_f32_16x16x32_bf16 v[108:111],a[184:187],a[200:203],0
 s_add_u32 s50,s50,32768
 v_mfma_f32_16x16x32_bf16 v[108:111],a[188:191],a[204:207],v[108:111]
 s_waitcnt lgkmcnt(0)
 v_mfma_f32_16x16x32_bf16 v[112:115],a[128:131],a[192:195],0
 s_cmp_ge_u32 s50,98304
 s_cselect_b32 s50,s51,s50
 v_mfma_f32_16x16x32_bf16 v[112:115],a[132:135],a[196:199],v[112:115]
 ds_read_b128 a[200:203],v4 offset:6144
 v_mfma_f32_16x16x32_bf16 v[116:119],a[136:139],a[192:195],0
 v_mfma_f32_16x16x32_bf16 v[116:119],a[140:143],a[196:199],v[116:119]
 ds_read_b128 a[204:207],v5 offset:6144
 s_add_u32 m0,s51,131072
 v_mfma_f32_16x16x32_bf16 v[120:123],a[144:147],a[192:195],0
 v_mfma_f32_16x16x32_bf16 v[120:123],a[148:151],a[196:199],v[120:123]
 buffer_load_dwordx4 v16,s[16:19],s32 offen offset:0 lds
 v_mfma_f32_16x16x32_bf16 v[124:127],a[152:155],a[192:195],0
 v_mfma_f32_16x16x32_bf16 v[124:127],a[156:159],a[196:199],v[124:127]
 v_mfma_f32_16x16x32_bf16 v[128:131],a[160:163],a[192:195],0
 buffer_load_dwordx4 v17,s[16:19],s33 offen offset:1024 lds
 v_mfma_f32_16x16x32_bf16 v[128:131],a[164:167],a[196:199],v[128:131]
 v_mfma_f32_16x16x32_bf16 v[132:135],a[168:171],a[192:195],0
 buffer_load_dwordx4 v16,s[16:19],s34 offen offset:2048 lds
 v_mfma_f32_16x16x32_bf16 v[132:135],a[172:175],a[196:199],v[132:135]
 v_mfma_f32_16x16x32_bf16 v[136:139],a[176:179],a[192:195],0
 v_mfma_f32_16x16x32_bf16 v[136:139],a[180:183],a[196:199],v[136:139]
 buffer_load_dwordx4 v17,s[16:19],s35 offen offset:3072 lds
 v_mfma_f32_16x16x32_bf16 v[140:143],a[184:187],a[192:195],0
 v_mfma_f32_16x16x32_bf16 v[140:143],a[188:191],a[196:199],v[140:143]
 s_waitcnt lgkmcnt(0)
 s_add_u32 m0,s51,135168
 v_mfma_f32_16x16x32_bf16 v[144:147],a[128:131],a[200:203],0
 v_mfma_f32_16x16x32_bf16 v[144:147],a[132:135],a[204:207],v[144:147]
 ds_read_b128 a[192:195],v4 offset:8192
 v_mfma_f32_16x16x32_bf16 v[148:151],a[136:139],a[200:203],0
 buffer_load_dwordx4 v18,s[16:19],s36 offen offset:0 lds
 v_mfma_f32_16x16x32_bf16 v[148:151],a[140:143],a[204:207],v[148:151]
 ds_read_b128 a[196:199],v5 offset:8192
 v_mfma_f32_16x16x32_bf16 v[152:155],a[144:147],a[200:203],0
 buffer_load_dwordx4 v19,s[16:19],s37 offen offset:1024 lds
 v_mfma_f32_16x16x32_bf16 v[152:155],a[148:151],a[204:207],v[152:155]
 v_mfma_f32_16x16x32_bf16 v[156:159],a[152:155],a[200:203],0
 v_mfma_f32_16x16x32_bf16 v[156:159],a[156:159],a[204:207],v[156:159]
 buffer_load_dwordx4 v18,s[16:19],s38 offen offset:2048 lds
 v_mfma_f32_16x16x32_bf16 v[160:163],a[160:163],a[200:203],0
 s_waitcnt vmcnt(15)
 s_barrier
 v_mfma_f32_16x16x32_bf16 v[160:163],a[164:167],a[204:207],v[160:163]
 ds_read_b64_tr_b16 a[64:65],v6 offset:0
 v_mfma_f32_16x16x32_bf16 v[164:167],a[168:171],a[200:203],0
 buffer_load_dwordx4 v19,s[16:19],s39 offen offset:3072 lds
 v_mfma_f32_16x16x32_bf16 v[164:167],a[172:175],a[204:207],v[164:167]
 ds_read_b64_tr_b16 a[66:67],v6 offset:2048
 ds_read_b64_tr_b16 a[68:69],v6 offset:16384
 v_mfma_f32_16x16x32_bf16 v[168:171],a[176:179],a[200:203],0
 s_add_u32 s16,s16,524288
 s_addc_u32 s17,s17,0
 v_mfma_f32_16x16x32_bf16 v[168:171],a[180:183],a[204:207],v[168:171]
 ds_read_b64_tr_b16 a[70:71],v6 offset:18432
 v_mfma_f32_16x16x32_bf16 v[172:175],a[184:187],a[200:203],0
 s_sub_u32 s18,s18,524288
 ds_read_b64_tr_b16 a[72:73],v7 offset:0
 v_mfma_f32_16x16x32_bf16 v[172:175],a[188:191],a[204:207],v[172:175]
 s_waitcnt lgkmcnt(5)
 v_mfma_f32_16x16x32_bf16 v[176:179],a[128:131],a[192:195],0
 ds_read_b64_tr_b16 a[74:75],v7 offset:2048
 v_mfma_f32_16x16x32_bf16 v[176:179],a[132:135],a[196:199],v[176:179]
 ds_read_b128 a[200:203],v4 offset:10240
 s_add_u32 m0,s50,0
 v_mfma_f32_16x16x32_bf16 v[180:183],a[136:139],a[192:195],0
 ds_read_b64_tr_b16 a[76:77],v7 offset:16384
 v_mfma_f32_16x16x32_bf16 v[180:183],a[140:143],a[196:199],v[180:183]
 ds_read_b128 a[204:207],v5 offset:10240
 ds_read_b64_tr_b16 a[78:79],v7 offset:18432
 v_mfma_f32_16x16x32_bf16 v[184:187],a[144:147],a[192:195],0
 buffer_load_dwordx4 v20,s[12:15],s20 offen offset:0 lds
 v_mfma_f32_16x16x32_bf16 v[184:187],a[148:151],a[196:199],v[184:187]
 ds_read_b64_tr_b16 a[80:81],v8 offset:0
 v_mfma_f32_16x16x32_bf16 v[188:191],a[152:155],a[192:195],0
 buffer_load_dwordx4 v21,s[12:15],s21 offen offset:1024 lds
 v_mfma_f32_16x16x32_bf16 v[188:191],a[156:159],a[196:199],v[188:191]
 ds_read_b64_tr_b16 a[82:83],v8 offset:2048
 ds_read_b64_tr_b16 a[84:85],v8 offset:16384
 v_mfma_f32_16x16x32_bf16 v[192:195],a[160:163],a[192:195],0
 buffer_load_dwordx4 v20,s[12:15],s22 offen offset:2048 lds
 v_mfma_f32_16x16x32_bf16 v[192:195],a[164:167],a[196:199],v[192:195]
 ds_read_b64_tr_b16 a[86:87],v8 offset:18432
 v_mfma_f32_16x16x32_bf16 v[196:199],a[168:171],a[192:195],0
 ds_read_b64_tr_b16 a[88:89],v9 offset:0
 v_mfma_f32_16x16x32_bf16 v[196:199],a[172:175],a[196:199],v[196:199]
 buffer_load_dwordx4 v21,s[12:15],s23 offen offset:3072 lds
 v_mfma_f32_16x16x32_bf16 v[200:203],a[176:179],a[192:195],0
 ds_read_b64_tr_b16 a[90:91],v9 offset:2048
 v_mfma_f32_16x16x32_bf16 v[200:203],a[180:183],a[196:199],v[200:203]
 s_add_u32 m0,s50,4096
 ds_read_b64_tr_b16 a[92:93],v9 offset:16384
 v_mfma_f32_16x16x32_bf16 v[204:207],a[184:187],a[192:195],0
 v_mfma_f32_16x16x32_bf16 v[204:207],a[188:191],a[196:199],v[204:207]
 s_waitcnt lgkmcnt(8)
 ds_read_b64_tr_b16 a[94:95],v9 offset:18432
 v_mfma_f32_16x16x32_bf16 v[208:211],a[128:131],a[200:203],0
 buffer_load_dwordx4 v20,s[12:15],s24 offen offset:0 lds
 v_mfma_f32_16x16x32_bf16 v[208:211],a[132:135],a[204:207],v[208:211]
 ds_read_b64_tr_b16 a[96:97],v10 offset:0
 ds_read_b128 a[192:195],v4 offset:12288
 v_mfma_f32_16x16x32_bf16 v[212:215],a[136:139],a[200:203],0
 ds_read_b64_tr_b16 a[98:99],v10 offset:2048
 v_mfma_f32_16x16x32_bf16 v[212:215],a[140:143],a[204:207],v[212:215]
 buffer_load_dwordx4 v21,s[12:15],s25 offen offset:1024 lds
 v_mfma_f32_16x16x32_bf16 v[216:219],a[144:147],a[200:203],0
 ds_read_b128 a[196:199],v5 offset:12288
 ds_read_b64_tr_b16 a[100:101],v10 offset:16384
 v_mfma_f32_16x16x32_bf16 v[216:219],a[148:151],a[204:207],v[216:219]
 ds_read_b64_tr_b16 a[102:103],v10 offset:18432
 v_mfma_f32_16x16x32_bf16 v[220:223],a[152:155],a[200:203],0
 buffer_load_dwordx4 v20,s[12:15],s26 offen offset:2048 lds
 v_mfma_f32_16x16x32_bf16 v[220:223],a[156:159],a[204:207],v[220:223]
 ds_read_b64_tr_b16 a[104:105],v11 offset:0
 ds_read_b64_tr_b16 a[106:107],v11 offset:2048
 v_mfma_f32_16x16x32_bf16 v[224:227],a[160:163],a[200:203],0
 buffer_load_dwordx4 v21,s[12:15],s27 offen offset:3072 lds
 v_mfma_f32_16x16x32_bf16 v[224:227],a[164:167],a[204:207],v[224:227]
 ds_read_b64_tr_b16 a[108:109],v11 offset:16384
 v_mfma_f32_16x16x32_bf16 v[228:231],a[168:171],a[200:203],0
 s_add_u32 s12,s12,128
 s_addc_u32 s13,s13,0
 v_mfma_f32_16x16x32_bf16 v[228:231],a[172:175],a[204:207],v[228:231]
 ds_read_b64_tr_b16 a[110:111],v11 offset:18432
 v_mfma_f32_16x16x32_bf16 v[232:235],a[176:179],a[200:203],0
 ds_read_b64_tr_b16 a[112:113],v12 offset:0
 s_sub_u32 s14,s14,128
 v_mfma_f32_16x16x32_bf16 v[232:235],a[180:183],a[204:207],v[232:235]
 ds_read_b64_tr_b16 a[114:115],v12 offset:2048
 v_mfma_f32_16x16x32_bf16 v[236:239],a[184:187],a[200:203],0
 v_mfma_f32_16x16x32_bf16 v[236:239],a[188:191],a[204:207],v[236:239]
 s_waitcnt lgkmcnt(8)
 s_add_u32 s50,s50,32768
 v_mfma_f32_16x16x32_bf16 v[240:243],a[128:131],a[192:195],0
 ds_read_b64_tr_b16 a[116:117],v12 offset:16384
 ds_read_b64_tr_b16 a[118:119],v12 offset:18432
 v_mfma_f32_16x16x32_bf16 v[240:243],a[132:135],a[196:199],v[240:243]
 ds_read_b128 a[200:203],v4 offset:14336
 v_mfma_f32_16x16x32_bf16 v[244:247],a[136:139],a[192:195],0
 s_cmp_ge_u32 s50,98304
 s_cselect_b32 s50,s51,s50
 v_mfma_f32_16x16x32_bf16 v[244:247],a[140:143],a[196:199],v[244:247]
 ds_read_b64_tr_b16 a[120:121],v13 offset:0
 ds_read_b128 a[204:207],v5 offset:14336
 v_mfma_f32_16x16x32_bf16 v[248:251],a[144:147],a[192:195],0
 ds_read_b64_tr_b16 a[122:123],v13 offset:2048
 v_mfma_f32_16x16x32_bf16 v[248:251],a[148:151],a[196:199],v[248:251]
 ds_read_b64_tr_b16 a[124:125],v13 offset:16384
 v_mfma_f32_16x16x32_bf16 v[252:255],a[152:155],a[192:195],0
 ds_read_b64_tr_b16 a[126:127],v13 offset:18432
 v_mfma_f32_16x16x32_bf16 v[252:255],a[156:159],a[196:199],v[252:255]
 v_mfma_f32_16x16x32_bf16 a[208:211],a[160:163],a[192:195],0
 v_mfma_f32_16x16x32_bf16 a[208:211],a[164:167],a[196:199],a[208:211]
 s_add_u32 s55,s55,32768
 v_mfma_f32_16x16x32_bf16 a[212:215],a[168:171],a[192:195],0
 s_cmp_ge_u32 s55,98304
 s_cselect_b32 s55,s54,s55
 v_mfma_f32_16x16x32_bf16 a[212:215],a[172:175],a[196:199],a[212:215]
 v_add_u32 v4,s55,v2
 v_mfma_f32_16x16x32_bf16 a[216:219],a[176:179],a[192:195],0
 v_add_u32 v5,s55,v3
 v_mfma_f32_16x16x32_bf16 a[216:219],a[180:183],a[196:199],a[216:219]
 v_mfma_f32_16x16x32_bf16 a[220:223],a[184:187],a[192:195],0
 v_mfma_f32_16x16x32_bf16 a[220:223],a[188:191],a[196:199],a[220:223]
 s_waitcnt vmcnt(16) lgkmcnt(0)
 s_barrier
 v_mfma_f32_16x16x32_bf16 a[224:227],a[128:131],a[200:203],0
 ds_read_b128 a[192:195],v4 offset:0
 v_mfma_f32_16x16x32_bf16 a[224:227],a[132:135],a[204:207],a[224:227]
 ds_read_b128 a[196:199],v5 offset:0
 v_mfma_f32_16x16x32_bf16 a[228:231],a[136:139],a[200:203],0
 v_mfma_f32_16x16x32_bf16 a[228:231],a[140:143],a[204:207],a[228:231]
 v_mfma_f32_16x16x32_bf16 a[232:235],a[144:147],a[200:203],0
 v_mfma_f32_16x16x32_bf16 a[232:235],a[148:151],a[204:207],a[232:235]
 v_mfma_f32_16x16x32_bf16 a[236:239],a[152:155],a[200:203],0
 v_mfma_f32_16x16x32_bf16 a[236:239],a[156:159],a[204:207],a[236:239]
 v_mfma_f32_16x16x32_bf16 a[240:243],a[160:163],a[200:203],0
 v_mfma_f32_16x16x32_bf16 a[240:243],a[164:167],a[204:207],a[240:243]
 v_mfma_f32_16x16x32_bf16 a[244:247],a[168:171],a[200:203],0
 v_mfma_f32_16x16x32_bf16 a[244:247],a[172:175],a[204:207],a[244:247]
 v_mfma_f32_16x16x32_bf16 a[248:251],a[176:179],a[200:203],0
 v_mfma_f32_16x16x32_bf16 a[248:251],a[180:183],a[204:207],a[248:251]
 v_mfma_f32_16x16x32_bf16 a[252:255],a[184:187],a[200:203],0
 v_mfma_f32_16x16x32_bf16 a[252:255],a[188:191],a[204:207],a[252:255]
 s_waitcnt lgkmcnt(0)
 v_mfma_f32_16x16x32_bf16 v[48:51],a[64:67],a[192:195],v[48:51]
 s_add_u32 m0,s51,98304
 v_mfma_f32_16x16x32_bf16 v[48:51],a[68:71],a[196:199],v[48:51]
 ds_read_b128 a[200:203],v4 offset:2048
 v_mfma_f32_16x16x32_bf16 v[52:55],a[72:75],a[192:195],v[52:55]
 v_mfma_f32_16x16x32_bf16 v[52:55],a[76:79],a[196:199],v[52:55]
 ds_read_b128 a[204:207],v5 offset:2048
 v_mfma_f32_16x16x32_bf16 v[56:59],a[80:83],a[192:195],v[56:59]
 buffer_load_dwordx4 v16,s[16:19],s32 offen offset:0 lds
 v_mfma_f32_16x16x32_bf16 v[56:59],a[84:87],a[196:199],v[56:59]
 v_mfma_f32_16x16x32_bf16 v[60:63],a[88:91],a[192:195],v[60:63]
 v_mfma_f32_16x16x32_bf16 v[60:63],a[92:95],a[196:199],v[60:63]
 buffer_load_dwordx4 v17,s[16:19],s33 offen offset:1024 lds
 v_mfma_f32_16x16x32_bf16 v[64:67],a[96:99],a[192:195],v[64:67]
 v_mfma_f32_16x16x32_bf16 v[64:67],a[100:103],a[196:199],v[64:67]
 v_mfma_f32_16x16x32_bf16 v[68:71],a[104:107],a[192:195],v[68:71]
 v_mfma_f32_16x16x32_bf16 v[68:71],a[108:111],a[196:199],v[68:71]
 buffer_load_dwordx4 v16,s[16:19],s34 offen offset:2048 lds
 v_mfma_f32_16x16x32_bf16 v[72:75],a[112:115],a[192:195],v[72:75]
 v_mfma_f32_16x16x32_bf16 v[72:75],a[116:119],a[196:199],v[72:75]
 v_mfma_f32_16x16x32_bf16 v[76:79],a[120:123],a[192:195],v[76:79]
 v_mfma_f32_16x16x32_bf16 v[76:79],a[124:127],a[196:199],v[76:79]
 s_waitcnt lgkmcnt(0)
 v_mfma_f32_16x16x32_bf16 v[80:83],a[64:67],a[200:203],v[80:83]
 buffer_load_dwordx4 v17,s[16:19],s35 offen offset:3072 lds
 v_mfma_f32_16x16x32_bf16 v[80:83],a[68:71],a[204:207],v[80:83]
 ds_read_b128 a[192:195],v4 offset:4096
 v_mfma_f32_16x16x32_bf16 v[84:87],a[72:75],a[200:203],v[84:87]
 v_mfma_f32_16x16x32_bf16 v[84:87],a[76:79],a[204:207],v[84:87]
 ds_read_b128 a[196:199],v5 offset:4096
 s_add_u32 m0,s51,102400
 v_mfma_f32_16x16x32_bf16 v[88:91],a[80:83],a[200:203],v[88:91]
 v_mfma_f32_16x16x32_bf16 v[88:91],a[84:87],a[204:207],v[88:91]
 v_mfma_f32_16x16x32_bf16 v[92:95],a[88:91],a[200:203],v[92:95]
 v_mfma_f32_16x16x32_bf16 v[92:95],a[92:95],a[204:207],v[92:95]
 buffer_load_dwordx4 v18,s[16:19],s36 offen offset:0 lds
 v_mfma_f32_16x16x32_bf16 v[96:99],a[96:99],a[200:203],v[96:99]
 v_mfma_f32_16x16x32_bf16 v[96:99],a[100:103],a[204:207],v[96:99]
 v_mfma_f32_16x16x32_bf16 v[100:103],a[104:107],a[200:203],v[100:103]
 buffer_load_dwordx4 v19,s[16:19],s37 offen offset:1024 lds
 v_mfma_f32_16x16x32_bf16 v[100:103],a[108:111],a[204:207],v[100:103]
 v_mfma_f32_16x16x32_bf16 v[104:107],a[112:115],a[200:203],v[104:107]
 v_mfma_f32_16x16x32_bf16 v[104:107],a[116:119],a[204:207],v[104:107]
 v_mfma_f32_16x16x32_bf16 v[108:111],a[120:123],a[200:203],v[108:111]
 buffer_load_dwordx4 v18,s[16:19],s38 offen offset:2048 lds
 v_mfma_f32_16x16x32_bf16 v[108:111],a[124:127],a[204:207],v[108:111]
 s_waitcnt lgkmcnt(0)
 v_mfma_f32_16x16x32_bf16 v[112:115],a[64:67],a[192:195],v[112:115]
 v_mfma_f32_16x16x32_bf16 v[112:115],a[68:71],a[196:199],v[112:115]
 ds_read_b128 a[200:203],v4 offset:6144
 v_mfma_f32_16x16x32_bf16 v[116:119],a[72:75],a[192:195],v[116:119]
 buffer_load_dwordx4 v19,s[16:19],s39 offen offset:3072 lds
 v_mfma_f32_16x16x32_bf16 v[116:119],a[76:79],a[196:199],v[116:119]
 ds_read_b128 a[204:207],v5 offset:6144
 v_mfma_f32_16x16x32_bf16 v[120:123],a[80:83],a[192:195],v[120:123]
 v_mfma_f32_16x16x32_bf16 v[120:123],a[84:87],a[196:199],v[120:123]
 v_mfma_f32_16x16x32_bf16 v[124:127],a[88:91],a[192:195],v[124:127]
 s_add_u32 s16,s16,524288
 s_addc_u32 s17,s17,0
 v_mfma_f32_16x16x32_bf16 v[124:127],a[92:95],a[196:199],v[124:127]
 v_mfma_f32_16x16x32_bf16 v[128:131],a[96:99],a[192:195],v[128:131]
 v_mfma_f32_16x16x32_bf16 v[128:131],a[100:103],a[196:199],v[128:131]
 v_mfma_f32_16x16x32_bf16 v[132:135],a[104:107],a[192:195],v[132:135]
 s_sub_u32 s18,s18,524288
 v_mfma_f32_16x16x32_bf16 v[132:135],a[108:111],a[196:199],v[132:135]
 v_mfma_f32_16x16x32_bf16 v[136:139],a[112:115],a[192:195],v[136:139]
 v_mfma_f32_16x16x32_bf16 v[136:139],a[116:119],a[196:199],v[136:139]
 v_mfma_f32_16x16x32_bf16 v[140:143],a[120:123],a[192:195],v[140:143]
 s_add_u32 m0,s50,0
 v_mfma_f32_16x16x32_bf16 v[140:143],a[124:127],a[196:199],v[140:143]
 s_waitcnt lgkmcnt(0)
 v_mfma_f32_16x16x32_bf16 v[144:147],a[64:67],a[200:203],v[144:147]
 v_mfma_f32_16x16x32_bf16 v[144:147],a[68:71],a[204:207],v[144:147]
 ds_read_b128 a[192:195],v4 offset:8192
 v_mfma_f32_16x16x32_bf16 v[148:151],a[72:75],a[200:203],v[148:151]
 buffer_load_dwordx4 v20,s[12:15],s20 offen offset:0 lds
 v_mfma_f32_16x16x32_bf16 v[148:151],a[76:79],a[204:207],v[148:151]
 ds_read_b128 a[196:199],v5 offset:8192
 v_mfma_f32_16x16x32_bf16 v[152:155],a[80:83],a[200:203],v[152:155]
 v_mfma_f32_16x16x32_bf16 v[152:155],a[84:87],a[204:207],v[152:155]
 buffer_load_dwordx4 v21,s[12:15],s21 offen offset:1024 lds
 v_mfma_f32_16x16x32_bf16 v[156:159],a[88:91],a[200:203],v[156:159]
 v_mfma_f32_16x16x32_bf16 v[156:159],a[92:95],a[204:207],v[156:159]
 v_mfma_f32_16x16x32_bf16 v[160:163],a[96:99],a[200:203],v[160:163]
 s_waitcnt vmcnt(18)
 s_barrier
 v_mfma_f32_16x16x32_bf16 v[160:163],a[100:103],a[204:207],v[160:163]
 ds_read_b64_tr_b16 a[128:129],v6 offset:32768
 v_mfma_f32_16x16x32_bf16 v[164:167],a[104:107],a[200:203],v[164:167]
 buffer_load_dwordx4 v20,s[12:15],s22 offen offset:2048 lds
 v_mfma_f32_16x16x32_bf16 v[164:167],a[108:111],a[204:207],v[164:167]
 ds_read_b64_tr_b16 a[130:131],v6 offset:34816
 ds_read_b64_tr_b16 a[132:133],v6 offset:49152
 v_mfma_f32_16x16x32_bf16 v[168:171],a[112:115],a[200:203],v[168:171]
 v_mfma_f32_16x16x32_bf16 v[168:171],a[116:119],a[204:207],v[168:171]
 ds_read_b64_tr_b16 a[134:135],v6 offset:51200
 v_mfma_f32_16x16x32_bf16 v[172:175],a[120:123],a[200:203],v[172:175]
 buffer_load_dwordx4 v21,s[12:15],s23 offen offset:3072 lds
 v_mfma_f32_16x16x32_bf16 v[172:175],a[124:127],a[204:207],v[172:175]
 s_waitcnt lgkmcnt(4)
 ds_read_b64_tr_b16 a[136:137],v7 offset:32768
 v_mfma_f32_16x16x32_bf16 v[176:179],a[64:67],a[192:195],v[176:179]
 ds_read_b64_tr_b16 a[138:139],v7 offset:34816
 v_mfma_f32_16x16x32_bf16 v[176:179],a[68:71],a[196:199],v[176:179]
 ds_read_b128 a[200:203],v4 offset:10240
 s_add_u32 m0,s50,4096
 v_mfma_f32_16x16x32_bf16 v[180:183],a[72:75],a[192:195],v[180:183]
 ds_read_b64_tr_b16 a[140:141],v7 offset:49152
 v_mfma_f32_16x16x32_bf16 v[180:183],a[76:79],a[196:199],v[180:183]
 ds_read_b128 a[204:207],v5 offset:10240
 ds_read_b64_tr_b16 a[142:143],v7 offset:51200
 v_mfma_f32_16x16x32_bf16 v[184:187],a[80:83],a[192:195],v[184:187]
 ds_read_b64_tr_b16 a[144:145],v8 offset:32768
 v_mfma_f32_16x16x32_bf16 v[184:187],a[84:87],a[196:199],v[184:187]
 buffer_load_dwordx4 v20,s[12:15],s24 offen offset:0 lds
 v_mfma_f32_16x16x32_bf16 v[188:191],a[88:91],a[192:195],v[188:191]
 ds_read_b64_tr_b16 a[146:147],v8 offset:34816
 v_mfma_f32_16x16x32_bf16 v[188:191],a[92:95],a[196:199],v[188:191]
 ds_read_b64_tr_b16 a[148:149],v8 offset:49152
 v_mfma_f32_16x16x32_bf16 v[192:195],a[96:99],a[192:195],v[192:195]
 v_mfma_f32_16x16x32_bf16 v[192:195],a[100:103],a[196:199],v[192:195]
 buffer_load_dwordx4 v21,s[12:15],s25 offen offset:1024 lds
 v_mfma_f32_16x16x32_bf16 v[196:199],a[104:107],a[192:195],v[196:199]
 ds_read_b64_tr_b16 a[150:151],v8 offset:51200
 ds_read_b64_tr_b16 a[152:153],v9 offset:32768
 v_mfma_f32_16x16x32_bf16 v[196:199],a[108:111],a[196:199],v[196:199]
 v_mfma_f32_16x16x32_bf16 v[200:203],a[112:115],a[192:195],v[200:203]
 ds_read_b64_tr_b16 a[154:155],v9 offset:34816
 v_mfma_f32_16x16x32_bf16 v[200:203],a[116:119],a[196:199],v[200:203]
 buffer_load_dwordx4 v20,s[12:15],s26 offen offset:2048 lds
 v_mfma_f32_16x16x32_bf16 v[204:207],a[120:123],a[192:195],v[204:207]
 ds_read_b64_tr_b16 a[156:157],v9 offset:49152
 v_mfma_f32_16x16x32_bf16 v[204:207],a[124:127],a[196:199],v[204:207]
 s_waitcnt lgkmcnt(8)
 ds_read_b64_tr_b16 a[158:159],v9 offset:51200
 v_mfma_f32_16x16x32_bf16 v[208:211],a[64:67],a[200:203],v[208:211]
 ds_read_b64_tr_b16 a[160:161],v10 offset:32768
 v_mfma_f32_16x16x32_bf16 v[208:211],a[68:71],a[204:207],v[208:211]
 buffer_load_dwordx4 v21,s[12:15],s27 offen offset:3072 lds
 v_mfma_f32_16x16x32_bf16 v[212:215],a[72:75],a[200:203],v[212:215]
 ds_read_b128 a[192:195],v4 offset:12288
 ds_read_b64_tr_b16 a[162:163],v10 offset:34816
 v_mfma_f32_16x16x32_bf16 v[212:215],a[76:79],a[204:207],v[212:215]
 ds_read_b128 a[196:199],v5 offset:12288
 ds_read_b64_tr_b16 a[164:165],v10 offset:49152
 v_mfma_f32_16x16x32_bf16 v[216:219],a[80:83],a[200:203],v[216:219]
 s_add_u32 s12,s12,128
 s_addc_u32 s13,s13,0
 v_mfma_f32_16x16x32_bf16 v[216:219],a[84:87],a[204:207],v[216:219]
 ds_read_b64_tr_b16 a[166:167],v10 offset:51200
 v_mfma_f32_16x16x32_bf16 v[220:223],a[88:91],a[200:203],v[220:223]
 ds_read_b64_tr_b16 a[168:169],v11 offset:32768
 v_mfma_f32_16x16x32_bf16 v[220:223],a[92:95],a[204:207],v[220:223]
 ds_read_b64_tr_b16 a[170:171],v11 offset:34816
 v_mfma_f32_16x16x32_bf16 v[224:227],a[96:99],a[200:203],v[224:227]
 s_sub_u32 s14,s14,128
 v_mfma_f32_16x16x32_bf16 v[224:227],a[100:103],a[204:207],v[224:227]
 ds_read_b64_tr_b16 a[172:173],v11 offset:49152
 v_mfma_f32_16x16x32_bf16 v[228:231],a[104:107],a[200:203],v[228:231]
 ds_read_b64_tr_b16 a[174:175],v11 offset:51200
 v_mfma_f32_16x16x32_bf16 v[228:231],a[108:111],a[204:207],v[228:231]
 v_mfma_f32_16x16x32_bf16 v[232:235],a[112:115],a[200:203],v[232:235]
 ds_read_b64_tr_b16 a[176:177],v12 offset:32768
 s_add_u32 s50,s50,32768
 v_mfma_f32_16x16x32_bf16 v[232:235],a[116:119],a[204:207],v[232:235]
 ds_read_b64_tr_b16 a[178:179],v12 offset:34816
 v_mfma_f32_16x16x32_bf16 v[236:239],a[120:123],a[200:203],v[236:239]
 v_mfma_f32_16x16x32_bf16 v[236:239],a[124:127],a[204:207],v[236:239]
 s_waitcnt lgkmcnt(8)
 ds_read_b64_tr_b16 a[180:181],v12 offset:49152
 v_mfma_f32_16x16x32_bf16 v[240:243],a[64:67],a[192:195],v[240:243]
 s_cmp_ge_u32 s50,98304
 s_cselect_b32 s50,s51,s50
 v_mfma_f32_16x16x32_bf16 v[240:243],a[68:71],a[196:199],v[240:243]
 ds_read_b64_tr_b16 a[182:183],v12 offset:51200
 ds_read_b128 a[200:203],v4 offset:14336
 v_mfma_f32_16x16x32_bf16 v[244:247],a[72:75],a[192:195],v[244:247]
 ds_read_b64_tr_b16 a[184:185],v13 offset:32768
 v_mfma_f32_16x16x32_bf16 v[244:247],a[76:79],a[196:199],v[244:247]
 ds_read_b128 a[204:207],v5 offset:14336
 ds_read_b64_tr_b16 a[186:187],v13 offset:34816
 v_mfma_f32_16x16x32_bf16 v[248:251],a[80:83],a[192:195],v[248:251]
 v_mfma_f32_16x16x32_bf16 v[248:251],a[84:87],a[196:199],v[248:251]
 ds_read_b64_tr_b16 a[188:189],v13 offset:49152
 v_mfma_f32_16x16x32_bf16 v[252:255],a[88:91],a[192:195],v[252:255]
 ds_read_b64_tr_b16 a[190:191],v13 offset:51200
 v_mfma_f32_16x16x32_bf16 v[252:255],a[92:95],a[196:199],v[252:255]
 v_mfma_f32_16x16x32_bf16 a[208:211],a[96:99],a[192:195],a[208:211]
 v_mfma_f32_16x16x32_bf16 a[208:211],a[100:103],a[196:199],a[208:211]
 s_add_u32 s55,s55,32768
 v_mfma_f32_16x16x32_bf16 a[212:215],a[104:107],a[192:195],a[212:215]
 s_cmp_ge_u32 s55,98304
 s_cselect_b32 s55,s54,s55
 v_mfma_f32_16x16x32_bf16 a[212:215],a[108:111],a[196:199],a[212:215]
 v_add_u32 v4,s55,v2
 v_mfma_f32_16x16x32_bf16 a[216:219],a[112:115],a[192:195],a[216:219]
 v_add_u32 v5,s55,v3
 v_mfma_f32_16x16x32_bf16 a[216:219],a[116:119],a[196:199],a[216:219]
 v_mfma_f32_16x16x32_bf16 a[220:223],a[120:123],a[192:195],a[220:223]
 v_mfma_f32_16x16x32_bf16 a[220:223],a[124:127],a[196:199],a[220:223]
 s_waitcnt vmcnt(16) lgkmcnt(0)
 s_barrier
 v_mfma_f32_16x16x32_bf16 a[224:227],a[64:67],a[200:203],a[224:227]
 ds_read_b128 a[192:195],v4 offset:0
 v_mfma_f32_16x16x32_bf16 a[224:227],a[68:71],a[204:207],a[224:227]
 ds_read_b128 a[196:199],v5 offset:0
 v_mfma_f32_16x16x32_bf16 a[228:231],a[72:75],a[200:203],a[228:231]
 v_mfma_f32_16x16x32_bf16 a[228:231],a[76:79],a[204:207],a[228:231]
 v_mfma_f32_16x16x32_bf16 a[232:235],a[80:83],a[200:203],a[232:235]
 v_mfma_f32_16x16x32_bf16 a[232:235],a[84:87],a[204:207],a[232:235]
 v_mfma_f32_16x16x32_bf16 a[236:239],a[88:91],a[200:203],a[236:239]
 v_mfma_f32_16x16x32_bf16 a[236:239],a[92:95],a[204:207],a[236:239]
 v_mfma_f32_16x16x32_bf16 a[240:243],a[96:99],a[200:203],a[240:243]
 v_mfma_f32_16x16x32_bf16 a[240:243],a[100:103],a[204:207],a[240:243]
 v_mfma_f32_16x16x32_bf16 a[244:247],a[104:107],a[200:203],a[244:247]
 v_mfma_f32_16x16x32_bf16 a[244:247],a[108:111],a[204:207],a[244:247]
 v_mfma_f32_16x16x32_bf16 a[248:251],a[112:115],a[200:203],a[248:251]
 v_mfma_f32_16x16x32_bf16 a[248:251],a[116:119],a[204:207],a[248:251]
 v_mfma_f32_16x16x32_bf16 a[252:255],a[120:123],a[200:203],a[252:255]
 v_mfma_f32_16x16x32_bf16 a[252:255],a[124:127],a[204:207],a[252:255]
 s_waitcnt lgkmcnt(0)
 v_mfma_f32_16x16x32_bf16 v[48:51],a[128:131],a[192:195],v[48:51]
 s_add_u32 m0,s51,131072
 v_mfma_f32_16x16x32_bf16 v[48:51],a[132:135],a[196:199],v[48:51]
 ds_read_b128 a[200:203],v4 offset:2048
 v_mfma_f32_16x16x32_bf16 v[52:55],a[136:139],a[192:195],v[52:55]
 v_mfma_f32_16x16x32_bf16 v[52:55],a[140:143],a[196:199],v[52:55]
 ds_read_b128 a[204:207],v5 offset:2048
 v_mfma_f32_16x16x32_bf16 v[56:59],a[144:147],a[192:195],v[56:59]
 buffer_load_dwordx4 v16,s[16:19],s32 offen offset:0 lds
 v_mfma_f32_16x16x32_bf16 v[56:59],a[148:151],a[196:199],v[56:59]
 v_mfma_f32_16x16x32_bf16 v[60:63],a[152:155],a[192:195],v[60:63]
 v_mfma_f32_16x16x32_bf16 v[60:63],a[156:159],a[196:199],v[60:63]
 buffer_load_dwordx4 v17,s[16:19],s33 offen offset:1024 lds
 v_mfma_f32_16x16x32_bf16 v[64:67],a[160:163],a[192:195],v[64:67]
 v_mfma_f32_16x16x32_bf16 v[64:67],a[164:167],a[196:199],v[64:67]
 v_mfma_f32_16x16x32_bf16 v[68:71],a[168:171],a[192:195],v[68:71]
 v_mfma_f32_16x16x32_bf16 v[68:71],a[172:175],a[196:199],v[68:71]
 buffer_load_dwordx4 v16,s[16:19],s34 offen offset:2048 lds
 v_mfma_f32_16x16x32_bf16 v[72:75],a[176:179],a[192:195],v[72:75]
 v_mfma_f32_16x16x32_bf16 v[72:75],a[180:183],a[196:199],v[72:75]
 v_mfma_f32_16x16x32_bf16 v[76:79],a[184:187],a[192:195],v[76:79]
 v_mfma_f32_16x16x32_bf16 v[76:79],a[188:191],a[196:199],v[76:79]
 s_waitcnt lgkmcnt(0)
 v_mfma_f32_16x16x32_bf16 v[80:83],a[128:131],a[200:203],v[80:83]
 buffer_load_dwordx4 v17,s[16:19],s35 offen offset:3072 lds
 v_mfma_f32_16x16x32_bf16 v[80:83],a[132:135],a[204:207],v[80:83]
 ds_read_b128 a[192:195],v4 offset:4096
 v_mfma_f32_16x16x32_bf16 v[84:87],a[136:139],a[200:203],v[84:87]
 v_mfma_f32_16x16x32_bf16 v[84:87],a[140:143],a[204:207],v[84:87]
 ds_read_b128 a[196:199],v5 offset:4096
 s_add_u32 m0,s51,135168
 v_mfma_f32_16x16x32_bf16 v[88:91],a[144:147],a[200:203],v[88:91]
 v_mfma_f32_16x16x32_bf16 v[88:91],a[148:151],a[204:207],v[88:91]
 v_mfma_f32_16x16x32_bf16 v[92:95],a[152:155],a[200:203],v[92:95]
 v_mfma_f32_16x16x32_bf16 v[92:95],a[156:159],a[204:207],v[92:95]
 buffer_load_dwordx4 v18,s[16:19],s36 offen offset:0 lds
 v_mfma_f32_16x16x32_bf16 v[96:99],a[160:163],a[200:203],v[96:99]
 v_mfma_f32_16x16x32_bf16 v[96:99],a[164:167],a[204:207],v[96:99]
 v_mfma_f32_16x16x32_bf16 v[100:103],a[168:171],a[200:203],v[100:103]
 buffer_load_dwordx4 v19,s[16:19],s37 offen offset:1024 lds
 v_mfma_f32_16x16x32_bf16 v[100:103],a[172:175],a[204:207],v[100:103]
 v_mfma_f32_16x16x32_bf16 v[104:107],a[176:179],a[200:203],v[104:107]
 v_mfma_f32_16x16x32_bf16 v[104:107],a[180:183],a[204:207],v[104:107]
 v_mfma_f32_16x16x32_bf16 v[108:111],a[184:187],a[200:203],v[108:111]
 buffer_load_dwordx4 v18,s[16:19],s38 offen offset:2048 lds
 v_mfma_f32_16x16x32_bf16 v[108:111],a[188:191],a[204:207],v[108:111]
 s_waitcnt lgkmcnt(0)
 v_mfma_f32_16x16x32_bf16 v[112:115],a[128:131],a[192:195],v[112:115]
 v_mfma_f32_16x16x32_bf16 v[112:115],a[132:135],a[196:199],v[112:115]
 ds_read_b128 a[200:203],v4 offset:6144
 v_mfma_f32_16x16x32_bf16 v[116:119],a[136:139],a[192:195],v[116:119]
 buffer_load_dwordx4 v19,s[16:19],s39 offen offset:3072 lds
 v_mfma_f32_16x16x32_bf16 v[116:119],a[140:143],a[196:199],v[116:119]
 ds_read_b128 a[204:207],v5 offset:6144
 v_mfma_f32_16x16x32_bf16 v[120:123],a[144:147],a[192:195],v[120:123]
 v_mfma_f32_16x16x32_bf16 v[120:123],a[148:151],a[196:199],v[120:123]
 v_mfma_f32_16x16x32_bf16 v[124:127],a[152:155],a[192:195],v[124:127]
 s_add_u32 s16,s16,524288
 s_addc_u32 s17,s17,0
 v_mfma_f32_16x16x32_bf16 v[124:127],a[156:159],a[196:199],v[124:127]
 v_mfma_f32_16x16x32_bf16 v[128:131],a[160:163],a[192:195],v[128:131]
 v_mfma_f32_16x16x32_bf16 v[128:131],a[164:167],a[196:199],v[128:131]
 v_mfma_f32_16x16x32_bf16 v[132:135],a[168:171],a[192:195],v[132:135]
 s_sub_u32 s18,s18,524288
 v_mfma_f32_16x16x32_bf16 v[132:135],a[172:175],a[196:199],v[132:135]
 v_mfma_f32_16x16x32_bf16 v[136:139],a[176:179],a[192:195],v[136:139]
 v_mfma_f32_16x16x32_bf16 v[136:139],a[180:183],a[196:199],v[136:139]
 v_mfma_f32_16x16x32_bf16 v[140:143],a[184:187],a[192:195],v[140:143]
 s_add_u32 m0,s50,0
 v_mfma_f32_16x16x32_bf16 v[140:143],a[188:191],a[196:199],v[140:143]
 s_waitcnt lgkmcnt(0)
 v_mfma_f32_16x16x32_bf16 v[144:147],a[128:131],a[200:203],v[144:147]
 v_mfma_f32_16x16x32_bf16 v[144:147],a[132:135],a[204:207],v[144:147]
 ds_read_b128 a[192:195],v4 offset:8192
 v_mfma_f32_16x16x32_bf16 v[148:151],a[136:139],a[200:203],v[148:151]
 buffer_load_dwordx4 v20,s[12:15],s20 offen offset:0 lds
 v_mfma_f32_16x16x32_bf16 v[148:151],a[140:143],a[204:207],v[148:151]
 ds_read_b128 a[196:199],v5 offset:8192
 v_mfma_f32_16x16x32_bf16 v[152:155],a[144:147],a[200:203],v[152:155]
 v_mfma_f32_16x16x32_bf16 v[152:155],a[148:151],a[204:207],v[152:155]
 buffer_load_dwordx4 v21,s[12:15],s21 offen offset:1024 lds
 v_mfma_f32_16x16x32_bf16 v[156:159],a[152:155],a[200:203],v[156:159]
 v_mfma_f32_16x16x32_bf16 v[156:159],a[156:159],a[204:207],v[156:159]
 v_mfma_f32_16x16x32_bf16 v[160:163],a[160:163],a[200:203],v[160:163]
 s_waitcnt vmcnt(18)
 s_barrier
 v_mfma_f32_16x16x32_bf16 v[160:163],a[164:167],a[204:207],v[160:163]
 ds_read_b64_tr_b16 a[64:65],v6 offset:0
 v_mfma_f32_16x16x32_bf16 v[164:167],a[168:171],a[200:203],v[164:167]
 buffer_load_dwordx4 v20,s[12:15],s22 offen offset:2048 lds
 v_mfma_f32_16x16x32_bf16 v[164:167],a[172:175],a[204:207],v[164:167]
 ds_read_b64_tr_b16 a[66:67],v6 offset:2048
 ds_read_b64_tr_b16 a[68:69],v6 offset:16384
 v_mfma_f32_16x16x32_bf16 v[168:171],a[176:179],a[200:203],v[168:171]
 v_mfma_f32_16x16x32_bf16 v[168:171],a[180:183],a[204:207],v[168:171]
 ds_read_b64_tr_b16 a[70:71],v6 offset:18432
 v_mfma_f32_16x16x32_bf16 v[172:175],a[184:187],a[200:203],v[172:175]
 buffer_load_dwordx4 v21,s[12:15],s23 offen offset:3072 lds
 v_mfma_f32_16x16x32_bf16 v[172:175],a[188:191],a[204:207],v[172:175]
 s_waitcnt lgkmcnt(4)
 ds_read_b64_tr_b16 a[72:73],v7 offset:0
 v_mfma_f32_16x16x32_bf16 v[176:179],a[128:131],a[192:195],v[176:179]
 ds_read_b64_tr_b16 a[74:75],v7 offset:2048
 v_mfma_f32_16x16x32_bf16 v[176:179],a[132:135],a[196:199],v[176:179]
 ds_read_b128 a[200:203],v4 offset:10240
 s_add_u32 m0,s50,4096
 v_mfma_f32_16x16x32_bf16 v[180:183],a[136:139],a[192:195],v[180:183]
 ds_read_b64_tr_b16 a[76:77],v7 offset:16384
 v_mfma_f32_16x16x32_bf16 v[180:183],a[140:143],a[196:199],v[180:183]
 ds_read_b128 a[204:207],v5 offset:10240
 ds_read_b64_tr_b16 a[78:79],v7 offset:18432
 v_mfma_f32_16x16x32_bf16 v[184:187],a[144:147],a[192:195],v[184:187]
 ds_read_b64_tr_b16 a[80:81],v8 offset:0
 v_mfma_f32_16x16x32_bf16 v[184:187],a[148:151],a[196:199],v[184:187]
 buffer_load_dwordx4 v20,s[12:15],s24 offen offset:0 lds
 v_mfma_f32_16x16x32_bf16 v[188:191],a[152:155],a[192:195],v[188:191]
 ds_read_b64_tr_b16 a[82:83],v8 offset:2048
 v_mfma_f32_16x16x32_bf16 v[188:191],a[156:159],a[196:199],v[188:191]
 ds_read_b64_tr_b16 a[84:85],v8 offset:16384
 v_mfma_f32_16x16x32_bf16 v[192:195],a[160:163],a[192:195],v[192:195]
 v_mfma_f32_16x16x32_bf16 v[192:195],a[164:167],a[196:199],v[192:195]
 buffer_load_dwordx4 v21,s[12:15],s25 offen offset:1024 lds
 v_mfma_f32_16x16x32_bf16 v[196:199],a[168:171],a[192:195],v[196:199]
 ds_read_b64_tr_b16 a[86:87],v8 offset:18432
 ds_read_b64_tr_b16 a[88:89],v9 offset:0
 v_mfma_f32_16x16x32_bf16 v[196:199],a[172:175],a[196:199],v[196:199]
 v_mfma_f32_16x16x32_bf16 v[200:203],a[176:179],a[192:195],v[200:203]
 ds_read_b64_tr_b16 a[90:91],v9 offset:2048
 v_mfma_f32_16x16x32_bf16 v[200:203],a[180:183],a[196:199],v[200:203]
 buffer_load_dwordx4 v20,s[12:15],s26 offen offset:2048 lds
 v_mfma_f32_16x16x32_bf16 v[204:207],a[184:187],a[192:195],v[204:207]
 ds_read_b64_tr_b16 a[92:93],v9 offset:16384
 v_mfma_f32_16x16x32_bf16 v[204:207],a[188:191],a[196:199],v[204:207]
 s_waitcnt lgkmcnt(8)
 ds_read_b64_tr_b16 a[94:95],v9 offset:18432
 v_mfma_f32_16x16x32_bf16 v[208:211],a[128:131],a[200:203],v[208:211]
 ds_read_b64_tr_b16 a[96:97],v10 offset:0
 v_mfma_f32_16x16x32_bf16 v[208:211],a[132:135],a[204:207],v[208:211]
 buffer_load_dwordx4 v21,s[12:15],s27 offen offset:3072 lds
 v_mfma_f32_16x16x32_bf16 v[212:215],a[136:139],a[200:203],v[212:215]
 ds_read_b128 a[192:195],v4 offset:12288
 ds_read_b64_tr_b16 a[98:99],v10 offset:2048
 v_mfma_f32_16x16x32_bf16 v[212:215],a[140:143],a[204:207],v[212:215]
 ds_read_b128 a[196:199],v5 offset:12288
 ds_read_b64_tr_b16 a[100:101],v10 offset:16384
 v_mfma_f32_16x16x32_bf16 v[216:219],a[144:147],a[200:203],v[216:219]
 s_add_u32 s12,s12,128
 s_addc_u32 s13,s13,0
 v_mfma_f32_16x16x32_bf16 v[216:219],a[148:151],a[204:207],v[216:219]
 ds_read_b64_tr_b16 a[102:103],v10 offset:18432
 v_mfma_f32_16x16x32_bf16 v[220:223],a[152:155],a[200:203],v[220:223]
 ds_read_b64_tr_b16 a[104:105],v11 offset:0
 v_mfma_f32_16x16x32_bf16 v[220:223],a[156:159],a[204:207],v[220:223]
 ds_read_b64_tr_b16 a[106:107],v11 offset:2048
 v_mfma_f32_16x16x32_bf16 v[224:227],a[160:163],a[200:203],v[224:227]
 s_sub_u32 s14,s14,128
 v_mfma_f32_16x16x32_bf16 v[224:227],a[164:167],a[204:207],v[224:227]
 ds_read_b64_tr_b16 a[108:109],v11 offset:16384
 v_mfma_f32_16x16x32_bf16 v[228:231],a[168:171],a[200:203],v[228:231]
 ds_read_b64_tr_b16 a[110:111],v11 offset:18432
 v_mfma_f32_16x16x32_bf16 v[228:231],a[172:175],a[204:207],v[228:231]
 v_mfma_f32_16x16x32_bf16 v[232:235],a[176:179],a[200:203],v[232:235]
 ds_read_b64_tr_b16 a[112:113],v12 offset:0
 s_add_u32 s50,s50,32768
 v_mfma_f32_16x16x32_bf16 v[232:235],a[180:183],a[204:207],v[232:235]
 ds_read_b64_tr_b16 a[114:115],v12 offset:2048
 v_mfma_f32_16x16x32_bf16 v[236:239],a[184:187],a[200:203],v[236:239]
 v_mfma_f32_16x16x32_bf16 v[236:239],a[188:191],a[204:207],v[236:239]
 s_waitcnt lgkmcnt(8)
 ds_read_b64_tr_b16 a[116:117],v12 offset:16384
 v_mfma_f32_16x16x32_bf16 v[240:243],a[128:131],a[192:195],v[240:243]
 s_cmp_ge_u32 s50,98304
 s_cselect_b32 s50,s51,s50
 v_mfma_f32_16x16x32_bf16 v[240:243],a[132:135],a[196:199],v[240:243]
 ds_read_b64_tr_b16 a[118:119],v12 offset:18432
 ds_read_b128 a[200:203],v4 offset:14336
 v_mfma_f32_16x16x32_bf16 v[244:247],a[136:139],a[192:195],v[244:247]
 ds_read_b64_tr_b16 a[120:121],v13 offset:0
 v_mfma_f32_16x16x32_bf16 v[244:247],a[140:143],a[196:199],v[244:247]
 ds_read_b128 a[204:207],v5 offset:14336
 ds_read_b64_tr_b16 a[122:123],v13 offset:2048
 v_mfma_f32_16x16x32_bf16 v[248:251],a[144:147],a[192:195],v[248:251]
 v_mfma_f32_16x16x32_bf16 v[248:251],a[148:151],a[196:199],v[248:251]
 ds_read_b64_tr_b16 a[124:125],v13 offset:16384
 v_mfma_f32_16x16x32_bf16 v[252:255],a[152:155],a[192:195],v[252:255]
 ds_read_b64_tr_b16 a[126:127],v13 offset:18432
 v_mfma_f32_16x16x32_bf16 v[252:255],a[156:159],a[196:199],v[252:255]
 v_mfma_f32_16x16x32_bf16 a[208:211],a[160:163],a[192:195],a[208:211]
 v_mfma_f32_16x16x32_bf16 a[208:211],a[164:167],a[196:199],a[208:211]
 s_add_u32 s55,s55,32768
 v_mfma_f32_16x16x32_bf16 a[212:215],a[168:171],a[192:195],a[212:215]
 s_cmp_ge_u32 s55,98304
 s_cselect_b32 s55,s54,s55
 v_mfma_f32_16x16x32_bf16 a[212:215],a[172:175],a[196:199],a[212:215]
 v_add_u32 v4,s55,v2
 v_mfma_f32_16x16x32_bf16 a[216:219],a[176:179],a[192:195],a[216:219]
 v_add_u32 v5,s55,v3
 v_mfma_f32_16x16x32_bf16 a[216:219],a[180:183],a[196:199],a[216:219]
 v_mfma_f32_16x16x32_bf16 a[220:223],a[184:187],a[192:195],a[220:223]
 v_mfma_f32_16x16x32_bf16 a[220:223],a[188:191],a[196:199],a[220:223]
 s_waitcnt vmcnt(16) lgkmcnt(0)
 s_barrier
 v_mfma_f32_16x16x32_bf16 a[224:227],a[128:131],a[200:203],a[224:227]
 ds_read_b128 a[192:195],v4 offset:0
 v_mfma_f32_16x16x32_bf16 a[224:227],a[132:135],a[204:207],a[224:227]
 ds_read_b128 a[196:199],v5 offset:0
 v_mfma_f32_16x16x32_bf16 a[228:231],a[136:139],a[200:203],a[228:231]
 v_mfma_f32_16x16x32_bf16 a[228:231],a[140:143],a[204:207],a[228:231]
 v_mfma_f32_16x16x32_bf16 a[232:235],a[144:147],a[200:203],a[232:235]
 v_mfma_f32_16x16x32_bf16 a[232:235],a[148:151],a[204:207],a[232:235]
 v_mfma_f32_16x16x32_bf16 a[236:239],a[152:155],a[200:203],a[236:239]
 v_mfma_f32_16x16x32_bf16 a[236:239],a[156:159],a[204:207],a[236:239]
 v_mfma_f32_16x16x32_bf16 a[240:243],a[160:163],a[200:203],a[240:243]
 v_mfma_f32_16x16x32_bf16 a[240:243],a[164:167],a[204:207],a[240:243]
 v_mfma_f32_16x16x32_bf16 a[244:247],a[168:171],a[200:203],a[244:247]
 v_mfma_f32_16x16x32_bf16 a[244:247],a[172:175],a[204:207],a[244:247]
 v_mfma_f32_16x16x32_bf16 a[248:251],a[176:179],a[200:203],a[248:251]
 v_mfma_f32_16x16x32_bf16 a[248:251],a[180:183],a[204:207],a[248:251]
 v_mfma_f32_16x16x32_bf16 a[252:255],a[184:187],a[200:203],a[252:255]
 v_mfma_f32_16x16x32_bf16 a[252:255],a[188:191],a[204:207],a[252:255]
 s_waitcnt lgkmcnt(0)
 v_mfma_f32_16x16x32_bf16 v[48:51],a[64:67],a[192:195],v[48:51]
 s_add_u32 m0,s51,98304
 v_mfma_f32_16x16x32_bf16 v[48:51],a[68:71],a[196:199],v[48:51]
 ds_read_b128 a[200:203],v4 offset:2048
 v_mfma_f32_16x16x32_bf16 v[52:55],a[72:75],a[192:195],v[52:55]
 v_mfma_f32_16x16x32_bf16 v[52:55],a[76:79],a[196:199],v[52:55]
 ds_read_b128 a[204:207],v5 offset:2048
 v_mfma_f32_16x16x32_bf16 v[56:59],a[80:83],a[192:195],v[56:59]
 buffer_load_dwordx4 v16,s[16:19],s32 offen offset:0 lds
 v_mfma_f32_16x16x32_bf16 v[56:59],a[84:87],a[196:199],v[56:59]
 v_mfma_f32_16x16x32_bf16 v[60:63],a[88:91],a[192:195],v[60:63]
 v_mfma_f32_16x16x32_bf16 v[60:63],a[92:95],a[196:199],v[60:63]
 buffer_load_dwordx4 v17,s[16:19],s33 offen offset:1024 lds
 v_mfma_f32_16x16x32_bf16 v[64:67],a[96:99],a[192:195],v[64:67]
 v_mfma_f32_16x16x32_bf16 v[64:67],a[100:103],a[196:199],v[64:67]
 v_mfma_f32_16x16x32_bf16 v[68:71],a[104:107],a[192:195],v[68:71]
 v_mfma_f32_16x16x32_bf16 v[68:71],a[108:111],a[196:199],v[68:71]
 buffer_load_dwordx4 v16,s[16:19],s34 offen offset:2048 lds
 v_mfma_f32_16x16x32_bf16 v[72:75],a[112:115],a[192:195],v[72:75]
 v_mfma_f32_16x16x32_bf16 v[72:75],a[116:119],a[196:199],v[72:75]
 v_mfma_f32_16x16x32_bf16 v[76:79],a[120:123],a[192:195],v[76:79]
 v_mfma_f32_16x16x32_bf16 v[76:79],a[124:127],a[196:199],v[76:79]
 s_waitcnt lgkmcnt(0)
 v_mfma_f32_16x16x32_bf16 v[80:83],a[64:67],a[200:203],v[80:83]
 buffer_load_dwordx4 v17,s[16:19],s35 offen offset:3072 lds
 v_mfma_f32_16x16x32_bf16 v[80:83],a[68:71],a[204:207],v[80:83]
 ds_read_b128 a[192:195],v4 offset:4096
 v_mfma_f32_16x16x32_bf16 v[84:87],a[72:75],a[200:203],v[84:87]
 v_mfma_f32_16x16x32_bf16 v[84:87],a[76:79],a[204:207],v[84:87]
 ds_read_b128 a[196:199],v5 offset:4096
 s_add_u32 m0,s51,102400
 v_mfma_f32_16x16x32_bf16 v[88:91],a[80:83],a[200:203],v[88:91]
 v_mfma_f32_16x16x32_bf16 v[88:91],a[84:87],a[204:207],v[88:91]
 v_mfma_f32_16x16x32_bf16 v[92:95],a[88:91],a[200:203],v[92:95]
 v_mfma_f32_16x16x32_bf16 v[92:95],a[92:95],a[204:207],v[92:95]
 buffer_load_dwordx4 v18,s[16:19],s36 offen offset:0 lds
 v_mfma_f32_16x16x32_bf16 v[96:99],a[96:99],a[200:203],v[96:99]
 v_mfma_f32_16x16x32_bf16 v[96:99],a[100:103],a[204:207],v[96:99]
 v_mfma_f32_16x16x32_bf16 v[100:103],a[104:107],a[200:203],v[100:103]
 buffer_load_dwordx4 v19,s[16:19],s37 offen offset:1024 lds
 v_mfma_f32_16x16x32_bf16 v[100:103],a[108:111],a[204:207],v[100:103]
 v_mfma_f32_16x16x32_bf16 v[104:107],a[112:115],a[200:203],v[104:107]
 v_mfma_f32_16x16x32_bf16 v[104:107],a[116:119],a[204:207],v[104:107]
 v_mfma_f32_16x16x32_bf16 v[108:111],a[120:123],a[200:203],v[108:111]
 buffer_load_dwordx4 v18,s[16:19],s38 offen offset:2048 lds
 v_mfma_f32_16x16x32_bf16 v[108:111],a[124:127],a[204:207],v[108:111]
 s_waitcnt lgkmcnt(0)
 v_mfma_f32_16x16x32_bf16 v[112:115],a[64:67],a[192:195],v[112:115]
 v_mfma_f32_16x16x32_bf16 v[112:115],a[68:71],a[196:199],v[112:115]
 ds_read_b128 a[200:203],v4 offset:6144
 v_mfma_f32_16x16x32_bf16 v[116:119],a[72:75],a[192:195],v[116:119]
 buffer_load_dwordx4 v19,s[16:19],s39 offen offset:3072 lds
 v_mfma_f32_16x16x32_bf16 v[116:119],a[76:79],a[196:199],v[116:119]
 ds_read_b128 a[204:207],v5 offset:6144
 v_mfma_f32_16x16x32_bf16 v[120:123],a[80:83],a[192:195],v[120:123]
 v_mfma_f32_16x16x32_bf16 v[120:123],a[84:87],a[196:199],v[120:123]
 v_mfma_f32_16x16x32_bf16 v[124:127],a[88:91],a[192:195],v[124:127]
 s_add_u32 s16,s16,524288
 s_addc_u32 s17,s17,0
 v_mfma_f32_16x16x32_bf16 v[124:127],a[92:95],a[196:199],v[124:127]
 v_mfma_f32_16x16x32_bf16 v[128:131],a[96:99],a[192:195],v[128:131]
 v_mfma_f32_16x16x32_bf16 v[128:131],a[100:103],a[196:199],v[128:131]
 v_mfma_f32_16x16x32_bf16 v[132:135],a[104:107],a[192:195],v[132:135]
 s_sub_u32 s18,s18,524288
 v_mfma_f32_16x16x32_bf16 v[132:135],a[108:111],a[196:199],v[132:135]
 v_mfma_f32_16x16x32_bf16 v[136:139],a[112:115],a[192:195],v[136:139]
 v_mfma_f32_16x16x32_bf16 v[136:139],a[116:119],a[196:199],v[136:139]
 v_mfma_f32_16x16x32_bf16 v[140:143],a[120:123],a[192:195],v[140:143]
 s_add_u32 m0,s50,0
 v_mfma_f32_16x16x32_bf16 v[140:143],a[124:127],a[196:199],v[140:143]
 s_waitcnt lgkmcnt(0)
 v_mfma_f32_16x16x32_bf16 v[144:147],a[64:67],a[200:203],v[144:147]
 v_mfma_f32_16x16x32_bf16 v[144:147],a[68:71],a[204:207],v[144:147]
 ds_read_b128 a[192:195],v4 offset:8192
 v_mfma_f32_16x16x32_bf16 v[148:151],a[72:75],a[200:203],v[148:151]
 buffer_load_dwordx4 v20,s[12:15],s20 offen offset:0 lds
 v_mfma_f32_16x16x32_bf16 v[148:151],a[76:79],a[204:207],v[148:151]
 ds_read_b128 a[196:199],v5 offset:8192
 v_mfma_f32_16x16x32_bf16 v[152:155],a[80:83],a[200:203],v[152:155]
 v_mfma_f32_16x16x32_bf16 v[152:155],a[84:87],a[204:207],v[152:155]
 buffer_load_dwordx4 v21,s[12:15],s21 offen offset:1024 lds
 v_mfma_f32_16x16x32_bf16 v[156:159],a[88:91],a[200:203],v[156:159]
 v_mfma_f32_16x16x32_bf16 v[156:159],a[92:95],a[204:207],v[156:159]
 v_mfma_f32_16x16x32_bf16 v[160:163],a[96:99],a[200:203],v[160:163]
 s_waitcnt vmcnt(18)
 s_barrier
 v_mfma_f32_16x16x32_bf16 v[160:163],a[100:103],a[204:207],v[160:163]
 ds_read_b64_tr_b16 a[128:129],v6 offset:32768
 v_mfma_f32_16x16x32_bf16 v[164:167],a[104:107],a[200:203],v[164:167]
 buffer_load_dwordx4 v20,s[12:15],s22 offen offset:2048 lds
 v_mfma_f32_16x16x32_bf16 v[164:167],a[108:111],a[204:207],v[164:167]
 ds_read_b64_tr_b16 a[130:131],v6 offset:34816
 ds_read_b64_tr_b16 a[132:133],v6 offset:49152
 v_mfma_f32_16x16x32_bf16 v[168:171],a[112:115],a[200:203],v[168:171]
 v_mfma_f32_16x16x32_bf16 v[168:171],a[116:119],a[204:207],v[168:171]
 ds_read_b64_tr_b16 a[134:135],v6 offset:51200
 v_mfma_f32_16x16x32_bf16 v[172:175],a[120:123],a[200:203],v[172:175]
 buffer_load_dwordx4 v21,s[12:15],s23 offen offset:3072 lds
 v_mfma_f32_16x16x32_bf16 v[172:175],a[124:127],a[204:207],v[172:175]
 s_waitcnt lgkmcnt(4)
 ds_read_b64_tr_b16 a[136:137],v7 offset:32768
 v_mfma_f32_16x16x32_bf16 v[176:179],a[64:67],a[192:195],v[176:179]
 ds_read_b64_tr_b16 a[138:139],v7 offset:34816
 v_mfma_f32_16x16x32_bf16 v[176:179],a[68:71],a[196:199],v[176:179]
 ds_read_b128 a[200:203],v4 offset:10240
 s_add_u32 m0,s50,4096
 v_mfma_f32_16x16x32_bf16 v[180:183],a[72:75],a[192:195],v[180:183]
 ds_read_b64_tr_b16 a[140:141],v7 offset:49152
 v_mfma_f32_16x16x32_bf16 v[180:183],a[76:79],a[196:199],v[180:183]
 ds_read_b128 a[204:207],v5 offset:10240
 ds_read_b64_tr_b16 a[142:143],v7 offset:51200
 v_mfma_f32_16x16x32_bf16 v[184:187],a[80:83],a[192:195],v[184:187]
 ds_read_b64_tr_b16 a[144:145],v8 offset:32768
 v_mfma_f32_16x16x32_bf16 v[184:187],a[84:87],a[196:199],v[184:187]
 buffer_load_dwordx4 v20,s[12:15],s24 offen offset:0 lds
 v_mfma_f32_16x16x32_bf16 v[188:191],a[88:91],a[192:195],v[188:191]
 ds_read_b64_tr_b16 a[146:147],v8 offset:34816
 v_mfma_f32_16x16x32_bf16 v[188:191],a[92:95],a[196:199],v[188:191]
 ds_read_b64_tr_b16 a[148:149],v8 offset:49152
 v_mfma_f32_16x16x32_bf16 v[192:195],a[96:99],a[192:195],v[192:195]
 v_mfma_f32_16x16x32_bf16 v[192:195],a[100:103],a[196:199],v[192:195]
 buffer_load_dwordx4 v21,s[12:15],s25 offen offset:1024 lds
 v_mfma_f32_16x16x32_bf16 v[196:199],a[104:107],a[192:195],v[196:199]
 ds_read_b64_tr_b16 a[150:151],v8 offset:51200
 ds_read_b64_tr_b16 a[152:153],v9 offset:32768
 v_mfma_f32_16x16x32_bf16 v[196:199],a[108:111],a[196:199],v[196:199]
 v_mfma_f32_16x16x32_bf16 v[200:203],a[112:115],a[192:195],v[200:203]
 ds_read_b64_tr_b16 a[154:155],v9 offset:34816
 v_mfma_f32_16x16x32_bf16 v[200:203],a[116:119],a[196:199],v[200:203]
 buffer_load_dwordx4 v20,s[12:15],s26 offen offset:2048 lds
 v_mfma_f32_16x16x32_bf16 v[204:207],a[120:123],a[192:195],v[204:207]
 ds_read_b64_tr_b16 a[156:157],v9 offset:49152
 v_mfma_f32_16x16x32_bf16 v[204:207],a[124:127],a[196:199],v[204:207]
 s_waitcnt lgkmcnt(8)
 ds_read_b64_tr_b16 a[158:159],v9 offset:51200
 v_mfma_f32_16x16x32_bf16 v[208:211],a[64:67],a[200:203],v[208:211]
 ds_read_b64_tr_b16 a[160:161],v10 offset:32768
 v_mfma_f32_16x16x32_bf16 v[208:211],a[68:71],a[204:207],v[208:211]
 buffer_load_dwordx4 v21,s[12:15],s27 offen offset:3072 lds
 v_mfma_f32_16x16x32_bf16 v[212:215],a[72:75],a[200:203],v[212:215]
 ds_read_b128 a[192:195],v4 offset:12288
 ds_read_b64_tr_b16 a[162:163],v10 offset:34816
 v_mfma_f32_16x16x32_bf16 v[212:215],a[76:79],a[204:207],v[212:215]
 buffer_load_dword v24,v38,s[4:7],0 offen
 v_mfma_f32_16x16x32_bf16 v[216:219],a[80:83],a[200:203],v[216:219]
 ds_read_b128 a[196:199],v5 offset:12288
 ds_read_b64_tr_b16 a[164:165],v10 offset:49152
 v_mfma_f32_16x16x32_bf16 v[216:219],a[84:87],a[204:207],v[216:219]
 s_add_u32 s12,s12,128
 s_addc_u32 s13,s13,0
 v_mfma_f32_16x16x32_bf16 v[220:223],a[88:91],a[200:203],v[220:223]
 ds_read_b64_tr_b16 a[166:167],v10 offset:51200
 ds_read_b64_tr_b16 a[168:169],v11 offset:32768
 v_mfma_f32_16x16x32_bf16 v[220:223],a[92:95],a[204:207],v[220:223]
 ds_read_b64_tr_b16 a[170:171],v11 offset:34816
 v_mfma_f32_16x16x32_bf16 v[224:227],a[96:99],a[200:203],v[224:227]
 s_sub_u32 s14,s14,128
 v_mfma_f32_16x16x32_bf16 v[224:227],a[100:103],a[204:207],v[224:227]
 ds_read_b64_tr_b16 a[172:173],v11 offset:49152
 v_mfma_f32_16x16x32_bf16 v[228:231],a[104:107],a[200:203],v[228:231]
 ds_read_b64_tr_b16 a[174:175],v11 offset:51200
 v_mfma_f32_16x16x32_bf16 v[228:231],a[108:111],a[204:207],v[228:231]
 v_mfma_f32_16x16x32_bf16 v[232:235],a[112:115],a[200:203],v[232:235]
 ds_read_b64_tr_b16 a[176:177],v12 offset:32768
 s_add_u32 s50,s50,32768
 v_mfma_f32_16x16x32_bf16 v[232:235],a[116:119],a[204:207],v[232:235]
 ds_read_b64_tr_b16 a[178:179],v12 offset:34816
 v_mfma_f32_16x16x32_bf16 v[236:239],a[120:123],a[200:203],v[236:239]
 v_mfma_f32_16x16x32_bf16 v[236:239],a[124:127],a[204:207],v[236:239]
 s_waitcnt lgkmcnt(8)
 ds_read_b64_tr_b16 a[180:181],v12 offset:49152
 v_mfma_f32_16x16x32_bf16 v[240:243],a[64:67],a[192:195],v[240:243]
 s_cmp_ge_u32 s50,98304
 s_cselect_b32 s50,s51,s50
 v_mfma_f32_16x16x32_bf16 v[240:243],a[68:71],a[196:199],v[240:243]
 ds_read_b64_tr_b16 a[182:183],v12 offset:51200
 ds_read_b128 a[200:203],v4 offset:14336
 v_mfma_f32_16x16x32_bf16 v[244:247],a[72:75],a[192:195],v[244:247]
 ds_read_b64_tr_b16 a[184:185],v13 offset:32768
 v_mfma_f32_16x16x32_bf16 v[244:247],a[76:79],a[196:199],v[244:247]
 ds_read_b128 a[204:207],v5 offset:14336
 ds_read_b64_tr_b16 a[186:187],v13 offset:34816
 v_mfma_f32_16x16x32_bf16 v[248:251],a[80:83],a[192:195],v[248:251]
 v_mfma_f32_16x16x32_bf16 v[248:251],a[84:87],a[196:199],v[248:251]
 ds_read_b64_tr_b16 a[188:189],v13 offset:49152
 v_mfma_f32_16x16x32_bf16 v[252:255],a[88:91],a[192:195],v[252:255]
 ds_read_b64_tr_b16 a[190:191],v13 offset:51200
 v_mfma_f32_16x16x32_bf16 v[252:255],a[92:95],a[196:199],v[252:255]
 v_mfma_f32_16x16x32_bf16 a[208:211],a[96:99],a[192:195],a[208:211]
 v_mfma_f32_16x16x32_bf16 a[208:211],a[100:103],a[196:199],a[208:211]
 s_add_u32 s55,s55,32768
 v_mfma_f32_16x16x32_bf16 a[212:215],a[104:107],a[192:195],a[212:215]
 s_cmp_ge_u32 s55,98304
 s_cselect_b32 s55,s54,s55
 v_mfma_f32_16x16x32_bf16 a[212:215],a[108:111],a[196:199],a[212:215]
 v_add_u32 v4,s55,v2
 v_mfma_f32_16x16x32_bf16 a[216:219],a[112:115],a[192:195],a[216:219]
 v_add_u32 v5,s55,v3
 v_mfma_f32_16x16x32_bf16 a[216:219],a[116:119],a[196:199],a[216:219]
 v_mfma_f32_16x16x32_bf16 a[220:223],a[120:123],a[192:195],a[220:223]
 v_mfma_f32_16x16x32_bf16 a[220:223],a[124:127],a[196:199],a[220:223]
 s_waitcnt vmcnt(17) lgkmcnt(0)
 s_barrier
 v_mfma_f32_16x16x32_bf16 a[224:227],a[64:67],a[200:203],a[224:227]
 ds_read_b128 a[192:195],v4 offset:0
 v_mfma_f32_16x16x32_bf16 a[224:227],a[68:71],a[204:207],a[224:227]
 ds_read_b128 a[196:199],v5 offset:0
 v_mfma_f32_16x16x32_bf16 a[228:231],a[72:75],a[200:203],a[228:231]
 v_mfma_f32_16x16x32_bf16 a[228:231],a[76:79],a[204:207],a[228:231]
 v_mfma_f32_16x16x32_bf16 a[232:235],a[80:83],a[200:203],a[232:235]
 v_mfma_f32_16x16x32_bf16 a[232:235],a[84:87],a[204:207],a[232:235]
 v_mfma_f32_16x16x32_bf16 a[236:239],a[88:91],a[200:203],a[236:239]
 v_mfma_f32_16x16x32_bf16 a[236:239],a[92:95],a[204:207],a[236:239]
 v_mfma_f32_16x16x32_bf16 a[240:243],a[96:99],a[200:203],a[240:243]
 v_mfma_f32_16x16x32_bf16 a[240:243],a[100:103],a[204:207],a[240:243]
 v_mfma_f32_16x16x32_bf16 a[244:247],a[104:107],a[200:203],a[244:247]
 v_mfma_f32_16x16x32_bf16 a[244:247],a[108:111],a[204:207],a[244:247]
 v_mfma_f32_16x16x32_bf16 a[248:251],a[112:115],a[200:203],a[248:251]
 v_mfma_f32_16x16x32_bf16 a[248:251],a[116:119],a[204:207],a[248:251]
 v_mfma_f32_16x16x32_bf16 a[252:255],a[120:123],a[200:203],a[252:255]
 v_mfma_f32_16x16x32_bf16 a[252:255],a[124:127],a[204:207],a[252:255]
 s_waitcnt lgkmcnt(0)
 v_mfma_f32_16x16x32_bf16 v[48:51],a[128:131],a[192:195],v[48:51]
 s_add_u32 m0,s51,131072
 v_mfma_f32_16x16x32_bf16 v[48:51],a[132:135],a[196:199],v[48:51]
 ds_read_b128 a[200:203],v4 offset:2048
 v_mfma_f32_16x16x32_bf16 v[52:55],a[136:139],a[192:195],v[52:55]
 v_mfma_f32_16x16x32_bf16 v[52:55],a[140:143],a[196:199],v[52:55]
 ds_read_b128 a[204:207],v5 offset:2048
 v_mfma_f32_16x16x32_bf16 v[56:59],a[144:147],a[192:195],v[56:59]
 buffer_load_dwordx4 v16,s[16:19],s32 offen offset:0 lds
 v_mfma_f32_16x16x32_bf16 v[56:59],a[148:151],a[196:199],v[56:59]
 v_mfma_f32_16x16x32_bf16 v[60:63],a[152:155],a[192:195],v[60:63]
 v_mfma_f32_16x16x32_bf16 v[60:63],a[156:159],a[196:199],v[60:63]
 buffer_load_dwordx4 v17,s[16:19],s33 offen offset:1024 lds
 v_mfma_f32_16x16x32_bf16 v[64:67],a[160:163],a[192:195],v[64:67]
 v_mfma_f32_16x16x32_bf16 v[64:67],a[164:167],a[196:199],v[64:67]
 v_mfma_f32_16x16x32_bf16 v[68:71],a[168:171],a[192:195],v[68:71]
 v_mfma_f32_16x16x32_bf16 v[68:71],a[172:175],a[196:199],v[68:71]
 buffer_load_dwordx4 v16,s[16:19],s34 offen offset:2048 lds
 v_mfma_f32_16x16x32_bf16 v[72:75],a[176:179],a[192:195],v[72:75]
 v_mfma_f32_16x16x32_bf16 v[72:75],a[180:183],a[196:199],v[72:75]
 v_mfma_f32_16x16x32_bf16 v[76:79],a[184:187],a[192:195],v[76:79]
 v_mfma_f32_16x16x32_bf16 v[76:79],a[188:191],a[196:199],v[76:79]
 s_waitcnt lgkmcnt(0)
 v_mfma_f32_16x16x32_bf16 v[80:83],a[128:131],a[200:203],v[80:83]
 buffer_load_dwordx4 v17,s[16:19],s35 offen offset:3072 lds
 v_mfma_f32_16x16x32_bf16 v[80:83],a[132:135],a[204:207],v[80:83]
 ds_read_b128 a[192:195],v4 offset:4096
 v_mfma_f32_16x16x32_bf16 v[84:87],a[136:139],a[200:203],v[84:87]
 v_mfma_f32_16x16x32_bf16 v[84:87],a[140:143],a[204:207],v[84:87]
 ds_read_b128 a[196:199],v5 offset:4096
 s_add_u32 m0,s51,135168
 v_mfma_f32_16x16x32_bf16 v[88:91],a[144:147],a[200:203],v[88:91]
 v_mfma_f32_16x16x32_bf16 v[88:91],a[148:151],a[204:207],v[88:91]
 v_mfma_f32_16x16x32_bf16 v[92:95],a[152:155],a[200:203],v[92:95]
 v_mfma_f32_16x16x32_bf16 v[92:95],a[156:159],a[204:207],v[92:95]
 buffer_load_dwordx4 v18,s[16:19],s36 offen offset:0 lds
 v_mfma_f32_16x16x32_bf16 v[96:99],a[160:163],a[200:203],v[96:99]
 v_mfma_f32_16x16x32_bf16 v[96:99],a[164:167],a[204:207],v[96:99]
 v_mfma_f32_16x16x32_bf16 v[100:103],a[168:171],a[200:203],v[100:103]
 buffer_load_dwordx4 v19,s[16:19],s37 offen offset:1024 lds
 v_mfma_f32_16x16x32_bf16 v[100:103],a[172:175],a[204:207],v[100:103]
 v_mfma_f32_16x16x32_bf16 v[104:107],a[176:179],a[200:203],v[104:107]
 v_mfma_f32_16x16x32_bf16 v[104:107],a[180:183],a[204:207],v[104:107]
 v_mfma_f32_16x16x32_bf16 v[108:111],a[184:187],a[200:203],v[108:111]
 buffer_load_dwordx4 v18,s[16:19],s38 offen offset:2048 lds
 v_mfma_f32_16x16x32_bf16 v[108:111],a[188:191],a[204:207],v[108:111]
 s_waitcnt lgkmcnt(0)
 v_mfma_f32_16x16x32_bf16 v[112:115],a[128:131],a[192:195],v[112:115]
 v_mfma_f32_16x16x32_bf16 v[112:115],a[132:135],a[196:199],v[112:115]
 ds_read_b128 a[200:203],v4 offset:6144
 v_mfma_f32_16x16x32_bf16 v[116:119],a[136:139],a[192:195],v[116:119]
 buffer_load_dwordx4 v19,s[16:19],s39 offen offset:3072 lds
 v_mfma_f32_16x16x32_bf16 v[116:119],a[140:143],a[196:199],v[116:119]
 ds_read_b128 a[204:207],v5 offset:6144
 v_mfma_f32_16x16x32_bf16 v[120:123],a[144:147],a[192:195],v[120:123]
 v_mfma_f32_16x16x32_bf16 v[120:123],a[148:151],a[196:199],v[120:123]
 v_mfma_f32_16x16x32_bf16 v[124:127],a[152:155],a[192:195],v[124:127]
 s_add_u32 s16,s16,524288
 s_addc_u32 s17,s17,0
 v_mfma_f32_16x16x32_bf16 v[124:127],a[156:159],a[196:199],v[124:127]
 v_mfma_f32_16x16x32_bf16 v[128:131],a[160:163],a[192:195],v[128:131]
 v_mfma_f32_16x16x32_bf16 v[128:131],a[164:167],a[196:199],v[128:131]
 v_mfma_f32_16x16x32_bf16 v[132:135],a[168:171],a[192:195],v[132:135]
 s_sub_u32 s18,s18,524288
 v_mfma_f32_16x16x32_bf16 v[132:135],a[172:175],a[196:199],v[132:135]
 v_mfma_f32_16x16x32_bf16 v[136:139],a[176:179],a[192:195],v[136:139]
 v_mfma_f32_16x16x32_bf16 v[136:139],a[180:183],a[196:199],v[136:139]
 v_mfma_f32_16x16x32_bf16 v[140:143],a[184:187],a[192:195],v[140:143]
 s_add_u32 m0,s50,0
 v_mfma_f32_16x16x32_bf16 v[140:143],a[188:191],a[196:199],v[140:143]
 s_waitcnt lgkmcnt(0)
 v_mfma_f32_16x16x32_bf16 v[144:147],a[128:131],a[200:203],v[144:147]
 v_mfma_f32_16x16x32_bf16 v[144:147],a[132:135],a[204:207],v[144:147]
 ds_read_b128 a[192:195],v4 offset:8192
 v_mfma_f32_16x16x32_bf16 v[148:151],a[136:139],a[200:203],v[148:151]
 buffer_load_dwordx4 v20,s[12:15],s20 offen offset:0 lds
 v_mfma_f32_16x16x32_bf16 v[148:151],a[140:143],a[204:207],v[148:151]
 ds_read_b128 a[196:199],v5 offset:8192
 v_mfma_f32_16x16x32_bf16 v[152:155],a[144:147],a[200:203],v[152:155]
 v_mfma_f32_16x16x32_bf16 v[152:155],a[148:151],a[204:207],v[152:155]
 buffer_load_dwordx4 v21,s[12:15],s21 offen offset:1024 lds
 v_mfma_f32_16x16x32_bf16 v[156:159],a[152:155],a[200:203],v[156:159]
 v_mfma_f32_16x16x32_bf16 v[156:159],a[156:159],a[204:207],v[156:159]
 v_mfma_f32_16x16x32_bf16 v[160:163],a[160:163],a[200:203],v[160:163]
 s_waitcnt vmcnt(19)
 s_barrier
 v_mfma_f32_16x16x32_bf16 v[160:163],a[164:167],a[204:207],v[160:163]
 ds_read_b64_tr_b16 a[64:65],v6 offset:0
 v_mfma_f32_16x16x32_bf16 v[164:167],a[168:171],a[200:203],v[164:167]
 buffer_load_dwordx4 v20,s[12:15],s22 offen offset:2048 lds
 v_mfma_f32_16x16x32_bf16 v[164:167],a[172:175],a[204:207],v[164:167]
 ds_read_b64_tr_b16 a[66:67],v6 offset:2048
 ds_read_b64_tr_b16 a[68:69],v6 offset:16384
 v_mfma_f32_16x16x32_bf16 v[168:171],a[176:179],a[200:203],v[168:171]
 v_mfma_f32_16x16x32_bf16 v[168:171],a[180:183],a[204:207],v[168:171]
 ds_read_b64_tr_b16 a[70:71],v6 offset:18432
 v_mfma_f32_16x16x32_bf16 v[172:175],a[184:187],a[200:203],v[172:175]
 buffer_load_dwordx4 v21,s[12:15],s23 offen offset:3072 lds
 v_mfma_f32_16x16x32_bf16 v[172:175],a[188:191],a[204:207],v[172:175]
 s_waitcnt lgkmcnt(4)
 ds_read_b64_tr_b16 a[72:73],v7 offset:0
 v_mfma_f32_16x16x32_bf16 v[176:179],a[128:131],a[192:195],v[176:179]
 ds_read_b64_tr_b16 a[74:75],v7 offset:2048
 v_mfma_f32_16x16x32_bf16 v[176:179],a[132:135],a[196:199],v[176:179]
 ds_read_b128 a[200:203],v4 offset:10240
 s_add_u32 m0,s50,4096
 v_mfma_f32_16x16x32_bf16 v[180:183],a[136:139],a[192:195],v[180:183]
 ds_read_b64_tr_b16 a[76:77],v7 offset:16384
 v_mfma_f32_16x16x32_bf16 v[180:183],a[140:143],a[196:199],v[180:183]
 ds_read_b128 a[204:207],v5 offset:10240
 ds_read_b64_tr_b16 a[78:79],v7 offset:18432
 v_mfma_f32_16x16x32_bf16 v[184:187],a[144:147],a[192:195],v[184:187]
 ds_read_b64_tr_b16 a[80:81],v8 offset:0
 v_mfma_f32_16x16x32_bf16 v[184:187],a[148:151],a[196:199],v[184:187]
 buffer_load_dwordx4 v20,s[12:15],s24 offen offset:0 lds
 v_mfma_f32_16x16x32_bf16 v[188:191],a[152:155],a[192:195],v[188:191]
 ds_read_b64_tr_b16 a[82:83],v8 offset:2048
 v_mfma_f32_16x16x32_bf16 v[188:191],a[156:159],a[196:199],v[188:191]
 ds_read_b64_tr_b16 a[84:85],v8 offset:16384
 v_mfma_f32_16x16x32_bf16 v[192:195],a[160:163],a[192:195],v[192:195]
 v_mfma_f32_16x16x32_bf16 v[192:195],a[164:167],a[196:199],v[192:195]
 buffer_load_dwordx4 v21,s[12:15],s25 offen offset:1024 lds
 v_mfma_f32_16x16x32_bf16 v[196:199],a[168:171],a[192:195],v[196:199]
 ds_read_b64_tr_b16 a[86:87],v8 offset:18432
 ds_read_b64_tr_b16 a[88:89],v9 offset:0
 v_mfma_f32_16x16x32_bf16 v[196:199],a[172:175],a[196:199],v[196:199]
 v_mfma_f32_16x16x32_bf16 v[200:203],a[176:179],a[192:195],v[200:203]
 ds_read_b64_tr_b16 a[90:91],v9 offset:2048
 v_mfma_f32_16x16x32_bf16 v[200:203],a[180:183],a[196:199],v[200:203]
 buffer_load_dwordx4 v20,s[12:15],s26 offen offset:2048 lds
 v_mfma_f32_16x16x32_bf16 v[204:207],a[184:187],a[192:195],v[204:207]
 ds_read_b64_tr_b16 a[92:93],v9 offset:16384
 v_mfma_f32_16x16x32_bf16 v[204:207],a[188:191],a[196:199],v[204:207]
 s_waitcnt lgkmcnt(8)
 ds_read_b64_tr_b16 a[94:95],v9 offset:18432
 v_mfma_f32_16x16x32_bf16 v[208:211],a[128:131],a[200:203],v[208:211]
 ds_read_b64_tr_b16 a[96:97],v10 offset:0
 v_mfma_f32_16x16x32_bf16 v[208:211],a[132:135],a[204:207],v[208:211]
 buffer_load_dwordx4 v21,s[12:15],s27 offen offset:3072 lds
 v_mfma_f32_16x16x32_bf16 v[212:215],a[136:139],a[200:203],v[212:215]
 ds_read_b128 a[192:195],v4 offset:12288
 ds_read_b64_tr_b16 a[98:99],v10 offset:2048
 v_mfma_f32_16x16x32_bf16 v[212:215],a[140:143],a[204:207],v[212:215]
 ds_read_b128 a[196:199],v5 offset:12288
 ds_read_b64_tr_b16 a[100:101],v10 offset:16384
 v_mfma_f32_16x16x32_bf16 v[216:219],a[144:147],a[200:203],v[216:219]
 s_add_u32 s12,s12,128
 s_addc_u32 s13,s13,0
 v_mfma_f32_16x16x32_bf16 v[216:219],a[148:151],a[204:207],v[216:219]
 ds_read_b64_tr_b16 a[102:103],v10 offset:18432
 v_mfma_f32_16x16x32_bf16 v[220:223],a[152:155],a[200:203],v[220:223]
 ds_read_b64_tr_b16 a[104:105],v11 offset:0
 v_mfma_f32_16x16x32_bf16 v[220:223],a[156:159],a[204:207],v[220:223]
 ds_read_b64_tr_b16 a[106:107],v11 offset:2048
 v_mfma_f32_16x16x32_bf16 v[224:227],a[160:163],a[200:203],v[224:227]
 s_sub_u32 s14,s14,128
 v_mfma_f32_16x16x32_bf16 v[224:227],a[164:167],a[204:207],v[224:227]
 ds_read_b64_tr_b16 a[108:109],v11 offset:16384
 v_mfma_f32_16x16x32_bf16 v[228:231],a[168:171],a[200:203],v[228:231]
 ds_read_b64_tr_b16 a[110:111],v11 offset:18432
 v_mfma_f32_16x16x32_bf16 v[228:231],a[172:175],a[204:207],v[228:231]
 v_mfma_f32_16x16x32_bf16 v[232:235],a[176:179],a[200:203],v[232:235]
 ds_read_b64_tr_b16 a[112:113],v12 offset:0
 s_add_u32 s50,s50,32768
 v_mfma_f32_16x16x32_bf16 v[232:235],a[180:183],a[204:207],v[232:235]
 ds_read_b64_tr_b16 a[114:115],v12 offset:2048
 v_mfma_f32_16x16x32_bf16 v[236:239],a[184:187],a[200:203],v[236:239]
 v_mfma_f32_16x16x32_bf16 v[236:239],a[188:191],a[204:207],v[236:239]
 s_waitcnt lgkmcnt(8)
 ds_read_b64_tr_b16 a[116:117],v12 offset:16384
 v_mfma_f32_16x16x32_bf16 v[240:243],a[128:131],a[192:195],v[240:243]
 s_cmp_ge_u32 s50,98304
 s_cselect_b32 s50,s51,s50
 v_mfma_f32_16x16x32_bf16 v[240:243],a[132:135],a[196:199],v[240:243]
 ds_read_b64_tr_b16 a[118:119],v12 offset:18432
 ds_read_b128 a[200:203],v4 offset:14336
 v_mfma_f32_16x16x32_bf16 v[244:247],a[136:139],a[192:195],v[244:247]
 ds_read_b64_tr_b16 a[120:121],v13 offset:0
 v_mfma_f32_16x16x32_bf16 v[244:247],a[140:143],a[196:199],v[244:247]
 ds_read_b128 a[204:207],v5 offset:14336
 ds_read_b64_tr_b16 a[122:123],v13 offset:2048
 v_mfma_f32_16x16x32_bf16 v[248:251],a[144:147],a[192:195],v[248:251]
 v_mfma_f32_16x16x32_bf16 v[248:251],a[148:151],a[196:199],v[248:251]
 ds_read_b64_tr_b16 a[124:125],v13 offset:16384
 v_mfma_f32_16x16x32_bf16 v[252:255],a[152:155],a[192:195],v[252:255]
 ds_read_b64_tr_b16 a[126:127],v13 offset:18432
 v_mfma_f32_16x16x32_bf16 v[252:255],a[156:159],a[196:199],v[252:255]
 v_mfma_f32_16x16x32_bf16 a[208:211],a[160:163],a[192:195],a[208:211]
 v_mfma_f32_16x16x32_bf16 a[208:211],a[164:167],a[196:199],a[208:211]
 s_add_u32 s55,s55,32768
 v_mfma_f32_16x16x32_bf16 a[212:215],a[168:171],a[192:195],a[212:215]
 s_cmp_ge_u32 s55,98304
 s_cselect_b32 s55,s54,s55
 v_mfma_f32_16x16x32_bf16 a[212:215],a[172:175],a[196:199],a[212:215]
 v_add_u32 v4,s55,v2
 v_mfma_f32_16x16x32_bf16 a[216:219],a[176:179],a[192:195],a[216:219]
 v_add_u32 v5,s55,v3
 v_mfma_f32_16x16x32_bf16 a[216:219],a[180:183],a[196:199],a[216:219]
 v_mfma_f32_16x16x32_bf16 a[220:223],a[184:187],a[192:195],a[220:223]
 v_mfma_f32_16x16x32_bf16 a[220:223],a[188:191],a[196:199],a[220:223]
 s_waitcnt vmcnt(17) lgkmcnt(0)
 s_barrier
 v_mfma_f32_16x16x32_bf16 a[224:227],a[128:131],a[200:203],a[224:227]
 ds_read_b128 a[192:195],v4 offset:0
 v_mfma_f32_16x16x32_bf16 a[224:227],a[132:135],a[204:207],a[224:227]
 ds_read_b128 a[196:199],v5 offset:0
 v_mfma_f32_16x16x32_bf16 a[228:231],a[136:139],a[200:203],a[228:231]
 v_mfma_f32_16x16x32_bf16 a[228:231],a[140:143],a[204:207],a[228:231]
 v_mfma_f32_16x16x32_bf16 a[232:235],a[144:147],a[200:203],a[232:235]
 v_mfma_f32_16x16x32_bf16 a[232:235],a[148:151],a[204:207],a[232:235]
 v_mfma_f32_16x16x32_bf16 a[236:239],a[152:155],a[200:203],a[236:239]
 v_mfma_f32_16x16x32_bf16 a[236:239],a[156:159],a[204:207],a[236:239]
 v_mfma_f32_16x16x32_bf16 a[240:243],a[160:163],a[200:203],a[240:243]
 v_mfma_f32_16x16x32_bf16 a[240:243],a[164:167],a[204:207],a[240:243]
 v_mfma_f32_16x16x32_bf16 a[244:247],a[168:171],a[200:203],a[244:247]
 v_mfma_f32_16x16x32_bf16 a[244:247],a[172:175],a[204:207],a[244:247]
 v_mfma_f32_16x16x32_bf16 a[248:251],a[176:179],a[200:203],a[248:251]
 v_mfma_f32_16x16x32_bf16 a[248:251],a[180:183],a[204:207],a[248:251]
 v_mfma_f32_16x16x32_bf16 a[252:255],a[184:187],a[200:203],a[252:255]
 v_mfma_f32_16x16x32_bf16 a[252:255],a[188:191],a[204:207],a[252:255]
 s_waitcnt lgkmcnt(0)
 v_mfma_f32_16x16x32_bf16 v[48:51],a[64:67],a[192:195],v[48:51]
 s_add_u32 m0,s51,98304
 v_mfma_f32_16x16x32_bf16 v[48:51],a[68:71],a[196:199],v[48:51]
 ds_read_b128 a[200:203],v4 offset:2048
 v_mfma_f32_16x16x32_bf16 v[52:55],a[72:75],a[192:195],v[52:55]
 v_mfma_f32_16x16x32_bf16 v[52:55],a[76:79],a[196:199],v[52:55]
 ds_read_b128 a[204:207],v5 offset:2048
 v_mfma_f32_16x16x32_bf16 v[56:59],a[80:83],a[192:195],v[56:59]
 buffer_load_dwordx4 v16,s[8:11],s32 offen offset:0 lds
 v_mfma_f32_16x16x32_bf16 v[56:59],a[84:87],a[196:199],v[56:59]
 v_mfma_f32_16x16x32_bf16 v[60:63],a[88:91],a[192:195],v[60:63]
 v_mfma_f32_16x16x32_bf16 v[60:63],a[92:95],a[196:199],v[60:63]
 buffer_load_dwordx4 v17,s[8:11],s33 offen offset:1024 lds
 v_mfma_f32_16x16x32_bf16 v[64:67],a[96:99],a[192:195],v[64:67]
 v_mfma_f32_16x16x32_bf16 v[64:67],a[100:103],a[196:199],v[64:67]
 v_mfma_f32_16x16x32_bf16 v[68:71],a[104:107],a[192:195],v[68:71]
 v_mfma_f32_16x16x32_bf16 v[68:71],a[108:111],a[196:199],v[68:71]
 buffer_load_dwordx4 v16,s[8:11],s34 offen offset:2048 lds
 v_mfma_f32_16x16x32_bf16 v[72:75],a[112:115],a[192:195],v[72:75]
 v_mfma_f32_16x16x32_bf16 v[72:75],a[116:119],a[196:199],v[72:75]
 v_mfma_f32_16x16x32_bf16 v[76:79],a[120:123],a[192:195],v[76:79]
 v_mfma_f32_16x16x32_bf16 v[76:79],a[124:127],a[196:199],v[76:79]
 s_waitcnt lgkmcnt(0)
 v_mfma_f32_16x16x32_bf16 v[80:83],a[64:67],a[200:203],v[80:83]
 buffer_load_dwordx4 v17,s[8:11],s35 offen offset:3072 lds
 v_mfma_f32_16x16x32_bf16 v[80:83],a[68:71],a[204:207],v[80:83]
 ds_read_b128 a[192:195],v4 offset:4096
 v_mfma_f32_16x16x32_bf16 v[84:87],a[72:75],a[200:203],v[84:87]
 v_mfma_f32_16x16x32_bf16 v[84:87],a[76:79],a[204:207],v[84:87]
 ds_read_b128 a[196:199],v5 offset:4096
 s_add_u32 m0,s51,102400
 v_mfma_f32_16x16x32_bf16 v[88:91],a[80:83],a[200:203],v[88:91]
 v_mfma_f32_16x16x32_bf16 v[88:91],a[84:87],a[204:207],v[88:91]
 v_mfma_f32_16x16x32_bf16 v[92:95],a[88:91],a[200:203],v[92:95]
 v_mfma_f32_16x16x32_bf16 v[92:95],a[92:95],a[204:207],v[92:95]
 buffer_load_dwordx4 v18,s[8:11],s36 offen offset:0 lds
 v_mfma_f32_16x16x32_bf16 v[96:99],a[96:99],a[200:203],v[96:99]
 v_mfma_f32_16x16x32_bf16 v[96:99],a[100:103],a[204:207],v[96:99]
 v_mfma_f32_16x16x32_bf16 v[100:103],a[104:107],a[200:203],v[100:103]
 buffer_load_dwordx4 v19,s[8:11],s37 offen offset:1024 lds
 v_mfma_f32_16x16x32_bf16 v[100:103],a[108:111],a[204:207],v[100:103]
 v_mfma_f32_16x16x32_bf16 v[104:107],a[112:115],a[200:203],v[104:107]
 v_mfma_f32_16x16x32_bf16 v[104:107],a[116:119],a[204:207],v[104:107]
 v_mfma_f32_16x16x32_bf16 v[108:111],a[120:123],a[200:203],v[108:111]
 buffer_load_dwordx4 v18,s[8:11],s38 offen offset:2048 lds
 v_mfma_f32_16x16x32_bf16 v[108:111],a[124:127],a[204:207],v[108:111]
 s_waitcnt lgkmcnt(0)
 v_mfma_f32_16x16x32_bf16 v[112:115],a[64:67],a[192:195],v[112:115]
 v_mfma_f32_16x16x32_bf16 v[112:115],a[68:71],a[196:199],v[112:115]
 ds_read_b128 a[200:203],v4 offset:6144
 v_mfma_f32_16x16x32_bf16 v[116:119],a[72:75],a[192:195],v[116:119]
 buffer_load_dwordx4 v19,s[8:11],s39 offen offset:3072 lds
 v_mfma_f32_16x16x32_bf16 v[116:119],a[76:79],a[196:199],v[116:119]
 ds_read_b128 a[204:207],v5 offset:6144
 v_mfma_f32_16x16x32_bf16 v[120:123],a[80:83],a[192:195],v[120:123]
 v_mfma_f32_16x16x32_bf16 v[120:123],a[84:87],a[196:199],v[120:123]
 v_mfma_f32_16x16x32_bf16 v[124:127],a[88:91],a[192:195],v[124:127]
 s_add_u32 s8,s8,524288
 s_addc_u32 s9,s9,0
 v_mfma_f32_16x16x32_bf16 v[124:127],a[92:95],a[196:199],v[124:127]
 v_mfma_f32_16x16x32_bf16 v[128:131],a[96:99],a[192:195],v[128:131]
 v_mfma_f32_16x16x32_bf16 v[128:131],a[100:103],a[196:199],v[128:131]
 v_mfma_f32_16x16x32_bf16 v[132:135],a[104:107],a[192:195],v[132:135]
 s_sub_u32 s10,s10,524288
 v_mfma_f32_16x16x32_bf16 v[132:135],a[108:111],a[196:199],v[132:135]
 v_mfma_f32_16x16x32_bf16 v[136:139],a[112:115],a[192:195],v[136:139]
 v_mfma_f32_16x16x32_bf16 v[136:139],a[116:119],a[196:199],v[136:139]
 v_mfma_f32_16x16x32_bf16 v[140:143],a[120:123],a[192:195],v[140:143]
 s_add_u32 m0,s50,0
 v_mfma_f32_16x16x32_bf16 v[140:143],a[124:127],a[196:199],v[140:143]
 s_waitcnt lgkmcnt(0)
 v_mfma_f32_16x16x32_bf16 v[144:147],a[64:67],a[200:203],v[144:147]
 v_mfma_f32_16x16x32_bf16 v[144:147],a[68:71],a[204:207],v[144:147]
 ds_read_b128 a[192:195],v4 offset:8192
 v_mfma_f32_16x16x32_bf16 v[148:151],a[72:75],a[200:203],v[148:151]
 buffer_load_dwordx4 v14,s[4:7],s32 offen offset:0 lds
 v_mfma_f32_16x16x32_bf16 v[148:151],a[76:79],a[204:207],v[148:151]
 ds_read_b128 a[196:199],v5 offset:8192
 v_mfma_f32_16x16x32_bf16 v[152:155],a[80:83],a[200:203],v[152:155]
 v_mfma_f32_16x16x32_bf16 v[152:155],a[84:87],a[204:207],v[152:155]
 buffer_load_dwordx4 v15,s[4:7],s33 offen offset:1024 lds
 v_mfma_f32_16x16x32_bf16 v[156:159],a[88:91],a[200:203],v[156:159]
 v_mfma_f32_16x16x32_bf16 v[156:159],a[92:95],a[204:207],v[156:159]
 v_mfma_f32_16x16x32_bf16 v[160:163],a[96:99],a[200:203],v[160:163]
 s_waitcnt vmcnt(18)
 s_barrier
 v_mfma_f32_16x16x32_bf16 v[160:163],a[100:103],a[204:207],v[160:163]
 ds_read_b64_tr_b16 a[128:129],v6 offset:32768
 v_mfma_f32_16x16x32_bf16 v[164:167],a[104:107],a[200:203],v[164:167]
 buffer_load_dwordx4 v14,s[4:7],s34 offen offset:2048 lds
 v_mfma_f32_16x16x32_bf16 v[164:167],a[108:111],a[204:207],v[164:167]
 ds_read_b64_tr_b16 a[130:131],v6 offset:34816
 ds_read_b64_tr_b16 a[132:133],v6 offset:49152
 v_mfma_f32_16x16x32_bf16 v[168:171],a[112:115],a[200:203],v[168:171]
 v_mfma_f32_16x16x32_bf16 v[168:171],a[116:119],a[204:207],v[168:171]
 ds_read_b64_tr_b16 a[134:135],v6 offset:51200
 v_mfma_f32_16x16x32_bf16 v[172:175],a[120:123],a[200:203],v[172:175]
 buffer_load_dwordx4 v15,s[4:7],s35 offen offset:3072 lds
 v_mfma_f32_16x16x32_bf16 v[172:175],a[124:127],a[204:207],v[172:175]
 s_waitcnt lgkmcnt(4)
 ds_read_b64_tr_b16 a[136:137],v7 offset:32768
 v_mfma_f32_16x16x32_bf16 v[176:179],a[64:67],a[192:195],v[176:179]
 ds_read_b64_tr_b16 a[138:139],v7 offset:34816
 v_mfma_f32_16x16x32_bf16 v[176:179],a[68:71],a[196:199],v[176:179]
 ds_read_b128 a[200:203],v4 offset:10240
 s_add_u32 m0,s50,4096
 v_mfma_f32_16x16x32_bf16 v[180:183],a[72:75],a[192:195],v[180:183]
 ds_read_b64_tr_b16 a[140:141],v7 offset:49152
 v_mfma_f32_16x16x32_bf16 v[180:183],a[76:79],a[196:199],v[180:183]
 ds_read_b128 a[204:207],v5 offset:10240
 ds_read_b64_tr_b16 a[142:143],v7 offset:51200
 v_mfma_f32_16x16x32_bf16 v[184:187],a[80:83],a[192:195],v[184:187]
 ds_read_b64_tr_b16 a[144:145],v8 offset:32768
 v_mfma_f32_16x16x32_bf16 v[184:187],a[84:87],a[196:199],v[184:187]
 buffer_load_dwordx4 v14,s[4:7],s36 offen offset:0 lds
 v_mfma_f32_16x16x32_bf16 v[188:191],a[88:91],a[192:195],v[188:191]
 ds_read_b64_tr_b16 a[146:147],v8 offset:34816
 v_mfma_f32_16x16x32_bf16 v[188:191],a[92:95],a[196:199],v[188:191]
 ds_read_b64_tr_b16 a[148:149],v8 offset:49152
 v_mfma_f32_16x16x32_bf16 v[192:195],a[96:99],a[192:195],v[192:195]
 v_mfma_f32_16x16x32_bf16 v[192:195],a[100:103],a[196:199],v[192:195]
 buffer_load_dwordx4 v15,s[4:7],s37 offen offset:1024 lds
 v_mfma_f32_16x16x32_bf16 v[196:199],a[104:107],a[192:195],v[196:199]
 ds_read_b64_tr_b16 a[150:151],v8 offset:51200
 ds_read_b64_tr_b16 a[152:153],v9 offset:32768
 v_mfma_f32_16x16x32_bf16 v[196:199],a[108:111],a[196:199],v[196:199]
 v_mfma_f32_16x16x32_bf16 v[200:203],a[112:115],a[192:195],v[200:203]
 ds_read_b64_tr_b16 a[154:155],v9 offset:34816
 v_mfma_f32_16x16x32_bf16 v[200:203],a[116:119],a[196:199],v[200:203]
 buffer_load_dwordx4 v14,s[4:7],s38 offen offset:2048 lds
 v_mfma_f32_16x16x32_bf16 v[204:207],a[120:123],a[192:195],v[204:207]
 ds_read_b64_tr_b16 a[156:157],v9 offset:49152
 v_mfma_f32_16x16x32_bf16 v[204:207],a[124:127],a[196:199],v[204:207]
 s_waitcnt lgkmcnt(8)
 ds_read_b64_tr_b16 a[158:159],v9 offset:51200
 v_mfma_f32_16x16x32_bf16 v[208:211],a[64:67],a[200:203],v[208:211]
 ds_read_b64_tr_b16 a[160:161],v10 offset:32768
 v_mfma_f32_16x16x32_bf16 v[208:211],a[68:71],a[204:207],v[208:211]
 buffer_load_dwordx4 v15,s[4:7],s39 offen offset:3072 lds
 v_mfma_f32_16x16x32_bf16 v[212:215],a[72:75],a[200:203],v[212:215]
 ds_read_b128 a[192:195],v4 offset:12288
 ds_read_b64_tr_b16 a[162:163],v10 offset:34816
 v_mfma_f32_16x16x32_bf16 v[212:215],a[76:79],a[204:207],v[212:215]
 ds_read_b128 a[196:199],v5 offset:12288
 ds_read_b64_tr_b16 a[164:165],v10 offset:49152
 v_mfma_f32_16x16x32_bf16 v[216:219],a[80:83],a[200:203],v[216:219]
 s_add_u32 s4,s4,128
 s_addc_u32 s5,s5,0
 v_mfma_f32_16x16x32_bf16 v[216:219],a[84:87],a[204:207],v[216:219]
 ds_read_b64_tr_b16 a[166:167],v10 offset:51200
 v_mfma_f32_16x16x32_bf16 v[220:223],a[88:91],a[200:203],v[220:223]
 ds_read_b64_tr_b16 a[168:169],v11 offset:32768
 v_mfma_f32_16x16x32_bf16 v[220:223],a[92:95],a[204:207],v[220:223]
 ds_read_b64_tr_b16 a[170:171],v11 offset:34816
 v_mfma_f32_16x16x32_bf16 v[224:227],a[96:99],a[200:203],v[224:227]
 s_sub_u32 s6,s6,128
 v_mfma_f32_16x16x32_bf16 v[224:227],a[100:103],a[204:207],v[224:227]
 ds_read_b64_tr_b16 a[172:173],v11 offset:49152
 v_mfma_f32_16x16x32_bf16 v[228:231],a[104:107],a[200:203],v[228:231]
 ds_read_b64_tr_b16 a[174:175],v11 offset:51200
 v_mfma_f32_16x16x32_bf16 v[228:231],a[108:111],a[204:207],v[228:231]
 v_mfma_f32_16x16x32_bf16 v[232:235],a[112:115],a[200:203],v[232:235]
 ds_read_b64_tr_b16 a[176:177],v12 offset:32768
 s_add_u32 s50,s50,32768
 v_mfma_f32_16x16x32_bf16 v[232:235],a[116:119],a[204:207],v[232:235]
 ds_read_b64_tr_b16 a[178:179],v12 offset:34816
 v_mfma_f32_16x16x32_bf16 v[236:239],a[120:123],a[200:203],v[236:239]
 v_mfma_f32_16x16x32_bf16 v[236:239],a[124:127],a[204:207],v[236:239]
 s_waitcnt lgkmcnt(8)
 ds_read_b64_tr_b16 a[180:181],v12 offset:49152
 v_mfma_f32_16x16x32_bf16 v[240:243],a[64:67],a[192:195],v[240:243]
 s_cmp_ge_u32 s50,98304
 s_cselect_b32 s50,s51,s50
 v_mfma_f32_16x16x32_bf16 v[240:243],a[68:71],a[196:199],v[240:243]
 ds_read_b64_tr_b16 a[182:183],v12 offset:51200
 ds_read_b128 a[200:203],v4 offset:14336
 v_mfma_f32_16x16x32_bf16 v[244:247],a[72:75],a[192:195],v[244:247]
 ds_read_b64_tr_b16 a[184:185],v13 offset:32768
 v_mfma_f32_16x16x32_bf16 v[244:247],a[76:79],a[196:199],v[244:247]
 ds_read_b128 a[204:207],v5 offset:14336
 ds_read_b64_tr_b16 a[186:187],v13 offset:34816
 v_mfma_f32_16x16x32_bf16 v[248:251],a[80:83],a[192:195],v[248:251]
 v_mfma_f32_16x16x32_bf16 v[248:251],a[84:87],a[196:199],v[248:251]
 ds_read_b64_tr_b16 a[188:189],v13 offset:49152
 v_mfma_f32_16x16x32_bf16 v[252:255],a[88:91],a[192:195],v[252:255]
 ds_read_b64_tr_b16 a[190:191],v13 offset:51200
 v_mfma_f32_16x16x32_bf16 v[252:255],a[92:95],a[196:199],v[252:255]
 v_mfma_f32_16x16x32_bf16 a[208:211],a[96:99],a[192:195],a[208:211]
 v_mfma_f32_16x16x32_bf16 a[208:211],a[100:103],a[196:199],a[208:211]
 s_add_u32 s55,s55,32768
 v_mfma_f32_16x16x32_bf16 a[212:215],a[104:107],a[192:195],a[212:215]
 s_cmp_ge_u32 s55,98304
 s_cselect_b32 s55,s54,s55
 v_mfma_f32_16x16x32_bf16 a[212:215],a[108:111],a[196:199],a[212:215]
 v_add_u32 v4,s55,v2
 v_mfma_f32_16x16x32_bf16 a[216:219],a[112:115],a[192:195],a[216:219]
 v_add_u32 v5,s55,v3
 v_mfma_f32_16x16x32_bf16 a[216:219],a[116:119],a[196:199],a[216:219]
 v_mfma_f32_16x16x32_bf16 a[220:223],a[120:123],a[192:195],a[220:223]
 v_mfma_f32_16x16x32_bf16 a[220:223],a[124:127],a[196:199],a[220:223]
 s_waitcnt vmcnt(16) lgkmcnt(0)
 s_barrier
 v_mfma_f32_16x16x32_bf16 a[224:227],a[64:67],a[200:203],a[224:227]
 ds_read_b128 a[192:195],v4 offset:0
 v_mfma_f32_16x16x32_bf16 a[224:227],a[68:71],a[204:207],a[224:227]
 ds_read_b128 a[196:199],v5 offset:0
 v_mfma_f32_16x16x32_bf16 a[228:231],a[72:75],a[200:203],a[228:231]
 v_mfma_f32_16x16x32_bf16 a[228:231],a[76:79],a[204:207],a[228:231]
 v_mfma_f32_16x16x32_bf16 a[232:235],a[80:83],a[200:203],a[232:235]
 v_mfma_f32_16x16x32_bf16 a[232:235],a[84:87],a[204:207],a[232:235]
 v_mfma_f32_16x16x32_bf16 a[236:239],a[88:91],a[200:203],a[236:239]
 v_mfma_f32_16x16x32_bf16 a[236:239],a[92:95],a[204:207],a[236:239]
 v_mfma_f32_16x16x32_bf16 a[240:243],a[96:99],a[200:203],a[240:243]
 v_mfma_f32_16x16x32_bf16 a[240:243],a[100:103],a[204:207],a[240:243]
 v_mfma_f32_16x16x32_bf16 a[244:247],a[104:107],a[200:203],a[244:247]
 v_mfma_f32_16x16x32_bf16 a[244:247],a[108:111],a[204:207],a[244:247]
 v_mfma_f32_16x16x32_bf16 a[248:251],a[112:115],a[200:203],a[248:251]
 v_mfma_f32_16x16x32_bf16 a[248:251],a[116:119],a[204:207],a[248:251]
 v_mfma_f32_16x16x32_bf16 a[252:255],a[120:123],a[200:203],a[252:255]
 v_mfma_f32_16x16x32_bf16 a[252:255],a[124:127],a[204:207],a[252:255]
 s_waitcnt lgkmcnt(0)
 v_mov_b32 v26,0
 global_load_dword v34,v26,s[70:71] sc1
 v_mfma_f32_16x16x32_bf16 v[48:51],a[128:131],a[192:195],v[48:51]
 s_add_u32 m0,s51,131072
 v_mfma_f32_16x16x32_bf16 v[48:51],a[132:135],a[196:199],v[48:51]
 ds_read_b128 a[200:203],v4 offset:2048
 v_mfma_f32_16x16x32_bf16 v[52:55],a[136:139],a[192:195],v[52:55]
 v_mfma_f32_16x16x32_bf16 v[52:55],a[140:143],a[196:199],v[52:55]
 ds_read_b128 a[204:207],v5 offset:2048
 v_mfma_f32_16x16x32_bf16 v[56:59],a[144:147],a[192:195],v[56:59]
 buffer_load_dwordx4 v16,s[8:11],s32 offen offset:0 lds
 v_mfma_f32_16x16x32_bf16 v[56:59],a[148:151],a[196:199],v[56:59]
 v_mfma_f32_16x16x32_bf16 v[60:63],a[152:155],a[192:195],v[60:63]
 v_mfma_f32_16x16x32_bf16 v[60:63],a[156:159],a[196:199],v[60:63]
 buffer_load_dwordx4 v17,s[8:11],s33 offen offset:1024 lds
 v_mfma_f32_16x16x32_bf16 v[64:67],a[160:163],a[192:195],v[64:67]
 v_mfma_f32_16x16x32_bf16 v[64:67],a[164:167],a[196:199],v[64:67]
 v_mfma_f32_16x16x32_bf16 v[68:71],a[168:171],a[192:195],v[68:71]
 v_mfma_f32_16x16x32_bf16 v[68:71],a[172:175],a[196:199],v[68:71]
 buffer_load_dwordx4 v16,s[8:11],s34 offen offset:2048 lds
 v_cvt_pk_bf16_f32 v48,v48,v49
 v_mfma_f32_16x16x32_bf16 v[72:75],a[176:179],a[192:195],v[72:75]
 v_cvt_pk_bf16_f32 v49,v50,v51
 s_add_u32 s60,s57,0
 v_cvt_pk_bf16_f32 v50,v52,v53
 v_mfma_f32_16x16x32_bf16 v[72:75],a[180:183],a[196:199],v[72:75]
 v_cvt_pk_bf16_f32 v51,v54,v55
 v_mfma_f32_16x16x32_bf16 v[76:79],a[184:187],a[192:195],v[76:79]
 buffer_store_dwordx4 v[48:51],v1,s[28:31],s60 offen sc1
 v_mfma_f32_16x16x32_bf16 v[76:79],a[188:191],a[196:199],v[76:79]
 s_waitcnt lgkmcnt(0)
 v_cvt_pk_bf16_f32 v56,v56,v57
 v_cvt_pk_bf16_f32 v57,v58,v59
 v_mfma_f32_16x16x32_bf16 v[80:83],a[128:131],a[200:203],v[80:83]
 v_cvt_pk_bf16_f32 v58,v60,v61
 v_cvt_pk_bf16_f32 v59,v62,v63
 v_accvgpr_write_b32 a0,v56
 v_mfma_f32_16x16x32_bf16 v[80:83],a[132:135],a[204:207],v[80:83]
 buffer_load_dwordx4 v17,s[8:11],s35 offen offset:3072 lds
 v_accvgpr_write_b32 a1,v57
 v_mfma_f32_16x16x32_bf16 v[84:87],a[136:139],a[200:203],v[84:87]
 ds_read_b128 a[192:195],v4 offset:4096
 v_accvgpr_write_b32 a2,v58
 v_accvgpr_write_b32 a3,v59
 v_mfma_f32_16x16x32_bf16 v[84:87],a[140:143],a[204:207],v[84:87]
 ds_read_b128 a[196:199],v5 offset:4096
 s_add_u32 m0,s51,135168
 v_cvt_pk_bf16_f32 v64,v64,v65
 v_mfma_f32_16x16x32_bf16 v[88:91],a[144:147],a[200:203],v[88:91]
 v_cvt_pk_bf16_f32 v65,v66,v67
 s_add_u32 s60,s57,2048
 v_cvt_pk_bf16_f32 v66,v68,v69
 v_mfma_f32_16x16x32_bf16 v[88:91],a[148:151],a[204:207],v[88:91]
 v_cvt_pk_bf16_f32 v67,v70,v71
 v_mfma_f32_16x16x32_bf16 v[92:95],a[152:155],a[200:203],v[92:95]
 v_mfma_f32_16x16x32_bf16 v[92:95],a[156:159],a[204:207],v[92:95]
 buffer_load_dwordx4 v18,s[8:11],s36 offen offset:0 lds
 v_mfma_f32_16x16x32_bf16 v[96:99],a[160:163],a[200:203],v[96:99]
 v_mfma_f32_16x16x32_bf16 v[96:99],a[164:167],a[204:207],v[96:99]
 v_mfma_f32_16x16x32_bf16 v[100:103],a[168:171],a[200:203],v[100:103]
 buffer_load_dwordx4 v19,s[8:11],s37 offen offset:1024 lds
 v_mfma_f32_16x16x32_bf16 v[100:103],a[172:175],a[204:207],v[100:103]
 v_mfma_f32_16x16x32_bf16 v[104:107],a[176:179],a[200:203],v[104:107]
 buffer_store_dwordx4 v[64:67],v1,s[28:31],s60 offen sc1
 v_cvt_pk_bf16_f32 v72,v72,v73
 v_mfma_f32_16x16x32_bf16 v[104:107],a[180:183],a[204:207],v[104:107]
 v_cvt_pk_bf16_f32 v73,v74,v75
 v_cvt_pk_bf16_f32 v74,v76,v77
 v_cvt_pk_bf16_f32 v75,v78,v79
 v_mfma_f32_16x16x32_bf16 v[108:111],a[184:187],a[200:203],v[108:111]
 v_accvgpr_write_b32 a4,v72
 v_accvgpr_write_b32 a5,v73
 v_accvgpr_write_b32 a6,v74
 v_mfma_f32_16x16x32_bf16 v[108:111],a[188:191],a[204:207],v[108:111]
 s_waitcnt lgkmcnt(0)
 v_accvgpr_write_b32 a7,v75
 v_cvt_pk_bf16_f32 v80,v80,v81
 v_mfma_f32_16x16x32_bf16 v[112:115],a[128:131],a[192:195],v[112:115]
 buffer_load_dwordx4 v18,s[8:11],s38 offen offset:2048 lds
 v_cvt_pk_bf16_f32 v81,v82,v83
 v_mfma_f32_16x16x32_bf16 v[112:115],a[132:135],a[196:199],v[112:115]
 ds_read_b128 a[200:203],v4 offset:6144
 s_add_u32 s60,s57,8192
 v_cvt_pk_bf16_f32 v82,v84,v85
 v_mfma_f32_16x16x32_bf16 v[116:119],a[136:139],a[192:195],v[116:119]
 buffer_load_dwordx4 v19,s[8:11],s39 offen offset:3072 lds
 v_cvt_pk_bf16_f32 v83,v86,v87
 v_mfma_f32_16x16x32_bf16 v[116:119],a[140:143],a[196:199],v[116:119]
 ds_read_b128 a[204:207],v5 offset:6144
 v_mfma_f32_16x16x32_bf16 v[120:123],a[144:147],a[192:195],v[120:123]
 v_mfma_f32_16x16x32_bf16 v[120:123],a[148:151],a[196:199],v[120:123]
 v_mfma_f32_16x16x32_bf16 v[124:127],a[152:155],a[192:195],v[124:127]
 s_add_u32 s8,s8,524288
 s_addc_u32 s9,s9,0
 v_mfma_f32_16x16x32_bf16 v[124:127],a[156:159],a[196:199],v[124:127]
 v_mfma_f32_16x16x32_bf16 v[128:131],a[160:163],a[192:195],v[128:131]
 v_mfma_f32_16x16x32_bf16 v[128:131],a[164:167],a[196:199],v[128:131]
 v_mfma_f32_16x16x32_bf16 v[132:135],a[168:171],a[192:195],v[132:135]
 buffer_store_dwordx4 v[80:83],v1,s[28:31],s60 offen sc1
 s_sub_u32 s10,s10,524288
 v_mfma_f32_16x16x32_bf16 v[132:135],a[172:175],a[196:199],v[132:135]
 v_cvt_pk_bf16_f32 v88,v88,v89
 v_cvt_pk_bf16_f32 v89,v90,v91
 v_cvt_pk_bf16_f32 v90,v92,v93
 v_mfma_f32_16x16x32_bf16 v[136:139],a[176:179],a[192:195],v[136:139]
 v_cvt_pk_bf16_f32 v91,v94,v95
 v_accvgpr_write_b32 a8,v88
 v_accvgpr_write_b32 a9,v89
 v_mfma_f32_16x16x32_bf16 v[136:139],a[180:183],a[196:199],v[136:139]
 v_accvgpr_write_b32 a10,v90
 v_accvgpr_write_b32 a11,v91
 v_cvt_pk_bf16_f32 v96,v96,v97
 v_mfma_f32_16x16x32_bf16 v[140:143],a[184:187],a[192:195],v[140:143]
 s_add_u32 m0,s50,0
 v_cvt_pk_bf16_f32 v97,v98,v99
 s_add_u32 s60,s57,10240
 v_mfma_f32_16x16x32_bf16 v[140:143],a[188:191],a[196:199],v[140:143]
 s_waitcnt lgkmcnt(0)
 v_cvt_pk_bf16_f32 v98,v100,v101
 v_cvt_pk_bf16_f32 v99,v102,v103
 v_mfma_f32_16x16x32_bf16 v[144:147],a[128:131],a[200:203],v[144:147]
 v_mfma_f32_16x16x32_bf16 v[144:147],a[132:135],a[204:207],v[144:147]
 ds_read_b128 a[192:195],v4 offset:8192
 v_mfma_f32_16x16x32_bf16 v[148:151],a[136:139],a[200:203],v[148:151]
 buffer_load_dwordx4 v14,s[4:7],s32 offen offset:0 lds
 v_mfma_f32_16x16x32_bf16 v[148:151],a[140:143],a[204:207],v[148:151]
 ds_read_b128 a[196:199],v5 offset:8192
 v_mfma_f32_16x16x32_bf16 v[152:155],a[144:147],a[200:203],v[152:155]
 v_mfma_f32_16x16x32_bf16 v[152:155],a[148:151],a[204:207],v[152:155]
 buffer_load_dwordx4 v15,s[4:7],s33 offen offset:1024 lds
 v_mfma_f32_16x16x32_bf16 v[156:159],a[152:155],a[200:203],v[156:159]
 v_mfma_f32_16x16x32_bf16 v[156:159],a[156:159],a[204:207],v[156:159]
 v_mfma_f32_16x16x32_bf16 v[160:163],a[160:163],a[200:203],v[160:163]
 s_waitcnt vmcnt(22)
 s_barrier
 v_mfma_f32_16x16x32_bf16 v[160:163],a[164:167],a[204:207],v[160:163]
 buffer_store_dwordx4 v[96:99],v1,s[28:31],s60 offen sc1
 ds_read_b64_tr_b16 a[64:65],v6 offset:0
 v_mfma_f32_16x16x32_bf16 v[164:167],a[168:171],a[200:203],v[164:167]
 ds_read_b64_tr_b16 a[66:67],v6 offset:2048
 v_cvt_pk_bf16_f32 v104,v104,v105
 v_cvt_pk_bf16_f32 v105,v106,v107
 v_mfma_f32_16x16x32_bf16 v[164:167],a[172:175],a[204:207],v[164:167]
 ds_read_b64_tr_b16 a[68:69],v6 offset:16384
 v_cvt_pk_bf16_f32 v106,v108,v109
 v_cvt_pk_bf16_f32 v107,v110,v111
 v_mfma_f32_16x16x32_bf16 v[168:171],a[176:179],a[200:203],v[168:171]
 buffer_load_dwordx4 v14,s[4:7],s34 offen offset:2048 lds
 v_accvgpr_write_b32 a12,v104
 v_mfma_f32_16x16x32_bf16 v[168:171],a[180:183],a[204:207],v[168:171]
 ds_read_b64_tr_b16 a[70:71],v6 offset:18432
 v_accvgpr_write_b32 a13,v105
 v_accvgpr_write_b32 a14,v106
 v_mfma_f32_16x16x32_bf16 v[172:175],a[184:187],a[200:203],v[172:175]
 buffer_load_dwordx4 v15,s[4:7],s35 offen offset:3072 lds
 v_accvgpr_write_b32 a15,v107
 v_mfma_f32_16x16x32_bf16 v[172:175],a[188:191],a[204:207],v[172:175]
 s_waitcnt lgkmcnt(4)
 ds_read_b64_tr_b16 a[72:73],v7 offset:0
 v_cvt_pk_bf16_f32 v112,v112,v113
 v_mfma_f32_16x16x32_bf16 v[176:179],a[128:131],a[192:195],v[176:179]
 ds_read_b64_tr_b16 a[74:75],v7 offset:2048
 v_cvt_pk_bf16_f32 v113,v114,v115
 s_add_u32 s60,s57,16384
 v_mfma_f32_16x16x32_bf16 v[176:179],a[132:135],a[196:199],v[176:179]
 ds_read_b128 a[200:203],v4 offset:10240
 s_add_u32 m0,s50,4096
 v_cvt_pk_bf16_f32 v114,v116,v117
 v_mfma_f32_16x16x32_bf16 v[180:183],a[136:139],a[192:195],v[180:183]
 ds_read_b64_tr_b16 a[76:77],v7 offset:16384
 v_cvt_pk_bf16_f32 v115,v118,v119
 v_mfma_f32_16x16x32_bf16 v[180:183],a[140:143],a[196:199],v[180:183]
 ds_read_b128 a[204:207],v5 offset:10240
 ds_read_b64_tr_b16 a[78:79],v7 offset:18432
 v_mfma_f32_16x16x32_bf16 v[184:187],a[144:147],a[192:195],v[184:187]
 ds_read_b64_tr_b16 a[80:81],v8 offset:0
 v_mfma_f32_16x16x32_bf16 v[184:187],a[148:151],a[196:199],v[184:187]
 buffer_load_dwordx4 v14,s[4:7],s36 offen offset:0 lds
 v_mfma_f32_16x16x32_bf16 v[188:191],a[152:155],a[192:195],v[188:191]
 buffer_store_dwordx4 v[112:115],v1,s[28:31],s60 offen sc1
 ds_read_b64_tr_b16 a[82:83],v8 offset:2048
 v_mfma_f32_16x16x32_bf16 v[188:191],a[156:159],a[196:199],v[188:191]
 ds_read_b64_tr_b16 a[84:85],v8 offset:16384
 v_cvt_pk_bf16_f32 v120,v120,v121
 v_cvt_pk_bf16_f32 v121,v122,v123
 v_mfma_f32_16x16x32_bf16 v[192:195],a[160:163],a[192:195],v[192:195]
 v_cvt_pk_bf16_f32 v122,v124,v125
 v_cvt_pk_bf16_f32 v123,v126,v127
 v_accvgpr_write_b32 a16,v120
 v_mfma_f32_16x16x32_bf16 v[192:195],a[164:167],a[196:199],v[192:195]
 buffer_load_dwordx4 v15,s[4:7],s37 offen offset:1024 lds
 v_accvgpr_write_b32 a17,v121
 v_mfma_f32_16x16x32_bf16 v[196:199],a[168:171],a[192:195],v[196:199]
 ds_read_b64_tr_b16 a[86:87],v8 offset:18432
 ds_read_b64_tr_b16 a[88:89],v9 offset:0
 v_accvgpr_write_b32 a18,v122
 v_mfma_f32_16x16x32_bf16 v[196:199],a[172:175],a[196:199],v[196:199]
 v_accvgpr_write_b32 a19,v123
 v_cvt_pk_bf16_f32 v128,v128,v129
 v_cvt_pk_bf16_f32 v129,v130,v131
 v_mfma_f32_16x16x32_bf16 v[200:203],a[176:179],a[192:195],v[200:203]
 ds_read_b64_tr_b16 a[90:91],v9 offset:2048
 s_add_u32 s60,s57,18432
 v_cvt_pk_bf16_f32 v130,v132,v133
 v_mfma_f32_16x16x32_bf16 v[200:203],a[180:183],a[196:199],v[200:203]
 buffer_load_dwordx4 v14,s[4:7],s38 offen offset:2048 lds
 v_cvt_pk_bf16_f32 v131,v134,v135
 v_mfma_f32_16x16x32_bf16 v[204:207],a[184:187],a[192:195],v[204:207]
 ds_read_b64_tr_b16 a[92:93],v9 offset:16384
 v_mfma_f32_16x16x32_bf16 v[204:207],a[188:191],a[196:199],v[204:207]
 s_waitcnt lgkmcnt(8)
 ds_read_b64_tr_b16 a[94:95],v9 offset:18432
 v_mfma_f32_16x16x32_bf16 v[208:211],a[128:131],a[200:203],v[208:211]
 ds_read_b64_tr_b16 a[96:97],v10 offset:0
 v_mfma_f32_16x16x32_bf16 v[208:211],a[132:135],a[204:207],v[208:211]
 buffer_load_dwordx4 v15,s[4:7],s39 offen offset:3072 lds
 v_mfma_f32_16x16x32_bf16 v[212:215],a[136:139],a[200:203],v[212:215]
 ds_read_b128 a[192:195],v4 offset:12288
 ds_read_b64_tr_b16 a[98:99],v10 offset:2048
 v_mfma_f32_16x16x32_bf16 v[212:215],a[140:143],a[204:207],v[212:215]
 ds_read_b128 a[196:199],v5 offset:12288
 ds_read_b64_tr_b16 a[100:101],v10 offset:16384
 v_mfma_f32_16x16x32_bf16 v[216:219],a[144:147],a[200:203],v[216:219]
 s_add_u32 s4,s4,128
 s_addc_u32 s5,s5,0
 v_mfma_f32_16x16x32_bf16 v[216:219],a[148:151],a[204:207],v[216:219]
 buffer_store_dwordx4 v[128:131],v1,s[28:31],s60 offen sc1
 ds_read_b64_tr_b16 a[102:103],v10 offset:18432
 v_mfma_f32_16x16x32_bf16 v[220:223],a[152:155],a[200:203],v[220:223]
 ds_read_b64_tr_b16 a[104:105],v11 offset:0
 v_cvt_pk_bf16_f32 v136,v136,v137
 v_cvt_pk_bf16_f32 v137,v138,v139
 v_mfma_f32_16x16x32_bf16 v[220:223],a[156:159],a[204:207],v[220:223]
 ds_read_b64_tr_b16 a[106:107],v11 offset:2048
 v_cvt_pk_bf16_f32 v138,v140,v141
 v_cvt_pk_bf16_f32 v139,v142,v143
 v_mfma_f32_16x16x32_bf16 v[224:227],a[160:163],a[200:203],v[224:227]
 s_sub_u32 s6,s6,128
 v_accvgpr_write_b32 a20,v136
 v_accvgpr_write_b32 a21,v137
 v_mfma_f32_16x16x32_bf16 v[224:227],a[164:167],a[204:207],v[224:227]
 ds_read_b64_tr_b16 a[108:109],v11 offset:16384
 v_accvgpr_write_b32 a22,v138
 v_accvgpr_write_b32 a23,v139
 v_mfma_f32_16x16x32_bf16 v[228:231],a[168:171],a[200:203],v[228:231]
 ds_read_b64_tr_b16 a[110:111],v11 offset:18432
 v_cvt_pk_bf16_f32 v144,v144,v145
 v_cvt_pk_bf16_f32 v145,v146,v147
 v_mfma_f32_16x16x32_bf16 v[228:231],a[172:175],a[204:207],v[228:231]
 s_add_u32 s60,s57,24576
 v_cvt_pk_bf16_f32 v146,v148,v149
 v_cvt_pk_bf16_f32 v147,v150,v151
 v_mfma_f32_16x16x32_bf16 v[232:235],a[176:179],a[200:203],v[232:235]
 ds_read_b64_tr_b16 a[112:113],v12 offset:0
 s_add_u32 s50,s50,32768
 v_mfma_f32_16x16x32_bf16 v[232:235],a[180:183],a[204:207],v[232:235]
 ds_read_b64_tr_b16 a[114:115],v12 offset:2048
 v_mfma_f32_16x16x32_bf16 v[236:239],a[184:187],a[200:203],v[236:239]
 v_mfma_f32_16x16x32_bf16 v[236:239],a[188:191],a[204:207],v[236:239]
 s_waitcnt lgkmcnt(8)
 ds_read_b64_tr_b16 a[116:117],v12 offset:16384
 v_mfma_f32_16x16x32_bf16 v[240:243],a[128:131],a[192:195],v[240:243]
 s_cmp_ge_u32 s50,98304
 s_cselect_b32 s50,s51,s50
 v_mfma_f32_16x16x32_bf16 v[240:243],a[132:135],a[196:199],v[240:243]
 ds_read_b64_tr_b16 a[118:119],v12 offset:18432
 ds_read_b128 a[200:203],v4 offset:14336
 v_mfma_f32_16x16x32_bf16 v[244:247],a[136:139],a[192:195],v[244:247]
 buffer_store_dwordx4 v[144:147],v1,s[28:31],s60 offen sc1
 ds_read_b64_tr_b16 a[120:121],v13 offset:0
 v_mfma_f32_16x16x32_bf16 v[244:247],a[140:143],a[196:199],v[244:247]
 ds_read_b128 a[204:207],v5 offset:14336
 ds_read_b64_tr_b16 a[122:123],v13 offset:2048
 v_cvt_pk_bf16_f32 v152,v152,v153
 v_mfma_f32_16x16x32_bf16 v[248:251],a[144:147],a[192:195],v[248:251]
 v_cvt_pk_bf16_f32 v153,v154,v155
 v_cvt_pk_bf16_f32 v154,v156,v157
 v_cvt_pk_bf16_f32 v155,v158,v159
 v_mfma_f32_16x16x32_bf16 v[248:251],a[148:151],a[196:199],v[248:251]
 ds_read_b64_tr_b16 a[124:125],v13 offset:16384
 v_accvgpr_write_b32 a24,v152
 v_accvgpr_write_b32 a25,v153
 v_mfma_f32_16x16x32_bf16 v[252:255],a[152:155],a[192:195],v[252:255]
 ds_read_b64_tr_b16 a[126:127],v13 offset:18432
 v_accvgpr_write_b32 a26,v154
 v_accvgpr_write_b32 a27,v155
 v_mfma_f32_16x16x32_bf16 v[252:255],a[156:159],a[196:199],v[252:255]
 v_cvt_pk_bf16_f32 v160,v160,v161
 v_cvt_pk_bf16_f32 v161,v162,v163
 s_add_u32 s60,s57,26624
 v_mfma_f32_16x16x32_bf16 a[208:211],a[160:163],a[192:195],a[208:211]
 v_cvt_pk_bf16_f32 v162,v164,v165
 v_cvt_pk_bf16_f32 v163,v166,v167
 v_mfma_f32_16x16x32_bf16 a[208:211],a[164:167],a[196:199],a[208:211]
 s_add_u32 s55,s55,32768
 v_mfma_f32_16x16x32_bf16 a[212:215],a[168:171],a[192:195],a[212:215]
 s_cmp_ge_u32 s55,98304
 s_cselect_b32 s55,s54,s55
 v_mfma_f32_16x16x32_bf16 a[212:215],a[172:175],a[196:199],a[212:215]
 v_add_u32 v4,s55,v2
 v_mfma_f32_16x16x32_bf16 a[216:219],a[176:179],a[192:195],a[216:219]
 v_add_u32 v5,s55,v3
 v_mfma_f32_16x16x32_bf16 a[216:219],a[180:183],a[196:199],a[216:219]
 v_mfma_f32_16x16x32_bf16 a[220:223],a[184:187],a[192:195],a[220:223]
 v_mfma_f32_16x16x32_bf16 a[220:223],a[188:191],a[196:199],a[220:223]
 s_waitcnt vmcnt(24) lgkmcnt(0)
 s_barrier
 v_mfma_f32_16x16x32_bf16 a[224:227],a[128:131],a[200:203],a[224:227]
 buffer_store_dwordx4 v[160:163],v1,s[28:31],s60 offen sc1
 ds_read_b128 a[192:195],v4 offset:0
 v_mfma_f32_16x16x32_bf16 a[224:227],a[132:135],a[204:207],a[224:227]
 ds_read_b128 a[196:199],v5 offset:0
 v_cvt_pk_bf16_f32 v168,v168,v169
 v_cvt_pk_bf16_f32 v169,v170,v171
 v_mfma_f32_16x16x32_bf16 a[228:231],a[136:139],a[200:203],a[228:231]
 v_cvt_pk_bf16_f32 v170,v172,v173
 v_cvt_pk_bf16_f32 v171,v174,v175
 v_accvgpr_write_b32 a28,v168
 v_mfma_f32_16x16x32_bf16 a[228:231],a[140:143],a[204:207],a[228:231]
 v_accvgpr_write_b32 a29,v169
 v_accvgpr_write_b32 a30,v170
 v_accvgpr_write_b32 a31,v171
 v_mfma_f32_16x16x32_bf16 a[232:235],a[144:147],a[200:203],a[232:235]
 v_cvt_pk_bf16_f32 v176,v176,v177
 v_cvt_pk_bf16_f32 v177,v178,v179
 s_add_u32 s60,s57,32768
 v_mfma_f32_16x16x32_bf16 a[232:235],a[148:151],a[204:207],a[232:235]
 v_cvt_pk_bf16_f32 v178,v180,v181
 v_cvt_pk_bf16_f32 v179,v182,v183
 v_mfma_f32_16x16x32_bf16 a[236:239],a[152:155],a[200:203],a[236:239]
 v_mfma_f32_16x16x32_bf16 a[236:239],a[156:159],a[204:207],a[236:239]
 v_mfma_f32_16x16x32_bf16 a[240:243],a[160:163],a[200:203],a[240:243]
 v_mfma_f32_16x16x32_bf16 a[240:243],a[164:167],a[204:207],a[240:243]
 v_mfma_f32_16x16x32_bf16 a[244:247],a[168:171],a[200:203],a[244:247]
 v_mfma_f32_16x16x32_bf16 a[244:247],a[172:175],a[204:207],a[244:247]
 v_mfma_f32_16x16x32_bf16 a[248:251],a[176:179],a[200:203],a[248:251]
 v_mfma_f32_16x16x32_bf16 a[248:251],a[180:183],a[204:207],a[248:251]
 v_mfma_f32_16x16x32_bf16 a[252:255],a[184:187],a[200:203],a[252:255]
 buffer_store_dwordx4 v[176:179],v1,s[28:31],s60 offen sc1
 v_cvt_pk_bf16_f32 v184,v184,v185
 v_mfma_f32_16x16x32_bf16 a[252:255],a[188:191],a[204:207],a[252:255]
 s_waitcnt lgkmcnt(0)
 v_cvt_pk_bf16_f32 v185,v186,v187
 v_cvt_pk_bf16_f32 v186,v188,v189
 s_bitcmp1_b32 s47,0
 s_cbranch_scc1 G2_V
 v_mfma_f32_16x16x32_bf16 v[48:51],a[64:67],a[192:195],0
 s_add_u32 m0,s51,98304
 v_cvt_pk_bf16_f32 v187,v190,v191
 v_accvgpr_write_b32 a32,v184
 v_mfma_f32_16x16x32_bf16 v[48:51],a[68:71],a[196:199],v[48:51]
 ds_read_b128 a[200:203],v4 offset:2048
 v_accvgpr_write_b32 a33,v185
 v_accvgpr_write_b32 a34,v186
 v_mfma_f32_16x16x32_bf16 v[52:55],a[72:75],a[192:195],0
 v_accvgpr_write_b32 a35,v187
 v_cvt_pk_bf16_f32 v192,v192,v193
 v_cvt_pk_bf16_f32 v193,v194,v195
 v_mfma_f32_16x16x32_bf16 v[52:55],a[76:79],a[196:199],v[52:55]
 ds_read_b128 a[204:207],v5 offset:2048
 s_add_u32 s60,s57,34816
 v_cvt_pk_bf16_f32 v194,v196,v197
 v_mfma_f32_16x16x32_bf16 v[56:59],a[80:83],a[192:195],0
 buffer_load_dwordx4 v16,s[8:11],s32 offen offset:0 lds
 v_cvt_pk_bf16_f32 v195,v198,v199
 v_mfma_f32_16x16x32_bf16 v[56:59],a[84:87],a[196:199],v[56:59]
 v_mfma_f32_16x16x32_bf16 v[60:63],a[88:91],a[192:195],0
 v_mfma_f32_16x16x32_bf16 v[60:63],a[92:95],a[196:199],v[60:63]
 buffer_load_dwordx4 v17,s[8:11],s33 offen offset:1024 lds
 v_mfma_f32_16x16x32_bf16 v[64:67],a[96:99],a[192:195],0
 v_mfma_f32_16x16x32_bf16 v[64:67],a[100:103],a[196:199],v[64:67]
 v_mfma_f32_16x16x32_bf16 v[68:71],a[104:107],a[192:195],0
 v_mfma_f32_16x16x32_bf16 v[68:71],a[108:111],a[196:199],v[68:71]
 buffer_load_dwordx4 v16,s[8:11],s34 offen offset:2048 lds
 v_mfma_f32_16x16x32_bf16 v[72:75],a[112:115],a[192:195],0
 buffer_store_dwordx4 v[192:195],v1,s[28:31],s60 offen sc1
 v_cvt_pk_bf16_f32 v200,v200,v201
 v_mfma_f32_16x16x32_bf16 v[72:75],a[116:119],a[196:199],v[72:75]
 v_cvt_pk_bf16_f32 v201,v202,v203
 v_cvt_pk_bf16_f32 v202,v204,v205
 v_cvt_pk_bf16_f32 v203,v206,v207
 v_mfma_f32_16x16x32_bf16 v[76:79],a[120:123],a[192:195],0
 v_accvgpr_write_b32 a36,v200
 v_accvgpr_write_b32 a37,v201
 v_accvgpr_write_b32 a38,v202
 v_mfma_f32_16x16x32_bf16 v[76:79],a[124:127],a[196:199],v[76:79]
 s_waitcnt lgkmcnt(0)
 v_accvgpr_write_b32 a39,v203
 v_cvt_pk_bf16_f32 v208,v208,v209
 v_mfma_f32_16x16x32_bf16 v[80:83],a[64:67],a[200:203],0
 buffer_load_dwordx4 v17,s[8:11],s35 offen offset:3072 lds
 v_cvt_pk_bf16_f32 v209,v210,v211
 v_mfma_f32_16x16x32_bf16 v[80:83],a[68:71],a[204:207],v[80:83]
 ds_read_b128 a[192:195],v4 offset:4096
 s_add_u32 s60,s57,40960
 v_cvt_pk_bf16_f32 v210,v212,v213
 v_mfma_f32_16x16x32_bf16 v[84:87],a[72:75],a[200:203],0
 v_cvt_pk_bf16_f32 v211,v214,v215
 v_mfma_f32_16x16x32_bf16 v[84:87],a[76:79],a[204:207],v[84:87]
 ds_read_b128 a[196:199],v5 offset:4096
 s_add_u32 m0,s51,102400
 v_mfma_f32_16x16x32_bf16 v[88:91],a[80:83],a[200:203],0
 v_mfma_f32_16x16x32_bf16 v[88:91],a[84:87],a[204:207],v[88:91]
 v_mfma_f32_16x16x32_bf16 v[92:95],a[88:91],a[200:203],0
 v_mfma_f32_16x16x32_bf16 v[92:95],a[92:95],a[204:207],v[92:95]
 buffer_load_dwordx4 v18,s[8:11],s36 offen offset:0 lds
 v_mfma_f32_16x16x32_bf16 v[96:99],a[96:99],a[200:203],0
 v_mfma_f32_16x16x32_bf16 v[96:99],a[100:103],a[204:207],v[96:99]
 v_mfma_f32_16x16x32_bf16 v[100:103],a[104:107],a[200:203],0
 buffer_load_dwordx4 v19,s[8:11],s37 offen offset:1024 lds
 v_mfma_f32_16x16x32_bf16 v[100:103],a[108:111],a[204:207],v[100:103]
 buffer_store_dwordx4 v[208:211],v1,s[28:31],s60 offen sc1
 v_cvt_pk_bf16_f32 v216,v216,v217
 v_mfma_f32_16x16x32_bf16 v[104:107],a[112:115],a[200:203],0
 v_cvt_pk_bf16_f32 v217,v218,v219
 v_cvt_pk_bf16_f32 v218,v220,v221
 v_cvt_pk_bf16_f32 v219,v222,v223
 v_mfma_f32_16x16x32_bf16 v[104:107],a[116:119],a[204:207],v[104:107]
 v_accvgpr_write_b32 a40,v216
 v_accvgpr_write_b32 a41,v217
 v_accvgpr_write_b32 a42,v218
 v_mfma_f32_16x16x32_bf16 v[108:111],a[120:123],a[200:203],0
 buffer_load_dwordx4 v18,s[8:11],s38 offen offset:2048 lds
 v_accvgpr_write_b32 a43,v219
 v_mfma_f32_16x16x32_bf16 v[108:111],a[124:127],a[204:207],v[108:111]
 s_waitcnt lgkmcnt(0)
 v_cvt_pk_bf16_f32 v224,v224,v225
 v_cvt_pk_bf16_f32 v225,v226,v227
 v_mfma_f32_16x16x32_bf16 v[112:115],a[64:67],a[192:195],0
 s_add_u32 s60,s57,43008
 v_cvt_pk_bf16_f32 v226,v228,v229
 v_cvt_pk_bf16_f32 v227,v230,v231
 v_mfma_f32_16x16x32_bf16 v[112:115],a[68:71],a[196:199],v[112:115]
 ds_read_b128 a[200:203],v4 offset:6144
 v_mfma_f32_16x16x32_bf16 v[116:119],a[72:75],a[192:195],0
 buffer_load_dwordx4 v19,s[8:11],s39 offen offset:3072 lds
 v_mfma_f32_16x16x32_bf16 v[116:119],a[76:79],a[196:199],v[116:119]
 ds_read_b128 a[204:207],v5 offset:6144
 v_mfma_f32_16x16x32_bf16 v[120:123],a[80:83],a[192:195],0
 v_mfma_f32_16x16x32_bf16 v[120:123],a[84:87],a[196:199],v[120:123]
 v_mfma_f32_16x16x32_bf16 v[124:127],a[88:91],a[192:195],0
 s_add_u32 s8,s8,524288
 s_addc_u32 s9,s9,0
 v_mfma_f32_16x16x32_bf16 v[124:127],a[92:95],a[196:199],v[124:127]
 v_mfma_f32_16x16x32_bf16 v[128:131],a[96:99],a[192:195],0
 buffer_store_dwordx4 v[224:227],v1,s[28:31],s60 offen sc1
 v_cvt_pk_bf16_f32 v232,v232,v233
 v_mfma_f32_16x16x32_bf16 v[128:131],a[100:103],a[196:199],v[128:131]
 v_cvt_pk_bf16_f32 v233,v234,v235
 v_cvt_pk_bf16_f32 v234,v236,v237
 v_cvt_pk_bf16_f32 v235,v238,v239
 v_mfma_f32_16x16x32_bf16 v[132:135],a[104:107],a[192:195],0
 s_sub_u32 s10,s10,524288
 v_accvgpr_write_b32 a44,v232
 v_accvgpr_write_b32 a45,v233
 v_mfma_f32_16x16x32_bf16 v[132:135],a[108:111],a[196:199],v[132:135]
 v_accvgpr_write_b32 a46,v234
 v_accvgpr_write_b32 a47,v235
 v_cvt_pk_bf16_f32 v240,v240,v241
 v_mfma_f32_16x16x32_bf16 v[136:139],a[112:115],a[192:195],0
 v_cvt_pk_bf16_f32 v241,v242,v243
 s_add_u32 s60,s57,49152
 v_cvt_pk_bf16_f32 v242,v244,v245
 v_mfma_f32_16x16x32_bf16 v[136:139],a[116:119],a[196:199],v[136:139]
 v_cvt_pk_bf16_f32 v243,v246,v247
 v_mfma_f32_16x16x32_bf16 v[140:143],a[120:123],a[192:195],0
 s_add_u32 m0,s50,0
 v_mfma_f32_16x16x32_bf16 v[140:143],a[124:127],a[196:199],v[140:143]
 s_waitcnt lgkmcnt(0)
 v_mfma_f32_16x16x32_bf16 v[144:147],a[64:67],a[200:203],0
 v_mfma_f32_16x16x32_bf16 v[144:147],a[68:71],a[204:207],v[144:147]
 ds_read_b128 a[192:195],v4 offset:8192
 v_mfma_f32_16x16x32_bf16 v[148:151],a[72:75],a[200:203],0
 buffer_load_dwordx4 v14,s[4:7],s32 offen offset:0 lds
 v_mfma_f32_16x16x32_bf16 v[148:151],a[76:79],a[204:207],v[148:151]
 ds_read_b128 a[196:199],v5 offset:8192
 v_mfma_f32_16x16x32_bf16 v[152:155],a[80:83],a[200:203],0
 v_mfma_f32_16x16x32_bf16 v[152:155],a[84:87],a[204:207],v[152:155]
 buffer_load_dwordx4 v15,s[4:7],s33 offen offset:1024 lds
 v_mfma_f32_16x16x32_bf16 v[156:159],a[88:91],a[200:203],0
 buffer_store_dwordx4 v[240:243],v1,s[28:31],s60 offen sc1
 v_cvt_pk_bf16_f32 v248,v248,v249
 v_mfma_f32_16x16x32_bf16 v[156:159],a[92:95],a[204:207],v[156:159]
 v_cvt_pk_bf16_f32 v249,v250,v251
 v_cvt_pk_bf16_f32 v250,v252,v253
 v_cvt_pk_bf16_f32 v251,v254,v255
 v_mfma_f32_16x16x32_bf16 v[160:163],a[96:99],a[200:203],0
 s_waitcnt vmcnt(29)
 s_barrier
 v_accvgpr_write_b32 a48,v248
 v_mfma_f32_16x16x32_bf16 v[160:163],a[100:103],a[204:207],v[160:163]
 ds_read_b64_tr_b16 a[128:129],v6 offset:32768
 v_accvgpr_write_b32 a49,v249
 v_accvgpr_write_b32 a50,v250
 v_mfma_f32_16x16x32_bf16 v[164:167],a[104:107],a[200:203],0
 buffer_load_dwordx4 v14,s[4:7],s34 offen offset:2048 lds
 v_accvgpr_write_b32 a51,v251
 v_mfma_f32_16x16x32_bf16 v[164:167],a[108:111],a[204:207],v[164:167]
 ds_read_b64_tr_b16 a[130:131],v6 offset:34816
 ds_read_b64_tr_b16 a[132:133],v6 offset:49152
 s_nop 1
 v_mfma_f32_16x16x32_bf16 v[168:171],a[112:115],a[200:203],0
 v_accvgpr_read_b32 v40,a208
 v_accvgpr_read_b32 v41,a209
 v_accvgpr_read_b32 v42,a210
 v_mfma_f32_16x16x32_bf16 v[168:171],a[116:119],a[204:207],v[168:171]
 ds_read_b64_tr_b16 a[134:135],v6 offset:51200
 v_accvgpr_read_b32 v43,a211
 v_accvgpr_read_b32 v44,a212
 v_mfma_f32_16x16x32_bf16 v[172:175],a[120:123],a[200:203],0
 buffer_load_dwordx4 v15,s[4:7],s35 offen offset:3072 lds
 v_accvgpr_read_b32 v45,a213
 v_mfma_f32_16x16x32_bf16 v[172:175],a[124:127],a[204:207],v[172:175]
 s_waitcnt lgkmcnt(4)
 ds_read_b64_tr_b16 a[136:137],v7 offset:32768
 v_accvgpr_read_b32 v46,a214
 v_mfma_f32_16x16x32_bf16 v[176:179],a[64:67],a[192:195],0
 ds_read_b64_tr_b16 a[138:139],v7 offset:34816
 v_accvgpr_read_b32 v47,a215
 v_cvt_pk_bf16_f32 v40,v40,v41
 v_mfma_f32_16x16x32_bf16 v[176:179],a[68:71],a[196:199],v[176:179]
 ds_read_b128 a[200:203],v4 offset:10240
 s_add_u32 m0,s50,4096
 v_cvt_pk_bf16_f32 v41,v42,v43
 v_mfma_f32_16x16x32_bf16 v[180:183],a[72:75],a[192:195],0
 ds_read_b64_tr_b16 a[140:141],v7 offset:49152
 s_add_u32 s60,s57,51200
 v_cvt_pk_bf16_f32 v42,v44,v45
 v_mfma_f32_16x16x32_bf16 v[180:183],a[76:79],a[196:199],v[180:183]
 ds_read_b128 a[204:207],v5 offset:10240
 ds_read_b64_tr_b16 a[142:143],v7 offset:51200
 v_cvt_pk_bf16_f32 v43,v46,v47
 v_mfma_f32_16x16x32_bf16 v[184:187],a[80:83],a[192:195],0
 buffer_store_dwordx4 v[40:43],v1,s[28:31],s60 offen sc1
 ds_read_b64_tr_b16 a[144:145],v8 offset:32768
 v_mfma_f32_16x16x32_bf16 v[184:187],a[84:87],a[196:199],v[184:187]
 s_nop 1
 v_accvgpr_read_b32 v40,a216
 v_accvgpr_read_b32 v41,a217
 v_mfma_f32_16x16x32_bf16 v[188:191],a[88:91],a[192:195],0
 ds_read_b64_tr_b16 a[146:147],v8 offset:34816
 v_accvgpr_read_b32 v42,a218
 v_accvgpr_read_b32 v43,a219
 v_mfma_f32_16x16x32_bf16 v[188:191],a[92:95],a[196:199],v[188:191]
 buffer_load_dwordx4 v14,s[4:7],s36 offen offset:0 lds
 v_accvgpr_read_b32 v44,a220
 v_mfma_f32_16x16x32_bf16 v[192:195],a[96:99],a[192:195],0
 ds_read_b64_tr_b16 a[148:149],v8 offset:49152
 v_accvgpr_read_b32 v45,a221
 v_accvgpr_read_b32 v46,a222
 v_mfma_f32_16x16x32_bf16 v[192:195],a[100:103],a[196:199],v[192:195]
 buffer_load_dwordx4 v15,s[4:7],s37 offen offset:1024 lds
 v_accvgpr_read_b32 v47,a223
 v_mfma_f32_16x16x32_bf16 v[196:199],a[104:107],a[192:195],0
 ds_read_b64_tr_b16 a[150:151],v8 offset:51200
 ds_read_b64_tr_b16 a[152:153],v9 offset:32768
 v_cvt_pk_bf16_f32 v40,v40,v41
 v_mfma_f32_16x16x32_bf16 v[196:199],a[108:111],a[196:199],v[196:199]
 v_cvt_pk_bf16_f32 v41,v42,v43
 v_cvt_pk_bf16_f32 v42,v44,v45
 v_cvt_pk_bf16_f32 v43,v46,v47
 v_mfma_f32_16x16x32_bf16 v[200:203],a[112:115],a[192:195],0
 ds_read_b64_tr_b16 a[154:155],v9 offset:34816
 v_accvgpr_write_b32 a52,v40
 v_accvgpr_write_b32 a53,v41
 v_mfma_f32_16x16x32_bf16 v[200:203],a[116:119],a[196:199],v[200:203]
 buffer_load_dwordx4 v14,s[4:7],s38 offen offset:2048 lds
 v_accvgpr_write_b32 a54,v42
 v_mfma_f32_16x16x32_bf16 v[204:207],a[120:123],a[192:195],0
 ds_read_b64_tr_b16 a[156:157],v9 offset:49152
 v_accvgpr_write_b32 a55,v43
 s_nop 1
 v_mfma_f32_16x16x32_bf16 v[204:207],a[124:127],a[196:199],v[204:207]
 s_waitcnt lgkmcnt(8)
 ds_read_b64_tr_b16 a[158:159],v9 offset:51200
 v_accvgpr_read_b32 v40,a224
 v_mfma_f32_16x16x32_bf16 v[208:211],a[64:67],a[200:203],0
 ds_read_b64_tr_b16 a[160:161],v10 offset:32768
 v_accvgpr_read_b32 v41,a225
 v_accvgpr_read_b32 v42,a226
 v_mfma_f32_16x16x32_bf16 v[208:211],a[68:71],a[204:207],v[208:211]
 buffer_load_dwordx4 v15,s[4:7],s39 offen offset:3072 lds
 v_accvgpr_read_b32 v43,a227
 v_mfma_f32_16x16x32_bf16 v[212:215],a[72:75],a[200:203],0
 ds_read_b128 a[192:195],v4 offset:12288
 ds_read_b64_tr_b16 a[162:163],v10 offset:34816
 v_accvgpr_read_b32 v44,a228
 v_mfma_f32_16x16x32_bf16 v[212:215],a[76:79],a[204:207],v[212:215]
 buffer_load_dword v24,v33,s[4:7],0 offen
 v_accvgpr_read_b32 v45,a229
 v_mfma_f32_16x16x32_bf16 v[216:219],a[80:83],a[200:203],0
 ds_read_b128 a[196:199],v5 offset:12288
 ds_read_b64_tr_b16 a[164:165],v10 offset:49152
 v_accvgpr_read_b32 v46,a230
 v_mfma_f32_16x16x32_bf16 v[216:219],a[84:87],a[204:207],v[216:219]
 s_add_u32 s4,s4,128
 s_addc_u32 s5,s5,0
 v_accvgpr_read_b32 v47,a231
 v_mfma_f32_16x16x32_bf16 v[220:223],a[88:91],a[200:203],0
 ds_read_b64_tr_b16 a[166:167],v10 offset:51200
 ds_read_b64_tr_b16 a[168:169],v11 offset:32768
 v_cvt_pk_bf16_f32 v40,v40,v41
 v_mfma_f32_16x16x32_bf16 v[220:223],a[92:95],a[204:207],v[220:223]
 ds_read_b64_tr_b16 a[170:171],v11 offset:34816
 v_cvt_pk_bf16_f32 v41,v42,v43
 s_add_u32 s60,s57,57344
 v_mfma_f32_16x16x32_bf16 v[224:227],a[96:99],a[200:203],0
 s_sub_u32 s6,s6,128
 v_cvt_pk_bf16_f32 v42,v44,v45
 v_cvt_pk_bf16_f32 v43,v46,v47
 v_mfma_f32_16x16x32_bf16 v[224:227],a[100:103],a[204:207],v[224:227]
 buffer_store_dwordx4 v[40:43],v1,s[28:31],s60 offen sc1
 ds_read_b64_tr_b16 a[172:173],v11 offset:49152
 v_mfma_f32_16x16x32_bf16 v[228:231],a[104:107],a[200:203],0
 ds_read_b64_tr_b16 a[174:175],v11 offset:51200
 s_nop 1
 v_accvgpr_read_b32 v40,a232
 v_mfma_f32_16x16x32_bf16 v[228:231],a[108:111],a[204:207],v[228:231]
 v_accvgpr_read_b32 v41,a233
 v_accvgpr_read_b32 v42,a234
 v_accvgpr_read_b32 v43,a235
 v_mfma_f32_16x16x32_bf16 v[232:235],a[112:115],a[200:203],0
 ds_read_b64_tr_b16 a[176:177],v12 offset:32768
 s_add_u32 s50,s50,32768
 v_accvgpr_read_b32 v44,a236
 v_mfma_f32_16x16x32_bf16 v[232:235],a[116:119],a[204:207],v[232:235]
 ds_read_b64_tr_b16 a[178:179],v12 offset:34816
 v_accvgpr_read_b32 v45,a237
 v_accvgpr_read_b32 v46,a238
 v_mfma_f32_16x16x32_bf16 v[236:239],a[120:123],a[200:203],0
 v_accvgpr_read_b32 v47,a239
 v_cvt_pk_bf16_f32 v40,v40,v41
 v_cvt_pk_bf16_f32 v41,v42,v43
 v_mfma_f32_16x16x32_bf16 v[236:239],a[124:127],a[204:207],v[236:239]
 s_waitcnt lgkmcnt(8)
 ds_read_b64_tr_b16 a[180:181],v12 offset:49152
 v_cvt_pk_bf16_f32 v42,v44,v45
 v_mfma_f32_16x16x32_bf16 v[240:243],a[64:67],a[192:195],0
 s_cmp_ge_u32 s50,98304
 s_cselect_b32 s50,s51,s50
 v_cvt_pk_bf16_f32 v43,v46,v47
 v_mfma_f32_16x16x32_bf16 v[240:243],a[68:71],a[196:199],v[240:243]
 ds_read_b64_tr_b16 a[182:183],v12 offset:51200
 ds_read_b128 a[200:203],v4 offset:14336
 v_accvgpr_write_b32 a56,v40
 v_mfma_f32_16x16x32_bf16 v[244:247],a[72:75],a[192:195],0
 ds_read_b64_tr_b16 a[184:185],v13 offset:32768
 v_accvgpr_write_b32 a57,v41
 v_accvgpr_write_b32 a58,v42
 v_mfma_f32_16x16x32_bf16 v[244:247],a[76:79],a[196:199],v[244:247]
 ds_read_b128 a[204:207],v5 offset:14336
 ds_read_b64_tr_b16 a[186:187],v13 offset:34816
 v_accvgpr_write_b32 a59,v43
 v_mfma_f32_16x16x32_bf16 v[248:251],a[80:83],a[192:195],0
 s_nop 1
 v_accvgpr_read_b32 v40,a240
 v_accvgpr_read_b32 v41,a241
 v_mfma_f32_16x16x32_bf16 v[248:251],a[84:87],a[196:199],v[248:251]
 ds_read_b64_tr_b16 a[188:189],v13 offset:49152
 v_accvgpr_read_b32 v42,a242
 v_accvgpr_read_b32 v43,a243
 v_mfma_f32_16x16x32_bf16 v[252:255],a[88:91],a[192:195],0
 ds_read_b64_tr_b16 a[190:191],v13 offset:51200
 v_accvgpr_read_b32 v44,a244
 v_accvgpr_read_b32 v45,a245
 v_mfma_f32_16x16x32_bf16 v[252:255],a[92:95],a[196:199],v[252:255]
 v_accvgpr_read_b32 v46,a246
 v_accvgpr_read_b32 v47,a247
 v_cvt_pk_bf16_f32 v40,v40,v41
 v_mfma_f32_16x16x32_bf16 a[208:211],a[96:99],a[192:195],0
 v_cvt_pk_bf16_f32 v41,v42,v43
 s_add_u32 s60,s57,59392
 v_cvt_pk_bf16_f32 v42,v44,v45
 v_mfma_f32_16x16x32_bf16 a[208:211],a[100:103],a[196:199],a[208:211]
 s_add_u32 s55,s55,32768
 v_cvt_pk_bf16_f32 v43,v46,v47
 v_mfma_f32_16x16x32_bf16 a[212:215],a[104:107],a[192:195],0
 s_cmp_ge_u32 s55,98304
 s_cselect_b32 s55,s54,s55
 v_mfma_f32_16x16x32_bf16 a[212:215],a[108:111],a[196:199],a[212:215]
 buffer_store_dwordx4 v[40:43],v1,s[28:31],s60 offen sc1
 v_add_u32 v4,s55,v2
 v_mfma_f32_16x16x32_bf16 a[216:219],a[112:115],a[192:195],0
 v_add_u32 v5,s55,v3
 s_nop 1
 v_accvgpr_read_b32 v40,a248
 v_mfma_f32_16x16x32_bf16 a[216:219],a[116:119],a[196:199],a[216:219]
 v_accvgpr_read_b32 v41,a249
 v_accvgpr_read_b32 v42,a250
 v_accvgpr_read_b32 v43,a251
 v_mfma_f32_16x16x32_bf16 a[220:223],a[120:123],a[192:195],0
 v_accvgpr_read_b32 v44,a252
 v_accvgpr_read_b32 v45,a253
 v_accvgpr_read_b32 v46,a254
 v_mfma_f32_16x16x32_bf16 a[220:223],a[124:127],a[196:199],a[220:223]
 s_waitcnt vmcnt(28) lgkmcnt(0)
 s_barrier
 v_accvgpr_read_b32 v47,a255
 v_mfma_f32_16x16x32_bf16 a[224:227],a[64:67],a[200:203],0
 ds_read_b128 a[192:195],v4 offset:0
 v_cvt_pk_bf16_f32 v40,v40,v41
 v_cvt_pk_bf16_f32 v41,v42,v43
 v_mfma_f32_16x16x32_bf16 a[224:227],a[68:71],a[204:207],a[224:227]
 ds_read_b128 a[196:199],v5 offset:0
 v_cvt_pk_bf16_f32 v42,v44,v45
 v_cvt_pk_bf16_f32 v43,v46,v47
 v_mfma_f32_16x16x32_bf16 a[228:231],a[72:75],a[200:203],0
 v_accvgpr_write_b32 a60,v40
 v_accvgpr_write_b32 a61,v41
 v_accvgpr_write_b32 a62,v42
 v_mfma_f32_16x16x32_bf16 a[228:231],a[76:79],a[204:207],a[228:231]
 v_accvgpr_write_b32 a63,v43
 v_mfma_f32_16x16x32_bf16 a[232:235],a[80:83],a[200:203],0
 v_mfma_f32_16x16x32_bf16 a[232:235],a[84:87],a[204:207],a[232:235]
 v_mfma_f32_16x16x32_bf16 a[236:239],a[88:91],a[200:203],0
 v_mfma_f32_16x16x32_bf16 a[236:239],a[92:95],a[204:207],a[236:239]
 v_mfma_f32_16x16x32_bf16 a[240:243],a[96:99],a[200:203],0
 v_mfma_f32_16x16x32_bf16 a[240:243],a[100:103],a[204:207],a[240:243]
 v_mfma_f32_16x16x32_bf16 a[244:247],a[104:107],a[200:203],0
 s_add_u32 s60,s57,1024
 buffer_store_dwordx4 a[0:3],v1,s[28:31],s60 offen sc1
 v_mfma_f32_16x16x32_bf16 a[244:247],a[108:111],a[204:207],a[244:247]
 v_mfma_f32_16x16x32_bf16 a[248:251],a[112:115],a[200:203],0
 v_mfma_f32_16x16x32_bf16 a[248:251],a[116:119],a[204:207],a[248:251]
 v_mfma_f32_16x16x32_bf16 a[252:255],a[120:123],a[200:203],0
 v_mfma_f32_16x16x32_bf16 a[252:255],a[124:127],a[204:207],a[252:255]
 s_waitcnt lgkmcnt(0)
 v_mfma_f32_16x16x32_bf16 v[48:51],a[128:131],a[192:195],v[48:51]
 s_add_u32 m0,s51,131072
 v_mfma_f32_16x16x32_bf16 v[48:51],a[132:135],a[196:199],v[48:51]
 ds_read_b128 a[200:203],v4 offset:2048
 s_add_u32 s60,s57,3072
 v_mfma_f32_16x16x32_bf16 v[52:55],a[136:139],a[192:195],v[52:55]
 buffer_store_dwordx4 a[4:7],v1,s[28:31],s60 offen sc1
 v_mfma_f32_16x16x32_bf16 v[52:55],a[140:143],a[196:199],v[52:55]
 ds_read_b128 a[204:207],v5 offset:2048
 v_mfma_f32_16x16x32_bf16 v[56:59],a[144:147],a[192:195],v[56:59]
 v_mfma_f32_16x16x32_bf16 v[56:59],a[148:151],a[196:199],v[56:59]
 buffer_load_dwordx4 v16,s[8:11],s32 offen offset:0 lds
 v_mfma_f32_16x16x32_bf16 v[60:63],a[152:155],a[192:195],v[60:63]
 v_mfma_f32_16x16x32_bf16 v[60:63],a[156:159],a[196:199],v[60:63]
 buffer_load_dwordx4 v17,s[8:11],s33 offen offset:1024 lds
 v_mfma_f32_16x16x32_bf16 v[64:67],a[160:163],a[192:195],v[64:67]
 v_mfma_f32_16x16x32_bf16 v[64:67],a[164:167],a[196:199],v[64:67]
 s_add_u32 s60,s57,9216
 buffer_store_dwordx4 a[8:11],v1,s[28:31],s60 offen sc1
 v_mfma_f32_16x16x32_bf16 v[68:71],a[168:171],a[192:195],v[68:71]
 v_mfma_f32_16x16x32_bf16 v[68:71],a[172:175],a[196:199],v[68:71]
 v_mfma_f32_16x16x32_bf16 v[72:75],a[176:179],a[192:195],v[72:75]
 buffer_load_dwordx4 v16,s[8:11],s34 offen offset:2048 lds
 v_mfma_f32_16x16x32_bf16 v[72:75],a[180:183],a[196:199],v[72:75]
 v_mfma_f32_16x16x32_bf16 v[76:79],a[184:187],a[192:195],v[76:79]
 v_mfma_f32_16x16x32_bf16 v[76:79],a[188:191],a[196:199],v[76:79]
 s_waitcnt lgkmcnt(0)
 v_mfma_f32_16x16x32_bf16 v[80:83],a[128:131],a[200:203],v[80:83]
 buffer_load_dwordx4 v17,s[8:11],s35 offen offset:3072 lds
 s_add_u32 s60,s57,11264
 v_mfma_f32_16x16x32_bf16 v[80:83],a[132:135],a[204:207],v[80:83]
 buffer_store_dwordx4 a[12:15],v1,s[28:31],s60 offen sc1
 ds_read_b128 a[192:195],v4 offset:4096
 v_mfma_f32_16x16x32_bf16 v[84:87],a[136:139],a[200:203],v[84:87]
 v_mfma_f32_16x16x32_bf16 v[84:87],a[140:143],a[204:207],v[84:87]
 ds_read_b128 a[196:199],v5 offset:4096
 s_add_u32 m0,s51,135168
 v_mfma_f32_16x16x32_bf16 v[88:91],a[144:147],a[200:203],v[88:91]
 v_mfma_f32_16x16x32_bf16 v[88:91],a[148:151],a[204:207],v[88:91]
 v_mfma_f32_16x16x32_bf16 v[92:95],a[152:155],a[200:203],v[92:95]
 v_mfma_f32_16x16x32_bf16 v[92:95],a[156:159],a[204:207],v[92:95]
 buffer_load_dwordx4 v18,s[8:11],s36 offen offset:0 lds
 v_mfma_f32_16x16x32_bf16 v[96:99],a[160:163],a[200:203],v[96:99]
 s_add_u32 s60,s57,17408
 buffer_store_dwordx4 a[16:19],v1,s[28:31],s60 offen sc1
 v_mfma_f32_16x16x32_bf16 v[96:99],a[164:167],a[204:207],v[96:99]
 v_mfma_f32_16x16x32_bf16 v[100:103],a[168:171],a[200:203],v[100:103]
 v_mfma_f32_16x16x32_bf16 v[100:103],a[172:175],a[204:207],v[100:103]
 buffer_load_dwordx4 v19,s[8:11],s37 offen offset:1024 lds
 v_mfma_f32_16x16x32_bf16 v[104:107],a[176:179],a[200:203],v[104:107]
 v_mfma_f32_16x16x32_bf16 v[104:107],a[180:183],a[204:207],v[104:107]
 v_mfma_f32_16x16x32_bf16 v[108:111],a[184:187],a[200:203],v[108:111]
 buffer_load_dwordx4 v18,s[8:11],s38 offen offset:2048 lds
 v_mfma_f32_16x16x32_bf16 v[108:111],a[188:191],a[204:207],v[108:111]
 s_waitcnt lgkmcnt(0)
 s_add_u32 s60,s57,19456
 v_mfma_f32_16x16x32_bf16 v[112:115],a[128:131],a[192:195],v[112:115]
 buffer_store_dwordx4 a[20:23],v1,s[28:31],s60 offen sc1
 v_mfma_f32_16x16x32_bf16 v[112:115],a[132:135],a[196:199],v[112:115]
 ds_read_b128 a[200:203],v4 offset:6144
 v_mfma_f32_16x16x32_bf16 v[116:119],a[136:139],a[192:195],v[116:119]
 v_mfma_f32_16x16x32_bf16 v[116:119],a[140:143],a[196:199],v[116:119]
 buffer_load_dwordx4 v19,s[8:11],s39 offen offset:3072 lds
 v_mfma_f32_16x16x32_bf16 v[120:123],a[144:147],a[192:195],v[120:123]
 ds_read_b128 a[204:207],v5 offset:6144
 v_mfma_f32_16x16x32_bf16 v[120:123],a[148:151],a[196:199],v[120:123]
 v_mfma_f32_16x16x32_bf16 v[124:127],a[152:155],a[192:195],v[124:127]
 s_add_u32 s8,s8,524288
 s_addc_u32 s9,s9,0
 v_mfma_f32_16x16x32_bf16 v[124:127],a[156:159],a[196:199],v[124:127]
 s_add_u32 s60,s57,25600
 buffer_store_dwordx4 a[24:27],v1,s[28:31],s60 offen sc1
 v_mfma_f32_16x16x32_bf16 v[128:131],a[160:163],a[192:195],v[128:131]
 v_mfma_f32_16x16x32_bf16 v[128:131],a[164:167],a[196:199],v[128:131]
 v_mfma_f32_16x16x32_bf16 v[132:135],a[168:171],a[192:195],v[132:135]
 s_sub_u32 s10,s10,524288
 v_mfma_f32_16x16x32_bf16 v[132:135],a[172:175],a[196:199],v[132:135]
 v_mfma_f32_16x16x32_bf16 v[136:139],a[176:179],a[192:195],v[136:139]
 v_mfma_f32_16x16x32_bf16 v[136:139],a[180:183],a[196:199],v[136:139]
 v_mfma_f32_16x16x32_bf16 v[140:143],a[184:187],a[192:195],v[140:143]
 s_add_u32 m0,s50,0
 s_add_u32 s60,s57,27648
 v_mfma_f32_16x16x32_bf16 v[140:143],a[188:191],a[196:199],v[140:143]
 s_waitcnt lgkmcnt(0)
 buffer_store_dwordx4 a[28:31],v1,s[28:31],s60 offen sc1
 v_mfma_f32_16x16x32_bf16 v[144:147],a[128:131],a[200:203],v[144:147]
 v_mfma_f32_16x16x32_bf16 v[144:147],a[132:135],a[204:207],v[144:147]
 ds_read_b128 a[192:195],v4 offset:8192
 v_mfma_f32_16x16x32_bf16 v[148:151],a[136:139],a[200:203],v[148:151]
 buffer_load_dwordx4 v14,s[4:7],s32 offen offset:0 lds
 v_mfma_f32_16x16x32_bf16 v[148:151],a[140:143],a[204:207],v[148:151]
 ds_read_b128 a[196:199],v5 offset:8192
 v_mfma_f32_16x16x32_bf16 v[152:155],a[144:147],a[200:203],v[152:155]
 v_mfma_f32_16x16x32_bf16 v[152:155],a[148:151],a[204:207],v[152:155]
 buffer_load_dwordx4 v15,s[4:7],s33 offen offset:1024 lds
 v_mfma_f32_16x16x32_bf16 v[156:159],a[152:155],a[200:203],v[156:159]
 s_add_u32 s60,s57,33792
 buffer_store_dwordx4 a[32:35],v1,s[28:31],s60 offen sc1
 v_mfma_f32_16x16x32_bf16 v[156:159],a[156:159],a[204:207],v[156:159]
 v_mfma_f32_16x16x32_bf16 v[160:163],a[160:163],a[200:203],v[160:163]
 s_waitcnt vmcnt(33)
 s_barrier
 v_mfma_f32_16x16x32_bf16 v[160:163],a[164:167],a[204:207],v[160:163]
 ds_read_b64_tr_b16 a[64:65],v6 offset:0
 v_mfma_f32_16x16x32_bf16 v[164:167],a[168:171],a[200:203],v[164:167]
 buffer_load_dwordx4 v14,s[4:7],s34 offen offset:2048 lds
 v_mfma_f32_16x16x32_bf16 v[164:167],a[172:175],a[204:207],v[164:167]
 ds_read_b64_tr_b16 a[66:67],v6 offset:2048
 ds_read_b64_tr_b16 a[68:69],v6 offset:16384
 v_mfma_f32_16x16x32_bf16 v[168:171],a[176:179],a[200:203],v[168:171]
 v_mfma_f32_16x16x32_bf16 v[168:171],a[180:183],a[204:207],v[168:171]
 ds_read_b64_tr_b16 a[70:71],v6 offset:18432
 s_add_u32 s60,s57,35840
 v_mfma_f32_16x16x32_bf16 v[172:175],a[184:187],a[200:203],v[172:175]
 buffer_load_dwordx4 v15,s[4:7],s35 offen offset:3072 lds
 v_mfma_f32_16x16x32_bf16 v[172:175],a[188:191],a[204:207],v[172:175]
 s_waitcnt lgkmcnt(4)
 ds_read_b64_tr_b16 a[72:73],v7 offset:0
 v_mfma_f32_16x16x32_bf16 v[176:179],a[128:131],a[192:195],v[176:179]
 buffer_store_dwordx4 a[36:39],v1,s[28:31],s60 offen sc1
 ds_read_b64_tr_b16 a[74:75],v7 offset:2048
 v_mfma_f32_16x16x32_bf16 v[176:179],a[132:135],a[196:199],v[176:179]
 ds_read_b128 a[200:203],v4 offset:10240
 s_add_u32 m0,s50,4096
 v_mfma_f32_16x16x32_bf16 v[180:183],a[136:139],a[192:195],v[180:183]
 ds_read_b64_tr_b16 a[76:77],v7 offset:16384
 v_mfma_f32_16x16x32_bf16 v[180:183],a[140:143],a[196:199],v[180:183]
 ds_read_b128 a[204:207],v5 offset:10240
 ds_read_b64_tr_b16 a[78:79],v7 offset:18432
 v_mfma_f32_16x16x32_bf16 v[184:187],a[144:147],a[192:195],v[184:187]
 ds_read_b64_tr_b16 a[80:81],v8 offset:0
 v_mfma_f32_16x16x32_bf16 v[184:187],a[148:151],a[196:199],v[184:187]
 buffer_load_dwordx4 v14,s[4:7],s36 offen offset:0 lds
 s_add_u32 s60,s57,41984
 v_mfma_f32_16x16x32_bf16 v[188:191],a[152:155],a[192:195],v[188:191]
 buffer_store_dwordx4 a[40:43],v1,s[28:31],s60 offen sc1
 ds_read_b64_tr_b16 a[82:83],v8 offset:2048
 v_mfma_f32_16x16x32_bf16 v[188:191],a[156:159],a[196:199],v[188:191]
 ds_read_b64_tr_b16 a[84:85],v8 offset:16384
 v_mfma_f32_16x16x32_bf16 v[192:195],a[160:163],a[192:195],v[192:195]
 v_mfma_f32_16x16x32_bf16 v[192:195],a[164:167],a[196:199],v[192:195]
 buffer_load_dwordx4 v15,s[4:7],s37 offen offset:1024 lds
 v_mfma_f32_16x16x32_bf16 v[196:199],a[168:171],a[192:195],v[196:199]
 ds_read_b64_tr_b16 a[86:87],v8 offset:18432
 ds_read_b64_tr_b16 a[88:89],v9 offset:0
 v_mfma_f32_16x16x32_bf16 v[196:199],a[172:175],a[196:199],v[196:199]
 v_mfma_f32_16x16x32_bf16 v[200:203],a[176:179],a[192:195],v[200:203]
 ds_read_b64_tr_b16 a[90:91],v9 offset:2048
 s_add_u32 s60,s57,44032
 v_mfma_f32_16x16x32_bf16 v[200:203],a[180:183],a[196:199],v[200:203]
 buffer_load_dwordx4 v14,s[4:7],s38 offen offset:2048 lds
 v_mfma_f32_16x16x32_bf16 v[204:207],a[184:187],a[192:195],v[204:207]
 buffer_store_dwordx4 a[44:47],v1,s[28:31],s60 offen sc1
 ds_read_b64_tr_b16 a[92:93],v9 offset:16384
 v_mfma_f32_16x16x32_bf16 v[204:207],a[188:191],a[196:199],v[204:207]
 s_waitcnt lgkmcnt(8)
 ds_read_b64_tr_b16 a[94:95],v9 offset:18432
 v_mfma_f32_16x16x32_bf16 v[208:211],a[128:131],a[200:203],v[208:211]
 ds_read_b64_tr_b16 a[96:97],v10 offset:0
 v_mfma_f32_16x16x32_bf16 v[208:211],a[132:135],a[204:207],v[208:211]
 buffer_load_dwordx4 v15,s[4:7],s39 offen offset:3072 lds
 v_mfma_f32_16x16x32_bf16 v[212:215],a[136:139],a[200:203],v[212:215]
 ds_read_b128 a[192:195],v4 offset:12288
 ds_read_b64_tr_b16 a[98:99],v10 offset:2048
 v_mfma_f32_16x16x32_bf16 v[212:215],a[140:143],a[204:207],v[212:215]
 ds_read_b128 a[196:199],v5 offset:12288
 ds_read_b64_tr_b16 a[100:101],v10 offset:16384
 v_mfma_f32_16x16x32_bf16 v[216:219],a[144:147],a[200:203],v[216:219]
 s_add_u32 s4,s4,128
 s_addc_u32 s5,s5,0
 s_add_u32 s60,s57,50176
 v_mfma_f32_16x16x32_bf16 v[216:219],a[148:151],a[204:207],v[216:219]
 buffer_store_dwordx4 a[48:51],v1,s[28:31],s60 offen sc1
 ds_read_b64_tr_b16 a[102:103],v10 offset:18432
 v_mfma_f32_16x16x32_bf16 v[220:223],a[152:155],a[200:203],v[220:223]
 ds_read_b64_tr_b16 a[104:105],v11 offset:0
 v_mfma_f32_16x16x32_bf16 v[220:223],a[156:159],a[204:207],v[220:223]
 ds_read_b64_tr_b16 a[106:107],v11 offset:2048
 v_mfma_f32_16x16x32_bf16 v[224:227],a[160:163],a[200:203],v[224:227]
 s_sub_u32 s6,s6,128
 v_mfma_f32_16x16x32_bf16 v[224:227],a[164:167],a[204:207],v[224:227]
 ds_read_b64_tr_b16 a[108:109],v11 offset:16384
 v_mfma_f32_16x16x32_bf16 v[228:231],a[168:171],a[200:203],v[228:231]
 ds_read_b64_tr_b16 a[110:111],v11 offset:18432
 v_mfma_f32_16x16x32_bf16 v[228:231],a[172:175],a[204:207],v[228:231]
 s_add_u32 s60,s57,52224
 buffer_store_dwordx4 a[52:55],v1,s[28:31],s60 offen sc1
 v_mfma_f32_16x16x32_bf16 v[232:235],a[176:179],a[200:203],v[232:235]
 ds_read_b64_tr_b16 a[112:113],v12 offset:0
 s_add_u32 s50,s50,32768
 v_mfma_f32_16x16x32_bf16 v[232:235],a[180:183],a[204:207],v[232:235]
 ds_read_b64_tr_b16 a[114:115],v12 offset:2048
 v_mfma_f32_16x16x32_bf16 v[236:239],a[184:187],a[200:203],v[236:239]
 v_mfma_f32_16x16x32_bf16 v[236:239],a[188:191],a[204:207],v[236:239]
 s_waitcnt lgkmcnt(8)
 ds_read_b64_tr_b16 a[116:117],v12 offset:16384
 v_mfma_f32_16x16x32_bf16 v[240:243],a[128:131],a[192:195],v[240:243]
 s_cmp_ge_u32 s50,98304
 s_cselect_b32 s50,s51,s50
 v_mfma_f32_16x16x32_bf16 v[240:243],a[132:135],a[196:199],v[240:243]
 ds_read_b64_tr_b16 a[118:119],v12 offset:18432
 ds_read_b128 a[200:203],v4 offset:14336
 v_mfma_f32_16x16x32_bf16 v[244:247],a[136:139],a[192:195],v[244:247]
 ds_read_b64_tr_b16 a[120:121],v13 offset:0
 v_mfma_f32_16x16x32_bf16 v[244:247],a[140:143],a[196:199],v[244:247]
 ds_read_b128 a[204:207],v5 offset:14336
 ds_read_b64_tr_b16 a[122:123],v13 offset:2048
 s_add_u32 s60,s57,58368
 v_mfma_f32_16x16x32_bf16 v[248:251],a[144:147],a[192:195],v[248:251]
 buffer_store_dwordx4 a[56:59],v1,s[28:31],s60 offen sc1
 v_mfma_f32_16x16x32_bf16 v[248:251],a[148:151],a[196:199],v[248:251]
 ds_read_b64_tr_b16 a[124:125],v13 offset:16384
 v_mfma_f32_16x16x32_bf16 v[252:255],a[152:155],a[192:195],v[252:255]
 ds_read_b64_tr_b16 a[126:127],v13 offset:18432
 v_mfma_f32_16x16x32_bf16 v[252:255],a[156:159],a[196:199],v[252:255]
 v_mfma_f32_16x16x32_bf16 a[208:211],a[160:163],a[192:195],a[208:211]
 v_mfma_f32_16x16x32_bf16 a[208:211],a[164:167],a[196:199],a[208:211]
 s_add_u32 s55,s55,32768
 v_mfma_f32_16x16x32_bf16 a[212:215],a[168:171],a[192:195],a[212:215]
 s_cmp_ge_u32 s55,98304
 s_cselect_b32 s55,s54,s55
 s_add_u32 s60,s57,60416
 v_mfma_f32_16x16x32_bf16 a[212:215],a[172:175],a[196:199],a[212:215]
 buffer_store_dwordx4 a[60:63],v1,s[28:31],s60 offen sc1
 v_add_u32 v4,s55,v2
 v_mfma_f32_16x16x32_bf16 a[216:219],a[176:179],a[192:195],a[216:219]
 v_add_u32 v5,s55,v3
 v_mfma_f32_16x16x32_bf16 a[216:219],a[180:183],a[196:199],a[216:219]
 v_mfma_f32_16x16x32_bf16 a[220:223],a[184:187],a[192:195],a[220:223]
 v_mfma_f32_16x16x32_bf16 a[220:223],a[188:191],a[196:199],a[220:223]
 s_waitcnt vmcnt(35) lgkmcnt(0)
 s_barrier
 v_mfma_f32_16x16x32_bf16 a[224:227],a[128:131],a[200:203],a[224:227]
 ds_read_b128 a[192:195],v4 offset:0
 v_mfma_f32_16x16x32_bf16 a[224:227],a[132:135],a[204:207],a[224:227]
 ds_read_b128 a[196:199],v5 offset:0
 v_mfma_f32_16x16x32_bf16 a[228:231],a[136:139],a[200:203],a[228:231]
 v_mfma_f32_16x16x32_bf16 a[228:231],a[140:143],a[204:207],a[228:231]
 v_mfma_f32_16x16x32_bf16 a[232:235],a[144:147],a[200:203],a[232:235]
 v_mfma_f32_16x16x32_bf16 a[232:235],a[148:151],a[204:207],a[232:235]
 v_mfma_f32_16x16x32_bf16 a[236:239],a[152:155],a[200:203],a[236:239]
 v_mfma_f32_16x16x32_bf16 a[236:239],a[156:159],a[204:207],a[236:239]
 v_mfma_f32_16x16x32_bf16 a[240:243],a[160:163],a[200:203],a[240:243]
 v_mfma_f32_16x16x32_bf16 a[240:243],a[164:167],a[204:207],a[240:243]
 v_mfma_f32_16x16x32_bf16 a[244:247],a[168:171],a[200:203],a[244:247]
 v_mfma_f32_16x16x32_bf16 a[244:247],a[172:175],a[204:207],a[244:247]
 v_mfma_f32_16x16x32_bf16 a[248:251],a[176:179],a[200:203],a[248:251]
 v_mfma_f32_16x16x32_bf16 a[248:251],a[180:183],a[204:207],a[248:251]
 v_mfma_f32_16x16x32_bf16 a[252:255],a[184:187],a[200:203],a[252:255]
 v_mfma_f32_16x16x32_bf16 a[252:255],a[188:191],a[204:207],a[252:255]
 s_waitcnt lgkmcnt(0)
ZP_52:
 v_readfirstlane_b32 s61,v34
 s_nop 3
 s_cmp_lg_u32 s61,0
 s_cbranch_scc1 ZC_51
 v_mov_b32 v26,0
 global_load_dword v34,v26,s[70:71] sc1
 s_waitcnt vmcnt(0)
 s_branch ZP_52
ZC_51:
 s_mov_b32 s49,6
.p2align 6
KVL_53:
 v_mfma_f32_16x16x32_bf16 v[48:51],a[64:67],a[192:195],v[48:51]
 s_add_u32 m0,s51,98304
 v_mfma_f32_16x16x32_bf16 v[48:51],a[68:71],a[196:199],v[48:51]
 ds_read_b128 a[200:203],v4 offset:2048
 v_mfma_f32_16x16x32_bf16 v[52:55],a[72:75],a[192:195],v[52:55]
 v_mfma_f32_16x16x32_bf16 v[52:55],a[76:79],a[196:199],v[52:55]
 ds_read_b128 a[204:207],v5 offset:2048
 v_mfma_f32_16x16x32_bf16 v[56:59],a[80:83],a[192:195],v[56:59]
 buffer_load_dwordx4 v16,s[8:11],s32 offen offset:0 lds
 v_mfma_f32_16x16x32_bf16 v[56:59],a[84:87],a[196:199],v[56:59]
 v_mfma_f32_16x16x32_bf16 v[60:63],a[88:91],a[192:195],v[60:63]
 v_mfma_f32_16x16x32_bf16 v[60:63],a[92:95],a[196:199],v[60:63]
 buffer_load_dwordx4 v17,s[8:11],s33 offen offset:1024 lds
 v_mfma_f32_16x16x32_bf16 v[64:67],a[96:99],a[192:195],v[64:67]
 v_mfma_f32_16x16x32_bf16 v[64:67],a[100:103],a[196:199],v[64:67]
 v_mfma_f32_16x16x32_bf16 v[68:71],a[104:107],a[192:195],v[68:71]
 v_mfma_f32_16x16x32_bf16 v[68:71],a[108:111],a[196:199],v[68:71]
 buffer_load_dwordx4 v16,s[8:11],s34 offen offset:2048 lds
 v_mfma_f32_16x16x32_bf16 v[72:75],a[112:115],a[192:195],v[72:75]
 v_mfma_f32_16x16x32_bf16 v[72:75],a[116:119],a[196:199],v[72:75]
 v_mfma_f32_16x16x32_bf16 v[76:79],a[120:123],a[192:195],v[76:79]
 v_mfma_f32_16x16x32_bf16 v[76:79],a[124:127],a[196:199],v[76:79]
 s_waitcnt lgkmcnt(0)
 v_mfma_f32_16x16x32_bf16 v[80:83],a[64:67],a[200:203],v[80:83]
 buffer_load_dwordx4 v17,s[8:11],s35 offen offset:3072 lds
 v_mfma_f32_16x16x32_bf16 v[80:83],a[68:71],a[204:207],v[80:83]
 ds_read_b128 a[192:195],v4 offset:4096
 v_mfma_f32_16x16x32_bf16 v[84:87],a[72:75],a[200:203],v[84:87]
 v_mfma_f32_16x16x32_bf16 v[84:87],a[76:79],a[204:207],v[84:87]
 ds_read_b128 a[196:199],v5 offset:4096
 s_add_u32 m0,s51,102400
 v_mfma_f32_16x16x32_bf16 v[88:91],a[80:83],a[200:203],v[88:91]
 v_mfma_f32_16x16x32_bf16 v[88:91],a[84:87],a[204:207],v[88:91]
 v_mfma_f32_16x16x32_bf16 v[92:95],a[88:91],a[200:203],v[92:95]
 v_mfma_f32_16x16x32_bf16 v[92:95],a[92:95],a[204:207],v[92:95]
 buffer_load_dwordx4 v18,s[8:11],s36 offen offset:0 lds
 v_mfma_f32_16x16x32_bf16 v[96:99],a[96:99],a[200:203],v[96:99]
 v_mfma_f32_16x16x32_bf16 v[96:99],a[100:103],a[204:207],v[96:99]
 v_mfma_f32_16x16x32_bf16 v[100:103],a[104:107],a[200:203],v[100:103]
 buffer_load_dwordx4 v19,s[8:11],s37 offen offset:1024 lds
 v_mfma_f32_16x16x32_bf16 v[100:103],a[108:111],a[204:207],v[100:103]
 v_mfma_f32_16x16x32_bf16 v[104:107],a[112:115],a[200:203],v[104:107]
 v_mfma_f32_16x16x32_bf16 v[104:107],a[116:119],a[204:207],v[104:107]
 v_mfma_f32_16x16x32_bf16 v[108:111],a[120:123],a[200:203],v[108:111]
 buffer_load_dwordx4 v18,s[8:11],s38 offen offset:2048 lds
 v_mfma_f32_16x16x32_bf16 v[108:111],a[124:127],a[204:207],v[108:111]
 s_waitcnt lgkmcnt(0)
 v_mfma_f32_16x16x32_bf16 v[112:115],a[64:67],a[192:195],v[112:115]
 v_mfma_f32_16x16x32_bf16 v[112:115],a[68:71],a[196:199],v[112:115]
 ds_read_b128 a[200:203],v4 offset:6144
 v_mfma_f32_16x16x32_bf16 v[116:119],a[72:75],a[192:195],v[116:119]
 buffer_load_dwordx4 v19,s[8:11],s39 offen offset:3072 lds
 v_mfma_f32_16x16x32_bf16 v[116:119],a[76:79],a[196:199],v[116:119]
 ds_read_b128 a[204:207],v5 offset:6144
 v_mfma_f32_16x16x32_bf16 v[120:123],a[80:83],a[192:195],v[120:123]
 v_mfma_f32_16x16x32_bf16 v[120:123],a[84:87],a[196:199],v[120:123]
 v_mfma_f32_16x16x32_bf16 v[124:127],a[88:91],a[192:195],v[124:127]
 s_add_u32 s8,s8,524288
 s_addc_u32 s9,s9,0
 v_mfma_f32_16x16x32_bf16 v[124:127],a[92:95],a[196:199],v[124:127]
 v_mfma_f32_16x16x32_bf16 v[128:131],a[96:99],a[192:195],v[128:131]
 v_mfma_f32_16x16x32_bf16 v[128:131],a[100:103],a[196:199],v[128:131]
 v_mfma_f32_16x16x32_bf16 v[132:135],a[104:107],a[192:195],v[132:135]
 s_sub_u32 s10,s10,524288
 v_mfma_f32_16x16x32_bf16 v[132:135],a[108:111],a[196:199],v[132:135]
 v_mfma_f32_16x16x32_bf16 v[136:139],a[112:115],a[192:195],v[136:139]
 v_mfma_f32_16x16x32_bf16 v[136:139],a[116:119],a[196:199],v[136:139]
 v_mfma_f32_16x16x32_bf16 v[140:143],a[120:123],a[192:195],v[140:143]
 s_add_u32 m0,s50,0
 v_mfma_f32_16x16x32_bf16 v[140:143],a[124:127],a[196:199],v[140:143]
 s_waitcnt lgkmcnt(0)
 v_mfma_f32_16x16x32_bf16 v[144:147],a[64:67],a[200:203],v[144:147]
 v_mfma_f32_16x16x32_bf16 v[144:147],a[68:71],a[204:207],v[144:147]
 ds_read_b128 a[192:195],v4 offset:8192
 v_mfma_f32_16x16x32_bf16 v[148:151],a[72:75],a[200:203],v[148:151]
 buffer_load_dwordx4 v14,s[4:7],s32 offen offset:0 lds
 v_mfma_f32_16x16x32_bf16 v[148:151],a[76:79],a[204:207],v[148:151]
 ds_read_b128 a[196:199],v5 offset:8192
 v_mfma_f32_16x16x32_bf16 v[152:155],a[80:83],a[200:203],v[152:155]
 v_mfma_f32_16x16x32_bf16 v[152:155],a[84:87],a[204:207],v[152:155]
 buffer_load_dwordx4 v15,s[4:7],s33 offen offset:1024 lds
 v_mfma_f32_16x16x32_bf16 v[156:159],a[88:91],a[200:203],v[156:159]
 v_mfma_f32_16x16x32_bf16 v[156:159],a[92:95],a[204:207],v[156:159]
 v_mfma_f32_16x16x32_bf16 v[160:163],a[96:99],a[200:203],v[160:163]
 s_waitcnt vmcnt(18)
 s_barrier
 v_mfma_f32_16x16x32_bf16 v[160:163],a[100:103],a[204:207],v[160:163]
 ds_read_b64_tr_b16 a[128:129],v6 offset:32768
 v_mfma_f32_16x16x32_bf16 v[164:167],a[104:107],a[200:203],v[164:167]
 buffer_load_dwordx4 v14,s[4:7],s34 offen offset:2048 lds
 v_mfma_f32_16x16x32_bf16 v[164:167],a[108:111],a[204:207],v[164:167]
 ds_read_b64_tr_b16 a[130:131],v6 offset:34816
 ds_read_b64_tr_b16 a[132:133],v6 offset:49152
 v_mfma_f32_16x16x32_bf16 v[168:171],a[112:115],a[200:203],v[168:171]
 v_mfma_f32_16x16x32_bf16 v[168:171],a[116:119],a[204:207],v[168:171]
 ds_read_b64_tr_b16 a[134:135],v6 offset:51200
 v_mfma_f32_16x16x32_bf16 v[172:175],a[120:123],a[200:203],v[172:175]
 buffer_load_dwordx4 v15,s[4:7],s35 offen offset:3072 lds
 v_mfma_f32_16x16x32_bf16 v[172:175],a[124:127],a[204:207],v[172:175]
 s_waitcnt lgkmcnt(4)
 ds_read_b64_tr_b16 a[136:137],v7 offset:32768
 v_mfma_f32_16x16x32_bf16 v[176:179],a[64:67],a[192:195],v[176:179]
 ds_read_b64_tr_b16 a[138:139],v7 offset:34816
 v_mfma_f32_16x16x32_bf16 v[176:179],a[68:71],a[196:199],v[176:179]
 ds_read_b128 a[200:203],v4 offset:10240
 s_add_u32 m0,s50,4096
 v_mfma_f32_16x16x32_bf16 v[180:183],a[72:75],a[192:195],v[180:183]
 ds_read_b64_tr_b16 a[140:141],v7 offset:49152
 v_mfma_f32_16x16x32_bf16 v[180:183],a[76:79],a[196:199],v[180:183]
 ds_read_b128 a[204:207],v5 offset:10240
 ds_read_b64_tr_b16 a[142:143],v7 offset:51200
 v_mfma_f32_16x16x32_bf16 v[184:187],a[80:83],a[192:195],v[184:187]
 ds_read_b64_tr_b16 a[144:145],v8 offset:32768
 v_mfma_f32_16x16x32_bf16 v[184:187],a[84:87],a[196:199],v[184:187]
 buffer_load_dwordx4 v14,s[4:7],s36 offen offset:0 lds
 v_mfma_f32_16x16x32_bf16 v[188:191],a[88:91],a[192:195],v[188:191]
 ds_read_b64_tr_b16 a[146:147],v8 offset:34816
 v_mfma_f32_16x16x32_bf16 v[188:191],a[92:95],a[196:199],v[188:191]
 ds_read_b64_tr_b16 a[148:149],v8 offset:49152
 v_mfma_f32_16x16x32_bf16 v[192:195],a[96:99],a[192:195],v[192:195]
 v_mfma_f32_16x16x32_bf16 v[192:195],a[100:103],a[196:199],v[192:195]
 buffer_load_dwordx4 v15,s[4:7],s37 offen offset:1024 lds
 v_mfma_f32_16x16x32_bf16 v[196:199],a[104:107],a[192:195],v[196:199]
 ds_read_b64_tr_b16 a[150:151],v8 offset:51200
 ds_read_b64_tr_b16 a[152:153],v9 offset:32768
 v_mfma_f32_16x16x32_bf16 v[196:199],a[108:111],a[196:199],v[196:199]
 v_mfma_f32_16x16x32_bf16 v[200:203],a[112:115],a[192:195],v[200:203]
 ds_read_b64_tr_b16 a[154:155],v9 offset:34816
 v_mfma_f32_16x16x32_bf16 v[200:203],a[116:119],a[196:199],v[200:203]
 buffer_load_dwordx4 v14,s[4:7],s38 offen offset:2048 lds
 v_mfma_f32_16x16x32_bf16 v[204:207],a[120:123],a[192:195],v[204:207]
 ds_read_b64_tr_b16 a[156:157],v9 offset:49152
 v_mfma_f32_16x16x32_bf16 v[204:207],a[124:127],a[196:199],v[204:207]
 s_waitcnt lgkmcnt(8)
 ds_read_b64_tr_b16 a[158:159],v9 offset:51200
 v_mfma_f32_16x16x32_bf16 v[208:211],a[64:67],a[200:203],v[208:211]
 ds_read_b64_tr_b16 a[160:161],v10 offset:32768
 v_mfma_f32_16x16x32_bf16 v[208:211],a[68:71],a[204:207],v[208:211]
 buffer_load_dwordx4 v15,s[4:7],s39 offen offset:3072 lds
 v_mfma_f32_16x16x32_bf16 v[212:215],a[72:75],a[200:203],v[212:215]
 ds_read_b128 a[192:195],v4 offset:12288
 ds_read_b64_tr_b16 a[162:163],v10 offset:34816
 v_mfma_f32_16x16x32_bf16 v[212:215],a[76:79],a[204:207],v[212:215]
 buffer_load_dword v24,v33,s[4:7],0 offen
 v_mfma_f32_16x16x32_bf16 v[216:219],a[80:83],a[200:203],v[216:219]
 ds_read_b128 a[196:199],v5 offset:12288
 ds_read_b64_tr_b16 a[164:165],v10 offset:49152
 v_mfma_f32_16x16x32_bf16 v[216:219],a[84:87],a[204:207],v[216:219]
 s_add_u32 s4,s4,128
 s_addc_u32 s5,s5,0
 v_mfma_f32_16x16x32_bf16 v[220:223],a[88:91],a[200:203],v[220:223]
 ds_read_b64_tr_b16 a[166:167],v10 offset:51200
 ds_read_b64_tr_b16 a[168:169],v11 offset:32768
 v_mfma_f32_16x16x32_bf16 v[220:223],a[92:95],a[204:207],v[220:223]
 ds_read_b64_tr_b16 a[170:171],v11 offset:34816
 v_mfma_f32_16x16x32_bf16 v[224:227],a[96:99],a[200:203],v[224:227]
 s_sub_u32 s6,s6,128
 v_mfma_f32_16x16x32_bf16 v[224:227],a[100:103],a[204:207],v[224:227]
 ds_read_b64_tr_b16 a[172:173],v11 offset:49152
 v_mfma_f32_16x16x32_bf16 v[228:231],a[104:107],a[200:203],v[228:231]
 ds_read_b64_tr_b16 a[174:175],v11 offset:51200
 v_mfma_f32_16x16x32_bf16 v[228:231],a[108:111],a[204:207],v[228:231]
 v_mfma_f32_16x16x32_bf16 v[232:235],a[112:115],a[200:203],v[232:235]
 ds_read_b64_tr_b16 a[176:177],v12 offset:32768
 s_add_u32 s50,s50,32768
 v_mfma_f32_16x16x32_bf16 v[232:235],a[116:119],a[204:207],v[232:235]
 ds_read_b64_tr_b16 a[178:179],v12 offset:34816
 v_mfma_f32_16x16x32_bf16 v[236:239],a[120:123],a[200:203],v[236:239]
 v_mfma_f32_16x16x32_bf16 v[236:239],a[124:127],a[204:207],v[236:239]
 s_waitcnt lgkmcnt(8)
 ds_read_b64_tr_b16 a[180:181],v12 offset:49152
 v_mfma_f32_16x16x32_bf16 v[240:243],a[64:67],a[192:195],v[240:243]
 s_cmp_ge_u32 s50,98304
 s_cselect_b32 s50,s51,s50
 v_mfma_f32_16x16x32_bf16 v[240:243],a[68:71],a[196:199],v[240:243]
 ds_read_b64_tr_b16 a[182:183],v12 offset:51200
 ds_read_b128 a[200:203],v4 offset:14336
 v_mfma_f32_16x16x32_bf16 v[244:247],a[72:75],a[192:195],v[244:247]
 ds_read_b64_tr_b16 a[184:185],v13 offset:32768
 v_mfma_f32_16x16x32_bf16 v[244:247],a[76:79],a[196:199],v[244:247]
 ds_read_b128 a[204:207],v5 offset:14336
 ds_read_b64_tr_b16 a[186:187],v13 offset:34816
 v_mfma_f32_16x16x32_bf16 v[248:251],a[80:83],a[192:195],v[248:251]
 v_mfma_f32_16x16x32_bf16 v[248:251],a[84:87],a[196:199],v[248:251]
 ds_read_b64_tr_b16 a[188:189],v13 offset:49152
 v_mfma_f32_16x16x32_bf16 v[252:255],a[88:91],a[192:195],v[252:255]
 ds_read_b64_tr_b16 a[190:191],v13 offset:51200
 v_mfma_f32_16x16x32_bf16 v[252:255],a[92:95],a[196:199],v[252:255]
 v_mfma_f32_16x16x32_bf16 a[208:211],a[96:99],a[192:195],a[208:211]
 v_mfma_f32_16x16x32_bf16 a[208:211],a[100:103],a[196:199],a[208:211]
 s_add_u32 s55,s55,32768
 v_mfma_f32_16x16x32_bf16 a[212:215],a[104:107],a[192:195],a[212:215]
 s_cmp_ge_u32 s55,98304
 s_cselect_b32 s55,s54,s55
 v_mfma_f32_16x16x32_bf16 a[212:215],a[108:111],a[196:199],a[212:215]
 v_add_u32 v4,s55,v2
 v_mfma_f32_16x16x32_bf16 a[216:219],a[112:115],a[192:195],a[216:219]
 v_add_u32 v5,s55,v3
 v_mfma_f32_16x16x32_bf16 a[216:219],a[116:119],a[196:199],a[216:219]
 v_mfma_f32_16x16x32_bf16 a[220:223],a[120:123],a[192:195],a[220:223]
 v_mfma_f32_16x16x32_bf16 a[220:223],a[124:127],a[196:199],a[220:223]
 s_waitcnt vmcnt(17) lgkmcnt(0)
 s_barrier
 v_mfma_f32_16x16x32_bf16 a[224:227],a[64:67],a[200:203],a[224:227]
 ds_read_b128 a[192:195],v4 offset:0
 v_mfma_f32_16x16x32_bf16 a[224:227],a[68:71],a[204:207],a[224:227]
 ds_read_b128 a[196:199],v5 offset:0
 v_mfma_f32_16x16x32_bf16 a[228:231],a[72:75],a[200:203],a[228:231]
 v_mfma_f32_16x16x32_bf16 a[228:231],a[76:79],a[204:207],a[228:231]
 v_mfma_f32_16x16x32_bf16 a[232:235],a[80:83],a[200:203],a[232:235]
 v_mfma_f32_16x16x32_bf16 a[232:235],a[84:87],a[204:207],a[232:235]
 v_mfma_f32_16x16x32_bf16 a[236:239],a[88:91],a[200:203],a[236:239]
 v_mfma_f32_16x16x32_bf16 a[236:239],a[92:95],a[204:207],a[236:239]
 v_mfma_f32_16x16x32_bf16 a[240:243],a[96:99],a[200:203],a[240:243]
 v_mfma_f32_16x16x32_bf16 a[240:243],a[100:103],a[204:207],a[240:243]
 v_mfma_f32_16x16x32_bf16 a[244:247],a[104:107],a[200:203],a[244:247]
 v_mfma_f32_16x16x32_bf16 a[244:247],a[108:111],a[204:207],a[244:247]
 v_mfma_f32_16x16x32_bf16 a[248:251],a[112:115],a[200:203],a[248:251]
 v_mfma_f32_16x16x32_bf16 a[248:251],a[116:119],a[204:207],a[248:251]
 v_mfma_f32_16x16x32_bf16 a[252:255],a[120:123],a[200:203],a[252:255]
 v_mfma_f32_16x16x32_bf16 a[252:255],a[124:127],a[204:207],a[252:255]
 s_waitcnt lgkmcnt(0)
 v_mfma_f32_16x16x32_bf16 v[48:51],a[128:131],a[192:195],v[48:51]
 s_add_u32 m0,s51,131072
 v_mfma_f32_16x16x32_bf16 v[48:51],a[132:135],a[196:199],v[48:51]
 ds_read_b128 a[200:203],v4 offset:2048
 v_mfma_f32_16x16x32_bf16 v[52:55],a[136:139],a[192:195],v[52:55]
 v_mfma_f32_16x16x32_bf16 v[52:55],a[140:143],a[196:199],v[52:55]
 ds_read_b128 a[204:207],v5 offset:2048
 v_mfma_f32_16x16x32_bf16 v[56:59],a[144:147],a[192:195],v[56:59]
 buffer_load_dwordx4 v16,s[8:11],s32 offen offset:0 lds
 v_mfma_f32_16x16x32_bf16 v[56:59],a[148:151],a[196:199],v[56:59]
 v_mfma_f32_16x16x32_bf16 v[60:63],a[152:155],a[192:195],v[60:63]
 v_mfma_f32_16x16x32_bf16 v[60:63],a[156:159],a[196:199],v[60:63]
 buffer_load_dwordx4 v17,s[8:11],s33 offen offset:1024 lds
 v_mfma_f32_16x16x32_bf16 v[64:67],a[160:163],a[192:195],v[64:67]
 v_mfma_f32_16x16x32_bf16 v[64:67],a[164:167],a[196:199],v[64:67]
 v_mfma_f32_16x16x32_bf16 v[68:71],a[168:171],a[192:195],v[68:71]
 v_mfma_f32_16x16x32_bf16 v[68:71],a[172:175],a[196:199],v[68:71]
 buffer_load_dwordx4 v16,s[8:11],s34 offen offset:2048 lds
 v_mfma_f32_16x16x32_bf16 v[72:75],a[176:179],a[192:195],v[72:75]
 v_mfma_f32_16x16x32_bf16 v[72:75],a[180:183],a[196:199],v[72:75]
 v_mfma_f32_16x16x32_bf16 v[76:79],a[184:187],a[192:195],v[76:79]
 v_mfma_f32_16x16x32_bf16 v[76:79],a[188:191],a[196:199],v[76:79]
 s_waitcnt lgkmcnt(0)
 v_mfma_f32_16x16x32_bf16 v[80:83],a[128:131],a[200:203],v[80:83]
 buffer_load_dwordx4 v17,s[8:11],s35 offen offset:3072 lds
 v_mfma_f32_16x16x32_bf16 v[80:83],a[132:135],a[204:207],v[80:83]
 ds_read_b128 a[192:195],v4 offset:4096
 v_mfma_f32_16x16x32_bf16 v[84:87],a[136:139],a[200:203],v[84:87]
 v_mfma_f32_16x16x32_bf16 v[84:87],a[140:143],a[204:207],v[84:87]
 ds_read_b128 a[196:199],v5 offset:4096
 s_add_u32 m0,s51,135168
 v_mfma_f32_16x16x32_bf16 v[88:91],a[144:147],a[200:203],v[88:91]
 v_mfma_f32_16x16x32_bf16 v[88:91],a[148:151],a[204:207],v[88:91]
 v_mfma_f32_16x16x32_bf16 v[92:95],a[152:155],a[200:203],v[92:95]
 v_mfma_f32_16x16x32_bf16 v[92:95],a[156:159],a[204:207],v[92:95]
 buffer_load_dwordx4 v18,s[8:11],s36 offen offset:0 lds
 v_mfma_f32_16x16x32_bf16 v[96:99],a[160:163],a[200:203],v[96:99]
 v_mfma_f32_16x16x32_bf16 v[96:99],a[164:167],a[204:207],v[96:99]
 v_mfma_f32_16x16x32_bf16 v[100:103],a[168:171],a[200:203],v[100:103]
 buffer_load_dwordx4 v19,s[8:11],s37 offen offset:1024 lds
 v_mfma_f32_16x16x32_bf16 v[100:103],a[172:175],a[204:207],v[100:103]
 v_mfma_f32_16x16x32_bf16 v[104:107],a[176:179],a[200:203],v[104:107]
 v_mfma_f32_16x16x32_bf16 v[104:107],a[180:183],a[204:207],v[104:107]
 v_mfma_f32_16x16x32_bf16 v[108:111],a[184:187],a[200:203],v[108:111]
 buffer_load_dwordx4 v18,s[8:11],s38 offen offset:2048 lds
 v_mfma_f32_16x16x32_bf16 v[108:111],a[188:191],a[204:207],v[108:111]
 s_waitcnt lgkmcnt(0)
 v_mfma_f32_16x16x32_bf16 v[112:115],a[128:131],a[192:195],v[112:115]
 v_mfma_f32_16x16x32_bf16 v[112:115],a[132:135],a[196:199],v[112:115]
 ds_read_b128 a[200:203],v4 offset:6144
 v_mfma_f32_16x16x32_bf16 v[116:119],a[136:139],a[192:195],v[116:119]
 buffer_load_dwordx4 v19,s[8:11],s39 offen offset:3072 lds
 v_mfma_f32_16x16x32_bf16 v[116:119],a[140:143],a[196:199],v[116:119]
 ds_read_b128 a[204:207],v5 offset:6144
 v_mfma_f32_16x16x32_bf16 v[120:123],a[144:147],a[192:195],v[120:123]
 v_mfma_f32_16x16x32_bf16 v[120:123],a[148:151],a[196:199],v[120:123]
 v_mfma_f32_16x16x32_bf16 v[124:127],a[152:155],a[192:195],v[124:127]
 s_add_u32 s8,s8,524288
 s_addc_u32 s9,s9,0
 v_mfma_f32_16x16x32_bf16 v[124:127],a[156:159],a[196:199],v[124:127]
 v_mfma_f32_16x16x32_bf16 v[128:131],a[160:163],a[192:195],v[128:131]
 v_mfma_f32_16x16x32_bf16 v[128:131],a[164:167],a[196:199],v[128:131]
 v_mfma_f32_16x16x32_bf16 v[132:135],a[168:171],a[192:195],v[132:135]
 s_sub_u32 s10,s10,524288
 v_mfma_f32_16x16x32_bf16 v[132:135],a[172:175],a[196:199],v[132:135]
 v_mfma_f32_16x16x32_bf16 v[136:139],a[176:179],a[192:195],v[136:139]
 v_mfma_f32_16x16x32_bf16 v[136:139],a[180:183],a[196:199],v[136:139]
 v_mfma_f32_16x16x32_bf16 v[140:143],a[184:187],a[192:195],v[140:143]
 s_add_u32 m0,s50,0
 v_mfma_f32_16x16x32_bf16 v[140:143],a[188:191],a[196:199],v[140:143]
 s_waitcnt lgkmcnt(0)
 v_mfma_f32_16x16x32_bf16 v[144:147],a[128:131],a[200:203],v[144:147]
 v_mfma_f32_16x16x32_bf16 v[144:147],a[132:135],a[204:207],v[144:147]
 ds_read_b128 a[192:195],v4 offset:8192
 v_mfma_f32_16x16x32_bf16 v[148:151],a[136:139],a[200:203],v[148:151]
 buffer_load_dwordx4 v14,s[4:7],s32 offen offset:0 lds
 v_mfma_f32_16x16x32_bf16 v[148:151],a[140:143],a[204:207],v[148:151]
 ds_read_b128 a[196:199],v5 offset:8192
 v_mfma_f32_16x16x32_bf16 v[152:155],a[144:147],a[200:203],v[152:155]
 v_mfma_f32_16x16x32_bf16 v[152:155],a[148:151],a[204:207],v[152:155]
 buffer_load_dwordx4 v15,s[4:7],s33 offen offset:1024 lds
 v_mfma_f32_16x16x32_bf16 v[156:159],a[152:155],a[200:203],v[156:159]
 v_mfma_f32_16x16x32_bf16 v[156:159],a[156:159],a[204:207],v[156:159]
 v_mfma_f32_16x16x32_bf16 v[160:163],a[160:163],a[200:203],v[160:163]
 s_waitcnt vmcnt(19)
 s_barrier
 v_mfma_f32_16x16x32_bf16 v[160:163],a[164:167],a[204:207],v[160:163]
 ds_read_b64_tr_b16 a[64:65],v6 offset:0
 v_mfma_f32_16x16x32_bf16 v[164:167],a[168:171],a[200:203],v[164:167]
 buffer_load_dwordx4 v14,s[4:7],s34 offen offset:2048 lds
 v_mfma_f32_16x16x32_bf16 v[164:167],a[172:175],a[204:207],v[164:167]
 ds_read_b64_tr_b16 a[66:67],v6 offset:2048
 ds_read_b64_tr_b16 a[68:69],v6 offset:16384
 v_mfma_f32_16x16x32_bf16 v[168:171],a[176:179],a[200:203],v[168:171]
 v_mfma_f32_16x16x32_bf16 v[168:171],a[180:183],a[204:207],v[168:171]
 ds_read_b64_tr_b16 a[70:71],v6 offset:18432
 v_mfma_f32_16x16x32_bf16 v[172:175],a[184:187],a[200:203],v[172:175]
 buffer_load_dwordx4 v15,s[4:7],s35 offen offset:3072 lds
 v_mfma_f32_16x16x32_bf16 v[172:175],a[188:191],a[204:207],v[172:175]
 s_waitcnt lgkmcnt(4)
 ds_read_b64_tr_b16 a[72:73],v7 offset:0
 v_mfma_f32_16x16x32_bf16 v[176:179],a[128:131],a[192:195],v[176:179]
 ds_read_b64_tr_b16 a[74:75],v7 offset:2048
 v_mfma_f32_16x16x32_bf16 v[176:179],a[132:135],a[196:199],v[176:179]
 ds_read_b128 a[200:203],v4 offset:10240
 s_add_u32 m0,s50,4096
 v_mfma_f32_16x16x32_bf16 v[180:183],a[136:139],a[192:195],v[180:183]
 ds_read_b64_tr_b16 a[76:77],v7 offset:16384
 v_mfma_f32_16x16x32_bf16 v[180:183],a[140:143],a[196:199],v[180:183]
 ds_read_b128 a[204:207],v5 offset:10240
 ds_read_b64_tr_b16 a[78:79],v7 offset:18432
 v_mfma_f32_16x16x32_bf16 v[184:187],a[144:147],a[192:195],v[184:187]
 ds_read_b64_tr_b16 a[80:81],v8 offset:0
 v_mfma_f32_16x16x32_bf16 v[184:187],a[148:151],a[196:199],v[184:187]
 buffer_load_dwordx4 v14,s[4:7],s36 offen offset:0 lds
 v_mfma_f32_16x16x32_bf16 v[188:191],a[152:155],a[192:195],v[188:191]
 ds_read_b64_tr_b16 a[82:83],v8 offset:2048
 v_mfma_f32_16x16x32_bf16 v[188:191],a[156:159],a[196:199],v[188:191]
 ds_read_b64_tr_b16 a[84:85],v8 offset:16384
 v_mfma_f32_16x16x32_bf16 v[192:195],a[160:163],a[192:195],v[192:195]
 v_mfma_f32_16x16x32_bf16 v[192:195],a[164:167],a[196:199],v[192:195]
 buffer_load_dwordx4 v15,s[4:7],s37 offen offset:1024 lds
 v_mfma_f32_16x16x32_bf16 v[196:199],a[168:171],a[192:195],v[196:199]
 ds_read_b64_tr_b16 a[86:87],v8 offset:18432
 ds_read_b64_tr_b16 a[88:89],v9 offset:0
 v_mfma_f32_16x16x32_bf16 v[196:199],a[172:175],a[196:199],v[196:199]
 v_mfma_f32_16x16x32_bf16 v[200:203],a[176:179],a[192:195],v[200:203]
 ds_read_b64_tr_b16 a[90:91],v9 offset:2048
 v_mfma_f32_16x16x32_bf16 v[200:203],a[180:183],a[196:199],v[200:203]
 buffer_load_dwordx4 v14,s[4:7],s38 offen offset:2048 lds
 v_mfma_f32_16x16x32_bf16 v[204:207],a[184:187],a[192:195],v[204:207]
 ds_read_b64_tr_b16 a[92:93],v9 offset:16384
 v_mfma_f32_16x16x32_bf16 v[204:207],a[188:191],a[196:199],v[204:207]
 s_waitcnt lgkmcnt(8)
 ds_read_b64_tr_b16 a[94:95],v9 offset:18432
 v_mfma_f32_16x16x32_bf16 v[208:211],a[128:131],a[200:203],v[208:211]
 ds_read_b64_tr_b16 a[96:97],v10 offset:0
 v_mfma_f32_16x16x32_bf16 v[208:211],a[132:135],a[204:207],v[208:211]
 buffer_load_dwordx4 v15,s[4:7],s39 offen offset:3072 lds
 v_mfma_f32_16x16x32_bf16 v[212:215],a[136:139],a[200:203],v[212:215]
 ds_read_b128 a[192:195],v4 offset:12288
 ds_read_b64_tr_b16 a[98:99],v10 offset:2048
 v_mfma_f32_16x16x32_bf16 v[212:215],a[140:143],a[204:207],v[212:215]
 ds_read_b128 a[196:199],v5 offset:12288
 ds_read_b64_tr_b16 a[100:101],v10 offset:16384
 v_mfma_f32_16x16x32_bf16 v[216:219],a[144:147],a[200:203],v[216:219]
 s_add_u32 s4,s4,128
 s_addc_u32 s5,s5,0
 v_mfma_f32_16x16x32_bf16 v[216:219],a[148:151],a[204:207],v[216:219]
 ds_read_b64_tr_b16 a[102:103],v10 offset:18432
 v_mfma_f32_16x16x32_bf16 v[220:223],a[152:155],a[200:203],v[220:223]
 ds_read_b64_tr_b16 a[104:105],v11 offset:0
 v_mfma_f32_16x16x32_bf16 v[220:223],a[156:159],a[204:207],v[220:223]
 ds_read_b64_tr_b16 a[106:107],v11 offset:2048
 v_mfma_f32_16x16x32_bf16 v[224:227],a[160:163],a[200:203],v[224:227]
 s_sub_u32 s6,s6,128
 v_mfma_f32_16x16x32_bf16 v[224:227],a[164:167],a[204:207],v[224:227]
 ds_read_b64_tr_b16 a[108:109],v11 offset:16384
 v_mfma_f32_16x16x32_bf16 v[228:231],a[168:171],a[200:203],v[228:231]
 ds_read_b64_tr_b16 a[110:111],v11 offset:18432
 v_mfma_f32_16x16x32_bf16 v[228:231],a[172:175],a[204:207],v[228:231]
 v_mfma_f32_16x16x32_bf16 v[232:235],a[176:179],a[200:203],v[232:235]
 ds_read_b64_tr_b16 a[112:113],v12 offset:0
 s_add_u32 s50,s50,32768
 v_mfma_f32_16x16x32_bf16 v[232:235],a[180:183],a[204:207],v[232:235]
 ds_read_b64_tr_b16 a[114:115],v12 offset:2048
 v_mfma_f32_16x16x32_bf16 v[236:239],a[184:187],a[200:203],v[236:239]
 v_mfma_f32_16x16x32_bf16 v[236:239],a[188:191],a[204:207],v[236:239]
 s_waitcnt lgkmcnt(8)
 ds_read_b64_tr_b16 a[116:117],v12 offset:16384
 v_mfma_f32_16x16x32_bf16 v[240:243],a[128:131],a[192:195],v[240:243]
 s_cmp_ge_u32 s50,98304
 s_cselect_b32 s50,s51,s50
 v_mfma_f32_16x16x32_bf16 v[240:243],a[132:135],a[196:199],v[240:243]
 ds_read_b64_tr_b16 a[118:119],v12 offset:18432
 ds_read_b128 a[200:203],v4 offset:14336
 v_mfma_f32_16x16x32_bf16 v[244:247],a[136:139],a[192:195],v[244:247]
 ds_read_b64_tr_b16 a[120:121],v13 offset:0
 v_mfma_f32_16x16x32_bf16 v[244:247],a[140:143],a[196:199],v[244:247]
 ds_read_b128 a[204:207],v5 offset:14336
 ds_read_b64_tr_b16 a[122:123],v13 offset:2048
 v_mfma_f32_16x16x32_bf16 v[248:251],a[144:147],a[192:195],v[248:251]
 v_mfma_f32_16x16x32_bf16 v[248:251],a[148:151],a[196:199],v[248:251]
 ds_read_b64_tr_b16 a[124:125],v13 offset:16384
 v_mfma_f32_16x16x32_bf16 v[252:255],a[152:155],a[192:195],v[252:255]
 ds_read_b64_tr_b16 a[126:127],v13 offset:18432
 v_mfma_f32_16x16x32_bf16 v[252:255],a[156:159],a[196:199],v[252:255]
 v_mfma_f32_16x16x32_bf16 a[208:211],a[160:163],a[192:195],a[208:211]
 v_mfma_f32_16x16x32_bf16 a[208:211],a[164:167],a[196:199],a[208:211]
 s_add_u32 s55,s55,32768
 v_mfma_f32_16x16x32_bf16 a[212:215],a[168:171],a[192:195],a[212:215]
 s_cmp_ge_u32 s55,98304
 s_cselect_b32 s55,s54,s55
 v_mfma_f32_16x16x32_bf16 a[212:215],a[172:175],a[196:199],a[212:215]
 v_add_u32 v4,s55,v2
 v_mfma_f32_16x16x32_bf16 a[216:219],a[176:179],a[192:195],a[216:219]
 v_add_u32 v5,s55,v3
 v_mfma_f32_16x16x32_bf16 a[216:219],a[180:183],a[196:199],a[216:219]
 v_mfma_f32_16x16x32_bf16 a[220:223],a[184:187],a[192:195],a[220:223]
 v_mfma_f32_16x16x32_bf16 a[220:223],a[188:191],a[196:199],a[220:223]
 s_waitcnt vmcnt(17) lgkmcnt(0)
 s_barrier
 v_mfma_f32_16x16x32_bf16 a[224:227],a[128:131],a[200:203],a[224:227]
 ds_read_b128 a[192:195],v4 offset:0
 v_mfma_f32_16x16x32_bf16 a[224:227],a[132:135],a[204:207],a[224:227]
 ds_read_b128 a[196:199],v5 offset:0
 v_mfma_f32_16x16x32_bf16 a[228:231],a[136:139],a[200:203],a[228:231]
 v_mfma_f32_16x16x32_bf16 a[228:231],a[140:143],a[204:207],a[228:231]
 v_mfma_f32_16x16x32_bf16 a[232:235],a[144:147],a[200:203],a[232:235]
 v_mfma_f32_16x16x32_bf16 a[232:235],a[148:151],a[204:207],a[232:235]
 v_mfma_f32_16x16x32_bf16 a[236:239],a[152:155],a[200:203],a[236:239]
 v_mfma_f32_16x16x32_bf16 a[236:239],a[156:159],a[204:207],a[236:239]
 v_mfma_f32_16x16x32_bf16 a[240:243],a[160:163],a[200:203],a[240:243]
 v_mfma_f32_16x16x32_bf16 a[240:243],a[164:167],a[204:207],a[240:243]
 v_mfma_f32_16x16x32_bf16 a[244:247],a[168:171],a[200:203],a[244:247]
 v_mfma_f32_16x16x32_bf16 a[244:247],a[172:175],a[204:207],a[244:247]
 v_mfma_f32_16x16x32_bf16 a[248:251],a[176:179],a[200:203],a[248:251]
 v_mfma_f32_16x16x32_bf16 a[248:251],a[180:183],a[204:207],a[248:251]
 v_mfma_f32_16x16x32_bf16 a[252:255],a[184:187],a[200:203],a[252:255]
 v_mfma_f32_16x16x32_bf16 a[252:255],a[188:191],a[204:207],a[252:255]
 s_waitcnt lgkmcnt(0)
 s_cmp_eq_u32 s49,6
 s_cbranch_scc0 QS_54
 s_cmp_eq_u32 s45,0
 s_cbranch_scc0 QS_54
 s_add_u32 s61,s77,224
 s_lshl_b32 s61,s61,7
 s_add_u32 s61,s61,125829120
 v_mov_b32 v25,1
 v_mov_b32 v26,0
 s_mov_b64 exec,1
 buffer_atomic_add v25,v26,s[28:31],s61 offen sc1
 s_mov_b64 exec,-1
QS_54:
 s_cmp_eq_u32 s49,2
 s_cbranch_scc0 QL_55
 s_add_u32 s61,s46,224
 s_lshl_b32 s61,s61,7
 s_add_u32 s61,s61,125829120
 v_mov_b32 v29,s61
 v_mov_b32 v30,8
 buffer_load_dword v31,v29,s[28:31],0 offen sc1
QL_55:
 s_sub_u32 s49,s49,1
 s_cmp_lg_u32 s49,0
 s_cbranch_scc1 KVL_53
 s_getpc_b64 s[60:61]
PC_57:
 s_add_u32 s60,s60,G2T_56-PC_57
 s_addc_u32 s61,s61,(G2T_56-PC_57)>>32
 s_bfe_u32 s62,s2,0x30004
 s_lshl_b32 s62,s62,2
 s_add_u32 s62,s62,s45
 v_and_b32 v25,63,v0
 v_mul_u32_u24 v25,32,v25
 v_add_lshl_u32 v25,v25,s62,7
 v_min_u32 v25,G2T_56E-G2T_56-4,v25
 global_load_dword v24,v25,s[60:61]
G2T_56:
 v_lshrrev_b32 v16,6,v0
 v_lshl_add_u32 v14,v16,13,v1
 v_add_u32 v15,4096,v14
 s_mov_b32 s49,1103101952
 s_sub_u32 s61,15,s59
 s_min_u32 s48,s61,s59
 s_sub_u32 s41,15,s48
 s_mul_i32 s36,s46,229376
 s_add_u32 s36,s36,104857600
 s_mov_b32 s53,2
 s_mov_b32 s67,0
 s_mov_b32 s72,0
 s_mul_i32 s62,s59,3
 s_min_u32 s62,s62,30
 s_lshr_b32 s73,0x92492,s62
 s_and_b32 s73,s73,7
 s_mov_b32 s74,14
 s_lshl_b32 s62,s59,2
 s_lshr_b32 s62,0xeca86420,s62
 s_and_b32 s62,s62,15
 s_cmp_lt_u32 s59,8
 s_cselect_b32 s74,s62,s74
 s_lshl_b32 s52,s41,1
 s_sub_i32 s52,s52,16
 s_cmp_lt_i32 s52,2
 s_cselect_b32 s52,0,s52
 s_cmp_eq_u32 s52,1
 s_cselect_b32 s52,2,s52
 s_lshl_b32 s43,s41,1
 s_add_u32 s43,s43,2
 s_sub_u32 s43,s43,s52
 s_mov_b32 s39,1
 s_mov_b32 s40,2
 s_min_u32 s44,s52,1
 s_mov_b32 s50,0
 s_min_u32 s42,s52,8
 s_sub_u32 s52,s52,s42
 s_mov_b32 s34,16
 s_add_u32 s67,s46,192
 s_lshl_b32 s61,s46,3
 s_add_u32 s61,s61,s48
 s_lshl_b32 s66,s61,2
 s_add_u32 s66,s66,s45
 s_lshl_b32 s66,s66,10
 s_add_u32 s66,s66,126877696
 s_lshl_b32 s61,s61,7
 s_add_u32 s61,s61,125837312
 s_lshl_b32 s62,s46,20
 s_lshl_b32 s32,s42,15
 s_add_u32 s32,s32,s62
 s_add_u32 s33,s32,16777216
 s_lshl_b32 s47,s41,3
 s_add_u32 s47,s47,s45
 s_lshl_b32 s47,s47,13
 s_add_u32 s47,s47,s62
 s_add_u32 s47,s47,33554432
 s_lshl_b32 s63,s48,3
 s_add_u32 s63,s63,s45
 s_lshl_b32 s63,s63,13
 s_add_u32 s63,s63,s62
 s_add_u32 s63,s63,33554432
 s_add_u32 s65,s47,16777216
 s_lshl_b32 s64,s46,16
 s_add_u32 s64,s64,s51
 s_add_u32 s64,s64,100663296
 s_cmp_lg_u32 s73,0
 s_cselect_b32 s64,s64,0xf0000000
 s_cmp_eq_u32 s44,1
 s_cselect_b32 s65,s65,s64
 s_add_u32 s64,s36,65536
 s_cmp_eq_u32 s50,1
 s_cselect_b32 s35,s62,s36
 s_cselect_b32 s65,s63,s65
 s_cselect_b32 s64,s33,s64
 s_sub_u32 s38,s43,1
 s_and_b32 s63,s43,1
 s_lshl_b32 s68,s63,15
 s_add_u32 s68,s68,s51
 s_xor_b32 s69,s68,0x8000
 s_sub_u32 s63,s38,s63
 s_sub_i32 s62,s63,2
 s_cmp_ge_i32 s62,3
 s_cselect_b32 s63,s62,s63
 s_sub_i32 s62,s43,5
 s_or_b32 s62,s62,1
 s_cmp_ge_i32 s62,3
 s_cselect_b32 s63,s62,s63
 s_mul_i32 s62,s50,8
 s_cmp_le_u32 s43,s62
 s_cselect_b32 s63,-2,s63
 s_cmp_eq_u32 s53,-1
 s_cselect_b32 s53,-1,s63
 s_lshl_b32 s61,s45,14
 s_sub_u32 s61,57344,s61
 v_add_u32 v38,s61,v1
FL_58:
 v_cmp_lt_u32 vcc,v31,v30
 s_nop 4
 s_cbranch_vccz FL_58D
 s_sleep 2
 buffer_load_dword v31,v29,s[28:31],0 offen sc1
 s_waitcnt vmcnt(0)
 s_branch FL_58
FL_58D:
 s_add_u32 s61,s46,0
 s_lshl_b32 s61,s61,7
 s_add_u32 s61,s61,125829120
 v_mov_b32 v29,s61
 v_mov_b32 v30,8
 buffer_load_dword v31,v29,s[28:31],0 offen sc1
 s_and_b32 s62,s68,0x8000
 s_xor_b32 s63,s62,0x8000
 s_add_u32 s37,s32,s63
 s_add_u32 s32,s32,s62
 v_mfma_f32_16x16x32_bf16 v[48:51],a[64:67],a[192:195],v[48:51]
 s_add_u32 s61,s47,0
 v_mfma_f32_16x16x32_bf16 v[48:51],a[68:71],a[196:199],v[48:51]
 ds_read_b128 a[200:203],v4 offset:2048
 v_mfma_f32_16x16x32_bf16 v[52:55],a[72:75],a[192:195],v[52:55]
 v_mfma_f32_16x16x32_bf16 v[52:55],a[76:79],a[196:199],v[52:55]
 ds_read_b128 a[204:207],v5 offset:2048
 v_mfma_f32_16x16x32_bf16 v[56:59],a[80:83],a[192:195],v[56:59]
 buffer_load_dwordx4 a[0:3],v1,s[28:31],s61 offen offset:0 sc1
 v_mfma_f32_16x16x32_bf16 v[56:59],a[84:87],a[196:199],v[56:59]
 v_mfma_f32_16x16x32_bf16 v[60:63],a[88:91],a[192:195],v[60:63]
 buffer_load_dwordx4 a[4:7],v1,s[28:31],s61 offen offset:1024 sc1
 v_mfma_f32_16x16x32_bf16 v[60:63],a[92:95],a[196:199],v[60:63]
 v_mfma_f32_16x16x32_bf16 v[64:67],a[96:99],a[192:195],v[64:67]
 v_mfma_f32_16x16x32_bf16 v[64:67],a[100:103],a[196:199],v[64:67]
 buffer_load_dwordx4 a[8:11],v1,s[28:31],s61 offen offset:2048 sc1
 v_mfma_f32_16x16x32_bf16 v[68:71],a[104:107],a[192:195],v[68:71]
 v_mfma_f32_16x16x32_bf16 v[68:71],a[108:111],a[196:199],v[68:71]
 v_mfma_f32_16x16x32_bf16 v[72:75],a[112:115],a[192:195],v[72:75]
 buffer_load_dwordx4 a[12:15],v1,s[28:31],s61 offen offset:3072 sc1
 v_mfma_f32_16x16x32_bf16 v[72:75],a[116:119],a[196:199],v[72:75]
 v_mfma_f32_16x16x32_bf16 v[76:79],a[120:123],a[192:195],v[76:79]
 v_mfma_f32_16x16x32_bf16 v[76:79],a[124:127],a[196:199],v[76:79]
 s_waitcnt lgkmcnt(0)
 s_add_u32 s61,s47,4096
 v_mfma_f32_16x16x32_bf16 v[80:83],a[64:67],a[200:203],v[80:83]
 v_mfma_f32_16x16x32_bf16 v[80:83],a[68:71],a[204:207],v[80:83]
 ds_read_b128 a[192:195],v4 offset:4096
 v_mfma_f32_16x16x32_bf16 v[84:87],a[72:75],a[200:203],v[84:87]
 buffer_load_dwordx4 a[16:19],v1,s[28:31],s61 offen offset:0 sc1
 v_mfma_f32_16x16x32_bf16 v[84:87],a[76:79],a[204:207],v[84:87]
 ds_read_b128 a[196:199],v5 offset:4096
 v_mfma_f32_16x16x32_bf16 v[88:91],a[80:83],a[200:203],v[88:91]
 v_mfma_f32_16x16x32_bf16 v[88:91],a[84:87],a[204:207],v[88:91]
 buffer_load_dwordx4 a[20:23],v1,s[28:31],s61 offen offset:1024 sc1
 v_mfma_f32_16x16x32_bf16 v[92:95],a[88:91],a[200:203],v[92:95]
 v_mfma_f32_16x16x32_bf16 v[92:95],a[92:95],a[204:207],v[92:95]
 v_mfma_f32_16x16x32_bf16 v[96:99],a[96:99],a[200:203],v[96:99]
 buffer_load_dwordx4 a[24:27],v1,s[28:31],s61 offen offset:2048 sc1
 v_mfma_f32_16x16x32_bf16 v[96:99],a[100:103],a[204:207],v[96:99]
 v_mfma_f32_16x16x32_bf16 v[100:103],a[104:107],a[200:203],v[100:103]
 v_mfma_f32_16x16x32_bf16 v[100:103],a[108:111],a[204:207],v[100:103]
 buffer_load_dwordx4 a[28:31],v1,s[28:31],s61 offen offset:3072 sc1
 v_mfma_f32_16x16x32_bf16 v[104:107],a[112:115],a[200:203],v[104:107]
 v_mfma_f32_16x16x32_bf16 v[104:107],a[116:119],a[204:207],v[104:107]
 v_mfma_f32_16x16x32_bf16 v[108:111],a[120:123],a[200:203],v[108:111]
 s_add_u32 s61,s47,0
 v_mfma_f32_16x16x32_bf16 v[108:111],a[124:127],a[204:207],v[108:111]
 s_waitcnt lgkmcnt(0)
 v_mfma_f32_16x16x32_bf16 v[112:115],a[64:67],a[192:195],v[112:115]
 v_mfma_f32_16x16x32_bf16 v[112:115],a[68:71],a[196:199],v[112:115]
 ds_read_b128 a[200:203],v4 offset:6144
 v_mfma_f32_16x16x32_bf16 v[116:119],a[72:75],a[192:195],v[116:119]
 buffer_load_dwordx4 a[32:35],v38,s[28:31],s61 offen offset:0 sc1
 v_mfma_f32_16x16x32_bf16 v[116:119],a[76:79],a[196:199],v[116:119]
 ds_read_b128 a[204:207],v5 offset:6144
 v_mfma_f32_16x16x32_bf16 v[120:123],a[80:83],a[192:195],v[120:123]
 buffer_load_dwordx4 a[36:39],v38,s[28:31],s61 offen offset:1024 sc1
 v_mfma_f32_16x16x32_bf16 v[120:123],a[84:87],a[196:199],v[120:123]
 v_mfma_f32_16x16x32_bf16 v[124:127],a[88:91],a[192:195],v[124:127]
 v_mfma_f32_16x16x32_bf16 v[124:127],a[92:95],a[196:199],v[124:127]
 buffer_load_dwordx4 a[40:43],v38,s[28:31],s61 offen offset:2048 sc1
 v_mfma_f32_16x16x32_bf16 v[128:131],a[96:99],a[192:195],v[128:131]
 v_mfma_f32_16x16x32_bf16 v[128:131],a[100:103],a[196:199],v[128:131]
 v_mfma_f32_16x16x32_bf16 v[132:135],a[104:107],a[192:195],v[132:135]
 buffer_load_dwordx4 a[44:47],v38,s[28:31],s61 offen offset:3072 sc1
 v_mfma_f32_16x16x32_bf16 v[132:135],a[108:111],a[196:199],v[132:135]
 v_mfma_f32_16x16x32_bf16 v[136:139],a[112:115],a[192:195],v[136:139]
 v_mfma_f32_16x16x32_bf16 v[136:139],a[116:119],a[196:199],v[136:139]
 s_add_u32 s61,s47,4096
 v_mfma_f32_16x16x32_bf16 v[140:143],a[120:123],a[192:195],v[140:143]
 v_mfma_f32_16x16x32_bf16 v[140:143],a[124:127],a[196:199],v[140:143]
 s_waitcnt lgkmcnt(0)
 v_mfma_f32_16x16x32_bf16 v[144:147],a[64:67],a[200:203],v[144:147]
 buffer_load_dwordx4 a[48:51],v38,s[28:31],s61 offen offset:0 sc1
 v_mfma_f32_16x16x32_bf16 v[144:147],a[68:71],a[204:207],v[144:147]
 ds_read_b128 a[192:195],v4 offset:8192
 v_mfma_f32_16x16x32_bf16 v[148:151],a[72:75],a[200:203],v[148:151]
 v_mfma_f32_16x16x32_bf16 v[148:151],a[76:79],a[204:207],v[148:151]
 ds_read_b128 a[196:199],v5 offset:8192
 v_mfma_f32_16x16x32_bf16 v[152:155],a[80:83],a[200:203],v[152:155]
 buffer_load_dwordx4 a[52:55],v38,s[28:31],s61 offen offset:1024 sc1
 v_mfma_f32_16x16x32_bf16 v[152:155],a[84:87],a[204:207],v[152:155]
 v_mfma_f32_16x16x32_bf16 v[156:159],a[88:91],a[200:203],v[156:159]
 buffer_load_dwordx4 a[56:59],v38,s[28:31],s61 offen offset:2048 sc1
 v_mfma_f32_16x16x32_bf16 v[156:159],a[92:95],a[204:207],v[156:159]
 v_mfma_f32_16x16x32_bf16 v[160:163],a[96:99],a[200:203],v[160:163]
 s_waitcnt vmcnt(15)
 s_barrier
 v_mfma_f32_16x16x32_bf16 v[160:163],a[100:103],a[204:207],v[160:163]
 ds_read_b64_tr_b16 a[128:129],v6 offset:32768
 v_mfma_f32_16x16x32_bf16 v[164:167],a[104:107],a[200:203],v[164:167]
 buffer_load_dwordx4 a[60:63],v38,s[28:31],s61 offen offset:3072 sc1
 v_mfma_f32_16x16x32_bf16 v[164:167],a[108:111],a[204:207],v[164:167]
 ds_read_b64_tr_b16 a[130:131],v6 offset:34816
 ds_read_b64_tr_b16 a[132:133],v6 offset:49152
 v_mfma_f32_16x16x32_bf16 v[168:171],a[112:115],a[200:203],v[168:171]
 v_cmp_lt_u32 vcc,v31,v30
 v_mfma_f32_16x16x32_bf16 v[168:171],a[116:119],a[204:207],v[168:171]
 ds_read_b64_tr_b16 a[134:135],v6 offset:51200
 v_mfma_f32_16x16x32_bf16 v[172:175],a[120:123],a[200:203],v[172:175]
 ds_read_b64_tr_b16 a[136:137],v7 offset:32768
 v_mfma_f32_16x16x32_bf16 v[172:175],a[124:127],a[204:207],v[172:175]
 s_waitcnt lgkmcnt(5)
 s_cbranch_vccnz FLX_59
FLX_59R:
 v_mfma_f32_16x16x32_bf16 v[176:179],a[64:67],a[192:195],v[176:179]
 s_add_u32 m0,s51,0
 ds_read_b64_tr_b16 a[138:139],v7 offset:34816
 v_mfma_f32_16x16x32_bf16 v[176:179],a[68:71],a[196:199],v[176:179]
 ds_read_b128 a[200:203],v4 offset:10240
 ds_read_b64_tr_b16 a[140:141],v7 offset:49152
 v_mfma_f32_16x16x32_bf16 v[180:183],a[72:75],a[192:195],v[180:183]
 v_mfma_f32_16x16x32_bf16 v[180:183],a[76:79],a[196:199],v[180:183]
 ds_read_b128 a[204:207],v5 offset:10240
 ds_read_b64_tr_b16 a[142:143],v7 offset:51200
 v_mfma_f32_16x16x32_bf16 v[184:187],a[80:83],a[192:195],v[184:187]
 ds_read_b64_tr_b16 a[144:145],v8 offset:32768
 v_mfma_f32_16x16x32_bf16 v[184:187],a[84:87],a[196:199],v[184:187]
 buffer_load_dwordx4 v14,s[28:31],s32 offen offset:0 sc1 lds
 v_mfma_f32_16x16x32_bf16 v[188:191],a[88:91],a[192:195],v[188:191]
 ds_read_b64_tr_b16 a[146:147],v8 offset:34816
 v_mfma_f32_16x16x32_bf16 v[188:191],a[92:95],a[196:199],v[188:191]
 ds_read_b64_tr_b16 a[148:149],v8 offset:49152
 v_mfma_f32_16x16x32_bf16 v[192:195],a[96:99],a[192:195],v[192:195]
 v_mfma_f32_16x16x32_bf16 v[192:195],a[100:103],a[196:199],v[192:195]
 ds_read_b64_tr_b16 a[150:151],v8 offset:51200
 v_mfma_f32_16x16x32_bf16 v[196:199],a[104:107],a[192:195],v[196:199]
 ds_read_b64_tr_b16 a[152:153],v9 offset:32768
 v_mfma_f32_16x16x32_bf16 v[196:199],a[108:111],a[196:199],v[196:199]
 buffer_load_dwordx4 v14,s[28:31],s32 offen offset:1024 sc1 lds
 v_mfma_f32_16x16x32_bf16 v[200:203],a[112:115],a[192:195],v[200:203]
 ds_read_b64_tr_b16 a[154:155],v9 offset:34816
 v_mfma_f32_16x16x32_bf16 v[200:203],a[116:119],a[196:199],v[200:203]
 ds_read_b64_tr_b16 a[156:157],v9 offset:49152
 v_mfma_f32_16x16x32_bf16 v[204:207],a[120:123],a[192:195],v[204:207]
 v_mfma_f32_16x16x32_bf16 v[204:207],a[124:127],a[196:199],v[204:207]
 s_waitcnt lgkmcnt(8)
 ds_read_b64_tr_b16 a[158:159],v9 offset:51200
 v_mfma_f32_16x16x32_bf16 v[208:211],a[64:67],a[200:203],v[208:211]
 ds_read_b64_tr_b16 a[160:161],v10 offset:32768
 v_mfma_f32_16x16x32_bf16 v[208:211],a[68:71],a[204:207],v[208:211]
 buffer_load_dwordx4 v14,s[28:31],s32 offen offset:2048 sc1 lds
 v_mfma_f32_16x16x32_bf16 v[212:215],a[72:75],a[200:203],v[212:215]
 ds_read_b128 a[192:195],v4 offset:12288
 ds_read_b64_tr_b16 a[162:163],v10 offset:34816
 v_mfma_f32_16x16x32_bf16 v[212:215],a[76:79],a[204:207],v[212:215]
 ds_read_b128 a[196:199],v5 offset:12288
 ds_read_b64_tr_b16 a[164:165],v10 offset:49152
 v_mfma_f32_16x16x32_bf16 v[216:219],a[80:83],a[200:203],v[216:219]
 ds_read_b64_tr_b16 a[166:167],v10 offset:51200
 v_mfma_f32_16x16x32_bf16 v[216:219],a[84:87],a[204:207],v[216:219]
 v_mfma_f32_16x16x32_bf16 v[220:223],a[88:91],a[200:203],v[220:223]
 ds_read_b64_tr_b16 a[168:169],v11 offset:32768
 v_mfma_f32_16x16x32_bf16 v[220:223],a[92:95],a[204:207],v[220:223]
 buffer_load_dwordx4 v14,s[28:31],s32 offen offset:3072 sc1 lds
 v_mfma_f32_16x16x32_bf16 v[224:227],a[96:99],a[200:203],v[224:227]
 ds_read_b64_tr_b16 a[170:171],v11 offset:34816
 v_mfma_f32_16x16x32_bf16 v[224:227],a[100:103],a[204:207],v[224:227]
 ds_read_b64_tr_b16 a[172:173],v11 offset:49152
 v_mfma_f32_16x16x32_bf16 v[228:231],a[104:107],a[200:203],v[228:231]
 ds_read_b64_tr_b16 a[174:175],v11 offset:51200
 v_mfma_f32_16x16x32_bf16 v[228:231],a[108:111],a[204:207],v[228:231]
 v_mfma_f32_16x16x32_bf16 v[232:235],a[112:115],a[200:203],v[232:235]
 s_add_u32 m0,s51,4096
 ds_read_b64_tr_b16 a[176:177],v12 offset:32768
 v_mfma_f32_16x16x32_bf16 v[232:235],a[116:119],a[204:207],v[232:235]
 ds_read_b64_tr_b16 a[178:179],v12 offset:34816
 v_mfma_f32_16x16x32_bf16 v[236:239],a[120:123],a[200:203],v[236:239]
 v_mfma_f32_16x16x32_bf16 v[236:239],a[124:127],a[204:207],v[236:239]
 s_waitcnt lgkmcnt(8)
 ds_read_b64_tr_b16 a[180:181],v12 offset:49152
 v_mfma_f32_16x16x32_bf16 v[240:243],a[64:67],a[192:195],v[240:243]
 ds_read_b64_tr_b16 a[182:183],v12 offset:51200
 v_mfma_f32_16x16x32_bf16 v[240:243],a[68:71],a[196:199],v[240:243]
 ds_read_b128 a[200:203],v4 offset:14336
 v_mfma_f32_16x16x32_bf16 v[244:247],a[72:75],a[192:195],v[244:247]
 buffer_load_dwordx4 v15,s[28:31],s32 offen offset:0 sc1 lds
 v_mfma_f32_16x16x32_bf16 v[244:247],a[76:79],a[196:199],v[244:247]
 ds_read_b64_tr_b16 a[184:185],v13 offset:32768
 ds_read_b128 a[204:207],v5 offset:14336
 v_mfma_f32_16x16x32_bf16 v[248:251],a[80:83],a[192:195],v[248:251]
 ds_read_b64_tr_b16 a[186:187],v13 offset:34816
 v_mfma_f32_16x16x32_bf16 v[248:251],a[84:87],a[196:199],v[248:251]
 ds_read_b64_tr_b16 a[188:189],v13 offset:49152
 v_mfma_f32_16x16x32_bf16 v[252:255],a[88:91],a[192:195],v[252:255]
 ds_read_b64_tr_b16 a[190:191],v13 offset:51200
 v_mfma_f32_16x16x32_bf16 v[252:255],a[92:95],a[196:199],v[252:255]
 buffer_load_dwordx4 v15,s[28:31],s32 offen offset:1024 sc1 lds
 v_mfma_f32_16x16x32_bf16 a[208:211],a[96:99],a[192:195],a[208:211]
 v_mfma_f32_16x16x32_bf16 a[208:211],a[100:103],a[196:199],a[208:211]
 s_add_u32 s55,s55,32768
 v_mfma_f32_16x16x32_bf16 a[212:215],a[104:107],a[192:195],a[212:215]
 s_cmp_ge_u32 s55,98304
 s_cselect_b32 s55,s54,s55
 v_mfma_f32_16x16x32_bf16 a[212:215],a[108:111],a[196:199],a[212:215]
 v_add_u32 v4,s55,v2
 v_mfma_f32_16x16x32_bf16 a[216:219],a[112:115],a[192:195],a[216:219]
 v_add_u32 v5,s55,v3
 v_mfma_f32_16x16x32_bf16 a[216:219],a[116:119],a[196:199],a[216:219]
 buffer_load_dwordx4 v15,s[28:31],s32 offen offset:2048 sc1 lds
 v_mfma_f32_16x16x32_bf16 a[220:223],a[120:123],a[192:195],a[220:223]
 v_mfma_f32_16x16x32_bf16 a[220:223],a[124:127],a[196:199],a[220:223]
 s_waitcnt vmcnt(25) lgkmcnt(0)
 s_barrier
 v_mfma_f32_16x16x32_bf16 a[224:227],a[64:67],a[200:203],a[224:227]
 ds_read_b128 a[192:195],v4 offset:0
 v_mfma_f32_16x16x32_bf16 a[224:227],a[68:71],a[204:207],a[224:227]
 ds_read_b128 a[196:199],v5 offset:0
 v_mfma_f32_16x16x32_bf16 a[228:231],a[72:75],a[200:203],a[228:231]
 buffer_load_dwordx4 v15,s[28:31],s32 offen offset:3072 sc1 lds
 v_mfma_f32_16x16x32_bf16 a[228:231],a[76:79],a[204:207],a[228:231]
 v_mfma_f32_16x16x32_bf16 a[232:235],a[80:83],a[200:203],a[232:235]
 v_mfma_f32_16x16x32_bf16 a[232:235],a[84:87],a[204:207],a[232:235]
 v_mfma_f32_16x16x32_bf16 a[236:239],a[88:91],a[200:203],a[236:239]
 v_mfma_f32_16x16x32_bf16 a[236:239],a[92:95],a[204:207],a[236:239]
 v_mfma_f32_16x16x32_bf16 a[240:243],a[96:99],a[200:203],a[240:243]
 s_mov_b32 s32,s37
 v_mfma_f32_16x16x32_bf16 a[240:243],a[100:103],a[204:207],a[240:243]
 v_mfma_f32_16x16x32_bf16 a[244:247],a[104:107],a[200:203],a[244:247]
 v_mfma_f32_16x16x32_bf16 a[244:247],a[108:111],a[204:207],a[244:247]
 v_mfma_f32_16x16x32_bf16 a[248:251],a[112:115],a[200:203],a[248:251]
 v_mfma_f32_16x16x32_bf16 a[248:251],a[116:119],a[204:207],a[248:251]
 v_mfma_f32_16x16x32_bf16 a[252:255],a[120:123],a[200:203],a[252:255]
 v_mfma_f32_16x16x32_bf16 a[252:255],a[124:127],a[204:207],a[252:255]
 s_waitcnt lgkmcnt(0)
 v_mfma_f32_16x16x32_bf16 v[48:51],a[128:131],a[192:195],v[48:51]
 s_add_u32 m0,s51,32768
 v_mfma_f32_16x16x32_bf16 v[48:51],a[132:135],a[196:199],v[48:51]
 ds_read_b128 a[200:203],v4 offset:2048
 v_mfma_f32_16x16x32_bf16 v[52:55],a[136:139],a[192:195],v[52:55]
 v_mfma_f32_16x16x32_bf16 v[52:55],a[140:143],a[196:199],v[52:55]
 ds_read_b128 a[204:207],v5 offset:2048
 v_mfma_f32_16x16x32_bf16 v[56:59],a[144:147],a[192:195],v[56:59]
 buffer_load_dwordx4 v14,s[28:31],s32 offen offset:0 sc1 lds
 v_mfma_f32_16x16x32_bf16 v[56:59],a[148:151],a[196:199],v[56:59]
 v_mfma_f32_16x16x32_bf16 v[60:63],a[152:155],a[192:195],v[60:63]
 buffer_load_dwordx4 v14,s[28:31],s32 offen offset:1024 sc1 lds
 v_mfma_f32_16x16x32_bf16 v[60:63],a[156:159],a[196:199],v[60:63]
 v_mfma_f32_16x16x32_bf16 v[64:67],a[160:163],a[192:195],v[64:67]
 v_mfma_f32_16x16x32_bf16 v[64:67],a[164:167],a[196:199],v[64:67]
 buffer_load_dwordx4 v14,s[28:31],s32 offen offset:2048 sc1 lds
 v_mfma_f32_16x16x32_bf16 v[68:71],a[168:171],a[192:195],v[68:71]
 v_mfma_f32_16x16x32_bf16 v[68:71],a[172:175],a[196:199],v[68:71]
 v_mul_f32 v48,s58,v48
 v_mul_f32 v49,s58,v49
 v_mfma_f32_16x16x32_bf16 v[72:75],a[176:179],a[192:195],v[72:75]
 buffer_load_dwordx4 v14,s[28:31],s32 offen offset:3072 sc1 lds
 v_mfma_f32_16x16x32_bf16 v[72:75],a[180:183],a[196:199],v[72:75]
 v_mul_f32 v50,s58,v50
 v_mul_f32 v51,s58,v51
 v_mfma_f32_16x16x32_bf16 v[76:79],a[184:187],a[192:195],v[76:79]
 v_mul_f32 v52,s58,v52
 v_mul_f32 v53,s58,v53
 v_mfma_f32_16x16x32_bf16 v[76:79],a[188:191],a[196:199],v[76:79]
 s_waitcnt lgkmcnt(0)
 v_mul_f32 v54,s58,v54
 v_mfma_f32_16x16x32_bf16 v[80:83],a[128:131],a[200:203],v[80:83]
 s_add_u32 m0,s51,36864
 v_mul_f32 v55,s58,v55
 v_mfma_f32_16x16x32_bf16 v[80:83],a[132:135],a[204:207],v[80:83]
 ds_read_b128 a[192:195],v4 offset:4096
 v_cvt_pk_bf16_f32 v48,v48,v49
 v_mfma_f32_16x16x32_bf16 v[84:87],a[136:139],a[200:203],v[84:87]
 v_cvt_pk_bf16_f32 v49,v50,v51
 v_cvt_pk_bf16_f32 v50,v52,v53
 v_mfma_f32_16x16x32_bf16 v[84:87],a[140:143],a[204:207],v[84:87]
 ds_read_b128 a[196:199],v5 offset:4096
 v_cvt_pk_bf16_f32 v51,v54,v55
 v_mfma_f32_16x16x32_bf16 v[88:91],a[144:147],a[200:203],v[88:91]
 buffer_load_dwordx4 v15,s[28:31],s32 offen offset:0 sc1 lds
 v_mfma_f32_16x16x32_bf16 v[88:91],a[148:151],a[204:207],v[88:91]
 s_add_u32 s60,s56,0
 v_mfma_f32_16x16x32_bf16 v[92:95],a[152:155],a[200:203],v[92:95]
 buffer_load_dwordx4 v15,s[28:31],s32 offen offset:1024 sc1 lds
 v_mfma_f32_16x16x32_bf16 v[92:95],a[156:159],a[204:207],v[92:95]
 buffer_store_dwordx4 v[48:51],v1,s[28:31],s60 offen sc1
 v_mfma_f32_16x16x32_bf16 v[96:99],a[160:163],a[200:203],v[96:99]
 v_mul_f32 v56,s58,v56
 v_mul_f32 v57,s58,v57
 v_mfma_f32_16x16x32_bf16 v[96:99],a[164:167],a[204:207],v[96:99]
 v_mul_f32 v58,s58,v58
 v_mul_f32 v59,s58,v59
 v_mfma_f32_16x16x32_bf16 v[100:103],a[168:171],a[200:203],v[100:103]
 buffer_load_dwordx4 v15,s[28:31],s32 offen offset:2048 sc1 lds
 v_mfma_f32_16x16x32_bf16 v[100:103],a[172:175],a[204:207],v[100:103]
 v_mul_f32 v60,s58,v60
 v_mul_f32 v61,s58,v61
 v_mfma_f32_16x16x32_bf16 v[104:107],a[176:179],a[200:203],v[104:107]
 buffer_load_dwordx4 v15,s[28:31],s32 offen offset:3072 sc1 lds
 v_mfma_f32_16x16x32_bf16 v[104:107],a[180:183],a[204:207],v[104:107]
 v_mul_f32 v62,s58,v62
 v_mul_f32 v63,s58,v63
 v_mfma_f32_16x16x32_bf16 v[108:111],a[184:187],a[200:203],v[108:111]
 v_cvt_pk_bf16_f32 v56,v56,v57
 v_cvt_pk_bf16_f32 v57,v58,v59
 v_mfma_f32_16x16x32_bf16 v[108:111],a[188:191],a[204:207],v[108:111]
 s_waitcnt lgkmcnt(0)
 v_cvt_pk_bf16_f32 v58,v60,v61
 v_mfma_f32_16x16x32_bf16 v[112:115],a[128:131],a[192:195],v[112:115]
 v_cvt_pk_bf16_f32 v59,v62,v63
 v_mul_f32 v64,s58,v64
 v_mfma_f32_16x16x32_bf16 v[112:115],a[132:135],a[196:199],v[112:115]
 ds_read_b128 a[200:203],v4 offset:6144
 v_mul_f32 v65,s58,v65
 v_mfma_f32_16x16x32_bf16 v[116:119],a[136:139],a[192:195],v[116:119]
 v_mul_f32 v66,s58,v66
 v_mul_f32 v67,s58,v67
 v_mfma_f32_16x16x32_bf16 v[116:119],a[140:143],a[196:199],v[116:119]
 ds_read_b128 a[204:207],v5 offset:6144
 s_add_u32 s60,s56,1024
 v_mfma_f32_16x16x32_bf16 v[120:123],a[144:147],a[192:195],v[120:123]
 buffer_store_dwordx4 v[56:59],v1,s[28:31],s60 offen sc1
 v_mfma_f32_16x16x32_bf16 v[120:123],a[148:151],a[196:199],v[120:123]
 v_mul_f32 v68,s58,v68
 v_mul_f32 v69,s58,v69
 v_mfma_f32_16x16x32_bf16 v[124:127],a[152:155],a[192:195],v[124:127]
 v_mul_f32 v70,s58,v70
 v_mul_f32 v71,s58,v71
 v_mfma_f32_16x16x32_bf16 v[124:127],a[156:159],a[196:199],v[124:127]
 v_cvt_pk_bf16_f32 v64,v64,v65
 v_cvt_pk_bf16_f32 v65,v66,v67
 v_mfma_f32_16x16x32_bf16 v[128:131],a[160:163],a[192:195],v[128:131]
 v_cvt_pk_bf16_f32 v66,v68,v69
 v_cvt_pk_bf16_f32 v67,v70,v71
 v_mfma_f32_16x16x32_bf16 v[128:131],a[164:167],a[196:199],v[128:131]
 v_mul_f32 v72,s58,v72
 v_mul_f32 v73,s58,v73
 v_mfma_f32_16x16x32_bf16 v[132:135],a[168:171],a[192:195],v[132:135]
 v_mul_f32 v74,s58,v74
 v_mul_f32 v75,s58,v75
 v_mfma_f32_16x16x32_bf16 v[132:135],a[172:175],a[196:199],v[132:135]
 v_mul_f32 v76,s58,v76
 v_mul_f32 v77,s58,v77
 v_mfma_f32_16x16x32_bf16 v[136:139],a[176:179],a[192:195],v[136:139]
 v_mul_f32 v78,s58,v78
 s_add_u32 s60,s56,2048
 v_mfma_f32_16x16x32_bf16 v[136:139],a[180:183],a[196:199],v[136:139]
 v_mul_f32 v79,s58,v79
 v_mfma_f32_16x16x32_bf16 v[140:143],a[184:187],a[192:195],v[140:143]
 buffer_store_dwordx4 v[64:67],v1,s[28:31],s60 offen sc1
 v_mfma_f32_16x16x32_bf16 v[140:143],a[188:191],a[196:199],v[140:143]
 s_waitcnt lgkmcnt(0)
 v_cvt_pk_bf16_f32 v72,v72,v73
 v_mfma_f32_16x16x32_bf16 v[144:147],a[128:131],a[200:203],v[144:147]
 v_cvt_pk_bf16_f32 v73,v74,v75
 v_cvt_pk_bf16_f32 v74,v76,v77
 v_mfma_f32_16x16x32_bf16 v[144:147],a[132:135],a[204:207],v[144:147]
 ds_read_b128 a[192:195],v4 offset:8192
 v_cvt_pk_bf16_f32 v75,v78,v79
 v_mfma_f32_16x16x32_bf16 v[148:151],a[136:139],a[200:203],v[148:151]
 v_mul_f32 v80,s58,v80
 v_mul_f32 v81,s58,v81
 v_mfma_f32_16x16x32_bf16 v[148:151],a[140:143],a[204:207],v[148:151]
 ds_read_b128 a[196:199],v5 offset:8192
 v_mul_f32 v82,s58,v82
 v_mfma_f32_16x16x32_bf16 v[152:155],a[144:147],a[200:203],v[152:155]
 v_mul_f32 v83,s58,v83
 v_mul_f32 v84,s58,v84
 v_mfma_f32_16x16x32_bf16 v[152:155],a[148:151],a[204:207],v[152:155]
 v_mul_f32 v85,s58,v85
 v_mul_f32 v86,s58,v86
 v_mfma_f32_16x16x32_bf16 v[156:159],a[152:155],a[200:203],v[156:159]
 v_mul_f32 v87,s58,v87
 v_cvt_pk_bf16_f32 v80,v80,v81
 v_mfma_f32_16x16x32_bf16 v[156:159],a[156:159],a[204:207],v[156:159]
 v_cvt_pk_bf16_f32 v81,v82,v83
 v_cvt_pk_bf16_f32 v82,v84,v85
 v_mfma_f32_16x16x32_bf16 v[160:163],a[160:163],a[200:203],v[160:163]
 s_add_u32 s60,s56,3072
 v_mfma_f32_16x16x32_bf16 v[160:163],a[164:167],a[204:207],v[160:163]
 buffer_store_dwordx4 v[72:75],v1,s[28:31],s60 offen sc1
 v_mfma_f32_16x16x32_bf16 v[164:167],a[168:171],a[200:203],v[164:167]
 v_cvt_pk_bf16_f32 v83,v86,v87
 v_mul_f32 v88,s58,v88
 v_mfma_f32_16x16x32_bf16 v[164:167],a[172:175],a[204:207],v[164:167]
 v_mul_f32 v89,s58,v89
 v_mul_f32 v90,s58,v90
 v_mfma_f32_16x16x32_bf16 v[168:171],a[176:179],a[200:203],v[168:171]
 v_mul_f32 v91,s58,v91
 v_mul_f32 v92,s58,v92
 v_mfma_f32_16x16x32_bf16 v[168:171],a[180:183],a[204:207],v[168:171]
 v_mul_f32 v93,s58,v93
 v_mul_f32 v94,s58,v94
 v_mfma_f32_16x16x32_bf16 v[172:175],a[184:187],a[200:203],v[172:175]
 v_mul_f32 v95,s58,v95
 v_cvt_pk_bf16_f32 v88,v88,v89
 v_mfma_f32_16x16x32_bf16 v[172:175],a[188:191],a[204:207],v[172:175]
 s_waitcnt lgkmcnt(0)
 v_cvt_pk_bf16_f32 v89,v90,v91
 v_mfma_f32_16x16x32_bf16 v[176:179],a[128:131],a[192:195],v[176:179]
 v_cvt_pk_bf16_f32 v90,v92,v93
 v_cvt_pk_bf16_f32 v91,v94,v95
 v_mfma_f32_16x16x32_bf16 v[176:179],a[132:135],a[196:199],v[176:179]
 ds_read_b128 a[200:203],v4 offset:10240
 v_mul_f32 v96,s58,v96
 v_mfma_f32_16x16x32_bf16 v[180:183],a[136:139],a[192:195],v[180:183]
 v_mul_f32 v97,s58,v97
 v_mul_f32 v98,s58,v98
 v_mfma_f32_16x16x32_bf16 v[180:183],a[140:143],a[196:199],v[180:183]
 ds_read_b128 a[204:207],v5 offset:10240
 s_add_u32 s60,s56,8192
 v_mfma_f32_16x16x32_bf16 v[184:187],a[144:147],a[192:195],v[184:187]
 buffer_store_dwordx4 v[80:83],v1,s[28:31],s60 offen sc1
 v_mfma_f32_16x16x32_bf16 v[184:187],a[148:151],a[196:199],v[184:187]
 v_mul_f32 v99,s58,v99
 v_mul_f32 v100,s58,v100
 v_mfma_f32_16x16x32_bf16 v[188:191],a[152:155],a[192:195],v[188:191]
 v_mul_f32 v101,s58,v101
 v_mul_f32 v102,s58,v102
 v_mfma_f32_16x16x32_bf16 v[188:191],a[156:159],a[196:199],v[188:191]
 v_mul_f32 v103,s58,v103
 v_cvt_pk_bf16_f32 v96,v96,v97
 v_mfma_f32_16x16x32_bf16 v[192:195],a[160:163],a[192:195],v[192:195]
 v_cvt_pk_bf16_f32 v97,v98,v99
 v_cvt_pk_bf16_f32 v98,v100,v101
 v_mfma_f32_16x16x32_bf16 v[192:195],a[164:167],a[196:199],v[192:195]
 v_cvt_pk_bf16_f32 v99,v102,v103
 v_mov_b32 v100,0
 v_mfma_f32_16x16x32_bf16 v[196:199],a[168:171],a[192:195],v[196:199]
 v_mov_b32 v101,0
 v_mov_b32 v102,0
 v_mfma_f32_16x16x32_bf16 v[196:199],a[172:175],a[196:199],v[196:199]
 v_mov_b32 v103,0
 v_mul_f32 v104,s58,v104
 v_mfma_f32_16x16x32_bf16 v[200:203],a[176:179],a[192:195],v[200:203]
 v_mul_f32 v105,s58,v105
 s_add_u32 s60,s56,9216
 v_mfma_f32_16x16x32_bf16 v[200:203],a[180:183],a[196:199],v[200:203]
 buffer_store_dwordx4 v[88:91],v1,s[28:31],s60 offen sc1
 v_mfma_f32_16x16x32_bf16 v[204:207],a[184:187],a[192:195],v[204:207]
 v_mul_f32 v106,s58,v106
 v_mul_f32 v107,s58,v107
 v_mfma_f32_16x16x32_bf16 v[204:207],a[188:191],a[196:199],v[204:207]
 s_waitcnt lgkmcnt(0)
 v_mul_f32 v108,s58,v108
 v_mfma_f32_16x16x32_bf16 v[208:211],a[128:131],a[200:203],v[208:211]
 v_mul_f32 v109,s58,v109
 v_mul_f32 v110,s58,v110
 v_mfma_f32_16x16x32_bf16 v[208:211],a[132:135],a[204:207],v[208:211]
 ds_read_b128 a[192:195],v4 offset:12288
 v_mul_f32 v111,s58,v111
 v_mfma_f32_16x16x32_bf16 v[212:215],a[136:139],a[200:203],v[212:215]
 v_cvt_pk_bf16_f32 v104,v104,v105
 v_cvt_pk_bf16_f32 v105,v106,v107
 v_mfma_f32_16x16x32_bf16 v[212:215],a[140:143],a[204:207],v[212:215]
 ds_read_b128 a[196:199],v5 offset:12288
 v_cvt_pk_bf16_f32 v106,v108,v109
 v_mfma_f32_16x16x32_bf16 v[216:219],a[144:147],a[200:203],v[216:219]
 v_cvt_pk_bf16_f32 v107,v110,v111
 v_mov_b32 v108,0
 v_mfma_f32_16x16x32_bf16 v[216:219],a[148:151],a[204:207],v[216:219]
 v_mov_b32 v109,0
 v_mov_b32 v110,0
 v_mfma_f32_16x16x32_bf16 v[220:223],a[152:155],a[200:203],v[220:223]
 v_mov_b32 v111,0
 v_mul_f32 v112,s58,v112
 v_mfma_f32_16x16x32_bf16 v[220:223],a[156:159],a[204:207],v[220:223]
 v_mul_f32 v113,s58,v113
 s_add_u32 s60,s56,10240
 v_mfma_f32_16x16x32_bf16 v[224:227],a[160:163],a[200:203],v[224:227]
 buffer_store_dwordx4 v[96:99],v1,s[28:31],s60 offen sc1
 v_mfma_f32_16x16x32_bf16 v[224:227],a[164:167],a[204:207],v[224:227]
 s_nop 1
 v_mov_b32 v96,0
 v_mfma_f32_16x16x32_bf16 v[228:231],a[168:171],a[200:203],v[228:231]
 v_mov_b32 v97,0
 v_mov_b32 v98,0
 v_mfma_f32_16x16x32_bf16 v[228:231],a[172:175],a[204:207],v[228:231]
 v_mov_b32 v99,0
 v_mul_f32 v114,s58,v114
 v_mfma_f32_16x16x32_bf16 v[232:235],a[176:179],a[200:203],v[232:235]
 v_mul_f32 v115,s58,v115
 v_mul_f32 v116,s58,v116
 v_mfma_f32_16x16x32_bf16 v[232:235],a[180:183],a[204:207],v[232:235]
 v_mul_f32 v117,s58,v117
 v_mul_f32 v118,s58,v118
 v_mfma_f32_16x16x32_bf16 v[236:239],a[184:187],a[200:203],v[236:239]
 v_mul_f32 v119,s58,v119
 v_cvt_pk_bf16_f32 v112,v112,v113
 v_mfma_f32_16x16x32_bf16 v[236:239],a[188:191],a[204:207],v[236:239]
 s_waitcnt lgkmcnt(0)
 v_cvt_pk_bf16_f32 v113,v114,v115
 v_mfma_f32_16x16x32_bf16 v[240:243],a[128:131],a[192:195],v[240:243]
 v_cvt_pk_bf16_f32 v114,v116,v117
 v_cvt_pk_bf16_f32 v115,v118,v119
 v_mfma_f32_16x16x32_bf16 v[240:243],a[132:135],a[196:199],v[240:243]
 ds_read_b128 a[200:203],v4 offset:14336
 v_mov_b32 v116,0
 v_mfma_f32_16x16x32_bf16 v[244:247],a[136:139],a[192:195],v[244:247]
 v_mov_b32 v117,0
 v_mov_b32 v118,0
 v_mfma_f32_16x16x32_bf16 v[244:247],a[140:143],a[196:199],v[244:247]
 ds_read_b128 a[204:207],v5 offset:14336
 v_mov_b32 v119,0
 v_mfma_f32_16x16x32_bf16 v[248:251],a[144:147],a[192:195],v[248:251]
 v_mul_f32 v120,s58,v120
 s_add_u32 s60,s56,11264
 v_mfma_f32_16x16x32_bf16 v[248:251],a[148:151],a[196:199],v[248:251]
 buffer_store_dwordx4 v[104:107],v1,s[28:31],s60 offen sc1
 v_mfma_f32_16x16x32_bf16 v[252:255],a[152:155],a[192:195],v[252:255]
 s_nop 1
 v_mov_b32 v104,0
 v_mfma_f32_16x16x32_bf16 v[252:255],a[156:159],a[196:199],v[252:255]
 v_mov_b32 v105,0
 v_mov_b32 v106,0
 v_mfma_f32_16x16x32_bf16 a[208:211],a[160:163],a[192:195],a[208:211]
 v_mov_b32 v107,0
 v_mul_f32 v121,s58,v121
 v_mfma_f32_16x16x32_bf16 a[208:211],a[164:167],a[196:199],a[208:211]
 v_mul_f32 v122,s58,v122
 v_mul_f32 v123,s58,v123
 v_mfma_f32_16x16x32_bf16 a[212:215],a[168:171],a[192:195],a[212:215]
 v_mul_f32 v124,s58,v124
 v_mul_f32 v125,s58,v125
 v_mfma_f32_16x16x32_bf16 a[212:215],a[172:175],a[196:199],a[212:215]
 v_mul_f32 v126,s58,v126
 v_mul_f32 v127,s58,v127
 v_mfma_f32_16x16x32_bf16 a[216:219],a[176:179],a[192:195],a[216:219]
 v_cvt_pk_bf16_f32 v120,v120,v121
 v_cvt_pk_bf16_f32 v121,v122,v123
 v_mfma_f32_16x16x32_bf16 a[216:219],a[180:183],a[196:199],a[216:219]
 v_cvt_pk_bf16_f32 v122,v124,v125
 v_cvt_pk_bf16_f32 v123,v126,v127
 v_mfma_f32_16x16x32_bf16 a[220:223],a[184:187],a[192:195],a[220:223]
 v_mov_b32 v124,0
 v_mov_b32 v125,0
 v_mfma_f32_16x16x32_bf16 a[220:223],a[188:191],a[196:199],a[220:223]
 s_waitcnt lgkmcnt(0)
 s_barrier
 v_mfma_f32_16x16x32_bf16 a[224:227],a[128:131],a[200:203],a[224:227]
 v_mov_b32 v126,0
 v_mov_b32 v127,0
 v_mfma_f32_16x16x32_bf16 a[224:227],a[132:135],a[204:207],a[224:227]
 v_mul_f32 v128,s58,v128
 s_add_u32 s60,s56,16384
 v_mfma_f32_16x16x32_bf16 a[228:231],a[136:139],a[200:203],a[228:231]
 buffer_store_dwordx4 v[112:115],v1,s[28:31],s60 offen sc1
 v_mfma_f32_16x16x32_bf16 a[228:231],a[140:143],a[204:207],a[228:231]
 s_nop 1
 v_mov_b32 v112,0
 v_mfma_f32_16x16x32_bf16 a[232:235],a[144:147],a[200:203],a[232:235]
 v_mov_b32 v113,0
 v_mov_b32 v114,0
 v_mfma_f32_16x16x32_bf16 a[232:235],a[148:151],a[204:207],a[232:235]
 v_mov_b32 v115,0
 v_mul_f32 v129,s58,v129
 v_mfma_f32_16x16x32_bf16 a[236:239],a[152:155],a[200:203],a[236:239]
 v_mul_f32 v130,s58,v130
 v_mul_f32 v131,s58,v131
 v_mfma_f32_16x16x32_bf16 a[236:239],a[156:159],a[204:207],a[236:239]
 v_mul_f32 v132,s58,v132
 v_mul_f32 v133,s58,v133
 v_mfma_f32_16x16x32_bf16 a[240:243],a[160:163],a[200:203],a[240:243]
 v_mul_f32 v134,s58,v134
 v_mul_f32 v135,s58,v135
 v_mfma_f32_16x16x32_bf16 a[240:243],a[164:167],a[204:207],a[240:243]
 v_cvt_pk_bf16_f32 v128,v128,v129
 v_cvt_pk_bf16_f32 v129,v130,v131
 v_mfma_f32_16x16x32_bf16 a[244:247],a[168:171],a[200:203],a[244:247]
 v_cvt_pk_bf16_f32 v130,v132,v133
 v_cvt_pk_bf16_f32 v131,v134,v135
 v_mfma_f32_16x16x32_bf16 a[244:247],a[172:175],a[204:207],a[244:247]
 v_mov_b32 v132,0
 v_mov_b32 v133,0
 v_mfma_f32_16x16x32_bf16 a[248:251],a[176:179],a[200:203],a[248:251]
 v_mov_b32 v134,0
 v_mov_b32 v135,0
 v_mfma_f32_16x16x32_bf16 a[248:251],a[180:183],a[204:207],a[248:251]
 s_add_u32 s60,s56,17408
 v_mfma_f32_16x16x32_bf16 a[252:255],a[184:187],a[200:203],a[252:255]
 buffer_store_dwordx4 v[120:123],v1,s[28:31],s60 offen sc1
 v_mfma_f32_16x16x32_bf16 a[252:255],a[188:191],a[204:207],a[252:255]
 v_mul_f32 v136,s58,v136
 s_nop 1
 s_and_b32 s61,s68,0x8000
 v_add_u32 v20,s61,v1
 v_xor_b32 v21,0x8000,v20
 s_waitcnt vmcnt(9)
 s_barrier
 ds_read_b128 a[64:67],v20 offset:0
 ds_read_b128 a[68:71],v20 offset:1024
 ds_read_b128 a[72:75],v20 offset:2048
 ds_read_b128 a[76:79],v20 offset:3072
 ds_read_b128 a[80:83],v20 offset:4096
 ds_read_b128 a[84:87],v20 offset:5120
 ds_read_b128 a[88:91],v20 offset:6144
 ds_read_b128 a[92:95],v20 offset:7168
 ds_read_b128 a[96:99],v20 offset:8192
 ds_read_b128 a[100:103],v20 offset:9216
 ds_read_b128 a[104:107],v20 offset:10240
 ds_read_b128 a[108:111],v20 offset:11264
 ds_read_b128 a[112:115],v20 offset:12288
 v_mov_b32 v24,0
 v_mov_b32 v25,0
 v_mov_b32 v26,0
 v_mov_b32 v27,0
 v_mov_b32 v28,0
 v_mov_b32 v29,0
 v_mov_b32 v30,0
 v_mov_b32 v31,0
 v_mov_b32 v6,0
 v_mov_b32 v7,0
 v_mov_b32 v120,0
 v_mov_b32 v121,0
 v_mov_b32 v122,0
 v_mov_b32 v123,0
 v_mul_f32 v137,s58,v137
 v_mul_f32 v138,s58,v138
 v_mul_f32 v139,s58,v139
 v_mul_f32 v140,s58,v140
 v_mul_f32 v141,s58,v141
 v_mul_f32 v142,s58,v142
 v_mul_f32 v143,s58,v143
 v_cvt_pk_bf16_f32 v136,v136,v137
 v_cvt_pk_bf16_f32 v137,v138,v139
 v_cvt_pk_bf16_f32 v138,v140,v141
 v_cvt_pk_bf16_f32 v139,v142,v143
 v_mov_b32 v140,0
 v_mov_b32 v141,0
 v_mov_b32 v142,0
 v_mov_b32 v143,0
 s_add_u32 s60,s56,18432
 buffer_store_dwordx4 v[128:131],v1,s[28:31],s60 offen sc1
 s_nop 1
 v_mov_b32 v128,0
 v_mov_b32 v129,0
 v_mov_b32 v130,0
 v_mov_b32 v131,0
 v_mul_f32 v144,s58,v144
 v_mul_f32 v145,s58,v145
 v_mul_f32 v146,s58,v146
 v_mul_f32 v147,s58,v147
 v_mul_f32 v148,s58,v148
 v_mul_f32 v149,s58,v149
 v_mul_f32 v150,s58,v150
 v_mul_f32 v151,s58,v151
 v_cvt_pk_bf16_f32 v144,v144,v145
 v_cvt_pk_bf16_f32 v145,v146,v147
 v_cvt_pk_bf16_f32 v146,v148,v149
 v_cvt_pk_bf16_f32 v147,v150,v151
 v_mov_b32 v148,0
 v_mov_b32 v149,0
 v_mov_b32 v150,0
 s_add_u32 s60,s56,19456
 v_mov_b32 v151,0
 buffer_store_dwordx4 v[136:139],v1,s[28:31],s60 offen sc1
 s_nop 1
 v_mov_b32 v136,0
 v_mov_b32 v137,0
 v_mov_b32 v138,0
 v_mov_b32 v139,0
 v_mul_f32 v152,s58,v152
 v_mul_f32 v153,s58,v153
 v_mul_f32 v154,s58,v154
 v_mul_f32 v155,s58,v155
 v_mul_f32 v156,s58,v156
 v_mul_f32 v157,s58,v157
 v_mul_f32 v158,s58,v158
 v_mul_f32 v159,s58,v159
 v_cvt_pk_bf16_f32 v152,v152,v153
 v_cvt_pk_bf16_f32 v153,v154,v155
 v_cvt_pk_bf16_f32 v154,v156,v157
 v_cvt_pk_bf16_f32 v155,v158,v159
 v_mov_b32 v156,0
 v_mov_b32 v157,0
 v_mov_b32 v158,0
 s_add_u32 s60,s56,24576
 buffer_store_dwordx4 v[144:147],v1,s[28:31],s60 offen sc1
 s_nop 1
 v_mov_b32 v144,0
 v_mov_b32 v145,0
 v_mov_b32 v146,0
 v_mov_b32 v147,0
 v_mov_b32 v159,0
 v_mul_f32 v160,s58,v160
 v_mul_f32 v161,s58,v161
 v_mul_f32 v162,s58,v162
 v_mul_f32 v163,s58,v163
 v_mul_f32 v164,s58,v164
 v_mul_f32 v165,s58,v165
 v_mul_f32 v166,s58,v166
 v_mul_f32 v167,s58,v167
 v_cvt_pk_bf16_f32 v160,v160,v161
 v_cvt_pk_bf16_f32 v161,v162,v163
 v_cvt_pk_bf16_f32 v162,v164,v165
 v_cvt_pk_bf16_f32 v163,v166,v167
 v_mov_b32 v164,0
 v_mov_b32 v165,0
 s_add_u32 s60,s56,25600
 v_mov_b32 v166,0
 buffer_store_dwordx4 v[152:155],v1,s[28:31],s60 offen sc1
 s_nop 1
 v_mov_b32 v152,0
 v_mov_b32 v153,0
 v_mov_b32 v154,0
 v_mov_b32 v155,0
 v_mov_b32 v167,0
 v_mul_f32 v168,s58,v168
 v_mul_f32 v169,s58,v169
 v_mul_f32 v170,s58,v170
 v_mul_f32 v171,s58,v171
 v_mul_f32 v172,s58,v172
 v_mul_f32 v173,s58,v173
 v_mul_f32 v174,s58,v174
 v_mul_f32 v175,s58,v175
 v_cvt_pk_bf16_f32 v168,v168,v169
 v_cvt_pk_bf16_f32 v169,v170,v171
 v_cvt_pk_bf16_f32 v170,v172,v173
 v_cvt_pk_bf16_f32 v171,v174,v175
 v_mov_b32 v172,0
 v_mov_b32 v173,0
 s_add_u32 s60,s56,26624
 buffer_store_dwordx4 v[160:163],v1,s[28:31],s60 offen sc1
 s_nop 1
 v_mov_b32 v160,0
 v_mov_b32 v161,0
 v_mov_b32 v162,0
 v_mov_b32 v163,0
 v_mov_b32 v174,0
 v_mov_b32 v175,0
 v_mul_f32 v176,s58,v176
 v_mul_f32 v177,s58,v177
 v_mul_f32 v178,s58,v178
 v_mul_f32 v179,s58,v179
 v_mul_f32 v180,s58,v180
 v_mul_f32 v181,s58,v181
 v_mul_f32 v182,s58,v182
 v_mul_f32 v183,s58,v183
 v_cvt_pk_bf16_f32 v176,v176,v177
 v_cvt_pk_bf16_f32 v177,v178,v179
 v_cvt_pk_bf16_f32 v178,v180,v181
 v_cvt_pk_bf16_f32 v179,v182,v183
 v_mov_b32 v180,0
 v_mov_b32 v181,0
 s_add_u32 s60,s56,27648
 buffer_store_dwordx4 v[168:171],v1,s[28:31],s60 offen sc1
 s_nop 1
 v_mov_b32 v168,0
 v_mov_b32 v169,0
 v_mov_b32 v170,0
 v_mov_b32 v171,0
 v_mov_b32 v182,0
 v_mov_b32 v183,0
 v_mul_f32 v184,s58,v184
 v_mul_f32 v185,s58,v185
 v_mul_f32 v186,s58,v186
 v_mul_f32 v187,s58,v187
 v_mul_f32 v188,s58,v188
 v_mul_f32 v189,s58,v189
 v_mul_f32 v190,s58,v190
 v_mul_f32 v191,s58,v191
 v_cvt_pk_bf16_f32 v184,v184,v185
 v_cvt_pk_bf16_f32 v185,v186,v187
 v_cvt_pk_bf16_f32 v186,v188,v189
 v_cvt_pk_bf16_f32 v187,v190,v191
 v_mov_b32 v188,0
 s_add_u32 s60,s56,32768
 buffer_store_dwordx4 v[176:179],v1,s[28:31],s60 offen sc1
 s_nop 1
 v_mov_b32 v176,0
 v_mov_b32 v177,0
 v_mov_b32 v178,0
 v_mov_b32 v179,0
 v_mov_b32 v189,0
 v_mov_b32 v190,0
 v_mov_b32 v191,0
 v_mul_f32 v192,s58,v192
 v_mul_f32 v193,s58,v193
 v_mul_f32 v194,s58,v194
 v_mul_f32 v195,s58,v195
 v_mul_f32 v196,s58,v196
 v_mul_f32 v197,s58,v197
 v_mul_f32 v198,s58,v198
 v_mul_f32 v199,s58,v199
 v_cvt_pk_bf16_f32 v192,v192,v193
 v_cvt_pk_bf16_f32 v193,v194,v195
 v_cvt_pk_bf16_f32 v194,v196,v197
 v_cvt_pk_bf16_f32 v195,v198,v199
 v_mov_b32 v196,0
 s_add_u32 s60,s56,33792
 buffer_store_dwordx4 v[184:187],v1,s[28:31],s60 offen sc1
 s_nop 1
 v_mov_b32 v184,0
 v_mov_b32 v185,0
 v_mov_b32 v186,0
 v_mov_b32 v187,0
 v_mov_b32 v197,0
 v_mov_b32 v198,0
 v_mov_b32 v199,0
 v_mul_f32 v200,s58,v200
 v_mul_f32 v201,s58,v201
 v_mul_f32 v202,s58,v202
 v_mul_f32 v203,s58,v203
 v_mul_f32 v204,s58,v204
 v_mul_f32 v205,s58,v205
 v_mul_f32 v206,s58,v206
 v_mul_f32 v207,s58,v207
 v_cvt_pk_bf16_f32 v200,v200,v201
 v_cvt_pk_bf16_f32 v201,v202,v203
 v_cvt_pk_bf16_f32 v202,v204,v205
 v_cvt_pk_bf16_f32 v203,v206,v207
 s_waitcnt lgkmcnt(5)
 v_mfma_f32_16x16x32_bf16 v[32:35],a[64:67],a[0:3],0
 ds_read_b128 a[116:119],v20 offset:13312
 s_add_u32 m0,s68,65536
 v_mfma_f32_16x16x32_bf16 v[32:35],a[68:71],a[4:7],v[32:35]
 v_mfma_f32_16x16x32_bf16 v[32:35],a[72:75],a[8:11],v[32:35]
 ds_read_b128 a[120:123],v20 offset:14336
 v_mfma_f32_16x16x32_bf16 v[32:35],a[76:79],a[12:15],v[32:35]
 v_mfma_f32_16x16x32_bf16 v[48:51],a[64:67],a[32:35],0
 ds_read_b128 a[124:127],v20 offset:15360
 s_add_u32 s60,s56,34816
 v_mfma_f32_16x16x32_bf16 v[48:51],a[68:71],a[36:39],v[48:51]
 buffer_load_dwordx4 v14,s[28:31],s33 offen offset:0 sc1 lds
 v_mfma_f32_16x16x32_bf16 v[48:51],a[72:75],a[40:43],v[48:51]
 buffer_store_dwordx4 v[192:195],v1,s[28:31],s60 offen sc1
 ds_read_b128 a[128:131],v20 offset:16384
 v_mfma_f32_16x16x32_bf16 v[48:51],a[76:79],a[44:47],v[48:51]
 v_mov_b32 v204,0
 s_nop 1
 v_mov_b32 v192,0
 v_mfma_f32_16x16x32_bf16 v[32:35],a[80:83],a[16:19],v[32:35]
 ds_read_b128 a[132:135],v20 offset:17408
 v_mov_b32 v193,0
 v_mov_b32 v194,0
 v_mfma_f32_16x16x32_bf16 v[32:35],a[84:87],a[20:23],v[32:35]
 v_mov_b32 v195,0
 v_mov_b32 v205,0
 v_mov_b32 v206,0
 v_mfma_f32_16x16x32_bf16 v[32:35],a[88:91],a[24:27],v[32:35]
 ds_read_b128 a[136:139],v20 offset:18432
 v_mov_b32 v207,0
 v_mul_f32 v208,s58,v208
 v_mfma_f32_16x16x32_bf16 v[32:35],a[92:95],a[28:31],v[32:35]
 buffer_load_dwordx4 v14,s[28:31],s33 offen offset:1024 sc1 lds
 v_mul_f32 v209,s58,v209
 v_mfma_f32_16x16x32_bf16 v[48:51],a[80:83],a[48:51],v[48:51]
 ds_read_b128 a[140:143],v20 offset:19456
 v_mul_f32 v210,s58,v210
 v_mul_f32 v211,s58,v211
 v_mfma_f32_16x16x32_bf16 v[48:51],a[84:87],a[52:55],v[48:51]
 v_mul_f32 v212,s58,v212
 v_mul_f32 v213,s58,v213
 v_mul_f32 v214,s58,v214
 v_mfma_f32_16x16x32_bf16 v[48:51],a[88:91],a[56:59],v[48:51]
 ds_read_b128 a[144:147],v20 offset:20480
 v_mul_f32 v215,s58,v215
 v_cvt_pk_bf16_f32 v208,v208,v209
 v_mfma_f32_16x16x32_bf16 v[48:51],a[92:95],a[60:63],v[48:51]
 s_waitcnt lgkmcnt(5)
 v_cvt_pk_bf16_f32 v209,v210,v211
 v_cvt_pk_bf16_f32 v210,v212,v213
 v_mfma_f32_16x16x32_bf16 v[36:39],a[96:99],a[0:3],0
 buffer_load_dwordx4 v14,s[28:31],s33 offen offset:2048 sc1 lds
 v_cvt_pk_bf16_f32 v211,v214,v215
 v_mfma_f32_16x16x32_bf16 v[36:39],a[100:103],a[4:7],v[36:39]
 ds_read_b128 a[148:151],v20 offset:21504
 s_add_u32 s60,s56,35840
 v_mfma_f32_16x16x32_bf16 v[36:39],a[104:107],a[8:11],v[36:39]
 buffer_store_dwordx4 v[200:203],v1,s[28:31],s60 offen sc1
 ds_read_b128 a[152:155],v20 offset:22528
 v_mfma_f32_16x16x32_bf16 v[36:39],a[108:111],a[12:15],v[36:39]
 s_nop 1
 v_mov_b32 v200,0
 v_mov_b32 v201,0
 v_mfma_f32_16x16x32_bf16 v[52:55],a[96:99],a[32:35],0
 ds_read_b128 a[156:159],v20 offset:23552
 v_mov_b32 v202,0
 v_mov_b32 v203,0
 v_mfma_f32_16x16x32_bf16 v[52:55],a[100:103],a[36:39],v[52:55]
 buffer_load_dwordx4 v14,s[28:31],s33 offen offset:3072 sc1 lds
 v_mov_b32 v212,0
 v_mfma_f32_16x16x32_bf16 v[52:55],a[104:107],a[40:43],v[52:55]
 ds_read_b128 a[160:163],v20 offset:24576
 v_mov_b32 v213,0
 v_mov_b32 v214,0
 v_mfma_f32_16x16x32_bf16 v[52:55],a[108:111],a[44:47],v[52:55]
 v_mov_b32 v215,0
 v_mul_f32 v216,s58,v216
 v_mul_f32 v217,s58,v217
 v_mfma_f32_16x16x32_bf16 v[36:39],a[112:115],a[16:19],v[36:39]
 ds_read_b128 a[164:167],v20 offset:25600
 v_mul_f32 v218,s58,v218
 v_mul_f32 v219,s58,v219
 v_mfma_f32_16x16x32_bf16 v[36:39],a[116:119],a[20:23],v[36:39]
 s_add_u32 m0,s68,69632
 v_mul_f32 v220,s58,v220
 v_mul_f32 v221,s58,v221
 v_mfma_f32_16x16x32_bf16 v[36:39],a[120:123],a[24:27],v[36:39]
 ds_read_b128 a[168:171],v20 offset:26624
 v_mul_f32 v222,s58,v222
 v_mul_f32 v223,s58,v223
 v_mfma_f32_16x16x32_bf16 v[36:39],a[124:127],a[28:31],v[36:39]
 v_cvt_pk_bf16_f32 v216,v216,v217
 v_cvt_pk_bf16_f32 v217,v218,v219
 v_cvt_pk_bf16_f32 v218,v220,v221
 v_mfma_f32_16x16x32_bf16 v[52:55],a[112:115],a[48:51],v[52:55]
 ds_read_b128 a[172:175],v20 offset:27648
 s_add_u32 s60,s56,40960
 v_cvt_pk_bf16_f32 v219,v222,v223
 v_mfma_f32_16x16x32_bf16 v[52:55],a[116:119],a[52:55],v[52:55]
 buffer_store_dwordx4 v[208:211],v1,s[28:31],s60 offen sc1
 s_nop 1
 v_mfma_f32_16x16x32_bf16 v[52:55],a[120:123],a[56:59],v[52:55]
 ds_read_b128 a[176:179],v20 offset:28672
 v_mov_b32 v208,0
 v_mov_b32 v209,0
 v_mfma_f32_16x16x32_bf16 v[52:55],a[124:127],a[60:63],v[52:55]
 s_waitcnt lgkmcnt(5)
 v_mov_b32 v210,0
 v_mov_b32 v211,0
 v_mfma_f32_16x16x32_bf16 v[40:43],a[128:131],a[0:3],0
 buffer_load_dwordx4 v15,s[28:31],s33 offen offset:0 sc1 lds
 v_mov_b32 v220,0
 v_mfma_f32_16x16x32_bf16 v[40:43],a[132:135],a[4:7],v[40:43]
 ds_read_b128 a[180:183],v20 offset:29696
 v_mov_b32 v221,0
 v_mov_b32 v222,0
 v_mfma_f32_16x16x32_bf16 v[40:43],a[136:139],a[8:11],v[40:43]
 ds_read_b128 a[184:187],v20 offset:30720
 v_mov_b32 v223,0
 v_mul_f32 v224,s58,v224
 v_mfma_f32_16x16x32_bf16 v[40:43],a[140:143],a[12:15],v[40:43]
 buffer_load_dwordx4 v15,s[28:31],s33 offen offset:1024 sc1 lds
 v_mul_f32 v225,s58,v225
 v_mfma_f32_16x16x32_bf16 v[56:59],a[128:131],a[32:35],0
 ds_read_b128 a[188:191],v20 offset:31744
 v_mul_f32 v226,s58,v226
 v_mul_f32 v227,s58,v227
 v_mfma_f32_16x16x32_bf16 v[56:59],a[132:135],a[36:39],v[56:59]
 v_mul_f32 v228,s58,v228
 v_mul_f32 v229,s58,v229
 v_mul_f32 v230,s58,v230
 v_mfma_f32_16x16x32_bf16 v[56:59],a[136:139],a[40:43],v[56:59]
 v_mul_f32 v231,s58,v231
 v_cvt_pk_bf16_f32 v224,v224,v225
 v_cvt_pk_bf16_f32 v225,v226,v227
 v_mfma_f32_16x16x32_bf16 v[56:59],a[140:143],a[44:47],v[56:59]
 v_cvt_pk_bf16_f32 v226,v228,v229
 s_add_u32 s60,s56,41984
 v_mfma_f32_16x16x32_bf16 v[40:43],a[144:147],a[16:19],v[40:43]
 buffer_load_dwordx4 v15,s[28:31],s33 offen offset:2048 sc1 lds
 v_mfma_f32_16x16x32_bf16 v[40:43],a[148:151],a[20:23],v[40:43]
 buffer_store_dwordx4 v[216:219],v1,s[28:31],s60 offen sc1
 s_nop 1
 v_mfma_f32_16x16x32_bf16 v[40:43],a[152:155],a[24:27],v[40:43]
 v_mov_b32 v216,0
 v_mov_b32 v217,0
 v_mov_b32 v218,0
 v_mfma_f32_16x16x32_bf16 v[40:43],a[156:159],a[28:31],v[40:43]
 v_mov_b32 v219,0
 v_cvt_pk_bf16_f32 v227,v230,v231
 v_mul_f32 v232,s58,v232
 v_mfma_f32_16x16x32_bf16 v[56:59],a[144:147],a[48:51],v[56:59]
 v_mul_f32 v233,s58,v233
 v_mul_f32 v234,s58,v234
 v_mul_f32 v235,s58,v235
 v_mfma_f32_16x16x32_bf16 v[56:59],a[148:151],a[52:55],v[56:59]
 buffer_load_dwordx4 v15,s[28:31],s33 offen offset:3072 sc1 lds
 v_mul_f32 v236,s58,v236
 v_mfma_f32_16x16x32_bf16 v[56:59],a[152:155],a[56:59],v[56:59]
 v_mul_f32 v237,s58,v237
 v_mul_f32 v238,s58,v238
 v_mul_f32 v239,s58,v239
 v_mfma_f32_16x16x32_bf16 v[56:59],a[156:159],a[60:63],v[56:59]
 s_waitcnt lgkmcnt(0)
 v_cvt_pk_bf16_f32 v232,v232,v233
 v_cvt_pk_bf16_f32 v233,v234,v235
 v_mfma_f32_16x16x32_bf16 v[44:47],a[160:163],a[0:3],0
 v_cvt_pk_bf16_f32 v234,v236,v237
 v_cvt_pk_bf16_f32 v235,v238,v239
 v_mul_f32 v240,s58,v240
 v_mfma_f32_16x16x32_bf16 v[44:47],a[164:167],a[4:7],v[44:47]
 v_mul_f32 v241,s58,v241
 v_mul_f32 v242,s58,v242
 s_add_u32 s60,s56,43008
 v_mfma_f32_16x16x32_bf16 v[44:47],a[168:171],a[8:11],v[44:47]
 buffer_store_dwordx4 v[224:227],v1,s[28:31],s60 offen sc1
 s_add_u32 s33,s33,32768
 v_mfma_f32_16x16x32_bf16 v[44:47],a[172:175],a[12:15],v[44:47]
 v_mul_f32 v243,s58,v243
 v_mul_f32 v244,s58,v244
 v_mul_f32 v245,s58,v245
 v_mfma_f32_16x16x32_bf16 v[60:63],a[160:163],a[32:35],0
 v_mul_f32 v246,s58,v246
 v_mul_f32 v247,s58,v247
 v_cvt_pk_bf16_f32 v240,v240,v241
 v_mfma_f32_16x16x32_bf16 v[60:63],a[164:167],a[36:39],v[60:63]
 v_cvt_pk_bf16_f32 v241,v242,v243
 v_cvt_pk_bf16_f32 v242,v244,v245
 v_cvt_pk_bf16_f32 v243,v246,v247
 v_mfma_f32_16x16x32_bf16 v[60:63],a[168:171],a[40:43],v[60:63]
 v_mul_f32 v248,s58,v248
 v_mul_f32 v249,s58,v249
 v_mul_f32 v250,s58,v250
 v_mfma_f32_16x16x32_bf16 v[60:63],a[172:175],a[44:47],v[60:63]
 v_mul_f32 v251,s58,v251
 v_mul_f32 v252,s58,v252
 v_mul_f32 v253,s58,v253
 v_mfma_f32_16x16x32_bf16 v[44:47],a[176:179],a[16:19],v[44:47]
 s_add_u32 s60,s56,44032
 buffer_store_dwordx4 v[232:235],v1,s[28:31],s60 offen sc1
 v_mfma_f32_16x16x32_bf16 v[44:47],a[180:183],a[20:23],v[44:47]
 v_mul_f32 v254,s58,v254
 v_mul_f32 v255,s58,v255
 v_cvt_pk_bf16_f32 v248,v248,v249
 v_mfma_f32_16x16x32_bf16 v[44:47],a[184:187],a[24:27],v[44:47]
 v_cvt_pk_bf16_f32 v249,v250,v251
 v_cvt_pk_bf16_f32 v250,v252,v253
 v_cvt_pk_bf16_f32 v251,v254,v255
 v_mfma_f32_16x16x32_bf16 v[44:47],a[188:191],a[28:31],v[44:47]
 s_nop 1
 v_accvgpr_read_b32 v64,a208
 v_accvgpr_read_b32 v65,a209
 v_mfma_f32_16x16x32_bf16 v[60:63],a[176:179],a[48:51],v[60:63]
 v_accvgpr_read_b32 v66,a210
 v_accvgpr_read_b32 v67,a211
 v_accvgpr_read_b32 v68,a212
 v_mfma_f32_16x16x32_bf16 v[60:63],a[180:183],a[52:55],v[60:63]
 v_accvgpr_read_b32 v69,a213
 v_accvgpr_read_b32 v70,a214
 v_accvgpr_read_b32 v71,a215
 v_mfma_f32_16x16x32_bf16 v[60:63],a[184:187],a[56:59],v[60:63]
 v_mul_f32 v64,s58,v64
 s_add_u32 s60,s56,49152
 v_mfma_f32_16x16x32_bf16 v[60:63],a[188:191],a[60:63],v[60:63]
 buffer_store_dwordx4 v[240:243],v1,s[28:31],s60 offen sc1
 v_mul_f32 v65,s58,v65
 s_barrier
 ds_read_b128 a[64:67],v21 offset:0
 ds_read_b128 a[68:71],v21 offset:1024
 ds_read_b128 a[72:75],v21 offset:2048
 ds_read_b128 a[76:79],v21 offset:3072
 ds_read_b128 a[80:83],v21 offset:4096
 ds_read_b128 a[84:87],v21 offset:5120
 ds_read_b128 a[88:91],v21 offset:6144
 ds_read_b128 a[92:95],v21 offset:7168
 ds_read_b128 a[96:99],v21 offset:8192
 ds_read_b128 a[100:103],v21 offset:9216
 ds_read_b128 a[104:107],v21 offset:10240
 ds_read_b128 a[108:111],v21 offset:11264
 ds_read_b128 a[112:115],v21 offset:12288
 v_max3_f32 v8,v32,v33,v34
 v_mul_f32 v66,s58,v66
 v_mul_f32 v67,s58,v67
 v_max3_f32 v9,v48,v49,v50
 v_mul_f32 v68,s58,v68
 v_max3_f32 v8,v8,v35,v36
 v_mul_f32 v69,s58,v69
 v_max3_f32 v9,v9,v51,v52
 v_mul_f32 v70,s58,v70
 v_max3_f32 v8,v8,v37,v38
 v_mul_f32 v71,s58,v71
 v_cvt_pk_bf16_f32 v64,v64,v65
 v_max3_f32 v9,v9,v53,v54
 v_cvt_pk_bf16_f32 v65,v66,v67
 v_max3_f32 v8,v8,v39,v40
 v_cvt_pk_bf16_f32 v66,v68,v69
 v_max3_f32 v9,v9,v55,v56
 v_cvt_pk_bf16_f32 v67,v70,v71
 v_max3_f32 v8,v8,v41,v42
 s_nop 1
 v_max3_f32 v9,v9,v57,v58
 v_accvgpr_read_b32 v72,a216
 v_accvgpr_read_b32 v73,a217
 v_max3_f32 v8,v8,v43,v44
 v_accvgpr_read_b32 v74,a218
 v_max3_f32 v9,v9,v59,v60
 s_add_u32 s60,s56,50176
 v_max3_f32 v8,v8,v45,v46
 buffer_store_dwordx4 v[248:251],v1,s[28:31],s60 offen sc1
 v_max3_f32 v9,v9,v61,v62
 v_accvgpr_read_b32 v75,a219
 v_max_f32 v8,v8,v47
 v_accvgpr_read_b32 v76,a220
 v_accvgpr_read_b32 v77,a221
 v_max_f32 v9,v9,v63
 v_accvgpr_read_b32 v78,a222
 v_mov_b32 v17,v8
 v_accvgpr_read_b32 v79,a223
 v_mov_b32 v18,v9
 v_mul_f32 v72,s58,v72
 s_nop 1
 v_mul_f32 v73,s58,v73
 v_permlane16_swap_b32 v17,v8
 v_mul_f32 v74,s58,v74
 v_mul_f32 v75,s58,v75
 v_permlane16_swap_b32 v18,v9
 v_mul_f32 v76,s58,v76
 s_nop 0
 v_mul_f32 v77,s58,v77
 v_max_f32 v8,v8,v17
 v_mul_f32 v78,s58,v78
 v_max_f32 v9,v9,v18
 v_mul_f32 v79,s58,v79
 v_mov_b32 v17,v8
 v_cvt_pk_bf16_f32 v72,v72,v73
 v_cvt_pk_bf16_f32 v73,v74,v75
 v_mov_b32 v18,v9
 v_cvt_pk_bf16_f32 v74,v76,v77
 s_nop 1
 s_add_u32 s60,s56,51200
 v_permlane32_swap_b32 v17,v8
 buffer_store_dwordx4 v[64:67],v1,s[28:31],s60 offen sc1
 v_permlane32_swap_b32 v18,v9
 v_cvt_pk_bf16_f32 v75,v78,v79
 s_nop 0
 s_nop 1
 v_accvgpr_read_b32 v80,a224
 v_max_f32 v8,v8,v17
 v_accvgpr_read_b32 v81,a225
 v_max_f32 v9,v9,v18
 v_accvgpr_read_b32 v82,a226
 v_sub_f32 v32,v32,v8
 v_accvgpr_read_b32 v83,a227
 v_sub_f32 v33,v33,v8
 v_accvgpr_read_b32 v84,a228
 v_sub_f32 v34,v34,v8
 v_accvgpr_read_b32 v85,a229
 v_accvgpr_read_b32 v86,a230
 v_sub_f32 v35,v35,v8
 v_accvgpr_read_b32 v87,a231
 v_sub_f32 v36,v36,v8
 v_mul_f32 v80,s58,v80
 v_sub_f32 v37,v37,v8
 v_mul_f32 v81,s58,v81
 v_sub_f32 v38,v38,v8
 v_mul_f32 v82,s58,v82
 v_mul_f32 v83,s58,v83
 v_sub_f32 v39,v39,v8
 v_mul_f32 v84,s58,v84
 v_sub_f32 v40,v40,v8
 s_add_u32 s60,s56,52224
 v_sub_f32 v41,v41,v8
 v_mul_f32 v85,s58,v85
 v_sub_f32 v42,v42,v8
 buffer_store_dwordx4 v[72:75],v1,s[28:31],s60 offen sc1
 v_sub_f32 v43,v43,v8
 v_mul_f32 v86,s58,v86
 v_mul_f32 v87,s58,v87
 v_sub_f32 v44,v44,v8
 v_cvt_pk_bf16_f32 v80,v80,v81
 v_sub_f32 v45,v45,v8
 v_cvt_pk_bf16_f32 v81,v82,v83
 v_sub_f32 v46,v46,v8
 v_cvt_pk_bf16_f32 v82,v84,v85
 v_sub_f32 v47,v47,v8
 v_cvt_pk_bf16_f32 v83,v86,v87
 v_sub_f32 v24,v24,v8
 s_nop 1
 v_accvgpr_read_b32 v88,a232
 v_sub_f32 v25,v25,v8
 v_accvgpr_read_b32 v89,a233
 v_sub_f32 v26,v26,v8
 v_accvgpr_read_b32 v90,a234
 v_sub_f32 v27,v27,v8
 v_accvgpr_read_b32 v91,a235
 v_sub_f32 v48,v48,v9
 v_accvgpr_read_b32 v92,a236
 v_sub_f32 v49,v49,v9
 v_accvgpr_read_b32 v93,a237
 v_accvgpr_read_b32 v94,a238
 v_sub_f32 v50,v50,v9
 v_accvgpr_read_b32 v95,a239
 v_sub_f32 v51,v51,v9
 s_add_u32 s60,s56,57344
 v_sub_f32 v52,v52,v9
 buffer_store_dwordx4 v[80:83],v1,s[28:31],s60 offen sc1
 v_sub_f32 v53,v53,v9
 v_mul_f32 v88,s58,v88
 v_sub_f32 v54,v54,v9
 v_mul_f32 v89,s58,v89
 v_mul_f32 v90,s58,v90
 v_sub_f32 v55,v55,v9
 v_mul_f32 v91,s58,v91
 v_sub_f32 v56,v56,v9
 v_mul_f32 v92,s58,v92
 v_sub_f32 v57,v57,v9
 v_mul_f32 v93,s58,v93
 v_sub_f32 v58,v58,v9
 v_mul_f32 v94,s58,v94
 v_sub_f32 v59,v59,v9
 v_mul_f32 v95,s58,v95
 v_cvt_pk_bf16_f32 v88,v88,v89
 v_sub_f32 v60,v60,v9
 v_cvt_pk_bf16_f32 v89,v90,v91
 v_sub_f32 v61,v61,v9
 v_cvt_pk_bf16_f32 v90,v92,v93
 v_sub_f32 v62,v62,v9
 v_cvt_pk_bf16_f32 v91,v94,v95
 v_sub_f32 v63,v63,v9
 s_nop 1
 v_sub_f32 v28,v28,v9
 v_accvgpr_read_b32 v64,a240
 v_accvgpr_read_b32 v65,a241
 v_sub_f32 v29,v29,v9
 s_add_u32 s60,s56,58368
 v_sub_f32 v30,v30,v9
 v_accvgpr_read_b32 v66,a242
 v_sub_f32 v31,v31,v9
 buffer_store_dwordx4 v[88:91],v1,s[28:31],s60 offen sc1
 v_exp_f32 v32,v32
 v_accvgpr_read_b32 v67,a243
 v_accvgpr_read_b32 v68,a244
 v_exp_f32 v33,v33
 v_accvgpr_read_b32 v69,a245
 v_exp_f32 v48,v48
 v_accvgpr_read_b32 v70,a246
 v_add_f32 v6,v6,v32
 v_accvgpr_read_b32 v71,a247
 v_exp_f32 v49,v49
 v_mul_f32 v64,s58,v64
 v_add_f32 v6,v6,v33
 v_mul_f32 v65,s58,v65
 v_mul_f32 v66,s58,v66
 v_cvt_pk_bf16_f32 v32,v32,v33
 v_mul_f32 v67,s58,v67
 v_exp_f32 v34,v34
 v_mul_f32 v68,s58,v68
 v_add_f32 v7,v7,v48
 v_mul_f32 v69,s58,v69
 v_exp_f32 v35,v35
 v_mul_f32 v70,s58,v70
 v_add_f32 v7,v7,v49
 v_mul_f32 v71,s58,v71
 v_cvt_pk_bf16_f32 v64,v64,v65
 v_cvt_pk_bf16_f32 v48,v48,v49
 v_cvt_pk_bf16_f32 v65,v66,v67
 v_exp_f32 v50,v50
 v_cvt_pk_bf16_f32 v66,v68,v69
 v_add_f32 v6,v6,v34
 v_cvt_pk_bf16_f32 v67,v70,v71
 v_exp_f32 v51,v51
 s_add_u32 s60,s56,59392
 v_add_f32 v6,v6,v35
 buffer_store_dwordx4 v[64:67],v1,s[28:31],s60 offen sc1
 s_nop 1
 v_cvt_pk_bf16_f32 v33,v34,v35
 v_accvgpr_read_b32 v72,a248
 v_exp_f32 v36,v36
 v_accvgpr_read_b32 v73,a249
 v_add_f32 v7,v7,v50
 v_accvgpr_read_b32 v74,a250
 v_exp_f32 v37,v37
 v_accvgpr_read_b32 v75,a251
 v_add_f32 v7,v7,v51
 v_accvgpr_read_b32 v76,a252
 v_accvgpr_read_b32 v77,a253
 v_cvt_pk_bf16_f32 v49,v50,v51
 v_accvgpr_read_b32 v78,a254
 v_exp_f32 v52,v52
 v_accvgpr_read_b32 v79,a255
 v_add_f32 v6,v6,v36
 v_mul_f32 v72,s58,v72
 v_exp_f32 v53,v53
 v_mul_f32 v73,s58,v73
 v_add_f32 v6,v6,v37
 v_mul_f32 v74,s58,v74
 v_mul_f32 v75,s58,v75
 v_cvt_pk_bf16_f32 v34,v36,v37
 v_mul_f32 v76,s58,v76
 v_exp_f32 v38,v38
 v_mul_f32 v77,s58,v77
 v_add_f32 v7,v7,v52
 v_mul_f32 v78,s58,v78
 v_exp_f32 v39,v39
 v_mul_f32 v79,s58,v79
 v_add_f32 v7,v7,v53
 v_cvt_pk_bf16_f32 v72,v72,v73
 v_cvt_pk_bf16_f32 v73,v74,v75
 v_cvt_pk_bf16_f32 v50,v52,v53
 v_cvt_pk_bf16_f32 v74,v76,v77
 v_add_f32 v6,v6,v38
 v_cvt_pk_bf16_f32 v75,v78,v79
 v_add_f32 v6,v6,v39
 s_add_u32 s60,s56,60416
 v_cvt_pk_bf16_f32 v35,v38,v39
 buffer_store_dwordx4 v[72:75],v1,s[28:31],s60 offen sc1
 s_nop 1
 v_lshrrev_b32 v16,4,v1
 s_add_u32 s63,s43,s42
 s_lshl_b32 s62,s46,20
 v_sub_u32 v17,s63,v16
 v_add_u32 v17,2,v17
 v_cmp_le_i32 vcc,s34,v17
 v_add_u32 v18,s52,v17
 s_add_u32 s61,s62,0
 v_cndmask_b32 v17,v17,v18,vcc
 v_lshl_add_u32 v252,v17,15,s61
 v_sub_u32 v17,s63,v16
 v_add_u32 v17,1,v17
 v_cmp_le_i32 vcc,s34,v17
 v_add_u32 v18,s52,v17
 s_add_u32 s61,s62,16777216
 v_cndmask_b32 v17,v17,v18,vcc
 v_lshl_add_u32 v253,v17,15,s61
 s_add_u32 s61,s35,32768
 v_writelane_b32 v252,s35,2
 v_writelane_b32 v252,s61,1
 s_add_u32 s61,s46,16
 s_lshl_b32 s61,s61,7
 s_add_u32 s61,s61,125829120
 v_mov_b32 v5,s61
 s_add_u32 s61,s46,192
 s_lshl_b32 s61,s61,7
 s_add_u32 s61,s61,125829120
 v_writelane_b32 v5,s61,1
 v_readlane_b32 s32,v252,s43
 v_lshrrev_b32 v16,6,v0
 v_add_u32 v2,0x10000,v1
 v_and_b32 v3,15,v0
 v_bfe_u32 v17,v0,4,2
 v_lshlrev_b32 v17,2,v17
 s_add_u32 m0,s68,0
 v_sub_u32 v3,v3,v17
 v_sub_u32 v17,3,v16
 v_lshl_add_u32 v255,v17,4,v3
 v_lshl_add_u32 v3,v16,4,v3
 s_lshl_b32 s61,s45,1
 buffer_load_dwordx4 v14,s[28:31],s32 offen offset:0 sc1 lds
 s_sub_u32 s61,7,s61
 s_mul_i32 s62,s61,229376
 v_add_u32 v249,s62,v1
 v_mov_b32 v4,0xff800000
 s_mov_b32 s12,s78
 buffer_load_dwordx4 v14,s[28:31],s32 offen offset:1024 sc1 lds
 s_and_b32 s13,s79,0xffff
 s_mov_b32 s14,3670016
 s_mov_b32 s15,0x20000
 s_lshl_b32 s61,s46,3
 s_add_u32 s61,s61,s48
 buffer_load_dwordx4 v14,s[28:31],s32 offen offset:2048 sc1 lds
 s_lshl_b32 s66,s61,2
 s_add_u32 s66,s66,s45
 s_lshl_b32 s66,s66,10
 s_add_u32 s66,s66,126877696
 s_lshl_b32 s61,s61,7
 buffer_load_dwordx4 v14,s[28:31],s32 offen offset:3072 sc1 lds
 s_add_u32 s61,s61,125837312
 v_mov_b32 v240,s61
 v_mov_b32 v241,s44
 v_mov_b32 v242,0
 s_lshr_b32 s62,s46,1
 s_add_u32 m0,s68,4096
 s_add_u32 s61,s62,48
 s_lshl_b32 s61,s61,7
 s_add_u32 s61,s61,125829120
 v_writelane_b32 v240,s61,1
 s_mov_b32 s61,125836032
 buffer_load_dwordx4 v15,s[28:31],s32 offen offset:0 sc1 lds
 v_writelane_b32 v240,s61,2
 s_mov_b32 s61,125836160
 v_writelane_b32 v240,s61,3
 s_mov_b32 s61,125835520
 v_writelane_b32 v240,s61,4
 buffer_load_dwordx4 v15,s[28:31],s32 offen offset:1024 sc1 lds
 s_mov_b32 s61,125835648
 v_writelane_b32 v240,s61,5
 v_writelane_b32 v241,16,1
 v_writelane_b32 v241,16,2
 v_writelane_b32 v241,16,3
 buffer_load_dwordx4 v15,s[28:31],s32 offen offset:2048 sc1 lds
 v_writelane_b32 v241,16,4
 v_writelane_b32 v241,16,5
 s_lshl_b32 s61,s45,14
 s_sub_u32 s61,57344,s61
 v_add_u32 v243,s61,v1
 buffer_load_dwordx4 v15,s[28:31],s32 offen offset:3072 sc1 lds
 s_branch K2_PENDS
FLX_59:
FL_60:
 v_cmp_lt_u32 vcc,v31,v30
 s_nop 4
 s_cbranch_vccz FL_60D
 s_sleep 2
 buffer_load_dword v31,v29,s[28:31],0 offen sc1
 s_waitcnt vmcnt(0)
 s_branch FL_60
FL_60D:
 s_branch FLX_59R
G2T_56E:
G2_V:
 v_mfma_f32_16x16x32_bf16 v[48:51],a[192:195],a[64:67],0
 s_add_u32 m0,s51,98304
 v_cvt_pk_bf16_f32 v187,v190,v191
 v_accvgpr_write_b32 a32,v184
 v_mfma_f32_16x16x32_bf16 v[48:51],a[196:199],a[68:71],v[48:51]
 ds_read_b128 a[200:203],v4 offset:2048
 v_accvgpr_write_b32 a33,v185
 v_accvgpr_write_b32 a34,v186
 v_mfma_f32_16x16x32_bf16 v[52:55],a[192:195],a[72:75],0
 v_accvgpr_write_b32 a35,v187
 v_cvt_pk_bf16_f32 v192,v192,v193
 v_cvt_pk_bf16_f32 v193,v194,v195
 v_mfma_f32_16x16x32_bf16 v[52:55],a[196:199],a[76:79],v[52:55]
 ds_read_b128 a[204:207],v5 offset:2048
 s_add_u32 s60,s57,34816
 v_cvt_pk_bf16_f32 v194,v196,v197
 v_mfma_f32_16x16x32_bf16 v[56:59],a[192:195],a[80:83],0
 buffer_load_dwordx4 v16,s[8:11],s32 offen offset:0 lds
 v_cvt_pk_bf16_f32 v195,v198,v199
 v_mfma_f32_16x16x32_bf16 v[56:59],a[196:199],a[84:87],v[56:59]
 v_mfma_f32_16x16x32_bf16 v[60:63],a[192:195],a[88:91],0
 v_mfma_f32_16x16x32_bf16 v[60:63],a[196:199],a[92:95],v[60:63]
 buffer_load_dwordx4 v17,s[8:11],s33 offen offset:1024 lds
 v_mfma_f32_16x16x32_bf16 v[64:67],a[192:195],a[96:99],0
 v_mfma_f32_16x16x32_bf16 v[64:67],a[196:199],a[100:103],v[64:67]
 v_mfma_f32_16x16x32_bf16 v[68:71],a[192:195],a[104:107],0
 v_mfma_f32_16x16x32_bf16 v[68:71],a[196:199],a[108:111],v[68:71]
 buffer_load_dwordx4 v16,s[8:11],s34 offen offset:2048 lds
 v_mfma_f32_16x16x32_bf16 v[72:75],a[192:195],a[112:115],0
 buffer_store_dwordx4 v[192:195],v1,s[28:31],s60 offen sc1
 v_cvt_pk_bf16_f32 v200,v200,v201
 v_mfma_f32_16x16x32_bf16 v[72:75],a[196:199],a[116:119],v[72:75]
 v_cvt_pk_bf16_f32 v201,v202,v203
 v_cvt_pk_bf16_f32 v202,v204,v205
 v_cvt_pk_bf16_f32 v203,v206,v207
 v_mfma_f32_16x16x32_bf16 v[76:79],a[192:195],a[120:123],0
 v_accvgpr_write_b32 a36,v200
 v_accvgpr_write_b32 a37,v201
 v_accvgpr_write_b32 a38,v202
 v_mfma_f32_16x16x32_bf16 v[76:79],a[196:199],a[124:127],v[76:79]
 s_waitcnt lgkmcnt(0)
 v_accvgpr_write_b32 a39,v203
 v_cvt_pk_bf16_f32 v208,v208,v209
 v_mfma_f32_16x16x32_bf16 v[80:83],a[200:203],a[64:67],0
 buffer_load_dwordx4 v17,s[8:11],s35 offen offset:3072 lds
 v_cvt_pk_bf16_f32 v209,v210,v211
 v_mfma_f32_16x16x32_bf16 v[80:83],a[204:207],a[68:71],v[80:83]
 ds_read_b128 a[192:195],v4 offset:4096
 s_add_u32 s60,s57,40960
 v_cvt_pk_bf16_f32 v210,v212,v213
 v_mfma_f32_16x16x32_bf16 v[84:87],a[200:203],a[72:75],0
 v_cvt_pk_bf16_f32 v211,v214,v215
 v_mfma_f32_16x16x32_bf16 v[84:87],a[204:207],a[76:79],v[84:87]
 ds_read_b128 a[196:199],v5 offset:4096
 s_add_u32 m0,s51,102400
 v_mfma_f32_16x16x32_bf16 v[88:91],a[200:203],a[80:83],0
 v_mfma_f32_16x16x32_bf16 v[88:91],a[204:207],a[84:87],v[88:91]
 v_mfma_f32_16x16x32_bf16 v[92:95],a[200:203],a[88:91],0
 v_mfma_f32_16x16x32_bf16 v[92:95],a[204:207],a[92:95],v[92:95]
 buffer_load_dwordx4 v18,s[8:11],s36 offen offset:0 lds
 v_mfma_f32_16x16x32_bf16 v[96:99],a[200:203],a[96:99],0
 v_mfma_f32_16x16x32_bf16 v[96:99],a[204:207],a[100:103],v[96:99]
 v_mfma_f32_16x16x32_bf16 v[100:103],a[200:203],a[104:107],0
 buffer_load_dwordx4 v19,s[8:11],s37 offen offset:1024 lds
 v_mfma_f32_16x16x32_bf16 v[100:103],a[204:207],a[108:111],v[100:103]
 buffer_store_dwordx4 v[208:211],v1,s[28:31],s60 offen sc1
 v_cvt_pk_bf16_f32 v216,v216,v217
 v_mfma_f32_16x16x32_bf16 v[104:107],a[200:203],a[112:115],0
 v_cvt_pk_bf16_f32 v217,v218,v219
 v_cvt_pk_bf16_f32 v218,v220,v221
 v_cvt_pk_bf16_f32 v219,v222,v223
 v_mfma_f32_16x16x32_bf16 v[104:107],a[204:207],a[116:119],v[104:107]
 v_accvgpr_write_b32 a40,v216
 v_accvgpr_write_b32 a41,v217
 v_accvgpr_write_b32 a42,v218
 v_mfma_f32_16x16x32_bf16 v[108:111],a[200:203],a[120:123],0
 buffer_load_dwordx4 v18,s[8:11],s38 offen offset:2048 lds
 v_accvgpr_write_b32 a43,v219
 v_mfma_f32_16x16x32_bf16 v[108:111],a[204:207],a[124:127],v[108:111]
 s_waitcnt lgkmcnt(0)
 v_cvt_pk_bf16_f32 v224,v224,v225
 v_cvt_pk_bf16_f32 v225,v226,v227
 v_mfma_f32_16x16x32_bf16 v[112:115],a[192:195],a[64:67],0
 s_add_u32 s60,s57,43008
 v_cvt_pk_bf16_f32 v226,v228,v229
 v_cvt_pk_bf16_f32 v227,v230,v231
 v_mfma_f32_16x16x32_bf16 v[112:115],a[196:199],a[68:71],v[112:115]
 ds_read_b128 a[200:203],v4 offset:6144
 v_mfma_f32_16x16x32_bf16 v[116:119],a[192:195],a[72:75],0
 buffer_load_dwordx4 v19,s[8:11],s39 offen offset:3072 lds
 v_mfma_f32_16x16x32_bf16 v[116:119],a[196:199],a[76:79],v[116:119]
 ds_read_b128 a[204:207],v5 offset:6144
 v_mfma_f32_16x16x32_bf16 v[120:123],a[192:195],a[80:83],0
 v_mfma_f32_16x16x32_bf16 v[120:123],a[196:199],a[84:87],v[120:123]
 v_mfma_f32_16x16x32_bf16 v[124:127],a[192:195],a[88:91],0
 s_add_u32 s8,s8,524288
 s_addc_u32 s9,s9,0
 v_mfma_f32_16x16x32_bf16 v[124:127],a[196:199],a[92:95],v[124:127]
 v_mfma_f32_16x16x32_bf16 v[128:131],a[192:195],a[96:99],0
 buffer_store_dwordx4 v[224:227],v1,s[28:31],s60 offen sc1
 v_cvt_pk_bf16_f32 v232,v232,v233
 v_mfma_f32_16x16x32_bf16 v[128:131],a[196:199],a[100:103],v[128:131]
 v_cvt_pk_bf16_f32 v233,v234,v235
 v_cvt_pk_bf16_f32 v234,v236,v237
 v_cvt_pk_bf16_f32 v235,v238,v239
 v_mfma_f32_16x16x32_bf16 v[132:135],a[192:195],a[104:107],0
 s_sub_u32 s10,s10,524288
 v_accvgpr_write_b32 a44,v232
 v_accvgpr_write_b32 a45,v233
 v_mfma_f32_16x16x32_bf16 v[132:135],a[196:199],a[108:111],v[132:135]
 v_accvgpr_write_b32 a46,v234
 v_accvgpr_write_b32 a47,v235
 v_cvt_pk_bf16_f32 v240,v240,v241
 v_mfma_f32_16x16x32_bf16 v[136:139],a[192:195],a[112:115],0
 v_cvt_pk_bf16_f32 v241,v242,v243
 s_add_u32 s60,s57,49152
 v_cvt_pk_bf16_f32 v242,v244,v245
 v_mfma_f32_16x16x32_bf16 v[136:139],a[196:199],a[116:119],v[136:139]
 v_cvt_pk_bf16_f32 v243,v246,v247
 v_mfma_f32_16x16x32_bf16 v[140:143],a[192:195],a[120:123],0
 s_add_u32 m0,s50,0
 v_mfma_f32_16x16x32_bf16 v[140:143],a[196:199],a[124:127],v[140:143]
 s_waitcnt lgkmcnt(0)
 v_mfma_f32_16x16x32_bf16 v[144:147],a[200:203],a[64:67],0
 v_mfma_f32_16x16x32_bf16 v[144:147],a[204:207],a[68:71],v[144:147]
 ds_read_b128 a[192:195],v4 offset:8192
 v_mfma_f32_16x16x32_bf16 v[148:151],a[200:203],a[72:75],0
 buffer_load_dwordx4 v14,s[4:7],s32 offen offset:0 lds
 v_mfma_f32_16x16x32_bf16 v[148:151],a[204:207],a[76:79],v[148:151]
 ds_read_b128 a[196:199],v5 offset:8192
 v_mfma_f32_16x16x32_bf16 v[152:155],a[200:203],a[80:83],0
 v_mfma_f32_16x16x32_bf16 v[152:155],a[204:207],a[84:87],v[152:155]
 buffer_load_dwordx4 v15,s[4:7],s33 offen offset:1024 lds
 v_mfma_f32_16x16x32_bf16 v[156:159],a[200:203],a[88:91],0
 buffer_store_dwordx4 v[240:243],v1,s[28:31],s60 offen sc1
 v_cvt_pk_bf16_f32 v248,v248,v249
 v_mfma_f32_16x16x32_bf16 v[156:159],a[204:207],a[92:95],v[156:159]
 v_cvt_pk_bf16_f32 v249,v250,v251
 v_cvt_pk_bf16_f32 v250,v252,v253
 v_cvt_pk_bf16_f32 v251,v254,v255
 v_mfma_f32_16x16x32_bf16 v[160:163],a[200:203],a[96:99],0
 s_waitcnt vmcnt(29)
 s_barrier
 v_accvgpr_write_b32 a48,v248
 v_mfma_f32_16x16x32_bf16 v[160:163],a[204:207],a[100:103],v[160:163]
 ds_read_b64_tr_b16 a[128:129],v6 offset:32768
 v_accvgpr_write_b32 a49,v249
 v_accvgpr_write_b32 a50,v250
 v_mfma_f32_16x16x32_bf16 v[164:167],a[200:203],a[104:107],0
 buffer_load_dwordx4 v14,s[4:7],s34 offen offset:2048 lds
 v_accvgpr_write_b32 a51,v251
 v_mfma_f32_16x16x32_bf16 v[164:167],a[204:207],a[108:111],v[164:167]
 ds_read_b64_tr_b16 a[130:131],v6 offset:34816
 ds_read_b64_tr_b16 a[132:133],v6 offset:49152
 s_nop 1
 v_mfma_f32_16x16x32_bf16 v[168:171],a[200:203],a[112:115],0
 v_accvgpr_read_b32 v40,a208
 v_accvgpr_read_b32 v41,a209
 v_accvgpr_read_b32 v42,a210
 v_mfma_f32_16x16x32_bf16 v[168:171],a[204:207],a[116:119],v[168:171]
 ds_read_b64_tr_b16 a[134:135],v6 offset:51200
 v_accvgpr_read_b32 v43,a211
 v_accvgpr_read_b32 v44,a212
 v_mfma_f32_16x16x32_bf16 v[172:175],a[200:203],a[120:123],0
 buffer_load_dwordx4 v15,s[4:7],s35 offen offset:3072 lds
 v_accvgpr_read_b32 v45,a213
 v_mfma_f32_16x16x32_bf16 v[172:175],a[204:207],a[124:127],v[172:175]
 s_waitcnt lgkmcnt(4)
 ds_read_b64_tr_b16 a[136:137],v7 offset:32768
 v_accvgpr_read_b32 v46,a214
 v_mfma_f32_16x16x32_bf16 v[176:179],a[192:195],a[64:67],0
 ds_read_b64_tr_b16 a[138:139],v7 offset:34816
 v_accvgpr_read_b32 v47,a215
 v_cvt_pk_bf16_f32 v40,v40,v41
 v_mfma_f32_16x16x32_bf16 v[176:179],a[196:199],a[68:71],v[176:179]
 ds_read_b128 a[200:203],v4 offset:10240
 s_add_u32 m0,s50,4096
 v_cvt_pk_bf16_f32 v41,v42,v43
 v_mfma_f32_16x16x32_bf16 v[180:183],a[192:195],a[72:75],0
 ds_read_b64_tr_b16 a[140:141],v7 offset:49152
 s_add_u32 s60,s57,51200
 v_cvt_pk_bf16_f32 v42,v44,v45
 v_mfma_f32_16x16x32_bf16 v[180:183],a[196:199],a[76:79],v[180:183]
 ds_read_b128 a[204:207],v5 offset:10240
 ds_read_b64_tr_b16 a[142:143],v7 offset:51200
 v_cvt_pk_bf16_f32 v43,v46,v47
 v_mfma_f32_16x16x32_bf16 v[184:187],a[192:195],a[80:83],0
 buffer_store_dwordx4 v[40:43],v1,s[28:31],s60 offen sc1
 ds_read_b64_tr_b16 a[144:145],v8 offset:32768
 v_mfma_f32_16x16x32_bf16 v[184:187],a[196:199],a[84:87],v[184:187]
 s_nop 1
 v_accvgpr_read_b32 v40,a216
 v_accvgpr_read_b32 v41,a217
 v_mfma_f32_16x16x32_bf16 v[188:191],a[192:195],a[88:91],0
 ds_read_b64_tr_b16 a[146:147],v8 offset:34816
 v_accvgpr_read_b32 v42,a218
 v_accvgpr_read_b32 v43,a219
 v_mfma_f32_16x16x32_bf16 v[188:191],a[196:199],a[92:95],v[188:191]
 buffer_load_dwordx4 v14,s[4:7],s36 offen offset:0 lds
 v_accvgpr_read_b32 v44,a220
 v_mfma_f32_16x16x32_bf16 v[192:195],a[192:195],a[96:99],0
 ds_read_b64_tr_b16 a[148:149],v8 offset:49152
 v_accvgpr_read_b32 v45,a221
 v_accvgpr_read_b32 v46,a222
 v_mfma_f32_16x16x32_bf16 v[192:195],a[196:199],a[100:103],v[192:195]
 buffer_load_dwordx4 v15,s[4:7],s37 offen offset:1024 lds
 v_accvgpr_read_b32 v47,a223
 v_mfma_f32_16x16x32_bf16 v[196:199],a[192:195],a[104:107],0
 ds_read_b64_tr_b16 a[150:151],v8 offset:51200
 ds_read_b64_tr_b16 a[152:153],v9 offset:32768
 v_cvt_pk_bf16_f32 v40,v40,v41
 v_mfma_f32_16x16x32_bf16 v[196:199],a[196:199],a[108:111],v[196:199]
 v_cvt_pk_bf16_f32 v41,v42,v43
 v_cvt_pk_bf16_f32 v42,v44,v45
 v_cvt_pk_bf16_f32 v43,v46,v47
 v_mfma_f32_16x16x32_bf16 v[200:203],a[192:195],a[112:115],0
 ds_read_b64_tr_b16 a[154:155],v9 offset:34816
 v_accvgpr_write_b32 a52,v40
 v_accvgpr_write_b32 a53,v41
 v_mfma_f32_16x16x32_bf16 v[200:203],a[196:199],a[116:119],v[200:203]
 buffer_load_dwordx4 v14,s[4:7],s38 offen offset:2048 lds
 v_accvgpr_write_b32 a54,v42
 v_mfma_f32_16x16x32_bf16 v[204:207],a[192:195],a[120:123],0
 ds_read_b64_tr_b16 a[156:157],v9 offset:49152
 v_accvgpr_write_b32 a55,v43
 s_nop 1
 v_mfma_f32_16x16x32_bf16 v[204:207],a[196:199],a[124:127],v[204:207]
 s_waitcnt lgkmcnt(8)
 ds_read_b64_tr_b16 a[158:159],v9 offset:51200
 v_accvgpr_read_b32 v40,a224
 v_mfma_f32_16x16x32_bf16 v[208:211],a[200:203],a[64:67],0
 ds_read_b64_tr_b16 a[160:161],v10 offset:32768
 v_accvgpr_read_b32 v41,a225
 v_accvgpr_read_b32 v42,a226
 v_mfma_f32_16x16x32_bf16 v[208:211],a[204:207],a[68:71],v[208:211]
 buffer_load_dwordx4 v15,s[4:7],s39 offen offset:3072 lds
 v_accvgpr_read_b32 v43,a227
 v_mfma_f32_16x16x32_bf16 v[212:215],a[200:203],a[72:75],0
 ds_read_b128 a[192:195],v4 offset:12288
 ds_read_b64_tr_b16 a[162:163],v10 offset:34816
 v_accvgpr_read_b32 v44,a228
 v_mfma_f32_16x16x32_bf16 v[212:215],a[204:207],a[76:79],v[212:215]
 buffer_load_dword v24,v33,s[4:7],0 offen
 v_accvgpr_read_b32 v45,a229
 v_mfma_f32_16x16x32_bf16 v[216:219],a[200:203],a[80:83],0
 ds_read_b128 a[196:199],v5 offset:12288
 ds_read_b64_tr_b16 a[164:165],v10 offset:49152
 v_accvgpr_read_b32 v46,a230
 v_mfma_f32_16x16x32_bf16 v[216:219],a[204:207],a[84:87],v[216:219]
 s_add_u32 s4,s4,128
 s_addc_u32 s5,s5,0
 v_accvgpr_read_b32 v47,a231
 v_mfma_f32_16x16x32_bf16 v[220:223],a[200:203],a[88:91],0
 ds_read_b64_tr_b16 a[166:167],v10 offset:51200
 ds_read_b64_tr_b16 a[168:169],v11 offset:32768
 v_cvt_pk_bf16_f32 v40,v40,v41
 v_mfma_f32_16x16x32_bf16 v[220:223],a[204:207],a[92:95],v[220:223]
 ds_read_b64_tr_b16 a[170:171],v11 offset:34816
 v_cvt_pk_bf16_f32 v41,v42,v43
 s_add_u32 s60,s57,57344
 v_mfma_f32_16x16x32_bf16 v[224:227],a[200:203],a[96:99],0
 s_sub_u32 s6,s6,128
 v_cvt_pk_bf16_f32 v42,v44,v45
 v_cvt_pk_bf16_f32 v43,v46,v47
 v_mfma_f32_16x16x32_bf16 v[224:227],a[204:207],a[100:103],v[224:227]
 buffer_store_dwordx4 v[40:43],v1,s[28:31],s60 offen sc1
 ds_read_b64_tr_b16 a[172:173],v11 offset:49152
 v_mfma_f32_16x16x32_bf16 v[228:231],a[200:203],a[104:107],0
 ds_read_b64_tr_b16 a[174:175],v11 offset:51200
 s_nop 1
 v_accvgpr_read_b32 v40,a232
 v_mfma_f32_16x16x32_bf16 v[228:231],a[204:207],a[108:111],v[228:231]
 v_accvgpr_read_b32 v41,a233
 v_accvgpr_read_b32 v42,a234
 v_accvgpr_read_b32 v43,a235
 v_mfma_f32_16x16x32_bf16 v[232:235],a[200:203],a[112:115],0
 ds_read_b64_tr_b16 a[176:177],v12 offset:32768
 s_add_u32 s50,s50,32768
 v_accvgpr_read_b32 v44,a236
 v_mfma_f32_16x16x32_bf16 v[232:235],a[204:207],a[116:119],v[232:235]
 ds_read_b64_tr_b16 a[178:179],v12 offset:34816
 v_accvgpr_read_b32 v45,a237
 v_accvgpr_read_b32 v46,a238
 v_mfma_f32_16x16x32_bf16 v[236:239],a[200:203],a[120:123],0
 v_accvgpr_read_b32 v47,a239
 v_cvt_pk_bf16_f32 v40,v40,v41
 v_cvt_pk_bf16_f32 v41,v42,v43
 v_mfma_f32_16x16x32_bf16 v[236:239],a[204:207],a[124:127],v[236:239]
 s_waitcnt lgkmcnt(8)
 ds_read_b64_tr_b16 a[180:181],v12 offset:49152
 v_cvt_pk_bf16_f32 v42,v44,v45
 v_mfma_f32_16x16x32_bf16 v[240:243],a[192:195],a[64:67],0
 s_cmp_ge_u32 s50,98304
 s_cselect_b32 s50,s51,s50
 v_cvt_pk_bf16_f32 v43,v46,v47
 v_mfma_f32_16x16x32_bf16 v[240:243],a[196:199],a[68:71],v[240:243]
 ds_read_b64_tr_b16 a[182:183],v12 offset:51200
 ds_read_b128 a[200:203],v4 offset:14336
 v_accvgpr_write_b32 a56,v40
 v_mfma_f32_16x16x32_bf16 v[244:247],a[192:195],a[72:75],0
 ds_read_b64_tr_b16 a[184:185],v13 offset:32768
 v_accvgpr_write_b32 a57,v41
 v_accvgpr_write_b32 a58,v42
 v_mfma_f32_16x16x32_bf16 v[244:247],a[196:199],a[76:79],v[244:247]
 ds_read_b128 a[204:207],v5 offset:14336
 ds_read_b64_tr_b16 a[186:187],v13 offset:34816
 v_accvgpr_write_b32 a59,v43
 v_mfma_f32_16x16x32_bf16 v[248:251],a[192:195],a[80:83],0
 s_nop 1
 v_accvgpr_read_b32 v40,a240
 v_accvgpr_read_b32 v41,a241
 v_mfma_f32_16x16x32_bf16 v[248:251],a[196:199],a[84:87],v[248:251]
 ds_read_b64_tr_b16 a[188:189],v13 offset:49152
 v_accvgpr_read_b32 v42,a242
 v_accvgpr_read_b32 v43,a243
 v_mfma_f32_16x16x32_bf16 v[252:255],a[192:195],a[88:91],0
 ds_read_b64_tr_b16 a[190:191],v13 offset:51200
 v_accvgpr_read_b32 v44,a244
 v_accvgpr_read_b32 v45,a245
 v_mfma_f32_16x16x32_bf16 v[252:255],a[196:199],a[92:95],v[252:255]
 v_accvgpr_read_b32 v46,a246
 v_accvgpr_read_b32 v47,a247
 v_cvt_pk_bf16_f32 v40,v40,v41
 v_mfma_f32_16x16x32_bf16 a[208:211],a[192:195],a[96:99],0
 v_cvt_pk_bf16_f32 v41,v42,v43
 s_add_u32 s60,s57,59392
 v_cvt_pk_bf16_f32 v42,v44,v45
 v_mfma_f32_16x16x32_bf16 a[208:211],a[196:199],a[100:103],a[208:211]
 s_add_u32 s55,s55,32768
 v_cvt_pk_bf16_f32 v43,v46,v47
 v_mfma_f32_16x16x32_bf16 a[212:215],a[192:195],a[104:107],0
 s_cmp_ge_u32 s55,98304
 s_cselect_b32 s55,s54,s55
 v_mfma_f32_16x16x32_bf16 a[212:215],a[196:199],a[108:111],a[212:215]
 buffer_store_dwordx4 v[40:43],v1,s[28:31],s60 offen sc1
 v_add_u32 v4,s55,v2
 v_mfma_f32_16x16x32_bf16 a[216:219],a[192:195],a[112:115],0
 v_add_u32 v5,s55,v3
 s_nop 1
 v_accvgpr_read_b32 v40,a248
 v_mfma_f32_16x16x32_bf16 a[216:219],a[196:199],a[116:119],a[216:219]
 v_accvgpr_read_b32 v41,a249
 v_accvgpr_read_b32 v42,a250
 v_accvgpr_read_b32 v43,a251
 v_mfma_f32_16x16x32_bf16 a[220:223],a[192:195],a[120:123],0
 v_accvgpr_read_b32 v44,a252
 v_accvgpr_read_b32 v45,a253
 v_accvgpr_read_b32 v46,a254
 v_mfma_f32_16x16x32_bf16 a[220:223],a[196:199],a[124:127],a[220:223]
 s_waitcnt vmcnt(28) lgkmcnt(0)
 s_barrier
 v_accvgpr_read_b32 v47,a255
 v_mfma_f32_16x16x32_bf16 a[224:227],a[200:203],a[64:67],0
 ds_read_b128 a[192:195],v4 offset:0
 v_cvt_pk_bf16_f32 v40,v40,v41
 v_cvt_pk_bf16_f32 v41,v42,v43
 v_mfma_f32_16x16x32_bf16 a[224:227],a[204:207],a[68:71],a[224:227]
 ds_read_b128 a[196:199],v5 offset:0
 v_cvt_pk_bf16_f32 v42,v44,v45
 v_cvt_pk_bf16_f32 v43,v46,v47
 v_mfma_f32_16x16x32_bf16 a[228:231],a[200:203],a[72:75],0
 v_accvgpr_write_b32 a60,v40
 v_accvgpr_write_b32 a61,v41
 v_accvgpr_write_b32 a62,v42
 v_mfma_f32_16x16x32_bf16 a[228:231],a[204:207],a[76:79],a[228:231]
 v_accvgpr_write_b32 a63,v43
 v_mfma_f32_16x16x32_bf16 a[232:235],a[200:203],a[80:83],0
 v_mfma_f32_16x16x32_bf16 a[232:235],a[204:207],a[84:87],a[232:235]
 v_mfma_f32_16x16x32_bf16 a[236:239],a[200:203],a[88:91],0
 v_mfma_f32_16x16x32_bf16 a[236:239],a[204:207],a[92:95],a[236:239]
 v_mfma_f32_16x16x32_bf16 a[240:243],a[200:203],a[96:99],0
 v_mfma_f32_16x16x32_bf16 a[240:243],a[204:207],a[100:103],a[240:243]
 v_mfma_f32_16x16x32_bf16 a[244:247],a[200:203],a[104:107],0
 s_add_u32 s60,s57,1024
 buffer_store_dwordx4 a[0:3],v1,s[28:31],s60 offen sc1
 v_mfma_f32_16x16x32_bf16 a[244:247],a[204:207],a[108:111],a[244:247]
 v_mfma_f32_16x16x32_bf16 a[248:251],a[200:203],a[112:115],0
 v_mfma_f32_16x16x32_bf16 a[248:251],a[204:207],a[116:119],a[248:251]
 v_mfma_f32_16x16x32_bf16 a[252:255],a[200:203],a[120:123],0
 v_mfma_f32_16x16x32_bf16 a[252:255],a[204:207],a[124:127],a[252:255]
 s_waitcnt lgkmcnt(0)
 v_mfma_f32_16x16x32_bf16 v[48:51],a[192:195],a[128:131],v[48:51]
 s_add_u32 m0,s51,131072
 v_mfma_f32_16x16x32_bf16 v[48:51],a[196:199],a[132:135],v[48:51]
 ds_read_b128 a[200:203],v4 offset:2048
 s_add_u32 s60,s57,3072
 v_mfma_f32_16x16x32_bf16 v[52:55],a[192:195],a[136:139],v[52:55]
 buffer_store_dwordx4 a[4:7],v1,s[28:31],s60 offen sc1
 v_mfma_f32_16x16x32_bf16 v[52:55],a[196:199],a[140:143],v[52:55]
 ds_read_b128 a[204:207],v5 offset:2048
 v_mfma_f32_16x16x32_bf16 v[56:59],a[192:195],a[144:147],v[56:59]
 v_mfma_f32_16x16x32_bf16 v[56:59],a[196:199],a[148:151],v[56:59]
 buffer_load_dwordx4 v16,s[8:11],s32 offen offset:0 lds
 v_mfma_f32_16x16x32_bf16 v[60:63],a[192:195],a[152:155],v[60:63]
 v_mfma_f32_16x16x32_bf16 v[60:63],a[196:199],a[156:159],v[60:63]
 buffer_load_dwordx4 v17,s[8:11],s33 offen offset:1024 lds
 v_mfma_f32_16x16x32_bf16 v[64:67],a[192:195],a[160:163],v[64:67]
 v_mfma_f32_16x16x32_bf16 v[64:67],a[196:199],a[164:167],v[64:67]
 s_add_u32 s60,s57,9216
 buffer_store_dwordx4 a[8:11],v1,s[28:31],s60 offen sc1
 v_mfma_f32_16x16x32_bf16 v[68:71],a[192:195],a[168:171],v[68:71]
 v_mfma_f32_16x16x32_bf16 v[68:71],a[196:199],a[172:175],v[68:71]
 v_mfma_f32_16x16x32_bf16 v[72:75],a[192:195],a[176:179],v[72:75]
 buffer_load_dwordx4 v16,s[8:11],s34 offen offset:2048 lds
 v_mfma_f32_16x16x32_bf16 v[72:75],a[196:199],a[180:183],v[72:75]
 v_mfma_f32_16x16x32_bf16 v[76:79],a[192:195],a[184:187],v[76:79]
 v_mfma_f32_16x16x32_bf16 v[76:79],a[196:199],a[188:191],v[76:79]
 s_waitcnt lgkmcnt(0)
 v_mfma_f32_16x16x32_bf16 v[80:83],a[200:203],a[128:131],v[80:83]
 buffer_load_dwordx4 v17,s[8:11],s35 offen offset:3072 lds
 s_add_u32 s60,s57,11264
 v_mfma_f32_16x16x32_bf16 v[80:83],a[204:207],a[132:135],v[80:83]
 buffer_store_dwordx4 a[12:15],v1,s[28:31],s60 offen sc1
 ds_read_b128 a[192:195],v4 offset:4096
 v_mfma_f32_16x16x32_bf16 v[84:87],a[200:203],a[136:139],v[84:87]
 v_mfma_f32_16x16x32_bf16 v[84:87],a[204:207],a[140:143],v[84:87]
 ds_read_b128 a[196:199],v5 offset:4096
 s_add_u32 m0,s51,135168
 v_mfma_f32_16x16x32_bf16 v[88:91],a[200:203],a[144:147],v[88:91]
 v_mfma_f32_16x16x32_bf16 v[88:91],a[204:207],a[148:151],v[88:91]
 v_mfma_f32_16x16x32_bf16 v[92:95],a[200:203],a[152:155],v[92:95]
 v_mfma_f32_16x16x32_bf16 v[92:95],a[204:207],a[156:159],v[92:95]
 buffer_load_dwordx4 v18,s[8:11],s36 offen offset:0 lds
 v_mfma_f32_16x16x32_bf16 v[96:99],a[200:203],a[160:163],v[96:99]
 s_add_u32 s60,s57,17408
 buffer_store_dwordx4 a[16:19],v1,s[28:31],s60 offen sc1
 v_mfma_f32_16x16x32_bf16 v[96:99],a[204:207],a[164:167],v[96:99]
 v_mfma_f32_16x16x32_bf16 v[100:103],a[200:203],a[168:171],v[100:103]
 v_mfma_f32_16x16x32_bf16 v[100:103],a[204:207],a[172:175],v[100:103]
 buffer_load_dwordx4 v19,s[8:11],s37 offen offset:1024 lds
 v_mfma_f32_16x16x32_bf16 v[104:107],a[200:203],a[176:179],v[104:107]
 v_mfma_f32_16x16x32_bf16 v[104:107],a[204:207],a[180:183],v[104:107]
 v_mfma_f32_16x16x32_bf16 v[108:111],a[200:203],a[184:187],v[108:111]
 buffer_load_dwordx4 v18,s[8:11],s38 offen offset:2048 lds
 v_mfma_f32_16x16x32_bf16 v[108:111],a[204:207],a[188:191],v[108:111]
 s_waitcnt lgkmcnt(0)
 s_add_u32 s60,s57,19456
 v_mfma_f32_16x16x32_bf16 v[112:115],a[192:195],a[128:131],v[112:115]
 buffer_store_dwordx4 a[20:23],v1,s[28:31],s60 offen sc1
 v_mfma_f32_16x16x32_bf16 v[112:115],a[196:199],a[132:135],v[112:115]
 ds_read_b128 a[200:203],v4 offset:6144
 v_mfma_f32_16x16x32_bf16 v[116:119],a[192:195],a[136:139],v[116:119]
 v_mfma_f32_16x16x32_bf16 v[116:119],a[196:199],a[140:143],v[116:119]
 buffer_load_dwordx4 v19,s[8:11],s39 offen offset:3072 lds
 v_mfma_f32_16x16x32_bf16 v[120:123],a[192:195],a[144:147],v[120:123]
 ds_read_b128 a[204:207],v5 offset:6144
 v_mfma_f32_16x16x32_bf16 v[120:123],a[196:199],a[148:151],v[120:123]
 v_mfma_f32_16x16x32_bf16 v[124:127],a[192:195],a[152:155],v[124:127]
 s_add_u32 s8,s8,524288
 s_addc_u32 s9,s9,0
 v_mfma_f32_16x16x32_bf16 v[124:127],a[196:199],a[156:159],v[124:127]
 s_add_u32 s60,s57,25600
 buffer_store_dwordx4 a[24:27],v1,s[28:31],s60 offen sc1
 v_mfma_f32_16x16x32_bf16 v[128:131],a[192:195],a[160:163],v[128:131]
 v_mfma_f32_16x16x32_bf16 v[128:131],a[196:199],a[164:167],v[128:131]
 v_mfma_f32_16x16x32_bf16 v[132:135],a[192:195],a[168:171],v[132:135]
 s_sub_u32 s10,s10,524288
 v_mfma_f32_16x16x32_bf16 v[132:135],a[196:199],a[172:175],v[132:135]
 v_mfma_f32_16x16x32_bf16 v[136:139],a[192:195],a[176:179],v[136:139]
 v_mfma_f32_16x16x32_bf16 v[136:139],a[196:199],a[180:183],v[136:139]
 v_mfma_f32_16x16x32_bf16 v[140:143],a[192:195],a[184:187],v[140:143]
 s_add_u32 m0,s50,0
 s_add_u32 s60,s57,27648
 v_mfma_f32_16x16x32_bf16 v[140:143],a[196:199],a[188:191],v[140:143]
 s_waitcnt lgkmcnt(0)
 buffer_store_dwordx4 a[28:31],v1,s[28:31],s60 offen sc1
 v_mfma_f32_16x16x32_bf16 v[144:147],a[200:203],a[128:131],v[144:147]
 v_mfma_f32_16x16x32_bf16 v[144:147],a[204:207],a[132:135],v[144:147]
 ds_read_b128 a[192:195],v4 offset:8192
 v_mfma_f32_16x16x32_bf16 v[148:151],a[200:203],a[136:139],v[148:151]
 buffer_load_dwordx4 v14,s[4:7],s32 offen offset:0 lds
 v_mfma_f32_16x16x32_bf16 v[148:151],a[204:207],a[140:143],v[148:151]
 ds_read_b128 a[196:199],v5 offset:8192
 v_mfma_f32_16x16x32_bf16 v[152:155],a[200:203],a[144:147],v[152:155]
 v_mfma_f32_16x16x32_bf16 v[152:155],a[204:207],a[148:151],v[152:155]
 buffer_load_dwordx4 v15,s[4:7],s33 offen offset:1024 lds
 v_mfma_f32_16x16x32_bf16 v[156:159],a[200:203],a[152:155],v[156:159]
 s_add_u32 s60,s57,33792
 buffer_store_dwordx4 a[32:35],v1,s[28:31],s60 offen sc1
 v_mfma_f32_16x16x32_bf16 v[156:159],a[204:207],a[156:159],v[156:159]
 v_mfma_f32_16x16x32_bf16 v[160:163],a[200:203],a[160:163],v[160:163]
 s_waitcnt vmcnt(33)
 s_barrier
 v_mfma_f32_16x16x32_bf16 v[160:163],a[204:207],a[164:167],v[160:163]
 ds_read_b64_tr_b16 a[64:65],v6 offset:0
 v_mfma_f32_16x16x32_bf16 v[164:167],a[200:203],a[168:171],v[164:167]
 buffer_load_dwordx4 v14,s[4:7],s34 offen offset:2048 lds
 v_mfma_f32_16x16x32_bf16 v[164:167],a[204:207],a[172:175],v[164:167]
 ds_read_b64_tr_b16 a[66:67],v6 offset:2048
 ds_read_b64_tr_b16 a[68:69],v6 offset:16384
 v_mfma_f32_16x16x32_bf16 v[168:171],a[200:203],a[176:179],v[168:171]
 v_mfma_f32_16x16x32_bf16 v[168:171],a[204:207],a[180:183],v[168:171]
 ds_read_b64_tr_b16 a[70:71],v6 offset:18432
 s_add_u32 s60,s57,35840
 v_mfma_f32_16x16x32_bf16 v[172:175],a[200:203],a[184:187],v[172:175]
 buffer_load_dwordx4 v15,s[4:7],s35 offen offset:3072 lds
 v_mfma_f32_16x16x32_bf16 v[172:175],a[204:207],a[188:191],v[172:175]
 s_waitcnt lgkmcnt(4)
 ds_read_b64_tr_b16 a[72:73],v7 offset:0
 v_mfma_f32_16x16x32_bf16 v[176:179],a[192:195],a[128:131],v[176:179]
 buffer_store_dwordx4 a[36:39],v1,s[28:31],s60 offen sc1
 ds_read_b64_tr_b16 a[74:75],v7 offset:2048
 v_mfma_f32_16x16x32_bf16 v[176:179],a[196:199],a[132:135],v[176:179]
 ds_read_b128 a[200:203],v4 offset:10240
 s_add_u32 m0,s50,4096
 v_mfma_f32_16x16x32_bf16 v[180:183],a[192:195],a[136:139],v[180:183]
 ds_read_b64_tr_b16 a[76:77],v7 offset:16384
 v_mfma_f32_16x16x32_bf16 v[180:183],a[196:199],a[140:143],v[180:183]
 ds_read_b128 a[204:207],v5 offset:10240
 ds_read_b64_tr_b16 a[78:79],v7 offset:18432
 v_mfma_f32_16x16x32_bf16 v[184:187],a[192:195],a[144:147],v[184:187]
 ds_read_b64_tr_b16 a[80:81],v8 offset:0
 v_mfma_f32_16x16x32_bf16 v[184:187],a[196:199],a[148:151],v[184:187]
 buffer_load_dwordx4 v14,s[4:7],s36 offen offset:0 lds
 s_add_u32 s60,s57,41984
 v_mfma_f32_16x16x32_bf16 v[188:191],a[192:195],a[152:155],v[188:191]
 buffer_store_dwordx4 a[40:43],v1,s[28:31],s60 offen sc1
 ds_read_b64_tr_b16 a[82:83],v8 offset:2048
 v_mfma_f32_16x16x32_bf16 v[188:191],a[196:199],a[156:159],v[188:191]
 ds_read_b64_tr_b16 a[84:85],v8 offset:16384
 v_mfma_f32_16x16x32_bf16 v[192:195],a[192:195],a[160:163],v[192:195]
 v_mfma_f32_16x16x32_bf16 v[192:195],a[196:199],a[164:167],v[192:195]
 buffer_load_dwordx4 v15,s[4:7],s37 offen offset:1024 lds
 v_mfma_f32_16x16x32_bf16 v[196:199],a[192:195],a[168:171],v[196:199]
 ds_read_b64_tr_b16 a[86:87],v8 offset:18432
 ds_read_b64_tr_b16 a[88:89],v9 offset:0
 v_mfma_f32_16x16x32_bf16 v[196:199],a[196:199],a[172:175],v[196:199]
 v_mfma_f32_16x16x32_bf16 v[200:203],a[192:195],a[176:179],v[200:203]
 ds_read_b64_tr_b16 a[90:91],v9 offset:2048
 s_add_u32 s60,s57,44032
 v_mfma_f32_16x16x32_bf16 v[200:203],a[196:199],a[180:183],v[200:203]
 buffer_load_dwordx4 v14,s[4:7],s38 offen offset:2048 lds
 v_mfma_f32_16x16x32_bf16 v[204:207],a[192:195],a[184:187],v[204:207]
 buffer_store_dwordx4 a[44:47],v1,s[28:31],s60 offen sc1
 ds_read_b64_tr_b16 a[92:93],v9 offset:16384
 v_mfma_f32_16x16x32_bf16 v[204:207],a[196:199],a[188:191],v[204:207]
 s_waitcnt lgkmcnt(8)
 ds_read_b64_tr_b16 a[94:95],v9 offset:18432
 v_mfma_f32_16x16x32_bf16 v[208:211],a[200:203],a[128:131],v[208:211]
 ds_read_b64_tr_b16 a[96:97],v10 offset:0
 v_mfma_f32_16x16x32_bf16 v[208:211],a[204:207],a[132:135],v[208:211]
 buffer_load_dwordx4 v15,s[4:7],s39 offen offset:3072 lds
 v_mfma_f32_16x16x32_bf16 v[212:215],a[200:203],a[136:139],v[212:215]
 ds_read_b128 a[192:195],v4 offset:12288
 ds_read_b64_tr_b16 a[98:99],v10 offset:2048
 v_mfma_f32_16x16x32_bf16 v[212:215],a[204:207],a[140:143],v[212:215]
 ds_read_b128 a[196:199],v5 offset:12288
 ds_read_b64_tr_b16 a[100:101],v10 offset:16384
 v_mfma_f32_16x16x32_bf16 v[216:219],a[200:203],a[144:147],v[216:219]
 s_add_u32 s4,s4,128
 s_addc_u32 s5,s5,0
 s_add_u32 s60,s57,50176
 v_mfma_f32_16x16x32_bf16 v[216:219],a[204:207],a[148:151],v[216:219]
 buffer_store_dwordx4 a[48:51],v1,s[28:31],s60 offen sc1
 ds_read_b64_tr_b16 a[102:103],v10 offset:18432
 v_mfma_f32_16x16x32_bf16 v[220:223],a[200:203],a[152:155],v[220:223]
 ds_read_b64_tr_b16 a[104:105],v11 offset:0
 v_mfma_f32_16x16x32_bf16 v[220:223],a[204:207],a[156:159],v[220:223]
 ds_read_b64_tr_b16 a[106:107],v11 offset:2048
 v_mfma_f32_16x16x32_bf16 v[224:227],a[200:203],a[160:163],v[224:227]
 s_sub_u32 s6,s6,128
 v_mfma_f32_16x16x32_bf16 v[224:227],a[204:207],a[164:167],v[224:227]
 ds_read_b64_tr_b16 a[108:109],v11 offset:16384
 v_mfma_f32_16x16x32_bf16 v[228:231],a[200:203],a[168:171],v[228:231]
 ds_read_b64_tr_b16 a[110:111],v11 offset:18432
 v_mfma_f32_16x16x32_bf16 v[228:231],a[204:207],a[172:175],v[228:231]
 s_add_u32 s60,s57,52224
 buffer_store_dwordx4 a[52:55],v1,s[28:31],s60 offen sc1
 v_mfma_f32_16x16x32_bf16 v[232:235],a[200:203],a[176:179],v[232:235]
 ds_read_b64_tr_b16 a[112:113],v12 offset:0
 s_add_u32 s50,s50,32768
 v_mfma_f32_16x16x32_bf16 v[232:235],a[204:207],a[180:183],v[232:235]
 ds_read_b64_tr_b16 a[114:115],v12 offset:2048
 v_mfma_f32_16x16x32_bf16 v[236:239],a[200:203],a[184:187],v[236:239]
 v_mfma_f32_16x16x32_bf16 v[236:239],a[204:207],a[188:191],v[236:239]
 s_waitcnt lgkmcnt(8)
 ds_read_b64_tr_b16 a[116:117],v12 offset:16384
 v_mfma_f32_16x16x32_bf16 v[240:243],a[192:195],a[128:131],v[240:243]
 s_cmp_ge_u32 s50,98304
 s_cselect_b32 s50,s51,s50
 v_mfma_f32_16x16x32_bf16 v[240:243],a[196:199],a[132:135],v[240:243]
 ds_read_b64_tr_b16 a[118:119],v12 offset:18432
 ds_read_b128 a[200:203],v4 offset:14336
 v_mfma_f32_16x16x32_bf16 v[244:247],a[192:195],a[136:139],v[244:247]
 ds_read_b64_tr_b16 a[120:121],v13 offset:0
 v_mfma_f32_16x16x32_bf16 v[244:247],a[196:199],a[140:143],v[244:247]
 ds_read_b128 a[204:207],v5 offset:14336
 ds_read_b64_tr_b16 a[122:123],v13 offset:2048
 s_add_u32 s60,s57,58368
 v_mfma_f32_16x16x32_bf16 v[248:251],a[192:195],a[144:147],v[248:251]
 buffer_store_dwordx4 a[56:59],v1,s[28:31],s60 offen sc1
 v_mfma_f32_16x16x32_bf16 v[248:251],a[196:199],a[148:151],v[248:251]
 ds_read_b64_tr_b16 a[124:125],v13 offset:16384
 v_mfma_f32_16x16x32_bf16 v[252:255],a[192:195],a[152:155],v[252:255]
 ds_read_b64_tr_b16 a[126:127],v13 offset:18432
 v_mfma_f32_16x16x32_bf16 v[252:255],a[196:199],a[156:159],v[252:255]
 v_mfma_f32_16x16x32_bf16 a[208:211],a[192:195],a[160:163],a[208:211]
 v_mfma_f32_16x16x32_bf16 a[208:211],a[196:199],a[164:167],a[208:211]
 s_add_u32 s55,s55,32768
 v_mfma_f32_16x16x32_bf16 a[212:215],a[192:195],a[168:171],a[212:215]
 s_cmp_ge_u32 s55,98304
 s_cselect_b32 s55,s54,s55
 s_add_u32 s60,s57,60416
 v_mfma_f32_16x16x32_bf16 a[212:215],a[196:199],a[172:175],a[212:215]
 buffer_store_dwordx4 a[60:63],v1,s[28:31],s60 offen sc1
 v_add_u32 v4,s55,v2
 v_mfma_f32_16x16x32_bf16 a[216:219],a[192:195],a[176:179],a[216:219]
 v_add_u32 v5,s55,v3
 v_mfma_f32_16x16x32_bf16 a[216:219],a[196:199],a[180:183],a[216:219]
 v_mfma_f32_16x16x32_bf16 a[220:223],a[192:195],a[184:187],a[220:223]
 v_mfma_f32_16x16x32_bf16 a[220:223],a[196:199],a[188:191],a[220:223]
 s_waitcnt vmcnt(35) lgkmcnt(0)
 s_barrier
 v_mfma_f32_16x16x32_bf16 a[224:227],a[200:203],a[128:131],a[224:227]
 ds_read_b128 a[192:195],v4 offset:0
 v_mfma_f32_16x16x32_bf16 a[224:227],a[204:207],a[132:135],a[224:227]
 ds_read_b128 a[196:199],v5 offset:0
 v_mfma_f32_16x16x32_bf16 a[228:231],a[200:203],a[136:139],a[228:231]
 v_mfma_f32_16x16x32_bf16 a[228:231],a[204:207],a[140:143],a[228:231]
 v_mfma_f32_16x16x32_bf16 a[232:235],a[200:203],a[144:147],a[232:235]
 v_mfma_f32_16x16x32_bf16 a[232:235],a[204:207],a[148:151],a[232:235]
 v_mfma_f32_16x16x32_bf16 a[236:239],a[200:203],a[152:155],a[236:239]
 v_mfma_f32_16x16x32_bf16 a[236:239],a[204:207],a[156:159],a[236:239]
 v_mfma_f32_16x16x32_bf16 a[240:243],a[200:203],a[160:163],a[240:243]
 v_mfma_f32_16x16x32_bf16 a[240:243],a[204:207],a[164:167],a[240:243]
 v_mfma_f32_16x16x32_bf16 a[244:247],a[200:203],a[168:171],a[244:247]
 v_mfma_f32_16x16x32_bf16 a[244:247],a[204:207],a[172:175],a[244:247]
 v_mfma_f32_16x16x32_bf16 a[248:251],a[200:203],a[176:179],a[248:251]
 v_mfma_f32_16x16x32_bf16 a[248:251],a[204:207],a[180:183],a[248:251]
 v_mfma_f32_16x16x32_bf16 a[252:255],a[200:203],a[184:187],a[252:255]
 v_mfma_f32_16x16x32_bf16 a[252:255],a[204:207],a[188:191],a[252:255]
 s_waitcnt lgkmcnt(0)
ZP_62:
 v_readfirstlane_b32 s61,v34
 s_nop 3
 s_cmp_lg_u32 s61,0
 s_cbranch_scc1 ZC_61
 v_mov_b32 v26,0
 global_load_dword v34,v26,s[70:71] sc1
 s_waitcnt vmcnt(0)
 s_branch ZP_62
ZC_61:
 s_mov_b32 s49,6
.p2align 6
KVL_63:
 v_mfma_f32_16x16x32_bf16 v[48:51],a[192:195],a[64:67],v[48:51]
 s_add_u32 m0,s51,98304
 v_mfma_f32_16x16x32_bf16 v[48:51],a[196:199],a[68:71],v[48:51]
 ds_read_b128 a[200:203],v4 offset:2048
 v_mfma_f32_16x16x32_bf16 v[52:55],a[192:195],a[72:75],v[52:55]
 v_mfma_f32_16x16x32_bf16 v[52:55],a[196:199],a[76:79],v[52:55]
 ds_read_b128 a[204:207],v5 offset:2048
 v_mfma_f32_16x16x32_bf16 v[56:59],a[192:195],a[80:83],v[56:59]
 buffer_load_dwordx4 v16,s[8:11],s32 offen offset:0 lds
 v_mfma_f32_16x16x32_bf16 v[56:59],a[196:199],a[84:87],v[56:59]
 v_mfma_f32_16x16x32_bf16 v[60:63],a[192:195],a[88:91],v[60:63]
 v_mfma_f32_16x16x32_bf16 v[60:63],a[196:199],a[92:95],v[60:63]
 buffer_load_dwordx4 v17,s[8:11],s33 offen offset:1024 lds
 v_mfma_f32_16x16x32_bf16 v[64:67],a[192:195],a[96:99],v[64:67]
 v_mfma_f32_16x16x32_bf16 v[64:67],a[196:199],a[100:103],v[64:67]
 v_mfma_f32_16x16x32_bf16 v[68:71],a[192:195],a[104:107],v[68:71]
 v_mfma_f32_16x16x32_bf16 v[68:71],a[196:199],a[108:111],v[68:71]
 buffer_load_dwordx4 v16,s[8:11],s34 offen offset:2048 lds
 v_mfma_f32_16x16x32_bf16 v[72:75],a[192:195],a[112:115],v[72:75]
 v_mfma_f32_16x16x32_bf16 v[72:75],a[196:199],a[116:119],v[72:75]
 v_mfma_f32_16x16x32_bf16 v[76:79],a[192:195],a[120:123],v[76:79]
 v_mfma_f32_16x16x32_bf16 v[76:79],a[196:199],a[124:127],v[76:79]
 s_waitcnt lgkmcnt(0)
 v_mfma_f32_16x16x32_bf16 v[80:83],a[200:203],a[64:67],v[80:83]
 buffer_load_dwordx4 v17,s[8:11],s35 offen offset:3072 lds
 v_mfma_f32_16x16x32_bf16 v[80:83],a[204:207],a[68:71],v[80:83]
 ds_read_b128 a[192:195],v4 offset:4096
 v_mfma_f32_16x16x32_bf16 v[84:87],a[200:203],a[72:75],v[84:87]
 v_mfma_f32_16x16x32_bf16 v[84:87],a[204:207],a[76:79],v[84:87]
 ds_read_b128 a[196:199],v5 offset:4096
 s_add_u32 m0,s51,102400
 v_mfma_f32_16x16x32_bf16 v[88:91],a[200:203],a[80:83],v[88:91]
 v_mfma_f32_16x16x32_bf16 v[88:91],a[204:207],a[84:87],v[88:91]
 v_mfma_f32_16x16x32_bf16 v[92:95],a[200:203],a[88:91],v[92:95]
 v_mfma_f32_16x16x32_bf16 v[92:95],a[204:207],a[92:95],v[92:95]
 buffer_load_dwordx4 v18,s[8:11],s36 offen offset:0 lds
 v_mfma_f32_16x16x32_bf16 v[96:99],a[200:203],a[96:99],v[96:99]
 v_mfma_f32_16x16x32_bf16 v[96:99],a[204:207],a[100:103],v[96:99]
 v_mfma_f32_16x16x32_bf16 v[100:103],a[200:203],a[104:107],v[100:103]
 buffer_load_dwordx4 v19,s[8:11],s37 offen offset:1024 lds
 v_mfma_f32_16x16x32_bf16 v[100:103],a[204:207],a[108:111],v[100:103]
 v_mfma_f32_16x16x32_bf16 v[104:107],a[200:203],a[112:115],v[104:107]
 v_mfma_f32_16x16x32_bf16 v[104:107],a[204:207],a[116:119],v[104:107]
 v_mfma_f32_16x16x32_bf16 v[108:111],a[200:203],a[120:123],v[108:111]
 buffer_load_dwordx4 v18,s[8:11],s38 offen offset:2048 lds
 v_mfma_f32_16x16x32_bf16 v[108:111],a[204:207],a[124:127],v[108:111]
 s_waitcnt lgkmcnt(0)
 v_mfma_f32_16x16x32_bf16 v[112:115],a[192:195],a[64:67],v[112:115]
 v_mfma_f32_16x16x32_bf16 v[112:115],a[196:199],a[68:71],v[112:115]
 ds_read_b128 a[200:203],v4 offset:6144
 v_mfma_f32_16x16x32_bf16 v[116:119],a[192:195],a[72:75],v[116:119]
 buffer_load_dwordx4 v19,s[8:11],s39 offen offset:3072 lds
 v_mfma_f32_16x16x32_bf16 v[116:119],a[196:199],a[76:79],v[116:119]
 ds_read_b128 a[204:207],v5 offset:6144
 v_mfma_f32_16x16x32_bf16 v[120:123],a[192:195],a[80:83],v[120:123]
 v_mfma_f32_16x16x32_bf16 v[120:123],a[196:199],a[84:87],v[120:123]
 v_mfma_f32_16x16x32_bf16 v[124:127],a[192:195],a[88:91],v[124:127]
 s_add_u32 s8,s8,524288
 s_addc_u32 s9,s9,0
 v_mfma_f32_16x16x32_bf16 v[124:127],a[196:199],a[92:95],v[124:127]
 v_mfma_f32_16x16x32_bf16 v[128:131],a[192:195],a[96:99],v[128:131]
 v_mfma_f32_16x16x32_bf16 v[128:131],a[196:199],a[100:103],v[128:131]
 v_mfma_f32_16x16x32_bf16 v[132:135],a[192:195],a[104:107],v[132:135]
 s_sub_u32 s10,s10,524288
 v_mfma_f32_16x16x32_bf16 v[132:135],a[196:199],a[108:111],v[132:135]
 v_mfma_f32_16x16x32_bf16 v[136:139],a[192:195],a[112:115],v[136:139]
 v_mfma_f32_16x16x32_bf16 v[136:139],a[196:199],a[116:119],v[136:139]
 v_mfma_f32_16x16x32_bf16 v[140:143],a[192:195],a[120:123],v[140:143]
 s_add_u32 m0,s50,0
 v_mfma_f32_16x16x32_bf16 v[140:143],a[196:199],a[124:127],v[140:143]
 s_waitcnt lgkmcnt(0)
 v_mfma_f32_16x16x32_bf16 v[144:147],a[200:203],a[64:67],v[144:147]
 v_mfma_f32_16x16x32_bf16 v[144:147],a[204:207],a[68:71],v[144:147]
 ds_read_b128 a[192:195],v4 offset:8192
 v_mfma_f32_16x16x32_bf16 v[148:151],a[200:203],a[72:75],v[148:151]
 buffer_load_dwordx4 v14,s[4:7],s32 offen offset:0 lds
 v_mfma_f32_16x16x32_bf16 v[148:151],a[204:207],a[76:79],v[148:151]
 ds_read_b128 a[196:199],v5 offset:8192
 v_mfma_f32_16x16x32_bf16 v[152:155],a[200:203],a[80:83],v[152:155]
 v_mfma_f32_16x16x32_bf16 v[152:155],a[204:207],a[84:87],v[152:155]
 buffer_load_dwordx4 v15,s[4:7],s33 offen offset:1024 lds
 v_mfma_f32_16x16x32_bf16 v[156:159],a[200:203],a[88:91],v[156:159]
 v_mfma_f32_16x16x32_bf16 v[156:159],a[204:207],a[92:95],v[156:159]
 v_mfma_f32_16x16x32_bf16 v[160:163],a[200:203],a[96:99],v[160:163]
 s_waitcnt vmcnt(18)
 s_barrier
 v_mfma_f32_16x16x32_bf16 v[160:163],a[204:207],a[100:103],v[160:163]
 ds_read_b64_tr_b16 a[128:129],v6 offset:32768
 v_mfma_f32_16x16x32_bf16 v[164:167],a[200:203],a[104:107],v[164:167]
 buffer_load_dwordx4 v14,s[4:7],s34 offen offset:2048 lds
 v_mfma_f32_16x16x32_bf16 v[164:167],a[204:207],a[108:111],v[164:167]
 ds_read_b64_tr_b16 a[130:131],v6 offset:34816
 ds_read_b64_tr_b16 a[132:133],v6 offset:49152
 v_mfma_f32_16x16x32_bf16 v[168:171],a[200:203],a[112:115],v[168:171]
 v_mfma_f32_16x16x32_bf16 v[168:171],a[204:207],a[116:119],v[168:171]
 ds_read_b64_tr_b16 a[134:135],v6 offset:51200
 v_mfma_f32_16x16x32_bf16 v[172:175],a[200:203],a[120:123],v[172:175]
 buffer_load_dwordx4 v15,s[4:7],s35 offen offset:3072 lds
 v_mfma_f32_16x16x32_bf16 v[172:175],a[204:207],a[124:127],v[172:175]
 s_waitcnt lgkmcnt(4)
 ds_read_b64_tr_b16 a[136:137],v7 offset:32768
 v_mfma_f32_16x16x32_bf16 v[176:179],a[192:195],a[64:67],v[176:179]
 ds_read_b64_tr_b16 a[138:139],v7 offset:34816
 v_mfma_f32_16x16x32_bf16 v[176:179],a[196:199],a[68:71],v[176:179]
 ds_read_b128 a[200:203],v4 offset:10240
 s_add_u32 m0,s50,4096
 v_mfma_f32_16x16x32_bf16 v[180:183],a[192:195],a[72:75],v[180:183]
 ds_read_b64_tr_b16 a[140:141],v7 offset:49152
 v_mfma_f32_16x16x32_bf16 v[180:183],a[196:199],a[76:79],v[180:183]
 ds_read_b128 a[204:207],v5 offset:10240
 ds_read_b64_tr_b16 a[142:143],v7 offset:51200
 v_mfma_f32_16x16x32_bf16 v[184:187],a[192:195],a[80:83],v[184:187]
 ds_read_b64_tr_b16 a[144:145],v8 offset:32768
 v_mfma_f32_16x16x32_bf16 v[184:187],a[196:199],a[84:87],v[184:187]
 buffer_load_dwordx4 v14,s[4:7],s36 offen offset:0 lds
 v_mfma_f32_16x16x32_bf16 v[188:191],a[192:195],a[88:91],v[188:191]
 ds_read_b64_tr_b16 a[146:147],v8 offset:34816
 v_mfma_f32_16x16x32_bf16 v[188:191],a[196:199],a[92:95],v[188:191]
 ds_read_b64_tr_b16 a[148:149],v8 offset:49152
 v_mfma_f32_16x16x32_bf16 v[192:195],a[192:195],a[96:99],v[192:195]
 v_mfma_f32_16x16x32_bf16 v[192:195],a[196:199],a[100:103],v[192:195]
 buffer_load_dwordx4 v15,s[4:7],s37 offen offset:1024 lds
 v_mfma_f32_16x16x32_bf16 v[196:199],a[192:195],a[104:107],v[196:199]
 ds_read_b64_tr_b16 a[150:151],v8 offset:51200
 ds_read_b64_tr_b16 a[152:153],v9 offset:32768
 v_mfma_f32_16x16x32_bf16 v[196:199],a[196:199],a[108:111],v[196:199]
 v_mfma_f32_16x16x32_bf16 v[200:203],a[192:195],a[112:115],v[200:203]
 ds_read_b64_tr_b16 a[154:155],v9 offset:34816
 v_mfma_f32_16x16x32_bf16 v[200:203],a[196:199],a[116:119],v[200:203]
 buffer_load_dwordx4 v14,s[4:7],s38 offen offset:2048 lds
 v_mfma_f32_16x16x32_bf16 v[204:207],a[192:195],a[120:123],v[204:207]
 ds_read_b64_tr_b16 a[156:157],v9 offset:49152
 v_mfma_f32_16x16x32_bf16 v[204:207],a[196:199],a[124:127],v[204:207]
 s_waitcnt lgkmcnt(8)
 ds_read_b64_tr_b16 a[158:159],v9 offset:51200
 v_mfma_f32_16x16x32_bf16 v[208:211],a[200:203],a[64:67],v[208:211]
 ds_read_b64_tr_b16 a[160:161],v10 offset:32768
 v_mfma_f32_16x16x32_bf16 v[208:211],a[204:207],a[68:71],v[208:211]
 buffer_load_dwordx4 v15,s[4:7],s39 offen offset:3072 lds
 v_mfma_f32_16x16x32_bf16 v[212:215],a[200:203],a[72:75],v[212:215]
 ds_read_b128 a[192:195],v4 offset:12288
 ds_read_b64_tr_b16 a[162:163],v10 offset:34816
 v_mfma_f32_16x16x32_bf16 v[212:215],a[204:207],a[76:79],v[212:215]
 buffer_load_dword v24,v33,s[4:7],0 offen
 v_mfma_f32_16x16x32_bf16 v[216:219],a[200:203],a[80:83],v[216:219]
 ds_read_b128 a[196:199],v5 offset:12288
 ds_read_b64_tr_b16 a[164:165],v10 offset:49152
 v_mfma_f32_16x16x32_bf16 v[216:219],a[204:207],a[84:87],v[216:219]
 s_add_u32 s4,s4,128
 s_addc_u32 s5,s5,0
 v_mfma_f32_16x16x32_bf16 v[220:223],a[200:203],a[88:91],v[220:223]
 ds_read_b64_tr_b16 a[166:167],v10 offset:51200
 ds_read_b64_tr_b16 a[168:169],v11 offset:32768
 v_mfma_f32_16x16x32_bf16 v[220:223],a[204:207],a[92:95],v[220:223]
 ds_read_b64_tr_b16 a[170:171],v11 offset:34816
 v_mfma_f32_16x16x32_bf16 v[224:227],a[200:203],a[96:99],v[224:227]
 s_sub_u32 s6,s6,128
 v_mfma_f32_16x16x32_bf16 v[224:227],a[204:207],a[100:103],v[224:227]
 ds_read_b64_tr_b16 a[172:173],v11 offset:49152
 v_mfma_f32_16x16x32_bf16 v[228:231],a[200:203],a[104:107],v[228:231]
 ds_read_b64_tr_b16 a[174:175],v11 offset:51200
 v_mfma_f32_16x16x32_bf16 v[228:231],a[204:207],a[108:111],v[228:231]
 v_mfma_f32_16x16x32_bf16 v[232:235],a[200:203],a[112:115],v[232:235]
 ds_read_b64_tr_b16 a[176:177],v12 offset:32768
 s_add_u32 s50,s50,32768
 v_mfma_f32_16x16x32_bf16 v[232:235],a[204:207],a[116:119],v[232:235]
 ds_read_b64_tr_b16 a[178:179],v12 offset:34816
 v_mfma_f32_16x16x32_bf16 v[236:239],a[200:203],a[120:123],v[236:239]
 v_mfma_f32_16x16x32_bf16 v[236:239],a[204:207],a[124:127],v[236:239]
 s_waitcnt lgkmcnt(8)
 ds_read_b64_tr_b16 a[180:181],v12 offset:49152
 v_mfma_f32_16x16x32_bf16 v[240:243],a[192:195],a[64:67],v[240:243]
 s_cmp_ge_u32 s50,98304
 s_cselect_b32 s50,s51,s50
 v_mfma_f32_16x16x32_bf16 v[240:243],a[196:199],a[68:71],v[240:243]
 ds_read_b64_tr_b16 a[182:183],v12 offset:51200
 ds_read_b128 a[200:203],v4 offset:14336
 v_mfma_f32_16x16x32_bf16 v[244:247],a[192:195],a[72:75],v[244:247]
 ds_read_b64_tr_b16 a[184:185],v13 offset:32768
 v_mfma_f32_16x16x32_bf16 v[244:247],a[196:199],a[76:79],v[244:247]
 ds_read_b128 a[204:207],v5 offset:14336
 ds_read_b64_tr_b16 a[186:187],v13 offset:34816
 v_mfma_f32_16x16x32_bf16 v[248:251],a[192:195],a[80:83],v[248:251]
 v_mfma_f32_16x16x32_bf16 v[248:251],a[196:199],a[84:87],v[248:251]
 ds_read_b64_tr_b16 a[188:189],v13 offset:49152
 v_mfma_f32_16x16x32_bf16 v[252:255],a[192:195],a[88:91],v[252:255]
 ds_read_b64_tr_b16 a[190:191],v13 offset:51200
 v_mfma_f32_16x16x32_bf16 v[252:255],a[196:199],a[92:95],v[252:255]
 v_mfma_f32_16x16x32_bf16 a[208:211],a[192:195],a[96:99],a[208:211]
 v_mfma_f32_16x16x32_bf16 a[208:211],a[196:199],a[100:103],a[208:211]
 s_add_u32 s55,s55,32768
 v_mfma_f32_16x16x32_bf16 a[212:215],a[192:195],a[104:107],a[212:215]
 s_cmp_ge_u32 s55,98304
 s_cselect_b32 s55,s54,s55
 v_mfma_f32_16x16x32_bf16 a[212:215],a[196:199],a[108:111],a[212:215]
 v_add_u32 v4,s55,v2
 v_mfma_f32_16x16x32_bf16 a[216:219],a[192:195],a[112:115],a[216:219]
 v_add_u32 v5,s55,v3
 v_mfma_f32_16x16x32_bf16 a[216:219],a[196:199],a[116:119],a[216:219]
 v_mfma_f32_16x16x32_bf16 a[220:223],a[192:195],a[120:123],a[220:223]
 v_mfma_f32_16x16x32_bf16 a[220:223],a[196:199],a[124:127],a[220:223]
 s_waitcnt vmcnt(17) lgkmcnt(0)
 s_barrier
 v_mfma_f32_16x16x32_bf16 a[224:227],a[200:203],a[64:67],a[224:227]
 ds_read_b128 a[192:195],v4 offset:0
 v_mfma_f32_16x16x32_bf16 a[224:227],a[204:207],a[68:71],a[224:227]
 ds_read_b128 a[196:199],v5 offset:0
 v_mfma_f32_16x16x32_bf16 a[228:231],a[200:203],a[72:75],a[228:231]
 v_mfma_f32_16x16x32_bf16 a[228:231],a[204:207],a[76:79],a[228:231]
 v_mfma_f32_16x16x32_bf16 a[232:235],a[200:203],a[80:83],a[232:235]
 v_mfma_f32_16x16x32_bf16 a[232:235],a[204:207],a[84:87],a[232:235]
 v_mfma_f32_16x16x32_bf16 a[236:239],a[200:203],a[88:91],a[236:239]
 v_mfma_f32_16x16x32_bf16 a[236:239],a[204:207],a[92:95],a[236:239]
 v_mfma_f32_16x16x32_bf16 a[240:243],a[200:203],a[96:99],a[240:243]
 v_mfma_f32_16x16x32_bf16 a[240:243],a[204:207],a[100:103],a[240:243]
 v_mfma_f32_16x16x32_bf16 a[244:247],a[200:203],a[104:107],a[244:247]
 v_mfma_f32_16x16x32_bf16 a[244:247],a[204:207],a[108:111],a[244:247]
 v_mfma_f32_16x16x32_bf16 a[248:251],a[200:203],a[112:115],a[248:251]
 v_mfma_f32_16x16x32_bf16 a[248:251],a[204:207],a[116:119],a[248:251]
 v_mfma_f32_16x16x32_bf16 a[252:255],a[200:203],a[120:123],a[252:255]
 v_mfma_f32_16x16x32_bf16 a[252:255],a[204:207],a[124:127],a[252:255]
 s_waitcnt lgkmcnt(0)
 v_mfma_f32_16x16x32_bf16 v[48:51],a[192:195],a[128:131],v[48:51]
 s_add_u32 m0,s51,131072
 v_mfma_f32_16x16x32_bf16 v[48:51],a[196:199],a[132:135],v[48:51]
 ds_read_b128 a[200:203],v4 offset:2048
 v_mfma_f32_16x16x32_bf16 v[52:55],a[192:195],a[136:139],v[52:55]
 v_mfma_f32_16x16x32_bf16 v[52:55],a[196:199],a[140:143],v[52:55]
 ds_read_b128 a[204:207],v5 offset:2048
 v_mfma_f32_16x16x32_bf16 v[56:59],a[192:195],a[144:147],v[56:59]
 buffer_load_dwordx4 v16,s[8:11],s32 offen offset:0 lds
 v_mfma_f32_16x16x32_bf16 v[56:59],a[196:199],a[148:151],v[56:59]
 v_mfma_f32_16x16x32_bf16 v[60:63],a[192:195],a[152:155],v[60:63]
 v_mfma_f32_16x16x32_bf16 v[60:63],a[196:199],a[156:159],v[60:63]
 buffer_load_dwordx4 v17,s[8:11],s33 offen offset:1024 lds
 v_mfma_f32_16x16x32_bf16 v[64:67],a[192:195],a[160:163],v[64:67]
 v_mfma_f32_16x16x32_bf16 v[64:67],a[196:199],a[164:167],v[64:67]
 v_mfma_f32_16x16x32_bf16 v[68:71],a[192:195],a[168:171],v[68:71]
 v_mfma_f32_16x16x32_bf16 v[68:71],a[196:199],a[172:175],v[68:71]
 buffer_load_dwordx4 v16,s[8:11],s34 offen offset:2048 lds
 v_mfma_f32_16x16x32_bf16 v[72:75],a[192:195],a[176:179],v[72:75]
 v_mfma_f32_16x16x32_bf16 v[72:75],a[196:199],a[180:183],v[72:75]
 v_mfma_f32_16x16x32_bf16 v[76:79],a[192:195],a[184:187],v[76:79]
 v_mfma_f32_16x16x32_bf16 v[76:79],a[196:199],a[188:191],v[76:79]
 s_waitcnt lgkmcnt(0)
 v_mfma_f32_16x16x32_bf16 v[80:83],a[200:203],a[128:131],v[80:83]
 buffer_load_dwordx4 v17,s[8:11],s35 offen offset:3072 lds
 v_mfma_f32_16x16x32_bf16 v[80:83],a[204:207],a[132:135],v[80:83]
 ds_read_b128 a[192:195],v4 offset:4096
 v_mfma_f32_16x16x32_bf16 v[84:87],a[200:203],a[136:139],v[84:87]
 v_mfma_f32_16x16x32_bf16 v[84:87],a[204:207],a[140:143],v[84:87]
 ds_read_b128 a[196:199],v5 offset:4096
 s_add_u32 m0,s51,135168
 v_mfma_f32_16x16x32_bf16 v[88:91],a[200:203],a[144:147],v[88:91]
 v_mfma_f32_16x16x32_bf16 v[88:91],a[204:207],a[148:151],v[88:91]
 v_mfma_f32_16x16x32_bf16 v[92:95],a[200:203],a[152:155],v[92:95]
 v_mfma_f32_16x16x32_bf16 v[92:95],a[204:207],a[156:159],v[92:95]
 buffer_load_dwordx4 v18,s[8:11],s36 offen offset:0 lds
 v_mfma_f32_16x16x32_bf16 v[96:99],a[200:203],a[160:163],v[96:99]
 v_mfma_f32_16x16x32_bf16 v[96:99],a[204:207],a[164:167],v[96:99]
 v_mfma_f32_16x16x32_bf16 v[100:103],a[200:203],a[168:171],v[100:103]
 buffer_load_dwordx4 v19,s[8:11],s37 offen offset:1024 lds
 v_mfma_f32_16x16x32_bf16 v[100:103],a[204:207],a[172:175],v[100:103]
 v_mfma_f32_16x16x32_bf16 v[104:107],a[200:203],a[176:179],v[104:107]
 v_mfma_f32_16x16x32_bf16 v[104:107],a[204:207],a[180:183],v[104:107]
 v_mfma_f32_16x16x32_bf16 v[108:111],a[200:203],a[184:187],v[108:111]
 buffer_load_dwordx4 v18,s[8:11],s38 offen offset:2048 lds
 v_mfma_f32_16x16x32_bf16 v[108:111],a[204:207],a[188:191],v[108:111]
 s_waitcnt lgkmcnt(0)
 v_mfma_f32_16x16x32_bf16 v[112:115],a[192:195],a[128:131],v[112:115]
 v_mfma_f32_16x16x32_bf16 v[112:115],a[196:199],a[132:135],v[112:115]
 ds_read_b128 a[200:203],v4 offset:6144
 v_mfma_f32_16x16x32_bf16 v[116:119],a[192:195],a[136:139],v[116:119]
 buffer_load_dwordx4 v19,s[8:11],s39 offen offset:3072 lds
 v_mfma_f32_16x16x32_bf16 v[116:119],a[196:199],a[140:143],v[116:119]
 ds_read_b128 a[204:207],v5 offset:6144
 v_mfma_f32_16x16x32_bf16 v[120:123],a[192:195],a[144:147],v[120:123]
 v_mfma_f32_16x16x32_bf16 v[120:123],a[196:199],a[148:151],v[120:123]
 v_mfma_f32_16x16x32_bf16 v[124:127],a[192:195],a[152:155],v[124:127]
 s_add_u32 s8,s8,524288
 s_addc_u32 s9,s9,0
 v_mfma_f32_16x16x32_bf16 v[124:127],a[196:199],a[156:159],v[124:127]
 v_mfma_f32_16x16x32_bf16 v[128:131],a[192:195],a[160:163],v[128:131]
 v_mfma_f32_16x16x32_bf16 v[128:131],a[196:199],a[164:167],v[128:131]
 v_mfma_f32_16x16x32_bf16 v[132:135],a[192:195],a[168:171],v[132:135]
 s_sub_u32 s10,s10,524288
 v_mfma_f32_16x16x32_bf16 v[132:135],a[196:199],a[172:175],v[132:135]
 v_mfma_f32_16x16x32_bf16 v[136:139],a[192:195],a[176:179],v[136:139]
 v_mfma_f32_16x16x32_bf16 v[136:139],a[196:199],a[180:183],v[136:139]
 v_mfma_f32_16x16x32_bf16 v[140:143],a[192:195],a[184:187],v[140:143]
 s_add_u32 m0,s50,0
 v_mfma_f32_16x16x32_bf16 v[140:143],a[196:199],a[188:191],v[140:143]
 s_waitcnt lgkmcnt(0)
 v_mfma_f32_16x16x32_bf16 v[144:147],a[200:203],a[128:131],v[144:147]
 v_mfma_f32_16x16x32_bf16 v[144:147],a[204:207],a[132:135],v[144:147]
 ds_read_b128 a[192:195],v4 offset:8192
 v_mfma_f32_16x16x32_bf16 v[148:151],a[200:203],a[136:139],v[148:151]
 buffer_load_dwordx4 v14,s[4:7],s32 offen offset:0 lds
 v_mfma_f32_16x16x32_bf16 v[148:151],a[204:207],a[140:143],v[148:151]
 ds_read_b128 a[196:199],v5 offset:8192
 v_mfma_f32_16x16x32_bf16 v[152:155],a[200:203],a[144:147],v[152:155]
 v_mfma_f32_16x16x32_bf16 v[152:155],a[204:207],a[148:151],v[152:155]
 buffer_load_dwordx4 v15,s[4:7],s33 offen offset:1024 lds
 v_mfma_f32_16x16x32_bf16 v[156:159],a[200:203],a[152:155],v[156:159]
 v_mfma_f32_16x16x32_bf16 v[156:159],a[204:207],a[156:159],v[156:159]
 v_mfma_f32_16x16x32_bf16 v[160:163],a[200:203],a[160:163],v[160:163]
 s_waitcnt vmcnt(19)
 s_barrier
 v_mfma_f32_16x16x32_bf16 v[160:163],a[204:207],a[164:167],v[160:163]
 ds_read_b64_tr_b16 a[64:65],v6 offset:0
 v_mfma_f32_16x16x32_bf16 v[164:167],a[200:203],a[168:171],v[164:167]
 buffer_load_dwordx4 v14,s[4:7],s34 offen offset:2048 lds
 v_mfma_f32_16x16x32_bf16 v[164:167],a[204:207],a[172:175],v[164:167]
 ds_read_b64_tr_b16 a[66:67],v6 offset:2048
 ds_read_b64_tr_b16 a[68:69],v6 offset:16384
 v_mfma_f32_16x16x32_bf16 v[168:171],a[200:203],a[176:179],v[168:171]
 v_mfma_f32_16x16x32_bf16 v[168:171],a[204:207],a[180:183],v[168:171]
 ds_read_b64_tr_b16 a[70:71],v6 offset:18432
 v_mfma_f32_16x16x32_bf16 v[172:175],a[200:203],a[184:187],v[172:175]
 buffer_load_dwordx4 v15,s[4:7],s35 offen offset:3072 lds
 v_mfma_f32_16x16x32_bf16 v[172:175],a[204:207],a[188:191],v[172:175]
 s_waitcnt lgkmcnt(4)
 ds_read_b64_tr_b16 a[72:73],v7 offset:0
 v_mfma_f32_16x16x32_bf16 v[176:179],a[192:195],a[128:131],v[176:179]
 ds_read_b64_tr_b16 a[74:75],v7 offset:2048
 v_mfma_f32_16x16x32_bf16 v[176:179],a[196:199],a[132:135],v[176:179]
 ds_read_b128 a[200:203],v4 offset:10240
 s_add_u32 m0,s50,4096
 v_mfma_f32_16x16x32_bf16 v[180:183],a[192:195],a[136:139],v[180:183]
 ds_read_b64_tr_b16 a[76:77],v7 offset:16384
 v_mfma_f32_16x16x32_bf16 v[180:183],a[196:199],a[140:143],v[180:183]
 ds_read_b128 a[204:207],v5 offset:10240
 ds_read_b64_tr_b16 a[78:79],v7 offset:18432
 v_mfma_f32_16x16x32_bf16 v[184:187],a[192:195],a[144:147],v[184:187]
 ds_read_b64_tr_b16 a[80:81],v8 offset:0
 v_mfma_f32_16x16x32_bf16 v[184:187],a[196:199],a[148:151],v[184:187]
 buffer_load_dwordx4 v14,s[4:7],s36 offen offset:0 lds
 v_mfma_f32_16x16x32_bf16 v[188:191],a[192:195],a[152:155],v[188:191]
 ds_read_b64_tr_b16 a[82:83],v8 offset:2048
 v_mfma_f32_16x16x32_bf16 v[188:191],a[196:199],a[156:159],v[188:191]
 ds_read_b64_tr_b16 a[84:85],v8 offset:16384
 v_mfma_f32_16x16x32_bf16 v[192:195],a[192:195],a[160:163],v[192:195]
 v_mfma_f32_16x16x32_bf16 v[192:195],a[196:199],a[164:167],v[192:195]
 buffer_load_dwordx4 v15,s[4:7],s37 offen offset:1024 lds
 v_mfma_f32_16x16x32_bf16 v[196:199],a[192:195],a[168:171],v[196:199]
 ds_read_b64_tr_b16 a[86:87],v8 offset:18432
 ds_read_b64_tr_b16 a[88:89],v9 offset:0
 v_mfma_f32_16x16x32_bf16 v[196:199],a[196:199],a[172:175],v[196:199]
 v_mfma_f32_16x16x32_bf16 v[200:203],a[192:195],a[176:179],v[200:203]
 ds_read_b64_tr_b16 a[90:91],v9 offset:2048
 v_mfma_f32_16x16x32_bf16 v[200:203],a[196:199],a[180:183],v[200:203]
 buffer_load_dwordx4 v14,s[4:7],s38 offen offset:2048 lds
 v_mfma_f32_16x16x32_bf16 v[204:207],a[192:195],a[184:187],v[204:207]
 ds_read_b64_tr_b16 a[92:93],v9 offset:16384
 v_mfma_f32_16x16x32_bf16 v[204:207],a[196:199],a[188:191],v[204:207]
 s_waitcnt lgkmcnt(8)
 ds_read_b64_tr_b16 a[94:95],v9 offset:18432
 v_mfma_f32_16x16x32_bf16 v[208:211],a[200:203],a[128:131],v[208:211]
 ds_read_b64_tr_b16 a[96:97],v10 offset:0
 v_mfma_f32_16x16x32_bf16 v[208:211],a[204:207],a[132:135],v[208:211]
 buffer_load_dwordx4 v15,s[4:7],s39 offen offset:3072 lds
 v_mfma_f32_16x16x32_bf16 v[212:215],a[200:203],a[136:139],v[212:215]
 ds_read_b128 a[192:195],v4 offset:12288
 ds_read_b64_tr_b16 a[98:99],v10 offset:2048
 v_mfma_f32_16x16x32_bf16 v[212:215],a[204:207],a[140:143],v[212:215]
 ds_read_b128 a[196:199],v5 offset:12288
 ds_read_b64_tr_b16 a[100:101],v10 offset:16384
 v_mfma_f32_16x16x32_bf16 v[216:219],a[200:203],a[144:147],v[216:219]
 s_add_u32 s4,s4,128
 s_addc_u32 s5,s5,0
 v_mfma_f32_16x16x32_bf16 v[216:219],a[204:207],a[148:151],v[216:219]
 ds_read_b64_tr_b16 a[102:103],v10 offset:18432
 v_mfma_f32_16x16x32_bf16 v[220:223],a[200:203],a[152:155],v[220:223]
 ds_read_b64_tr_b16 a[104:105],v11 offset:0
 v_mfma_f32_16x16x32_bf16 v[220:223],a[204:207],a[156:159],v[220:223]
 ds_read_b64_tr_b16 a[106:107],v11 offset:2048
 v_mfma_f32_16x16x32_bf16 v[224:227],a[200:203],a[160:163],v[224:227]
 s_sub_u32 s6,s6,128
 v_mfma_f32_16x16x32_bf16 v[224:227],a[204:207],a[164:167],v[224:227]
 ds_read_b64_tr_b16 a[108:109],v11 offset:16384
 v_mfma_f32_16x16x32_bf16 v[228:231],a[200:203],a[168:171],v[228:231]
 ds_read_b64_tr_b16 a[110:111],v11 offset:18432
 v_mfma_f32_16x16x32_bf16 v[228:231],a[204:207],a[172:175],v[228:231]
 v_mfma_f32_16x16x32_bf16 v[232:235],a[200:203],a[176:179],v[232:235]
 ds_read_b64_tr_b16 a[112:113],v12 offset:0
 s_add_u32 s50,s50,32768
 v_mfma_f32_16x16x32_bf16 v[232:235],a[204:207],a[180:183],v[232:235]
 ds_read_b64_tr_b16 a[114:115],v12 offset:2048
 v_mfma_f32_16x16x32_bf16 v[236:239],a[200:203],a[184:187],v[236:239]
 v_mfma_f32_16x16x32_bf16 v[236:239],a[204:207],a[188:191],v[236:239]
 s_waitcnt lgkmcnt(8)
 ds_read_b64_tr_b16 a[116:117],v12 offset:16384
 v_mfma_f32_16x16x32_bf16 v[240:243],a[192:195],a[128:131],v[240:243]
 s_cmp_ge_u32 s50,98304
 s_cselect_b32 s50,s51,s50
 v_mfma_f32_16x16x32_bf16 v[240:243],a[196:199],a[132:135],v[240:243]
 ds_read_b64_tr_b16 a[118:119],v12 offset:18432
 ds_read_b128 a[200:203],v4 offset:14336
 v_mfma_f32_16x16x32_bf16 v[244:247],a[192:195],a[136:139],v[244:247]
 ds_read_b64_tr_b16 a[120:121],v13 offset:0
 v_mfma_f32_16x16x32_bf16 v[244:247],a[196:199],a[140:143],v[244:247]
 ds_read_b128 a[204:207],v5 offset:14336
 ds_read_b64_tr_b16 a[122:123],v13 offset:2048
 v_mfma_f32_16x16x32_bf16 v[248:251],a[192:195],a[144:147],v[248:251]
 v_mfma_f32_16x16x32_bf16 v[248:251],a[196:199],a[148:151],v[248:251]
 ds_read_b64_tr_b16 a[124:125],v13 offset:16384
 v_mfma_f32_16x16x32_bf16 v[252:255],a[192:195],a[152:155],v[252:255]
 ds_read_b64_tr_b16 a[126:127],v13 offset:18432
 v_mfma_f32_16x16x32_bf16 v[252:255],a[196:199],a[156:159],v[252:255]
 v_mfma_f32_16x16x32_bf16 a[208:211],a[192:195],a[160:163],a[208:211]
 v_mfma_f32_16x16x32_bf16 a[208:211],a[196:199],a[164:167],a[208:211]
 s_add_u32 s55,s55,32768
 v_mfma_f32_16x16x32_bf16 a[212:215],a[192:195],a[168:171],a[212:215]
 s_cmp_ge_u32 s55,98304
 s_cselect_b32 s55,s54,s55
 v_mfma_f32_16x16x32_bf16 a[212:215],a[196:199],a[172:175],a[212:215]
 v_add_u32 v4,s55,v2
 v_mfma_f32_16x16x32_bf16 a[216:219],a[192:195],a[176:179],a[216:219]
 v_add_u32 v5,s55,v3
 v_mfma_f32_16x16x32_bf16 a[216:219],a[196:199],a[180:183],a[216:219]
 v_mfma_f32_16x16x32_bf16 a[220:223],a[192:195],a[184:187],a[220:223]
 v_mfma_f32_16x16x32_bf16 a[220:223],a[196:199],a[188:191],a[220:223]
 s_waitcnt vmcnt(17) lgkmcnt(0)
 s_barrier
 v_mfma_f32_16x16x32_bf16 a[224:227],a[200:203],a[128:131],a[224:227]
 ds_read_b128 a[192:195],v4 offset:0
 v_mfma_f32_16x16x32_bf16 a[224:227],a[204:207],a[132:135],a[224:227]
 ds_read_b128 a[196:199],v5 offset:0
 v_mfma_f32_16x16x32_bf16 a[228:231],a[200:203],a[136:139],a[228:231]
 v_mfma_f32_16x16x32_bf16 a[228:231],a[204:207],a[140:143],a[228:231]
 v_mfma_f32_16x16x32_bf16 a[232:235],a[200:203],a[144:147],a[232:235]
 v_mfma_f32_16x16x32_bf16 a[232:235],a[204:207],a[148:151],a[232:235]
 v_mfma_f32_16x16x32_bf16 a[236:239],a[200:203],a[152:155],a[236:239]
 v_mfma_f32_16x16x32_bf16 a[236:239],a[204:207],a[156:159],a[236:239]
 v_mfma_f32_16x16x32_bf16 a[240:243],a[200:203],a[160:163],a[240:243]
 v_mfma_f32_16x16x32_bf16 a[240:243],a[204:207],a[164:167],a[240:243]
 v_mfma_f32_16x16x32_bf16 a[244:247],a[200:203],a[168:171],a[244:247]
 v_mfma_f32_16x16x32_bf16 a[244:247],a[204:207],a[172:175],a[244:247]
 v_mfma_f32_16x16x32_bf16 a[248:251],a[200:203],a[176:179],a[248:251]
 v_mfma_f32_16x16x32_bf16 a[248:251],a[204:207],a[180:183],a[248:251]
 v_mfma_f32_16x16x32_bf16 a[252:255],a[200:203],a[184:187],a[252:255]
 v_mfma_f32_16x16x32_bf16 a[252:255],a[204:207],a[188:191],a[252:255]
 s_waitcnt lgkmcnt(0)
 s_cmp_eq_u32 s49,6
 s_cbranch_scc0 QS_64
 s_cmp_eq_u32 s45,0
 s_cbranch_scc0 QS_64
 s_add_u32 s61,s77,224
 s_lshl_b32 s61,s61,7
 s_add_u32 s61,s61,125829120
 v_mov_b32 v25,1
 v_mov_b32 v26,0
 s_mov_b64 exec,1
 buffer_atomic_add v25,v26,s[28:31],s61 offen sc1
 s_mov_b64 exec,-1
QS_64:
 s_cmp_eq_u32 s49,2
 s_cbranch_scc0 QL_65
 s_add_u32 s61,s46,224
 s_lshl_b32 s61,s61,7
 s_add_u32 s61,s61,125829120
 v_mov_b32 v29,s61
 v_mov_b32 v30,8
 buffer_load_dword v31,v29,s[28:31],0 offen sc1
QL_65:
 s_sub_u32 s49,s49,1
 s_cmp_lg_u32 s49,0
 s_cbranch_scc1 KVL_63
 s_getpc_b64 s[60:61]
PC_67:
 s_add_u32 s60,s60,G2T_66-PC_67
 s_addc_u32 s61,s61,(G2T_66-PC_67)>>32
 s_bfe_u32 s62,s2,0x30004
 s_lshl_b32 s62,s62,2
 s_add_u32 s62,s62,s45
 v_and_b32 v25,63,v0
 v_mul_u32_u24 v25,32,v25
 v_add_lshl_u32 v25,v25,s62,7
 v_min_u32 v25,G2T_66E-G2T_66-4,v25
 global_load_dword v24,v25,s[60:61]
G2T_66:
 v_lshrrev_b32 v16,6,v0
 v_lshl_add_u32 v14,v16,13,v1
 v_add_u32 v15,4096,v14
 s_mov_b32 s49,1103101952
 s_sub_u32 s61,15,s59
 s_min_u32 s48,s61,s59
 s_sub_u32 s41,15,s48
 s_mul_i32 s36,s46,229376
 s_add_u32 s36,s36,104857600
 s_mov_b32 s53,2
 s_mov_b32 s67,0
 s_mov_b32 s72,0
 s_mul_i32 s62,s59,3
 s_min_u32 s62,s62,30
 s_lshr_b32 s73,0x92492,s62
 s_and_b32 s73,s73,7
 s_mov_b32 s74,14
 s_lshl_b32 s62,s59,2
 s_lshr_b32 s62,0xeca86420,s62
 s_and_b32 s62,s62,15
 s_cmp_lt_u32 s59,8
 s_cselect_b32 s74,s62,s74
 s_lshl_b32 s52,s41,1
 s_sub_i32 s52,s52,16
 s_cmp_lt_i32 s52,2
 s_cselect_b32 s52,0,s52
 s_cmp_eq_u32 s52,1
 s_cselect_b32 s52,2,s52
 s_lshl_b32 s43,s41,1
 s_add_u32 s43,s43,2
 s_sub_u32 s43,s43,s52
 s_mov_b32 s39,1
 s_mov_b32 s40,2
 s_min_u32 s44,s52,1
 s_mov_b32 s50,0
 s_min_u32 s42,s52,8
 s_sub_u32 s52,s52,s42
 s_mov_b32 s34,16
 s_add_u32 s67,s46,192
 s_lshl_b32 s61,s46,3
 s_add_u32 s61,s61,s48
 s_lshl_b32 s66,s61,2
 s_add_u32 s66,s66,s45
 s_lshl_b32 s66,s66,10
 s_add_u32 s66,s66,126877696
 s_lshl_b32 s61,s61,7
 s_add_u32 s61,s61,125837312
 s_lshl_b32 s62,s46,20
 s_lshl_b32 s32,s42,15
 s_add_u32 s32,s32,s62
 s_add_u32 s33,s32,16777216
 s_lshl_b32 s47,s41,3
 s_add_u32 s47,s47,s45
 s_lshl_b32 s47,s47,13
 s_add_u32 s47,s47,s62
 s_add_u32 s47,s47,33554432
 s_lshl_b32 s63,s48,3
 s_add_u32 s63,s63,s45
 s_lshl_b32 s63,s63,13
 s_add_u32 s63,s63,s62
 s_add_u32 s63,s63,33554432
 s_add_u32 s65,s47,16777216
 s_lshl_b32 s64,s46,16
 s_add_u32 s64,s64,s51
 s_add_u32 s64,s64,100663296
 s_cmp_lg_u32 s73,0
 s_cselect_b32 s64,s64,0xf0000000
 s_cmp_eq_u32 s44,1
 s_cselect_b32 s65,s65,s64
 s_add_u32 s64,s36,65536
 s_cmp_eq_u32 s50,1
 s_cselect_b32 s35,s62,s36
 s_cselect_b32 s65,s63,s65
 s_cselect_b32 s64,s33,s64
 s_sub_u32 s38,s43,1
 s_and_b32 s63,s43,1
 s_lshl_b32 s68,s63,15
 s_add_u32 s68,s68,s51
 s_xor_b32 s69,s68,0x8000
 s_sub_u32 s63,s38,s63
 s_sub_i32 s62,s63,2
 s_cmp_ge_i32 s62,3
 s_cselect_b32 s63,s62,s63
 s_sub_i32 s62,s43,5
 s_or_b32 s62,s62,1
 s_cmp_ge_i32 s62,3
 s_cselect_b32 s63,s62,s63
 s_mul_i32 s62,s50,8
 s_cmp_le_u32 s43,s62
 s_cselect_b32 s63,-2,s63
 s_cmp_eq_u32 s53,-1
 s_cselect_b32 s53,-1,s63
 s_lshl_b32 s61,s45,14
 s_sub_u32 s61,57344,s61
 v_add_u32 v38,s61,v1
FL_68:
 v_cmp_lt_u32 vcc,v31,v30
 s_nop 4
 s_cbranch_vccz FL_68D
 s_sleep 2
 buffer_load_dword v31,v29,s[28:31],0 offen sc1
 s_waitcnt vmcnt(0)
 s_branch FL_68
FL_68D:
 s_add_u32 s61,s46,0
 s_lshl_b32 s61,s61,7
 s_add_u32 s61,s61,125829120
 v_mov_b32 v29,s61
 v_mov_b32 v30,8
 buffer_load_dword v31,v29,s[28:31],0 offen sc1
 s_and_b32 s62,s68,0x8000
 s_xor_b32 s63,s62,0x8000
 s_add_u32 s37,s32,s63
 s_add_u32 s32,s32,s62
 v_mfma_f32_16x16x32_bf16 v[48:51],a[192:195],a[64:67],v[48:51]
 s_add_u32 s61,s47,0
 v_mfma_f32_16x16x32_bf16 v[48:51],a[196:199],a[68:71],v[48:51]
 ds_read_b128 a[200:203],v4 offset:2048
 v_mfma_f32_16x16x32_bf16 v[52:55],a[192:195],a[72:75],v[52:55]
 v_mfma_f32_16x16x32_bf16 v[52:55],a[196:199],a[76:79],v[52:55]
 ds_read_b128 a[204:207],v5 offset:2048
 v_mfma_f32_16x16x32_bf16 v[56:59],a[192:195],a[80:83],v[56:59]
 buffer_load_dwordx4 a[0:3],v1,s[28:31],s61 offen offset:0 sc1
 v_mfma_f32_16x16x32_bf16 v[56:59],a[196:199],a[84:87],v[56:59]
 v_mfma_f32_16x16x32_bf16 v[60:63],a[192:195],a[88:91],v[60:63]
 buffer_load_dwordx4 a[4:7],v1,s[28:31],s61 offen offset:1024 sc1
 v_mfma_f32_16x16x32_bf16 v[60:63],a[196:199],a[92:95],v[60:63]
 v_mfma_f32_16x16x32_bf16 v[64:67],a[192:195],a[96:99],v[64:67]
 v_mfma_f32_16x16x32_bf16 v[64:67],a[196:199],a[100:103],v[64:67]
 buffer_load_dwordx4 a[8:11],v1,s[28:31],s61 offen offset:2048 sc1
 v_mfma_f32_16x16x32_bf16 v[68:71],a[192:195],a[104:107],v[68:71]
 v_mfma_f32_16x16x32_bf16 v[68:71],a[196:199],a[108:111],v[68:71]
 v_mfma_f32_16x16x32_bf16 v[72:75],a[192:195],a[112:115],v[72:75]
 buffer_load_dwordx4 a[12:15],v1,s[28:31],s61 offen offset:3072 sc1
 v_mfma_f32_16x16x32_bf16 v[72:75],a[196:199],a[116:119],v[72:75]
 v_mfma_f32_16x16x32_bf16 v[76:79],a[192:195],a[120:123],v[76:79]
 v_mfma_f32_16x16x32_bf16 v[76:79],a[196:199],a[124:127],v[76:79]
 s_waitcnt lgkmcnt(0)
 s_add_u32 s61,s47,4096
 v_mfma_f32_16x16x32_bf16 v[80:83],a[200:203],a[64:67],v[80:83]
 v_mfma_f32_16x16x32_bf16 v[80:83],a[204:207],a[68:71],v[80:83]
 ds_read_b128 a[192:195],v4 offset:4096
 v_mfma_f32_16x16x32_bf16 v[84:87],a[200:203],a[72:75],v[84:87]
 buffer_load_dwordx4 a[16:19],v1,s[28:31],s61 offen offset:0 sc1
 v_mfma_f32_16x16x32_bf16 v[84:87],a[204:207],a[76:79],v[84:87]
 ds_read_b128 a[196:199],v5 offset:4096
 v_mfma_f32_16x16x32_bf16 v[88:91],a[200:203],a[80:83],v[88:91]
 v_mfma_f32_16x16x32_bf16 v[88:91],a[204:207],a[84:87],v[88:91]
 buffer_load_dwordx4 a[20:23],v1,s[28:31],s61 offen offset:1024 sc1
 v_mfma_f32_16x16x32_bf16 v[92:95],a[200:203],a[88:91],v[92:95]
 v_mfma_f32_16x16x32_bf16 v[92:95],a[204:207],a[92:95],v[92:95]
 v_mfma_f32_16x16x32_bf16 v[96:99],a[200:203],a[96:99],v[96:99]
 buffer_load_dwordx4 a[24:27],v1,s[28:31],s61 offen offset:2048 sc1
 v_mfma_f32_16x16x32_bf16 v[96:99],a[204:207],a[100:103],v[96:99]
 v_mfma_f32_16x16x32_bf16 v[100:103],a[200:203],a[104:107],v[100:103]
 v_mfma_f32_16x16x32_bf16 v[100:103],a[204:207],a[108:111],v[100:103]
 buffer_load_dwordx4 a[28:31],v1,s[28:31],s61 offen offset:3072 sc1
 v_mfma_f32_16x16x32_bf16 v[104:107],a[200:203],a[112:115],v[104:107]
 v_mfma_f32_16x16x32_bf16 v[104:107],a[204:207],a[116:119],v[104:107]
 v_mfma_f32_16x16x32_bf16 v[108:111],a[200:203],a[120:123],v[108:111]
 s_add_u32 s61,s47,0
 v_mfma_f32_16x16x32_bf16 v[108:111],a[204:207],a[124:127],v[108:111]
 s_waitcnt lgkmcnt(0)
 v_mfma_f32_16x16x32_bf16 v[112:115],a[192:195],a[64:67],v[112:115]
 v_mfma_f32_16x16x32_bf16 v[112:115],a[196:199],a[68:71],v[112:115]
 ds_read_b128 a[200:203],v4 offset:6144
 v_mfma_f32_16x16x32_bf16 v[116:119],a[192:195],a[72:75],v[116:119]
 buffer_load_dwordx4 a[32:35],v38,s[28:31],s61 offen offset:0 sc1
 v_mfma_f32_16x16x32_bf16 v[116:119],a[196:199],a[76:79],v[116:119]
 ds_read_b128 a[204:207],v5 offset:6144
 v_mfma_f32_16x16x32_bf16 v[120:123],a[192:195],a[80:83],v[120:123]
 buffer_load_dwordx4 a[36:39],v38,s[28:31],s61 offen offset:1024 sc1
 v_mfma_f32_16x16x32_bf16 v[120:123],a[196:199],a[84:87],v[120:123]
 v_mfma_f32_16x16x32_bf16 v[124:127],a[192:195],a[88:91],v[124:127]
 v_mfma_f32_16x16x32_bf16 v[124:127],a[196:199],a[92:95],v[124:127]
 buffer_load_dwordx4 a[40:43],v38,s[28:31],s61 offen offset:2048 sc1
 v_mfma_f32_16x16x32_bf16 v[128:131],a[192:195],a[96:99],v[128:131]
 v_mfma_f32_16x16x32_bf16 v[128:131],a[196:199],a[100:103],v[128:131]
 v_mfma_f32_16x16x32_bf16 v[132:135],a[192:195],a[104:107],v[132:135]
 buffer_load_dwordx4 a[44:47],v38,s[28:31],s61 offen offset:3072 sc1
 v_mfma_f32_16x16x32_bf16 v[132:135],a[196:199],a[108:111],v[132:135]
 v_mfma_f32_16x16x32_bf16 v[136:139],a[192:195],a[112:115],v[136:139]
 v_mfma_f32_16x16x32_bf16 v[136:139],a[196:199],a[116:119],v[136:139]
 s_add_u32 s61,s47,4096
 v_mfma_f32_16x16x32_bf16 v[140:143],a[192:195],a[120:123],v[140:143]
 v_mfma_f32_16x16x32_bf16 v[140:143],a[196:199],a[124:127],v[140:143]
 s_waitcnt lgkmcnt(0)
 v_mfma_f32_16x16x32_bf16 v[144:147],a[200:203],a[64:67],v[144:147]
 buffer_load_dwordx4 a[48:51],v38,s[28:31],s61 offen offset:0 sc1
 v_mfma_f32_16x16x32_bf16 v[144:147],a[204:207],a[68:71],v[144:147]
 ds_read_b128 a[192:195],v4 offset:8192
 v_mfma_f32_16x16x32_bf16 v[148:151],a[200:203],a[72:75],v[148:151]
 v_mfma_f32_16x16x32_bf16 v[148:151],a[204:207],a[76:79],v[148:151]
 ds_read_b128 a[196:199],v5 offset:8192
 v_mfma_f32_16x16x32_bf16 v[152:155],a[200:203],a[80:83],v[152:155]
 buffer_load_dwordx4 a[52:55],v38,s[28:31],s61 offen offset:1024 sc1
 v_mfma_f32_16x16x32_bf16 v[152:155],a[204:207],a[84:87],v[152:155]
 v_mfma_f32_16x16x32_bf16 v[156:159],a[200:203],a[88:91],v[156:159]
 buffer_load_dwordx4 a[56:59],v38,s[28:31],s61 offen offset:2048 sc1
 v_mfma_f32_16x16x32_bf16 v[156:159],a[204:207],a[92:95],v[156:159]
 v_mfma_f32_16x16x32_bf16 v[160:163],a[200:203],a[96:99],v[160:163]
 s_waitcnt vmcnt(15)
 s_barrier
 v_mfma_f32_16x16x32_bf16 v[160:163],a[204:207],a[100:103],v[160:163]
 ds_read_b64_tr_b16 a[128:129],v6 offset:32768
 v_mfma_f32_16x16x32_bf16 v[164:167],a[200:203],a[104:107],v[164:167]
 buffer_load_dwordx4 a[60:63],v38,s[28:31],s61 offen offset:3072 sc1
 v_mfma_f32_16x16x32_bf16 v[164:167],a[204:207],a[108:111],v[164:167]
 ds_read_b64_tr_b16 a[130:131],v6 offset:34816
 ds_read_b64_tr_b16 a[132:133],v6 offset:49152
 v_mfma_f32_16x16x32_bf16 v[168:171],a[200:203],a[112:115],v[168:171]
 v_cmp_lt_u32 vcc,v31,v30
 v_mfma_f32_16x16x32_bf16 v[168:171],a[204:207],a[116:119],v[168:171]
 ds_read_b64_tr_b16 a[134:135],v6 offset:51200
 v_mfma_f32_16x16x32_bf16 v[172:175],a[200:203],a[120:123],v[172:175]
 ds_read_b64_tr_b16 a[136:137],v7 offset:32768
 v_mfma_f32_16x16x32_bf16 v[172:175],a[204:207],a[124:127],v[172:175]
 s_waitcnt lgkmcnt(5)
 s_cbranch_vccnz FLX_69
FLX_69R:
 v_mfma_f32_16x16x32_bf16 v[176:179],a[192:195],a[64:67],v[176:179]
 s_add_u32 m0,s51,0
 ds_read_b64_tr_b16 a[138:139],v7 offset:34816
 v_mfma_f32_16x16x32_bf16 v[176:179],a[196:199],a[68:71],v[176:179]
 ds_read_b128 a[200:203],v4 offset:10240
 ds_read_b64_tr_b16 a[140:141],v7 offset:49152
 v_mfma_f32_16x16x32_bf16 v[180:183],a[192:195],a[72:75],v[180:183]
 v_mfma_f32_16x16x32_bf16 v[180:183],a[196:199],a[76:79],v[180:183]
 ds_read_b128 a[204:207],v5 offset:10240
 ds_read_b64_tr_b16 a[142:143],v7 offset:51200
 v_mfma_f32_16x16x32_bf16 v[184:187],a[192:195],a[80:83],v[184:187]
 ds_read_b64_tr_b16 a[144:145],v8 offset:32768
 v_mfma_f32_16x16x32_bf16 v[184:187],a[196:199],a[84:87],v[184:187]
 buffer_load_dwordx4 v14,s[28:31],s32 offen offset:0 sc1 lds
 v_mfma_f32_16x16x32_bf16 v[188:191],a[192:195],a[88:91],v[188:191]
 ds_read_b64_tr_b16 a[146:147],v8 offset:34816
 v_mfma_f32_16x16x32_bf16 v[188:191],a[196:199],a[92:95],v[188:191]
 ds_read_b64_tr_b16 a[148:149],v8 offset:49152
 v_mfma_f32_16x16x32_bf16 v[192:195],a[192:195],a[96:99],v[192:195]
 v_mfma_f32_16x16x32_bf16 v[192:195],a[196:199],a[100:103],v[192:195]
 ds_read_b64_tr_b16 a[150:151],v8 offset:51200
 v_mfma_f32_16x16x32_bf16 v[196:199],a[192:195],a[104:107],v[196:199]
 ds_read_b64_tr_b16 a[152:153],v9 offset:32768
 v_mfma_f32_16x16x32_bf16 v[196:199],a[196:199],a[108:111],v[196:199]
 buffer_load_dwordx4 v14,s[28:31],s32 offen offset:1024 sc1 lds
 v_mfma_f32_16x16x32_bf16 v[200:203],a[192:195],a[112:115],v[200:203]
 ds_read_b64_tr_b16 a[154:155],v9 offset:34816
 v_mfma_f32_16x16x32_bf16 v[200:203],a[196:199],a[116:119],v[200:203]
 ds_read_b64_tr_b16 a[156:157],v9 offset:49152
 v_mfma_f32_16x16x32_bf16 v[204:207],a[192:195],a[120:123],v[204:207]
 v_mfma_f32_16x16x32_bf16 v[204:207],a[196:199],a[124:127],v[204:207]
 s_waitcnt lgkmcnt(8)
 ds_read_b64_tr_b16 a[158:159],v9 offset:51200
 v_mfma_f32_16x16x32_bf16 v[208:211],a[200:203],a[64:67],v[208:211]
 ds_read_b64_tr_b16 a[160:161],v10 offset:32768
 v_mfma_f32_16x16x32_bf16 v[208:211],a[204:207],a[68:71],v[208:211]
 buffer_load_dwordx4 v14,s[28:31],s32 offen offset:2048 sc1 lds
 v_mfma_f32_16x16x32_bf16 v[212:215],a[200:203],a[72:75],v[212:215]
 ds_read_b128 a[192:195],v4 offset:12288
 ds_read_b64_tr_b16 a[162:163],v10 offset:34816
 v_mfma_f32_16x16x32_bf16 v[212:215],a[204:207],a[76:79],v[212:215]
 ds_read_b128 a[196:199],v5 offset:12288
 ds_read_b64_tr_b16 a[164:165],v10 offset:49152
 v_mfma_f32_16x16x32_bf16 v[216:219],a[200:203],a[80:83],v[216:219]
 ds_read_b64_tr_b16 a[166:167],v10 offset:51200
 v_mfma_f32_16x16x32_bf16 v[216:219],a[204:207],a[84:87],v[216:219]
 v_mfma_f32_16x16x32_bf16 v[220:223],a[200:203],a[88:91],v[220:223]
 ds_read_b64_tr_b16 a[168:169],v11 offset:32768
 v_mfma_f32_16x16x32_bf16 v[220:223],a[204:207],a[92:95],v[220:223]
 buffer_load_dwordx4 v14,s[28:31],s32 offen offset:3072 sc1 lds
 v_mfma_f32_16x16x32_bf16 v[224:227],a[200:203],a[96:99],v[224:227]
 ds_read_b64_tr_b16 a[170:171],v11 offset:34816
 v_mfma_f32_16x16x32_bf16 v[224:227],a[204:207],a[100:103],v[224:227]
 ds_read_b64_tr_b16 a[172:173],v11 offset:49152
 v_mfma_f32_16x16x32_bf16 v[228:231],a[200:203],a[104:107],v[228:231]
 ds_read_b64_tr_b16 a[174:175],v11 offset:51200
 v_mfma_f32_16x16x32_bf16 v[228:231],a[204:207],a[108:111],v[228:231]
 v_mfma_f32_16x16x32_bf16 v[232:235],a[200:203],a[112:115],v[232:235]
 s_add_u32 m0,s51,4096
 ds_read_b64_tr_b16 a[176:177],v12 offset:32768
 v_mfma_f32_16x16x32_bf16 v[232:235],a[204:207],a[116:119],v[232:235]
 ds_read_b64_tr_b16 a[178:179],v12 offset:34816
 v_mfma_f32_16x16x32_bf16 v[236:239],a[200:203],a[120:123],v[236:239]
 v_mfma_f32_16x16x32_bf16 v[236:239],a[204:207],a[124:127],v[236:239]
 s_waitcnt lgkmcnt(8)
 ds_read_b64_tr_b16 a[180:181],v12 offset:49152
 v_mfma_f32_16x16x32_bf16 v[240:243],a[192:195],a[64:67],v[240:243]
 ds_read_b64_tr_b16 a[182:183],v12 offset:51200
 v_mfma_f32_16x16x32_bf16 v[240:243],a[196:199],a[68:71],v[240:243]
 ds_read_b128 a[200:203],v4 offset:14336
 v_mfma_f32_16x16x32_bf16 v[244:247],a[192:195],a[72:75],v[244:247]
 buffer_load_dwordx4 v15,s[28:31],s32 offen offset:0 sc1 lds
 v_mfma_f32_16x16x32_bf16 v[244:247],a[196:199],a[76:79],v[244:247]
 ds_read_b64_tr_b16 a[184:185],v13 offset:32768
 ds_read_b128 a[204:207],v5 offset:14336
 v_mfma_f32_16x16x32_bf16 v[248:251],a[192:195],a[80:83],v[248:251]
 ds_read_b64_tr_b16 a[186:187],v13 offset:34816
 v_mfma_f32_16x16x32_bf16 v[248:251],a[196:199],a[84:87],v[248:251]
 ds_read_b64_tr_b16 a[188:189],v13 offset:49152
 v_mfma_f32_16x16x32_bf16 v[252:255],a[192:195],a[88:91],v[252:255]
 ds_read_b64_tr_b16 a[190:191],v13 offset:51200
 v_mfma_f32_16x16x32_bf16 v[252:255],a[196:199],a[92:95],v[252:255]
 buffer_load_dwordx4 v15,s[28:31],s32 offen offset:1024 sc1 lds
 v_mfma_f32_16x16x32_bf16 a[208:211],a[192:195],a[96:99],a[208:211]
 v_mfma_f32_16x16x32_bf16 a[208:211],a[196:199],a[100:103],a[208:211]
 s_add_u32 s55,s55,32768
 v_mfma_f32_16x16x32_bf16 a[212:215],a[192:195],a[104:107],a[212:215]
 s_cmp_ge_u32 s55,98304
 s_cselect_b32 s55,s54,s55
 v_mfma_f32_16x16x32_bf16 a[212:215],a[196:199],a[108:111],a[212:215]
 v_add_u32 v4,s55,v2
 v_mfma_f32_16x16x32_bf16 a[216:219],a[192:195],a[112:115],a[216:219]
 v_add_u32 v5,s55,v3
 v_mfma_f32_16x16x32_bf16 a[216:219],a[196:199],a[116:119],a[216:219]
 buffer_load_dwordx4 v15,s[28:31],s32 offen offset:2048 sc1 lds
 v_mfma_f32_16x16x32_bf16 a[220:223],a[192:195],a[120:123],a[220:223]
 v_mfma_f32_16x16x32_bf16 a[220:223],a[196:199],a[124:127],a[220:223]
 s_waitcnt vmcnt(25) lgkmcnt(0)
 s_barrier
 v_mfma_f32_16x16x32_bf16 a[224:227],a[200:203],a[64:67],a[224:227]
 ds_read_b128 a[192:195],v4 offset:0
 v_mfma_f32_16x16x32_bf16 a[224:227],a[204:207],a[68:71],a[224:227]
 ds_read_b128 a[196:199],v5 offset:0
 v_mfma_f32_16x16x32_bf16 a[228:231],a[200:203],a[72:75],a[228:231]
 buffer_load_dwordx4 v15,s[28:31],s32 offen offset:3072 sc1 lds
 v_mfma_f32_16x16x32_bf16 a[228:231],a[204:207],a[76:79],a[228:231]
 v_mfma_f32_16x16x32_bf16 a[232:235],a[200:203],a[80:83],a[232:235]
 v_mfma_f32_16x16x32_bf16 a[232:235],a[204:207],a[84:87],a[232:235]
 v_mfma_f32_16x16x32_bf16 a[236:239],a[200:203],a[88:91],a[236:239]
 v_mfma_f32_16x16x32_bf16 a[236:239],a[204:207],a[92:95],a[236:239]
 v_mfma_f32_16x16x32_bf16 a[240:243],a[200:203],a[96:99],a[240:243]
 s_mov_b32 s32,s37
 v_mfma_f32_16x16x32_bf16 a[240:243],a[204:207],a[100:103],a[240:243]
 v_mfma_f32_16x16x32_bf16 a[244:247],a[200:203],a[104:107],a[244:247]
 v_mfma_f32_16x16x32_bf16 a[244:247],a[204:207],a[108:111],a[244:247]
 v_mfma_f32_16x16x32_bf16 a[248:251],a[200:203],a[112:115],a[248:251]
 v_mfma_f32_16x16x32_bf16 a[248:251],a[204:207],a[116:119],a[248:251]
 v_mfma_f32_16x16x32_bf16 a[252:255],a[200:203],a[120:123],a[252:255]
 v_mfma_f32_16x16x32_bf16 a[252:255],a[204:207],a[124:127],a[252:255]
 s_waitcnt lgkmcnt(0)
 v_mfma_f32_16x16x32_bf16 v[48:51],a[192:195],a[128:131],v[48:51]
 s_add_u32 m0,s51,32768
 v_mfma_f32_16x16x32_bf16 v[48:51],a[196:199],a[132:135],v[48:51]
 ds_read_b128 a[200:203],v4 offset:2048
 v_mfma_f32_16x16x32_bf16 v[52:55],a[192:195],a[136:139],v[52:55]
 v_mfma_f32_16x16x32_bf16 v[52:55],a[196:199],a[140:143],v[52:55]
 ds_read_b128 a[204:207],v5 offset:2048
 v_mfma_f32_16x16x32_bf16 v[56:59],a[192:195],a[144:147],v[56:59]
 buffer_load_dwordx4 v14,s[28:31],s32 offen offset:0 sc1 lds
 v_mfma_f32_16x16x32_bf16 v[56:59],a[196:199],a[148:151],v[56:59]
 v_mfma_f32_16x16x32_bf16 v[60:63],a[192:195],a[152:155],v[60:63]
 buffer_load_dwordx4 v14,s[28:31],s32 offen offset:1024 sc1 lds
 v_mfma_f32_16x16x32_bf16 v[60:63],a[196:199],a[156:159],v[60:63]
 v_mfma_f32_16x16x32_bf16 v[64:67],a[192:195],a[160:163],v[64:67]
 v_mfma_f32_16x16x32_bf16 v[64:67],a[196:199],a[164:167],v[64:67]
 buffer_load_dwordx4 v14,s[28:31],s32 offen offset:2048 sc1 lds
 v_mfma_f32_16x16x32_bf16 v[68:71],a[192:195],a[168:171],v[68:71]
 v_mfma_f32_16x16x32_bf16 v[68:71],a[196:199],a[172:175],v[68:71]
 v_mfma_f32_16x16x32_bf16 v[72:75],a[192:195],a[176:179],v[72:75]
 buffer_load_dwordx4 v14,s[28:31],s32 offen offset:3072 sc1 lds
 v_mfma_f32_16x16x32_bf16 v[72:75],a[196:199],a[180:183],v[72:75]
 v_mfma_f32_16x16x32_bf16 v[76:79],a[192:195],a[184:187],v[76:79]
 v_mfma_f32_16x16x32_bf16 v[76:79],a[196:199],a[188:191],v[76:79]
 s_waitcnt lgkmcnt(0)
 v_mfma_f32_16x16x32_bf16 v[80:83],a[200:203],a[128:131],v[80:83]
 s_add_u32 m0,s51,36864
 v_mfma_f32_16x16x32_bf16 v[80:83],a[204:207],a[132:135],v[80:83]
 ds_read_b128 a[192:195],v4 offset:4096
 v_mfma_f32_16x16x32_bf16 v[84:87],a[200:203],a[136:139],v[84:87]
 v_mfma_f32_16x16x32_bf16 v[84:87],a[204:207],a[140:143],v[84:87]
 ds_read_b128 a[196:199],v5 offset:4096
 v_mfma_f32_16x16x32_bf16 v[88:91],a[200:203],a[144:147],v[88:91]
 buffer_load_dwordx4 v15,s[28:31],s32 offen offset:0 sc1 lds
 v_mfma_f32_16x16x32_bf16 v[88:91],a[204:207],a[148:151],v[88:91]
 v_mfma_f32_16x16x32_bf16 v[92:95],a[200:203],a[152:155],v[92:95]
 buffer_load_dwordx4 v15,s[28:31],s32 offen offset:1024 sc1 lds
 v_mfma_f32_16x16x32_bf16 v[92:95],a[204:207],a[156:159],v[92:95]
 v_mfma_f32_16x16x32_bf16 v[96:99],a[200:203],a[160:163],v[96:99]
 v_mfma_f32_16x16x32_bf16 v[96:99],a[204:207],a[164:167],v[96:99]
 buffer_load_dwordx4 v15,s[28:31],s32 offen offset:2048 sc1 lds
 v_mfma_f32_16x16x32_bf16 v[100:103],a[200:203],a[168:171],v[100:103]
 v_cvt_pk_bf16_f32 v48,v48,v49
 v_cvt_pk_bf16_f32 v49,v50,v51
 v_mfma_f32_16x16x32_bf16 v[100:103],a[204:207],a[172:175],v[100:103]
 v_cvt_pk_bf16_f32 v50,v80,v81
 v_cvt_pk_bf16_f32 v51,v82,v83
 v_mfma_f32_16x16x32_bf16 v[104:107],a[200:203],a[176:179],v[104:107]
 buffer_load_dwordx4 v15,s[28:31],s32 offen offset:3072 sc1 lds
 v_mfma_f32_16x16x32_bf16 v[104:107],a[204:207],a[180:183],v[104:107]
 s_add_u32 s60,s56,0
 v_mfma_f32_16x16x32_bf16 v[108:111],a[200:203],a[184:187],v[108:111]
 buffer_store_dwordx4 v[48:51],v1,s[28:31],s60 offen sc1
 v_mfma_f32_16x16x32_bf16 v[108:111],a[204:207],a[188:191],v[108:111]
 s_waitcnt lgkmcnt(0)
 v_cvt_pk_bf16_f32 v52,v52,v53
 v_mfma_f32_16x16x32_bf16 v[112:115],a[192:195],a[128:131],v[112:115]
 v_cvt_pk_bf16_f32 v53,v54,v55
 v_cvt_pk_bf16_f32 v54,v84,v85
 v_mfma_f32_16x16x32_bf16 v[112:115],a[196:199],a[132:135],v[112:115]
 ds_read_b128 a[200:203],v4 offset:6144
 v_cvt_pk_bf16_f32 v55,v86,v87
 v_mfma_f32_16x16x32_bf16 v[116:119],a[192:195],a[136:139],v[116:119]
 v_cvt_pk_bf16_f32 v56,v56,v57
 v_cvt_pk_bf16_f32 v57,v58,v59
 v_mfma_f32_16x16x32_bf16 v[116:119],a[196:199],a[140:143],v[116:119]
 ds_read_b128 a[204:207],v5 offset:6144
 v_cvt_pk_bf16_f32 v58,v88,v89
 v_mfma_f32_16x16x32_bf16 v[120:123],a[192:195],a[144:147],v[120:123]
 v_cvt_pk_bf16_f32 v59,v90,v91
 v_cvt_pk_bf16_f32 v60,v60,v61
 v_mfma_f32_16x16x32_bf16 v[120:123],a[196:199],a[148:151],v[120:123]
 v_cvt_pk_bf16_f32 v61,v62,v63
 v_cvt_pk_bf16_f32 v62,v92,v93
 v_mfma_f32_16x16x32_bf16 v[124:127],a[192:195],a[152:155],v[124:127]
 v_cvt_pk_bf16_f32 v63,v94,v95
 v_cvt_pk_bf16_f32 v64,v64,v65
 v_mfma_f32_16x16x32_bf16 v[124:127],a[196:199],a[156:159],v[124:127]
 v_cvt_pk_bf16_f32 v65,v66,v67
 s_add_u32 s60,s56,2048
 v_mfma_f32_16x16x32_bf16 v[128:131],a[192:195],a[160:163],v[128:131]
 buffer_store_dwordx4 v[52:55],v1,s[28:31],s60 offen sc1
 v_mfma_f32_16x16x32_bf16 v[128:131],a[196:199],a[164:167],v[128:131]
 v_cvt_pk_bf16_f32 v66,v96,v97
 v_cvt_pk_bf16_f32 v67,v98,v99
 v_mfma_f32_16x16x32_bf16 v[132:135],a[192:195],a[168:171],v[132:135]
 v_mov_b32 v96,0
 v_mov_b32 v97,0
 v_mfma_f32_16x16x32_bf16 v[132:135],a[196:199],a[172:175],v[132:135]
 v_mov_b32 v98,0
 v_mov_b32 v99,0
 v_mfma_f32_16x16x32_bf16 v[136:139],a[192:195],a[176:179],v[136:139]
 v_cvt_pk_bf16_f32 v68,v68,v69
 v_cvt_pk_bf16_f32 v69,v70,v71
 v_mfma_f32_16x16x32_bf16 v[136:139],a[196:199],a[180:183],v[136:139]
 v_cvt_pk_bf16_f32 v70,v100,v101
 v_cvt_pk_bf16_f32 v71,v102,v103
 v_mfma_f32_16x16x32_bf16 v[140:143],a[192:195],a[184:187],v[140:143]
 v_mov_b32 v100,0
 v_mov_b32 v101,0
 v_mfma_f32_16x16x32_bf16 v[140:143],a[196:199],a[188:191],v[140:143]
 s_waitcnt lgkmcnt(0)
 v_mov_b32 v102,0
 v_mfma_f32_16x16x32_bf16 v[144:147],a[200:203],a[128:131],v[144:147]
 v_mov_b32 v103,0
 v_cvt_pk_bf16_f32 v72,v72,v73
 v_mfma_f32_16x16x32_bf16 v[144:147],a[204:207],a[132:135],v[144:147]
 ds_read_b128 a[192:195],v4 offset:8192
 v_cvt_pk_bf16_f32 v73,v74,v75
 v_mfma_f32_16x16x32_bf16 v[148:151],a[200:203],a[136:139],v[148:151]
 s_add_u32 s60,s56,4096
 v_mfma_f32_16x16x32_bf16 v[148:151],a[204:207],a[140:143],v[148:151]
 ds_read_b128 a[196:199],v5 offset:8192
 v_mfma_f32_16x16x32_bf16 v[152:155],a[200:203],a[144:147],v[152:155]
 buffer_store_dwordx4 v[56:59],v1,s[28:31],s60 offen sc1
 v_mfma_f32_16x16x32_bf16 v[152:155],a[204:207],a[148:151],v[152:155]
 v_cvt_pk_bf16_f32 v74,v104,v105
 v_cvt_pk_bf16_f32 v75,v106,v107
 v_mfma_f32_16x16x32_bf16 v[156:159],a[200:203],a[152:155],v[156:159]
 v_mov_b32 v104,0
 v_mov_b32 v105,0
 v_mfma_f32_16x16x32_bf16 v[156:159],a[204:207],a[156:159],v[156:159]
 v_mov_b32 v106,0
 v_mov_b32 v107,0
 v_mfma_f32_16x16x32_bf16 v[160:163],a[200:203],a[160:163],v[160:163]
 v_cvt_pk_bf16_f32 v76,v76,v77
 v_cvt_pk_bf16_f32 v77,v78,v79
 v_mfma_f32_16x16x32_bf16 v[160:163],a[204:207],a[164:167],v[160:163]
 v_cvt_pk_bf16_f32 v78,v108,v109
 v_cvt_pk_bf16_f32 v79,v110,v111
 v_mfma_f32_16x16x32_bf16 v[164:167],a[200:203],a[168:171],v[164:167]
 v_mov_b32 v108,0
 v_mov_b32 v109,0
 v_mfma_f32_16x16x32_bf16 v[164:167],a[204:207],a[172:175],v[164:167]
 v_mov_b32 v110,0
 v_mov_b32 v111,0
 v_mfma_f32_16x16x32_bf16 v[168:171],a[200:203],a[176:179],v[168:171]
 s_add_u32 s60,s56,6144
 v_mfma_f32_16x16x32_bf16 v[168:171],a[204:207],a[180:183],v[168:171]
 buffer_store_dwordx4 v[60:63],v1,s[28:31],s60 offen sc1
 v_mfma_f32_16x16x32_bf16 v[172:175],a[200:203],a[184:187],v[172:175]
 s_add_u32 s60,s56,8192
 v_mfma_f32_16x16x32_bf16 v[172:175],a[204:207],a[188:191],v[172:175]
 s_waitcnt lgkmcnt(0)
 v_mfma_f32_16x16x32_bf16 v[176:179],a[192:195],a[128:131],v[176:179]
 buffer_store_dwordx4 v[64:67],v1,s[28:31],s60 offen sc1
 v_mfma_f32_16x16x32_bf16 v[176:179],a[196:199],a[132:135],v[176:179]
 ds_read_b128 a[200:203],v4 offset:10240
 v_cvt_pk_bf16_f32 v112,v112,v113
 v_mfma_f32_16x16x32_bf16 v[180:183],a[192:195],a[136:139],v[180:183]
 v_cvt_pk_bf16_f32 v113,v114,v115
 v_cvt_pk_bf16_f32 v114,v144,v145
 v_mfma_f32_16x16x32_bf16 v[180:183],a[196:199],a[140:143],v[180:183]
 ds_read_b128 a[204:207],v5 offset:10240
 v_cvt_pk_bf16_f32 v115,v146,v147
 v_mfma_f32_16x16x32_bf16 v[184:187],a[192:195],a[144:147],v[184:187]
 v_mov_b32 v144,0
 v_mov_b32 v145,0
 v_mfma_f32_16x16x32_bf16 v[184:187],a[196:199],a[148:151],v[184:187]
 v_mov_b32 v146,0
 v_mov_b32 v147,0
 v_mfma_f32_16x16x32_bf16 v[188:191],a[192:195],a[152:155],v[188:191]
 v_cvt_pk_bf16_f32 v116,v116,v117
 v_cvt_pk_bf16_f32 v117,v118,v119
 v_mfma_f32_16x16x32_bf16 v[188:191],a[196:199],a[156:159],v[188:191]
 v_cvt_pk_bf16_f32 v118,v148,v149
 s_add_u32 s60,s56,10240
 v_mfma_f32_16x16x32_bf16 v[192:195],a[192:195],a[160:163],v[192:195]
 buffer_store_dwordx4 v[68:71],v1,s[28:31],s60 offen sc1
 v_mfma_f32_16x16x32_bf16 v[192:195],a[196:199],a[164:167],v[192:195]
 v_cvt_pk_bf16_f32 v119,v150,v151
 v_mov_b32 v148,0
 v_mfma_f32_16x16x32_bf16 v[196:199],a[192:195],a[168:171],v[196:199]
 v_mov_b32 v149,0
 v_mov_b32 v150,0
 v_mfma_f32_16x16x32_bf16 v[196:199],a[196:199],a[172:175],v[196:199]
 v_mov_b32 v151,0
 v_cvt_pk_bf16_f32 v120,v120,v121
 v_mfma_f32_16x16x32_bf16 v[200:203],a[192:195],a[176:179],v[200:203]
 v_cvt_pk_bf16_f32 v121,v122,v123
 v_cvt_pk_bf16_f32 v122,v152,v153
 v_mfma_f32_16x16x32_bf16 v[200:203],a[196:199],a[180:183],v[200:203]
 v_cvt_pk_bf16_f32 v123,v154,v155
 v_mov_b32 v152,0
 v_mfma_f32_16x16x32_bf16 v[204:207],a[192:195],a[184:187],v[204:207]
 v_mov_b32 v153,0
 v_mov_b32 v154,0
 v_mfma_f32_16x16x32_bf16 v[204:207],a[196:199],a[188:191],v[204:207]
 s_waitcnt lgkmcnt(0)
 v_mov_b32 v155,0
 v_mfma_f32_16x16x32_bf16 v[208:211],a[200:203],a[128:131],v[208:211]
 v_cvt_pk_bf16_f32 v124,v124,v125
 v_cvt_pk_bf16_f32 v125,v126,v127
 v_mfma_f32_16x16x32_bf16 v[208:211],a[204:207],a[132:135],v[208:211]
 ds_read_b128 a[192:195],v4 offset:12288
 s_add_u32 s60,s56,12288
 v_mfma_f32_16x16x32_bf16 v[212:215],a[200:203],a[136:139],v[212:215]
 v_cvt_pk_bf16_f32 v126,v156,v157
 v_mfma_f32_16x16x32_bf16 v[212:215],a[204:207],a[140:143],v[212:215]
 ds_read_b128 a[196:199],v5 offset:12288
 v_mfma_f32_16x16x32_bf16 v[216:219],a[200:203],a[144:147],v[216:219]
 buffer_store_dwordx4 v[72:75],v1,s[28:31],s60 offen sc1
 v_mfma_f32_16x16x32_bf16 v[216:219],a[204:207],a[148:151],v[216:219]
 v_cvt_pk_bf16_f32 v127,v158,v159
 v_mov_b32 v156,0
 v_mfma_f32_16x16x32_bf16 v[220:223],a[200:203],a[152:155],v[220:223]
 v_mov_b32 v157,0
 v_mov_b32 v158,0
 v_mfma_f32_16x16x32_bf16 v[220:223],a[204:207],a[156:159],v[220:223]
 v_mov_b32 v159,0
 v_cvt_pk_bf16_f32 v128,v128,v129
 v_mfma_f32_16x16x32_bf16 v[224:227],a[200:203],a[160:163],v[224:227]
 v_cvt_pk_bf16_f32 v129,v130,v131
 v_cvt_pk_bf16_f32 v130,v160,v161
 v_mfma_f32_16x16x32_bf16 v[224:227],a[204:207],a[164:167],v[224:227]
 v_cvt_pk_bf16_f32 v131,v162,v163
 v_mov_b32 v160,0
 v_mfma_f32_16x16x32_bf16 v[228:231],a[200:203],a[168:171],v[228:231]
 v_mov_b32 v161,0
 v_mov_b32 v162,0
 v_mfma_f32_16x16x32_bf16 v[228:231],a[204:207],a[172:175],v[228:231]
 v_mov_b32 v163,0
 v_cvt_pk_bf16_f32 v132,v132,v133
 v_mfma_f32_16x16x32_bf16 v[232:235],a[200:203],a[176:179],v[232:235]
 v_cvt_pk_bf16_f32 v133,v134,v135
 s_add_u32 s60,s56,14336
 v_mfma_f32_16x16x32_bf16 v[232:235],a[204:207],a[180:183],v[232:235]
 buffer_store_dwordx4 v[76:79],v1,s[28:31],s60 offen sc1
 v_mfma_f32_16x16x32_bf16 v[236:239],a[200:203],a[184:187],v[236:239]
 v_cvt_pk_bf16_f32 v134,v164,v165
 v_cvt_pk_bf16_f32 v135,v166,v167
 v_mfma_f32_16x16x32_bf16 v[236:239],a[204:207],a[188:191],v[236:239]
 s_waitcnt lgkmcnt(0)
 v_mov_b32 v164,0
 v_mfma_f32_16x16x32_bf16 v[240:243],a[192:195],a[128:131],v[240:243]
 v_mov_b32 v165,0
 v_mov_b32 v166,0
 v_mfma_f32_16x16x32_bf16 v[240:243],a[196:199],a[132:135],v[240:243]
 ds_read_b128 a[200:203],v4 offset:14336
 v_mov_b32 v167,0
 v_mfma_f32_16x16x32_bf16 v[244:247],a[192:195],a[136:139],v[244:247]
 v_cvt_pk_bf16_f32 v136,v136,v137
 v_cvt_pk_bf16_f32 v137,v138,v139
 v_mfma_f32_16x16x32_bf16 v[244:247],a[196:199],a[140:143],v[244:247]
 ds_read_b128 a[204:207],v5 offset:14336
 v_cvt_pk_bf16_f32 v138,v168,v169
 v_mfma_f32_16x16x32_bf16 v[248:251],a[192:195],a[144:147],v[248:251]
 v_cvt_pk_bf16_f32 v139,v170,v171
 v_mov_b32 v168,0
 v_mfma_f32_16x16x32_bf16 v[248:251],a[196:199],a[148:151],v[248:251]
 v_mov_b32 v169,0
 v_mov_b32 v170,0
 v_mfma_f32_16x16x32_bf16 v[252:255],a[192:195],a[152:155],v[252:255]
 v_mov_b32 v171,0
 v_cvt_pk_bf16_f32 v140,v140,v141
 v_mfma_f32_16x16x32_bf16 v[252:255],a[196:199],a[156:159],v[252:255]
 v_cvt_pk_bf16_f32 v141,v142,v143
 s_add_u32 s60,s56,1024
 v_mfma_f32_16x16x32_bf16 a[208:211],a[192:195],a[160:163],a[208:211]
 buffer_store_dwordx4 v[112:115],v1,s[28:31],s60 offen sc1
 v_mfma_f32_16x16x32_bf16 a[208:211],a[196:199],a[164:167],a[208:211]
 s_nop 1
 v_mov_b32 v112,0
 v_mfma_f32_16x16x32_bf16 a[212:215],a[192:195],a[168:171],a[212:215]
 v_mov_b32 v113,0
 v_mov_b32 v114,0
 v_mfma_f32_16x16x32_bf16 a[212:215],a[196:199],a[172:175],a[212:215]
 v_mov_b32 v115,0
 v_cvt_pk_bf16_f32 v142,v172,v173
 v_mfma_f32_16x16x32_bf16 a[216:219],a[192:195],a[176:179],a[216:219]
 v_cvt_pk_bf16_f32 v143,v174,v175
 v_mov_b32 v172,0
 v_mfma_f32_16x16x32_bf16 a[216:219],a[196:199],a[180:183],a[216:219]
 v_mov_b32 v173,0
 v_mov_b32 v174,0
 v_mfma_f32_16x16x32_bf16 a[220:223],a[192:195],a[184:187],a[220:223]
 v_mov_b32 v175,0
 v_cvt_pk_bf16_f32 v176,v176,v177
 v_mfma_f32_16x16x32_bf16 a[220:223],a[196:199],a[188:191],a[220:223]
 s_waitcnt lgkmcnt(0)
 s_barrier
 v_mfma_f32_16x16x32_bf16 a[224:227],a[200:203],a[128:131],a[224:227]
 v_cvt_pk_bf16_f32 v177,v178,v179
 s_add_u32 s60,s56,3072
 v_mfma_f32_16x16x32_bf16 a[224:227],a[204:207],a[132:135],a[224:227]
 buffer_store_dwordx4 v[116:119],v1,s[28:31],s60 offen sc1
 v_mfma_f32_16x16x32_bf16 a[228:231],a[200:203],a[136:139],a[228:231]
 s_nop 1
 v_mov_b32 v116,0
 v_mfma_f32_16x16x32_bf16 a[228:231],a[204:207],a[140:143],a[228:231]
 v_mov_b32 v117,0
 v_mov_b32 v118,0
 v_mfma_f32_16x16x32_bf16 a[232:235],a[200:203],a[144:147],a[232:235]
 v_mov_b32 v119,0
 v_cvt_pk_bf16_f32 v178,v208,v209
 v_mfma_f32_16x16x32_bf16 a[232:235],a[204:207],a[148:151],a[232:235]
 v_cvt_pk_bf16_f32 v179,v210,v211
 v_mov_b32 v208,0
 v_mfma_f32_16x16x32_bf16 a[236:239],a[200:203],a[152:155],a[236:239]
 v_mov_b32 v209,0
 v_mov_b32 v210,0
 v_mfma_f32_16x16x32_bf16 a[236:239],a[204:207],a[156:159],a[236:239]
 v_mov_b32 v211,0
 v_cvt_pk_bf16_f32 v180,v180,v181
 v_mfma_f32_16x16x32_bf16 a[240:243],a[200:203],a[160:163],a[240:243]
 v_cvt_pk_bf16_f32 v181,v182,v183
 v_cvt_pk_bf16_f32 v182,v212,v213
 v_mfma_f32_16x16x32_bf16 a[240:243],a[204:207],a[164:167],a[240:243]
 v_cvt_pk_bf16_f32 v183,v214,v215
 v_mov_b32 v212,0
 v_mfma_f32_16x16x32_bf16 a[244:247],a[200:203],a[168:171],a[244:247]
 v_mov_b32 v213,0
 v_mov_b32 v214,0
 v_mfma_f32_16x16x32_bf16 a[244:247],a[204:207],a[172:175],a[244:247]
 v_mov_b32 v215,0
 v_cvt_pk_bf16_f32 v184,v184,v185
 v_mfma_f32_16x16x32_bf16 a[248:251],a[200:203],a[176:179],a[248:251]
 v_cvt_pk_bf16_f32 v185,v186,v187
 s_add_u32 s60,s56,5120
 v_mfma_f32_16x16x32_bf16 a[248:251],a[204:207],a[180:183],a[248:251]
 buffer_store_dwordx4 v[120:123],v1,s[28:31],s60 offen sc1
 v_mfma_f32_16x16x32_bf16 a[252:255],a[200:203],a[184:187],a[252:255]
 s_nop 1
 v_mov_b32 v120,0
 v_mfma_f32_16x16x32_bf16 a[252:255],a[204:207],a[188:191],a[252:255]
 v_mov_b32 v121,0
 v_mov_b32 v122,0
 s_and_b32 s61,s68,0x8000
 v_add_u32 v20,s61,v1
 v_xor_b32 v21,0x8000,v20
 s_waitcnt vmcnt(11)
 s_barrier
 ds_read_b128 a[64:67],v20 offset:0
 ds_read_b128 a[68:71],v20 offset:1024
 ds_read_b128 a[72:75],v20 offset:2048
 ds_read_b128 a[76:79],v20 offset:3072
 ds_read_b128 a[80:83],v20 offset:4096
 ds_read_b128 a[84:87],v20 offset:5120
 ds_read_b128 a[88:91],v20 offset:6144
 ds_read_b128 a[92:95],v20 offset:7168
 ds_read_b128 a[96:99],v20 offset:8192
 ds_read_b128 a[100:103],v20 offset:9216
 ds_read_b128 a[104:107],v20 offset:10240
 ds_read_b128 a[108:111],v20 offset:11264
 ds_read_b128 a[112:115],v20 offset:12288
 v_mov_b32 v24,0
 v_mov_b32 v25,0
 v_mov_b32 v26,0
 v_mov_b32 v27,0
 v_mov_b32 v28,0
 v_mov_b32 v29,0
 v_mov_b32 v30,0
 v_mov_b32 v31,0
 v_mov_b32 v6,0
 v_mov_b32 v7,0
 v_mov_b32 v123,0
 v_cvt_pk_bf16_f32 v186,v216,v217
 v_cvt_pk_bf16_f32 v187,v218,v219
 v_mov_b32 v216,0
 v_mov_b32 v217,0
 v_mov_b32 v218,0
 v_mov_b32 v219,0
 v_cvt_pk_bf16_f32 v188,v188,v189
 v_cvt_pk_bf16_f32 v189,v190,v191
 v_cvt_pk_bf16_f32 v190,v220,v221
 v_cvt_pk_bf16_f32 v191,v222,v223
 v_mov_b32 v220,0
 v_mov_b32 v221,0
 v_mov_b32 v222,0
 v_mov_b32 v223,0
 v_cvt_pk_bf16_f32 v192,v192,v193
 s_add_u32 s60,s56,7168
 buffer_store_dwordx4 v[124:127],v1,s[28:31],s60 offen sc1
 s_nop 1
 v_mov_b32 v124,0
 v_mov_b32 v125,0
 v_mov_b32 v126,0
 v_mov_b32 v127,0
 v_cvt_pk_bf16_f32 v193,v194,v195
 v_cvt_pk_bf16_f32 v194,v224,v225
 v_cvt_pk_bf16_f32 v195,v226,v227
 v_cvt_pk_bf16_f32 v196,v196,v197
 v_cvt_pk_bf16_f32 v197,v198,v199
 v_cvt_pk_bf16_f32 v198,v228,v229
 v_cvt_pk_bf16_f32 v199,v230,v231
 v_cvt_pk_bf16_f32 v200,v200,v201
 v_cvt_pk_bf16_f32 v201,v202,v203
 v_cvt_pk_bf16_f32 v202,v232,v233
 v_cvt_pk_bf16_f32 v203,v234,v235
 v_cvt_pk_bf16_f32 v204,v204,v205
 v_cvt_pk_bf16_f32 v205,v206,v207
 v_cvt_pk_bf16_f32 v206,v236,v237
 v_cvt_pk_bf16_f32 v207,v238,v239
 s_add_u32 s60,s56,9216
 buffer_store_dwordx4 v[128:131],v1,s[28:31],s60 offen sc1
 s_nop 1
 v_mov_b32 v128,0
 v_mov_b32 v129,0
 v_mov_b32 v130,0
 v_mov_b32 v131,0
 s_add_u32 s60,s56,11264
 buffer_store_dwordx4 v[132:135],v1,s[28:31],s60 offen sc1
 s_nop 1
 v_mov_b32 v132,0
 v_mov_b32 v133,0
 v_mov_b32 v134,0
 v_mov_b32 v135,0
 s_nop 1
 v_accvgpr_read_b32 v84,a224
 v_accvgpr_read_b32 v85,a225
 v_accvgpr_read_b32 v86,a226
 v_accvgpr_read_b32 v87,a227
 v_cvt_pk_bf16_f32 v240,v240,v241
 v_cvt_pk_bf16_f32 v241,v242,v243
 v_cvt_pk_bf16_f32 v242,v84,v85
 v_cvt_pk_bf16_f32 v243,v86,v87
 s_add_u32 s60,s56,13312
 buffer_store_dwordx4 v[136:139],v1,s[28:31],s60 offen sc1
 s_nop 1
 v_mov_b32 v136,0
 v_mov_b32 v137,0
 v_mov_b32 v138,0
 v_mov_b32 v139,0
 s_nop 1
 v_accvgpr_read_b32 v92,a228
 v_accvgpr_read_b32 v93,a229
 v_accvgpr_read_b32 v94,a230
 v_accvgpr_read_b32 v95,a231
 v_cvt_pk_bf16_f32 v244,v244,v245
 v_cvt_pk_bf16_f32 v245,v246,v247
 v_cvt_pk_bf16_f32 v246,v92,v93
 v_cvt_pk_bf16_f32 v247,v94,v95
 s_nop 1
 v_accvgpr_read_b32 v84,a232
 v_accvgpr_read_b32 v85,a233
 v_accvgpr_read_b32 v86,a234
 v_accvgpr_read_b32 v87,a235
 v_cvt_pk_bf16_f32 v248,v248,v249
 s_add_u32 s60,s56,15360
 v_cvt_pk_bf16_f32 v249,v250,v251
 buffer_store_dwordx4 v[140:143],v1,s[28:31],s60 offen sc1
 s_nop 1
 v_mov_b32 v140,0
 v_mov_b32 v141,0
 v_mov_b32 v142,0
 v_mov_b32 v143,0
 v_cvt_pk_bf16_f32 v250,v84,v85
 v_cvt_pk_bf16_f32 v251,v86,v87
 s_nop 1
 v_accvgpr_read_b32 v92,a236
 v_accvgpr_read_b32 v93,a237
 v_accvgpr_read_b32 v94,a238
 v_accvgpr_read_b32 v95,a239
 v_cvt_pk_bf16_f32 v252,v252,v253
 v_cvt_pk_bf16_f32 v253,v254,v255
 v_cvt_pk_bf16_f32 v254,v92,v93
 v_cvt_pk_bf16_f32 v255,v94,v95
 s_nop 1
 v_accvgpr_read_b32 v80,a208
 v_accvgpr_read_b32 v81,a209
 v_accvgpr_read_b32 v82,a210
 s_waitcnt lgkmcnt(5)
 v_mfma_f32_16x16x32_bf16 v[32:35],a[64:67],a[0:3],0
 ds_read_b128 a[116:119],v20 offset:13312
 s_add_u32 m0,s68,65536
 s_add_u32 s60,s56,32768
 v_mfma_f32_16x16x32_bf16 v[32:35],a[68:71],a[4:7],v[32:35]
 buffer_store_dwordx4 v[176:179],v1,s[28:31],s60 offen sc1
 s_nop 1
 v_mfma_f32_16x16x32_bf16 v[32:35],a[72:75],a[8:11],v[32:35]
 ds_read_b128 a[120:123],v20 offset:14336
 v_mov_b32 v176,0
 v_mov_b32 v177,0
 v_mfma_f32_16x16x32_bf16 v[32:35],a[76:79],a[12:15],v[32:35]
 v_mov_b32 v178,0
 v_mov_b32 v179,0
 v_accvgpr_read_b32 v83,a211
 v_mfma_f32_16x16x32_bf16 v[48:51],a[64:67],a[32:35],0
 ds_read_b128 a[124:127],v20 offset:15360
 v_accvgpr_read_b32 v84,a240
 v_accvgpr_read_b32 v85,a241
 v_mfma_f32_16x16x32_bf16 v[48:51],a[68:71],a[36:39],v[48:51]
 buffer_load_dwordx4 v14,s[28:31],s33 offen offset:0 sc1 lds
 v_accvgpr_read_b32 v86,a242
 v_mfma_f32_16x16x32_bf16 v[48:51],a[72:75],a[40:43],v[48:51]
 ds_read_b128 a[128:131],v20 offset:16384
 v_accvgpr_read_b32 v87,a243
 v_cvt_pk_bf16_f32 v80,v80,v81
 v_mfma_f32_16x16x32_bf16 v[48:51],a[76:79],a[44:47],v[48:51]
 v_cvt_pk_bf16_f32 v81,v82,v83
 v_cvt_pk_bf16_f32 v82,v84,v85
 v_cvt_pk_bf16_f32 v83,v86,v87
 v_mfma_f32_16x16x32_bf16 v[32:35],a[80:83],a[16:19],v[32:35]
 ds_read_b128 a[132:135],v20 offset:17408
 s_nop 1
 v_accvgpr_read_b32 v88,a212
 v_mfma_f32_16x16x32_bf16 v[32:35],a[84:87],a[20:23],v[32:35]
 v_accvgpr_read_b32 v89,a213
 v_accvgpr_read_b32 v90,a214
 v_accvgpr_read_b32 v91,a215
 v_mfma_f32_16x16x32_bf16 v[32:35],a[88:91],a[24:27],v[32:35]
 ds_read_b128 a[136:139],v20 offset:18432
 v_accvgpr_read_b32 v92,a244
 s_add_u32 s60,s56,34816
 v_mfma_f32_16x16x32_bf16 v[32:35],a[92:95],a[28:31],v[32:35]
 buffer_load_dwordx4 v14,s[28:31],s33 offen offset:1024 sc1 lds
 v_accvgpr_read_b32 v93,a245
 v_mfma_f32_16x16x32_bf16 v[48:51],a[80:83],a[48:51],v[48:51]
 buffer_store_dwordx4 v[180:183],v1,s[28:31],s60 offen sc1
 ds_read_b128 a[140:143],v20 offset:19456
 v_mfma_f32_16x16x32_bf16 v[48:51],a[84:87],a[52:55],v[48:51]
 s_nop 1
 v_mov_b32 v180,0
 v_mov_b32 v181,0
 v_mfma_f32_16x16x32_bf16 v[48:51],a[88:91],a[56:59],v[48:51]
 ds_read_b128 a[144:147],v20 offset:20480
 v_mov_b32 v182,0
 v_mov_b32 v183,0
 v_mfma_f32_16x16x32_bf16 v[48:51],a[92:95],a[60:63],v[48:51]
 s_waitcnt lgkmcnt(5)
 v_accvgpr_read_b32 v94,a246
 v_accvgpr_read_b32 v95,a247
 v_mfma_f32_16x16x32_bf16 v[36:39],a[96:99],a[0:3],0
 buffer_load_dwordx4 v14,s[28:31],s33 offen offset:2048 sc1 lds
 v_cvt_pk_bf16_f32 v88,v88,v89
 v_mfma_f32_16x16x32_bf16 v[36:39],a[100:103],a[4:7],v[36:39]
 ds_read_b128 a[148:151],v20 offset:21504
 v_cvt_pk_bf16_f32 v89,v90,v91
 v_cvt_pk_bf16_f32 v90,v92,v93
 v_mfma_f32_16x16x32_bf16 v[36:39],a[104:107],a[8:11],v[36:39]
 ds_read_b128 a[152:155],v20 offset:22528
 v_cvt_pk_bf16_f32 v91,v94,v95
 s_add_u32 s60,s56,36864
 v_mfma_f32_16x16x32_bf16 v[36:39],a[108:111],a[12:15],v[36:39]
 buffer_store_dwordx4 v[184:187],v1,s[28:31],s60 offen sc1
 s_nop 1
 v_mfma_f32_16x16x32_bf16 v[52:55],a[96:99],a[32:35],0
 ds_read_b128 a[156:159],v20 offset:23552
 v_mov_b32 v184,0
 v_mov_b32 v185,0
 v_mfma_f32_16x16x32_bf16 v[52:55],a[100:103],a[36:39],v[52:55]
 v_mov_b32 v186,0
 v_mov_b32 v187,0
 s_add_u32 s60,s56,38912
 v_mfma_f32_16x16x32_bf16 v[52:55],a[104:107],a[40:43],v[52:55]
 buffer_load_dwordx4 v14,s[28:31],s33 offen offset:3072 sc1 lds
 v_mfma_f32_16x16x32_bf16 v[52:55],a[108:111],a[44:47],v[52:55]
 buffer_store_dwordx4 v[188:191],v1,s[28:31],s60 offen sc1
 ds_read_b128 a[160:163],v20 offset:24576
 v_mfma_f32_16x16x32_bf16 v[36:39],a[112:115],a[16:19],v[36:39]
 ds_read_b128 a[164:167],v20 offset:25600
 s_nop 1
 v_mov_b32 v188,0
 v_mfma_f32_16x16x32_bf16 v[36:39],a[116:119],a[20:23],v[36:39]
 s_add_u32 m0,s68,69632
 v_mov_b32 v189,0
 v_mov_b32 v190,0
 v_mfma_f32_16x16x32_bf16 v[36:39],a[120:123],a[24:27],v[36:39]
 ds_read_b128 a[168:171],v20 offset:26624
 v_mov_b32 v191,0
 v_mfma_f32_16x16x32_bf16 v[36:39],a[124:127],a[28:31],v[36:39]
 v_mfma_f32_16x16x32_bf16 v[52:55],a[112:115],a[48:51],v[52:55]
 ds_read_b128 a[172:175],v20 offset:27648
 s_add_u32 s60,s56,40960
 v_mfma_f32_16x16x32_bf16 v[52:55],a[116:119],a[52:55],v[52:55]
 buffer_store_dwordx4 v[192:195],v1,s[28:31],s60 offen sc1
 s_nop 1
 v_mfma_f32_16x16x32_bf16 v[52:55],a[120:123],a[56:59],v[52:55]
 ds_read_b128 a[176:179],v20 offset:28672
 v_mov_b32 v192,0
 v_mov_b32 v193,0
 v_mfma_f32_16x16x32_bf16 v[52:55],a[124:127],a[60:63],v[52:55]
 s_waitcnt lgkmcnt(5)
 v_mov_b32 v194,0
 v_mov_b32 v195,0
 v_mfma_f32_16x16x32_bf16 v[40:43],a[128:131],a[0:3],0
 buffer_load_dwordx4 v15,s[28:31],s33 offen offset:0 sc1 lds
 v_mfma_f32_16x16x32_bf16 v[40:43],a[132:135],a[4:7],v[40:43]
 ds_read_b128 a[180:183],v20 offset:29696
 v_mfma_f32_16x16x32_bf16 v[40:43],a[136:139],a[8:11],v[40:43]
 ds_read_b128 a[184:187],v20 offset:30720
 v_mfma_f32_16x16x32_bf16 v[40:43],a[140:143],a[12:15],v[40:43]
 buffer_load_dwordx4 v15,s[28:31],s33 offen offset:1024 sc1 lds
 s_add_u32 s60,s56,43008
 v_mfma_f32_16x16x32_bf16 v[56:59],a[128:131],a[32:35],0
 buffer_store_dwordx4 v[196:199],v1,s[28:31],s60 offen sc1
 ds_read_b128 a[188:191],v20 offset:31744
 v_mfma_f32_16x16x32_bf16 v[56:59],a[132:135],a[36:39],v[56:59]
 s_nop 1
 v_mov_b32 v196,0
 v_mov_b32 v197,0
 v_mfma_f32_16x16x32_bf16 v[56:59],a[136:139],a[40:43],v[56:59]
 v_mov_b32 v198,0
 v_mov_b32 v199,0
 v_mfma_f32_16x16x32_bf16 v[56:59],a[140:143],a[44:47],v[56:59]
 v_mfma_f32_16x16x32_bf16 v[40:43],a[144:147],a[16:19],v[40:43]
 buffer_load_dwordx4 v15,s[28:31],s33 offen offset:2048 sc1 lds
 v_mfma_f32_16x16x32_bf16 v[40:43],a[148:151],a[20:23],v[40:43]
 v_mfma_f32_16x16x32_bf16 v[40:43],a[152:155],a[24:27],v[40:43]
 s_add_u32 s60,s56,45056
 v_mfma_f32_16x16x32_bf16 v[40:43],a[156:159],a[28:31],v[40:43]
 buffer_store_dwordx4 v[200:203],v1,s[28:31],s60 offen sc1
 s_nop 1
 v_mfma_f32_16x16x32_bf16 v[56:59],a[144:147],a[48:51],v[56:59]
 v_mov_b32 v200,0
 v_mov_b32 v201,0
 v_mov_b32 v202,0
 v_mfma_f32_16x16x32_bf16 v[56:59],a[148:151],a[52:55],v[56:59]
 v_mov_b32 v203,0
 v_mfma_f32_16x16x32_bf16 v[56:59],a[152:155],a[56:59],v[56:59]
 buffer_load_dwordx4 v15,s[28:31],s33 offen offset:3072 sc1 lds
 v_mfma_f32_16x16x32_bf16 v[56:59],a[156:159],a[60:63],v[56:59]
 s_waitcnt lgkmcnt(0)
 v_mfma_f32_16x16x32_bf16 v[44:47],a[160:163],a[0:3],0
 v_mfma_f32_16x16x32_bf16 v[44:47],a[164:167],a[4:7],v[44:47]
 s_add_u32 s60,s56,47104
 v_mfma_f32_16x16x32_bf16 v[44:47],a[168:171],a[8:11],v[44:47]
 buffer_store_dwordx4 v[204:207],v1,s[28:31],s60 offen sc1
 s_add_u32 s33,s33,32768
 v_mfma_f32_16x16x32_bf16 v[44:47],a[172:175],a[12:15],v[44:47]
 s_nop 1
 v_mov_b32 v204,0
 v_mov_b32 v205,0
 v_mfma_f32_16x16x32_bf16 v[60:63],a[160:163],a[32:35],0
 v_mov_b32 v206,0
 v_mov_b32 v207,0
 v_mfma_f32_16x16x32_bf16 v[60:63],a[164:167],a[36:39],v[60:63]
 v_mfma_f32_16x16x32_bf16 v[60:63],a[168:171],a[40:43],v[60:63]
 v_mfma_f32_16x16x32_bf16 v[60:63],a[172:175],a[44:47],v[60:63]
 v_mfma_f32_16x16x32_bf16 v[44:47],a[176:179],a[16:19],v[44:47]
 s_add_u32 s60,s56,33792
 v_mfma_f32_16x16x32_bf16 v[44:47],a[180:183],a[20:23],v[44:47]
 buffer_store_dwordx4 v[240:243],v1,s[28:31],s60 offen sc1
 v_mfma_f32_16x16x32_bf16 v[44:47],a[184:187],a[24:27],v[44:47]
 v_mfma_f32_16x16x32_bf16 v[44:47],a[188:191],a[28:31],v[44:47]
 v_mfma_f32_16x16x32_bf16 v[60:63],a[176:179],a[48:51],v[60:63]
 v_mfma_f32_16x16x32_bf16 v[60:63],a[180:183],a[52:55],v[60:63]
 v_mfma_f32_16x16x32_bf16 v[60:63],a[184:187],a[56:59],v[60:63]
 v_mfma_f32_16x16x32_bf16 v[60:63],a[188:191],a[60:63],v[60:63]
 s_add_u32 s60,s56,35840
 s_barrier
 ds_read_b128 a[64:67],v21 offset:0
 ds_read_b128 a[68:71],v21 offset:1024
 ds_read_b128 a[72:75],v21 offset:2048
 ds_read_b128 a[76:79],v21 offset:3072
 ds_read_b128 a[80:83],v21 offset:4096
 ds_read_b128 a[84:87],v21 offset:5120
 ds_read_b128 a[88:91],v21 offset:6144
 ds_read_b128 a[92:95],v21 offset:7168
 ds_read_b128 a[96:99],v21 offset:8192
 ds_read_b128 a[100:103],v21 offset:9216
 ds_read_b128 a[104:107],v21 offset:10240
 ds_read_b128 a[108:111],v21 offset:11264
 ds_read_b128 a[112:115],v21 offset:12288
 v_max3_f32 v8,v32,v33,v34
 buffer_store_dwordx4 v[244:247],v1,s[28:31],s60 offen sc1
 v_max3_f32 v9,v48,v49,v50
 v_max3_f32 v8,v8,v35,v36
 s_add_u32 s60,s56,37888
 v_max3_f32 v9,v9,v51,v52
 v_max3_f32 v8,v8,v37,v38
 v_max3_f32 v9,v9,v53,v54
 buffer_store_dwordx4 v[248:251],v1,s[28:31],s60 offen sc1
 v_max3_f32 v8,v8,v39,v40
 v_max3_f32 v9,v9,v55,v56
 v_max3_f32 v8,v8,v41,v42
 s_add_u32 s60,s56,39936
 v_max3_f32 v9,v9,v57,v58
 v_max3_f32 v8,v8,v43,v44
 buffer_store_dwordx4 v[252:255],v1,s[28:31],s60 offen sc1
 v_max3_f32 v9,v9,v59,v60
 v_max3_f32 v8,v8,v45,v46
 v_max3_f32 v9,v9,v61,v62
 s_add_u32 s60,s56,41984
 v_max_f32 v8,v8,v47
 v_max_f32 v9,v9,v63
 v_mov_b32 v17,v8
 buffer_store_dwordx4 v[80:83],v1,s[28:31],s60 offen sc1
 v_mov_b32 v18,v9
 s_nop 1
 v_permlane16_swap_b32 v17,v8
 s_nop 1
 v_permlane16_swap_b32 v18,v9
 s_nop 0
 v_accvgpr_read_b32 v80,a216
 v_max_f32 v8,v8,v17
 v_max_f32 v9,v9,v18
 v_mov_b32 v17,v8
 v_accvgpr_read_b32 v81,a217
 v_mov_b32 v18,v9
 s_nop 1
 v_permlane32_swap_b32 v17,v8
 v_accvgpr_read_b32 v82,a218
 v_permlane32_swap_b32 v18,v9
 s_nop 0
 v_max_f32 v8,v8,v17
 v_accvgpr_read_b32 v83,a219
 v_max_f32 v9,v9,v18
 v_sub_f32 v32,v32,v8
 v_accvgpr_read_b32 v84,a248
 v_sub_f32 v33,v33,v8
 v_sub_f32 v34,v34,v8
 v_sub_f32 v35,v35,v8
 v_accvgpr_read_b32 v85,a249
 v_sub_f32 v36,v36,v8
 v_sub_f32 v37,v37,v8
 v_sub_f32 v38,v38,v8
 v_accvgpr_read_b32 v86,a250
 v_sub_f32 v39,v39,v8
 v_sub_f32 v40,v40,v8
 v_sub_f32 v41,v41,v8
 v_accvgpr_read_b32 v87,a251
 v_sub_f32 v42,v42,v8
 v_sub_f32 v43,v43,v8
 v_cvt_pk_bf16_f32 v80,v80,v81
 v_sub_f32 v44,v44,v8
 v_sub_f32 v45,v45,v8
 v_sub_f32 v46,v46,v8
 v_cvt_pk_bf16_f32 v81,v82,v83
 v_sub_f32 v47,v47,v8
 v_sub_f32 v24,v24,v8
 v_sub_f32 v25,v25,v8
 v_cvt_pk_bf16_f32 v82,v84,v85
 v_sub_f32 v26,v26,v8
 v_sub_f32 v27,v27,v8
 v_sub_f32 v48,v48,v9
 v_cvt_pk_bf16_f32 v83,v86,v87
 v_sub_f32 v49,v49,v9
 v_sub_f32 v50,v50,v9
 s_add_u32 s60,s56,44032
 v_sub_f32 v51,v51,v9
 v_sub_f32 v52,v52,v9
 v_sub_f32 v53,v53,v9
 buffer_store_dwordx4 v[88:91],v1,s[28:31],s60 offen sc1
 v_sub_f32 v54,v54,v9
 v_sub_f32 v55,v55,v9
 v_sub_f32 v56,v56,v9
 s_nop 1
 v_sub_f32 v57,v57,v9
 v_sub_f32 v58,v58,v9
 v_sub_f32 v59,v59,v9
 v_accvgpr_read_b32 v88,a220
 v_sub_f32 v60,v60,v9
 v_sub_f32 v61,v61,v9
 v_accvgpr_read_b32 v89,a221
 v_sub_f32 v62,v62,v9
 v_sub_f32 v63,v63,v9
 v_sub_f32 v28,v28,v9
 v_accvgpr_read_b32 v90,a222
 v_sub_f32 v29,v29,v9
 v_sub_f32 v30,v30,v9
 v_sub_f32 v31,v31,v9
 v_accvgpr_read_b32 v91,a223
 v_exp_f32 v32,v32
 v_exp_f32 v33,v33
 v_exp_f32 v48,v48
 v_accvgpr_read_b32 v92,a252
 v_add_f32 v6,v6,v32
 v_exp_f32 v49,v49
 v_accvgpr_read_b32 v93,a253
 v_add_f32 v6,v6,v33
 v_cvt_pk_bf16_f32 v32,v32,v33
 v_exp_f32 v34,v34
 v_accvgpr_read_b32 v94,a254
 v_add_f32 v7,v7,v48
 v_exp_f32 v35,v35
 v_add_f32 v7,v7,v49
 v_accvgpr_read_b32 v95,a255
 v_cvt_pk_bf16_f32 v48,v48,v49
 v_exp_f32 v50,v50
 v_add_f32 v6,v6,v34
 v_cvt_pk_bf16_f32 v88,v88,v89
 v_exp_f32 v51,v51
 v_add_f32 v6,v6,v35
 v_cvt_pk_bf16_f32 v89,v90,v91
 v_cvt_pk_bf16_f32 v33,v34,v35
 v_exp_f32 v36,v36
 v_add_f32 v7,v7,v50
 v_cvt_pk_bf16_f32 v90,v92,v93
 v_exp_f32 v37,v37
 v_add_f32 v7,v7,v51
 v_cvt_pk_bf16_f32 v49,v50,v51
 v_cvt_pk_bf16_f32 v91,v94,v95
 v_exp_f32 v52,v52
 v_add_f32 v6,v6,v36
 v_exp_f32 v53,v53
 s_add_u32 s60,s56,46080
 v_add_f32 v6,v6,v37
 v_cvt_pk_bf16_f32 v34,v36,v37
 buffer_store_dwordx4 v[80:83],v1,s[28:31],s60 offen sc1
 v_exp_f32 v38,v38
 v_add_f32 v7,v7,v52
 v_exp_f32 v39,v39
 s_add_u32 s60,s56,48128
 v_add_f32 v7,v7,v53
 v_cvt_pk_bf16_f32 v50,v52,v53
 v_add_f32 v6,v6,v38
 buffer_store_dwordx4 v[88:91],v1,s[28:31],s60 offen sc1
 v_add_f32 v6,v6,v39
 v_cvt_pk_bf16_f32 v35,v38,v39
 s_nop 1
 v_lshrrev_b32 v16,4,v1
 s_add_u32 s63,s43,s42
 s_lshl_b32 s62,s46,20
 v_sub_u32 v17,s63,v16
 v_add_u32 v17,2,v17
 v_cmp_le_i32 vcc,s34,v17
 v_add_u32 v18,s52,v17
 s_add_u32 s61,s62,0
 v_cndmask_b32 v17,v17,v18,vcc
 v_lshl_add_u32 v252,v17,15,s61
 v_sub_u32 v17,s63,v16
 v_add_u32 v17,1,v17
 v_cmp_le_i32 vcc,s34,v17
 v_add_u32 v18,s52,v17
 s_add_u32 s61,s62,16777216
 v_cndmask_b32 v17,v17,v18,vcc
 v_lshl_add_u32 v253,v17,15,s61
 s_add_u32 s61,s35,32768
 v_writelane_b32 v252,s35,2
 v_writelane_b32 v252,s61,1
 s_add_u32 s61,s46,16
 s_lshl_b32 s61,s61,7
 s_add_u32 s61,s61,125829120
 v_mov_b32 v5,s61
 s_add_u32 s61,s46,192
 s_lshl_b32 s61,s61,7
 s_add_u32 s61,s61,125829120
 v_writelane_b32 v5,s61,1
 v_readlane_b32 s32,v252,s43
 v_lshrrev_b32 v16,6,v0
 v_add_u32 v2,0x10000,v1
 v_and_b32 v3,15,v0
 v_bfe_u32 v17,v0,4,2
 v_lshlrev_b32 v17,2,v17
 s_add_u32 m0,s68,0
 v_sub_u32 v3,v3,v17
 v_sub_u32 v17,3,v16
 v_lshl_add_u32 v255,v17,4,v3
 v_lshl_add_u32 v3,v16,4,v3
 s_lshl_b32 s61,s45,1
 buffer_load_dwordx4 v14,s[28:31],s32 offen offset:0 sc1 lds
 s_sub_u32 s61,7,s61
 s_mul_i32 s62,s61,229376
 v_add_u32 v249,s62,v1
 v_mov_b32 v4,0xff800000
 s_mov_b32 s12,s78
 buffer_load_dwordx4 v14,s[28:31],s32 offen offset:1024 sc1 lds
 s_and_b32 s13,s79,0xffff
 s_mov_b32 s14,3670016
 s_mov_b32 s15,0x20000
 s_lshl_b32 s61,s46,3
 s_add_u32 s61,s61,s48
 buffer_load_dwordx4 v14,s[28:31],s32 offen offset:2048 sc1 lds
 s_lshl_b32 s66,s61,2
 s_add_u32 s66,s66,s45
 s_lshl_b32 s66,s66,10
 s_add_u32 s66,s66,126877696
 s_lshl_b32 s61,s61,7
 buffer_load_dwordx4 v14,s[28:31],s32 offen offset:3072 sc1 lds
 s_add_u32 s61,s61,125837312
 v_mov_b32 v240,s61
 v_mov_b32 v241,s44
 v_mov_b32 v242,0
 s_lshr_b32 s62,s46,1
 s_add_u32 m0,s68,4096
 s_add_u32 s61,s62,48
 s_lshl_b32 s61,s61,7
 s_add_u32 s61,s61,125829120
 v_writelane_b32 v240,s61,1
 s_mov_b32 s61,125836032
 buffer_load_dwordx4 v15,s[28:31],s32 offen offset:0 sc1 lds
 v_writelane_b32 v240,s61,2
 s_mov_b32 s61,125836160
 v_writelane_b32 v240,s61,3
 s_mov_b32 s61,125835520
 v_writelane_b32 v240,s61,4
 buffer_load_dwordx4 v15,s[28:31],s32 offen offset:1024 sc1 lds
 s_mov_b32 s61,125835648
 v_writelane_b32 v240,s61,5
 v_writelane_b32 v241,16,1
 v_writelane_b32 v241,16,2
 v_writelane_b32 v241,16,3
 buffer_load_dwordx4 v15,s[28:31],s32 offen offset:2048 sc1 lds
 v_writelane_b32 v241,16,4
 v_writelane_b32 v241,16,5
 s_lshl_b32 s61,s45,14
 s_sub_u32 s61,57344,s61
 v_add_u32 v243,s61,v1
 buffer_load_dwordx4 v15,s[28:31],s32 offen offset:3072 sc1 lds
 s_branch K2_PENDS
FLX_69:
FL_70:
 v_cmp_lt_u32 vcc,v31,v30
 s_nop 4
 s_cbranch_vccz FL_70D
 s_sleep 2
 buffer_load_dword v31,v29,s[28:31],0 offen sc1
 s_waitcnt vmcnt(0)
 s_branch FL_70
FL_70D:
 s_branch FLX_69R
G2T_66E:
F_ALL:
.section .rodata,"a"
.p2align 6
.amdhsa_kernel concat_heads__sliding_local_dilated__compressed_kv_cla__prompt_kernel
  .amdhsa_next_free_vgpr 512
  .amdhsa_next_free_sgpr 102
  .amdhsa_accum_offset 256
  .amdhsa_group_segment_fixed_size 0
  .amdhsa_kernarg_size 96
  .amdhsa_user_sgpr_count 2
  .amdhsa_user_sgpr_kernarg_segment_ptr 1
  .amdhsa_system_sgpr_workgroup_id_x 1
.end_amdhsa_kernel
```
